```python
import torch

def _softmax(x, axis=-1):
    return torch.softmax(x, dim=axis)
def _gelu(x):
    return torch.nn.functional.gelu(x, approximate="tanh")
def _silu(x):
    return torch.nn.functional.silu(x)
def _sigmoid(x):
    return torch.sigmoid(x)
def _layernorm(x, axis=-1, eps=1e-5):
    m = x.mean(dim=axis, keepdim=True)
    v = x.var(dim=axis, keepdim=True, unbiased=False)
    return (x - m) / torch.sqrt(v + eps)
def _scatter_add(tgt, idx, src, axis=0):
    return tgt.clone().index_add_(axis, idx, src)
def _segment_sum(src, seg, n):
    out = torch.zeros((n,) + src.shape[1:], dtype=src.dtype)
    return out.index_add_(0, seg, src)
def _pad(x, pw):
    flat = tuple(v for pair in reversed(pw) for v in pair)
    return torch.nn.functional.pad(x, flat)

kernel_name = 'recurrent_scan__sliding_block_cached__moe_arch_mod__prompt'

def setup_inputs():

    _w = (lambda a: (lambda t: t.to(torch.bfloat16) if t.is_floating_point() else t)(torch.as_tensor(a)))
    def _A_setup():
        B, Sq, D = 1, 2048, 640
        Hq, Hkv, Sk, Dh = 32, 32, 2048, 192
        assert Hq % Hkv == 0, (Hq, Hkv)
        return {
            "x": _w((lambda *s: torch.randn(*s, dtype=torch.bfloat16) * 0.05)(B, Sq, D)),
            "k_cache": _w((lambda *s: torch.randn(*s, dtype=torch.bfloat16) * 0.8)(B, Hkv, Sk, Dh)),
            "v_cache": _w((lambda *s: torch.randn(*s, dtype=torch.bfloat16) * 0.2)(B, Hkv, Sk, Dh)),
            "wq": _w((lambda *s: torch.randn(*s, dtype=torch.bfloat16) * 0.8)(D, Hq * Dh) * (D ** -0.5)),
            "wo": _w((lambda *s: torch.randn(*s, dtype=torch.bfloat16) * 0.2)(Hq * Dh, D) * ((Hq * Dh) ** -0.5)),
        }
    _A_in = _A_setup()

    def _B_setup():
        B, S, D, F, C = 1, 2048, 640, 1536, 2
        return {
            "x": _w((lambda *s: torch.randn(*s, dtype=torch.bfloat16) * 0.05)(B, S, D)),
            "w_r": _w((lambda *s: torch.randn(*s, dtype=torch.bfloat16) * 0.2)(D)),
            "w_gate": _w((lambda *s: torch.randn(*s, dtype=torch.bfloat16) * 0.1)(D, F)),
            "w_up": _w((lambda *s: torch.randn(*s, dtype=torch.bfloat16) * 0.1)(D, F)),
            "w_down": _w((lambda *s: torch.randn(*s, dtype=torch.bfloat16) * 0.1)(F, D)),
        }
    _B_in = _B_setup()

    return {
        "A_x": _A_in["x"],
        "A_k_cache": _A_in["k_cache"],
        "A_v_cache": _A_in["v_cache"],
        "A_wq": _A_in["wq"],
        "A_wo": _A_in["wo"],
        "B_x": _B_in["x"],
        "B_w_r": _B_in["w_r"],
        "B_w_gate": _B_in["w_gate"],
        "B_w_up": _B_in["w_up"],
        "B_w_down": _B_in["w_down"],
    }

def reference(A_x, A_k_cache, A_v_cache, A_wq, A_wo, B_x, B_w_r, B_w_gate, B_w_up, B_w_down):
    def _A_ref(x, k_cache, v_cache, wq, wo):
        B, Sq, D = x.shape
        Hq, Dh = 32, 192
        Hkv, Sk = k_cache.shape[1], k_cache.shape[2]
        W = min(4096, max(256, Sk // 4))
        rep = Hq // Hkv
        q = (lambda x, *d: x.permute(*d))((x @ wq).reshape(B, Sq, Hq, Dh), 0, 2, 1, 3)
        k = (lambda x, n, axis: torch.repeat_interleave(x, n, dim=axis))(k_cache[:, :, Sk - W:, :], rep, axis=1)
        v = (lambda x, n, axis: torch.repeat_interleave(x, n, dim=axis))(v_cache[:, :, Sk - W:, :], rep, axis=1)
        scores = torch.einsum("bhqd,bhkd->bhqk", q, k) * (Dh ** -0.5)
        p = _softmax(scores, axis=-1)
        o = torch.einsum("bhqk,bhkd->bhqd", p, v)
        return (lambda x, *d: x.permute(*d))(o, 0, 2, 1, 3).reshape(B, Sq, Hq * Dh) @ wo

    def _B_ref(x, w_r, w_gate, w_up, w_down):
        B, S, D = x.shape
        C = 2
        r = x @ w_r
        idx = torch.argsort(-r, axis=-1)[:, :C]
        idx_e = (lambda x, n, axis: torch.repeat_interleave(x, n, dim=axis))(idx.reshape(B, C, 1), D, axis=2)
        x_sel = (lambda x, i, axis: torch.take_along_dim(x, i, dim=axis))(x, idx_e, axis=1)
        g = _silu(x_sel @ w_gate)
        u = x_sel @ w_up
        y = (g * u) @ w_down
        r_sel = _sigmoid((lambda x, i, axis: torch.take_along_dim(x, i, dim=axis))(r, idx, axis=1))
        y = y * r_sel.reshape(B, C, 1)
        b_off = (torch.arange(B) * S).reshape(B, 1)
        flat_idx = (idx + b_off).reshape(B * C)
        zero = (x * 0.0).reshape(B * S, D)
        upd = _scatter_add(zero, flat_idx, y.reshape(B * C, D), axis=0)
        return x + upd.reshape(B, S, D)

    x = A_x
    xn = _layernorm(x, axis=-1)
    s = _A_ref(xn, A_k_cache, A_v_cache, A_wq, A_wo)
    g = _silu(_B_ref(xn, B_w_r, B_w_gate, B_w_up, B_w_down))
    return x + s * g
```

```asm
; @launch grid=(256,1,1) block=(256,1,1) lds=163840
.amdgcn_target "amdgcn-amd-amdhsa--gfx950"
.text
.globl recurrent_scan__sliding_block_cached__moe_arch_mod__prompt_kernel
.p2align 8
.type recurrent_scan__sliding_block_cached__moe_arch_mod__prompt_kernel,@function
recurrent_scan__sliding_block_cached__moe_arch_mod__prompt_kernel:
    s_cmp_ge_u32 s2, 256
    s_cbranch_scc1 main_end
    s_load_dwordx16 s[64:79], s[0:1], 0
    s_load_dwordx4 s[80:83], s[0:1], 64
    s_load_dwordx2 s[84:85], s[0:1], 80
    s_load_dwordx2 s[86:87], s[0:1], 96
    s_lshr_b32 s56, s2, 3
    s_lshl_b32 s56, s56, 11
    v_lshrrev_b32 v17, 4, v0
    v_lshlrev_b32 v17, 7, v17
    v_add_u32 v17, s56, v17
    s_getpc_b64 s[88:89]
    global_load_dword a220, v17, s[88:89]
    v_lshrrev_b32 v17, 6, v0
    v_lshlrev_b32 v17, 12, v17
    v_and_b32 v1, 63, v0
    v_lshl_add_u32 v17, v1, 4, v17
    v_and_b32 v1, 63, v0
    v_lshrrev_b32 v29, 6, v0
    v_mov_b32 v16, v0
    v_readfirstlane_b32 s3, v29
    s_and_b32 s53, s2, 7
    s_lshr_b32 s52, s2, 5
    s_bfe_u32 s51, s2, 0x20003
    s_lshl_b32 s50, s53, 2
    s_add_u32 s50, s50, s51
    s_lshl_b32 s60, s2, 3
    s_lshl_b32 s56, s3, 1
    s_add_u32 s60, s60, s56
    v_bfe_u32 v240, v1, 2, 1
    v_add_u32 v240, s60, v240
    v_lshrrev_b32 v241, 3, v1
    v_lshlrev_b32 v241, 6, v241
    v_and_b32 v29, 3, v1
    v_lshl_add_u32 v241, v29, 4, v241
    v_mul_u32_u24 v242, 1280, v240
    v_add_u32 v242, v242, v241
    v_lshrrev_b32 v29, 4, v1
    v_lshlrev_b32 v29, 1, v29
    v_and_b32 v7, 7, v1
    v_xor_b32 v7, v7, v29
    v_lshlrev_b32 v7, 4, v7
    v_lshrrev_b32 v29, 5, v1
    v_lshlrev_b32 v29, 3, v29
    v_bfe_u32 v5, v1, 3, 2
    v_add_u32 v5, v5, v29
    v_mul_u32_u24 v2, 12288, v5
    v_add_u32 v2, v2, v7
    v_add_u32 v3, 196608, v2
    s_lshl_b32 s54, s52, 2
    s_add_u32 s54, s54, s3
    s_mul_i32 s49, s3, 6144
    s_lshr_b32 s59, s3, 1
    s_lshl_b32 s59, s59, 5
    s_and_b32 s56, s3, 1
    s_lshl_b32 s56, s56, 2
    s_add_u32 s59, s59, s56
    s_mul_i32 s36, s59, 12288
    s_mov_b32 s37, 786432
    s_add_u32 s45, s51, s52
    s_and_b32 s45, s45, 3
    s_lshl_b32 s45, s45, 2
    s_lshr_b32 s45, 0x5050, s45
    s_and_b32 s45, s45, 15
    s_mul_i32 s56, s45, 786432
    s_add_u32 s36, s36, s56
    s_lshl_b32 s45, s45, 13
    s_lshr_b32 s56, s2, 3
    s_lshl_b32 s56, s56, 8
    v_add_u32 v22, s56, v16
    s_mov_b32 s56, 357913942
    v_mul_hi_u32 v23, s56, v22
    v_mul_u32_u24 v24, 12, v23
    v_sub_u32 v24, v22, v24
    v_mul_u32_u24 v23, 12288, v23
    v_lshl_add_u32 v23, v24, 7, v23
    s_mul_i32 s40, s51, 384
    s_sub_u32 s40, 1572864, s40
    v_lshlrev_b32 v24, 7, v1
    s_mul_i32 s47, s50, 786432
    s_add_u32 s47, s47, 589824
    s_lshl_b32 s48, s52, 13
    s_mul_i32 s56, s50, 384
    s_sub_u32 s57, 7864320, s56
    s_waitcnt lgkmcnt(0)
    s_mov_b32 s12, s64
    s_and_b32 s13, s65, 0xffff
    s_mov_b32 s14, 2621440
    s_mov_b32 s15, 0x00020000
    s_mov_b32 s16, s76
    s_and_b32 s17, s77, 0xffff
    s_mov_b32 s18, 1280
    s_mov_b32 s19, 0x00020000
    buffer_load_dwordx4 v[64:67], v242, s[12:15], 0 offen
    buffer_load_dwordx4 v[68:71], v242, s[12:15], 0 offen offset:512
    buffer_load_dwordx4 v[72:75], v242, s[12:15], 0 offen offset:1024
    v_mov_b32 v25, 3203072
    global_load_dword v26, v25, s[86:87] sc1
    s_lshr_b32 s44, s2, 3
    s_lshl_b32 s44, s44, 7
    s_add_u32 s44, s44, 4784128
    s_load_dword s92, s[86:87], s44 glc
    s_lshr_b32 s58, s2, 4
    s_lshl_b32 s58, s58, 14
    s_and_b32 s44, s2, 15
    s_lshl_b32 s44, s44, 2
    s_add_u32 s44, s44, s3
    s_lshl_b32 s44, s44, 7
    s_add_u32 s58, s58, s44
    s_add_u32 s58, s58, 4456448
    v_and_b32 v27, 31, v1
    v_lshlrev_b32 v27, 2, v27
    v_lshrrev_b32 v25, 5, v1
    v_lshl_add_u32 v27, v25, 13, v27
    v_add_u32 v27, s58, v27
    global_store_dword v27, v1, s[86:87] sc1
    buffer_load_dwordx4 v[76:79], v241, s[16:19], 0 offen offset:0
    buffer_load_dwordx4 v[80:83], v241, s[16:19], 0 offen offset:512
    buffer_load_dwordx4 v[84:87], v241, s[16:19], 0 offen offset:1024
    s_add_u32 s8, s70, s56
    s_addc_u32 s9, s71, 0
    s_and_b32 s9, s9, 0xffff
    s_mov_b32 s10, s57
    s_mov_b32 s11, 0x00020000
    s_add_u32 m0, s49, 49152
    s_nop 0
    buffer_load_dwordx4 v2, s[8:11], s36 offen offset:0 lds
    s_add_u32 m0, s49, 50048
    s_nop 0
    buffer_load_dwordx4 v2, s[8:11], s36 offen offset:128 lds
    s_add_u32 m0, s49, 50944
    s_nop 0
    buffer_load_dwordx4 v2, s[8:11], s36 offen offset:256 lds
    s_add_u32 m0, s49, 52224
    s_nop 0
    buffer_load_dwordx4 v3, s[8:11], s36 offen offset:0 lds
    s_add_u32 m0, s49, 53120
    s_nop 0
    buffer_load_dwordx4 v3, s[8:11], s36 offen offset:128 lds
    s_add_u32 m0, s49, 54016
    s_nop 0
    buffer_load_dwordx4 v3, s[8:11], s36 offen offset:256 lds
    s_add_u32 s36, s36, s37
    s_sub_u32 s55, s36, 7864320
    s_min_u32 s36, s36, s55
    s_mov_b32 s24, s86
    s_and_b32 s25, s87, 0xffff
    s_mov_b32 s26, 268435456
    s_mov_b32 s27, 0x00020000
    s_lshl_b32 s56, s2, 2
    s_add_u32 s56, s56, s3
    s_cmp_lt_u32 s56, 20
    s_cselect_b32 s57, 0, 0x70000000
    s_add_u32 s57, s57, 3670016
    s_lshl_b32 s56, s56, 10
    s_add_u32 s56, s56, s57
    v_mov_b32 v160, 0
    v_mov_b32 v161, 0
    v_mov_b32 v162, 0
    v_mov_b32 v163, 0
    v_lshlrev_b32 v164, 4, v1
    buffer_store_dwordx4 v[160:163], v164, s[24:27], s56 offen sc1
    v_lshrrev_b32 v243, 6, v240
    v_mul_u32_u24 v243, 81920, v243
    v_bfe_u32 v29, v240, 4, 2
    v_lshl_add_u32 v243, v29, 10, v243
    v_and_b32 v29, 15, v240
    v_lshl_add_u32 v243, v29, 6, v243
    v_lshrrev_b32 v29, 3, v1
    v_lshl_add_u32 v243, v29, 12, v243
    v_and_b32 v29, 3, v1
    v_lshl_add_u32 v243, v29, 4, v243
    s_mov_b32 s38, 0x3acccccd
    s_mov_b32 s39, 0x3727c5ac
    s_mov_b32 s41, 0
    s_mov_b32 s42, 32768
    s_mov_b32 s43, 65536
    v_bfe_u32 v29, v1, 2, 3
    v_lshlrev_b32 v12, 7, v29
    v_lshrrev_b32 v29, 1, v29
    v_xor_b32 v29, 0, v29
    v_lshl_add_u32 v12, v29, 5, v12
    v_and_b32 v29, 3, v1
    v_lshl_add_u32 v12, v29, 3, v12
    v_lshrrev_b32 v29, 5, v1
    v_mul_u32_u24 v29, 3072, v29
    v_add_u32 v12, v12, v29
    v_xor_b32 v13, 32, v12
    v_xor_b32 v14, 64, v12
    v_xor_b32 v15, 96, v12
    v_add_u32 v8, 49152, v12
    v_add_u32 v9, 49152, v13
    v_add_u32 v10, 49152, v14
    v_add_u32 v11, 49152, v15
    v_and_b32 v28, 15, v1
    v_lshlrev_b32 v28, 6, v28
    v_lshrrev_b32 v29, 4, v1
    v_lshl_add_u32 v28, v29, 4, v28
    s_mul_i32 s56, s54, 81920
    s_add_u32 s56, s56, 0
    s_add_u32 s20, s86, s56
    s_addc_u32 s21, s87, 0
    s_and_b32 s21, s21, 0xffff
    s_mov_b32 s22, 81920
    s_mov_b32 s23, 0x00020000
    s_lshl_b32 s46, s54, 7
    s_add_u32 s46, s46, 4784128
    s_mov_b32 s101, 0
    s_bitcmp1_b32 s53, 1
    s_cselect_b32 s56, 0x4000, 0
    s_add_u32 s46, s46, s56
    s_and_b32 s56, s53, 1
    s_lshl_b32 s56, s56, 12
    s_add_u32 s46, s46, s56
    s_load_dword s47, s[86:87], s46 glc
    s_load_dword s48, s[86:87], s46 offset:0x2000 glc
    s_lshr_b32 s6, s2, 3
    s_lshl_b32 s6, s6, 7
    s_lshl_b32 s56, s53, 2
    s_add_u32 s6, s6, s56
    s_add_u32 s6, s6, 4784128
    s_cmp_eq_u32 s3, 0
    s_cselect_b32 s6, s6, 0x70000000
    v_lshlrev_b32 v20, 12, v1
    s_mov_b64 exec, 0
    s_cmp_eq_u32 s3, 0
    s_cbranch_scc1 pg_0
    s_cmp_eq_u32 s3, 1
    s_cbranch_scc1 pg_1
    s_cmp_eq_u32 s3, 2
    s_cbranch_scc1 pg_2
    s_cmp_eq_u32 s3, 3
    s_cbranch_scc1 pg_3
pg_ret:
    s_mov_b64 exec, -1
    s_waitcnt vmcnt(12)
    v_lshlrev_b32 v96, 16, v64
    v_and_b32 v97, 0xffff0000, v64
    v_lshlrev_b32 v98, 16, v65
    v_and_b32 v99, 0xffff0000, v65
    v_lshlrev_b32 v100, 16, v66
    v_and_b32 v101, 0xffff0000, v66
    v_lshlrev_b32 v102, 16, v67
    v_and_b32 v103, 0xffff0000, v67
    v_lshlrev_b32 v104, 16, v68
    v_and_b32 v105, 0xffff0000, v68
    v_lshlrev_b32 v106, 16, v69
    v_and_b32 v107, 0xffff0000, v69
    v_lshlrev_b32 v108, 16, v70
    v_and_b32 v109, 0xffff0000, v70
    v_lshlrev_b32 v110, 16, v71
    v_and_b32 v111, 0xffff0000, v71
    v_lshlrev_b32 v112, 16, v72
    v_and_b32 v113, 0xffff0000, v72
    v_lshlrev_b32 v114, 16, v73
    v_and_b32 v115, 0xffff0000, v73
    v_lshlrev_b32 v116, 16, v74
    v_and_b32 v117, 0xffff0000, v74
    v_lshlrev_b32 v118, 16, v75
    v_and_b32 v119, 0xffff0000, v75
    v_pk_add_f32 v[120:121], v[96:97], v[98:99]
    v_pk_add_f32 v[122:123], v[100:101], v[102:103]
    v_pk_add_f32 v[120:121], v[120:121], v[104:105]
    v_pk_add_f32 v[122:123], v[122:123], v[106:107]
    v_pk_add_f32 v[120:121], v[120:121], v[108:109]
    v_pk_add_f32 v[122:123], v[122:123], v[110:111]
    s_mov_b32 exec_hi, 0
    v_pk_add_f32 v[120:121], v[120:121], v[112:113]
    v_pk_add_f32 v[122:123], v[122:123], v[114:115]
    v_pk_add_f32 v[120:121], v[120:121], v[116:117]
    v_pk_add_f32 v[122:123], v[122:123], v[118:119]
    s_mov_b64 exec, -1
    v_pk_add_f32 v[120:121], v[120:121], v[122:123]
    v_add_f32 v120, v120, v121
    s_nop 1
    v_add_f32_dpp v120, v120, v120 quad_perm:[1,0,3,2] row_mask:0xf bank_mask:0xf
    s_nop 1
    v_add_f32_dpp v120, v120, v120 quad_perm:[2,3,0,1] row_mask:0xf bank_mask:0xf
    s_nop 1
    v_add_f32_dpp v120, v120, v120 row_ror:8 row_mask:0xf bank_mask:0xf
    v_mov_b32 v124, v120
    s_nop 1
    v_permlane16_swap_b32 v120, v124
    s_nop 1
    v_add_f32 v120, v120, v124
    v_mov_b32 v124, v120
    s_nop 1
    v_permlane32_swap_b32 v120, v124
    s_nop 1
    v_add_f32 v120, v120, v124
    v_mul_f32 v126, s38, v120
    v_mul_f32 v128, s38, -v120
    v_mul_f32 v129, s38, -v120
    v_pk_add_f32 v[132:133], v[96:97], v[128:129]
    v_pk_mul_f32 v[120:121], v[132:133], v[132:133]
    v_pk_add_f32 v[134:135], v[98:99], v[128:129]
    v_pk_mul_f32 v[122:123], v[134:135], v[134:135]
    v_pk_add_f32 v[136:137], v[100:101], v[128:129]
    v_pk_fma_f32 v[120:121], v[136:137], v[136:137], v[120:121]
    v_pk_add_f32 v[138:139], v[102:103], v[128:129]
    v_pk_fma_f32 v[122:123], v[138:139], v[138:139], v[122:123]
    v_pk_add_f32 v[132:133], v[104:105], v[128:129]
    v_pk_fma_f32 v[120:121], v[132:133], v[132:133], v[120:121]
    v_pk_add_f32 v[134:135], v[106:107], v[128:129]
    v_pk_fma_f32 v[122:123], v[134:135], v[134:135], v[122:123]
    v_pk_add_f32 v[136:137], v[108:109], v[128:129]
    v_pk_fma_f32 v[120:121], v[136:137], v[136:137], v[120:121]
    v_pk_add_f32 v[138:139], v[110:111], v[128:129]
    v_pk_fma_f32 v[122:123], v[138:139], v[138:139], v[122:123]
    s_mov_b32 exec_hi, 0
    v_pk_add_f32 v[132:133], v[112:113], v[128:129]
    v_pk_fma_f32 v[120:121], v[132:133], v[132:133], v[120:121]
    v_pk_add_f32 v[134:135], v[114:115], v[128:129]
    v_pk_fma_f32 v[122:123], v[134:135], v[134:135], v[122:123]
    v_pk_add_f32 v[136:137], v[116:117], v[128:129]
    v_pk_fma_f32 v[120:121], v[136:137], v[136:137], v[120:121]
    v_pk_add_f32 v[138:139], v[118:119], v[128:129]
    v_pk_fma_f32 v[122:123], v[138:139], v[138:139], v[122:123]
    s_mov_b64 exec, -1
    v_pk_add_f32 v[120:121], v[120:121], v[122:123]
    v_add_f32 v120, v120, v121
    s_nop 1
    v_add_f32_dpp v120, v120, v120 quad_perm:[1,0,3,2] row_mask:0xf bank_mask:0xf
    s_nop 1
    v_add_f32_dpp v120, v120, v120 quad_perm:[2,3,0,1] row_mask:0xf bank_mask:0xf
    s_nop 1
    v_add_f32_dpp v120, v120, v120 row_ror:8 row_mask:0xf bank_mask:0xf
    v_mov_b32 v124, v120
    s_nop 1
    v_permlane16_swap_b32 v120, v124
    s_nop 1
    v_add_f32 v120, v120, v124
    v_mov_b32 v124, v120
    s_nop 1
    v_permlane32_swap_b32 v120, v124
    s_nop 1
    v_add_f32 v120, v120, v124
    v_mul_f32 v130, s38, v120
    v_cvt_pk_bf16_f32 v126, v126, v126
    v_and_b32 v126, 0xffff0000, v126
    v_cvt_pk_bf16_f32 v130, v130, v130
    v_and_b32 v130, 0xffff0000, v130
    v_add_f32 v130, s39, v130
    v_cvt_pk_bf16_f32 v130, v130, v130
    v_and_b32 v130, 0xffff0000, v130
    v_sqrt_f32 v130, v130
    v_sub_f32 v128, 0, v126
    v_cvt_pk_bf16_f32 v130, v130, v130
    v_and_b32 v130, 0xffff0000, v130
    v_rcp_f32 v127, v130
    v_sub_f32 v129, 0, v126
    v_mul_f32 v120, 0x3dd53b95, v127
    v_mul_f32 v121, 0x3dd53b95, v127
    v_mov_b32 v130, v127
    v_mov_b32 v131, v127
    v_pk_add_f32 v[96:97], v[96:97], v[128:129]
    v_pk_mul_f32 v[132:133], v[96:97], v[120:121]
    v_cvt_pk_bf16_f32 v144, v132, v133
    v_pk_add_f32 v[98:99], v[98:99], v[128:129]
    v_pk_mul_f32 v[134:135], v[98:99], v[120:121]
    v_cvt_pk_bf16_f32 v145, v134, v135
    v_pk_add_f32 v[100:101], v[100:101], v[128:129]
    v_pk_mul_f32 v[136:137], v[100:101], v[120:121]
    v_cvt_pk_bf16_f32 v146, v136, v137
    v_pk_add_f32 v[102:103], v[102:103], v[128:129]
    v_pk_mul_f32 v[138:139], v[102:103], v[120:121]
    v_cvt_pk_bf16_f32 v147, v138, v139
    buffer_store_dwordx4 v[144:147], v243, s[24:27], s41 offen sc1
    v_pk_add_f32 v[104:105], v[104:105], v[128:129]
    v_pk_mul_f32 v[132:133], v[104:105], v[120:121]
    v_cvt_pk_bf16_f32 v148, v132, v133
    v_pk_add_f32 v[106:107], v[106:107], v[128:129]
    v_pk_mul_f32 v[134:135], v[106:107], v[120:121]
    v_cvt_pk_bf16_f32 v149, v134, v135
    v_pk_add_f32 v[108:109], v[108:109], v[128:129]
    v_pk_mul_f32 v[136:137], v[108:109], v[120:121]
    v_cvt_pk_bf16_f32 v150, v136, v137
    v_pk_add_f32 v[110:111], v[110:111], v[128:129]
    v_pk_mul_f32 v[138:139], v[110:111], v[120:121]
    v_cvt_pk_bf16_f32 v151, v138, v139
    buffer_store_dwordx4 v[148:151], v243, s[24:27], s42 offen sc1
    v_pk_add_f32 v[112:113], v[112:113], v[128:129]
    v_pk_mul_f32 v[132:133], v[112:113], v[120:121]
    v_cvt_pk_bf16_f32 v152, v132, v133
    v_pk_add_f32 v[114:115], v[114:115], v[128:129]
    v_pk_mul_f32 v[134:135], v[114:115], v[120:121]
    v_cvt_pk_bf16_f32 v153, v134, v135
    v_pk_add_f32 v[116:117], v[116:117], v[128:129]
    v_pk_mul_f32 v[136:137], v[116:117], v[120:121]
    v_cvt_pk_bf16_f32 v154, v136, v137
    v_pk_add_f32 v[118:119], v[118:119], v[128:129]
    v_pk_mul_f32 v[138:139], v[118:119], v[120:121]
    v_cvt_pk_bf16_f32 v155, v138, v139
    s_mov_b32 exec_hi, 0
    buffer_store_dwordx4 v[152:155], v243, s[24:27], s43 offen sc1
    s_mov_b64 exec, -1
    s_branch pg_start
    .p2align 12
pg_0:
    s_cbranch_execz pg_ret
pg_start:
    s_waitcnt vmcnt(10)
    v_readfirstlane_b32 s7, v26
    v_cvt_pk_bf16_f32 v64, v96, v97
    v_lshlrev_b32 v96, 16, v64
    v_and_b32 v97, 0xffff0000, v64
    v_pk_mul_f32 v[96:97], v[96:97], v[130:131]
    v_cvt_pk_bf16_f32 v64, v96, v97
    v_lshlrev_b32 v96, 16, v64
    v_and_b32 v97, 0xffff0000, v64
    v_lshlrev_b32 v132, 16, v76
    v_and_b32 v133, 0xffff0000, v76
    v_pk_mul_f32 v[120:121], v[96:97], v[132:133]
    s_add_u32 m0, s49, 73728
    s_nop 0
    buffer_load_dwordx4 v2, s[8:11], s36 offen offset:0 lds
    s_add_u32 m0, s49, 74624
    s_nop 0
    buffer_load_dwordx4 v2, s[8:11], s36 offen offset:128 lds
    v_cvt_pk_bf16_f32 v65, v98, v99
    v_lshlrev_b32 v98, 16, v65
    v_and_b32 v99, 0xffff0000, v65
    v_pk_mul_f32 v[98:99], v[98:99], v[130:131]
    v_cvt_pk_bf16_f32 v65, v98, v99
    v_lshlrev_b32 v98, 16, v65
    v_and_b32 v99, 0xffff0000, v65
    v_lshlrev_b32 v134, 16, v77
    v_and_b32 v135, 0xffff0000, v77
    v_pk_mul_f32 v[122:123], v[98:99], v[134:135]
    s_add_u32 m0, s49, 75520
    s_nop 0
    buffer_load_dwordx4 v2, s[8:11], s36 offen offset:256 lds
    s_add_u32 m0, s49, 76800
    s_nop 0
    buffer_load_dwordx4 v3, s[8:11], s36 offen offset:0 lds
    v_cvt_pk_bf16_f32 v66, v100, v101
    v_lshlrev_b32 v100, 16, v66
    v_and_b32 v101, 0xffff0000, v66
    v_pk_mul_f32 v[100:101], v[100:101], v[130:131]
    v_cvt_pk_bf16_f32 v66, v100, v101
    v_lshlrev_b32 v100, 16, v66
    v_and_b32 v101, 0xffff0000, v66
    v_lshlrev_b32 v136, 16, v78
    v_and_b32 v137, 0xffff0000, v78
    v_pk_fma_f32 v[120:121], v[100:101], v[136:137], v[120:121]
    s_add_u32 m0, s49, 77696
    s_nop 0
    buffer_load_dwordx4 v3, s[8:11], s36 offen offset:128 lds
    s_add_u32 m0, s49, 78592
    s_nop 0
    buffer_load_dwordx4 v3, s[8:11], s36 offen offset:256 lds
    s_add_u32 s36, s36, s37
    s_sub_u32 s55, s36, 7864320
    s_min_u32 s36, s36, s55
    v_cvt_pk_bf16_f32 v67, v102, v103
    v_lshlrev_b32 v102, 16, v67
    v_and_b32 v103, 0xffff0000, v67
    v_pk_mul_f32 v[102:103], v[102:103], v[130:131]
    v_cvt_pk_bf16_f32 v67, v102, v103
    v_lshlrev_b32 v102, 16, v67
    v_and_b32 v103, 0xffff0000, v67
    v_lshlrev_b32 v138, 16, v79
    v_and_b32 v139, 0xffff0000, v79
    v_pk_fma_f32 v[122:123], v[102:103], v[138:139], v[122:123]
    s_add_u32 m0, s49, 98304
    s_nop 0
    buffer_load_dwordx4 v2, s[8:11], s36 offen offset:0 lds
    s_add_u32 m0, s49, 99200
    s_nop 0
    buffer_load_dwordx4 v2, s[8:11], s36 offen offset:128 lds
    v_cvt_pk_bf16_f32 v68, v104, v105
    v_lshlrev_b32 v104, 16, v68
    v_and_b32 v105, 0xffff0000, v68
    v_pk_mul_f32 v[104:105], v[104:105], v[130:131]
    v_cvt_pk_bf16_f32 v68, v104, v105
    v_lshlrev_b32 v104, 16, v68
    v_and_b32 v105, 0xffff0000, v68
    v_lshlrev_b32 v132, 16, v80
    v_and_b32 v133, 0xffff0000, v80
    v_pk_fma_f32 v[120:121], v[104:105], v[132:133], v[120:121]
    s_add_u32 m0, s49, 100096
    s_nop 0
    buffer_load_dwordx4 v2, s[8:11], s36 offen offset:256 lds
    s_add_u32 m0, s49, 101376
    s_nop 0
    buffer_load_dwordx4 v3, s[8:11], s36 offen offset:0 lds
    s_waitcnt vmcnt(10) lgkmcnt(0)
    s_lshr_b32 s7, s7, 4
    s_mul_i32 s7, s7, 0x2c9277b5
    s_add_u32 s7, s7, 0x6c564b05
    s_lshl_b32 s7, s7, 4
    s_barrier
    v_mov_b32 v21, s7
    s_mov_b64 exec, 255
    buffer_store_dword v21, v20, s[24:27], s6 offen sc1
    s_mov_b64 exec, 0x11
    v_lshlrev_b32 v29, 3, v240
    s_mov_b32 s56, 3211264
    buffer_store_dwordx2 v[126:127], v29, s[24:27], s56 offen sc1
    s_mov_b64 exec, -1
    v_cvt_pk_bf16_f32 v69, v106, v107
    v_lshlrev_b32 v106, 16, v69
    v_and_b32 v107, 0xffff0000, v69
    v_pk_mul_f32 v[106:107], v[106:107], v[130:131]
    v_cvt_pk_bf16_f32 v69, v106, v107
    v_lshlrev_b32 v106, 16, v69
    v_and_b32 v107, 0xffff0000, v69
    v_lshlrev_b32 v134, 16, v81
    v_and_b32 v135, 0xffff0000, v81
    v_pk_fma_f32 v[122:123], v[106:107], v[134:135], v[122:123]
    s_add_u32 m0, s49, 102272
    s_nop 0
    buffer_load_dwordx4 v3, s[8:11], s36 offen offset:128 lds
    s_add_u32 m0, s49, 103168
    s_nop 0
    buffer_load_dwordx4 v3, s[8:11], s36 offen offset:256 lds
    s_add_u32 s36, s36, s37
    s_sub_u32 s55, s36, 7864320
    s_min_u32 s36, s36, s55
    v_cvt_pk_bf16_f32 v70, v108, v109
    v_lshlrev_b32 v108, 16, v70
    v_and_b32 v109, 0xffff0000, v70
    v_pk_mul_f32 v[108:109], v[108:109], v[130:131]
    v_cvt_pk_bf16_f32 v70, v108, v109
    v_lshlrev_b32 v108, 16, v70
    v_and_b32 v109, 0xffff0000, v70
    v_lshlrev_b32 v136, 16, v82
    v_and_b32 v137, 0xffff0000, v82
    v_pk_fma_f32 v[120:121], v[108:109], v[136:137], v[120:121]
    s_add_u32 m0, s49, 122880
    s_nop 0
    buffer_load_dwordx4 v2, s[8:11], s36 offen offset:0 lds
    s_add_u32 m0, s49, 123776
    s_nop 0
    buffer_load_dwordx4 v2, s[8:11], s36 offen offset:128 lds
    v_cvt_pk_bf16_f32 v71, v110, v111
    v_lshlrev_b32 v110, 16, v71
    v_and_b32 v111, 0xffff0000, v71
    v_pk_mul_f32 v[110:111], v[110:111], v[130:131]
    v_cvt_pk_bf16_f32 v71, v110, v111
    v_lshlrev_b32 v110, 16, v71
    v_and_b32 v111, 0xffff0000, v71
    v_lshlrev_b32 v138, 16, v83
    v_and_b32 v139, 0xffff0000, v83
    v_pk_fma_f32 v[122:123], v[110:111], v[138:139], v[122:123]
    s_add_u32 m0, s49, 124672
    s_nop 0
    buffer_load_dwordx4 v2, s[8:11], s36 offen offset:256 lds
    s_add_u32 m0, s49, 125952
    s_nop 0
    buffer_load_dwordx4 v3, s[8:11], s36 offen offset:0 lds
    s_mov_b32 exec_hi, 0
    v_cvt_pk_bf16_f32 v72, v112, v113
    v_lshlrev_b32 v112, 16, v72
    v_and_b32 v113, 0xffff0000, v72
    v_pk_mul_f32 v[112:113], v[112:113], v[130:131]
    v_cvt_pk_bf16_f32 v72, v112, v113
    v_lshlrev_b32 v112, 16, v72
    v_and_b32 v113, 0xffff0000, v72
    v_lshlrev_b32 v132, 16, v84
    v_and_b32 v133, 0xffff0000, v84
    v_pk_fma_f32 v[120:121], v[112:113], v[132:133], v[120:121]
    s_waitcnt lgkmcnt(0)
    s_mov_b32 s63, -1
    s_load_dword s4, s[86:87], s58 offset:0x2000 glc
    s_load_dword s63, s[86:87], s58 glc
    s_waitcnt lgkmcnt(1)
    v_cvt_pk_bf16_f32 v73, v114, v115
    v_lshlrev_b32 v114, 16, v73
    v_and_b32 v115, 0xffff0000, v73
    v_pk_mul_f32 v[114:115], v[114:115], v[130:131]
    v_cvt_pk_bf16_f32 v73, v114, v115
    v_lshlrev_b32 v114, 16, v73
    v_and_b32 v115, 0xffff0000, v73
    v_lshlrev_b32 v134, 16, v85
    v_and_b32 v135, 0xffff0000, v85
    v_pk_fma_f32 v[122:123], v[114:115], v[134:135], v[122:123]
    s_and_b32 s93, s63, 0x2000
    s_add_u32 s46, s46, s93
    s_getreg_b32 s61, hwreg(HW_REG_XCC_ID, 2, 1)
    s_mul_i32 s61, s61, 0x6000
    s_lshl_b32 s93, s93, 1
    s_xor_b32 s93, s93, s61
    v_cvt_pk_bf16_f32 v74, v116, v117
    v_lshlrev_b32 v116, 16, v74
    v_and_b32 v117, 0xffff0000, v74
    v_pk_mul_f32 v[116:117], v[116:117], v[130:131]
    v_cvt_pk_bf16_f32 v74, v116, v117
    v_lshlrev_b32 v116, 16, v74
    v_and_b32 v117, 0xffff0000, v74
    v_lshlrev_b32 v136, 16, v86
    v_and_b32 v137, 0xffff0000, v86
    v_pk_fma_f32 v[120:121], v[116:117], v[136:137], v[120:121]
    v_cvt_pk_bf16_f32 v75, v118, v119
    v_lshlrev_b32 v118, 16, v75
    v_and_b32 v119, 0xffff0000, v75
    v_pk_mul_f32 v[118:119], v[118:119], v[130:131]
    v_cvt_pk_bf16_f32 v75, v118, v119
    v_lshlrev_b32 v118, 16, v75
    v_and_b32 v119, 0xffff0000, v75
    v_lshlrev_b32 v138, 16, v87
    v_and_b32 v139, 0xffff0000, v87
    v_pk_fma_f32 v[122:123], v[118:119], v[138:139], v[122:123]
    s_mov_b64 exec, -1
    v_pk_add_f32 v[120:121], v[120:121], v[122:123]
    v_add_f32 v120, v120, v121
    s_nop 1
    v_add_f32_dpp v120, v120, v120 quad_perm:[1,0,3,2] row_mask:0xf bank_mask:0xf
    s_nop 1
    v_add_f32_dpp v120, v120, v120 quad_perm:[2,3,0,1] row_mask:0xf bank_mask:0xf
    s_nop 1
    v_add_f32_dpp v120, v120, v120 row_ror:8 row_mask:0xf bank_mask:0xf
    v_mov_b32 v124, v120
    s_nop 1
    v_permlane16_swap_b32 v120, v124
    s_nop 1
    v_add_f32 v120, v120, v124
    v_mov_b32 v124, v120
    s_nop 1
    v_permlane32_swap_b32 v120, v124
    s_nop 1
    v_add_f32 v120, v120, v124
    v_cvt_pk_bf16_f32 v120, v120, v120
    v_and_b32 v120, 0xffff0000, v120
    v_ashrrev_i32 v122, 31, v120
    v_or_b32 v122, 0x80000000, v122
    v_xor_b32 v120, v120, v122
    v_and_b32 v120, 0xffff0000, v120
    v_sub_u32 v122, 2047, v240
    v_or_b32 v120, v120, v122
    s_nop 1
    v_mov_b32_dpp v121, v120 row_ror:4 row_mask:0xf bank_mask:0xf
    v_mov_b32 v122, s7
    v_mov_b32 v123, s93
    s_lshl_b32 s56, s2, 2
    s_add_u32 s56, s56, s3
    s_lshl_b32 s56, s56, 4
    s_add_u32 s56, s56, 3162112
    v_mov_b32 v29, 0
    s_mov_b64 exec, 1
    s_waitcnt vmcnt(6)
    buffer_store_dwordx4 v[120:123], v29, s[24:27], s56 offen sc1
    s_mov_b64 exec, -1
    s_add_u32 m0, s49, 126848
    s_nop 0
    buffer_load_dwordx4 v3, s[8:11], s36 offen offset:128 lds
    s_add_u32 m0, s49, 127744
    s_nop 0
    buffer_load_dwordx4 v3, s[8:11], s36 offen offset:256 lds
    s_add_u32 s36, s36, s37
    s_sub_u32 s55, s36, 7864320
    s_min_u32 s36, s36, s55
spin_ln:
    s_load_dwordx8 s[28:35], s[86:87], s46 glc
    s_add_u32 s101, s101, 1
    s_cmp_gt_u32 s101, 0x2000000
    s_cselect_b32 s57, 0, -1
    s_waitcnt lgkmcnt(0)
    s_xor_b32 s56, s28, s7
    s_xor_b32 s29, s29, s7
    s_or_b32 s56, s56, s29
    s_xor_b32 s30, s30, s7
    s_or_b32 s56, s56, s30
    s_xor_b32 s31, s31, s7
    s_or_b32 s56, s56, s31
    s_xor_b32 s32, s32, s7
    s_or_b32 s56, s56, s32
    s_xor_b32 s33, s33, s7
    s_or_b32 s56, s56, s33
    s_xor_b32 s34, s34, s7
    s_or_b32 s56, s56, s34
    s_xor_b32 s35, s35, s7
    s_or_b32 s56, s56, s35
    s_and_b32 s56, s56, s57
    s_cbranch_scc1 spin_ln
z_skip:
    s_add_u32 s46, s45, 0
    s_sub_u32 s5, s46, 81920
    s_min_u32 s46, s46, s5
    buffer_load_dwordx4 a[0:3], v28, s[20:23], s46 offen offset:0 sc1
    buffer_load_dwordx4 a[4:7], v28, s[20:23], s46 offen offset:1024 sc1
    buffer_load_dwordx4 a[8:11], v28, s[20:23], s46 offen offset:2048 sc1
    buffer_load_dwordx4 a[12:15], v28, s[20:23], s46 offen offset:3072 sc1
    s_add_u32 s46, s45, 4096
    s_sub_u32 s5, s46, 81920
    s_min_u32 s46, s46, s5
    buffer_load_dwordx4 a[16:19], v28, s[20:23], s46 offen offset:0 sc1
    buffer_load_dwordx4 a[20:23], v28, s[20:23], s46 offen offset:1024 sc1
    buffer_load_dwordx4 a[24:27], v28, s[20:23], s46 offen offset:2048 sc1
    buffer_load_dwordx4 a[28:31], v28, s[20:23], s46 offen offset:3072 sc1
    s_mov_b64 exec, 0
    s_cmp_eq_u32 s3, 0
    s_cbranch_scc1 pg_4
    s_cmp_eq_u32 s3, 1
    s_cbranch_scc1 pg_5
    s_cmp_eq_u32 s3, 2
    s_cbranch_scc1 pg_6
    s_cmp_eq_u32 s3, 3
    s_cbranch_scc1 pg_7
pg_ret2:
    s_mov_b64 exec, -1
    s_waitcnt vmcnt(33)
    s_barrier
    ds_read_b64_tr_b16 a[192:193], v8 offset:0
    ds_read_b64_tr_b16 a[194:195], v8 offset:6144
    ds_read_b64_tr_b16 a[196:197], v9 offset:0
    ds_read_b64_tr_b16 a[198:199], v9 offset:6144
    ds_read_b64_tr_b16 a[200:201], v10 offset:0
    ds_read_b64_tr_b16 a[202:203], v10 offset:6144
    ds_read_b64_tr_b16 a[204:205], v11 offset:0
    ds_read_b64_tr_b16 a[206:207], v11 offset:6144
    s_waitcnt lgkmcnt(4)
    s_waitcnt vmcnt(4)
head_code:
    v_mfma_f32_16x16x32_bf16 v[64:67], a[192:195], a[0:3], 0
    s_add_u32 s46, s45, 8192
    ds_read_b64_tr_b16 a[208:209], v8 offset:1024
    s_sub_u32 s77, s46, 81920
    v_mfma_f32_16x16x32_bf16 v[68:71], a[196:199], a[0:3], 0
    s_min_u32 s46, s46, s77
    ds_read_b64_tr_b16 a[210:211], v8 offset:7168
    v_mfma_f32_16x16x32_bf16 v[76:79], a[196:199], a[4:7], 0
    buffer_load_dwordx4 a[32:35], v28, s[20:23], s46 offen offset:0 sc1
    v_mfma_f32_16x16x32_bf16 v[72:75], a[192:195], a[4:7], 0
    v_mfma_f32_16x16x32_bf16 v[80:83], a[192:195], a[8:11], 0
    ds_read_b64_tr_b16 a[212:213], v9 offset:1024
    v_mfma_f32_16x16x32_bf16 v[84:87], a[196:199], a[8:11], 0
    ds_read_b64_tr_b16 a[214:215], v9 offset:7168
    v_mfma_f32_16x16x32_bf16 v[92:95], a[196:199], a[12:15], 0
    v_mfma_f32_16x16x32_bf16 v[88:91], a[192:195], a[12:15], 0
    s_waitcnt lgkmcnt(4)
    v_mfma_f32_16x16x32_bf16 v[120:123], a[200:203], a[12:15], 0
    ds_read_b64_tr_b16 a[192:193], v10 offset:1024
    v_mul_u32_u24 v56, 3072, v5
    v_mfma_f32_16x16x32_bf16 v[124:127], a[204:207], a[12:15], 0
    ds_read_b64_tr_b16 a[194:195], v10 offset:7168
    v_add_u32 v56, v56, v7
    v_mfma_f32_16x16x32_bf16 v[116:119], a[204:207], a[8:11], 0
    buffer_load_dwordx4 a[36:39], v28, s[20:23], s46 offen offset:1024 sc1
    v_mfma_f32_16x16x32_bf16 v[112:115], a[200:203], a[8:11], 0
    v_add_u32 v57, 49152, v56
    v_lshrrev_b32 v29, 3, v1
    v_mfma_f32_16x16x32_bf16 v[104:107], a[200:203], a[4:7], 0
    ds_read_b64_tr_b16 a[196:197], v11 offset:1024
    v_mul_u32_u24 v62, 1280, v29
    v_mfma_f32_16x16x32_bf16 v[108:111], a[204:207], a[4:7], 0
    ds_read_b64_tr_b16 a[198:199], v11 offset:7168
    v_add_u32 v62, v62, v7
    v_mfma_f32_16x16x32_bf16 v[100:103], a[204:207], a[0:3], 0
    v_add_u32 v63, 10240, v62
    v_mul_u32_u24 v31, 384, v29
    v_mfma_f32_16x16x32_bf16 v[96:99], a[200:203], a[0:3], 0
    s_waitcnt lgkmcnt(4)
    v_add_u32 v6, v31, v7
    v_add_u32 v7, 3072, v6
    v_mfma_f32_16x16x32_bf16 v[128:131], a[208:211], a[0:3], 0
    ds_read_b64_tr_b16 a[200:201], v8 offset:2048
    v_bfe_u32 v29, v1, 4, 1
    v_mfma_f32_16x16x32_bf16 v[132:135], a[212:215], a[0:3], 0
    ds_read_b64_tr_b16 a[202:203], v8 offset:8192
    v_bfe_u32 v30, v1, 5, 1
    v_mfma_f32_16x16x32_bf16 v[140:143], a[212:215], a[4:7], 0
    buffer_load_dwordx4 a[40:43], v28, s[20:23], s46 offen offset:2048 sc1
    v_mfma_f32_16x16x32_bf16 v[136:139], a[208:211], a[4:7], 0
    v_lshl_add_u32 v29, v29, 1, v30
    v_and_b32 v30, 7, v1
    v_mfma_f32_16x16x32_bf16 v[144:147], a[208:211], a[8:11], 0
    ds_read_b64_tr_b16 a[204:205], v9 offset:2048
    v_xor_b32 v30, v30, v29
    v_mfma_f32_16x16x32_bf16 v[148:151], a[212:215], a[8:11], 0
    ds_read_b64_tr_b16 a[206:207], v9 offset:8192
    v_lshl_add_u32 v4, v30, 4, v31
    v_mfma_f32_16x16x32_bf16 v[156:159], a[212:215], a[12:15], 0
    buffer_load_dwordx4 a[44:47], v28, s[20:23], s46 offen offset:3072 sc1
    v_mfma_f32_16x16x32_bf16 v[152:155], a[208:211], a[12:15], 0
    s_waitcnt lgkmcnt(4)
    v_xor_b32 v30, 4, v30
    v_lshl_add_u32 v5, v30, 4, v31
    v_mfma_f32_16x16x32_bf16 v[184:187], a[192:195], a[12:15], 0
    s_add_u32 s46, s45, 12288
    ds_read_b64_tr_b16 a[208:209], v10 offset:2048
    v_add_u32 v5, 3072, v5
    v_mfma_f32_16x16x32_bf16 v[188:191], a[196:199], a[12:15], 0
    s_sub_u32 s77, s46, 81920
    ds_read_b64_tr_b16 a[210:211], v10 offset:8192
    v_bfe_u32 v30, v1, 1, 1
    v_mfma_f32_16x16x32_bf16 v[180:183], a[196:199], a[8:11], 0
    s_min_u32 s46, s46, s77
    v_bfe_u32 v31, v1, 2, 1
    v_lshl_add_u32 v30, v30, 1, v31
    v_mfma_f32_16x16x32_bf16 v[176:179], a[192:195], a[8:11], 0
    v_bfe_u32 v31, v1, 3, 1
    v_lshl_add_u32 v30, v31, 2, v30
    v_mfma_f32_16x16x32_bf16 v[168:171], a[192:195], a[4:7], 0
    ds_read_b64_tr_b16 a[212:213], v11 offset:2048
    v_xor_b32 v30, v30, v29
    v_mfma_f32_16x16x32_bf16 v[172:175], a[196:199], a[4:7], 0
    ds_read_b64_tr_b16 a[214:215], v11 offset:8192
    v_lshlrev_b32 v30, 4, v30
    v_mfma_f32_16x16x32_bf16 v[164:167], a[196:199], a[0:3], 0
    buffer_load_dwordx4 a[48:51], v28, s[20:23], s46 offen offset:0 sc1
    v_mfma_f32_16x16x32_bf16 v[160:163], a[192:195], a[0:3], 0
    s_waitcnt lgkmcnt(4)
    v_mul_u32_u24 v31, 3072, v31
    v_and_b32 v29, 7, v1
    v_mfma_f32_16x16x32_bf16 v[192:195], a[200:203], a[0:3], 0
    ds_read_b64_tr_b16 a[192:193], v8 offset:12288
    v_lshl_add_u32 v31, v29, 7, v31
    v_mfma_f32_16x16x32_bf16 v[196:199], a[204:207], a[0:3], 0
    ds_read_b64_tr_b16 a[194:195], v8 offset:18432
    v_subrev_u32 v31, s49, v31
    v_mfma_f32_16x16x32_bf16 v[204:207], a[204:207], a[4:7], 0
    buffer_load_dwordx4 a[52:55], v28, s[20:23], s46 offen offset:1024 sc1
    v_mfma_f32_16x16x32_bf16 v[200:203], a[200:203], a[4:7], 0
    v_add_u32 v18, v31, v30
    v_xor_b32 v30, 64, v30
    v_mfma_f32_16x16x32_bf16 v[208:211], a[200:203], a[8:11], 0
    ds_read_b64_tr_b16 a[196:197], v9 offset:12288
    v_add_u32 v19, v31, v30
    v_mfma_f32_16x16x32_bf16 v[212:215], a[204:207], a[8:11], 0
    s_mul_i32 s56, s50, 786432
    ds_read_b64_tr_b16 a[198:199], v9 offset:18432
    s_add_u32 s56, s56, 589824
    v_mfma_f32_16x16x32_bf16 v[220:223], a[204:207], a[12:15], 0
    s_add_u32 s12, s66, s56
    s_addc_u32 s13, s67, 0
    s_and_b32 s13, s13, 0xffff
    v_mfma_f32_16x16x32_bf16 v[216:219], a[200:203], a[12:15], 0
    s_waitcnt lgkmcnt(4)
    s_mov_b32 s14, 196608
    s_mov_b32 s15, 0x00020000
    v_mfma_f32_16x16x32_bf16 v[248:251], a[208:211], a[12:15], 0
    s_add_u32 s16, s68, s56
    s_addc_u32 s17, s69, 0
    ds_read_b64_tr_b16 a[200:201], v10 offset:12288
    v_mfma_f32_16x16x32_bf16 v[252:255], a[212:215], a[12:15], 0
    s_and_b32 s17, s17, 0xffff
    ds_read_b64_tr_b16 a[202:203], v10 offset:18432
    s_mov_b32 s18, 196608
    v_mfma_f32_16x16x32_bf16 v[244:247], a[212:215], a[8:11], 0
    buffer_load_dwordx4 a[56:59], v28, s[20:23], s46 offen offset:2048 sc1
    v_mfma_f32_16x16x32_bf16 v[240:243], a[208:211], a[8:11], 0
    s_mov_b32 s19, 0x00020000
    s_mov_b32 s28, s78
    s_and_b32 s29, s79, 0xffff
    v_mfma_f32_16x16x32_bf16 v[232:235], a[208:211], a[4:7], 0
    s_mov_b32 s30, 1966080
    ds_read_b64_tr_b16 a[204:205], v11 offset:12288
    s_mov_b32 s31, 0x00020000
    v_mfma_f32_16x16x32_bf16 v[236:239], a[212:215], a[4:7], 0
    s_waitcnt vmcnt(7)
    ds_read_b64_tr_b16 a[206:207], v11 offset:18432
    s_mov_b32 s32, s80
    v_mfma_f32_16x16x32_bf16 v[228:231], a[212:215], a[0:3], 0
    s_and_b32 s33, s81, 0xffff
    s_mov_b32 s34, 1966080
    s_mov_b32 s35, 0x00020000
    v_mfma_f32_16x16x32_bf16 v[224:227], a[208:211], a[0:3], 0
    s_waitcnt lgkmcnt(4)
    s_min_u32 s58, s2, 239
    s_mul_hi_u32 s56, s58, 178956971
    v_mfma_f32_16x16x32_bf16 v[64:67], a[192:195], a[16:19], v[64:67]
    s_mul_i32 s57, s56, 24
    ds_read_b64_tr_b16 a[208:209], v8 offset:13312
    s_sub_u32 s57, s58, s57
    v_mfma_f32_16x16x32_bf16 v[68:71], a[196:199], a[16:19], v[68:71]
    s_lshl_b32 s60, s56, 6
    ds_read_b64_tr_b16 a[210:211], v8 offset:19456
    s_add_u32 s60, s60, s59
    v_mfma_f32_16x16x32_bf16 v[76:79], a[196:199], a[20:23], v[76:79]
    buffer_load_dwordx4 a[60:63], v28, s[20:23], s46 offen offset:3072 sc1
    v_mfma_f32_16x16x32_bf16 v[72:75], a[192:195], a[20:23], v[72:75]
    s_add_u32 s46, s45, 16384
    s_sub_u32 s77, s46, 81920
    s_min_u32 s46, s46, s77
    v_mfma_f32_16x16x32_bf16 v[80:83], a[192:195], a[24:27], v[80:83]
    s_mul_i32 s60, s60, 3072
    ds_read_b64_tr_b16 a[212:213], v9 offset:13312
    s_lshl_b32 s44, s57, 7
    v_mfma_f32_16x16x32_bf16 v[84:87], a[196:199], a[24:27], v[84:87]
    s_add_u32 s60, s60, s44
    ds_read_b64_tr_b16 a[214:215], v9 offset:19456
    s_lshl_b32 s61, s56, 7
    v_mfma_f32_16x16x32_bf16 v[92:95], a[196:199], a[28:31], v[92:95]
    buffer_load_dwordx4 a[64:67], v28, s[20:23], s46 offen offset:0 sc1
    v_mfma_f32_16x16x32_bf16 v[88:91], a[192:195], a[28:31], v[88:91]
    s_waitcnt lgkmcnt(4)
    s_mul_i32 s62, s56, 1536
    s_lshl_b32 s44, s57, 6
    v_mfma_f32_16x16x32_bf16 v[120:123], a[200:203], a[28:31], v[120:123]
    s_add_u32 s62, s62, s44
    ds_read_b64_tr_b16 a[192:193], v10 offset:13312
    s_lshl_b32 s44, s3, 4
    v_mfma_f32_16x16x32_bf16 v[124:127], a[204:207], a[28:31], v[124:127]
    s_add_u32 s62, s62, s44
    ds_read_b64_tr_b16 a[194:195], v10 offset:19456
    s_lshl_b32 s62, s62, 4
    v_mfma_f32_16x16x32_bf16 v[116:119], a[204:207], a[24:27], v[116:119]
    s_add_u32 s62, s62, 3276800
    s_lshl_b32 s4, s2, 8
    s_lshl_b32 s44, s3, 2
    v_mfma_f32_16x16x32_bf16 v[112:115], a[200:203], a[24:27], v[112:115]
    s_add_u32 s4, s4, s44
    s_add_u32 s4, s4, 268369920
    s_lshl_b32 s5, s52, 3
    v_mfma_f32_16x16x32_bf16 v[104:107], a[200:203], a[20:23], v[104:107]
    s_add_u32 s5, s5, s53
    ds_read_b64_tr_b16 a[196:197], v11 offset:13312
    s_lshl_b32 s5, s5, 2
    v_mfma_f32_16x16x32_bf16 v[108:111], a[204:207], a[20:23], v[108:111]
    s_add_u32 s5, s5, s3
    ds_read_b64_tr_b16 a[198:199], v11 offset:19456
    s_lshl_b32 s5, s5, 7
    v_mfma_f32_16x16x32_bf16 v[100:103], a[204:207], a[16:19], v[100:103]
    buffer_load_dwordx4 a[68:71], v28, s[20:23], s46 offen offset:1024 sc1
    v_mfma_f32_16x16x32_bf16 v[96:99], a[200:203], a[16:19], v[96:99]
    s_waitcnt lgkmcnt(4)
    s_add_u32 s5, s5, 4718592
    s_lshl_b32 s76, s51, 2
    v_mfma_f32_16x16x32_bf16 v[128:131], a[208:211], a[16:19], v[128:131]
    s_add_u32 s76, s76, s5
    ds_read_b64_tr_b16 a[200:201], v8 offset:14336
    s_mov_b32 s92, 0xbfb8aa3b
    v_mfma_f32_16x16x32_bf16 v[132:135], a[212:215], a[16:19], v[132:135]
    s_lshl_b32 s44, s3, 12
    ds_read_b64_tr_b16 a[202:203], v8 offset:20480
    s_mov_b32 s38, s49
    v_mfma_f32_16x16x32_bf16 v[140:143], a[212:215], a[20:23], v[140:143]
    s_mov_b32 s40, s49
    v_add_u32 v8, 73728, v12
    s_mov_b32 s39, 24576
    v_mfma_f32_16x16x32_bf16 v[136:139], a[208:211], a[20:23], v[136:139]
    buffer_load_dwordx4 a[72:75], v28, s[20:23], s46 offen offset:2048 sc1
    v_mfma_f32_16x16x32_bf16 v[144:147], a[208:211], a[24:27], v[144:147]
    s_mov_b32 s47, 3162112
    ds_read_b64_tr_b16 a[204:205], v9 offset:14336
    s_mov_b32 s88, 0xaaaaaaaa
    v_mfma_f32_16x16x32_bf16 v[148:151], a[212:215], a[24:27], v[148:151]
    s_mov_b32 s89, 0xaaaaaaaa
    ds_read_b64_tr_b16 a[206:207], v9 offset:20480
    v_mfma_f32_16x16x32_bf16 v[156:159], a[212:215], a[28:31], v[156:159]
    v_add_u32 v9, 73728, v13
    v_mfma_f32_16x16x32_bf16 v[152:155], a[208:211], a[28:31], v[152:155]
    s_waitcnt lgkmcnt(4)
    v_mfma_f32_16x16x32_bf16 v[184:187], a[192:195], a[28:31], v[184:187]
    ds_read_b64_tr_b16 a[208:209], v10 offset:14336
    v_mfma_f32_16x16x32_bf16 v[188:191], a[196:199], a[28:31], v[188:191]
    ds_read_b64_tr_b16 a[210:211], v10 offset:20480
    v_mfma_f32_16x16x32_bf16 v[180:183], a[196:199], a[24:27], v[180:183]
    buffer_load_dwordx4 a[76:79], v28, s[20:23], s46 offen offset:3072 sc1
    v_mfma_f32_16x16x32_bf16 v[176:179], a[192:195], a[24:27], v[176:179]
    v_add_u32 v10, 73728, v14
    v_mfma_f32_16x16x32_bf16 v[168:171], a[192:195], a[20:23], v[168:171]
    s_add_u32 s46, s45, 20480
    ds_read_b64_tr_b16 a[212:213], v11 offset:14336
    s_sub_u32 s77, s46, 81920
    v_mfma_f32_16x16x32_bf16 v[172:175], a[196:199], a[20:23], v[172:175]
    s_waitcnt vmcnt(35)
    ds_read_b64_tr_b16 a[214:215], v11 offset:20480
    s_min_u32 s46, s46, s77
    v_mfma_f32_16x16x32_bf16 v[164:167], a[196:199], a[16:19], v[164:167]
    s_barrier
    v_mfma_f32_16x16x32_bf16 v[160:163], a[192:195], a[16:19], v[160:163]
    s_waitcnt lgkmcnt(4)
    v_add_u32 v11, 73728, v15
    v_mfma_f32_16x16x32_bf16 v[192:195], a[200:203], a[16:19], v[192:195]
    ds_read_b64_tr_b16 a[192:193], v8 offset:0
    v_mfma_f32_16x16x32_bf16 v[196:199], a[204:207], a[16:19], v[196:199]
    ds_read_b64_tr_b16 a[194:195], v8 offset:6144
    v_mfma_f32_16x16x32_bf16 v[204:207], a[204:207], a[20:23], v[204:207]
    buffer_load_dwordx4 a[80:83], v28, s[20:23], s46 offen offset:0 sc1
    v_mfma_f32_16x16x32_bf16 v[200:203], a[200:203], a[20:23], v[200:203]
    v_mfma_f32_16x16x32_bf16 v[208:211], a[200:203], a[24:27], v[208:211]
    ds_read_b64_tr_b16 a[196:197], v8 offset:12288
    v_mfma_f32_16x16x32_bf16 v[212:215], a[204:207], a[24:27], v[212:215]
    ds_read_b64_tr_b16 a[198:199], v8 offset:18432
    v_mfma_f32_16x16x32_bf16 v[220:223], a[204:207], a[28:31], v[220:223]
    buffer_load_dwordx4 a[84:87], v28, s[20:23], s46 offen offset:1024 sc1
    v_mfma_f32_16x16x32_bf16 v[216:219], a[200:203], a[28:31], v[216:219]
    s_waitcnt lgkmcnt(4)
    v_mfma_f32_16x16x32_bf16 v[248:251], a[208:211], a[28:31], v[248:251]
    ds_read_b64_tr_b16 a[200:201], v9 offset:0
    v_mfma_f32_16x16x32_bf16 v[252:255], a[212:215], a[28:31], v[252:255]
    ds_read_b64_tr_b16 a[202:203], v9 offset:6144
    v_mfma_f32_16x16x32_bf16 v[244:247], a[212:215], a[24:27], v[244:247]
    v_mfma_f32_16x16x32_bf16 v[240:243], a[208:211], a[24:27], v[240:243]
    v_mfma_f32_16x16x32_bf16 v[232:235], a[208:211], a[20:23], v[232:235]
    ds_read_b64_tr_b16 a[204:205], v9 offset:12288
    v_mfma_f32_16x16x32_bf16 v[236:239], a[212:215], a[20:23], v[236:239]
    s_waitcnt vmcnt(10)
    s_waitcnt vmcnt(6)
    ds_read_b64_tr_b16 a[206:207], v9 offset:18432
    v_mfma_f32_16x16x32_bf16 v[228:231], a[212:215], a[16:19], v[228:231]
    buffer_load_dwordx4 a[88:91], v28, s[20:23], s46 offen offset:2048 sc1
    v_mfma_f32_16x16x32_bf16 v[224:227], a[208:211], a[16:19], v[224:227]
    s_waitcnt lgkmcnt(4)
    v_mfma_f32_16x16x32_bf16 v[64:67], a[192:195], a[32:35], v[64:67]
    ds_read_b64_tr_b16 a[208:209], v10 offset:0
    v_mfma_f32_16x16x32_bf16 v[64:67], a[196:199], a[48:51], v[64:67]
    ds_read_b64_tr_b16 a[210:211], v10 offset:6144
    v_mfma_f32_16x16x32_bf16 v[72:75], a[196:199], a[52:55], v[72:75]
    v_mfma_f32_16x16x32_bf16 v[72:75], a[192:195], a[36:39], v[72:75]
    buffer_load_dwordx4 a[92:95], v28, s[20:23], s46 offen offset:3072 sc1
    v_mfma_f32_16x16x32_bf16 v[80:83], a[192:195], a[40:43], v[80:83]
    ds_read_b64_tr_b16 a[212:213], v10 offset:12288
    v_mfma_f32_16x16x32_bf16 v[80:83], a[196:199], a[56:59], v[80:83]
    ds_read_b64_tr_b16 a[214:215], v10 offset:18432
    v_mfma_f32_16x16x32_bf16 v[88:91], a[196:199], a[60:63], v[88:91]
    s_add_u32 s46, s45, 24576
    s_sub_u32 s77, s46, 81920
    s_min_u32 s46, s46, s77
    v_mfma_f32_16x16x32_bf16 v[88:91], a[192:195], a[44:47], v[88:91]
    s_waitcnt lgkmcnt(4)
    v_mfma_f32_16x16x32_bf16 v[92:95], a[200:203], a[44:47], v[92:95]
    ds_read_b64_tr_b16 a[192:193], v11 offset:0
    v_mfma_f32_16x16x32_bf16 v[92:95], a[204:207], a[60:63], v[92:95]
    ds_read_b64_tr_b16 a[194:195], v11 offset:6144
    v_mfma_f32_16x16x32_bf16 v[84:87], a[204:207], a[56:59], v[84:87]
    buffer_load_dwordx4 a[96:99], v28, s[20:23], s46 offen offset:0 sc1
    v_mfma_f32_16x16x32_bf16 v[84:87], a[200:203], a[40:43], v[84:87]
    v_mfma_f32_16x16x32_bf16 v[76:79], a[200:203], a[36:39], v[76:79]
    ds_read_b64_tr_b16 a[196:197], v11 offset:12288
    v_mfma_f32_16x16x32_bf16 v[76:79], a[204:207], a[52:55], v[76:79]
    ds_read_b64_tr_b16 a[198:199], v11 offset:18432
    v_mfma_f32_16x16x32_bf16 v[68:71], a[204:207], a[48:51], v[68:71]
pg_1:
    s_cbranch_execz pg_ret
    v_mfma_f32_16x16x32_bf16 v[68:71], a[200:203], a[32:35], v[68:71]
    s_waitcnt lgkmcnt(4)
    v_mfma_f32_16x16x32_bf16 v[96:99], a[208:211], a[32:35], v[96:99]
    ds_read_b64_tr_b16 a[200:201], v8 offset:1024
    v_mfma_f32_16x16x32_bf16 v[96:99], a[212:215], a[48:51], v[96:99]
    ds_read_b64_tr_b16 a[202:203], v8 offset:7168
    v_mfma_f32_16x16x32_bf16 v[104:107], a[212:215], a[52:55], v[104:107]
    buffer_load_dwordx4 a[100:103], v28, s[20:23], s46 offen offset:1024 sc1
    v_mfma_f32_16x16x32_bf16 v[104:107], a[208:211], a[36:39], v[104:107]
    v_mfma_f32_16x16x32_bf16 v[112:115], a[208:211], a[40:43], v[112:115]
    ds_read_b64_tr_b16 a[204:205], v8 offset:13312
    v_mfma_f32_16x16x32_bf16 v[112:115], a[212:215], a[56:59], v[112:115]
    ds_read_b64_tr_b16 a[206:207], v8 offset:19456
    v_mfma_f32_16x16x32_bf16 v[120:123], a[212:215], a[60:63], v[120:123]
    v_mfma_f32_16x16x32_bf16 v[120:123], a[208:211], a[44:47], v[120:123]
    s_waitcnt lgkmcnt(4)
    v_mfma_f32_16x16x32_bf16 v[124:127], a[192:195], a[44:47], v[124:127]
    ds_read_b64_tr_b16 a[208:209], v9 offset:1024
    v_mfma_f32_16x16x32_bf16 v[124:127], a[196:199], a[60:63], v[124:127]
    ds_read_b64_tr_b16 a[210:211], v9 offset:7168
    v_mfma_f32_16x16x32_bf16 v[116:119], a[196:199], a[56:59], v[116:119]
    buffer_load_dwordx4 a[104:107], v28, s[20:23], s46 offen offset:2048 sc1
    v_mfma_f32_16x16x32_bf16 v[116:119], a[192:195], a[40:43], v[116:119]
    v_mfma_f32_16x16x32_bf16 v[108:111], a[192:195], a[36:39], v[108:111]
    ds_read_b64_tr_b16 a[212:213], v9 offset:13312
    v_mfma_f32_16x16x32_bf16 v[108:111], a[196:199], a[52:55], v[108:111]
    ds_read_b64_tr_b16 a[214:215], v9 offset:19456
    v_mfma_f32_16x16x32_bf16 v[100:103], a[196:199], a[48:51], v[100:103]
    buffer_load_dwordx4 a[108:111], v28, s[20:23], s46 offen offset:3072 sc1
    v_mfma_f32_16x16x32_bf16 v[100:103], a[192:195], a[32:35], v[100:103]
    s_waitcnt lgkmcnt(4)
    v_mfma_f32_16x16x32_bf16 v[128:131], a[200:203], a[32:35], v[128:131]
    ds_read_b64_tr_b16 a[192:193], v10 offset:1024
    v_mfma_f32_16x16x32_bf16 v[128:131], a[204:207], a[48:51], v[128:131]
    ds_read_b64_tr_b16 a[194:195], v10 offset:7168
    v_mfma_f32_16x16x32_bf16 v[136:139], a[204:207], a[52:55], v[136:139]
    v_mfma_f32_16x16x32_bf16 v[136:139], a[200:203], a[36:39], v[136:139]
    s_add_u32 m0, s49, 0
    v_mfma_f32_16x16x32_bf16 v[144:147], a[200:203], a[40:43], v[144:147]
    ds_read_b64_tr_b16 a[196:197], v10 offset:13312
    v_mfma_f32_16x16x32_bf16 v[144:147], a[204:207], a[56:59], v[144:147]
    ds_read_b64_tr_b16 a[198:199], v10 offset:19456
    v_mfma_f32_16x16x32_bf16 v[152:155], a[204:207], a[60:63], v[152:155]
    buffer_load_dwordx4 v2, s[8:11], s36 offen offset:0 lds
    v_mfma_f32_16x16x32_bf16 v[152:155], a[200:203], a[44:47], v[152:155]
    s_waitcnt lgkmcnt(4)
    v_mfma_f32_16x16x32_bf16 v[156:159], a[208:211], a[44:47], v[156:159]
    ds_read_b64_tr_b16 a[200:201], v11 offset:1024
    v_mfma_f32_16x16x32_bf16 v[156:159], a[212:215], a[60:63], v[156:159]
    s_add_u32 m0, s49, 896
    ds_read_b64_tr_b16 a[202:203], v11 offset:7168
    v_mfma_f32_16x16x32_bf16 v[148:151], a[212:215], a[56:59], v[148:151]
    buffer_load_dwordx4 v2, s[8:11], s36 offen offset:128 lds
    v_mfma_f32_16x16x32_bf16 v[148:151], a[208:211], a[40:43], v[148:151]
    v_mfma_f32_16x16x32_bf16 v[140:143], a[208:211], a[36:39], v[140:143]
    ds_read_b64_tr_b16 a[204:205], v11 offset:13312
    v_mfma_f32_16x16x32_bf16 v[140:143], a[212:215], a[52:55], v[140:143]
    ds_read_b64_tr_b16 a[206:207], v11 offset:19456
    v_mfma_f32_16x16x32_bf16 v[132:135], a[212:215], a[48:51], v[132:135]
    v_mfma_f32_16x16x32_bf16 v[132:135], a[208:211], a[32:35], v[132:135]
    s_waitcnt lgkmcnt(4)
    v_mfma_f32_16x16x32_bf16 v[160:163], a[192:195], a[32:35], v[160:163]
    s_add_u32 m0, s49, 1792
    ds_read_b64_tr_b16 a[208:209], v8 offset:2048
    v_mfma_f32_16x16x32_bf16 v[160:163], a[196:199], a[48:51], v[160:163]
    ds_read_b64_tr_b16 a[210:211], v8 offset:8192
    v_mfma_f32_16x16x32_bf16 v[168:171], a[196:199], a[52:55], v[168:171]
    buffer_load_dwordx4 v2, s[8:11], s36 offen offset:256 lds
    v_mfma_f32_16x16x32_bf16 v[168:171], a[192:195], a[36:39], v[168:171]
    v_mfma_f32_16x16x32_bf16 v[176:179], a[192:195], a[40:43], v[176:179]
    ds_read_b64_tr_b16 a[212:213], v8 offset:14336
    v_mfma_f32_16x16x32_bf16 v[176:179], a[196:199], a[56:59], v[176:179]
    ds_read_b64_tr_b16 a[214:215], v8 offset:20480
    v_mfma_f32_16x16x32_bf16 v[184:187], a[196:199], a[60:63], v[184:187]
    s_add_u32 m0, s49, 3072
    v_add_u32 v8, 98304, v12
    v_mfma_f32_16x16x32_bf16 v[184:187], a[192:195], a[44:47], v[184:187]
    s_waitcnt lgkmcnt(4)
    v_mfma_f32_16x16x32_bf16 v[188:191], a[200:203], a[44:47], v[188:191]
    ds_read_b64_tr_b16 a[192:193], v9 offset:2048
    v_mfma_f32_16x16x32_bf16 v[188:191], a[204:207], a[60:63], v[188:191]
    ds_read_b64_tr_b16 a[194:195], v9 offset:8192
    v_mfma_f32_16x16x32_bf16 v[180:183], a[204:207], a[56:59], v[180:183]
    buffer_load_dwordx4 v3, s[8:11], s36 offen offset:0 lds
    v_mfma_f32_16x16x32_bf16 v[180:183], a[200:203], a[40:43], v[180:183]
    v_mfma_f32_16x16x32_bf16 v[172:175], a[200:203], a[36:39], v[172:175]
    ds_read_b64_tr_b16 a[196:197], v9 offset:14336
    v_mfma_f32_16x16x32_bf16 v[172:175], a[204:207], a[52:55], v[172:175]
    s_add_u32 m0, s49, 3968
    ds_read_b64_tr_b16 a[198:199], v9 offset:20480
    v_mfma_f32_16x16x32_bf16 v[164:167], a[204:207], a[48:51], v[164:167]
    buffer_load_dwordx4 v3, s[8:11], s36 offen offset:128 lds
    v_mfma_f32_16x16x32_bf16 v[164:167], a[200:203], a[32:35], v[164:167]
    s_waitcnt lgkmcnt(4)
    v_add_u32 v9, 98304, v13
    v_mfma_f32_16x16x32_bf16 v[192:195], a[208:211], a[32:35], v[192:195]
    ds_read_b64_tr_b16 a[200:201], v10 offset:2048
    v_mfma_f32_16x16x32_bf16 v[192:195], a[212:215], a[48:51], v[192:195]
    ds_read_b64_tr_b16 a[202:203], v10 offset:8192
    v_mfma_f32_16x16x32_bf16 v[200:203], a[212:215], a[52:55], v[200:203]
    v_mfma_f32_16x16x32_bf16 v[200:203], a[208:211], a[36:39], v[200:203]
    s_add_u32 m0, s49, 4864
    v_mfma_f32_16x16x32_bf16 v[208:211], a[208:211], a[40:43], v[208:211]
    ds_read_b64_tr_b16 a[204:205], v10 offset:14336
    v_mfma_f32_16x16x32_bf16 v[208:211], a[212:215], a[56:59], v[208:211]
    ds_read_b64_tr_b16 a[206:207], v10 offset:20480
    v_mfma_f32_16x16x32_bf16 v[216:219], a[212:215], a[60:63], v[216:219]
    buffer_load_dwordx4 v3, s[8:11], s36 offen offset:256 lds
    v_mfma_f32_16x16x32_bf16 v[216:219], a[208:211], a[44:47], v[216:219]
    s_waitcnt lgkmcnt(4)
    v_add_u32 v10, 98304, v14
    s_add_u32 s36, s36, s37
    v_mfma_f32_16x16x32_bf16 v[220:223], a[192:195], a[44:47], v[220:223]
    s_sub_u32 s55, s36, 7864320
    ds_read_b64_tr_b16 a[208:209], v11 offset:2048
    s_min_u32 s36, s36, s55
    v_mfma_f32_16x16x32_bf16 v[220:223], a[196:199], a[60:63], v[220:223]
    s_add_u32 s46, s45, 28672
    ds_read_b64_tr_b16 a[210:211], v11 offset:8192
    s_sub_u32 s77, s46, 81920
    v_mfma_f32_16x16x32_bf16 v[212:215], a[196:199], a[56:59], v[212:215]
    s_min_u32 s46, s46, s77
    v_mfma_f32_16x16x32_bf16 v[212:215], a[192:195], a[40:43], v[212:215]
    buffer_load_dwordx4 a[112:115], v28, s[20:23], s46 offen offset:0 sc1
    v_mfma_f32_16x16x32_bf16 v[204:207], a[192:195], a[36:39], v[204:207]
    ds_read_b64_tr_b16 a[212:213], v11 offset:14336
    v_mfma_f32_16x16x32_bf16 v[204:207], a[196:199], a[52:55], v[204:207]
    s_waitcnt vmcnt(42)
    ds_read_b64_tr_b16 a[214:215], v11 offset:20480
    v_mfma_f32_16x16x32_bf16 v[196:199], a[196:199], a[48:51], v[196:199]
    s_barrier
    v_mfma_f32_16x16x32_bf16 v[196:199], a[192:195], a[32:35], v[196:199]
    s_waitcnt lgkmcnt(4)
    v_add_u32 v11, 98304, v15
    v_mfma_f32_16x16x32_bf16 v[224:227], a[200:203], a[32:35], v[224:227]
    ds_read_b64_tr_b16 a[192:193], v8 offset:0
    v_mfma_f32_16x16x32_bf16 v[224:227], a[204:207], a[48:51], v[224:227]
    ds_read_b64_tr_b16 a[194:195], v8 offset:6144
    v_mfma_f32_16x16x32_bf16 v[232:235], a[204:207], a[52:55], v[232:235]
    buffer_load_dwordx4 a[116:119], v28, s[20:23], s46 offen offset:1024 sc1
    v_mfma_f32_16x16x32_bf16 v[232:235], a[200:203], a[36:39], v[232:235]
    v_mfma_f32_16x16x32_bf16 v[240:243], a[200:203], a[40:43], v[240:243]
    s_lshl_b32 s67, s2, 2
    ds_read_b64_tr_b16 a[196:197], v8 offset:12288
    v_mfma_f32_16x16x32_bf16 v[240:243], a[204:207], a[56:59], v[240:243]
    s_add_u32 s67, s67, s3
    ds_read_b64_tr_b16 a[198:199], v8 offset:18432
    v_mfma_f32_16x16x32_bf16 v[248:251], a[204:207], a[60:63], v[248:251]
    s_lshl_b32 s67, s67, 7
    s_add_u32 s67, s67, 4194304
    s_add_u32 s56, s4, 128
    v_mfma_f32_16x16x32_bf16 v[248:251], a[200:203], a[44:47], v[248:251]
    s_waitcnt lgkmcnt(4)
    v_mov_b32 v23, s56
    v_writelane_b32 v23, s67, 0
    v_mfma_f32_16x16x32_bf16 v[252:255], a[208:211], a[44:47], v[252:255]
    s_add_u32 s56, s67, 2097152
    ds_read_b64_tr_b16 a[200:201], v9 offset:0
    v_writelane_b32 v23, s56, 1
    v_mfma_f32_16x16x32_bf16 v[252:255], a[212:215], a[60:63], v[252:255]
    ds_read_b64_tr_b16 a[202:203], v9 offset:6144
    v_writelane_b32 v23, s76, 2
    v_mfma_f32_16x16x32_bf16 v[244:247], a[212:215], a[56:59], v[244:247]
    buffer_load_dwordx4 a[120:123], v28, s[20:23], s46 offen offset:2048 sc1
    v_mfma_f32_16x16x32_bf16 v[244:247], a[208:211], a[40:43], v[244:247]
    s_add_u32 s56, s76, 2097152
    v_writelane_b32 v23, s56, 3
    v_mfma_f32_16x16x32_bf16 v[236:239], a[208:211], a[36:39], v[236:239]
    ds_read_b64_tr_b16 a[204:205], v9 offset:12288
    v_mfma_f32_16x16x32_bf16 v[236:239], a[212:215], a[52:55], v[236:239]
    s_waitcnt vmcnt(17)
    s_waitcnt vmcnt(13)
    ds_read_b64_tr_b16 a[206:207], v9 offset:18432
    v_mfma_f32_16x16x32_bf16 v[228:231], a[212:215], a[48:51], v[228:231]
    buffer_load_dword a218, v23, s[24:27], 0 offen sc1
    v_mfma_f32_16x16x32_bf16 v[228:231], a[208:211], a[32:35], v[228:231]
    s_waitcnt lgkmcnt(4)
    v_mfma_f32_16x16x32_bf16 v[64:67], a[192:195], a[64:67], v[64:67]
    ds_read_b64_tr_b16 a[208:209], v10 offset:0
    v_mfma_f32_16x16x32_bf16 v[64:67], a[196:199], a[80:83], v[64:67]
    ds_read_b64_tr_b16 a[210:211], v10 offset:6144
    v_mfma_f32_16x16x32_bf16 v[72:75], a[196:199], a[84:87], v[72:75]
    buffer_load_dwordx4 a[124:127], v28, s[20:23], s46 offen offset:3072 sc1
    v_mfma_f32_16x16x32_bf16 v[72:75], a[192:195], a[68:71], v[72:75]
    s_add_u32 s46, s45, 32768
    s_sub_u32 s77, s46, 81920
    s_min_u32 s46, s46, s77
    v_mfma_f32_16x16x32_bf16 v[80:83], a[192:195], a[72:75], v[80:83]
    ds_read_b64_tr_b16 a[212:213], v10 offset:12288
    v_mfma_f32_16x16x32_bf16 v[80:83], a[196:199], a[88:91], v[80:83]
    ds_read_b64_tr_b16 a[214:215], v10 offset:18432
    v_mfma_f32_16x16x32_bf16 v[88:91], a[196:199], a[92:95], v[88:91]
    buffer_load_dwordx4 a[128:131], v28, s[20:23], s46 offen offset:0 sc1
    v_mfma_f32_16x16x32_bf16 v[88:91], a[192:195], a[76:79], v[88:91]
    s_waitcnt lgkmcnt(4)
    v_mfma_f32_16x16x32_bf16 v[92:95], a[200:203], a[76:79], v[92:95]
    ds_read_b64_tr_b16 a[192:193], v11 offset:0
    v_mfma_f32_16x16x32_bf16 v[92:95], a[204:207], a[92:95], v[92:95]
    ds_read_b64_tr_b16 a[194:195], v11 offset:6144
    v_mfma_f32_16x16x32_bf16 v[84:87], a[204:207], a[88:91], v[84:87]
    v_mfma_f32_16x16x32_bf16 v[84:87], a[200:203], a[72:75], v[84:87]
    buffer_load_dwordx4 a[132:135], v28, s[20:23], s46 offen offset:1024 sc1
    v_mfma_f32_16x16x32_bf16 v[76:79], a[200:203], a[68:71], v[76:79]
    ds_read_b64_tr_b16 a[196:197], v11 offset:12288
    v_mfma_f32_16x16x32_bf16 v[76:79], a[204:207], a[84:87], v[76:79]
    ds_read_b64_tr_b16 a[198:199], v11 offset:18432
    v_mfma_f32_16x16x32_bf16 v[68:71], a[204:207], a[80:83], v[68:71]
    v_mfma_f32_16x16x32_bf16 v[68:71], a[200:203], a[64:67], v[68:71]
    s_waitcnt lgkmcnt(4)
    v_mfma_f32_16x16x32_bf16 v[96:99], a[208:211], a[64:67], v[96:99]
    ds_read_b64_tr_b16 a[200:201], v8 offset:1024
    v_mfma_f32_16x16x32_bf16 v[96:99], a[212:215], a[80:83], v[96:99]
    ds_read_b64_tr_b16 a[202:203], v8 offset:7168
    v_mfma_f32_16x16x32_bf16 v[104:107], a[212:215], a[84:87], v[104:107]
    buffer_load_dwordx4 a[136:139], v28, s[20:23], s46 offen offset:2048 sc1
    v_mfma_f32_16x16x32_bf16 v[104:107], a[208:211], a[68:71], v[104:107]
    v_mfma_f32_16x16x32_bf16 v[112:115], a[208:211], a[72:75], v[112:115]
    ds_read_b64_tr_b16 a[204:205], v8 offset:13312
    v_mfma_f32_16x16x32_bf16 v[112:115], a[212:215], a[88:91], v[112:115]
    ds_read_b64_tr_b16 a[206:207], v8 offset:19456
    v_mfma_f32_16x16x32_bf16 v[120:123], a[212:215], a[92:95], v[120:123]
    v_mfma_f32_16x16x32_bf16 v[120:123], a[208:211], a[76:79], v[120:123]
    s_waitcnt lgkmcnt(4)
    v_mfma_f32_16x16x32_bf16 v[124:127], a[192:195], a[76:79], v[124:127]
    ds_read_b64_tr_b16 a[208:209], v9 offset:1024
    v_mfma_f32_16x16x32_bf16 v[124:127], a[196:199], a[92:95], v[124:127]
    ds_read_b64_tr_b16 a[210:211], v9 offset:7168
    v_mfma_f32_16x16x32_bf16 v[116:119], a[196:199], a[88:91], v[116:119]
    buffer_load_dwordx4 a[140:143], v28, s[20:23], s46 offen offset:3072 sc1
    v_mfma_f32_16x16x32_bf16 v[116:119], a[192:195], a[72:75], v[116:119]
    v_mfma_f32_16x16x32_bf16 v[108:111], a[192:195], a[68:71], v[108:111]
    ds_read_b64_tr_b16 a[212:213], v9 offset:13312
    v_mfma_f32_16x16x32_bf16 v[108:111], a[196:199], a[84:87], v[108:111]
    ds_read_b64_tr_b16 a[214:215], v9 offset:19456
    v_mfma_f32_16x16x32_bf16 v[100:103], a[196:199], a[80:83], v[100:103]
    s_add_u32 m0, s49, 24576
    v_mfma_f32_16x16x32_bf16 v[100:103], a[192:195], a[64:67], v[100:103]
    s_waitcnt lgkmcnt(4)
    v_mfma_f32_16x16x32_bf16 v[128:131], a[200:203], a[64:67], v[128:131]
    ds_read_b64_tr_b16 a[192:193], v10 offset:1024
    v_mfma_f32_16x16x32_bf16 v[128:131], a[204:207], a[80:83], v[128:131]
    ds_read_b64_tr_b16 a[194:195], v10 offset:7168
    v_mfma_f32_16x16x32_bf16 v[136:139], a[204:207], a[84:87], v[136:139]
    buffer_load_dwordx4 v2, s[8:11], s36 offen offset:0 lds
    v_mfma_f32_16x16x32_bf16 v[136:139], a[200:203], a[68:71], v[136:139]
    v_mfma_f32_16x16x32_bf16 v[144:147], a[200:203], a[72:75], v[144:147]
    s_add_u32 m0, s49, 25472
    ds_read_b64_tr_b16 a[196:197], v10 offset:13312
    v_mfma_f32_16x16x32_bf16 v[144:147], a[204:207], a[88:91], v[144:147]
    ds_read_b64_tr_b16 a[198:199], v10 offset:19456
    v_mfma_f32_16x16x32_bf16 v[152:155], a[204:207], a[92:95], v[152:155]
    buffer_load_dwordx4 v2, s[8:11], s36 offen offset:128 lds
    v_mfma_f32_16x16x32_bf16 v[152:155], a[200:203], a[76:79], v[152:155]
    s_waitcnt lgkmcnt(4)
    v_mfma_f32_16x16x32_bf16 v[156:159], a[208:211], a[76:79], v[156:159]
    ds_read_b64_tr_b16 a[200:201], v11 offset:1024
    v_mfma_f32_16x16x32_bf16 v[156:159], a[212:215], a[92:95], v[156:159]
    ds_read_b64_tr_b16 a[202:203], v11 offset:7168
    v_mfma_f32_16x16x32_bf16 v[148:151], a[212:215], a[88:91], v[148:151]
    buffer_load_dwordx4 v[32:35], v17, s[24:27], s47 offen offset:0 sc1
    v_mfma_f32_16x16x32_bf16 v[148:151], a[208:211], a[72:75], v[148:151]
    s_add_u32 m0, s49, 26368
    v_mfma_f32_16x16x32_bf16 v[140:143], a[208:211], a[68:71], v[140:143]
    ds_read_b64_tr_b16 a[204:205], v11 offset:13312
    v_mfma_f32_16x16x32_bf16 v[140:143], a[212:215], a[84:87], v[140:143]
    ds_read_b64_tr_b16 a[206:207], v11 offset:19456
    v_mfma_f32_16x16x32_bf16 v[132:135], a[212:215], a[80:83], v[132:135]
    buffer_load_dwordx4 v2, s[8:11], s36 offen offset:256 lds
    v_mfma_f32_16x16x32_bf16 v[132:135], a[208:211], a[64:67], v[132:135]
    s_waitcnt lgkmcnt(4)
    v_mfma_f32_16x16x32_bf16 v[160:163], a[192:195], a[64:67], v[160:163]
    ds_read_b64_tr_b16 a[208:209], v8 offset:2048
    v_mfma_f32_16x16x32_bf16 v[160:163], a[196:199], a[80:83], v[160:163]
    s_add_u32 m0, s49, 27648
    ds_read_b64_tr_b16 a[210:211], v8 offset:8192
    v_mfma_f32_16x16x32_bf16 v[168:171], a[196:199], a[84:87], v[168:171]
    buffer_load_dwordx4 v3, s[8:11], s36 offen offset:0 lds
    v_mfma_f32_16x16x32_bf16 v[168:171], a[192:195], a[68:71], v[168:171]
    v_mfma_f32_16x16x32_bf16 v[176:179], a[192:195], a[72:75], v[176:179]
    ds_read_b64_tr_b16 a[212:213], v8 offset:14336
    v_mfma_f32_16x16x32_bf16 v[176:179], a[196:199], a[88:91], v[176:179]
    ds_read_b64_tr_b16 a[214:215], v8 offset:20480
    v_mfma_f32_16x16x32_bf16 v[184:187], a[196:199], a[92:95], v[184:187]
    buffer_load_dwordx4 v[36:39], v17, s[24:27], s47 offen offset:1024 sc1
    v_mfma_f32_16x16x32_bf16 v[184:187], a[192:195], a[76:79], v[184:187]
    s_waitcnt lgkmcnt(4)
    v_add_u32 v8, 122880, v12
    v_mfma_f32_16x16x32_bf16 v[188:191], a[200:203], a[76:79], v[188:191]
    s_add_u32 m0, s49, 28544
    ds_read_b64_tr_b16 a[192:193], v9 offset:2048
    v_mfma_f32_16x16x32_bf16 v[188:191], a[204:207], a[92:95], v[188:191]
    ds_read_b64_tr_b16 a[194:195], v9 offset:8192
    v_mfma_f32_16x16x32_bf16 v[180:183], a[204:207], a[88:91], v[180:183]
    buffer_load_dwordx4 v3, s[8:11], s36 offen offset:128 lds
    v_mfma_f32_16x16x32_bf16 v[180:183], a[200:203], a[72:75], v[180:183]
    v_mfma_f32_16x16x32_bf16 v[172:175], a[200:203], a[68:71], v[172:175]
    ds_read_b64_tr_b16 a[196:197], v9 offset:14336
    v_mfma_f32_16x16x32_bf16 v[172:175], a[204:207], a[84:87], v[172:175]
    ds_read_b64_tr_b16 a[198:199], v9 offset:20480
    v_mfma_f32_16x16x32_bf16 v[164:167], a[204:207], a[80:83], v[164:167]
    s_add_u32 m0, s49, 29440
    v_add_u32 v9, 122880, v13
    v_mfma_f32_16x16x32_bf16 v[164:167], a[200:203], a[64:67], v[164:167]
    s_waitcnt lgkmcnt(4)
    v_mfma_f32_16x16x32_bf16 v[192:195], a[208:211], a[64:67], v[192:195]
    ds_read_b64_tr_b16 a[200:201], v10 offset:2048
    v_mfma_f32_16x16x32_bf16 v[192:195], a[212:215], a[80:83], v[192:195]
    ds_read_b64_tr_b16 a[202:203], v10 offset:8192
    v_mfma_f32_16x16x32_bf16 v[200:203], a[212:215], a[84:87], v[200:203]
    buffer_load_dwordx4 v3, s[8:11], s36 offen offset:256 lds
    v_mfma_f32_16x16x32_bf16 v[200:203], a[208:211], a[68:71], v[200:203]
    buffer_load_dwordx4 v[40:43], v17, s[24:27], s47 offen offset:2048 sc1
    v_mfma_f32_16x16x32_bf16 v[208:211], a[208:211], a[72:75], v[208:211]
    s_add_u32 s36, s36, s37
    ds_read_b64_tr_b16 a[204:205], v10 offset:14336
    s_sub_u32 s55, s36, 7864320
    v_mfma_f32_16x16x32_bf16 v[208:211], a[212:215], a[88:91], v[208:211]
    s_min_u32 s36, s36, s55
    ds_read_b64_tr_b16 a[206:207], v10 offset:20480
    s_add_u32 s46, s45, 36864
    v_mfma_f32_16x16x32_bf16 v[216:219], a[212:215], a[92:95], v[216:219]
    s_sub_u32 s77, s46, 81920
    v_add_u32 v10, 122880, v14
    s_min_u32 s46, s46, s77
    v_mfma_f32_16x16x32_bf16 v[216:219], a[208:211], a[76:79], v[216:219]
    s_waitcnt lgkmcnt(4)
    v_mfma_f32_16x16x32_bf16 v[220:223], a[192:195], a[76:79], v[220:223]
    ds_read_b64_tr_b16 a[208:209], v11 offset:2048
    v_mfma_f32_16x16x32_bf16 v[220:223], a[196:199], a[92:95], v[220:223]
    ds_read_b64_tr_b16 a[210:211], v11 offset:8192
    v_mfma_f32_16x16x32_bf16 v[212:215], a[196:199], a[88:91], v[212:215]
    buffer_load_dwordx4 a[144:147], v28, s[20:23], s46 offen offset:0 sc1
    v_mfma_f32_16x16x32_bf16 v[212:215], a[192:195], a[72:75], v[212:215]
    v_mfma_f32_16x16x32_bf16 v[204:207], a[192:195], a[68:71], v[204:207]
    ds_read_b64_tr_b16 a[212:213], v11 offset:14336
    v_mfma_f32_16x16x32_bf16 v[204:207], a[196:199], a[84:87], v[204:207]
    s_waitcnt vmcnt(53)
    ds_read_b64_tr_b16 a[214:215], v11 offset:20480
    v_mfma_f32_16x16x32_bf16 v[196:199], a[196:199], a[80:83], v[196:199]
    s_barrier
    v_mfma_f32_16x16x32_bf16 v[196:199], a[192:195], a[64:67], v[196:199]
    s_waitcnt lgkmcnt(4)
    buffer_load_dwordx4 a[148:151], v28, s[20:23], s46 offen offset:1024 sc1
    v_mfma_f32_16x16x32_bf16 v[224:227], a[200:203], a[64:67], v[224:227]
    ds_read_b64_tr_b16 a[192:193], v8 offset:0
    v_add_u32 v11, 122880, v15
    v_mfma_f32_16x16x32_bf16 v[224:227], a[204:207], a[80:83], v[224:227]
    ds_read_b64_tr_b16 a[194:195], v8 offset:6144
    v_mfma_f32_16x16x32_bf16 v[232:235], a[204:207], a[84:87], v[232:235]
    buffer_load_dwordx4 v[44:47], v17, s[24:27], s47 offen offset:3072 sc1
    v_mfma_f32_16x16x32_bf16 v[232:235], a[200:203], a[68:71], v[232:235]
    buffer_load_dwordx4 a[152:155], v28, s[20:23], s46 offen offset:2048 sc1
    v_mfma_f32_16x16x32_bf16 v[240:243], a[200:203], a[72:75], v[240:243]
    ds_read_b64_tr_b16 a[196:197], v8 offset:12288
    v_mfma_f32_16x16x32_bf16 v[240:243], a[204:207], a[88:91], v[240:243]
    ds_read_b64_tr_b16 a[198:199], v8 offset:18432
    v_mfma_f32_16x16x32_bf16 v[248:251], a[204:207], a[92:95], v[248:251]
    v_mfma_f32_16x16x32_bf16 v[248:251], a[200:203], a[76:79], v[248:251]
    s_waitcnt lgkmcnt(4)
    v_mfma_f32_16x16x32_bf16 v[252:255], a[208:211], a[76:79], v[252:255]
    ds_read_b64_tr_b16 a[200:201], v9 offset:0
    v_mfma_f32_16x16x32_bf16 v[252:255], a[212:215], a[92:95], v[252:255]
    ds_read_b64_tr_b16 a[202:203], v9 offset:6144
    v_mfma_f32_16x16x32_bf16 v[244:247], a[212:215], a[88:91], v[244:247]
    buffer_load_dwordx4 a[156:159], v28, s[20:23], s46 offen offset:3072 sc1
    v_mfma_f32_16x16x32_bf16 v[244:247], a[208:211], a[72:75], v[244:247]
    v_mfma_f32_16x16x32_bf16 v[236:239], a[208:211], a[68:71], v[236:239]
    s_add_u32 s46, s45, 40960
    ds_read_b64_tr_b16 a[204:205], v9 offset:12288
    s_sub_u32 s77, s46, 81920
    v_mfma_f32_16x16x32_bf16 v[236:239], a[212:215], a[84:87], v[236:239]
    s_waitcnt vmcnt(29)
    s_waitcnt vmcnt(18)
    ds_read_b64_tr_b16 a[206:207], v9 offset:18432
    v_mfma_f32_16x16x32_bf16 v[228:231], a[212:215], a[80:83], v[228:231]
    s_min_u32 s46, s46, s77
    v_mfma_f32_16x16x32_bf16 v[228:231], a[208:211], a[64:67], v[228:231]
    s_waitcnt lgkmcnt(4)
    v_mfma_f32_16x16x32_bf16 v[64:67], a[192:195], a[96:99], v[64:67]
    ds_read_b64_tr_b16 a[208:209], v10 offset:0
    v_mfma_f32_16x16x32_bf16 v[64:67], a[196:199], a[112:115], v[64:67]
    ds_read_b64_tr_b16 a[210:211], v10 offset:6144
    v_mfma_f32_16x16x32_bf16 v[72:75], a[196:199], a[116:119], v[72:75]
    buffer_load_dwordx4 a[160:163], v28, s[20:23], s46 offen offset:0 sc1
    v_mfma_f32_16x16x32_bf16 v[72:75], a[192:195], a[100:103], v[72:75]
    v_mfma_f32_16x16x32_bf16 v[80:83], a[192:195], a[104:107], v[80:83]
    ds_read_b64_tr_b16 a[212:213], v10 offset:12288
    v_mfma_f32_16x16x32_bf16 v[80:83], a[196:199], a[120:123], v[80:83]
    ds_read_b64_tr_b16 a[214:215], v10 offset:18432
    v_mfma_f32_16x16x32_bf16 v[88:91], a[196:199], a[124:127], v[88:91]
    buffer_load_dwordx4 a[164:167], v28, s[20:23], s46 offen offset:1024 sc1
    v_mfma_f32_16x16x32_bf16 v[88:91], a[192:195], a[108:111], v[88:91]
    s_waitcnt lgkmcnt(4)
    v_mfma_f32_16x16x32_bf16 v[92:95], a[200:203], a[108:111], v[92:95]
    ds_read_b64_tr_b16 a[192:193], v11 offset:0
    v_mfma_f32_16x16x32_bf16 v[92:95], a[204:207], a[124:127], v[92:95]
    ds_read_b64_tr_b16 a[194:195], v11 offset:6144
    v_mfma_f32_16x16x32_bf16 v[84:87], a[204:207], a[120:123], v[84:87]
    v_mfma_f32_16x16x32_bf16 v[84:87], a[200:203], a[104:107], v[84:87]
    v_mfma_f32_16x16x32_bf16 v[76:79], a[200:203], a[100:103], v[76:79]
    ds_read_b64_tr_b16 a[196:197], v11 offset:12288
    v_mfma_f32_16x16x32_bf16 v[76:79], a[204:207], a[116:119], v[76:79]
    ds_read_b64_tr_b16 a[198:199], v11 offset:18432
    v_mfma_f32_16x16x32_bf16 v[68:71], a[204:207], a[112:115], v[68:71]
    buffer_load_dwordx4 a[168:171], v28, s[20:23], s46 offen offset:2048 sc1
    v_mfma_f32_16x16x32_bf16 v[68:71], a[200:203], a[96:99], v[68:71]
    s_waitcnt lgkmcnt(4)
    v_mfma_f32_16x16x32_bf16 v[96:99], a[208:211], a[96:99], v[96:99]
    ds_read_b64_tr_b16 a[200:201], v8 offset:1024
    v_mfma_f32_16x16x32_bf16 v[96:99], a[212:215], a[112:115], v[96:99]
    ds_read_b64_tr_b16 a[202:203], v8 offset:7168
    v_mfma_f32_16x16x32_bf16 v[104:107], a[212:215], a[116:119], v[104:107]
    v_mfma_f32_16x16x32_bf16 v[104:107], a[208:211], a[100:103], v[104:107]
    buffer_load_dwordx4 a[172:175], v28, s[20:23], s46 offen offset:3072 sc1
    v_mfma_f32_16x16x32_bf16 v[112:115], a[208:211], a[104:107], v[112:115]
    ds_read_b64_tr_b16 a[204:205], v8 offset:13312
    v_mfma_f32_16x16x32_bf16 v[112:115], a[212:215], a[120:123], v[112:115]
    ds_read_b64_tr_b16 a[206:207], v8 offset:19456
    v_mfma_f32_16x16x32_bf16 v[120:123], a[212:215], a[124:127], v[120:123]
    v_mfma_f32_16x16x32_bf16 v[120:123], a[208:211], a[108:111], v[120:123]
    s_waitcnt lgkmcnt(4)
    v_mfma_f32_16x16x32_bf16 v[124:127], a[192:195], a[108:111], v[124:127]
    ds_read_b64_tr_b16 a[208:209], v9 offset:1024
    v_mfma_f32_16x16x32_bf16 v[124:127], a[196:199], a[124:127], v[124:127]
    s_add_u32 m0, s49, 49152
    ds_read_b64_tr_b16 a[210:211], v9 offset:7168
    v_mfma_f32_16x16x32_bf16 v[116:119], a[196:199], a[120:123], v[116:119]
    buffer_load_dwordx4 v2, s[8:11], s36 offen offset:0 lds
    v_mfma_f32_16x16x32_bf16 v[116:119], a[192:195], a[104:107], v[116:119]
    v_mfma_f32_16x16x32_bf16 v[108:111], a[192:195], a[100:103], v[108:111]
    ds_read_b64_tr_b16 a[212:213], v9 offset:13312
    v_mfma_f32_16x16x32_bf16 v[108:111], a[196:199], a[116:119], v[108:111]
    ds_read_b64_tr_b16 a[214:215], v9 offset:19456
    v_mfma_f32_16x16x32_bf16 v[100:103], a[196:199], a[112:115], v[100:103]
    v_mfma_f32_16x16x32_bf16 v[100:103], a[192:195], a[96:99], v[100:103]
    s_waitcnt lgkmcnt(4)
    s_add_u32 m0, s49, 50048
    v_mfma_f32_16x16x32_bf16 v[128:131], a[200:203], a[96:99], v[128:131]
    ds_read_b64_tr_b16 a[192:193], v10 offset:1024
    v_mfma_f32_16x16x32_bf16 v[128:131], a[204:207], a[112:115], v[128:131]
    ds_read_b64_tr_b16 a[194:195], v10 offset:7168
    v_mfma_f32_16x16x32_bf16 v[136:139], a[204:207], a[116:119], v[136:139]
    buffer_load_dwordx4 v2, s[8:11], s36 offen offset:128 lds
    v_mfma_f32_16x16x32_bf16 v[136:139], a[200:203], a[100:103], v[136:139]
    v_mfma_f32_16x16x32_bf16 v[144:147], a[200:203], a[104:107], v[144:147]
    ds_read_b64_tr_b16 a[196:197], v10 offset:13312
    v_mfma_f32_16x16x32_bf16 v[144:147], a[204:207], a[120:123], v[144:147]
    ds_read_b64_tr_b16 a[198:199], v10 offset:19456
    v_mfma_f32_16x16x32_bf16 v[152:155], a[204:207], a[124:127], v[152:155]
    s_add_u32 m0, s49, 50944
    v_mfma_f32_16x16x32_bf16 v[152:155], a[200:203], a[108:111], v[152:155]
    s_waitcnt lgkmcnt(4)
    v_mfma_f32_16x16x32_bf16 v[156:159], a[208:211], a[108:111], v[156:159]
    ds_read_b64_tr_b16 a[200:201], v11 offset:1024
    v_mfma_f32_16x16x32_bf16 v[156:159], a[212:215], a[124:127], v[156:159]
    ds_read_b64_tr_b16 a[202:203], v11 offset:7168
    v_mfma_f32_16x16x32_bf16 v[148:151], a[212:215], a[120:123], v[148:151]
    buffer_load_dwordx4 v2, s[8:11], s36 offen offset:256 lds
    v_mfma_f32_16x16x32_bf16 v[148:151], a[208:211], a[104:107], v[148:151]
    v_mfma_f32_16x16x32_bf16 v[140:143], a[208:211], a[100:103], v[140:143]
    s_add_u32 m0, s49, 52224
    ds_read_b64_tr_b16 a[204:205], v11 offset:13312
    v_mfma_f32_16x16x32_bf16 v[140:143], a[212:215], a[116:119], v[140:143]
    ds_read_b64_tr_b16 a[206:207], v11 offset:19456
    v_mfma_f32_16x16x32_bf16 v[132:135], a[212:215], a[112:115], v[132:135]
    buffer_load_dwordx4 v3, s[8:11], s36 offen offset:0 lds
    v_mfma_f32_16x16x32_bf16 v[132:135], a[208:211], a[96:99], v[132:135]
    s_waitcnt lgkmcnt(4)
    v_mfma_f32_16x16x32_bf16 v[160:163], a[192:195], a[96:99], v[160:163]
    ds_read_b64_tr_b16 a[208:209], v8 offset:2048
    v_mfma_f32_16x16x32_bf16 v[160:163], a[196:199], a[112:115], v[160:163]
    ds_read_b64_tr_b16 a[210:211], v8 offset:8192
    v_mfma_f32_16x16x32_bf16 v[168:171], a[196:199], a[116:119], v[168:171]
    v_mfma_f32_16x16x32_bf16 v[168:171], a[192:195], a[100:103], v[168:171]
    s_add_u32 m0, s49, 53120
    v_mfma_f32_16x16x32_bf16 v[176:179], a[192:195], a[104:107], v[176:179]
    ds_read_b64_tr_b16 a[212:213], v8 offset:14336
    v_mfma_f32_16x16x32_bf16 v[176:179], a[196:199], a[120:123], v[176:179]
    ds_read_b64_tr_b16 a[214:215], v8 offset:20480
    v_mfma_f32_16x16x32_bf16 v[184:187], a[196:199], a[124:127], v[184:187]
    buffer_load_dwordx4 v3, s[8:11], s36 offen offset:128 lds
    v_mfma_f32_16x16x32_bf16 v[184:187], a[192:195], a[108:111], v[184:187]
    s_waitcnt lgkmcnt(4)
    v_add_u32 v8, 0, v12
    v_mfma_f32_16x16x32_bf16 v[188:191], a[200:203], a[108:111], v[188:191]
    ds_read_b64_tr_b16 a[192:193], v9 offset:2048
    v_mfma_f32_16x16x32_bf16 v[188:191], a[204:207], a[124:127], v[188:191]
    s_add_u32 m0, s49, 54016
    ds_read_b64_tr_b16 a[194:195], v9 offset:8192
    v_mfma_f32_16x16x32_bf16 v[180:183], a[204:207], a[120:123], v[180:183]
    buffer_load_dwordx4 v3, s[8:11], s36 offen offset:256 lds
    v_mfma_f32_16x16x32_bf16 v[180:183], a[200:203], a[104:107], v[180:183]
    s_add_u32 s36, s36, s37
    s_sub_u32 s55, s36, 7864320
    s_min_u32 s36, s36, s55
    v_mfma_f32_16x16x32_bf16 v[172:175], a[200:203], a[100:103], v[172:175]
    ds_read_b64_tr_b16 a[196:197], v9 offset:14336
    v_mfma_f32_16x16x32_bf16 v[172:175], a[204:207], a[116:119], v[172:175]
    s_add_u32 s46, s45, 45056
    ds_read_b64_tr_b16 a[198:199], v9 offset:20480
    s_sub_u32 s77, s46, 81920
    v_mfma_f32_16x16x32_bf16 v[164:167], a[204:207], a[112:115], v[164:167]
    s_min_u32 s46, s46, s77
    v_add_u32 v9, 0, v13
    v_mfma_f32_16x16x32_bf16 v[164:167], a[200:203], a[96:99], v[164:167]
    s_waitcnt lgkmcnt(4)
    v_mfma_f32_16x16x32_bf16 v[192:195], a[208:211], a[96:99], v[192:195]
    ds_read_b64_tr_b16 a[200:201], v10 offset:2048
    v_mfma_f32_16x16x32_bf16 v[192:195], a[212:215], a[112:115], v[192:195]
    ds_read_b64_tr_b16 a[202:203], v10 offset:8192
    v_mfma_f32_16x16x32_bf16 v[200:203], a[212:215], a[116:119], v[200:203]
    buffer_load_dwordx4 a[176:179], v28, s[20:23], s46 offen offset:0 sc1
    v_mfma_f32_16x16x32_bf16 v[200:203], a[208:211], a[100:103], v[200:203]
    v_mfma_f32_16x16x32_bf16 v[208:211], a[208:211], a[104:107], v[208:211]
    ds_read_b64_tr_b16 a[204:205], v10 offset:14336
    v_mfma_f32_16x16x32_bf16 v[208:211], a[212:215], a[120:123], v[208:211]
    ds_read_b64_tr_b16 a[206:207], v10 offset:20480
    v_mfma_f32_16x16x32_bf16 v[216:219], a[212:215], a[124:127], v[216:219]
    v_add_u32 v10, 0, v14
    v_mfma_f32_16x16x32_bf16 v[216:219], a[208:211], a[108:111], v[216:219]
    s_waitcnt lgkmcnt(4)
    v_mfma_f32_16x16x32_bf16 v[220:223], a[192:195], a[108:111], v[220:223]
    s_waitcnt vmcnt(13)
    ds_read_b64_tr_b16 a[208:209], v11 offset:2048
    v_xor_b32 v34, s7, v34
    v_mfma_f32_16x16x32_bf16 v[220:223], a[196:199], a[124:127], v[220:223]
    ds_read_b64_tr_b16 a[210:211], v11 offset:8192
    v_xor_b32 v38, s7, v38
    v_mfma_f32_16x16x32_bf16 v[212:215], a[196:199], a[120:123], v[212:215]
    buffer_load_dwordx4 a[180:183], v28, s[20:23], s46 offen offset:1024 sc1
    v_mfma_f32_16x16x32_bf16 v[212:215], a[192:195], a[104:107], v[212:215]
    v_xor_b32 v42, s7, v42
    v_xor_b32 v46, s7, v46
    v_mfma_f32_16x16x32_bf16 v[204:207], a[192:195], a[100:103], v[204:207]
    ds_read_b64_tr_b16 a[212:213], v11 offset:14336
    v_or3_b32 v34, v34, v38, v42
    v_mfma_f32_16x16x32_bf16 v[204:207], a[196:199], a[116:119], v[204:207]
    s_waitcnt vmcnt(35)
    ds_read_b64_tr_b16 a[214:215], v11 offset:20480
    v_or_b32 v34, v34, v46
    v_mfma_f32_16x16x32_bf16 v[196:199], a[196:199], a[112:115], v[196:199]
    s_barrier
    v_mfma_f32_16x16x32_bf16 v[196:199], a[192:195], a[96:99], v[196:199]
    s_waitcnt lgkmcnt(4)
    v_cmp_ne_u32 vcc, 0, v34
    v_add_u32 v11, 0, v15
    v_mfma_f32_16x16x32_bf16 v[224:227], a[200:203], a[96:99], v[224:227]
pg_2:
    s_cbranch_execz pg_ret
    ds_read_b64_tr_b16 a[192:193], v8 offset:0
    v_mfma_f32_16x16x32_bf16 v[224:227], a[204:207], a[112:115], v[224:227]
    ds_read_b64_tr_b16 a[194:195], v8 offset:6144
    v_mfma_f32_16x16x32_bf16 v[232:235], a[204:207], a[116:119], v[232:235]
    s_cbranch_vccnz spin_rec
spin_rec_ret:
    v_max_u32 v20, v32, v33
    v_mfma_f32_16x16x32_bf16 v[232:235], a[200:203], a[100:103], v[232:235]
    buffer_load_dwordx4 a[184:187], v28, s[20:23], s46 offen offset:2048 sc1
    v_mfma_f32_16x16x32_bf16 v[240:243], a[200:203], a[104:107], v[240:243]
    ds_read_b64_tr_b16 a[196:197], v8 offset:12288
    v_min_u32 v21, v32, v33
    v_mfma_f32_16x16x32_bf16 v[240:243], a[204:207], a[120:123], v[240:243]
    ds_read_b64_tr_b16 a[198:199], v8 offset:18432
    v_med3_u32 v21, v20, v21, v36
    v_mfma_f32_16x16x32_bf16 v[248:251], a[204:207], a[124:127], v[248:251]
    buffer_load_dwordx4 a[188:191], v28, s[20:23], s46 offen offset:3072 sc1
    v_mfma_f32_16x16x32_bf16 v[248:251], a[200:203], a[108:111], v[248:251]
    s_waitcnt lgkmcnt(4)
    v_max_u32 v20, v20, v36
    v_med3_u32 v21, v20, v21, v37
    v_mfma_f32_16x16x32_bf16 v[252:255], a[208:211], a[108:111], v[252:255]
    s_add_u32 s46, s45, 49152
    ds_read_b64_tr_b16 a[200:201], v9 offset:0
    v_max_u32 v20, v20, v37
    v_mfma_f32_16x16x32_bf16 v[252:255], a[212:215], a[124:127], v[252:255]
    s_sub_u32 s77, s46, 81920
    ds_read_b64_tr_b16 a[202:203], v9 offset:6144
    v_med3_u32 v21, v20, v21, v40
    v_mfma_f32_16x16x32_bf16 v[244:247], a[212:215], a[120:123], v[244:247]
    s_min_u32 s46, s46, s77
    v_max_u32 v20, v20, v40
    v_med3_u32 v21, v20, v21, v41
    v_mfma_f32_16x16x32_bf16 v[244:247], a[208:211], a[104:107], v[244:247]
    buffer_load_dwordx4 a[0:3], v28, s[20:23], s46 offen offset:0 sc1
    v_mfma_f32_16x16x32_bf16 v[236:239], a[208:211], a[100:103], v[236:239]
    ds_read_b64_tr_b16 a[204:205], v9 offset:12288
    v_max_u32 v20, v20, v41
    v_mfma_f32_16x16x32_bf16 v[236:239], a[212:215], a[116:119], v[236:239]
    s_waitcnt vmcnt(29)
    s_waitcnt vmcnt(15)
    ds_read_b64_tr_b16 a[206:207], v9 offset:18432
    v_mfma_f32_16x16x32_bf16 v[228:231], a[212:215], a[112:115], v[228:231]
    v_med3_u32 v21, v20, v21, v44
    v_max_u32 v20, v20, v44
    v_mfma_f32_16x16x32_bf16 v[228:231], a[208:211], a[96:99], v[228:231]
    s_waitcnt lgkmcnt(4)
    v_med3_u32 v21, v20, v21, v45
    v_max_u32 v20, v20, v45
    v_mfma_f32_16x16x32_bf16 v[64:67], a[192:195], a[128:131], v[64:67]
    ds_read_b64_tr_b16 a[208:209], v10 offset:0
    v_mov_b32_dpp v22, v20 row_ror:8 row_mask:0xf bank_mask:0xf
    v_mfma_f32_16x16x32_bf16 v[64:67], a[196:199], a[144:147], v[64:67]
    ds_read_b64_tr_b16 a[210:211], v10 offset:6144
    v_mov_b32_dpp v23, v21 row_ror:8 row_mask:0xf bank_mask:0xf
    v_mfma_f32_16x16x32_bf16 v[72:75], a[196:199], a[148:151], v[72:75]
    buffer_load_dwordx4 a[4:7], v28, s[20:23], s46 offen offset:1024 sc1
    v_mfma_f32_16x16x32_bf16 v[72:75], a[192:195], a[132:135], v[72:75]
    v_min_u32 v24, v20, v22
    v_max_u32 v20, v20, v22
    v_mfma_f32_16x16x32_bf16 v[80:83], a[192:195], a[136:139], v[80:83]
    ds_read_b64_tr_b16 a[212:213], v10 offset:12288
    v_max3_u32 v21, v24, v21, v23
    v_mfma_f32_16x16x32_bf16 v[80:83], a[196:199], a[152:155], v[80:83]
    ds_read_b64_tr_b16 a[214:215], v10 offset:18432
    v_mov_b32_dpp v22, v20 row_ror:4 row_mask:0xf bank_mask:0xf
    v_mfma_f32_16x16x32_bf16 v[88:91], a[196:199], a[156:159], v[88:91]
    v_mov_b32_dpp v23, v21 row_ror:4 row_mask:0xf bank_mask:0xf
    v_min_u32 v24, v20, v22
    v_mfma_f32_16x16x32_bf16 v[88:91], a[192:195], a[140:143], v[88:91]
    s_waitcnt lgkmcnt(4)
    v_max_u32 v20, v20, v22
    v_max3_u32 v21, v24, v21, v23
    v_mfma_f32_16x16x32_bf16 v[92:95], a[200:203], a[140:143], v[92:95]
    ds_read_b64_tr_b16 a[192:193], v11 offset:0
    v_mov_b32_dpp v22, v20 row_ror:2 row_mask:0xf bank_mask:0xf
    v_mfma_f32_16x16x32_bf16 v[92:95], a[204:207], a[156:159], v[92:95]
    ds_read_b64_tr_b16 a[194:195], v11 offset:6144
    v_mov_b32_dpp v23, v21 row_ror:2 row_mask:0xf bank_mask:0xf
    v_mfma_f32_16x16x32_bf16 v[84:87], a[204:207], a[152:155], v[84:87]
    buffer_load_dwordx4 a[8:11], v28, s[20:23], s46 offen offset:2048 sc1
    v_mfma_f32_16x16x32_bf16 v[84:87], a[200:203], a[136:139], v[84:87]
    v_min_u32 v24, v20, v22
    v_max_u32 v20, v20, v22
    v_mfma_f32_16x16x32_bf16 v[76:79], a[200:203], a[132:135], v[76:79]
    ds_read_b64_tr_b16 a[196:197], v11 offset:12288
    v_max3_u32 v21, v24, v21, v23
    v_mfma_f32_16x16x32_bf16 v[76:79], a[204:207], a[148:151], v[76:79]
    ds_read_b64_tr_b16 a[198:199], v11 offset:18432
    v_mov_b32_dpp v22, v20 row_ror:1 row_mask:0xf bank_mask:0xf
    v_mfma_f32_16x16x32_bf16 v[68:71], a[204:207], a[144:147], v[68:71]
    buffer_load_dwordx4 a[12:15], v28, s[20:23], s46 offen offset:3072 sc1
    v_mfma_f32_16x16x32_bf16 v[68:71], a[200:203], a[128:131], v[68:71]
    s_waitcnt lgkmcnt(4)
    v_mov_b32_dpp v23, v21 row_ror:1 row_mask:0xf bank_mask:0xf
    v_min_u32 v24, v20, v22
    v_mfma_f32_16x16x32_bf16 v[96:99], a[208:211], a[128:131], v[96:99]
    s_andn2_b32 s88, s2, 7
    ds_read_b64_tr_b16 a[200:201], v8 offset:1024
    v_max_u32 v20, v20, v22
    v_mfma_f32_16x16x32_bf16 v[96:99], a[212:215], a[144:147], v[96:99]
    s_lshl_b32 s88, s88, 2
    ds_read_b64_tr_b16 a[202:203], v8 offset:7168
    v_max3_u32 v21, v24, v21, v23
    v_mfma_f32_16x16x32_bf16 v[104:107], a[212:215], a[148:151], v[104:107]
    s_lshr_b32 s89, s53, 1
    v_mov_b32 v22, v20
    v_mov_b32 v23, v21
    v_mfma_f32_16x16x32_bf16 v[104:107], a[208:211], a[132:135], v[104:107]
    s_add_u32 s88, s88, s89
    v_permlane16_swap_b32 v20, v22
    v_mfma_f32_16x16x32_bf16 v[112:115], a[208:211], a[136:139], v[112:115]
    s_add_u32 m0, s49, 73728
    ds_read_b64_tr_b16 a[204:205], v8 offset:13312
    v_lshl_add_u32 v60, v1, 2, s88
    v_mfma_f32_16x16x32_bf16 v[112:115], a[212:215], a[152:155], v[112:115]
    s_andn2_b32 s88, s2, 0x18
    ds_read_b64_tr_b16 a[206:207], v8 offset:19456
    v_accvgpr_write_b32 a96, 0
    v_mfma_f32_16x16x32_bf16 v[120:123], a[212:215], a[156:159], v[120:123]
    buffer_load_dwordx4 v2, s[8:11], s36 offen offset:0 lds
    v_mfma_f32_16x16x32_bf16 v[120:123], a[208:211], a[140:143], v[120:123]
    s_waitcnt lgkmcnt(4)
    v_permlane16_swap_b32 v21, v23
    v_mfma_f32_16x16x32_bf16 v[124:127], a[192:195], a[140:143], v[124:127]
    s_lshl_b32 s88, s88, 2
    ds_read_b64_tr_b16 a[208:209], v9 offset:1024
    v_min_u32 v24, v20, v22
    v_mfma_f32_16x16x32_bf16 v[124:127], a[196:199], a[156:159], v[124:127]
    s_add_u32 s88, s88, s3
    ds_read_b64_tr_b16 a[210:211], v9 offset:7168
    v_max_u32 v20, v20, v22
    v_mfma_f32_16x16x32_bf16 v[116:119], a[196:199], a[152:155], v[116:119]
    s_add_u32 m0, s49, 74624
    v_max3_u32 v21, v24, v21, v23
    v_mov_b32 v22, v20
    v_mfma_f32_16x16x32_bf16 v[116:119], a[192:195], a[136:139], v[116:119]
    buffer_load_dwordx4 v2, s[8:11], s36 offen offset:128 lds
    v_mfma_f32_16x16x32_bf16 v[108:111], a[192:195], a[132:135], v[108:111]
    ds_read_b64_tr_b16 a[212:213], v9 offset:13312
    v_mov_b32 v23, v21
    v_mfma_f32_16x16x32_bf16 v[108:111], a[196:199], a[148:151], v[108:111]
    ds_read_b64_tr_b16 a[214:215], v9 offset:19456
    v_and_b32 v61, 3, v1
    v_mfma_f32_16x16x32_bf16 v[100:103], a[196:199], a[144:147], v[100:103]
    v_permlane32_swap_b32 v20, v22
    v_mfma_f32_16x16x32_bf16 v[100:103], a[192:195], a[128:131], v[100:103]
    s_waitcnt lgkmcnt(4)
    v_permlane32_swap_b32 v21, v23
    v_mfma_f32_16x16x32_bf16 v[128:131], a[200:203], a[128:131], v[128:131]
    ds_read_b64_tr_b16 a[192:193], v10 offset:1024
    v_min_u32 v24, v20, v22
    v_mfma_f32_16x16x32_bf16 v[128:131], a[204:207], a[144:147], v[128:131]
    s_add_u32 m0, s49, 75520
    ds_read_b64_tr_b16 a[194:195], v10 offset:7168
    v_max_u32 v20, v20, v22
    v_mfma_f32_16x16x32_bf16 v[136:139], a[204:207], a[148:151], v[136:139]
    buffer_load_dwordx4 v2, s[8:11], s36 offen offset:256 lds
    v_mfma_f32_16x16x32_bf16 v[136:139], a[200:203], a[132:135], v[136:139]
    v_max3_u32 v21, v24, v21, v23
    v_lshl_add_u32 v61, v61, 5, s88
    v_mfma_f32_16x16x32_bf16 v[144:147], a[200:203], a[136:139], v[144:147]
    s_lshl_b32 s56, s3, 3
    ds_read_b64_tr_b16 a[196:197], v10 offset:13312
    v_cmp_gt_u32 s[88:89], 8, v1
    v_mfma_f32_16x16x32_bf16 v[144:147], a[204:207], a[152:155], v[144:147]
    s_add_u32 s56, s56, 147456
    ds_read_b64_tr_b16 a[198:199], v10 offset:19456
    v_mov_b32 v22, s56
    v_mfma_f32_16x16x32_bf16 v[152:155], a[204:207], a[156:159], v[152:155]
    v_mov_b32 v23, 147456
    v_cndmask_b32 v60, v61, v60, s[88:89]
    v_mfma_f32_16x16x32_bf16 v[152:155], a[200:203], a[140:143], v[152:155]
    s_waitcnt lgkmcnt(4)
    v_lshlrev_b32 v61, 2, v1
    v_cmp_gt_u32 s[88:89], 12, v1
    v_mfma_f32_16x16x32_bf16 v[156:159], a[208:211], a[140:143], v[156:159]
    s_add_u32 m0, s49, 76800
    ds_read_b64_tr_b16 a[200:201], v11 offset:1024
    v_cndmask_b32 v60, v61, v60, s[88:89]
    v_mfma_f32_16x16x32_bf16 v[156:159], a[212:215], a[156:159], v[156:159]
    ds_read_b64_tr_b16 a[202:203], v11 offset:7168
    v_lshlrev_b32 v60, 4, v60
    v_mfma_f32_16x16x32_bf16 v[148:151], a[212:215], a[152:155], v[148:151]
    buffer_load_dwordx4 v3, s[8:11], s36 offen offset:0 lds
    v_mfma_f32_16x16x32_bf16 v[148:151], a[208:211], a[136:139], v[148:151]
    v_accvgpr_write_b32 a97, 0
    v_accvgpr_write_b32 a98, 0
    v_mfma_f32_16x16x32_bf16 v[140:143], a[208:211], a[132:135], v[140:143]
    ds_read_b64_tr_b16 a[204:205], v11 offset:13312
    v_accvgpr_write_b32 a99, 0
    v_mfma_f32_16x16x32_bf16 v[140:143], a[212:215], a[148:151], v[140:143]
    ds_read_b64_tr_b16 a[206:207], v11 offset:19456
    v_accvgpr_write_b32 a100, 0
    v_mfma_f32_16x16x32_bf16 v[132:135], a[212:215], a[144:147], v[132:135]
    s_add_u32 m0, s49, 77696
    v_accvgpr_write_b32 a101, 0
    v_accvgpr_write_b32 a102, 0
    v_mfma_f32_16x16x32_bf16 v[132:135], a[208:211], a[128:131], v[132:135]
    s_waitcnt lgkmcnt(4)
    v_accvgpr_write_b32 a103, 0
    v_accvgpr_write_b32 a104, 0
    v_mfma_f32_16x16x32_bf16 v[160:163], a[192:195], a[128:131], v[160:163]
    ds_read_b64_tr_b16 a[208:209], v8 offset:2048
    v_accvgpr_write_b32 a105, 0
    v_mfma_f32_16x16x32_bf16 v[160:163], a[196:199], a[144:147], v[160:163]
    ds_read_b64_tr_b16 a[210:211], v8 offset:8192
    v_accvgpr_write_b32 a106, 0
    v_mfma_f32_16x16x32_bf16 v[168:171], a[196:199], a[148:151], v[168:171]
    buffer_load_dwordx4 v3, s[8:11], s36 offen offset:128 lds
    v_mfma_f32_16x16x32_bf16 v[168:171], a[192:195], a[132:135], v[168:171]
    v_accvgpr_write_b32 a107, 0
    v_accvgpr_write_b32 a108, 0
    v_mfma_f32_16x16x32_bf16 v[176:179], a[192:195], a[136:139], v[176:179]
    s_add_u32 m0, s49, 78592
    ds_read_b64_tr_b16 a[212:213], v8 offset:14336
    v_accvgpr_write_b32 a109, 0
    v_mfma_f32_16x16x32_bf16 v[176:179], a[196:199], a[152:155], v[176:179]
    ds_read_b64_tr_b16 a[214:215], v8 offset:20480
    v_accvgpr_write_b32 a110, 0
    v_mfma_f32_16x16x32_bf16 v[184:187], a[196:199], a[156:159], v[184:187]
    buffer_load_dwordx4 v3, s[8:11], s36 offen offset:256 lds
    v_mfma_f32_16x16x32_bf16 v[184:187], a[192:195], a[140:143], v[184:187]
    s_waitcnt lgkmcnt(4)
    v_accvgpr_write_b32 a111, 0
    v_accvgpr_write_b32 a112, 0
    v_mfma_f32_16x16x32_bf16 v[188:191], a[200:203], a[140:143], v[188:191]
    s_add_u32 s36, s36, s37
    ds_read_b64_tr_b16 a[192:193], v9 offset:2048
    v_accvgpr_write_b32 a113, 0
    v_mfma_f32_16x16x32_bf16 v[188:191], a[204:207], a[156:159], v[188:191]
    s_sub_u32 s55, s36, 7864320
    ds_read_b64_tr_b16 a[194:195], v9 offset:8192
    v_accvgpr_write_b32 a114, 0
    v_mfma_f32_16x16x32_bf16 v[180:183], a[204:207], a[152:155], v[180:183]
    s_min_u32 s36, s36, s55
    ds_write_b64 v22, v[20:21]
    v_accvgpr_write_b32 a115, 0
    v_mfma_f32_16x16x32_bf16 v[180:183], a[200:203], a[136:139], v[180:183]
    s_add_u32 s46, s45, 53248
    v_accvgpr_write_b32 a116, 0
    v_accvgpr_write_b32 a117, 0
    v_mfma_f32_16x16x32_bf16 v[172:175], a[200:203], a[132:135], v[172:175]
    s_sub_u32 s77, s46, 81920
    ds_read_b64_tr_b16 a[196:197], v9 offset:14336
    v_accvgpr_write_b32 a118, 0
    v_mfma_f32_16x16x32_bf16 v[172:175], a[204:207], a[148:151], v[172:175]
    s_min_u32 s46, s46, s77
    ds_read_b64_tr_b16 a[198:199], v9 offset:20480
    v_accvgpr_write_b32 a119, 0
    v_mfma_f32_16x16x32_bf16 v[164:167], a[204:207], a[144:147], v[164:167]
    buffer_load_dwordx4 a[16:19], v28, s[20:23], s46 offen offset:0 sc1
    v_mfma_f32_16x16x32_bf16 v[164:167], a[200:203], a[128:131], v[164:167]
    s_waitcnt lgkmcnt(4)
    v_accvgpr_write_b32 a120, 0
    v_accvgpr_write_b32 a121, 0
    v_mfma_f32_16x16x32_bf16 v[192:195], a[208:211], a[128:131], v[192:195]
    ds_read_b64_tr_b16 a[200:201], v10 offset:2048
    v_accvgpr_write_b32 a122, 0
    v_mfma_f32_16x16x32_bf16 v[192:195], a[212:215], a[144:147], v[192:195]
    ds_read_b64_tr_b16 a[202:203], v10 offset:8192
    v_accvgpr_write_b32 a123, 0
    v_mfma_f32_16x16x32_bf16 v[200:203], a[212:215], a[148:151], v[200:203]
    buffer_load_dwordx4 a[20:23], v28, s[20:23], s46 offen offset:1024 sc1
    v_mfma_f32_16x16x32_bf16 v[200:203], a[208:211], a[132:135], v[200:203]
    v_accvgpr_write_b32 a124, 0
    v_accvgpr_write_b32 a125, 0
    v_mfma_f32_16x16x32_bf16 v[208:211], a[208:211], a[136:139], v[208:211]
    ds_read_b64_tr_b16 a[204:205], v10 offset:14336
    v_accvgpr_write_b32 a126, 0
    v_mfma_f32_16x16x32_bf16 v[208:211], a[212:215], a[152:155], v[208:211]
    ds_read_b64_tr_b16 a[206:207], v10 offset:20480
    v_accvgpr_write_b32 a127, 0
    v_mfma_f32_16x16x32_bf16 v[216:219], a[212:215], a[156:159], v[216:219]
    v_add_u32 v8, 24576, v12
    v_add_u32 v9, 24576, v13
    v_mfma_f32_16x16x32_bf16 v[216:219], a[208:211], a[140:143], v[216:219]
    s_waitcnt lgkmcnt(4)
    v_add_u32 v10, 24576, v14
    v_mfma_f32_16x16x32_bf16 v[220:223], a[192:195], a[140:143], v[220:223]
    ds_read_b64_tr_b16 a[208:209], v11 offset:2048
    v_mfma_f32_16x16x32_bf16 v[220:223], a[196:199], a[156:159], v[220:223]
    ds_read_b64_tr_b16 a[210:211], v11 offset:8192
    v_mfma_f32_16x16x32_bf16 v[212:215], a[196:199], a[152:155], v[212:215]
    buffer_load_dwordx4 a[24:27], v28, s[20:23], s46 offen offset:2048 sc1
    v_mfma_f32_16x16x32_bf16 v[212:215], a[192:195], a[136:139], v[212:215]
    v_mfma_f32_16x16x32_bf16 v[204:207], a[192:195], a[132:135], v[204:207]
    ds_read_b64_tr_b16 a[212:213], v11 offset:14336
    v_mfma_f32_16x16x32_bf16 v[204:207], a[196:199], a[148:151], v[204:207]
    s_waitcnt vmcnt(33)
    ds_read_b64_tr_b16 a[214:215], v11 offset:20480
    v_mfma_f32_16x16x32_bf16 v[196:199], a[196:199], a[144:147], v[196:199]
    s_barrier
    v_mfma_f32_16x16x32_bf16 v[196:199], a[192:195], a[128:131], v[196:199]
    s_waitcnt lgkmcnt(4)
    v_add_u32 v11, 24576, v15
    v_mfma_f32_16x16x32_bf16 v[224:227], a[200:203], a[128:131], v[224:227]
    ds_read_b64_tr_b16 a[192:193], v8 offset:0
    v_mfma_f32_16x16x32_bf16 v[224:227], a[204:207], a[144:147], v[224:227]
    ds_read_b64_tr_b16 a[194:195], v8 offset:6144
    v_mfma_f32_16x16x32_bf16 v[232:235], a[204:207], a[148:151], v[232:235]
    ds_read_b128 v[32:35], v23
    v_mfma_f32_16x16x32_bf16 v[232:235], a[200:203], a[132:135], v[232:235]
    ds_read_b128 v[36:39], v23 offset:16
    v_mfma_f32_16x16x32_bf16 v[240:243], a[200:203], a[136:139], v[240:243]
    ds_read_b64_tr_b16 a[196:197], v8 offset:12288
    v_mfma_f32_16x16x32_bf16 v[240:243], a[204:207], a[152:155], v[240:243]
    ds_read_b64_tr_b16 a[198:199], v8 offset:18432
    v_mfma_f32_16x16x32_bf16 v[248:251], a[204:207], a[156:159], v[248:251]
    buffer_load_dwordx4 a[28:31], v28, s[20:23], s46 offen offset:3072 sc1
    v_mfma_f32_16x16x32_bf16 v[248:251], a[200:203], a[140:143], v[248:251]
    s_waitcnt lgkmcnt(4)
    s_add_u32 s46, s45, 57344
    s_sub_u32 s77, s46, 81920
    v_mfma_f32_16x16x32_bf16 v[252:255], a[208:211], a[140:143], v[252:255]
    s_min_u32 s46, s46, s77
    ds_read_b64_tr_b16 a[200:201], v9 offset:0
    v_mfma_f32_16x16x32_bf16 v[252:255], a[212:215], a[156:159], v[252:255]
    ds_read_b64_tr_b16 a[202:203], v9 offset:6144
    v_mfma_f32_16x16x32_bf16 v[244:247], a[212:215], a[152:155], v[244:247]
    buffer_load_dwordx4 a[32:35], v28, s[20:23], s46 offen offset:0 sc1
    v_mfma_f32_16x16x32_bf16 v[244:247], a[208:211], a[136:139], v[244:247]
    v_mfma_f32_16x16x32_bf16 v[236:239], a[208:211], a[132:135], v[236:239]
    ds_read_b64_tr_b16 a[204:205], v9 offset:12288
    v_mfma_f32_16x16x32_bf16 v[236:239], a[212:215], a[148:151], v[236:239]
    s_waitcnt vmcnt(25)
    s_waitcnt vmcnt(15)
    ds_read_b64_tr_b16 a[206:207], v9 offset:18432
    v_mfma_f32_16x16x32_bf16 v[228:231], a[212:215], a[144:147], v[228:231]
    buffer_load_dwordx4 a[36:39], v28, s[20:23], s46 offen offset:1024 sc1
    v_mfma_f32_16x16x32_bf16 v[228:231], a[208:211], a[128:131], v[228:231]
    s_waitcnt lgkmcnt(4)
    v_mfma_f32_16x16x32_bf16 v[64:67], a[192:195], a[160:163], v[64:67]
    ds_read_b64_tr_b16 a[208:209], v10 offset:0
    v_mfma_f32_16x16x32_bf16 v[64:67], a[196:199], a[176:179], v[64:67]
    ds_read_b64_tr_b16 a[210:211], v10 offset:6144
    v_accvgpr_write_b32 a128, 0
    v_mfma_f32_16x16x32_bf16 v[72:75], a[196:199], a[180:183], v[72:75]
    v_accvgpr_write_b32 a129, 0
    v_mfma_f32_16x16x32_bf16 v[72:75], a[192:195], a[164:167], v[72:75]
    buffer_load_dwordx4 a[40:43], v28, s[20:23], s46 offen offset:2048 sc1
    v_mfma_f32_16x16x32_bf16 v[80:83], a[192:195], a[168:171], v[80:83]
    ds_read_b64_tr_b16 a[212:213], v10 offset:12288
    v_max_u32 v20, v32, v33
    v_mfma_f32_16x16x32_bf16 v[80:83], a[196:199], a[184:187], v[80:83]
    ds_read_b64_tr_b16 a[214:215], v10 offset:18432
    v_min_u32 v21, v32, v33
    v_mfma_f32_16x16x32_bf16 v[88:91], a[196:199], a[188:191], v[88:91]
    v_med3_u32 v21, v20, v21, v34
    v_max_u32 v20, v20, v34
    v_mfma_f32_16x16x32_bf16 v[88:91], a[192:195], a[172:175], v[88:91]
    s_waitcnt lgkmcnt(4)
    v_med3_u32 v21, v20, v21, v35
    v_max_u32 v20, v20, v35
    v_mfma_f32_16x16x32_bf16 v[92:95], a[200:203], a[172:175], v[92:95]
    ds_read_b64_tr_b16 a[192:193], v11 offset:0
    v_med3_u32 v21, v20, v21, v36
    v_mfma_f32_16x16x32_bf16 v[92:95], a[204:207], a[188:191], v[92:95]
    ds_read_b64_tr_b16 a[194:195], v11 offset:6144
    v_max_u32 v20, v20, v36
    v_mfma_f32_16x16x32_bf16 v[84:87], a[204:207], a[184:187], v[84:87]
    buffer_load_dwordx4 a[44:47], v28, s[20:23], s46 offen offset:3072 sc1
    v_mfma_f32_16x16x32_bf16 v[84:87], a[200:203], a[168:171], v[84:87]
    v_med3_u32 v21, v20, v21, v37
    v_max_u32 v20, v20, v37
    v_mfma_f32_16x16x32_bf16 v[76:79], a[200:203], a[164:167], v[76:79]
    ds_read_b64_tr_b16 a[196:197], v11 offset:12288
    v_med3_u32 v21, v20, v21, v38
    v_mfma_f32_16x16x32_bf16 v[76:79], a[204:207], a[180:183], v[76:79]
    ds_read_b64_tr_b16 a[198:199], v11 offset:18432
    v_max_u32 v20, v20, v38
    v_mfma_f32_16x16x32_bf16 v[68:71], a[204:207], a[176:179], v[68:71]
    v_med3_u32 v21, v20, v21, v39
    v_max_u32 v20, v20, v39
    v_mfma_f32_16x16x32_bf16 v[68:71], a[200:203], a[160:163], v[68:71]
    s_waitcnt lgkmcnt(4)
    v_and_b32 v22, 1, v1
    v_cmp_eq_u32 vcc, 1, v22
    v_mfma_f32_16x16x32_bf16 v[96:99], a[208:211], a[160:163], v[96:99]
    s_add_u32 m0, s49, 98304
    ds_read_b64_tr_b16 a[200:201], v8 offset:1024
    v_readfirstlane_b32 s70, v20
    v_mfma_f32_16x16x32_bf16 v[96:99], a[212:215], a[176:179], v[96:99]
    ds_read_b64_tr_b16 a[202:203], v8 offset:7168
    v_readfirstlane_b32 s71, v21
    v_mfma_f32_16x16x32_bf16 v[104:107], a[212:215], a[180:183], v[104:107]
    buffer_load_dwordx4 v2, s[8:11], s36 offen offset:0 lds
    v_mfma_f32_16x16x32_bf16 v[104:107], a[208:211], a[164:167], v[104:107]
    v_cndmask_b32 v22, v20, v21, vcc
    v_and_b32 v22, 0x7ff, v22
    v_mfma_f32_16x16x32_bf16 v[112:115], a[208:211], a[168:171], v[112:115]
    ds_read_b64_tr_b16 a[204:205], v8 offset:13312
    v_sub_u32 v22, 2047, v22
    v_mfma_f32_16x16x32_bf16 v[112:115], a[212:215], a[184:187], v[112:115]
    s_add_u32 m0, s49, 99200
    ds_read_b64_tr_b16 a[206:207], v8 offset:19456
    v_mul_u32_u24 v23, 1280, v22
    v_mfma_f32_16x16x32_bf16 v[120:123], a[212:215], a[188:191], v[120:123]
    buffer_load_dwordx4 v2, s[8:11], s36 offen offset:128 lds
    v_mfma_f32_16x16x32_bf16 v[120:123], a[208:211], a[172:175], v[120:123]
    s_waitcnt lgkmcnt(4)
    v_lshrrev_b32 v24, 4, v1
    v_lshl_add_u32 v23, v24, 4, v23
    v_mfma_f32_16x16x32_bf16 v[124:127], a[192:195], a[172:175], v[124:127]
    ds_read_b64_tr_b16 a[208:209], v9 offset:1024
    v_add_u32 v23, s61, v23
    v_mfma_f32_16x16x32_bf16 v[124:127], a[196:199], a[188:191], v[124:127]
    ds_read_b64_tr_b16 a[210:211], v9 offset:7168
    v_lshlrev_b32 v24, 3, v22
    v_mfma_f32_16x16x32_bf16 v[116:119], a[196:199], a[184:187], v[116:119]
    s_mov_b32 s56, 3211264
    v_accvgpr_write_b32 a130, 0
    v_accvgpr_write_b32 a131, 0
    v_mfma_f32_16x16x32_bf16 v[116:119], a[192:195], a[168:171], v[116:119]
    v_accvgpr_write_b32 a132, 0
    v_accvgpr_write_b32 a133, 0
    v_mfma_f32_16x16x32_bf16 v[108:111], a[192:195], a[164:167], v[108:111]
    s_add_u32 m0, s49, 100096
    ds_read_b64_tr_b16 a[212:213], v9 offset:13312
    v_accvgpr_write_b32 a134, 0
    v_mfma_f32_16x16x32_bf16 v[108:111], a[196:199], a[180:183], v[108:111]
    ds_read_b64_tr_b16 a[214:215], v9 offset:19456
    v_accvgpr_write_b32 a135, 0
    v_mfma_f32_16x16x32_bf16 v[100:103], a[196:199], a[176:179], v[100:103]
    buffer_load_dwordx4 v2, s[8:11], s36 offen offset:256 lds
    v_mfma_f32_16x16x32_bf16 v[100:103], a[192:195], a[160:163], v[100:103]
    s_waitcnt lgkmcnt(4)
    v_accvgpr_write_b32 a136, 0
    v_accvgpr_write_b32 a137, 0
    v_mfma_f32_16x16x32_bf16 v[128:131], a[200:203], a[160:163], v[128:131]
    ds_read_b64_tr_b16 a[192:193], v10 offset:1024
    v_accvgpr_write_b32 a138, 0
    v_mfma_f32_16x16x32_bf16 v[128:131], a[204:207], a[176:179], v[128:131]
    ds_read_b64_tr_b16 a[194:195], v10 offset:7168
    v_accvgpr_write_b32 a139, 0
    v_mfma_f32_16x16x32_bf16 v[136:139], a[204:207], a[180:183], v[136:139]
    s_add_u32 m0, s49, 101376
    v_accvgpr_write_b32 a140, 0
    v_accvgpr_write_b32 a141, 0
    v_mfma_f32_16x16x32_bf16 v[136:139], a[200:203], a[164:167], v[136:139]
    buffer_load_dwordx4 v3, s[8:11], s36 offen offset:0 lds
    v_mfma_f32_16x16x32_bf16 v[144:147], a[200:203], a[168:171], v[144:147]
    ds_read_b64_tr_b16 a[196:197], v10 offset:13312
    v_accvgpr_write_b32 a142, 0
    v_mfma_f32_16x16x32_bf16 v[144:147], a[204:207], a[184:187], v[144:147]
    ds_read_b64_tr_b16 a[198:199], v10 offset:19456
    v_accvgpr_write_b32 a143, 0
    v_mfma_f32_16x16x32_bf16 v[152:155], a[204:207], a[188:191], v[152:155]
    v_accvgpr_write_b32 a144, 0
    v_accvgpr_write_b32 a145, 0
    v_mfma_f32_16x16x32_bf16 v[152:155], a[200:203], a[172:175], v[152:155]
    s_waitcnt lgkmcnt(4)
    v_accvgpr_write_b32 a146, 0
    v_accvgpr_write_b32 a147, 0
    v_mfma_f32_16x16x32_bf16 v[156:159], a[208:211], a[172:175], v[156:159]
    ds_read_b64_tr_b16 a[200:201], v11 offset:1024
    v_accvgpr_write_b32 a148, 0
    v_mfma_f32_16x16x32_bf16 v[156:159], a[212:215], a[188:191], v[156:159]
    s_add_u32 m0, s49, 102272
    ds_read_b64_tr_b16 a[202:203], v11 offset:7168
    v_accvgpr_write_b32 a149, 0
    v_mfma_f32_16x16x32_bf16 v[148:151], a[212:215], a[184:187], v[148:151]
    buffer_load_dwordx4 v3, s[8:11], s36 offen offset:128 lds
    v_mfma_f32_16x16x32_bf16 v[148:151], a[208:211], a[168:171], v[148:151]
    v_accvgpr_write_b32 a150, 0
    v_accvgpr_write_b32 a151, 0
    v_mfma_f32_16x16x32_bf16 v[140:143], a[208:211], a[164:167], v[140:143]
    ds_read_b64_tr_b16 a[204:205], v11 offset:13312
    v_accvgpr_write_b32 a152, 0
    v_mfma_f32_16x16x32_bf16 v[140:143], a[212:215], a[180:183], v[140:143]
    ds_read_b64_tr_b16 a[206:207], v11 offset:19456
    v_accvgpr_write_b32 a153, 0
    v_mfma_f32_16x16x32_bf16 v[132:135], a[212:215], a[176:179], v[132:135]
    v_accvgpr_write_b32 a154, 0
    v_accvgpr_write_b32 a155, 0
    v_mfma_f32_16x16x32_bf16 v[132:135], a[208:211], a[160:163], v[132:135]
    s_waitcnt lgkmcnt(4)
    v_accvgpr_write_b32 a156, 0
    v_accvgpr_write_b32 a157, 0
    v_mfma_f32_16x16x32_bf16 v[160:163], a[192:195], a[160:163], v[160:163]
    s_add_u32 m0, s49, 103168
    ds_read_b64_tr_b16 a[208:209], v8 offset:2048
    v_accvgpr_write_b32 a158, 0
    v_mfma_f32_16x16x32_bf16 v[160:163], a[196:199], a[176:179], v[160:163]
    ds_read_b64_tr_b16 a[210:211], v8 offset:8192
    v_accvgpr_write_b32 a159, 0
    v_mfma_f32_16x16x32_bf16 v[168:171], a[196:199], a[180:183], v[168:171]
    buffer_load_dwordx4 v3, s[8:11], s36 offen offset:256 lds
    v_mfma_f32_16x16x32_bf16 v[168:171], a[192:195], a[164:167], v[168:171]
    s_add_u32 s36, s36, s37
    s_sub_u32 s55, s36, 7864320
    s_min_u32 s36, s36, s55
    v_mfma_f32_16x16x32_bf16 v[176:179], a[192:195], a[168:171], v[176:179]
    s_add_u32 s46, s45, 61440
    ds_read_b64_tr_b16 a[212:213], v8 offset:14336
    s_sub_u32 s77, s46, 81920
    v_mfma_f32_16x16x32_bf16 v[176:179], a[196:199], a[184:187], v[176:179]
    s_min_u32 s46, s46, s77
    ds_read_b64_tr_b16 a[214:215], v8 offset:20480
    v_mfma_f32_16x16x32_bf16 v[184:187], a[196:199], a[188:191], v[184:187]
    v_add_u32 v8, 49152, v12
    v_mfma_f32_16x16x32_bf16 v[184:187], a[192:195], a[172:175], v[184:187]
    s_waitcnt lgkmcnt(4)
    v_mfma_f32_16x16x32_bf16 v[188:191], a[200:203], a[172:175], v[188:191]
    ds_read_b64_tr_b16 a[192:193], v9 offset:2048
    v_mfma_f32_16x16x32_bf16 v[188:191], a[204:207], a[188:191], v[188:191]
    ds_read_b64_tr_b16 a[194:195], v9 offset:8192
    v_mfma_f32_16x16x32_bf16 v[180:183], a[204:207], a[184:187], v[180:183]
    buffer_load_dwordx4 a[48:51], v28, s[20:23], s46 offen offset:0 sc1
    v_mfma_f32_16x16x32_bf16 v[180:183], a[200:203], a[168:171], v[180:183]
    v_mfma_f32_16x16x32_bf16 v[172:175], a[200:203], a[164:167], v[172:175]
    ds_read_b64_tr_b16 a[196:197], v9 offset:14336
    v_mfma_f32_16x16x32_bf16 v[172:175], a[204:207], a[180:183], v[172:175]
    ds_read_b64_tr_b16 a[198:199], v9 offset:20480
    v_mfma_f32_16x16x32_bf16 v[164:167], a[204:207], a[176:179], v[164:167]
    buffer_load_dwordx4 a[52:55], v28, s[20:23], s46 offen offset:1024 sc1
    v_mfma_f32_16x16x32_bf16 v[164:167], a[200:203], a[160:163], v[164:167]
    s_waitcnt lgkmcnt(4)
    v_add_u32 v9, 49152, v13
    v_mfma_f32_16x16x32_bf16 v[192:195], a[208:211], a[160:163], v[192:195]
    ds_read_b64_tr_b16 a[200:201], v10 offset:2048
    v_mfma_f32_16x16x32_bf16 v[192:195], a[212:215], a[176:179], v[192:195]
    ds_read_b64_tr_b16 a[202:203], v10 offset:8192
    v_mfma_f32_16x16x32_bf16 v[200:203], a[212:215], a[180:183], v[200:203]
    v_mfma_f32_16x16x32_bf16 v[200:203], a[208:211], a[164:167], v[200:203]
    v_mfma_f32_16x16x32_bf16 v[208:211], a[208:211], a[168:171], v[208:211]
    ds_read_b64_tr_b16 a[204:205], v10 offset:14336
    v_mfma_f32_16x16x32_bf16 v[208:211], a[212:215], a[184:187], v[208:211]
    ds_read_b64_tr_b16 a[206:207], v10 offset:20480
    v_mfma_f32_16x16x32_bf16 v[216:219], a[212:215], a[188:191], v[216:219]
    buffer_load_dwordx4 a[56:59], v28, s[20:23], s46 offen offset:2048 sc1
    v_mfma_f32_16x16x32_bf16 v[216:219], a[208:211], a[172:175], v[216:219]
    s_waitcnt lgkmcnt(4)
    v_add_u32 v10, 49152, v14
    v_mfma_f32_16x16x32_bf16 v[220:223], a[192:195], a[172:175], v[220:223]
    ds_read_b64_tr_b16 a[208:209], v11 offset:2048
    v_mfma_f32_16x16x32_bf16 v[220:223], a[196:199], a[188:191], v[220:223]
    ds_read_b64_tr_b16 a[210:211], v11 offset:8192
    v_mfma_f32_16x16x32_bf16 v[212:215], a[196:199], a[184:187], v[212:215]
    buffer_load_dwordx4 a[60:63], v28, s[20:23], s46 offen offset:3072 sc1
    v_mfma_f32_16x16x32_bf16 v[212:215], a[192:195], a[168:171], v[212:215]
    v_mfma_f32_16x16x32_bf16 v[204:207], a[192:195], a[164:167], v[204:207]
    ds_read_b64_tr_b16 a[212:213], v11 offset:14336
    v_mfma_f32_16x16x32_bf16 v[204:207], a[196:199], a[180:183], v[204:207]
    s_waitcnt vmcnt(32)
    ds_read_b64_tr_b16 a[214:215], v11 offset:20480
    v_mfma_f32_16x16x32_bf16 v[196:199], a[196:199], a[176:179], v[196:199]
    s_barrier
    v_mfma_f32_16x16x32_bf16 v[196:199], a[192:195], a[160:163], v[196:199]
    s_waitcnt lgkmcnt(4)
    global_load_dwordx4 v[48:51], v23, s[64:65]
    v_mfma_f32_16x16x32_bf16 v[224:227], a[200:203], a[160:163], v[224:227]
    ds_read_b64_tr_b16 a[192:193], v8 offset:0
    v_add_u32 v11, 49152, v15
    v_mfma_f32_16x16x32_bf16 v[224:227], a[204:207], a[176:179], v[224:227]
    s_add_u32 m0, s44, 147456
    ds_read_b64_tr_b16 a[194:195], v8 offset:6144
    v_mfma_f32_16x16x32_bf16 v[232:235], a[204:207], a[180:183], v[232:235]
pg_3:
    s_cbranch_execz pg_ret
    global_load_dwordx4 v[52:55], v23, s[64:65] offset:64
    v_mfma_f32_16x16x32_bf16 v[232:235], a[200:203], a[164:167], v[232:235]
    buffer_load_dwordx2 v[40:41], v24, s[24:27], s56 offen sc1
    v_mfma_f32_16x16x32_bf16 v[240:243], a[200:203], a[168:171], v[240:243]
    ds_read_b64_tr_b16 a[196:197], v8 offset:12288
    v_bfe_u32 v26, v1, 2, 3
    v_mfma_f32_16x16x32_bf16 v[240:243], a[204:207], a[184:187], v[240:243]
    ds_read_b64_tr_b16 a[198:199], v8 offset:18432
    v_lshlrev_b32 v25, 7, v26
    v_mfma_f32_16x16x32_bf16 v[248:251], a[204:207], a[188:191], v[248:251]
    buffer_load_dword v61, v60, s[24:27], s47 offen offset:12 sc1
    v_mfma_f32_16x16x32_bf16 v[248:251], a[200:203], a[172:175], v[248:251]
    s_waitcnt lgkmcnt(4)
    buffer_load_dwordx4 v56, s[28:31], s60 offen lds
    v_mfma_f32_16x16x32_bf16 v[252:255], a[208:211], a[172:175], v[252:255]
    s_add_u32 m0, s44, 148480
    ds_read_b64_tr_b16 a[200:201], v9 offset:0
    v_lshrrev_b32 v26, 1, v26
    v_mfma_f32_16x16x32_bf16 v[252:255], a[212:215], a[188:191], v[252:255]
    ds_read_b64_tr_b16 a[202:203], v9 offset:6144
    v_xor_b32 v26, s3, v26
    v_mfma_f32_16x16x32_bf16 v[244:247], a[212:215], a[184:187], v[244:247]
    buffer_load_dwordx4 v56, s[32:35], s60 offen lds
    v_mfma_f32_16x16x32_bf16 v[244:247], a[208:211], a[168:171], v[244:247]
    s_add_u32 m0, s44, 149504
    v_lshl_add_u32 v25, v26, 5, v25
    v_and_b32 v26, 3, v1
    v_mfma_f32_16x16x32_bf16 v[236:239], a[208:211], a[164:167], v[236:239]
    ds_read_b64_tr_b16 a[204:205], v9 offset:12288
    v_lshl_add_u32 v25, v26, 3, v25
    v_mfma_f32_16x16x32_bf16 v[236:239], a[212:215], a[180:183], v[236:239]
    s_waitcnt vmcnt(30)
    s_waitcnt vmcnt(20)
    ds_read_b64_tr_b16 a[206:207], v9 offset:18432
    v_mfma_f32_16x16x32_bf16 v[228:231], a[212:215], a[176:179], v[228:231]
    buffer_load_dwordx4 v57, s[28:31], s60 offen lds
    v_mfma_f32_16x16x32_bf16 v[228:231], a[208:211], a[160:163], v[228:231]
    s_waitcnt lgkmcnt(4)
    v_lshrrev_b32 v26, 5, v1
    v_mul_u32_u24 v26, 2048, v26
    v_mfma_f32_16x16x32_bf16 v[64:67], a[192:195], a[0:3], v[64:67]
    s_add_u32 m0, s44, 150528
    ds_read_b64_tr_b16 a[208:209], v10 offset:0
    v_add_u32 v25, v25, v26
    v_mfma_f32_16x16x32_bf16 v[64:67], a[196:199], a[16:19], v[64:67]
    ds_read_b64_tr_b16 a[210:211], v10 offset:6144
    v_add_u32 v25, 147456, v25
    v_mfma_f32_16x16x32_bf16 v[72:75], a[196:199], a[20:23], v[72:75]
    buffer_load_dwordx4 v57, s[32:35], s60 offen lds
    v_mfma_f32_16x16x32_bf16 v[72:75], a[192:195], a[4:7], v[72:75]
    v_lshlrev_b32 v26, 4, v1
    v_cmp_gt_u32 vcc, 16, v1
    v_mfma_f32_16x16x32_bf16 v[80:83], a[192:195], a[8:11], v[80:83]
    ds_read_b64_tr_b16 a[212:213], v10 offset:12288
    v_mov_b32 v27, 0x7ffffff0
    v_mfma_f32_16x16x32_bf16 v[80:83], a[196:199], a[24:27], v[80:83]
    ds_read_b64_tr_b16 a[214:215], v10 offset:18432
    v_cndmask_b32 v26, v27, v26, vcc
    v_mfma_f32_16x16x32_bf16 v[88:91], a[196:199], a[28:31], v[88:91]
    v_accvgpr_write_b32 a160, 0
    v_mfma_f32_16x16x32_bf16 v[88:91], a[192:195], a[12:15], v[88:91]
    s_waitcnt lgkmcnt(4)
    v_accvgpr_write_b32 a161, 0
    v_mfma_f32_16x16x32_bf16 v[92:95], a[200:203], a[12:15], v[92:95]
    s_add_u32 s46, s45, 65536
    ds_read_b64_tr_b16 a[192:193], v11 offset:0
    v_accvgpr_write_b32 a162, 0
    v_mfma_f32_16x16x32_bf16 v[92:95], a[204:207], a[28:31], v[92:95]
    s_sub_u32 s77, s46, 81920
    ds_read_b64_tr_b16 a[194:195], v11 offset:6144
    v_accvgpr_write_b32 a163, 0
    v_mfma_f32_16x16x32_bf16 v[84:87], a[204:207], a[24:27], v[84:87]
    s_min_u32 s46, s46, s77
    v_accvgpr_write_b32 a164, 0
    v_mfma_f32_16x16x32_bf16 v[84:87], a[200:203], a[8:11], v[84:87]
    buffer_load_dwordx4 a[64:67], v28, s[20:23], s46 offen offset:0 sc1
    v_mfma_f32_16x16x32_bf16 v[76:79], a[200:203], a[4:7], v[76:79]
    ds_read_b64_tr_b16 a[196:197], v11 offset:12288
    v_accvgpr_write_b32 a165, 0
    v_mfma_f32_16x16x32_bf16 v[76:79], a[204:207], a[20:23], v[76:79]
    ds_read_b64_tr_b16 a[198:199], v11 offset:18432
    v_accvgpr_write_b32 a166, 0
    v_mfma_f32_16x16x32_bf16 v[68:71], a[204:207], a[16:19], v[68:71]
    v_accvgpr_write_b32 a167, 0
    v_mfma_f32_16x16x32_bf16 v[68:71], a[200:203], a[0:3], v[68:71]
    s_waitcnt lgkmcnt(4)
    v_accvgpr_write_b32 a168, 0
    v_mfma_f32_16x16x32_bf16 v[96:99], a[208:211], a[0:3], v[96:99]
    ds_read_b64_tr_b16 a[200:201], v8 offset:1024
    v_accvgpr_write_b32 a169, 0
    v_mfma_f32_16x16x32_bf16 v[96:99], a[212:215], a[16:19], v[96:99]
    ds_read_b64_tr_b16 a[202:203], v8 offset:7168
    v_accvgpr_write_b32 a170, 0
    v_mfma_f32_16x16x32_bf16 v[104:107], a[212:215], a[20:23], v[104:107]
    buffer_load_dwordx4 a[68:71], v28, s[20:23], s46 offen offset:1024 sc1
    v_mfma_f32_16x16x32_bf16 v[104:107], a[208:211], a[4:7], v[104:107]
    v_accvgpr_write_b32 a171, 0
    v_accvgpr_write_b32 a172, 0
    v_mfma_f32_16x16x32_bf16 v[112:115], a[208:211], a[8:11], v[112:115]
    ds_read_b64_tr_b16 a[204:205], v8 offset:13312
    v_accvgpr_write_b32 a173, 0
    v_mfma_f32_16x16x32_bf16 v[112:115], a[212:215], a[24:27], v[112:115]
    ds_read_b64_tr_b16 a[206:207], v8 offset:19456
    v_accvgpr_write_b32 a174, 0
    v_mfma_f32_16x16x32_bf16 v[120:123], a[212:215], a[28:31], v[120:123]
    v_accvgpr_write_b32 a175, 0
    v_accvgpr_write_b32 a176, 0
    v_mfma_f32_16x16x32_bf16 v[120:123], a[208:211], a[12:15], v[120:123]
    s_waitcnt lgkmcnt(4)
    v_accvgpr_write_b32 a177, 0
    v_accvgpr_write_b32 a178, 0
    v_mfma_f32_16x16x32_bf16 v[124:127], a[192:195], a[12:15], v[124:127]
    ds_read_b64_tr_b16 a[208:209], v9 offset:1024
    v_accvgpr_write_b32 a179, 0
    v_mfma_f32_16x16x32_bf16 v[124:127], a[196:199], a[28:31], v[124:127]
    ds_read_b64_tr_b16 a[210:211], v9 offset:7168
    v_accvgpr_write_b32 a180, 0
    v_mfma_f32_16x16x32_bf16 v[116:119], a[196:199], a[24:27], v[116:119]
    buffer_load_dwordx4 a[72:75], v28, s[20:23], s46 offen offset:2048 sc1
    v_mfma_f32_16x16x32_bf16 v[116:119], a[192:195], a[8:11], v[116:119]
    v_accvgpr_write_b32 a181, 0
    v_accvgpr_write_b32 a182, 0
    v_mfma_f32_16x16x32_bf16 v[108:111], a[192:195], a[4:7], v[108:111]
    ds_read_b64_tr_b16 a[212:213], v9 offset:13312
    v_accvgpr_write_b32 a183, 0
    v_mfma_f32_16x16x32_bf16 v[108:111], a[196:199], a[20:23], v[108:111]
    ds_read_b64_tr_b16 a[214:215], v9 offset:19456
    v_accvgpr_write_b32 a184, 0
    v_mfma_f32_16x16x32_bf16 v[100:103], a[196:199], a[16:19], v[100:103]
    buffer_load_dwordx4 a[76:79], v28, s[20:23], s46 offen offset:3072 sc1
    v_mfma_f32_16x16x32_bf16 v[100:103], a[192:195], a[0:3], v[100:103]
    s_waitcnt lgkmcnt(4)
    v_accvgpr_write_b32 a185, 0
    v_accvgpr_write_b32 a186, 0
    v_mfma_f32_16x16x32_bf16 v[128:131], a[200:203], a[0:3], v[128:131]
    ds_read_b64_tr_b16 a[192:193], v10 offset:1024
    v_accvgpr_write_b32 a187, 0
    v_mfma_f32_16x16x32_bf16 v[128:131], a[204:207], a[16:19], v[128:131]
    ds_read_b64_tr_b16 a[194:195], v10 offset:7168
    v_accvgpr_write_b32 a188, 0
    v_mfma_f32_16x16x32_bf16 v[136:139], a[204:207], a[20:23], v[136:139]
    v_accvgpr_write_b32 a189, 0
    v_accvgpr_write_b32 a190, 0
    v_mfma_f32_16x16x32_bf16 v[136:139], a[200:203], a[4:7], v[136:139]
    v_accvgpr_write_b32 a191, 0
    v_mfma_f32_16x16x32_bf16 v[144:147], a[200:203], a[8:11], v[144:147]
    s_add_u32 m0, s49, 122880
    ds_read_b64_tr_b16 a[196:197], v10 offset:13312
    v_mfma_f32_16x16x32_bf16 v[144:147], a[204:207], a[24:27], v[144:147]
    ds_read_b64_tr_b16 a[198:199], v10 offset:19456
    v_mfma_f32_16x16x32_bf16 v[152:155], a[204:207], a[28:31], v[152:155]
    buffer_load_dwordx4 v2, s[8:11], s36 offen offset:0 lds
    v_mfma_f32_16x16x32_bf16 v[152:155], a[200:203], a[12:15], v[152:155]
    s_waitcnt lgkmcnt(4)
    v_mfma_f32_16x16x32_bf16 v[156:159], a[208:211], a[12:15], v[156:159]
    ds_read_b64_tr_b16 a[200:201], v11 offset:1024
    v_mfma_f32_16x16x32_bf16 v[156:159], a[212:215], a[28:31], v[156:159]
    ds_read_b64_tr_b16 a[202:203], v11 offset:7168
    v_mfma_f32_16x16x32_bf16 v[148:151], a[212:215], a[24:27], v[148:151]
    s_add_u32 m0, s49, 123776
    v_mfma_f32_16x16x32_bf16 v[148:151], a[208:211], a[8:11], v[148:151]
    buffer_load_dwordx4 v2, s[8:11], s36 offen offset:128 lds
    v_mfma_f32_16x16x32_bf16 v[140:143], a[208:211], a[4:7], v[140:143]
    ds_read_b64_tr_b16 a[204:205], v11 offset:13312
    v_mfma_f32_16x16x32_bf16 v[140:143], a[212:215], a[20:23], v[140:143]
    ds_read_b64_tr_b16 a[206:207], v11 offset:19456
    v_mfma_f32_16x16x32_bf16 v[132:135], a[212:215], a[16:19], v[132:135]
    v_mfma_f32_16x16x32_bf16 v[132:135], a[208:211], a[0:3], v[132:135]
    s_waitcnt lgkmcnt(4)
    v_mfma_f32_16x16x32_bf16 v[160:163], a[192:195], a[0:3], v[160:163]
    ds_read_b64_tr_b16 a[208:209], v8 offset:2048
    v_mfma_f32_16x16x32_bf16 v[160:163], a[196:199], a[16:19], v[160:163]
    s_add_u32 m0, s49, 124672
    ds_read_b64_tr_b16 a[210:211], v8 offset:8192
    v_mfma_f32_16x16x32_bf16 v[168:171], a[196:199], a[20:23], v[168:171]
    buffer_load_dwordx4 v2, s[8:11], s36 offen offset:256 lds
    v_mfma_f32_16x16x32_bf16 v[168:171], a[192:195], a[4:7], v[168:171]
    v_mfma_f32_16x16x32_bf16 v[176:179], a[192:195], a[8:11], v[176:179]
    ds_read_b64_tr_b16 a[212:213], v8 offset:14336
    v_mfma_f32_16x16x32_bf16 v[176:179], a[196:199], a[24:27], v[176:179]
    ds_read_b64_tr_b16 a[214:215], v8 offset:20480
    v_mfma_f32_16x16x32_bf16 v[184:187], a[196:199], a[28:31], v[184:187]
    v_add_u32 v8, 73728, v12
    v_mfma_f32_16x16x32_bf16 v[184:187], a[192:195], a[12:15], v[184:187]
    s_waitcnt lgkmcnt(4)
    s_add_u32 m0, s49, 125952
    v_mfma_f32_16x16x32_bf16 v[188:191], a[200:203], a[12:15], v[188:191]
    ds_read_b64_tr_b16 a[192:193], v9 offset:2048
    v_mfma_f32_16x16x32_bf16 v[188:191], a[204:207], a[28:31], v[188:191]
    ds_read_b64_tr_b16 a[194:195], v9 offset:8192
    v_mfma_f32_16x16x32_bf16 v[180:183], a[204:207], a[24:27], v[180:183]
    buffer_load_dwordx4 v3, s[8:11], s36 offen offset:0 lds
    v_mfma_f32_16x16x32_bf16 v[180:183], a[200:203], a[8:11], v[180:183]
    v_mfma_f32_16x16x32_bf16 v[172:175], a[200:203], a[4:7], v[172:175]
    ds_read_b64_tr_b16 a[196:197], v9 offset:14336
    v_mfma_f32_16x16x32_bf16 v[172:175], a[204:207], a[20:23], v[172:175]
    ds_read_b64_tr_b16 a[198:199], v9 offset:20480
    v_mfma_f32_16x16x32_bf16 v[164:167], a[204:207], a[16:19], v[164:167]
    s_add_u32 m0, s49, 126848
    v_add_u32 v9, 73728, v13
    v_mfma_f32_16x16x32_bf16 v[164:167], a[200:203], a[0:3], v[164:167]
    s_waitcnt lgkmcnt(4)
    v_mfma_f32_16x16x32_bf16 v[192:195], a[208:211], a[0:3], v[192:195]
    ds_read_b64_tr_b16 a[200:201], v10 offset:2048
    v_mfma_f32_16x16x32_bf16 v[192:195], a[212:215], a[16:19], v[192:195]
    ds_read_b64_tr_b16 a[202:203], v10 offset:8192
    v_mfma_f32_16x16x32_bf16 v[200:203], a[212:215], a[20:23], v[200:203]
    buffer_load_dwordx4 v3, s[8:11], s36 offen offset:128 lds
    v_mfma_f32_16x16x32_bf16 v[200:203], a[208:211], a[4:7], v[200:203]
    v_mfma_f32_16x16x32_bf16 v[208:211], a[208:211], a[8:11], v[208:211]
    s_add_u32 m0, s49, 127744
    ds_read_b64_tr_b16 a[204:205], v10 offset:14336
    v_mfma_f32_16x16x32_bf16 v[208:211], a[212:215], a[24:27], v[208:211]
    ds_read_b64_tr_b16 a[206:207], v10 offset:20480
    v_mfma_f32_16x16x32_bf16 v[216:219], a[212:215], a[28:31], v[216:219]
    buffer_load_dwordx4 v3, s[8:11], s36 offen offset:256 lds
    v_mfma_f32_16x16x32_bf16 v[216:219], a[208:211], a[12:15], v[216:219]
    s_waitcnt lgkmcnt(4)
    v_add_u32 v10, 73728, v14
    s_add_u32 s36, s36, s37
    v_mfma_f32_16x16x32_bf16 v[220:223], a[192:195], a[12:15], v[220:223]
    s_sub_u32 s55, s36, 7864320
    ds_read_b64_tr_b16 a[208:209], v11 offset:2048
    s_min_u32 s36, s36, s55
    v_mfma_f32_16x16x32_bf16 v[220:223], a[196:199], a[28:31], v[220:223]
    s_add_u32 s46, s45, 69632
    ds_read_b64_tr_b16 a[210:211], v11 offset:8192
    s_sub_u32 s77, s46, 81920
    v_mfma_f32_16x16x32_bf16 v[212:215], a[196:199], a[24:27], v[212:215]
    s_min_u32 s46, s46, s77
    v_mfma_f32_16x16x32_bf16 v[212:215], a[192:195], a[8:11], v[212:215]
    v_mfma_f32_16x16x32_bf16 v[204:207], a[192:195], a[4:7], v[204:207]
    ds_read_b64_tr_b16 a[212:213], v11 offset:14336
    v_mfma_f32_16x16x32_bf16 v[204:207], a[196:199], a[20:23], v[204:207]
    s_waitcnt vmcnt(36)
    ds_read_b64_tr_b16 a[214:215], v11 offset:20480
    v_mfma_f32_16x16x32_bf16 v[196:199], a[196:199], a[16:19], v[196:199]
    s_barrier
    v_mfma_f32_16x16x32_bf16 v[196:199], a[192:195], a[0:3], v[196:199]
    s_waitcnt lgkmcnt(4)
    buffer_load_dwordx4 a[80:83], v28, s[20:23], s46 offen offset:0 sc1
    v_mfma_f32_16x16x32_bf16 v[224:227], a[200:203], a[0:3], v[224:227]
    ds_read_b64_tr_b16 a[192:193], v8 offset:0
    v_add_u32 v11, 73728, v15
    v_mfma_f32_16x16x32_bf16 v[224:227], a[204:207], a[16:19], v[224:227]
    ds_read_b64_tr_b16 a[194:195], v8 offset:6144
    v_mfma_f32_16x16x32_bf16 v[232:235], a[204:207], a[20:23], v[232:235]
    buffer_load_dwordx4 a[84:87], v28, s[20:23], s46 offen offset:1024 sc1
    v_mfma_f32_16x16x32_bf16 v[232:235], a[200:203], a[4:7], v[232:235]
    v_mfma_f32_16x16x32_bf16 v[240:243], a[200:203], a[8:11], v[240:243]
    ds_read_b64_tr_b16 a[196:197], v8 offset:12288
    v_mfma_f32_16x16x32_bf16 v[240:243], a[204:207], a[24:27], v[240:243]
    ds_read_b64_tr_b16 a[198:199], v8 offset:18432
    v_mfma_f32_16x16x32_bf16 v[248:251], a[204:207], a[28:31], v[248:251]
    v_mfma_f32_16x16x32_bf16 v[248:251], a[200:203], a[12:15], v[248:251]
    s_waitcnt lgkmcnt(4)
    v_mfma_f32_16x16x32_bf16 v[252:255], a[208:211], a[12:15], v[252:255]
    ds_read_b64_tr_b16 a[200:201], v9 offset:0
    v_mfma_f32_16x16x32_bf16 v[252:255], a[212:215], a[28:31], v[252:255]
    ds_read_b64_tr_b16 a[202:203], v9 offset:6144
    v_mfma_f32_16x16x32_bf16 v[244:247], a[212:215], a[24:27], v[244:247]
    buffer_load_dwordx4 a[88:91], v28, s[20:23], s46 offen offset:2048 sc1
    v_mfma_f32_16x16x32_bf16 v[244:247], a[208:211], a[8:11], v[244:247]
    v_mfma_f32_16x16x32_bf16 v[236:239], a[208:211], a[4:7], v[236:239]
    ds_read_b64_tr_b16 a[204:205], v9 offset:12288
    v_mfma_f32_16x16x32_bf16 v[236:239], a[212:215], a[20:23], v[236:239]
    s_waitcnt vmcnt(31)
    s_waitcnt vmcnt(21)
    ds_read_b64_tr_b16 a[206:207], v9 offset:18432
    v_mfma_f32_16x16x32_bf16 v[228:231], a[212:215], a[16:19], v[228:231]
    v_mfma_f32_16x16x32_bf16 v[228:231], a[208:211], a[0:3], v[228:231]
    s_waitcnt lgkmcnt(4)
    v_mfma_f32_16x16x32_bf16 v[64:67], a[192:195], a[32:35], v[64:67]
    ds_read_b64_tr_b16 a[208:209], v10 offset:0
    v_mfma_f32_16x16x32_bf16 v[64:67], a[196:199], a[48:51], v[64:67]
    ds_read_b64_tr_b16 a[210:211], v10 offset:6144
    v_accvgpr_write_b32 a0, 0
    v_mfma_f32_16x16x32_bf16 v[72:75], a[196:199], a[52:55], v[72:75]
    buffer_load_dwordx4 a[92:95], v28, s[20:23], s46 offen offset:3072 sc1
    v_mfma_f32_16x16x32_bf16 v[72:75], a[192:195], a[36:39], v[72:75]
    s_add_u32 s46, s45, 73728
    v_accvgpr_write_b32 a1, 0
    v_mfma_f32_16x16x32_bf16 v[80:83], a[192:195], a[40:43], v[80:83]
    s_sub_u32 s77, s46, 81920
    ds_read_b64_tr_b16 a[212:213], v10 offset:12288
    v_accvgpr_write_b32 a2, 0
    v_mfma_f32_16x16x32_bf16 v[80:83], a[196:199], a[56:59], v[80:83]
    s_min_u32 s46, s46, s77
    ds_read_b64_tr_b16 a[214:215], v10 offset:18432
    v_accvgpr_write_b32 a3, 0
    v_mfma_f32_16x16x32_bf16 v[88:91], a[196:199], a[60:63], v[88:91]
    buffer_load_dwordx4 a[224:227], v28, s[20:23], s46 offen offset:0 sc1
    v_mfma_f32_16x16x32_bf16 v[88:91], a[192:195], a[44:47], v[88:91]
    s_waitcnt lgkmcnt(4)
    v_accvgpr_write_b32 a4, 0
    v_mfma_f32_16x16x32_bf16 v[92:95], a[200:203], a[44:47], v[92:95]
    s_waitcnt vmcnt(20)
    ds_read_b64_tr_b16 a[192:193], v11 offset:0
    v_lshlrev_b32 v42, 16, v48
    v_mfma_f32_16x16x32_bf16 v[92:95], a[204:207], a[60:63], v[92:95]
    ds_read_b64_tr_b16 a[194:195], v11 offset:6144
    v_and_b32 v43, 0xffff0000, v48
    v_mfma_f32_16x16x32_bf16 v[84:87], a[204:207], a[56:59], v[84:87]
    v_sub_f32 v42, v42, v40
    v_sub_f32 v43, v43, v40
    v_mfma_f32_16x16x32_bf16 v[84:87], a[200:203], a[40:43], v[84:87]
    v_cvt_pk_bf16_f32 v44, v42, v43
    v_lshlrev_b32 v42, 16, v44
    v_mfma_f32_16x16x32_bf16 v[76:79], a[200:203], a[36:39], v[76:79]
    ds_read_b64_tr_b16 a[196:197], v11 offset:12288
    v_and_b32 v43, 0xffff0000, v44
    v_mfma_f32_16x16x32_bf16 v[76:79], a[204:207], a[52:55], v[76:79]
    ds_read_b64_tr_b16 a[198:199], v11 offset:18432
    v_mul_f32 v42, v42, v41
    v_mfma_f32_16x16x32_bf16 v[68:71], a[204:207], a[48:51], v[68:71]
    buffer_load_dwordx4 a[228:231], v28, s[20:23], s46 offen offset:1024 sc1
    v_mfma_f32_16x16x32_bf16 v[68:71], a[200:203], a[32:35], v[68:71]
    s_waitcnt lgkmcnt(4)
    v_mul_f32 v43, v43, v41
    v_cvt_pk_bf16_f32 v48, v42, v43
    v_mfma_f32_16x16x32_bf16 v[96:99], a[208:211], a[32:35], v[96:99]
    ds_read_b64_tr_b16 a[200:201], v8 offset:1024
    v_lshlrev_b32 v42, 16, v49
    v_mfma_f32_16x16x32_bf16 v[96:99], a[212:215], a[48:51], v[96:99]
    ds_read_b64_tr_b16 a[202:203], v8 offset:7168
    v_and_b32 v43, 0xffff0000, v49
    v_mfma_f32_16x16x32_bf16 v[104:107], a[212:215], a[52:55], v[104:107]
    s_waitcnt vmcnt(20)
    v_sub_f32 v42, v42, v40
    v_sub_f32 v43, v43, v40
    v_mfma_f32_16x16x32_bf16 v[104:107], a[208:211], a[36:39], v[104:107]
    buffer_load_dwordx4 a[232:235], v28, s[20:23], s46 offen offset:2048 sc1
    v_mfma_f32_16x16x32_bf16 v[112:115], a[208:211], a[40:43], v[112:115]
    ds_read_b64_tr_b16 a[204:205], v8 offset:13312
    v_cvt_pk_bf16_f32 v44, v42, v43
    v_mfma_f32_16x16x32_bf16 v[112:115], a[212:215], a[56:59], v[112:115]
    ds_read_b64_tr_b16 a[206:207], v8 offset:19456
    v_lshlrev_b32 v42, 16, v44
    v_mfma_f32_16x16x32_bf16 v[120:123], a[212:215], a[60:63], v[120:123]
    v_and_b32 v43, 0xffff0000, v44
    v_mul_f32 v42, v42, v41
    v_mfma_f32_16x16x32_bf16 v[120:123], a[208:211], a[44:47], v[120:123]
    s_waitcnt lgkmcnt(4)
    v_mul_f32 v43, v43, v41
    v_cvt_pk_bf16_f32 v49, v42, v43
    v_mfma_f32_16x16x32_bf16 v[124:127], a[192:195], a[44:47], v[124:127]
    ds_read_b64_tr_b16 a[208:209], v9 offset:1024
    v_lshlrev_b32 v42, 16, v50
    v_mfma_f32_16x16x32_bf16 v[124:127], a[196:199], a[60:63], v[124:127]
    ds_read_b64_tr_b16 a[210:211], v9 offset:7168
    v_and_b32 v43, 0xffff0000, v50
    v_mfma_f32_16x16x32_bf16 v[116:119], a[196:199], a[56:59], v[116:119]
    buffer_load_dwordx4 a[236:239], v28, s[20:23], s46 offen offset:3072 sc1
    v_mfma_f32_16x16x32_bf16 v[116:119], a[192:195], a[40:43], v[116:119]
    v_sub_f32 v42, v42, v40
    v_sub_f32 v43, v43, v40
    v_mfma_f32_16x16x32_bf16 v[108:111], a[192:195], a[36:39], v[108:111]
    s_add_u32 s46, s45, 77824
    ds_read_b64_tr_b16 a[212:213], v9 offset:13312
    v_cvt_pk_bf16_f32 v44, v42, v43
    v_mfma_f32_16x16x32_bf16 v[108:111], a[196:199], a[52:55], v[108:111]
    s_sub_u32 s77, s46, 81920
    ds_read_b64_tr_b16 a[214:215], v9 offset:19456
    v_lshlrev_b32 v42, 16, v44
    v_mfma_f32_16x16x32_bf16 v[100:103], a[196:199], a[48:51], v[100:103]
    s_min_u32 s46, s46, s77
    v_and_b32 v43, 0xffff0000, v44
    v_mul_f32 v42, v42, v41
    v_mfma_f32_16x16x32_bf16 v[100:103], a[192:195], a[32:35], v[100:103]
    s_waitcnt lgkmcnt(4)
    v_mul_f32 v43, v43, v41
    v_cvt_pk_bf16_f32 v50, v42, v43
    v_mfma_f32_16x16x32_bf16 v[128:131], a[200:203], a[32:35], v[128:131]
    ds_read_b64_tr_b16 a[192:193], v10 offset:1024
    v_lshlrev_b32 v42, 16, v51
    v_mfma_f32_16x16x32_bf16 v[128:131], a[204:207], a[48:51], v[128:131]
    ds_read_b64_tr_b16 a[194:195], v10 offset:7168
    v_and_b32 v43, 0xffff0000, v51
    v_mfma_f32_16x16x32_bf16 v[136:139], a[204:207], a[52:55], v[136:139]
    buffer_load_dwordx4 a[240:243], v28, s[20:23], s46 offen offset:0 sc1
    v_mfma_f32_16x16x32_bf16 v[136:139], a[200:203], a[36:39], v[136:139]
    v_sub_f32 v42, v42, v40
    v_sub_f32 v43, v43, v40
    v_mfma_f32_16x16x32_bf16 v[144:147], a[200:203], a[40:43], v[144:147]
    ds_read_b64_tr_b16 a[196:197], v10 offset:13312
    v_cvt_pk_bf16_f32 v44, v42, v43
    v_mfma_f32_16x16x32_bf16 v[144:147], a[204:207], a[56:59], v[144:147]
    ds_read_b64_tr_b16 a[198:199], v10 offset:19456
    v_lshlrev_b32 v42, 16, v44
    v_mfma_f32_16x16x32_bf16 v[152:155], a[204:207], a[60:63], v[152:155]
    buffer_load_dwordx4 a[244:247], v28, s[20:23], s46 offen offset:1024 sc1
    v_mfma_f32_16x16x32_bf16 v[152:155], a[200:203], a[44:47], v[152:155]
    s_waitcnt lgkmcnt(4)
    v_and_b32 v43, 0xffff0000, v44
    v_mul_f32 v42, v42, v41
    v_mfma_f32_16x16x32_bf16 v[156:159], a[208:211], a[44:47], v[156:159]
    ds_read_b64_tr_b16 a[200:201], v11 offset:1024
    v_mul_f32 v43, v43, v41
    v_mfma_f32_16x16x32_bf16 v[156:159], a[212:215], a[60:63], v[156:159]
    ds_read_b64_tr_b16 a[202:203], v11 offset:7168
    v_cvt_pk_bf16_f32 v51, v42, v43
    v_mfma_f32_16x16x32_bf16 v[148:151], a[212:215], a[56:59], v[148:151]
    v_lshlrev_b32 v42, 16, v52
    v_and_b32 v43, 0xffff0000, v52
    v_mfma_f32_16x16x32_bf16 v[148:151], a[208:211], a[40:43], v[148:151]
    v_sub_f32 v42, v42, v40
    v_sub_f32 v43, v43, v40
    v_mfma_f32_16x16x32_bf16 v[140:143], a[208:211], a[36:39], v[140:143]
    ds_read_b64_tr_b16 a[204:205], v11 offset:13312
    v_cvt_pk_bf16_f32 v44, v42, v43
    v_mfma_f32_16x16x32_bf16 v[140:143], a[212:215], a[52:55], v[140:143]
    ds_read_b64_tr_b16 a[206:207], v11 offset:19456
    v_lshlrev_b32 v42, 16, v44
    v_mfma_f32_16x16x32_bf16 v[132:135], a[212:215], a[48:51], v[132:135]
    buffer_load_dwordx4 a[248:251], v28, s[20:23], s46 offen offset:2048 sc1
    v_mfma_f32_16x16x32_bf16 v[132:135], a[208:211], a[32:35], v[132:135]
    s_waitcnt lgkmcnt(4)
    v_and_b32 v43, 0xffff0000, v44
    v_mul_f32 v42, v42, v41
    v_mfma_f32_16x16x32_bf16 v[160:163], a[192:195], a[32:35], v[160:163]
    ds_read_b64_tr_b16 a[208:209], v8 offset:2048
    v_mul_f32 v43, v43, v41
    v_mfma_f32_16x16x32_bf16 v[160:163], a[196:199], a[48:51], v[160:163]
    ds_read_b64_tr_b16 a[210:211], v8 offset:8192
    v_cvt_pk_bf16_f32 v52, v42, v43
    v_mfma_f32_16x16x32_bf16 v[168:171], a[196:199], a[52:55], v[168:171]
    v_lshlrev_b32 v42, 16, v53
    v_and_b32 v43, 0xffff0000, v53
    v_mfma_f32_16x16x32_bf16 v[168:171], a[192:195], a[36:39], v[168:171]
    buffer_load_dwordx4 a[252:255], v28, s[20:23], s46 offen offset:3072 sc1
    v_mfma_f32_16x16x32_bf16 v[176:179], a[192:195], a[40:43], v[176:179]
    ds_read_b64_tr_b16 a[212:213], v8 offset:14336
    v_sub_f32 v42, v42, v40
    v_mfma_f32_16x16x32_bf16 v[176:179], a[196:199], a[56:59], v[176:179]
    ds_read_b64_tr_b16 a[214:215], v8 offset:20480
    v_sub_f32 v43, v43, v40
    v_mfma_f32_16x16x32_bf16 v[184:187], a[196:199], a[60:63], v[184:187]
    v_cvt_pk_bf16_f32 v44, v42, v43
    v_lshlrev_b32 v42, 16, v44
    v_mfma_f32_16x16x32_bf16 v[184:187], a[192:195], a[44:47], v[184:187]
    s_waitcnt lgkmcnt(4)
    v_and_b32 v43, 0xffff0000, v44
    v_mul_f32 v42, v42, v41
    v_mfma_f32_16x16x32_bf16 v[188:191], a[200:203], a[44:47], v[188:191]
    ds_read_b64_tr_b16 a[192:193], v9 offset:2048
    v_mul_f32 v43, v43, v41
    v_mfma_f32_16x16x32_bf16 v[188:191], a[204:207], a[60:63], v[188:191]
    s_add_u32 m0, s49, 0
    ds_read_b64_tr_b16 a[194:195], v9 offset:8192
    v_cvt_pk_bf16_f32 v53, v42, v43
    v_mfma_f32_16x16x32_bf16 v[180:183], a[204:207], a[56:59], v[180:183]
    buffer_load_dwordx4 v4, s[12:15], s38 offen offset:0 lds
    v_mfma_f32_16x16x32_bf16 v[180:183], a[200:203], a[40:43], v[180:183]
    v_lshlrev_b32 v42, 16, v54
    v_and_b32 v43, 0xffff0000, v54
    v_mfma_f32_16x16x32_bf16 v[172:175], a[200:203], a[36:39], v[172:175]
    ds_read_b64_tr_b16 a[196:197], v9 offset:14336
    v_sub_f32 v42, v42, v40
    v_mfma_f32_16x16x32_bf16 v[172:175], a[204:207], a[52:55], v[172:175]
    ds_read_b64_tr_b16 a[198:199], v9 offset:20480
    v_sub_f32 v43, v43, v40
    v_mfma_f32_16x16x32_bf16 v[164:167], a[204:207], a[48:51], v[164:167]
    v_cvt_pk_bf16_f32 v44, v42, v43
    v_lshlrev_b32 v42, 16, v44
    v_mfma_f32_16x16x32_bf16 v[164:167], a[200:203], a[32:35], v[164:167]
    s_waitcnt lgkmcnt(4)
    v_and_b32 v43, 0xffff0000, v44
    v_mul_f32 v42, v42, v41
    v_mfma_f32_16x16x32_bf16 v[192:195], a[208:211], a[32:35], v[192:195]
    s_add_u32 m0, s49, 896
    ds_read_b64_tr_b16 a[200:201], v10 offset:2048
    v_mul_f32 v43, v43, v41
    v_mfma_f32_16x16x32_bf16 v[192:195], a[212:215], a[48:51], v[192:195]
    ds_read_b64_tr_b16 a[202:203], v10 offset:8192
    v_cvt_pk_bf16_f32 v54, v42, v43
    v_mfma_f32_16x16x32_bf16 v[200:203], a[212:215], a[52:55], v[200:203]
    buffer_load_dwordx4 v4, s[12:15], s38 offen offset:128 lds
    v_mfma_f32_16x16x32_bf16 v[200:203], a[208:211], a[36:39], v[200:203]
    v_lshlrev_b32 v42, 16, v55
    v_and_b32 v43, 0xffff0000, v55
    v_mfma_f32_16x16x32_bf16 v[208:211], a[208:211], a[40:43], v[208:211]
    ds_read_b64_tr_b16 a[204:205], v10 offset:14336
    v_sub_f32 v42, v42, v40
    v_mfma_f32_16x16x32_bf16 v[208:211], a[212:215], a[56:59], v[208:211]
    ds_read_b64_tr_b16 a[206:207], v10 offset:20480
    v_sub_f32 v43, v43, v40
    v_mfma_f32_16x16x32_bf16 v[216:219], a[212:215], a[60:63], v[216:219]
    s_add_u32 m0, s49, 1792
    v_cvt_pk_bf16_f32 v44, v42, v43
    v_lshlrev_b32 v42, 16, v44
    v_mfma_f32_16x16x32_bf16 v[216:219], a[208:211], a[44:47], v[216:219]
    s_waitcnt lgkmcnt(4)
    v_and_b32 v43, 0xffff0000, v44
    v_mul_f32 v42, v42, v41
    v_mfma_f32_16x16x32_bf16 v[220:223], a[192:195], a[44:47], v[220:223]
    ds_read_b64_tr_b16 a[208:209], v11 offset:2048
    v_mul_f32 v43, v43, v41
    v_mfma_f32_16x16x32_bf16 v[220:223], a[196:199], a[60:63], v[220:223]
    ds_read_b64_tr_b16 a[210:211], v11 offset:8192
    v_cvt_pk_bf16_f32 v55, v42, v43
    v_mfma_f32_16x16x32_bf16 v[212:215], a[196:199], a[56:59], v[212:215]
    buffer_load_dwordx4 v4, s[12:15], s38 offen offset:256 lds
    v_mfma_f32_16x16x32_bf16 v[212:215], a[192:195], a[40:43], v[212:215]
    v_lshrrev_b32 v60, 14, v61
    v_and_b32 v61, 0x2000, v61
    v_mfma_f32_16x16x32_bf16 v[204:207], a[192:195], a[36:39], v[204:207]
    s_add_u32 m0, s49, 3072
    ds_read_b64_tr_b16 a[212:213], v11 offset:14336
    v_cmp_ne_u32 s[88:89], 0, v60
    v_mfma_f32_16x16x32_bf16 v[204:207], a[196:199], a[52:55], v[204:207]
    s_waitcnt vmcnt(25)
    ds_read_b64_tr_b16 a[214:215], v11 offset:20480
    v_accvgpr_write_b32 a5, 0
    v_mfma_f32_16x16x32_bf16 v[196:199], a[196:199], a[48:51], v[196:199]
    s_barrier
    v_mfma_f32_16x16x32_bf16 v[196:199], a[192:195], a[32:35], v[196:199]
    s_waitcnt lgkmcnt(4)
    buffer_load_dwordx4 v5, s[12:15], s38 offen offset:0 lds
    v_add_u32 v8, 98304, v12
    v_mfma_f32_16x16x32_bf16 v[224:227], a[200:203], a[32:35], v[224:227]
    s_lshr_b64 s[88:89], s[88:89], 12
    ds_read_b64_tr_b16 a[192:193], v8 offset:0
    v_accvgpr_write_b32 a6, 0
    v_mfma_f32_16x16x32_bf16 v[224:227], a[204:207], a[48:51], v[224:227]
    s_bcnt1_i32_b64 s93, s[88:89]
    ds_read_b64_tr_b16 a[194:195], v8 offset:6144
    v_cmp_ne_u32 s[88:89], 0, v61
    v_mfma_f32_16x16x32_bf16 v[232:235], a[204:207], a[52:55], v[232:235]
    s_cmp_gt_u32 s93, 26
    s_cselect_b32 s93, -1, 0
    v_accvgpr_write_b32 a7, 0
    v_mfma_f32_16x16x32_bf16 v[232:235], a[200:203], a[36:39], v[232:235]
    s_add_u32 m0, s49, 3968
    v_accvgpr_write_b32 a8, 0
    v_accvgpr_write_b32 a9, 0
    v_mfma_f32_16x16x32_bf16 v[240:243], a[200:203], a[40:43], v[240:243]
    s_xor_b32 s88, s88, s93
    ds_read_b64_tr_b16 a[196:197], v8 offset:12288
    v_accvgpr_write_b32 a10, 0
    v_mfma_f32_16x16x32_bf16 v[240:243], a[204:207], a[56:59], v[240:243]
    s_and_b32 s88, s88, 0xfff
    ds_read_b64_tr_b16 a[198:199], v8 offset:18432
    v_accvgpr_write_b32 a11, 0
    v_mfma_f32_16x16x32_bf16 v[248:251], a[204:207], a[60:63], v[248:251]
    buffer_load_dwordx4 v5, s[12:15], s38 offen offset:128 lds
    v_mfma_f32_16x16x32_bf16 v[248:251], a[200:203], a[44:47], v[248:251]
    s_waitcnt lgkmcnt(4)
    v_accvgpr_write_b32 a12, 0
    v_accvgpr_write_b32 a13, 0
    v_add_u32 v9, 98304, v13
    v_mfma_f32_16x16x32_bf16 v[252:255], a[208:211], a[44:47], v[252:255]
    s_lshl_b32 s93, s88, 13
    ds_read_b64_tr_b16 a[200:201], v9 offset:0
    v_accvgpr_write_b32 a14, 0
    s_add_u32 s88, s51, 8
    s_lshr_b32 s88, s93, s88
    s_and_b32 s88, s88, 0x2000
    s_xor_b32 s88, s88, s5
    s_and_b32 s88, s88, 0x2000
    s_lshl_b32 s88, s88, 8
    s_add_u32 s5, s5, s88
    v_mfma_f32_16x16x32_bf16 v[252:255], a[212:215], a[60:63], v[252:255]
    s_add_u32 m0, s49, 4864
    ds_read_b64_tr_b16 a[202:203], v9 offset:6144
    v_accvgpr_write_b32 a15, 0
    v_mfma_f32_16x16x32_bf16 v[244:247], a[212:215], a[56:59], v[244:247]
    buffer_load_dwordx4 v5, s[12:15], s38 offen offset:256 lds
    v_mfma_f32_16x16x32_bf16 v[244:247], a[208:211], a[40:43], v[244:247]
    s_add_u32 s38, s38, 24576
    v_accvgpr_write_b32 a16, 0
    v_accvgpr_write_b32 a17, 0
    v_mfma_f32_16x16x32_bf16 v[236:239], a[208:211], a[36:39], v[236:239]
pg_4:
    s_cbranch_execz pg_8
    ds_read_b64_tr_b16 a[204:205], v9 offset:12288
    v_accvgpr_write_b32 a18, 0
    v_mfma_f32_16x16x32_bf16 v[236:239], a[212:215], a[52:55], v[236:239]
    s_waitcnt vmcnt(24)
    s_waitcnt vmcnt(14)
    ds_read_b64_tr_b16 a[206:207], v9 offset:18432
    v_mfma_f32_16x16x32_bf16 v[228:231], a[212:215], a[48:51], v[228:231]
    v_accvgpr_write_b32 a19, 0
    v_accvgpr_write_b32 a20, 0
    v_mfma_f32_16x16x32_bf16 v[228:231], a[208:211], a[32:35], v[228:231]
    s_waitcnt lgkmcnt(4)
    v_accvgpr_write_b32 a21, 0
    v_accvgpr_write_b32 a22, 0
    v_add_u32 v10, 98304, v14
    v_mfma_f32_16x16x32_bf16 v[64:67], a[192:195], a[64:67], v[64:67]
    s_add_u32 m0, s49, 24576
    ds_read_b64_tr_b16 a[208:209], v10 offset:0
    v_accvgpr_write_b32 a23, 0
    v_mfma_f32_16x16x32_bf16 v[64:67], a[196:199], a[80:83], v[64:67]
    ds_read_b64_tr_b16 a[210:211], v10 offset:6144
    v_accvgpr_write_b32 a24, 0
    v_mfma_f32_16x16x32_bf16 v[72:75], a[196:199], a[84:87], v[72:75]
    ds_read_b64_tr_b16 v[32:33], v25 offset:0
    v_accvgpr_write_b32 a25, 0
    v_mfma_f32_16x16x32_bf16 v[72:75], a[192:195], a[68:71], v[72:75]
    ds_read_b64_tr_b16 v[34:35], v25 offset:4096
    v_accvgpr_write_b32 a26, 0
    v_mfma_f32_16x16x32_bf16 v[80:83], a[192:195], a[72:75], v[80:83]
    ds_read_b64_tr_b16 a[212:213], v10 offset:12288
    v_accvgpr_write_b32 a27, 0
    v_mfma_f32_16x16x32_bf16 v[80:83], a[196:199], a[88:91], v[80:83]
    ds_read_b64_tr_b16 a[214:215], v10 offset:18432
    v_accvgpr_write_b32 a28, 0
    v_mfma_f32_16x16x32_bf16 v[88:91], a[196:199], a[92:95], v[88:91]
    ds_read_b64_tr_b16 v[36:37], v25 offset:1024
    v_accvgpr_write_b32 a29, 0
    v_mfma_f32_16x16x32_bf16 v[88:91], a[192:195], a[76:79], v[88:91]
    s_waitcnt lgkmcnt(4)
    buffer_load_dwordx4 v4, s[12:15], s38 offen offset:0 lds
    v_add_u32 v11, 98304, v15
    v_mfma_f32_16x16x32_bf16 v[92:95], a[200:203], a[76:79], v[92:95]
    s_add_u32 m0, s49, 25472
    ds_read_b64_tr_b16 a[192:193], v11 offset:0
    v_accvgpr_write_b32 a30, 0
    v_mfma_f32_16x16x32_bf16 v[92:95], a[204:207], a[92:95], v[92:95]
    ds_read_b64_tr_b16 a[194:195], v11 offset:6144
    v_accvgpr_write_b32 a31, 0
    v_mfma_f32_16x16x32_bf16 v[84:87], a[204:207], a[88:91], v[84:87]
    ds_read_b64_tr_b16 v[38:39], v25 offset:5120
    v_accvgpr_write_b32 a32, 0
    v_mfma_f32_16x16x32_bf16 v[84:87], a[200:203], a[72:75], v[84:87]
    ds_read_b64_tr_b16 v[40:41], v25 offset:8192
    v_accvgpr_write_b32 a33, 0
    v_mfma_f32_16x16x32_bf16 v[76:79], a[200:203], a[68:71], v[76:79]
    ds_read_b64_tr_b16 a[196:197], v11 offset:12288
    v_accvgpr_write_b32 a34, 0
    v_mfma_f32_16x16x32_bf16 v[76:79], a[204:207], a[84:87], v[76:79]
    ds_read_b64_tr_b16 a[198:199], v11 offset:18432
    v_accvgpr_write_b32 a35, 0
    v_mfma_f32_16x16x32_bf16 v[68:71], a[204:207], a[80:83], v[68:71]
    ds_read_b64_tr_b16 v[42:43], v25 offset:12288
    v_accvgpr_write_b32 a36, 0
    v_mfma_f32_16x16x32_bf16 v[68:71], a[200:203], a[64:67], v[68:71]
    s_waitcnt lgkmcnt(4)
    buffer_load_dwordx4 v4, s[12:15], s38 offen offset:128 lds
    v_mfma_f32_16x16x32_bf16 v[96:99], a[208:211], a[64:67], v[96:99]
    s_add_u32 m0, s49, 26368
    ds_read_b64_tr_b16 a[200:201], v8 offset:1024
    v_accvgpr_write_b32 a37, 0
    v_mfma_f32_16x16x32_bf16 v[96:99], a[212:215], a[80:83], v[96:99]
    ds_read_b64_tr_b16 a[202:203], v8 offset:7168
    v_accvgpr_write_b32 a38, 0
    v_mfma_f32_16x16x32_bf16 v[104:107], a[212:215], a[84:87], v[104:107]
    ds_read_b64_tr_b16 v[44:45], v25 offset:9216
    v_accvgpr_write_b32 a39, 0
    v_mfma_f32_16x16x32_bf16 v[104:107], a[208:211], a[68:71], v[104:107]
    ds_read_b64_tr_b16 v[46:47], v25 offset:13312
    v_accvgpr_write_b32 a40, 0
    v_mfma_f32_16x16x32_bf16 v[112:115], a[208:211], a[72:75], v[112:115]
    ds_read_b64_tr_b16 a[204:205], v8 offset:13312
    v_accvgpr_write_b32 a41, 0
    v_mfma_f32_16x16x32_bf16 v[112:115], a[212:215], a[88:91], v[112:115]
    ds_read_b64_tr_b16 a[206:207], v8 offset:19456
    v_accvgpr_write_b32 a42, 0
    v_mfma_f32_16x16x32_bf16 v[120:123], a[212:215], a[92:95], v[120:123]
    buffer_load_dwordx4 v4, s[12:15], s38 offen offset:256 lds
    v_mfma_f32_16x16x32_bf16 v[120:123], a[208:211], a[76:79], v[120:123]
    s_waitcnt lgkmcnt(4)
    v_accvgpr_write_b32 a43, 0
    v_accvgpr_write_b32 a44, 0
    v_mfma_f32_16x16x32_bf16 v[124:127], a[192:195], a[76:79], v[124:127]
    s_add_u32 m0, s49, 27648
    ds_read_b64_tr_b16 a[208:209], v9 offset:1024
    v_accvgpr_write_b32 a45, 0
    v_mfma_f32_16x16x32_bf16 v[124:127], a[196:199], a[92:95], v[124:127]
    s_mul_hi_u32 s47, s58, 429496730
    ds_read_b64_tr_b16 a[210:211], v9 offset:7168
    v_accvgpr_write_b32 a46, 0
    v_mfma_f32_16x16x32_bf16 v[116:119], a[196:199], a[88:91], v[116:119]
    buffer_load_dwordx4 v5, s[12:15], s38 offen offset:0 lds
    v_mfma_f32_16x16x32_bf16 v[116:119], a[192:195], a[72:75], v[116:119]
    s_add_u32 m0, s49, 28544
    v_accvgpr_write_b32 a47, 0
    v_accvgpr_write_b32 a48, 0
    v_mfma_f32_16x16x32_bf16 v[108:111], a[192:195], a[68:71], v[108:111]
    s_lshl_b32 s37, s47, 8
    ds_read_b64_tr_b16 a[212:213], v9 offset:13312
    v_accvgpr_write_b32 a49, 0
    v_mfma_f32_16x16x32_bf16 v[108:111], a[196:199], a[84:87], v[108:111]
    s_add_u32 s37, s37, 268370064
    ds_read_b64_tr_b16 a[214:215], v9 offset:19456
    v_accvgpr_write_b32 a50, 0
    v_mfma_f32_16x16x32_bf16 v[100:103], a[196:199], a[80:83], v[100:103]
    buffer_load_dwordx4 v5, s[12:15], s38 offen offset:128 lds
    v_mfma_f32_16x16x32_bf16 v[100:103], a[192:195], a[64:67], v[100:103]
    s_waitcnt lgkmcnt(4)
    v_accvgpr_write_b32 a51, 0
    v_accvgpr_write_b32 a52, 0
    v_mfma_f32_16x16x32_bf16 v[128:131], a[200:203], a[64:67], v[128:131]
    s_add_u32 m0, s49, 29440
    ds_read_b64_tr_b16 a[192:193], v10 offset:1024
    v_accvgpr_write_b32 a53, 0
    v_mfma_f32_16x16x32_bf16 v[128:131], a[204:207], a[80:83], v[128:131]
    s_mov_b32 s32, s82
    ds_read_b64_tr_b16 a[194:195], v10 offset:7168
    v_accvgpr_write_b32 a54, 0
    v_mfma_f32_16x16x32_bf16 v[136:139], a[204:207], a[84:87], v[136:139]
    v_mfma_f32_16x16x32_bf16 v[20:23], v[48:51], v[32:35], 0
    v_mfma_f32_16x16x32_bf16 v[58:61], v[48:51], v[36:39], 0
    v_mfma_f32_16x16x32_bf16 v[20:23], v[52:55], v[40:43], v[20:23]
    v_mfma_f32_16x16x32_bf16 v[58:61], v[52:55], v[44:47], v[58:61]
    v_mfma_f32_16x16x32_bf16 v[136:139], a[200:203], a[68:71], v[136:139]
    buffer_load_dwordx4 v5, s[12:15], s38 offen offset:256 lds
    v_mfma_f32_16x16x32_bf16 v[144:147], a[200:203], a[72:75], v[144:147]
    s_add_u32 s38, s38, 24576
    ds_read_b64_tr_b16 a[196:197], v10 offset:13312
    v_accvgpr_write_b32 a55, 0
    v_mfma_f32_16x16x32_bf16 v[144:147], a[204:207], a[88:91], v[144:147]
    s_and_b32 s33, s83, 0xffff
    ds_read_b64_tr_b16 a[198:199], v10 offset:19456
    v_accvgpr_write_b32 a56, 0
    v_mfma_f32_16x16x32_bf16 v[152:155], a[204:207], a[92:95], v[152:155]
    s_mov_b32 s34, 1966080
    v_accvgpr_write_b32 a57, 0
    v_accvgpr_write_b32 a58, 0
    v_mfma_f32_16x16x32_bf16 v[152:155], a[200:203], a[76:79], v[152:155]
    s_waitcnt lgkmcnt(4)
    v_accvgpr_write_b32 a59, 0
    v_accvgpr_write_b32 a60, 0
    v_mfma_f32_16x16x32_bf16 v[156:159], a[208:211], a[76:79], v[156:159]
    s_add_u32 m0, s49, 73728
    ds_read_b64_tr_b16 a[200:201], v11 offset:1024
    v_accvgpr_write_b32 a61, 0
    v_mfma_f32_16x16x32_bf16 v[156:159], a[212:215], a[92:95], v[156:159]
    s_mov_b32 s35, 0x00020000
    ds_read_b64_tr_b16 a[202:203], v11 offset:7168
    v_accvgpr_write_b32 a62, 0
    v_mfma_f32_16x16x32_bf16 v[148:151], a[212:215], a[88:91], v[148:151]
    buffer_load_dwordx4 v6, s[16:19], s40 offen offset:0 lds
    v_mfma_f32_16x16x32_bf16 v[148:151], a[208:211], a[72:75], v[148:151]
    s_mul_i32 s60, s47, 80640
    v_accvgpr_write_b32 a63, 0
    v_mov_b32 v22, v58
    v_mfma_f32_16x16x32_bf16 v[140:143], a[208:211], a[68:71], v[140:143]
    s_lshl_b32 s56, s58, 7
    ds_read_b64_tr_b16 a[204:205], v11 offset:13312
    v_mov_b32 v23, v59
    v_mfma_f32_16x16x32_bf16 v[140:143], a[212:215], a[84:87], v[140:143]
    s_add_u32 m0, s49, 74624
    ds_read_b64_tr_b16 a[206:207], v11 offset:19456
    s_add_u32 s60, s60, s56
    v_mfma_f32_16x16x32_bf16 v[132:135], a[212:215], a[80:83], v[132:135]
    buffer_store_dwordx4 v[20:23], v26, s[24:27], s62 offen sc1
    v_mfma_f32_16x16x32_bf16 v[132:135], a[208:211], a[64:67], v[132:135]
    s_waitcnt lgkmcnt(4)
    s_mul_i32 s56, s53, 983040
    s_add_u32 s28, s72, s56
    s_addc_u32 s29, s73, 0
    v_mfma_f32_16x16x32_bf16 v[160:163], a[192:195], a[64:67], v[160:163]
    s_and_b32 s29, s29, 0xffff
    ds_read_b64_tr_b16 a[208:209], v8 offset:2048
    s_mov_b32 s30, 983040
    v_mfma_f32_16x16x32_bf16 v[160:163], a[196:199], a[80:83], v[160:163]
    s_mov_b32 s31, 0x00020000
    ds_read_b64_tr_b16 a[210:211], v8 offset:8192
    s_lshr_b32 s48, s2, 3
    v_mfma_f32_16x16x32_bf16 v[168:171], a[196:199], a[84:87], v[168:171]
    buffer_load_dwordx4 v6, s[16:19], s40 offen offset:128 lds
    v_mfma_f32_16x16x32_bf16 v[168:171], a[192:195], a[68:71], v[168:171]
    s_lshl_b32 s48, s48, 2
    s_add_u32 s48, s48, s3
    s_mul_i32 s6, s48, 7680
    v_mfma_f32_16x16x32_bf16 v[176:179], a[192:195], a[72:75], v[176:179]
    s_add_u32 m0, s49, 75520
    ds_read_b64_tr_b16 a[212:213], v8 offset:14336
    v_lshlrev_b32 v16, 7, v16
    v_mfma_f32_16x16x32_bf16 v[176:179], a[196:199], a[88:91], v[176:179]
    s_mul_i32 s57, s51, 320
    ds_read_b64_tr_b16 a[214:215], v8 offset:20480
    s_and_b32 s57, s57, 0xffffff80
    v_mfma_f32_16x16x32_bf16 v[184:187], a[196:199], a[92:95], v[184:187]
    buffer_load_dwordx4 v6, s[16:19], s40 offen offset:256 lds
    v_mfma_f32_16x16x32_bf16 v[184:187], a[192:195], a[76:79], v[184:187]
    s_waitcnt lgkmcnt(4)
    v_add_u32 v8, 122880, v12
    s_add_u32 s56, s56, s57
    v_mfma_f32_16x16x32_bf16 v[188:191], a[200:203], a[76:79], v[188:191]
    s_sub_u32 s57, 7864320, s56
    ds_read_b64_tr_b16 a[192:193], v9 offset:2048
    s_add_u32 s8, s72, s56
    s_addc_u32 s9, s73, 0
    v_mfma_f32_16x16x32_bf16 v[188:191], a[204:207], a[92:95], v[188:191]
    s_and_b32 s9, s9, 0xffff
    ds_read_b64_tr_b16 a[194:195], v9 offset:8192
    s_mov_b32 s10, s57
    v_mfma_f32_16x16x32_bf16 v[180:183], a[204:207], a[88:91], v[180:183]
    s_add_u32 m0, s49, 76800
    s_mov_b32 s11, 0x00020000
    s_mul_i32 s36, s51, 245760
    v_mfma_f32_16x16x32_bf16 v[180:183], a[200:203], a[72:75], v[180:183]
    buffer_load_dwordx4 v7, s[16:19], s40 offen offset:0 lds
    v_mfma_f32_16x16x32_bf16 v[172:175], a[200:203], a[68:71], v[172:175]
    s_mul_i32 s56, s3, 20480
    ds_read_b64_tr_b16 a[196:197], v9 offset:14336
    s_add_u32 s36, s36, s56
    v_mfma_f32_16x16x32_bf16 v[172:175], a[204:207], a[84:87], v[172:175]
    s_lshl_b32 s59, s53, 23
    ds_read_b64_tr_b16 a[198:199], v9 offset:20480
    s_add_u32 s59, s59, 16777216
    v_mfma_f32_16x16x32_bf16 v[164:167], a[204:207], a[80:83], v[164:167]
    s_add_u32 s20, s86, s59
    s_addc_u32 s21, s87, 0
    v_add_u32 v9, 122880, v13
    v_mfma_f32_16x16x32_bf16 v[164:167], a[200:203], a[64:67], v[164:167]
    s_waitcnt lgkmcnt(4)
    s_and_b32 s21, s21, 0xffff
    s_mov_b32 s22, 8388608
    v_mfma_f32_16x16x32_bf16 v[192:195], a[208:211], a[64:67], v[192:195]
    s_mov_b32 s23, 0x00020000
    ds_read_b64_tr_b16 a[200:201], v10 offset:2048
    s_add_u32 s55, s51, 8
    v_mfma_f32_16x16x32_bf16 v[192:195], a[212:215], a[80:83], v[192:195]
    s_add_u32 m0, s49, 77696
    ds_read_b64_tr_b16 a[202:203], v10 offset:8192
    s_lshr_b32 s55, s93, s55
    v_mfma_f32_16x16x32_bf16 v[200:203], a[212:215], a[84:87], v[200:203]
    buffer_load_dwordx4 v7, s[16:19], s40 offen offset:128 lds
    v_mfma_f32_16x16x32_bf16 v[200:203], a[208:211], a[68:71], v[200:203]
    s_and_b32 s55, s55, 0x2000
    s_lshl_b32 s59, s54, 16
    s_or_b32 s55, s55, s59
    v_mfma_f32_16x16x32_bf16 v[208:211], a[208:211], a[72:75], v[208:211]
    s_and_b32 s59, s3, 1
    ds_read_b64_tr_b16 a[204:205], v10 offset:14336
    s_lshl_b32 s59, s59, 14
    v_mfma_f32_16x16x32_bf16 v[208:211], a[212:215], a[88:91], v[208:211]
    s_or_b32 s55, s55, s59
    ds_read_b64_tr_b16 a[206:207], v10 offset:20480
    s_mul_i32 s59, s51, 0x202000
    v_mfma_f32_16x16x32_bf16 v[216:219], a[212:215], a[92:95], v[216:219]
    s_and_b32 s59, s59, 6299648
    v_add_u32 v10, 122880, v14
    s_xor_b32 s55, s55, s59
    v_mfma_f32_16x16x32_bf16 v[216:219], a[208:211], a[76:79], v[216:219]
    s_waitcnt lgkmcnt(4)
    v_lshlrev_b32 v2, 7, v1
    v_and_b32 v3, 3, v1
    v_mfma_f32_16x16x32_bf16 v[220:223], a[192:195], a[76:79], v[220:223]
    s_add_u32 m0, s49, 78592
    ds_read_b64_tr_b16 a[208:209], v11 offset:2048
    v_lshlrev_b32 v3, 11, v3
    v_mfma_f32_16x16x32_bf16 v[220:223], a[196:199], a[92:95], v[220:223]
    ds_read_b64_tr_b16 a[210:211], v11 offset:8192
    v_lshlrev_b32 v28, 4, v1
    v_mfma_f32_16x16x32_bf16 v[212:215], a[196:199], a[88:91], v[212:215]
    buffer_load_dwordx4 v7, s[16:19], s40 offen offset:256 lds
    v_mfma_f32_16x16x32_bf16 v[212:215], a[192:195], a[72:75], v[212:215]
    s_add_u32 s40, s40, 24576
    v_mov_b32 v31, v16
    s_mov_b32 s41, s49
    v_mfma_f32_16x16x32_bf16 v[204:207], a[192:195], a[68:71], v[204:207]
    s_add_u32 s42, s49, 24576
    ds_read_b64_tr_b16 a[212:213], v11 offset:14336
    s_add_u32 s43, s49, 49152
    v_mfma_f32_16x16x32_bf16 v[204:207], a[196:199], a[84:87], v[204:207]
    s_waitcnt vmcnt(31)
    ds_read_b64_tr_b16 a[214:215], v11 offset:20480
    s_mov_b32 s45, 6
    v_mfma_f32_16x16x32_bf16 v[196:199], a[196:199], a[80:83], v[196:199]
    s_barrier
    v_mfma_f32_16x16x32_bf16 v[196:199], a[192:195], a[64:67], v[196:199]
    s_waitcnt lgkmcnt(4)
    v_add_u32 v11, 122880, v15
    s_sub_u32 s56, 73728, s49
    v_mfma_f32_16x16x32_bf16 v[224:227], a[200:203], a[64:67], v[224:227]
    ds_read_b64_tr_b16 a[192:193], v8 offset:0
    v_add_u32 v16, s49, v18
    v_mfma_f32_16x16x32_bf16 v[224:227], a[204:207], a[80:83], v[224:227]
    ds_read_b64_tr_b16 a[194:195], v8 offset:6144
    v_add_u32 v17, s49, v19
    v_mfma_f32_16x16x32_bf16 v[232:235], a[204:207], a[84:87], v[232:235]
    v_mfma_f32_16x16x32_bf16 v[232:235], a[200:203], a[68:71], v[232:235]
    v_mfma_f32_16x16x32_bf16 v[240:243], a[200:203], a[72:75], v[240:243]
    ds_read_b64_tr_b16 a[196:197], v8 offset:12288
    v_mfma_f32_16x16x32_bf16 v[240:243], a[204:207], a[88:91], v[240:243]
    ds_read_b64_tr_b16 a[198:199], v8 offset:18432
    v_mfma_f32_16x16x32_bf16 v[248:251], a[204:207], a[92:95], v[248:251]
    v_mfma_f32_16x16x32_bf16 v[248:251], a[200:203], a[76:79], v[248:251]
    s_waitcnt lgkmcnt(4)
    v_mfma_f32_16x16x32_bf16 v[252:255], a[208:211], a[76:79], v[252:255]
    ds_read_b64_tr_b16 a[200:201], v9 offset:0
    v_mfma_f32_16x16x32_bf16 v[252:255], a[212:215], a[92:95], v[252:255]
    ds_read_b64_tr_b16 a[202:203], v9 offset:6144
    v_mfma_f32_16x16x32_bf16 v[244:247], a[212:215], a[88:91], v[244:247]
    v_mfma_f32_16x16x32_bf16 v[244:247], a[208:211], a[72:75], v[244:247]
    v_mfma_f32_16x16x32_bf16 v[236:239], a[208:211], a[68:71], v[236:239]
    ds_read_b64_tr_b16 a[204:205], v9 offset:12288
    v_mfma_f32_16x16x32_bf16 v[236:239], a[212:215], a[84:87], v[236:239]
    s_waitcnt vmcnt(23)
    s_waitcnt vmcnt(19)
    ds_read_b64_tr_b16 a[206:207], v9 offset:18432
    v_mfma_f32_16x16x32_bf16 v[228:231], a[212:215], a[80:83], v[228:231]
    v_mfma_f32_16x16x32_bf16 v[228:231], a[208:211], a[64:67], v[228:231]
    s_waitcnt lgkmcnt(4)
    v_mfma_f32_16x16x32_bf16 v[64:67], a[192:195], a[224:227], v[64:67]
    ds_read_b64_tr_b16 a[208:209], v10 offset:0
    v_add_u32 v12, s56, v12
    v_mfma_f32_16x16x32_bf16 v[64:67], a[196:199], a[240:243], v[64:67]
    ds_read_b64_tr_b16 a[210:211], v10 offset:6144
    v_add_u32 v13, s56, v13
    v_mfma_f32_16x16x32_bf16 v[72:75], a[196:199], a[244:247], v[72:75]
    v_add_u32 v14, s56, v14
    v_add_u32 v15, s56, v15
    v_mfma_f32_16x16x32_bf16 v[72:75], a[192:195], a[228:231], v[72:75]
    v_mov_b32 v30, 0x47800000
    v_mov_b32 v20, 0
    v_mfma_f32_16x16x32_bf16 v[80:83], a[192:195], a[232:235], v[80:83]
    ds_read_b64_tr_b16 a[212:213], v10 offset:12288
    v_mov_b32 v21, 0
    v_mfma_f32_16x16x32_bf16 v[80:83], a[196:199], a[248:251], v[80:83]
    ds_read_b64_tr_b16 a[214:215], v10 offset:18432
    v_mov_b32 v22, 0
    v_mfma_f32_16x16x32_bf16 v[88:91], a[196:199], a[252:255], v[88:91]
    v_mov_b32 v23, 0
    v_mfma_f32_16x16x32_bf16 v[88:91], a[192:195], a[236:239], v[88:91]
    s_waitcnt lgkmcnt(4)
    v_accvgpr_write_b32 a64, 0
    v_mfma_f32_16x16x32_bf16 v[92:95], a[200:203], a[236:239], v[92:95]
    ds_read_b64_tr_b16 a[192:193], v11 offset:0
    v_accvgpr_write_b32 a65, 0
    v_mfma_f32_16x16x32_bf16 v[92:95], a[204:207], a[252:255], v[92:95]
    ds_read_b64_tr_b16 a[194:195], v11 offset:6144
    v_accvgpr_write_b32 a66, 0
    v_mfma_f32_16x16x32_bf16 v[84:87], a[204:207], a[248:251], v[84:87]
    s_getpc_b64 s[74:75]
ct3:
    s_add_u32 s74, s74, at_switch-ct3
    s_addc_u32 s75, s75, 0
    global_load_dword a222, v2, s[74:75]
    v_mfma_f32_16x16x32_bf16 v[84:87], a[200:203], a[232:235], v[84:87]
    v_min_u32 v2, 15, v1
    v_mfma_f32_16x16x32_bf16 v[76:79], a[200:203], a[228:231], v[76:79]
    s_lshl_b32 s59, s3, 4
    ds_read_b64_tr_b16 a[196:197], v11 offset:12288
    v_add_u32 v2, s59, v2
    v_mfma_f32_16x16x32_bf16 v[76:79], a[204:207], a[244:247], v[76:79]
    ds_read_b64_tr_b16 a[198:199], v11 offset:18432
    v_mul_u32_u24 v2, 1280, v2
    v_mfma_f32_16x16x32_bf16 v[68:71], a[204:207], a[240:243], v[68:71]
    buffer_load_dword a217, v2, s[32:35], s60 offen
    v_mfma_f32_16x16x32_bf16 v[68:71], a[200:203], a[224:227], v[68:71]
    s_waitcnt lgkmcnt(4)
    v_and_b32 v2, 1, v1
    v_lshlrev_b32 v2, 7, v2
    v_mfma_f32_16x16x32_bf16 v[96:99], a[208:211], a[224:227], v[96:99]
    s_lshl_b32 s59, s48, 8
    ds_read_b64_tr_b16 a[200:201], v8 offset:1024
    v_add_u32 v2, s59, v2
    v_mfma_f32_16x16x32_bf16 v[96:99], a[212:215], a[240:243], v[96:99]
    ds_read_b64_tr_b16 a[202:203], v8 offset:7168
    v_accvgpr_write_b32 a67, 0
    v_mfma_f32_16x16x32_bf16 v[104:107], a[212:215], a[244:247], v[104:107]
    v_accvgpr_write_b32 a68, 0
    v_accvgpr_write_b32 a69, 0
    v_mfma_f32_16x16x32_bf16 v[104:107], a[208:211], a[228:231], v[104:107]
    v_accvgpr_write_b32 a70, 0
    v_accvgpr_write_b32 a71, 0
    v_mfma_f32_16x16x32_bf16 v[112:115], a[208:211], a[232:235], v[112:115]
    ds_read_b64_tr_b16 a[204:205], v8 offset:13312
    v_accvgpr_write_b32 a72, 0
    v_mfma_f32_16x16x32_bf16 v[112:115], a[212:215], a[248:251], v[112:115]
    ds_read_b64_tr_b16 a[206:207], v8 offset:19456
    v_accvgpr_write_b32 a73, 0
    v_mfma_f32_16x16x32_bf16 v[120:123], a[212:215], a[252:255], v[120:123]
    s_getpc_b64 s[74:75]
ct4:
    s_add_u32 s74, s74, tail_code-ct4
    s_addc_u32 s75, s75, 0
    global_load_dword a218, v2, s[74:75]
    v_mfma_f32_16x16x32_bf16 v[120:123], a[208:211], a[236:239], v[120:123]
    s_waitcnt lgkmcnt(4)
    v_accvgpr_write_b32 a74, 0
    v_accvgpr_write_b32 a75, 0
    v_mfma_f32_16x16x32_bf16 v[124:127], a[192:195], a[236:239], v[124:127]
    ds_read_b64_tr_b16 a[208:209], v9 offset:1024
    v_accvgpr_write_b32 a76, 0
    v_mfma_f32_16x16x32_bf16 v[124:127], a[196:199], a[252:255], v[124:127]
    ds_read_b64_tr_b16 a[210:211], v9 offset:7168
    v_accvgpr_write_b32 a77, 0
    v_mfma_f32_16x16x32_bf16 v[116:119], a[196:199], a[248:251], v[116:119]
    v_accvgpr_write_b32 a78, 0
    v_accvgpr_write_b32 a79, 0
    v_mfma_f32_16x16x32_bf16 v[116:119], a[192:195], a[232:235], v[116:119]
    v_accvgpr_write_b32 a80, 0
    v_accvgpr_write_b32 a81, 0
    v_mfma_f32_16x16x32_bf16 v[108:111], a[192:195], a[228:231], v[108:111]
    ds_read_b64_tr_b16 a[212:213], v9 offset:13312
    v_accvgpr_write_b32 a82, 0
    v_mfma_f32_16x16x32_bf16 v[108:111], a[196:199], a[244:247], v[108:111]
    ds_read_b64_tr_b16 a[214:215], v9 offset:19456
    v_accvgpr_write_b32 a83, 0
    v_mfma_f32_16x16x32_bf16 v[100:103], a[196:199], a[240:243], v[100:103]
    v_accvgpr_write_b32 a84, 0
    v_accvgpr_write_b32 a85, 0
    v_mfma_f32_16x16x32_bf16 v[100:103], a[192:195], a[224:227], v[100:103]
    s_waitcnt lgkmcnt(4)
    v_accvgpr_write_b32 a86, 0
    v_accvgpr_write_b32 a87, 0
    v_mfma_f32_16x16x32_bf16 v[128:131], a[200:203], a[224:227], v[128:131]
    ds_read_b64_tr_b16 a[192:193], v10 offset:1024
    v_accvgpr_write_b32 a88, 0
    v_mfma_f32_16x16x32_bf16 v[128:131], a[204:207], a[240:243], v[128:131]
    ds_read_b64_tr_b16 a[194:195], v10 offset:7168
    v_accvgpr_write_b32 a89, 0
    v_mfma_f32_16x16x32_bf16 v[136:139], a[204:207], a[244:247], v[136:139]
    v_accvgpr_write_b32 a90, 0
    v_accvgpr_write_b32 a91, 0
    v_mfma_f32_16x16x32_bf16 v[136:139], a[200:203], a[228:231], v[136:139]
    v_accvgpr_write_b32 a92, 0
    v_accvgpr_write_b32 a93, 0
    v_mfma_f32_16x16x32_bf16 v[144:147], a[200:203], a[232:235], v[144:147]
    ds_read_b64_tr_b16 a[196:197], v10 offset:13312
    v_accvgpr_write_b32 a94, 0
    v_mfma_f32_16x16x32_bf16 v[144:147], a[204:207], a[248:251], v[144:147]
    ds_read_b64_tr_b16 a[198:199], v10 offset:19456
    v_accvgpr_write_b32 a95, 0
    v_mfma_f32_16x16x32_bf16 v[152:155], a[204:207], a[252:255], v[152:155]
    v_and_b32 v31, 3, v1
    v_lshlrev_b32 v31, 7, v31
    v_mfma_f32_16x16x32_bf16 v[152:155], a[200:203], a[236:239], v[152:155]
    s_waitcnt lgkmcnt(4)
    v_cvt_pk_bf16_f32 v64, v64, v65
    v_cvt_pk_bf16_f32 v65, v66, v67
    v_mfma_f32_16x16x32_bf16 v[156:159], a[208:211], a[236:239], v[156:159]
    s_lshl_b32 s59, s48, 9
    ds_read_b64_tr_b16 a[200:201], v11 offset:1024
    v_cvt_pk_bf16_f32 v66, v68, v69
    v_mfma_f32_16x16x32_bf16 v[156:159], a[212:215], a[252:255], v[156:159]
    s_and_b32 s59, s59, 0x7fff
    ds_read_b64_tr_b16 a[202:203], v11 offset:7168
    v_add_u32 v31, s59, v31
    v_mfma_f32_16x16x32_bf16 v[148:151], a[212:215], a[248:251], v[148:151]
    v_permlane16_swap_b32 v64, v66
    v_mfma_f32_16x16x32_bf16 v[148:151], a[208:211], a[232:235], v[148:151]
    v_min_u32 v2, 11, v1
    v_lshlrev_b32 v2, 7, v2
    v_mfma_f32_16x16x32_bf16 v[140:143], a[208:211], a[228:231], v[140:143]
    ds_read_b64_tr_b16 a[204:205], v11 offset:13312
    v_cvt_pk_bf16_f32 v67, v70, v71
    v_mfma_f32_16x16x32_bf16 v[140:143], a[212:215], a[244:247], v[140:143]
    ds_read_b64_tr_b16 a[206:207], v11 offset:19456
    v_cvt_pk_bf16_f32 v72, v72, v73
    v_mfma_f32_16x16x32_bf16 v[132:135], a[212:215], a[240:243], v[132:135]
    v_permlane16_swap_b32 v65, v67
    v_mfma_f32_16x16x32_bf16 v[132:135], a[208:211], a[224:227], v[132:135]
    s_waitcnt lgkmcnt(4)
    v_cvt_pk_bf16_f32 v73, v74, v75
    v_cvt_pk_bf16_f32 v74, v76, v77
    v_mfma_f32_16x16x32_bf16 v[160:163], a[192:195], a[224:227], v[160:163]
    ds_read_b64_tr_b16 a[208:209], v8 offset:2048
    v_cvt_pk_bf16_f32 v75, v78, v79
    v_mfma_f32_16x16x32_bf16 v[160:163], a[196:199], a[240:243], v[160:163]
    ds_read_b64_tr_b16 a[210:211], v8 offset:8192
    v_cvt_pk_bf16_f32 v80, v80, v81
    v_mfma_f32_16x16x32_bf16 v[168:171], a[196:199], a[244:247], v[168:171]
    v_permlane16_swap_b32 v72, v74
    v_mfma_f32_16x16x32_bf16 v[168:171], a[192:195], a[228:231], v[168:171]
    v_permlane16_swap_b32 v73, v75
    v_mfma_f32_16x16x32_bf16 v[176:179], a[192:195], a[232:235], v[176:179]
    ds_read_b64_tr_b16 a[212:213], v8 offset:14336
    v_cvt_pk_bf16_f32 v81, v82, v83
    v_mfma_f32_16x16x32_bf16 v[176:179], a[196:199], a[248:251], v[176:179]
    ds_read_b64_tr_b16 a[214:215], v8 offset:20480
    v_cvt_pk_bf16_f32 v82, v84, v85
    v_mfma_f32_16x16x32_bf16 v[184:187], a[196:199], a[252:255], v[184:187]
    v_cvt_pk_bf16_f32 v83, v86, v87
    v_cvt_pk_bf16_f32 v88, v88, v89
    v_mfma_f32_16x16x32_bf16 v[184:187], a[192:195], a[236:239], v[184:187]
    s_waitcnt lgkmcnt(4)
    v_permlane16_swap_b32 v80, v82
    v_mfma_f32_16x16x32_bf16 v[188:191], a[200:203], a[236:239], v[188:191]
    ds_read_b64_tr_b16 a[192:193], v9 offset:2048
    v_cvt_pk_bf16_f32 v89, v90, v91
    v_mfma_f32_16x16x32_bf16 v[188:191], a[204:207], a[252:255], v[188:191]
    ds_read_b64_tr_b16 a[194:195], v9 offset:8192
    v_cvt_pk_bf16_f32 v90, v92, v93
    v_mfma_f32_16x16x32_bf16 v[180:183], a[204:207], a[248:251], v[180:183]
    v_permlane16_swap_b32 v81, v83
    v_mfma_f32_16x16x32_bf16 v[180:183], a[200:203], a[232:235], v[180:183]
    v_permlane16_swap_b32 v88, v90
    v_mfma_f32_16x16x32_bf16 v[172:175], a[200:203], a[228:231], v[172:175]
    ds_read_b64_tr_b16 a[196:197], v9 offset:14336
    v_cvt_pk_bf16_f32 v91, v94, v95
    v_mfma_f32_16x16x32_bf16 v[172:175], a[204:207], a[244:247], v[172:175]
    ds_read_b64_tr_b16 a[198:199], v9 offset:20480
    v_cvt_pk_bf16_f32 v96, v96, v97
    v_mfma_f32_16x16x32_bf16 v[164:167], a[204:207], a[240:243], v[164:167]
    v_permlane16_swap_b32 v89, v91
    v_mfma_f32_16x16x32_bf16 v[164:167], a[200:203], a[224:227], v[164:167]
    s_waitcnt lgkmcnt(4)
    v_cvt_pk_bf16_f32 v97, v98, v99
    v_cvt_pk_bf16_f32 v98, v100, v101
    v_mfma_f32_16x16x32_bf16 v[192:195], a[208:211], a[224:227], v[192:195]
    ds_read_b64_tr_b16 a[200:201], v10 offset:2048
    v_cvt_pk_bf16_f32 v99, v102, v103
    v_mfma_f32_16x16x32_bf16 v[192:195], a[212:215], a[240:243], v[192:195]
    ds_read_b64_tr_b16 a[202:203], v10 offset:8192
    v_cvt_pk_bf16_f32 v104, v104, v105
    v_mfma_f32_16x16x32_bf16 v[200:203], a[212:215], a[244:247], v[200:203]
    v_permlane16_swap_b32 v96, v98
    v_mfma_f32_16x16x32_bf16 v[200:203], a[208:211], a[228:231], v[200:203]
    v_permlane16_swap_b32 v97, v99
    v_mfma_f32_16x16x32_bf16 v[208:211], a[208:211], a[232:235], v[208:211]
    ds_read_b64_tr_b16 a[204:205], v10 offset:14336
    v_cvt_pk_bf16_f32 v105, v106, v107
    v_mfma_f32_16x16x32_bf16 v[208:211], a[212:215], a[248:251], v[208:211]
    ds_read_b64_tr_b16 a[206:207], v10 offset:20480
    v_cvt_pk_bf16_f32 v106, v108, v109
    v_mfma_f32_16x16x32_bf16 v[216:219], a[212:215], a[252:255], v[216:219]
    v_cvt_pk_bf16_f32 v107, v110, v111
    v_cvt_pk_bf16_f32 v112, v112, v113
    v_mfma_f32_16x16x32_bf16 v[216:219], a[208:211], a[236:239], v[216:219]
    s_waitcnt lgkmcnt(4)
    v_permlane16_swap_b32 v104, v106
    v_mfma_f32_16x16x32_bf16 v[220:223], a[192:195], a[236:239], v[220:223]
    ds_read_b64_tr_b16 a[208:209], v11 offset:2048
    v_cvt_pk_bf16_f32 v113, v114, v115
    v_mfma_f32_16x16x32_bf16 v[220:223], a[196:199], a[252:255], v[220:223]
    ds_read_b64_tr_b16 a[210:211], v11 offset:8192
    v_cvt_pk_bf16_f32 v114, v116, v117
    v_mfma_f32_16x16x32_bf16 v[212:215], a[196:199], a[248:251], v[212:215]
    v_permlane16_swap_b32 v105, v107
    v_mfma_f32_16x16x32_bf16 v[212:215], a[192:195], a[232:235], v[212:215]
    v_permlane16_swap_b32 v112, v114
    v_mfma_f32_16x16x32_bf16 v[204:207], a[192:195], a[228:231], v[204:207]
    ds_read_b64_tr_b16 a[212:213], v11 offset:14336
    v_cvt_pk_bf16_f32 v115, v118, v119
    v_mfma_f32_16x16x32_bf16 v[204:207], a[196:199], a[244:247], v[204:207]
    s_waitcnt vmcnt(16)
    ds_read_b64_tr_b16 a[214:215], v11 offset:20480
    v_cvt_pk_bf16_f32 v120, v120, v121
    v_mfma_f32_16x16x32_bf16 v[196:199], a[196:199], a[240:243], v[196:199]
pg_5:
    s_cbranch_execz pg_9
    s_barrier
    v_mfma_f32_16x16x32_bf16 v[196:199], a[192:195], a[224:227], v[196:199]
    s_waitcnt lgkmcnt(4)
    v_permlane16_swap_b32 v113, v115
    v_mfma_f32_16x16x32_bf16 v[224:227], a[200:203], a[224:227], v[224:227]
    s_add_u32 m0, s49, 49152
    ds_read_b128 a[192:195], v16 offset:0
    v_cvt_pk_bf16_f32 v121, v122, v123
    v_mfma_f32_16x16x32_bf16 v[224:227], a[204:207], a[240:243], v[224:227]
    buffer_load_dwordx4 v4, s[12:15], s38 offen offset:0 lds
    v_mfma_f32_16x16x32_bf16 v[232:235], a[204:207], a[244:247], v[232:235]
    v_cvt_pk_bf16_f32 v122, v124, v125
    v_cvt_pk_bf16_f32 v123, v126, v127
    v_mfma_f32_16x16x32_bf16 v[232:235], a[200:203], a[228:231], v[232:235]
    v_permlane16_swap_b32 v120, v122
    v_mfma_f32_16x16x32_bf16 v[240:243], a[200:203], a[232:235], v[240:243]
    ds_read_b128 a[196:199], v17 offset:0
    v_cvt_pk_bf16_f32 v128, v128, v129
    v_mfma_f32_16x16x32_bf16 v[240:243], a[204:207], a[248:251], v[240:243]
    s_add_u32 m0, s49, 50048
    v_permlane16_swap_b32 v121, v123
    v_mfma_f32_16x16x32_bf16 v[248:251], a[204:207], a[252:255], v[248:251]
    buffer_load_dwordx4 v4, s[12:15], s38 offen offset:128 lds
    v_mfma_f32_16x16x32_bf16 v[248:251], a[200:203], a[236:239], v[248:251]
    s_waitcnt lgkmcnt(2)
    v_cvt_pk_bf16_f32 v129, v130, v131
    v_cvt_pk_bf16_f32 v130, v132, v133
    v_mfma_f32_16x16x32_bf16 v[252:255], a[208:211], a[236:239], v[252:255]
    ds_read_b128 a[200:203], v16 offset:1024
    v_cvt_pk_bf16_f32 v131, v134, v135
    v_mfma_f32_16x16x32_bf16 v[252:255], a[212:215], a[252:255], v[252:255]
    v_permlane16_swap_b32 v128, v130
    v_mfma_f32_16x16x32_bf16 v[244:247], a[212:215], a[248:251], v[244:247]
    v_permlane16_swap_b32 v129, v131
    v_mfma_f32_16x16x32_bf16 v[244:247], a[208:211], a[232:235], v[244:247]
    v_cvt_pk_bf16_f32 v136, v136, v137
    v_cvt_pk_bf16_f32 v137, v138, v139
    v_mfma_f32_16x16x32_bf16 v[236:239], a[208:211], a[228:231], v[236:239]
    s_add_u32 m0, s49, 50944
    ds_read_b128 a[204:207], v17 offset:1024
    v_cvt_pk_bf16_f32 v138, v140, v141
    v_mfma_f32_16x16x32_bf16 v[236:239], a[212:215], a[244:247], v[236:239]
    buffer_load_dwordx4 v4, s[12:15], s38 offen offset:256 lds
    v_mfma_f32_16x16x32_bf16 v[228:231], a[212:215], a[240:243], v[228:231]
    v_permlane16_swap_b32 v136, v138
    v_mfma_f32_16x16x32_bf16 v[228:231], a[208:211], a[224:227], v[228:231]
    s_waitcnt lgkmcnt(2)
    v_cvt_pk_bf16_f32 v139, v142, v143
    v_cvt_pk_bf16_f32 v144, v144, v145
    v_mfma_f32_16x16x32_bf16 v[68:71], a[192:195], v[64:67], 0
    ds_read_b128 a[208:211], v16 offset:2048
    v_cvt_pk_bf16_f32 v145, v146, v147
    v_mfma_f32_16x16x32_bf16 v[68:71], a[196:199], v[96:99], v[68:71]
    v_permlane16_swap_b32 v137, v139
    v_mfma_f32_16x16x32_bf16 v[76:79], a[196:199], v[104:107], 0
    s_add_u32 m0, s49, 52224
    v_cvt_pk_bf16_f32 v146, v148, v149
    v_cvt_pk_bf16_f32 v147, v150, v151
    v_mfma_f32_16x16x32_bf16 v[76:79], a[192:195], v[72:75], v[76:79]
    buffer_load_dwordx4 v5, s[12:15], s38 offen offset:0 lds
    v_mfma_f32_16x16x32_bf16 v[84:87], a[192:195], v[80:83], 0
    ds_read_b128 a[212:215], v17 offset:2048
    v_cvt_pk_bf16_f32 v152, v152, v153
    v_mfma_f32_16x16x32_bf16 v[84:87], a[196:199], v[112:115], v[84:87]
    v_permlane16_swap_b32 v144, v146
    v_permlane16_swap_b32 v145, v147
    v_cvt_pk_bf16_f32 v153, v154, v155
    v_cvt_pk_bf16_f32 v154, v156, v157
    v_cvt_pk_bf16_f32 v155, v158, v159
    v_mov_b32 v26, s7
    v_permlane16_swap_b32 v152, v154
    v_permlane16_swap_b32 v153, v155
    v_cvt_pk_bf16_f32 v160, v160, v161
    v_cvt_pk_bf16_f32 v161, v162, v163
    v_cvt_pk_bf16_f32 v162, v164, v165
    v_min_u32 v27, 1, v1
    v_lshlrev_b32 v27, 30, v27
    v_permlane16_swap_b32 v160, v162
    v_cvt_pk_bf16_f32 v163, v166, v167
    s_waitcnt vmcnt(12)
    v_cvt_pk_bf16_f32 v168, v168, v169
    v_permlane16_swap_b32 v161, v163
    v_cvt_pk_bf16_f32 v169, v170, v171
    v_cvt_pk_bf16_f32 v170, v172, v173
    v_cvt_pk_bf16_f32 v171, v174, v175
    v_cvt_pk_bf16_f32 v176, v176, v177
    v_permlane16_swap_b32 v168, v170
    v_permlane16_swap_b32 v169, v171
    v_cvt_pk_bf16_f32 v177, v178, v179
    v_cvt_pk_bf16_f32 v178, v180, v181
    v_cvt_pk_bf16_f32 v179, v182, v183
    v_cvt_pk_bf16_f32 v184, v184, v185
    v_permlane16_swap_b32 v176, v178
    v_permlane16_swap_b32 v177, v179
    v_cvt_pk_bf16_f32 v185, v186, v187
    v_cvt_pk_bf16_f32 v186, v188, v189
    v_cvt_pk_bf16_f32 v187, v190, v191
    v_cvt_pk_bf16_f32 v192, v192, v193
    v_permlane16_swap_b32 v184, v186
    v_permlane16_swap_b32 v185, v187
    v_mfma_f32_16x16x32_bf16 v[92:95], a[196:199], v[120:123], 0
    buffer_store_dword v26, v27, s[24:27], s4 offen offset:144 sc1
    v_mfma_f32_16x16x32_bf16 v[92:95], a[192:195], v[88:91], v[92:95]
    s_waitcnt lgkmcnt(2)
    v_cvt_pk_bf16_f32 v193, v194, v195
    v_cvt_pk_bf16_f32 v194, v196, v197
    v_mfma_f32_16x16x32_bf16 v[92:95], a[200:203], v[152:155], v[92:95]
    ds_read_b128 a[192:195], v16 offset:6144
    v_cvt_pk_bf16_f32 v195, v198, v199
    v_mfma_f32_16x16x32_bf16 v[92:95], a[204:207], v[184:187], v[92:95]
    s_add_u32 m0, s49, 53120
    v_permlane16_swap_b32 v192, v194
    v_mfma_f32_16x16x32_bf16 v[84:87], a[204:207], v[176:179], v[84:87]
    buffer_load_dwordx4 v5, s[12:15], s38 offen offset:128 lds
    v_mfma_f32_16x16x32_bf16 v[84:87], a[200:203], v[144:147], v[84:87]
    v_permlane16_swap_b32 v193, v195
    v_mfma_f32_16x16x32_bf16 v[76:79], a[200:203], v[136:139], v[76:79]
    ds_read_b128 a[196:199], v17 offset:6144
    v_cvt_pk_bf16_f32 v200, v200, v201
    v_mfma_f32_16x16x32_bf16 v[76:79], a[204:207], v[168:171], v[76:79]
    v_cvt_pk_bf16_f32 v201, v202, v203
    v_cvt_pk_bf16_f32 v202, v204, v205
    v_cvt_pk_bf16_f32 v203, v206, v207
    v_cvt_pk_bf16_f32 v208, v208, v209
    v_permlane16_swap_b32 v200, v202
    v_permlane16_swap_b32 v201, v203
    v_cvt_pk_bf16_f32 v209, v210, v211
    v_cvt_pk_bf16_f32 v210, v212, v213
    v_cvt_pk_bf16_f32 v211, v214, v215
    v_cvt_pk_bf16_f32 v216, v216, v217
    v_permlane16_swap_b32 v208, v210
    v_permlane16_swap_b32 v209, v211
    v_cvt_pk_bf16_f32 v217, v218, v219
    v_cvt_pk_bf16_f32 v218, v220, v221
    v_cvt_pk_bf16_f32 v219, v222, v223
    v_cvt_pk_bf16_f32 v224, v224, v225
    v_permlane16_swap_b32 v216, v218
    v_permlane16_swap_b32 v217, v219
    v_cvt_pk_bf16_f32 v225, v226, v227
    v_cvt_pk_bf16_f32 v226, v228, v229
    v_cvt_pk_bf16_f32 v227, v230, v231
    v_cvt_pk_bf16_f32 v232, v232, v233
    v_permlane16_swap_b32 v224, v226
    v_permlane16_swap_b32 v225, v227
    v_cvt_pk_bf16_f32 v233, v234, v235
    v_cvt_pk_bf16_f32 v234, v236, v237
    v_cvt_pk_bf16_f32 v235, v238, v239
    v_cvt_pk_bf16_f32 v240, v240, v241
    v_permlane16_swap_b32 v232, v234
    v_permlane16_swap_b32 v233, v235
    v_cvt_pk_bf16_f32 v241, v242, v243
    v_cvt_pk_bf16_f32 v242, v244, v245
    v_cvt_pk_bf16_f32 v243, v246, v247
    v_cvt_pk_bf16_f32 v248, v248, v249
    v_permlane16_swap_b32 v240, v242
    v_permlane16_swap_b32 v241, v243
    v_cvt_pk_bf16_f32 v249, v250, v251
    v_cvt_pk_bf16_f32 v250, v252, v253
    v_cvt_pk_bf16_f32 v251, v254, v255
    s_nop 0
    v_permlane16_swap_b32 v248, v250
    v_permlane16_swap_b32 v249, v251
    v_mfma_f32_16x16x32_bf16 v[68:71], a[204:207], v[160:163], v[68:71]
    v_mfma_f32_16x16x32_bf16 v[68:71], a[200:203], v[128:131], v[68:71]
    s_waitcnt lgkmcnt(2)
    s_add_u32 m0, s49, 54016
    v_mfma_f32_16x16x32_bf16 v[68:71], a[208:211], v[192:195], v[68:71]
    ds_read_b128 a[200:203], v16 offset:7168
    v_mfma_f32_16x16x32_bf16 v[68:71], a[212:215], v[224:227], v[68:71]
    buffer_load_dwordx4 v5, s[12:15], s38 offen offset:256 lds
    v_mfma_f32_16x16x32_bf16 v[76:79], a[212:215], v[232:235], v[76:79]
    s_add_u32 s38, s38, 24576
    v_mfma_f32_16x16x32_bf16 v[76:79], a[208:211], v[200:203], v[76:79]
    v_mfma_f32_16x16x32_bf16 v[84:87], a[208:211], v[208:211], v[84:87]
    ds_read_b128 a[204:207], v17 offset:7168
    v_mfma_f32_16x16x32_bf16 v[84:87], a[212:215], v[240:243], v[84:87]
    v_mfma_f32_16x16x32_bf16 v[92:95], a[212:215], v[248:251], v[92:95]
    v_mfma_f32_16x16x32_bf16 v[92:95], a[208:211], v[216:219], v[92:95]
    s_waitcnt lgkmcnt(2)
    v_mfma_f32_16x16x32_bf16 v[124:127], a[192:195], v[88:91], 0
    ds_read_b128 a[208:211], v16 offset:8192
    v_mfma_f32_16x16x32_bf16 v[124:127], a[196:199], v[120:123], v[124:127]
    v_mfma_f32_16x16x32_bf16 v[116:119], a[196:199], v[112:115], 0
    v_mfma_f32_16x16x32_bf16 v[116:119], a[192:195], v[80:83], v[116:119]
    v_mfma_f32_16x16x32_bf16 v[108:111], a[192:195], v[72:75], 0
    ds_read_b128 a[212:215], v17 offset:8192
    v_mfma_f32_16x16x32_bf16 v[108:111], a[196:199], v[104:107], v[108:111]
    s_add_u32 m0, s49, 98304
    v_max3_f32 v56, v68, v69, v70
    v_max_f32 v56, v56, v71
    v_mfma_f32_16x16x32_bf16 v[100:103], a[196:199], v[96:99], 0
    buffer_load_dwordx4 v6, s[16:19], s40 offen offset:0 lds
    v_mfma_f32_16x16x32_bf16 v[100:103], a[192:195], v[64:67], v[100:103]
    s_waitcnt lgkmcnt(2)
    v_mov_b32 v48, v56
    v_max3_f32 v57, v76, v77, v78
    v_mfma_f32_16x16x32_bf16 v[100:103], a[200:203], v[128:131], v[100:103]
    ds_read_b128 a[192:195], v16 offset:12288
    v_max_f32 v57, v57, v79
    v_mfma_f32_16x16x32_bf16 v[100:103], a[204:207], v[160:163], v[100:103]
    v_permlane16_swap_b32 v56, v48
    v_mfma_f32_16x16x32_bf16 v[108:111], a[204:207], v[168:171], v[108:111]
    v_max_f32 v56, v56, v48
    v_mov_b32 v48, v56
    v_mfma_f32_16x16x32_bf16 v[108:111], a[200:203], v[136:139], v[108:111]
    s_add_u32 m0, s49, 99200
    v_permlane32_swap_b32 v56, v48
    v_mfma_f32_16x16x32_bf16 v[116:119], a[200:203], v[144:147], v[116:119]
    ds_read_b128 a[196:199], v17 offset:12288
    v_max_f32 v56, v56, v48
    v_mfma_f32_16x16x32_bf16 v[116:119], a[204:207], v[176:179], v[116:119]
    buffer_load_dwordx4 v6, s[16:19], s40 offen offset:128 lds
    v_mfma_f32_16x16x32_bf16 v[124:127], a[204:207], v[184:187], v[124:127]
    v_sub_f32 v32, 0, v56
    v_sub_f32 v33, 0, v56
    v_mfma_f32_16x16x32_bf16 v[124:127], a[200:203], v[152:155], v[124:127]
    s_waitcnt lgkmcnt(2)
    v_sub_f32 v34, 0, v56
    v_sub_f32 v35, 0, v56
    v_mfma_f32_16x16x32_bf16 v[124:127], a[208:211], v[216:219], v[124:127]
    ds_read_b128 a[200:203], v16 offset:13312
    v_mov_b32 v49, v57
    v_mfma_f32_16x16x32_bf16 v[124:127], a[212:215], v[248:251], v[124:127]
    v_max3_f32 v58, v84, v85, v86
    v_max_f32 v58, v58, v87
    v_mfma_f32_16x16x32_bf16 v[116:119], a[212:215], v[240:243], v[116:119]
    s_add_u32 m0, s49, 100096
    v_permlane16_swap_b32 v57, v49
    v_mfma_f32_16x16x32_bf16 v[116:119], a[208:211], v[208:211], v[116:119]
    buffer_load_dwordx4 v6, s[16:19], s40 offen offset:256 lds
    v_mfma_f32_16x16x32_bf16 v[108:111], a[208:211], v[200:203], v[108:111]
    ds_read_b128 a[204:207], v17 offset:13312
    v_max_f32 v57, v57, v49
    v_mfma_f32_16x16x32_bf16 v[108:111], a[212:215], v[232:235], v[108:111]
    v_mov_b32 v49, v57
    v_mov_b32 v50, v58
    v_max3_f32 v59, v92, v93, v94
    v_permlane32_swap_b32 v57, v49
    v_permlane16_swap_b32 v58, v50
    v_max_f32 v57, v57, v49
    v_sub_f32 v36, 0, v57
    v_sub_f32 v37, 0, v57
    v_sub_f32 v38, 0, v57
    v_sub_f32 v39, 0, v57
    v_max_f32 v58, v58, v50
    v_mov_b32 v50, v58
    v_max_f32 v59, v59, v95
    v_mov_b32 v51, v59
    v_permlane32_swap_b32 v58, v50
    s_nop 0
    v_max_f32 v58, v58, v50
    v_sub_f32 v40, 0, v58
    v_sub_f32 v41, 0, v58
    v_sub_f32 v42, 0, v58
    v_sub_f32 v43, 0, v58
    v_permlane16_swap_b32 v59, v51
    s_nop 0
    v_max_f32 v59, v59, v51
    v_mov_b32 v51, v59
    s_nop 0
    s_nop 0
    v_permlane32_swap_b32 v59, v51
    s_nop 0
    v_max_f32 v59, v59, v51
    v_sub_f32 v44, 0, v59
    v_sub_f32 v45, 0, v59
    v_sub_f32 v46, 0, v59
    v_sub_f32 v47, 0, v59
    v_mfma_f32_16x16x32_bf16 v[100:103], a[212:215], v[224:227], v[100:103]
    v_sub_f32 v68, v68, v56
    v_sub_f32 v69, v69, v56
    v_mfma_f32_16x16x32_bf16 v[100:103], a[208:211], v[192:195], v[100:103]
    s_waitcnt lgkmcnt(2)
    v_exp_f32 v48, v68
    v_mfma_f32_16x16x32_bf16 v[132:135], a[192:195], v[64:67], v[32:35]
    s_add_u32 m0, s49, 101376
    ds_read_b128 a[208:211], v16 offset:14336
    v_sub_f32 v70, v70, v56
    v_mfma_f32_16x16x32_bf16 v[132:135], a[196:199], v[96:99], v[132:135]
    buffer_load_dwordx4 v7, s[16:19], s40 offen offset:0 lds
    v_mfma_f32_16x16x32_bf16 v[140:143], a[196:199], v[104:107], v[36:39]
    v_exp_f32 v49, v69
    v_mfma_f32_16x16x32_bf16 v[140:143], a[192:195], v[72:75], v[140:143]
    v_exp_f32 v50, v70
    v_mfma_f32_16x16x32_bf16 v[148:151], a[192:195], v[80:83], v[40:43]
    ds_read_b128 a[212:215], v17 offset:14336
    v_sub_f32 v71, v71, v56
    v_mfma_f32_16x16x32_bf16 v[148:151], a[196:199], v[112:115], v[148:151]
    v_exp_f32 v51, v71
    v_mfma_f32_16x16x32_bf16 v[156:159], a[196:199], v[120:123], v[44:47]
    v_sub_f32 v100, v100, v56
    v_cvt_pk_bf16_f32 v196, v48, v49
    v_mfma_f32_16x16x32_bf16 v[156:159], a[192:195], v[88:91], v[156:159]
    s_waitcnt lgkmcnt(2)
    v_exp_f32 v52, v100
    v_mfma_f32_16x16x32_bf16 v[156:159], a[200:203], v[152:155], v[156:159]
    s_add_u32 m0, s49, 102272
    ds_read_b128 a[192:195], v16 offset:18432
    v_add_f32 v24, v48, v49
    v_mfma_f32_16x16x32_bf16 v[156:159], a[204:207], v[184:187], v[156:159]
    buffer_load_dwordx4 v7, s[16:19], s40 offen offset:128 lds
    v_mfma_f32_16x16x32_bf16 v[148:151], a[204:207], v[176:179], v[148:151]
    v_sub_f32 v101, v101, v56
    v_sub_f32 v102, v102, v56
    v_mfma_f32_16x16x32_bf16 v[148:151], a[200:203], v[144:147], v[148:151]
    v_exp_f32 v53, v101
    v_mfma_f32_16x16x32_bf16 v[140:143], a[200:203], v[136:139], v[140:143]
    ds_read_b128 a[196:199], v17 offset:18432
    v_add_f32 v24, v24, v50
    v_mfma_f32_16x16x32_bf16 v[140:143], a[204:207], v[168:171], v[140:143]
    s_add_u32 m0, s49, 103168
    v_exp_f32 v54, v102
    v_mfma_f32_16x16x32_bf16 v[132:135], a[204:207], v[160:163], v[132:135]
    buffer_load_dwordx4 v7, s[16:19], s40 offen offset:256 lds
    v_mfma_f32_16x16x32_bf16 v[132:135], a[200:203], v[128:131], v[132:135]
    s_waitcnt lgkmcnt(2)
    v_sub_f32 v103, v103, v56
    v_cvt_pk_bf16_f32 v197, v50, v51
    v_mfma_f32_16x16x32_bf16 v[132:135], a[208:211], v[192:195], v[132:135]
    s_add_u32 s40, s40, 24576
    ds_read_b128 a[200:203], v16 offset:19456
    v_add_f32 v24, v24, v51
    v_mfma_f32_16x16x32_bf16 v[132:135], a[212:215], v[224:227], v[132:135]
    v_exp_f32 v55, v103
    v_mfma_f32_16x16x32_bf16 v[140:143], a[212:215], v[232:235], v[140:143]
    v_sub_f32 v76, v76, v57
    v_sub_f32 v77, v77, v57
    v_mfma_f32_16x16x32_bf16 v[140:143], a[208:211], v[200:203], v[140:143]
    v_exp_f32 v48, v76
    v_mfma_f32_16x16x32_bf16 v[148:151], a[208:211], v[208:211], v[148:151]
    ds_read_b128 a[204:207], v17 offset:19456
    v_add_f32 v24, v24, v52
    v_mfma_f32_16x16x32_bf16 v[148:151], a[212:215], v[240:243], v[148:151]
    v_exp_f32 v49, v77
    v_mfma_f32_16x16x32_bf16 v[156:159], a[212:215], v[248:251], v[156:159]
    v_sub_f32 v78, v78, v57
    v_cvt_pk_bf16_f32 v198, v52, v53
    v_mfma_f32_16x16x32_bf16 v[156:159], a[208:211], v[216:219], v[156:159]
    s_waitcnt lgkmcnt(2)
    v_exp_f32 v50, v78
    v_mfma_f32_16x16x32_bf16 v[188:191], a[192:195], v[88:91], v[44:47]
    ds_read_b128 a[208:211], v16 offset:20480
    v_add_f32 v24, v24, v53
    v_mfma_f32_16x16x32_bf16 v[188:191], a[196:199], v[120:123], v[188:191]
    v_sub_f32 v79, v79, v57
    v_sub_f32 v108, v108, v57
    v_mfma_f32_16x16x32_bf16 v[180:183], a[196:199], v[112:115], v[40:43]
    v_exp_f32 v51, v79
    v_mfma_f32_16x16x32_bf16 v[180:183], a[192:195], v[80:83], v[180:183]
    v_add_f32 v24, v24, v54
    v_sub_f32 v109, v109, v57
    v_mfma_f32_16x16x32_bf16 v[172:175], a[192:195], v[72:75], v[36:39]
    ds_read_b128 a[212:215], v17 offset:20480
    v_cvt_pk_bf16_f32 v199, v54, v55
    v_mfma_f32_16x16x32_bf16 v[172:175], a[196:199], v[104:107], v[172:175]
    s_waitcnt vmcnt(16)
    v_exp_f32 v52, v108
    v_mfma_f32_16x16x32_bf16 v[164:167], a[196:199], v[96:99], v[32:35]
    s_barrier
    v_mfma_f32_16x16x32_bf16 v[164:167], a[192:195], v[64:67], v[164:167]
    s_waitcnt lgkmcnt(2)
    v_add_f32 v24, v24, v55
    v_sub_f32 v110, v110, v57
    v_add_u32 v16, s42, v18
    v_mfma_f32_16x16x32_bf16 v[164:167], a[200:203], v[128:131], v[164:167]
    ds_read_b128 a[224:227], v16 offset:0
    v_sub_f32 v111, v111, v57
    v_mfma_f32_16x16x32_bf16 v[164:167], a[204:207], v[160:163], v[164:167]
    v_exp_f32 v53, v109
    v_add_u32 v17, s42, v19
    v_mfma_f32_16x16x32_bf16 v[172:175], a[204:207], v[168:171], v[172:175]
    ds_read_b128 a[228:231], v17 offset:0
    v_sub_f32 v84, v84, v58
    v_mfma_f32_16x16x32_bf16 v[172:175], a[200:203], v[136:139], v[172:175]
    v_exp_f32 v54, v110
    v_mfma_f32_16x16x32_bf16 v[180:183], a[200:203], v[144:147], v[180:183]
    ds_read_b128 a[232:235], v16 offset:1024
    v_cvt_pk_bf16_f32 v204, v48, v49
    v_mfma_f32_16x16x32_bf16 v[180:183], a[204:207], v[176:179], v[180:183]
    v_exp_f32 v55, v111
    v_mfma_f32_16x16x32_bf16 v[188:191], a[204:207], v[184:187], v[188:191]
    ds_read_b128 a[236:239], v17 offset:1024
    v_add_f32 v25, v48, v49
    v_mfma_f32_16x16x32_bf16 v[188:191], a[200:203], v[152:155], v[188:191]
    s_waitcnt lgkmcnt(4)
    v_sub_f32 v85, v85, v58
    v_sub_f32 v86, v86, v58
    v_mfma_f32_16x16x32_bf16 v[188:191], a[208:211], v[216:219], v[188:191]
    ds_read_b128 a[240:243], v16 offset:2048
    v_add_f32 v25, v25, v50
    v_mfma_f32_16x16x32_bf16 v[188:191], a[212:215], v[248:251], v[188:191]
    v_exp_f32 v48, v84
    v_mfma_f32_16x16x32_bf16 v[180:183], a[212:215], v[240:243], v[180:183]
    ds_read_b128 a[244:247], v17 offset:2048
    v_sub_f32 v87, v87, v58
    v_mfma_f32_16x16x32_bf16 v[180:183], a[208:211], v[208:211], v[180:183]
    v_cvt_pk_bf16_f32 v205, v50, v51
    v_add_f32 v25, v25, v51
    v_mfma_f32_16x16x32_bf16 v[172:175], a[208:211], v[200:203], v[172:175]
    v_sub_f32 v116, v116, v58
    v_sub_f32 v117, v117, v58
    v_mfma_f32_16x16x32_bf16 v[172:175], a[212:215], v[232:235], v[172:175]
    v_exp_f32 v49, v85
    v_mfma_f32_16x16x32_bf16 v[164:167], a[212:215], v[224:227], v[164:167]
    v_exp_f32 v50, v86
    v_mfma_f32_16x16x32_bf16 v[164:167], a[208:211], v[192:195], v[164:167]
    v_add_f32 v25, v25, v52
    v_cvt_pk_bf16_f32 v206, v52, v53
    v_cvt_pk_bf16_f32 v207, v54, v55
    v_add_f32 v25, v25, v53
    v_add_f32 v25, v25, v54
    v_add_f32 v25, v25, v55
    v_cvt_pk_bf16_f32 v212, v48, v49
    v_exp_f32 v51, v87
    v_sub_f32 v118, v118, v58
    v_cvt_pk_bf16_f32 v213, v50, v51
    v_exp_f32 v52, v116
    v_exp_f32 v53, v117
    v_sub_f32 v119, v119, v58
    v_cvt_pk_bf16_f32 v214, v52, v53
    v_exp_f32 v54, v118
    v_exp_f32 v55, v119
    v_sub_f32 v92, v92, v59
    v_cvt_pk_bf16_f32 v215, v54, v55
    v_add_f32 v26, v48, v49
    v_add_f32 v26, v26, v50
    v_add_f32 v26, v26, v51
    v_add_f32 v26, v26, v52
    v_add_f32 v26, v26, v53
    v_add_f32 v26, v26, v54
    v_add_f32 v26, v26, v55
    v_max3_f32 v29, v24, v25, v26
    v_exp_f32 v48, v92
    v_sub_f32 v93, v93, v59
    v_exp_f32 v49, v93
    v_sub_f32 v94, v94, v59
    v_cvt_pk_bf16_f32 v220, v48, v49
    v_exp_f32 v50, v94
    v_sub_f32 v95, v95, v59
    v_exp_f32 v51, v95
    v_sub_f32 v124, v124, v59
    v_cvt_pk_bf16_f32 v221, v50, v51
    v_exp_f32 v52, v124
    v_sub_f32 v125, v125, v59
    v_exp_f32 v53, v125
    v_sub_f32 v126, v126, v59
    v_cvt_pk_bf16_f32 v222, v52, v53
    v_exp_f32 v54, v126
    v_sub_f32 v127, v127, v59
    v_exp_f32 v55, v127
    v_add_f32 v27, v48, v49
    v_cvt_pk_bf16_f32 v223, v54, v55
    v_add_f32 v27, v27, v50
    v_add_f32 v27, v27, v51
    v_add_f32 v27, v27, v52
    v_add_f32 v27, v27, v53
    v_add_f32 v27, v27, v54
    v_add_f32 v27, v27, v55
    v_max_f32 v29, v29, v27
    v_cmp_nle_f32 vcc, v29, v30
    s_cbranch_vccnz rare_p
rare_p_ret:
    s_waitcnt lgkmcnt(0)
    s_mov_b64 s[88:89], s[12:13]
    s_mov_b32 s57, s38
    v_mov_b32 v58, v4
    v_mov_b32 v59, v5
at_switch:
    s_mov_b32 s12, s8
    s_mov_b32 s13, s9
    s_mov_b32 s14, s10
    s_mov_b32 s38, s36
    s_mov_b32 s39, 81920
    v_mov_b32 v4, v62
    v_mov_b32 v5, v63
    v_lshrrev_b32 v60, 2, v1
    v_min_u32 v60, 9, v60
    v_mul_u32_u24 v60, 6144, v60
    v_lshrrev_b32 v57, 9, v3
    v_add_u32 v60, v60, v57
    v_and_b32 v57, 15, v1
    v_lshl_add_u32 v57, s3, 4, v57
    v_mul_u32_u24 v57, 1280, v57
    s_getpc_b64 s[74:75]
ct1:
    s_add_u32 s74, s74, tail_code-ct1
    s_addc_u32 s75, s75, 0
    s_cmp_eq_u32 s45, 1
    s_cbranch_scc0 at_dry
    global_load_dword a219, v31, s[74:75]
    buffer_load_dword a217, v57, s[32:35], s60 offen
    buffer_load_dword v61, v60, s[24:27], s37 offen sc1
    s_branch at_switch_ret
at_dry:
    s_mov_b64 s[12:13], s[88:89]
    s_mov_b32 s14, 196608
    s_mov_b32 s38, s57
    s_mov_b32 s39, 24576
    v_mov_b32 v4, v58
    v_mov_b32 v5, v59
    .p2align 6
at_loop:
    v_mfma_f32_16x16x32_bf16 v[68:71], a[224:227], v[64:67], v[32:35]
    ds_read_b128 a[192:195], v16 offset:6144
    v_add_f32 v20, v20, v24
    v_mfma_f32_16x16x32_bf16 v[68:71], a[228:231], v[96:99], v[68:71]
    s_cmp_eq_u32 s45, 1
    s_cbranch_scc1 at_switch
at_switch_ret:
    v_add_f32 v21, v21, v25
    v_mfma_f32_16x16x32_bf16 v[68:71], a[232:235], v[128:131], v[68:71]
    v_add_f32 v22, v22, v26
    v_add_f32 v23, v23, v27
    v_mfma_f32_16x16x32_bf16 v[68:71], a[236:239], v[160:163], v[68:71]
    ds_read_b128 a[196:199], v17 offset:6144
    v_add_u32 v8, s41, v12
    v_mfma_f32_16x16x32_bf16 v[68:71], a[240:243], v[192:195], v[68:71]
    v_exp_f32 v48, v132
    v_mfma_f32_16x16x32_bf16 v[68:71], a[244:247], v[224:227], v[68:71]
    s_add_u32 m0, s41, 0
    v_exp_f32 v49, v133
    v_mfma_f32_16x16x32_bf16 v[76:79], a[244:247], v[232:235], v[36:39]
    ds_read_b128 a[200:203], v16 offset:7168
    v_cvt_pk_bf16_f32 v228, v48, v49
    v_mfma_f32_16x16x32_bf16 v[76:79], a[240:243], v[200:203], v[76:79]
    buffer_load_dwordx4 v4, s[12:15], s38 offen offset:0 lds
    v_mfma_f32_16x16x32_bf16 v[76:79], a[236:239], v[168:171], v[76:79]
    v_exp_f32 v50, v134
    v_mfma_f32_16x16x32_bf16 v[76:79], a[232:235], v[136:139], v[76:79]
    ds_read_b128 a[204:207], v17 offset:7168
    v_add_f32 v24, v48, v49
    v_mfma_f32_16x16x32_bf16 v[76:79], a[228:231], v[104:107], v[76:79]
    v_exp_f32 v51, v135
    v_mfma_f32_16x16x32_bf16 v[76:79], a[224:227], v[72:75], v[76:79]
    v_exp_f32 v52, v164
    v_mfma_f32_16x16x32_bf16 v[84:87], a[224:227], v[80:83], v[40:43]
    ds_read_b128 a[208:211], v16 offset:8192
    v_add_u32 v9, s41, v13
    v_mfma_f32_16x16x32_bf16 v[84:87], a[228:231], v[112:115], v[84:87]
    v_exp_f32 v53, v165
    v_mfma_f32_16x16x32_bf16 v[84:87], a[232:235], v[144:147], v[84:87]
    v_exp_f32 v54, v166
    v_mfma_f32_16x16x32_bf16 v[84:87], a[236:239], v[176:179], v[84:87]
    ds_read_b128 a[212:215], v17 offset:8192
    v_add_f32 v24, v24, v50
    v_mfma_f32_16x16x32_bf16 v[84:87], a[240:243], v[208:211], v[84:87]
    v_exp_f32 v55, v167
    v_mfma_f32_16x16x32_bf16 v[84:87], a[244:247], v[240:243], v[84:87]
    s_add_u32 m0, s41, 896
    v_add_u32 v10, s41, v14
    v_cvt_pk_bf16_f32 v229, v50, v51
    v_mfma_f32_16x16x32_bf16 v[92:95], a[244:247], v[248:251], v[44:47]
    buffer_load_dwordx4 v4, s[12:15], s38 offen offset:128 lds
    v_mfma_f32_16x16x32_bf16 v[92:95], a[240:243], v[216:219], v[92:95]
    v_add_f32 v24, v24, v51
    v_add_u32 v11, s41, v15
    v_mfma_f32_16x16x32_bf16 v[92:95], a[236:239], v[184:187], v[92:95]
    v_exp_f32 v48, v140
    v_mfma_f32_16x16x32_bf16 v[92:95], a[232:235], v[152:155], v[92:95]
    v_add_f32 v24, v24, v52
    v_cvt_pk_bf16_f32 v230, v52, v53
    v_mfma_f32_16x16x32_bf16 v[92:95], a[228:231], v[120:123], v[92:95]
    v_exp_f32 v49, v141
    v_mfma_f32_16x16x32_bf16 v[92:95], a[224:227], v[88:91], v[92:95]
    s_waitcnt lgkmcnt(0)
    v_add_f32 v24, v24, v53
    v_add_f32 v24, v24, v54
    v_mfma_f32_16x16x32_bf16 v[124:127], a[192:195], v[88:91], v[44:47]
    ds_read_b64_tr_b16 a[224:225], v8 offset:0
    v_cvt_pk_bf16_f32 v231, v54, v55
    v_mfma_f32_16x16x32_bf16 v[124:127], a[196:199], v[120:123], v[124:127]
    ds_read_b64_tr_b16 a[226:227], v8 offset:6144
    v_add_f32 v24, v24, v55
    v_mfma_f32_16x16x32_bf16 v[124:127], a[200:203], v[152:155], v[124:127]
    v_exp_f32 v50, v142
    v_mfma_f32_16x16x32_bf16 v[124:127], a[204:207], v[184:187], v[124:127]
    ds_read_b64_tr_b16 a[228:229], v9 offset:0
    v_cvt_pk_bf16_f32 v236, v48, v49
    v_mfma_f32_16x16x32_bf16 v[124:127], a[208:211], v[216:219], v[124:127]
    ds_read_b64_tr_b16 a[230:231], v9 offset:6144
    v_add_f32 v25, v48, v49
    v_mfma_f32_16x16x32_bf16 v[124:127], a[212:215], v[248:251], v[124:127]
    v_exp_f32 v51, v143
    v_mfma_f32_16x16x32_bf16 v[116:119], a[212:215], v[240:243], v[40:43]
    ds_read_b64_tr_b16 a[232:233], v10 offset:0
    v_add_f32 v25, v25, v50
    v_mfma_f32_16x16x32_bf16 v[116:119], a[208:211], v[208:211], v[116:119]
    s_add_u32 m0, s41, 1792
    ds_read_b64_tr_b16 a[234:235], v10 offset:6144
    v_cvt_pk_bf16_f32 v237, v50, v51
    v_mfma_f32_16x16x32_bf16 v[116:119], a[204:207], v[176:179], v[116:119]
    buffer_load_dwordx4 v4, s[12:15], s38 offen offset:256 lds
    v_mfma_f32_16x16x32_bf16 v[116:119], a[200:203], v[144:147], v[116:119]
    ds_read_b64_tr_b16 a[236:237], v11 offset:0
    v_add_f32 v25, v25, v51
    v_mfma_f32_16x16x32_bf16 v[116:119], a[196:199], v[112:115], v[116:119]
    ds_read_b64_tr_b16 a[238:239], v11 offset:6144
    v_mfma_f32_16x16x32_bf16 v[116:119], a[192:195], v[80:83], v[116:119]
    v_exp_f32 v52, v172
    v_mfma_f32_16x16x32_bf16 v[108:111], a[192:195], v[72:75], v[36:39]
    ds_read_b64_tr_b16 a[240:241], v8 offset:1024
    v_add_f32 v25, v25, v52
    v_mfma_f32_16x16x32_bf16 v[108:111], a[196:199], v[104:107], v[108:111]
    ds_read_b64_tr_b16 a[242:243], v8 offset:7168
    v_mfma_f32_16x16x32_bf16 v[108:111], a[200:203], v[136:139], v[108:111]
    v_exp_f32 v53, v173
    v_mfma_f32_16x16x32_bf16 v[108:111], a[204:207], v[168:171], v[108:111]
    ds_read_b64_tr_b16 a[244:245], v9 offset:1024
    v_cvt_pk_bf16_f32 v238, v52, v53
    v_mfma_f32_16x16x32_bf16 v[108:111], a[208:211], v[200:203], v[108:111]
    ds_read_b64_tr_b16 a[246:247], v9 offset:7168
    v_add_f32 v25, v25, v53
    v_mfma_f32_16x16x32_bf16 v[108:111], a[212:215], v[232:235], v[108:111]
    v_exp_f32 v54, v174
    v_mfma_f32_16x16x32_bf16 v[100:103], a[212:215], v[224:227], v[32:35]
    v_exp_f32 v55, v175
    v_mfma_f32_16x16x32_bf16 v[100:103], a[208:211], v[192:195], v[100:103]
    v_exp_f32 v48, v148
    v_mfma_f32_16x16x32_bf16 v[100:103], a[204:207], v[160:163], v[100:103]
    v_exp_f32 v49, v149
    v_mfma_f32_16x16x32_bf16 v[100:103], a[200:203], v[128:131], v[100:103]
    s_add_u32 m0, s41, 3072
    v_exp_f32 v50, v150
    v_mfma_f32_16x16x32_bf16 v[100:103], a[196:199], v[96:99], v[100:103]
    buffer_load_dwordx4 v5, s[12:15], s38 offen offset:0 lds
    v_mfma_f32_16x16x32_bf16 v[100:103], a[192:195], v[64:67], v[100:103]
    s_waitcnt lgkmcnt(0)
    v_add_f32 v25, v25, v54
    v_cvt_pk_bf16_f32 v239, v54, v55
    v_mfma_f32_16x16x32_bf16 a[0:3], a[224:227], v[196:199], a[0:3]
    ds_read_b64_tr_b16 a[192:193], v10 offset:1024
    v_add_f32 v25, v25, v55
    v_mfma_f32_16x16x32_bf16 a[16:19], a[228:231], v[196:199], a[16:19]
    ds_read_b64_tr_b16 a[194:195], v10 offset:7168
    v_cvt_pk_bf16_f32 v244, v48, v49
    v_mfma_f32_16x16x32_bf16 a[32:35], a[232:235], v[196:199], a[32:35]
    v_exp_f32 v51, v151
    v_mfma_f32_16x16x32_bf16 a[48:51], a[236:239], v[196:199], a[48:51]
    ds_read_b64_tr_b16 a[196:197], v11 offset:1024
    v_add_f32 v26, v48, v49
    v_mfma_f32_16x16x32_bf16 a[64:67], a[240:243], v[196:199], a[64:67]
    ds_read_b64_tr_b16 a[198:199], v11 offset:7168
    v_add_f32 v26, v26, v50
    v_mfma_f32_16x16x32_bf16 a[80:83], a[244:247], v[196:199], a[80:83]
    v_exp_f32 v52, v180
    v_mfma_f32_16x16x32_bf16 a[84:87], a[244:247], v[204:207], a[84:87]
    ds_read_b64_tr_b16 a[200:201], v8 offset:2048
    v_cvt_pk_bf16_f32 v245, v50, v51
    v_mfma_f32_16x16x32_bf16 a[68:71], a[240:243], v[204:207], a[68:71]
    ds_read_b64_tr_b16 a[202:203], v8 offset:8192
    v_add_f32 v26, v26, v51
    v_mfma_f32_16x16x32_bf16 a[52:55], a[236:239], v[204:207], a[52:55]
pg_6:
    s_cbranch_execz pg_10
    v_exp_f32 v53, v181
    v_mfma_f32_16x16x32_bf16 a[36:39], a[232:235], v[204:207], a[36:39]
    ds_read_b64_tr_b16 a[204:205], v9 offset:2048
    v_add_f32 v26, v26, v52
    v_mfma_f32_16x16x32_bf16 a[20:23], a[228:231], v[204:207], a[20:23]
    ds_read_b64_tr_b16 a[206:207], v9 offset:8192
    v_cvt_pk_bf16_f32 v246, v52, v53
    v_mfma_f32_16x16x32_bf16 a[4:7], a[224:227], v[204:207], a[4:7]
    s_add_u32 m0, s41, 3968
    v_exp_f32 v54, v182
    v_mfma_f32_16x16x32_bf16 a[8:11], a[224:227], v[212:215], a[8:11]
    ds_read_b64_tr_b16 a[208:209], v10 offset:2048
    v_add_f32 v26, v26, v53
    v_mfma_f32_16x16x32_bf16 a[24:27], a[228:231], v[212:215], a[24:27]
    ds_read_b64_tr_b16 a[210:211], v10 offset:8192
    v_add_f32 v26, v26, v54
    v_mfma_f32_16x16x32_bf16 a[40:43], a[232:235], v[212:215], a[40:43]
    buffer_load_dwordx4 v5, s[12:15], s38 offen offset:128 lds
    v_mfma_f32_16x16x32_bf16 a[56:59], a[236:239], v[212:215], a[56:59]
    ds_read_b64_tr_b16 a[212:213], v11 offset:2048
    v_mfma_f32_16x16x32_bf16 a[72:75], a[240:243], v[212:215], a[72:75]
    ds_read_b64_tr_b16 a[214:215], v11 offset:8192
    v_mfma_f32_16x16x32_bf16 a[88:91], a[244:247], v[212:215], a[88:91]
    v_exp_f32 v55, v183
    v_mfma_f32_16x16x32_bf16 a[92:95], a[244:247], v[220:223], a[92:95]
    v_exp_f32 v48, v156
    v_mfma_f32_16x16x32_bf16 a[76:79], a[240:243], v[220:223], a[76:79]
    v_exp_f32 v49, v157
    v_mfma_f32_16x16x32_bf16 a[60:63], a[236:239], v[220:223], a[60:63]
    v_exp_f32 v50, v158
    v_mfma_f32_16x16x32_bf16 a[44:47], a[232:235], v[220:223], a[44:47]
    v_exp_f32 v51, v159
    v_mfma_f32_16x16x32_bf16 a[28:31], a[228:231], v[220:223], a[28:31]
    v_cvt_pk_bf16_f32 v247, v54, v55
    v_add_f32 v26, v26, v55
    v_mfma_f32_16x16x32_bf16 a[12:15], a[224:227], v[220:223], a[12:15]
    s_waitcnt lgkmcnt(0)
    v_exp_f32 v52, v188
    v_mfma_f32_16x16x32_bf16 a[108:111], a[192:195], v[220:223], a[108:111]
    ds_read_b128 a[224:227], v16 offset:12288
    v_cvt_pk_bf16_f32 v252, v48, v49
    v_mfma_f32_16x16x32_bf16 a[124:127], a[196:199], v[220:223], a[124:127]
    s_add_u32 m0, s41, 4864
    v_exp_f32 v53, v189
    v_mfma_f32_16x16x32_bf16 a[140:143], a[200:203], v[220:223], a[140:143]
    buffer_load_dwordx4 v5, s[12:15], s38 offen offset:256 lds
    v_mfma_f32_16x16x32_bf16 a[156:159], a[204:207], v[220:223], a[156:159]
    ds_read_b128 a[228:231], v17 offset:12288
    v_add_f32 v27, v48, v49
    v_mfma_f32_16x16x32_bf16 a[172:175], a[208:211], v[220:223], a[172:175]
    s_add_u32 s38, s38, s39
    v_exp_f32 v54, v190
    v_mfma_f32_16x16x32_bf16 a[188:191], a[212:215], v[220:223], a[188:191]
    v_add_f32 v27, v27, v50
    v_cvt_pk_bf16_f32 v253, v50, v51
    v_mfma_f32_16x16x32_bf16 a[184:187], a[212:215], v[212:215], a[184:187]
    ds_read_b128 a[232:235], v16 offset:13312
    v_add_f32 v27, v27, v51
    v_mfma_f32_16x16x32_bf16 a[168:171], a[208:211], v[212:215], a[168:171]
    v_exp_f32 v55, v191
    v_mfma_f32_16x16x32_bf16 a[152:155], a[204:207], v[212:215], a[152:155]
    v_add_f32 v27, v27, v52
    v_mfma_f32_16x16x32_bf16 a[136:139], a[200:203], v[212:215], a[136:139]
    ds_read_b128 a[236:239], v17 offset:13312
    v_cvt_pk_bf16_f32 v254, v52, v53
    v_mfma_f32_16x16x32_bf16 a[120:123], a[196:199], v[212:215], a[120:123]
    v_add_f32 v27, v27, v53
    v_mfma_f32_16x16x32_bf16 a[104:107], a[192:195], v[212:215], a[104:107]
    v_add_f32 v27, v27, v54
    v_mfma_f32_16x16x32_bf16 a[100:103], a[192:195], v[204:207], a[100:103]
    ds_read_b128 a[240:243], v16 offset:14336
    v_cvt_pk_bf16_f32 v255, v54, v55
    v_mfma_f32_16x16x32_bf16 a[116:119], a[196:199], v[204:207], a[116:119]
    v_add_f32 v27, v27, v55
    v_mfma_f32_16x16x32_bf16 a[132:135], a[200:203], v[204:207], a[132:135]
    v_max3_f32 v29, v24, v25, v26
    v_mfma_f32_16x16x32_bf16 a[148:151], a[204:207], v[204:207], a[148:151]
    s_add_u32 m0, s43, 73728
    ds_read_b128 a[244:247], v17 offset:14336
    v_max_f32 v29, v29, v27
    v_mfma_f32_16x16x32_bf16 a[164:167], a[208:211], v[204:207], a[164:167]
    buffer_load_dwordx4 v6, s[16:19], s40 offen offset:0 lds
    v_mfma_f32_16x16x32_bf16 a[180:183], a[212:215], v[204:207], a[180:183]
    v_cmp_nle_f32 vcc, v29, v30
    v_mfma_f32_16x16x32_bf16 a[176:179], a[212:215], v[196:199], a[176:179]
    v_mfma_f32_16x16x32_bf16 a[160:163], a[208:211], v[196:199], a[160:163]
    v_mfma_f32_16x16x32_bf16 a[144:147], a[204:207], v[196:199], a[144:147]
    v_mfma_f32_16x16x32_bf16 a[128:131], a[200:203], v[196:199], a[128:131]
    v_mfma_f32_16x16x32_bf16 a[112:115], a[196:199], v[196:199], a[112:115]
    v_mfma_f32_16x16x32_bf16 a[96:99], a[192:195], v[196:199], a[96:99]
    s_waitcnt lgkmcnt(0)
    s_cbranch_vccnz rare_a
rare_a_ret:
    v_mfma_f32_16x16x32_bf16 v[132:135], a[224:227], v[64:67], v[32:35]
    ds_read_b128 a[192:195], v16 offset:18432
    v_add_f32 v20, v20, v24
    v_mfma_f32_16x16x32_bf16 v[132:135], a[228:231], v[96:99], v[132:135]
    v_add_f32 v21, v21, v25
    v_add_f32 v22, v22, v26
    v_mfma_f32_16x16x32_bf16 v[132:135], a[232:235], v[128:131], v[132:135]
    v_add_f32 v23, v23, v27
    v_mfma_f32_16x16x32_bf16 v[132:135], a[236:239], v[160:163], v[132:135]
    ds_read_b128 a[196:199], v17 offset:18432
    v_mfma_f32_16x16x32_bf16 v[132:135], a[240:243], v[192:195], v[132:135]
    v_exp_f32 v48, v68
    v_mfma_f32_16x16x32_bf16 v[132:135], a[244:247], v[224:227], v[132:135]
    s_add_u32 m0, s43, 74624
    v_exp_f32 v49, v69
    v_mfma_f32_16x16x32_bf16 v[140:143], a[244:247], v[232:235], v[36:39]
    ds_read_b128 a[200:203], v16 offset:19456
    v_cvt_pk_bf16_f32 v196, v48, v49
    v_mfma_f32_16x16x32_bf16 v[140:143], a[240:243], v[200:203], v[140:143]
    buffer_load_dwordx4 v6, s[16:19], s40 offen offset:128 lds
    v_mfma_f32_16x16x32_bf16 v[140:143], a[236:239], v[168:171], v[140:143]
    v_exp_f32 v50, v70
    v_mfma_f32_16x16x32_bf16 v[140:143], a[232:235], v[136:139], v[140:143]
    ds_read_b128 a[204:207], v17 offset:19456
    v_add_f32 v24, v48, v49
    v_mfma_f32_16x16x32_bf16 v[140:143], a[228:231], v[104:107], v[140:143]
    v_exp_f32 v51, v71
    v_mfma_f32_16x16x32_bf16 v[140:143], a[224:227], v[72:75], v[140:143]
    v_exp_f32 v52, v100
    v_mfma_f32_16x16x32_bf16 v[148:151], a[224:227], v[80:83], v[40:43]
    ds_read_b128 a[208:211], v16 offset:20480
    v_add_f32 v24, v24, v50
    v_mfma_f32_16x16x32_bf16 v[148:151], a[228:231], v[112:115], v[148:151]
    v_exp_f32 v53, v101
    v_mfma_f32_16x16x32_bf16 v[148:151], a[232:235], v[144:147], v[148:151]
    v_exp_f32 v54, v102
    v_mfma_f32_16x16x32_bf16 v[148:151], a[236:239], v[176:179], v[148:151]
    ds_read_b128 a[212:215], v17 offset:20480
    v_cvt_pk_bf16_f32 v197, v50, v51
    v_mfma_f32_16x16x32_bf16 v[148:151], a[240:243], v[208:211], v[148:151]
    v_exp_f32 v55, v103
    v_mfma_f32_16x16x32_bf16 v[148:151], a[244:247], v[240:243], v[148:151]
    v_add_f32 v24, v24, v51
    v_add_f32 v24, v24, v52
    v_mfma_f32_16x16x32_bf16 v[156:159], a[244:247], v[248:251], v[44:47]
    v_exp_f32 v48, v76
    v_mfma_f32_16x16x32_bf16 v[156:159], a[240:243], v[216:219], v[156:159]
    s_add_u32 m0, s43, 75520
    v_exp_f32 v49, v77
    v_mfma_f32_16x16x32_bf16 v[156:159], a[236:239], v[184:187], v[156:159]
    buffer_load_dwordx4 v6, s[16:19], s40 offen offset:256 lds
    v_mfma_f32_16x16x32_bf16 v[156:159], a[232:235], v[152:155], v[156:159]
    v_cvt_pk_bf16_f32 v198, v52, v53
    v_add_f32 v24, v24, v53
    v_mfma_f32_16x16x32_bf16 v[156:159], a[228:231], v[120:123], v[156:159]
    v_exp_f32 v50, v78
    v_mfma_f32_16x16x32_bf16 v[156:159], a[224:227], v[88:91], v[156:159]
    s_waitcnt lgkmcnt(0)
    v_add_f32 v24, v24, v54
    v_cvt_pk_bf16_f32 v199, v54, v55
    v_mfma_f32_16x16x32_bf16 v[188:191], a[192:195], v[88:91], v[44:47]
    ds_read_b64_tr_b16 a[224:225], v8 offset:12288
    v_add_f32 v24, v24, v55
    v_mfma_f32_16x16x32_bf16 v[188:191], a[196:199], v[120:123], v[188:191]
    ds_read_b64_tr_b16 a[226:227], v8 offset:18432
    v_cvt_pk_bf16_f32 v204, v48, v49
    v_mfma_f32_16x16x32_bf16 v[188:191], a[200:203], v[152:155], v[188:191]
    v_exp_f32 v51, v79
    v_mfma_f32_16x16x32_bf16 v[188:191], a[204:207], v[184:187], v[188:191]
    ds_read_b64_tr_b16 a[228:229], v9 offset:12288
    v_add_f32 v25, v48, v49
    v_mfma_f32_16x16x32_bf16 v[188:191], a[208:211], v[216:219], v[188:191]
    ds_read_b64_tr_b16 a[230:231], v9 offset:18432
    v_add_f32 v25, v25, v50
    v_mfma_f32_16x16x32_bf16 v[188:191], a[212:215], v[248:251], v[188:191]
    v_exp_f32 v52, v108
    v_mfma_f32_16x16x32_bf16 v[180:183], a[212:215], v[240:243], v[40:43]
    ds_read_b64_tr_b16 a[232:233], v10 offset:12288
    v_cvt_pk_bf16_f32 v205, v50, v51
    v_mfma_f32_16x16x32_bf16 v[180:183], a[208:211], v[208:211], v[180:183]
    ds_read_b64_tr_b16 a[234:235], v10 offset:18432
    v_add_f32 v25, v25, v51
    v_mfma_f32_16x16x32_bf16 v[180:183], a[204:207], v[176:179], v[180:183]
    v_exp_f32 v53, v109
    v_mfma_f32_16x16x32_bf16 v[180:183], a[200:203], v[144:147], v[180:183]
    s_add_u32 m0, s43, 76800
    ds_read_b64_tr_b16 a[236:237], v11 offset:12288
    v_add_f32 v25, v25, v52
    v_mfma_f32_16x16x32_bf16 v[180:183], a[196:199], v[112:115], v[180:183]
    ds_read_b64_tr_b16 a[238:239], v11 offset:18432
    v_cvt_pk_bf16_f32 v206, v52, v53
    v_mfma_f32_16x16x32_bf16 v[180:183], a[192:195], v[80:83], v[180:183]
    buffer_load_dwordx4 v7, s[16:19], s40 offen offset:0 lds
    v_mfma_f32_16x16x32_bf16 v[172:175], a[192:195], v[72:75], v[36:39]
    ds_read_b64_tr_b16 a[240:241], v8 offset:13312
    v_add_f32 v25, v25, v53
    v_mfma_f32_16x16x32_bf16 v[172:175], a[196:199], v[104:107], v[172:175]
    ds_read_b64_tr_b16 a[242:243], v8 offset:19456
    v_add_u32 v16, s43, v18
    v_mfma_f32_16x16x32_bf16 v[172:175], a[200:203], v[136:139], v[172:175]
    v_exp_f32 v54, v110
    v_mfma_f32_16x16x32_bf16 v[172:175], a[204:207], v[168:171], v[172:175]
    ds_read_b64_tr_b16 a[244:245], v9 offset:13312
    v_add_f32 v25, v25, v54
    v_mfma_f32_16x16x32_bf16 v[172:175], a[208:211], v[200:203], v[172:175]
    ds_read_b64_tr_b16 a[246:247], v9 offset:19456
    v_add_u32 v17, s43, v19
    v_mfma_f32_16x16x32_bf16 v[172:175], a[212:215], v[232:235], v[172:175]
    v_exp_f32 v55, v111
    v_mfma_f32_16x16x32_bf16 v[164:167], a[212:215], v[224:227], v[32:35]
    v_exp_f32 v48, v84
    v_mfma_f32_16x16x32_bf16 v[164:167], a[208:211], v[192:195], v[164:167]
    v_exp_f32 v49, v85
    v_mfma_f32_16x16x32_bf16 v[164:167], a[204:207], v[160:163], v[164:167]
    v_exp_f32 v50, v86
    v_mfma_f32_16x16x32_bf16 v[164:167], a[200:203], v[128:131], v[164:167]
    v_exp_f32 v51, v87
    v_mfma_f32_16x16x32_bf16 v[164:167], a[196:199], v[96:99], v[164:167]
    v_cvt_pk_bf16_f32 v207, v54, v55
    v_add_f32 v25, v25, v55
    v_mfma_f32_16x16x32_bf16 v[164:167], a[192:195], v[64:67], v[164:167]
    s_waitcnt lgkmcnt(0)
    v_exp_f32 v52, v116
    v_mfma_f32_16x16x32_bf16 a[0:3], a[224:227], v[228:231], a[0:3]
    s_add_u32 m0, s43, 77696
    ds_read_b64_tr_b16 a[192:193], v10 offset:13312
    v_cvt_pk_bf16_f32 v212, v48, v49
    v_mfma_f32_16x16x32_bf16 a[16:19], a[228:231], v[228:231], a[16:19]
    ds_read_b64_tr_b16 a[194:195], v10 offset:19456
    v_add_f32 v26, v48, v49
    v_mfma_f32_16x16x32_bf16 a[32:35], a[232:235], v[228:231], a[32:35]
    buffer_load_dwordx4 v7, s[16:19], s40 offen offset:128 lds
    v_mfma_f32_16x16x32_bf16 a[48:51], a[236:239], v[228:231], a[48:51]
    ds_read_b64_tr_b16 a[196:197], v11 offset:13312
    v_add_f32 v26, v26, v50
    v_mfma_f32_16x16x32_bf16 a[64:67], a[240:243], v[228:231], a[64:67]
    ds_read_b64_tr_b16 a[198:199], v11 offset:19456
    v_cvt_pk_bf16_f32 v213, v50, v51
    v_mfma_f32_16x16x32_bf16 a[80:83], a[244:247], v[228:231], a[80:83]
    v_exp_f32 v53, v117
    v_mfma_f32_16x16x32_bf16 a[84:87], a[244:247], v[236:239], a[84:87]
    ds_read_b64_tr_b16 a[200:201], v8 offset:14336
    v_add_f32 v26, v26, v51
    v_mfma_f32_16x16x32_bf16 a[68:71], a[240:243], v[236:239], a[68:71]
    ds_read_b64_tr_b16 a[202:203], v8 offset:20480
    v_add_f32 v26, v26, v52
    v_mfma_f32_16x16x32_bf16 a[52:55], a[236:239], v[236:239], a[52:55]
    v_exp_f32 v54, v118
    v_mfma_f32_16x16x32_bf16 a[36:39], a[232:235], v[236:239], a[36:39]
    ds_read_b64_tr_b16 a[204:205], v9 offset:14336
    v_cvt_pk_bf16_f32 v214, v52, v53
    v_mfma_f32_16x16x32_bf16 a[20:23], a[228:231], v[236:239], a[20:23]
    ds_read_b64_tr_b16 a[206:207], v9 offset:20480
    v_add_f32 v26, v26, v53
    v_mfma_f32_16x16x32_bf16 a[4:7], a[224:227], v[236:239], a[4:7]
    v_exp_f32 v55, v119
    v_mfma_f32_16x16x32_bf16 a[8:11], a[224:227], v[244:247], a[8:11]
    ds_read_b64_tr_b16 a[208:209], v10 offset:14336
    v_add_f32 v26, v26, v54
    v_mfma_f32_16x16x32_bf16 a[24:27], a[228:231], v[244:247], a[24:27]
    s_add_u32 m0, s43, 78592
    ds_read_b64_tr_b16 a[210:211], v10 offset:20480
    v_cvt_pk_bf16_f32 v215, v54, v55
    v_mfma_f32_16x16x32_bf16 a[40:43], a[232:235], v[244:247], a[40:43]
    buffer_load_dwordx4 v7, s[16:19], s40 offen offset:256 lds
    v_mfma_f32_16x16x32_bf16 a[56:59], a[236:239], v[244:247], a[56:59]
    ds_read_b64_tr_b16 a[212:213], v11 offset:14336
    v_add_f32 v26, v26, v55
    v_mfma_f32_16x16x32_bf16 a[72:75], a[240:243], v[244:247], a[72:75]
    s_add_u32 s40, s40, 24576
    ds_read_b64_tr_b16 a[214:215], v11 offset:20480
    v_max3_f32 v29, v24, v25, v26
    v_mfma_f32_16x16x32_bf16 a[88:91], a[244:247], v[244:247], a[88:91]
    v_exp_f32 v48, v92
    v_mfma_f32_16x16x32_bf16 a[92:95], a[244:247], v[252:255], a[92:95]
    v_exp_f32 v49, v93
    v_mfma_f32_16x16x32_bf16 a[76:79], a[240:243], v[252:255], a[76:79]
    v_exp_f32 v50, v94
    v_mfma_f32_16x16x32_bf16 a[60:63], a[236:239], v[252:255], a[60:63]
    v_exp_f32 v51, v95
    v_mfma_f32_16x16x32_bf16 a[44:47], a[232:235], v[252:255], a[44:47]
    s_waitcnt vmcnt(12)
    v_exp_f32 v52, v124
    v_mfma_f32_16x16x32_bf16 a[28:31], a[228:231], v[252:255], a[28:31]
    s_barrier
    v_mfma_f32_16x16x32_bf16 a[12:15], a[224:227], v[252:255], a[12:15]
    s_waitcnt lgkmcnt(0)
    v_exp_f32 v53, v125
    v_mfma_f32_16x16x32_bf16 a[108:111], a[192:195], v[252:255], a[108:111]
    ds_read_b128 a[224:227], v16 offset:0
    v_cvt_pk_bf16_f32 v220, v48, v49
    v_mfma_f32_16x16x32_bf16 a[124:127], a[196:199], v[252:255], a[124:127]
    v_add_f32 v27, v48, v49
    v_mfma_f32_16x16x32_bf16 a[140:143], a[200:203], v[252:255], a[140:143]
    v_exp_f32 v54, v126
    v_mfma_f32_16x16x32_bf16 a[156:159], a[204:207], v[252:255], a[156:159]
    ds_read_b128 a[228:231], v17 offset:0
    v_add_f32 v27, v27, v50
    v_mfma_f32_16x16x32_bf16 a[172:175], a[208:211], v[252:255], a[172:175]
    v_exp_f32 v55, v127
    v_mfma_f32_16x16x32_bf16 a[188:191], a[212:215], v[252:255], a[188:191]
    v_cvt_pk_bf16_f32 v221, v50, v51
    v_add_f32 v27, v27, v51
    v_mfma_f32_16x16x32_bf16 a[184:187], a[212:215], v[244:247], a[184:187]
    ds_read_b128 a[232:235], v16 offset:1024
    v_add_f32 v27, v27, v52
    v_mfma_f32_16x16x32_bf16 a[168:171], a[208:211], v[244:247], a[168:171]
    v_cvt_pk_bf16_f32 v222, v52, v53
    v_mfma_f32_16x16x32_bf16 a[152:155], a[204:207], v[244:247], a[152:155]
    v_add_f32 v27, v27, v53
    v_mfma_f32_16x16x32_bf16 a[136:139], a[200:203], v[244:247], a[136:139]
    ds_read_b128 a[236:239], v17 offset:1024
    v_add_f32 v27, v27, v54
    v_mfma_f32_16x16x32_bf16 a[120:123], a[196:199], v[244:247], a[120:123]
    buffer_load_dword a216, v2, s[28:31], s6 offen
    v_mfma_f32_16x16x32_bf16 a[104:107], a[192:195], v[244:247], a[104:107]
    s_add_u32 s6, s6, 1536
    v_cvt_pk_bf16_f32 v223, v54, v55
    v_mfma_f32_16x16x32_bf16 a[100:103], a[192:195], v[236:239], a[100:103]
    s_mov_b32 s44, s41
    ds_read_b128 a[240:243], v16 offset:2048
    v_add_f32 v27, v27, v55
    v_mfma_f32_16x16x32_bf16 a[116:119], a[196:199], v[236:239], a[116:119]
    s_mov_b32 s41, s42
    v_max_f32 v29, v29, v27
    v_mfma_f32_16x16x32_bf16 a[132:135], a[200:203], v[236:239], a[132:135]
    s_mov_b32 s42, s43
    v_cmp_nle_f32 vcc, v29, v30
    s_mov_b32 s43, s44
    v_mfma_f32_16x16x32_bf16 a[148:151], a[204:207], v[236:239], a[148:151]
    s_sub_u32 s45, s45, 1
    ds_read_b128 a[244:247], v17 offset:2048
    v_mfma_f32_16x16x32_bf16 a[164:167], a[208:211], v[236:239], a[164:167]
    v_mfma_f32_16x16x32_bf16 a[180:183], a[212:215], v[236:239], a[180:183]
    v_mfma_f32_16x16x32_bf16 a[176:179], a[212:215], v[228:231], a[176:179]
    v_mfma_f32_16x16x32_bf16 a[160:163], a[208:211], v[228:231], a[160:163]
    v_mfma_f32_16x16x32_bf16 a[144:147], a[204:207], v[228:231], a[144:147]
    v_mfma_f32_16x16x32_bf16 a[128:131], a[200:203], v[228:231], a[128:131]
    v_mfma_f32_16x16x32_bf16 a[112:115], a[196:199], v[228:231], a[112:115]
    s_waitcnt lgkmcnt(0)
    v_mfma_f32_16x16x32_bf16 a[96:99], a[192:195], v[228:231], a[96:99]
    s_cbranch_vccnz rare_b
rare_b_ret:
    s_cbranch_scc0 at_loop
tail_code:
    v_add_u32 v8, s41, v12
    v_add_u32 v9, s41, v13
    v_add_u32 v10, s41, v14
    v_add_u32 v11, s41, v15
    v_mov_b32 v16, s7
    v_min_u32 v3, 2, v1
    v_lshlrev_b32 v17, 21, v3
    v_and_b32 v3, 2, v3
    v_lshl_or_b32 v17, v3, 29, v17
    s_waitcnt lgkmcnt(0)
    ds_read_b64_tr_b16 a[192:193], v8 offset:0
    ds_read_b64_tr_b16 a[194:195], v8 offset:6144
    ds_read_b64_tr_b16 a[196:197], v9 offset:0
    ds_read_b64_tr_b16 a[198:199], v9 offset:6144
    ds_read_b64_tr_b16 a[200:201], v10 offset:0
    ds_read_b64_tr_b16 a[202:203], v10 offset:6144
    ds_read_b64_tr_b16 a[204:205], v11 offset:0
    ds_read_b64_tr_b16 a[206:207], v11 offset:6144
    s_waitcnt lgkmcnt(4)
    v_mfma_f32_16x16x32_bf16 a[0:3], a[192:195], v[196:199], a[0:3]
    s_waitcnt vmcnt(26)
    ds_read_b64_tr_b16 a[208:209], v8 offset:1024
    v_cmp_ne_u32 vcc, s7, v61
    v_mfma_f32_16x16x32_bf16 a[16:19], a[196:199], v[196:199], a[16:19]
    s_and_b32 s59, s51, 1
    ds_read_b64_tr_b16 a[210:211], v8 offset:7168
    v_add_f32 v20, v20, v24
    v_mfma_f32_16x16x32_bf16 a[20:23], a[196:199], v[204:207], a[20:23]
    s_cbranch_vccnz spin_gu
spin_gu_ret:
    v_add_f32 v21, v21, v25
    v_mfma_f32_16x16x32_bf16 a[4:7], a[192:195], v[204:207], a[4:7]
    s_lshl_b32 s61, s47, 10
    v_add_f32 v22, v22, v26
    v_add_f32 v23, v23, v27
    v_mfma_f32_16x16x32_bf16 a[8:11], a[192:195], v[212:215], a[8:11]
    s_add_u32 s61, s61, 3276800
    ds_read_b64_tr_b16 a[212:213], v9 offset:1024
    s_add_u32 s56, s3, 0
    v_mfma_f32_16x16x32_bf16 a[24:27], a[196:199], v[212:215], a[24:27]
    s_min_u32 s56, s56, 9
    ds_read_b64_tr_b16 a[214:215], v9 offset:7168
    s_mul_i32 s57, s56, 24576
    v_mfma_f32_16x16x32_bf16 a[28:31], a[196:199], v[220:223], a[28:31]
    s_add_u32 s57, s57, s61
    v_exp_f32 v48, v132
    v_mfma_f32_16x16x32_bf16 a[12:15], a[192:195], v[220:223], a[12:15]
    s_waitcnt lgkmcnt(4)
    v_exp_f32 v49, v133
    v_mfma_f32_16x16x32_bf16 a[44:47], a[200:203], v[220:223], a[44:47]
    s_lshl_b32 s56, s56, 10
    ds_read_b64_tr_b16 a[192:193], v10 offset:1024
    v_cvt_pk_bf16_f32 v228, v48, v49
    v_mfma_f32_16x16x32_bf16 a[60:63], a[204:207], v[220:223], a[60:63]
    s_add_u32 m0, s56, 147456
    ds_read_b64_tr_b16 a[194:195], v10 offset:7168
    v_add_f32 v24, v48, v49
    v_mfma_f32_16x16x32_bf16 a[56:59], a[204:207], v[212:215], a[56:59]
    buffer_load_dwordx4 v28, s[24:27], s57 offen sc1 lds
    v_mfma_f32_16x16x32_bf16 a[40:43], a[200:203], v[212:215], a[40:43]
    s_add_u32 s56, s3, 4
    v_exp_f32 v50, v134
    v_mfma_f32_16x16x32_bf16 a[36:39], a[200:203], v[204:207], a[36:39]
    s_min_u32 s56, s56, 9
    ds_read_b64_tr_b16 a[196:197], v11 offset:1024
    v_add_f32 v24, v24, v50
    v_mfma_f32_16x16x32_bf16 a[52:55], a[204:207], v[204:207], a[52:55]
    s_mul_i32 s57, s56, 24576
    ds_read_b64_tr_b16 a[198:199], v11 offset:7168
    s_add_u32 s57, s57, s61
    v_mfma_f32_16x16x32_bf16 a[48:51], a[204:207], v[196:199], a[48:51]
    s_lshl_b32 s56, s56, 10
    v_exp_f32 v51, v135
    v_mfma_f32_16x16x32_bf16 a[32:35], a[200:203], v[196:199], a[32:35]
    s_waitcnt lgkmcnt(4)
    v_exp_f32 v52, v164
    v_mfma_f32_16x16x32_bf16 a[64:67], a[208:211], v[196:199], a[64:67]
    s_add_u32 m0, s56, 147456
    ds_read_b64_tr_b16 a[200:201], v8 offset:2048
    v_cvt_pk_bf16_f32 v229, v50, v51
    v_mfma_f32_16x16x32_bf16 a[80:83], a[212:215], v[196:199], a[80:83]
    s_lshl_b32 s60, s59, 10
    ds_read_b64_tr_b16 a[202:203], v8 offset:8192
    v_add_f32 v24, v24, v51
    v_mfma_f32_16x16x32_bf16 a[84:87], a[212:215], v[204:207], a[84:87]
    buffer_load_dwordx4 v28, s[24:27], s57 offen sc1 lds
    v_mfma_f32_16x16x32_bf16 a[68:71], a[208:211], v[204:207], a[68:71]
    s_add_u32 s56, s3, 8
    v_exp_f32 v53, v165
    v_mfma_f32_16x16x32_bf16 a[72:75], a[208:211], v[212:215], a[72:75]
    s_min_u32 s56, s56, 9
    ds_read_b64_tr_b16 a[204:205], v9 offset:2048
    v_add_f32 v24, v24, v52
    v_mfma_f32_16x16x32_bf16 a[88:91], a[212:215], v[212:215], a[88:91]
    s_mul_i32 s57, s56, 24576
    ds_read_b64_tr_b16 a[206:207], v9 offset:8192
    v_cvt_pk_bf16_f32 v230, v52, v53
    v_mfma_f32_16x16x32_bf16 a[92:95], a[212:215], v[220:223], a[92:95]
    s_add_u32 s57, s57, s61
    v_exp_f32 v54, v166
    v_mfma_f32_16x16x32_bf16 a[76:79], a[208:211], v[220:223], a[76:79]
    s_waitcnt lgkmcnt(4)
    v_exp_f32 v55, v167
    v_mfma_f32_16x16x32_bf16 a[108:111], a[192:195], v[220:223], a[108:111]
    s_lshl_b32 s56, s56, 10
    ds_read_b64_tr_b16 a[208:209], v10 offset:2048
    v_add_f32 v24, v24, v53
    v_mfma_f32_16x16x32_bf16 a[124:127], a[196:199], v[220:223], a[124:127]
    s_add_u32 m0, s56, 147456
    ds_read_b64_tr_b16 a[210:211], v10 offset:8192
    v_add_f32 v24, v24, v54
    v_mfma_f32_16x16x32_bf16 a[120:123], a[196:199], v[212:215], a[120:123]
    buffer_load_dwordx4 v28, s[24:27], s57 offen sc1 lds
    v_mfma_f32_16x16x32_bf16 a[104:107], a[192:195], v[212:215], a[104:107]
    s_lshl_b32 s59, s59, 6
    v_exp_f32 v48, v140
    v_mfma_f32_16x16x32_bf16 a[100:103], a[192:195], v[204:207], a[100:103]
    s_sub_u32 s44, s49, 73728
    ds_read_b64_tr_b16 a[212:213], v11 offset:2048
    v_add_u32 v12, s44, v12
    v_mfma_f32_16x16x32_bf16 a[116:119], a[196:199], v[204:207], a[116:119]
    ds_read_b64_tr_b16 a[214:215], v11 offset:8192
    v_xor_b32 v12, s59, v12
    v_mfma_f32_16x16x32_bf16 a[112:115], a[196:199], v[196:199], a[112:115]
    v_add_u32 v13, s44, v13
    v_xor_b32 v13, s59, v13
    v_mfma_f32_16x16x32_bf16 a[96:99], a[192:195], v[196:199], a[96:99]
    s_waitcnt lgkmcnt(4)
    v_add_u32 v14, s44, v14
    v_xor_b32 v14, s59, v14
    v_mfma_f32_16x16x32_bf16 a[128:131], a[200:203], v[196:199], a[128:131]
    ds_read_b64_tr_b16 a[192:193], v8 offset:12288
    v_add_u32 v15, s44, v15
    v_mfma_f32_16x16x32_bf16 a[144:147], a[204:207], v[196:199], a[144:147]
    ds_read_b64_tr_b16 a[194:195], v8 offset:18432
    v_xor_b32 v15, s59, v15
    v_mfma_f32_16x16x32_bf16 a[148:151], a[204:207], v[204:207], a[148:151]
    v_add_u32 v14, s60, v14
    v_add_u32 v15, s60, v15
    v_mfma_f32_16x16x32_bf16 a[132:135], a[200:203], v[204:207], a[132:135]
    s_mov_b32 s39, s59
    v_exp_f32 v49, v141
    v_mfma_f32_16x16x32_bf16 a[136:139], a[200:203], v[212:215], a[136:139]
    s_and_b32 s59, s3, 1
    ds_read_b64_tr_b16 a[196:197], v9 offset:12288
    v_cvt_pk_bf16_f32 v231, v54, v55
    v_mfma_f32_16x16x32_bf16 a[152:155], a[204:207], v[212:215], a[152:155]
    s_mul_i32 s59, s59, 20480
    ds_read_b64_tr_b16 a[198:199], v9 offset:18432
    v_add_f32 v24, v24, v55
    v_mfma_f32_16x16x32_bf16 a[156:159], a[204:207], v[220:223], a[156:159]
    s_lshl_b32 s36, s3, 10
    v_exp_f32 v50, v142
    v_mfma_f32_16x16x32_bf16 a[140:143], a[200:203], v[220:223], a[140:143]
    s_waitcnt lgkmcnt(4)
    v_exp_f32 v51, v143
    v_mfma_f32_16x16x32_bf16 a[172:175], a[208:211], v[220:223], a[172:175]
    s_add_u32 s60, s51, 0
    ds_read_b64_tr_b16 a[200:201], v10 offset:12288
    v_cvt_pk_bf16_f32 v236, v48, v49
    v_mfma_f32_16x16x32_bf16 a[188:191], a[212:215], v[220:223], a[188:191]
    s_and_b32 s60, s60, 3
    ds_read_b64_tr_b16 a[202:203], v10 offset:18432
    v_add_f32 v25, v48, v49
    v_mfma_f32_16x16x32_bf16 a[184:187], a[212:215], v[212:215], a[184:187]
    s_mul_i32 s60, s60, 245760
    v_exp_f32 v52, v172
    v_mfma_f32_16x16x32_bf16 a[168:171], a[208:211], v[212:215], a[168:171]
    s_add_u32 s32, s60, s59
    v_exp_f32 v53, v173
    v_mfma_f32_16x16x32_bf16 a[164:167], a[208:211], v[204:207], a[164:167]
    s_add_u32 s60, s51, 1
    ds_read_b64_tr_b16 a[204:205], v11 offset:12288
    v_add_f32 v25, v25, v50
    v_mfma_f32_16x16x32_bf16 a[180:183], a[212:215], v[204:207], a[180:183]
    s_and_b32 s60, s60, 3
    ds_read_b64_tr_b16 a[206:207], v11 offset:18432
    v_cvt_pk_bf16_f32 v237, v50, v51
    v_mfma_f32_16x16x32_bf16 a[176:179], a[212:215], v[196:199], a[176:179]
    s_mul_i32 s60, s60, 245760
    v_exp_f32 v54, v174
    v_mfma_f32_16x16x32_bf16 a[160:163], a[208:211], v[196:199], a[160:163]
    s_waitcnt lgkmcnt(4)
    v_exp_f32 v55, v175
    v_cvt_pk_bf16_f32 v238, v52, v53
    v_cvt_pk_bf16_f32 v239, v54, v55
    v_add_f32 v25, v25, v51
    v_add_f32 v25, v25, v52
    v_add_f32 v25, v25, v53
    v_add_f32 v25, v25, v54
    v_add_f32 v25, v25, v55
    v_exp_f32 v48, v148
    v_exp_f32 v49, v149
    s_add_u32 s33, s60, s59
    v_cvt_pk_bf16_f32 v244, v48, v49
    v_exp_f32 v50, v150
    v_exp_f32 v51, v151
    s_add_u32 s60, s51, 2
    v_cvt_pk_bf16_f32 v245, v50, v51
    v_exp_f32 v52, v180
    v_exp_f32 v53, v181
    s_and_b32 s60, s60, 3
    v_cvt_pk_bf16_f32 v246, v52, v53
    v_exp_f32 v54, v182
    v_exp_f32 v55, v183
    s_mul_i32 s60, s60, 245760
    v_cvt_pk_bf16_f32 v247, v54, v55
    v_add_f32 v26, v48, v49
    v_add_f32 v26, v26, v50
    v_add_f32 v26, v26, v51
    v_add_f32 v26, v26, v52
    v_add_f32 v26, v26, v53
    v_add_f32 v26, v26, v54
    v_add_f32 v26, v26, v55
    v_max3_f32 v29, v24, v25, v26
    v_exp_f32 v48, v156
    v_exp_f32 v49, v157
    s_add_u32 s34, s60, s59
    v_cvt_pk_bf16_f32 v252, v48, v49
    v_exp_f32 v50, v158
    v_exp_f32 v51, v159
    s_add_u32 s60, s51, 3
    v_cvt_pk_bf16_f32 v253, v50, v51
    v_exp_f32 v52, v188
    v_exp_f32 v53, v189
    s_and_b32 s60, s60, 3
    v_cvt_pk_bf16_f32 v254, v52, v53
    v_exp_f32 v54, v190
    v_exp_f32 v55, v191
    s_mul_i32 s60, s60, 245760
    v_cvt_pk_bf16_f32 v255, v54, v55
    v_add_f32 v27, v48, v49
    v_add_f32 v27, v27, v50
    v_add_f32 v27, v27, v51
    v_add_f32 v27, v27, v52
    v_add_f32 v27, v27, v53
    v_add_f32 v27, v27, v54
    v_add_f32 v27, v27, v55
    v_max_f32 v29, v29, v27
    v_cmp_nle_f32 vcc, v29, v30
    s_cbranch_vccnz rare_e
rare_e_ret:
    v_mfma_f32_16x16x32_bf16 a[0:3], a[192:195], v[228:231], a[0:3]
    s_add_u32 s35, s60, s59
    ds_read_b64_tr_b16 a[208:209], v8 offset:13312
    v_add_f32 v20, v20, v24
    v_mfma_f32_16x16x32_bf16 a[16:19], a[196:199], v[228:231], a[16:19]
    s_add_u32 s38, s32, 163840
    ds_read_b64_tr_b16 a[210:211], v8 offset:19456
    v_add_f32 v21, v21, v25
    v_mfma_f32_16x16x32_bf16 a[20:23], a[196:199], v[236:239], a[20:23]
    s_add_u32 s57, s32, 204800
    v_add_f32 v22, v22, v26
    v_add_f32 v23, v23, v27
    v_mfma_f32_16x16x32_bf16 a[4:7], a[192:195], v[236:239], a[4:7]
    s_cmp_lt_u32 s3, 2
    s_cselect_b32 s38, s38, s57
    v_mov_b32 v56, v20
    v_mfma_f32_16x16x32_bf16 a[8:11], a[192:195], v[244:247], a[8:11]
    s_add_u32 m0, s49, 122880
    ds_read_b64_tr_b16 a[212:213], v9 offset:13312
    v_mov_b32 v57, v21
    v_mfma_f32_16x16x32_bf16 a[24:27], a[196:199], v[244:247], a[24:27]
    ds_read_b64_tr_b16 a[214:215], v9 offset:19456
    v_mov_b32 v58, v22
    v_mfma_f32_16x16x32_bf16 a[28:31], a[196:199], v[252:255], a[28:31]
    buffer_load_dwordx4 v4, s[12:15], s38 offen offset:0 lds
    v_mfma_f32_16x16x32_bf16 a[12:15], a[192:195], v[252:255], a[12:15]
    s_waitcnt lgkmcnt(4)
    v_permlane16_swap_b32 v20, v56
    v_mfma_f32_16x16x32_bf16 a[44:47], a[200:203], v[252:255], a[44:47]
    s_add_u32 m0, s49, 123776
    ds_read_b64_tr_b16 a[192:193], v10 offset:13312
    v_add_f32 v20, v20, v56
    v_mfma_f32_16x16x32_bf16 a[60:63], a[204:207], v[252:255], a[60:63]
    ds_read_b64_tr_b16 a[194:195], v10 offset:19456
    v_mov_b32 v56, v20
    v_mfma_f32_16x16x32_bf16 a[56:59], a[204:207], v[244:247], a[56:59]
    buffer_load_dwordx4 v4, s[12:15], s38 offen offset:128 lds
    v_mfma_f32_16x16x32_bf16 a[40:43], a[200:203], v[244:247], a[40:43]
    s_add_u32 m0, s49, 124672
    v_permlane32_swap_b32 v20, v56
    v_mfma_f32_16x16x32_bf16 a[36:39], a[200:203], v[236:239], a[36:39]
    s_lshl_b32 s11, s54, 16
    ds_read_b64_tr_b16 a[196:197], v11 offset:13312
    v_add_f32 v20, v20, v56
    v_mfma_f32_16x16x32_bf16 a[52:55], a[204:207], v[236:239], a[52:55]
    s_and_b32 s72, s3, 1
    ds_read_b64_tr_b16 a[198:199], v11 offset:19456
    v_mov_b32 v59, v23
    v_mfma_f32_16x16x32_bf16 a[48:51], a[204:207], v[228:231], a[48:51]
    buffer_load_dwordx4 v4, s[12:15], s38 offen offset:256 lds
    v_mfma_f32_16x16x32_bf16 a[32:35], a[200:203], v[228:231], a[32:35]
    s_waitcnt lgkmcnt(4)
    v_rcp_f32 v20, v20
    v_mfma_f32_16x16x32_bf16 a[64:67], a[208:211], v[228:231], a[64:67]
    s_add_u32 m0, s49, 125952
    ds_read_b64_tr_b16 a[200:201], v8 offset:14336
    v_accvgpr_read_b32 v64, a0
    v_mfma_f32_16x16x32_bf16 a[80:83], a[212:215], v[228:231], a[80:83]
    s_lshl_b32 s72, s72, 14
    ds_read_b64_tr_b16 a[202:203], v8 offset:20480
    v_accvgpr_read_b32 v65, a1
    v_mfma_f32_16x16x32_bf16 a[84:87], a[212:215], v[236:239], a[84:87]
pg_7:
    s_cbranch_execz pg_11
    buffer_load_dwordx4 v5, s[12:15], s38 offen offset:0 lds
    v_mfma_f32_16x16x32_bf16 a[68:71], a[208:211], v[236:239], a[68:71]
    s_add_u32 m0, s49, 126848
    v_permlane16_swap_b32 v21, v57
    v_mfma_f32_16x16x32_bf16 a[72:75], a[208:211], v[244:247], a[72:75]
    s_or_b32 s11, s11, s72
    ds_read_b64_tr_b16 a[204:205], v9 offset:14336
    v_add_f32 v21, v21, v57
    v_mfma_f32_16x16x32_bf16 a[88:91], a[212:215], v[244:247], a[88:91]
    s_lshr_b32 s73, s93, 8
    ds_read_b64_tr_b16 a[206:207], v9 offset:20480
    v_mov_b32 v57, v21
    v_mfma_f32_16x16x32_bf16 a[92:95], a[212:215], v[252:255], a[92:95]
    buffer_load_dwordx4 v5, s[12:15], s38 offen offset:128 lds
    v_mfma_f32_16x16x32_bf16 a[76:79], a[208:211], v[252:255], a[76:79]
    s_waitcnt lgkmcnt(4)
    v_permlane32_swap_b32 v21, v57
    v_mfma_f32_16x16x32_bf16 a[108:111], a[192:195], v[252:255], a[108:111]
    s_add_u32 m0, s49, 127744
    ds_read_b64_tr_b16 a[208:209], v10 offset:14336
    v_add_f32 v21, v21, v57
    v_mfma_f32_16x16x32_bf16 a[124:127], a[196:199], v[252:255], a[124:127]
    s_add_u32 s8, s51, 1
    ds_read_b64_tr_b16 a[210:211], v10 offset:20480
    v_add_u32 v8, 49152, v12
    v_mfma_f32_16x16x32_bf16 a[120:123], a[196:199], v[244:247], a[120:123]
    buffer_load_dwordx4 v5, s[12:15], s38 offen offset:256 lds
    v_mfma_f32_16x16x32_bf16 a[104:107], a[192:195], v[244:247], a[104:107]
    s_add_u32 s38, s33, 0
    v_rcp_f32 v21, v21
    v_mfma_f32_16x16x32_bf16 a[100:103], a[192:195], v[236:239], a[100:103]
    s_add_u32 s57, s34, 0
    ds_read_b64_tr_b16 a[212:213], v11 offset:14336
    v_add_u32 v9, 49152, v13
    v_mfma_f32_16x16x32_bf16 a[116:119], a[196:199], v[236:239], a[116:119]
    s_waitcnt vmcnt(29)
    ds_read_b64_tr_b16 a[214:215], v11 offset:20480
    v_add_u32 v10, 49152, v14
    v_mfma_f32_16x16x32_bf16 a[112:115], a[196:199], v[228:231], a[112:115]
    s_barrier
    v_mfma_f32_16x16x32_bf16 a[96:99], a[192:195], v[228:231], a[96:99]
    s_waitcnt lgkmcnt(4)
    v_permlane16_swap_b32 v22, v58
    v_mfma_f32_16x16x32_bf16 a[128:131], a[200:203], v[228:231], a[128:131]
    s_cmp_lt_u32 s3, 2
    s_cselect_b32 s38, s38, s57
    ds_read_b64_tr_b16 a[192:193], v8 offset:0
    v_mfma_f32_16x16x32_bf16 a[144:147], a[204:207], v[228:231], a[144:147]
    s_add_u32 m0, s49, 24576
    ds_read_b64_tr_b16 a[194:195], v8 offset:6144
    v_add_f32 v22, v22, v58
    v_mfma_f32_16x16x32_bf16 a[148:151], a[204:207], v[236:239], a[148:151]
    buffer_load_dwordx4 v4, s[12:15], s38 offen offset:0 lds
    v_mfma_f32_16x16x32_bf16 a[132:135], a[200:203], v[236:239], a[132:135]
    s_add_u32 m0, s49, 25472
    v_permlane16_swap_b32 v23, v59
    v_mfma_f32_16x16x32_bf16 a[136:139], a[200:203], v[244:247], a[136:139]
    s_and_b32 s8, s8, 3
    ds_read_b64_tr_b16 a[196:197], v9 offset:0
    v_mov_b32 v58, v22
    v_mfma_f32_16x16x32_bf16 a[152:155], a[204:207], v[244:247], a[152:155]
    s_lshr_b32 s72, s73, s8
    ds_read_b64_tr_b16 a[198:199], v9 offset:6144
    v_add_f32 v23, v23, v59
    v_mfma_f32_16x16x32_bf16 a[156:159], a[204:207], v[252:255], a[156:159]
    buffer_load_dwordx4 v4, s[12:15], s38 offen offset:128 lds
    v_mfma_f32_16x16x32_bf16 a[140:143], a[200:203], v[252:255], a[140:143]
    s_waitcnt lgkmcnt(4)
    v_permlane32_swap_b32 v22, v58
    v_mfma_f32_16x16x32_bf16 a[172:175], a[208:211], v[252:255], a[172:175]
    s_add_u32 m0, s49, 26368
    ds_read_b64_tr_b16 a[200:201], v10 offset:0
    v_add_f32 v22, v22, v58
    v_mfma_f32_16x16x32_bf16 a[188:191], a[212:215], v[252:255], a[188:191]
    s_and_b32 s72, s72, 0x2000
    ds_read_b64_tr_b16 a[202:203], v10 offset:6144
    v_mov_b32 v59, v23
    v_mfma_f32_16x16x32_bf16 a[184:187], a[212:215], v[244:247], a[184:187]
    buffer_load_dwordx4 v4, s[12:15], s38 offen offset:256 lds
    v_mfma_f32_16x16x32_bf16 a[168:171], a[208:211], v[244:247], a[168:171]
    s_add_u32 m0, s49, 27648
    v_rcp_f32 v22, v22
    v_add_u32 v11, 49152, v15
    v_mfma_f32_16x16x32_bf16 a[164:167], a[208:211], v[236:239], a[164:167]
    s_mul_i32 s8, s8, 0x202000
    ds_read_b64_tr_b16 a[204:205], v11 offset:0
    v_accvgpr_read_b32 v66, a2
    v_mfma_f32_16x16x32_bf16 a[180:183], a[212:215], v[236:239], a[180:183]
    s_xor_b32 s8, s8, s72
    ds_read_b64_tr_b16 a[206:207], v11 offset:6144
    v_accvgpr_read_b32 v67, a3
    v_accvgpr_read_b32 v24, a18
    v_mul_f32 v24, v20, v24
    v_accvgpr_read_b32 v25, a19
    v_mul_f32 v25, v20, v25
    v_mul_f32 v66, v20, v66
    v_mul_f32 v67, v20, v67
    v_mul_f32 v64, v20, v64
    v_mul_f32 v65, v20, v65
    v_cvt_pk_bf16_f32 v64, v64, v65
    v_cvt_pk_bf16_f32 v65, v66, v67
    v_accvgpr_read_b32 v66, a16
    v_mul_f32 v66, v20, v66
    v_accvgpr_read_b32 v67, a17
    v_mul_f32 v67, v20, v67
    v_cvt_pk_bf16_f32 v66, v66, v67
    v_cvt_pk_bf16_f32 v67, v24, v25
    v_accvgpr_read_b32 v26, a22
    v_mul_f32 v26, v21, v26
    v_accvgpr_read_b32 v27, a23
    v_mul_f32 v27, v21, v27
    v_accvgpr_read_b32 v74, a6
    v_mul_f32 v74, v21, v74
    v_accvgpr_read_b32 v75, a7
    v_mul_f32 v75, v21, v75
    v_accvgpr_read_b32 v72, a4
    v_mul_f32 v72, v21, v72
    v_accvgpr_read_b32 v73, a5
    v_mul_f32 v73, v21, v73
    v_cvt_pk_bf16_f32 v72, v72, v73
    v_cvt_pk_bf16_f32 v73, v74, v75
    v_accvgpr_read_b32 v74, a20
    v_mul_f32 v74, v21, v74
    v_accvgpr_read_b32 v75, a21
    v_mul_f32 v75, v21, v75
    v_cvt_pk_bf16_f32 v74, v74, v75
    v_cvt_pk_bf16_f32 v75, v26, v27
    v_accvgpr_read_b32 v30, a26
    v_mul_f32 v30, v22, v30
    v_accvgpr_read_b32 v31, a27
    v_mul_f32 v31, v22, v31
    v_accvgpr_read_b32 v82, a10
    v_mul_f32 v82, v22, v82
    v_accvgpr_read_b32 v83, a11
    v_mul_f32 v83, v22, v83
    v_accvgpr_read_b32 v80, a8
    v_mul_f32 v80, v22, v80
    v_accvgpr_read_b32 v81, a9
    v_mul_f32 v81, v22, v81
    v_cvt_pk_bf16_f32 v80, v80, v81
    v_cvt_pk_bf16_f32 v81, v82, v83
    v_accvgpr_read_b32 v82, a24
    v_mul_f32 v82, v22, v82
    v_accvgpr_read_b32 v83, a25
    v_mul_f32 v83, v22, v83
    v_cvt_pk_bf16_f32 v82, v82, v83
    v_cvt_pk_bf16_f32 v83, v30, v31
    v_permlane32_swap_b32 v23, v59
    s_and_b32 s8, s8, 6299648
    v_add_f32 v23, v23, v59
    v_rcp_f32 v23, v23
    v_accvgpr_read_b32 v24, a30
    v_mul_f32 v24, v23, v24
    v_accvgpr_read_b32 v25, a31
    v_mul_f32 v25, v23, v25
    v_accvgpr_read_b32 v90, a14
    v_mul_f32 v90, v23, v90
    v_accvgpr_read_b32 v91, a15
    v_mul_f32 v91, v23, v91
    v_accvgpr_read_b32 v88, a12
    v_mul_f32 v88, v23, v88
    v_accvgpr_read_b32 v89, a13
    v_mul_f32 v89, v23, v89
    v_cvt_pk_bf16_f32 v88, v88, v89
    v_cvt_pk_bf16_f32 v89, v90, v91
    v_accvgpr_read_b32 v90, a28
    v_mul_f32 v90, v23, v90
    v_accvgpr_read_b32 v91, a29
    v_mul_f32 v91, v23, v91
    v_cvt_pk_bf16_f32 v90, v90, v91
    v_cvt_pk_bf16_f32 v91, v24, v25
    v_mfma_f32_16x16x32_bf16 a[176:179], a[212:215], v[228:231], a[176:179]
    buffer_load_dwordx4 v5, s[12:15], s38 offen offset:0 lds
    v_mfma_f32_16x16x32_bf16 a[160:163], a[208:211], v[228:231], a[160:163]
    s_waitcnt lgkmcnt(4)
    buffer_store_dwordx4 v[64:67], v28, s[20:23], s55 offen offset:0 sc1
    v_mfma_f32_16x16x32_bf16 a[224:227], a[192:195], v[64:67], 0
    s_add_u32 m0, s49, 28544
    ds_read_b64_tr_b16 a[208:209], v8 offset:1024
    v_accvgpr_read_b32 v96, a32
    v_mfma_f32_16x16x32_bf16 a[240:243], a[196:199], v[64:67], 0
    s_xor_b32 s8, s8, s11
    ds_read_b64_tr_b16 a[210:211], v8 offset:7168
    v_accvgpr_read_b32 v97, a33
    v_mfma_f32_16x16x32_bf16 a[244:247], a[196:199], v[72:75], 0
    buffer_load_dwordx4 v5, s[12:15], s38 offen offset:128 lds
    v_mfma_f32_16x16x32_bf16 a[228:231], a[192:195], v[72:75], 0
    buffer_store_dwordx4 v[72:75], v28, s[20:23], s55 offen offset:1024 sc1
    v_mfma_f32_16x16x32_bf16 a[232:235], a[192:195], v[80:83], 0
    s_add_u32 m0, s49, 29440
    ds_read_b64_tr_b16 a[212:213], v9 offset:1024
    v_accvgpr_read_b32 v98, a34
    v_mfma_f32_16x16x32_bf16 a[248:251], a[196:199], v[80:83], 0
    s_add_u32 s9, s51, 2
    ds_read_b64_tr_b16 a[214:215], v9 offset:7168
    v_accvgpr_read_b32 v99, a35
    v_mfma_f32_16x16x32_bf16 a[252:255], a[196:199], v[88:91], 0
    buffer_load_dwordx4 v5, s[12:15], s38 offen offset:256 lds
    v_mfma_f32_16x16x32_bf16 a[236:239], a[192:195], v[88:91], 0
    s_waitcnt lgkmcnt(4)
    buffer_store_dwordx4 v[80:83], v28, s[20:23], s55 offen offset:2048 sc1
    buffer_store_dwordx4 v[88:91], v28, s[20:23], s55 offen offset:3072 sc1
    v_accvgpr_read_b32 v26, a50
    v_mul_f32 v26, v20, v26
    v_accvgpr_read_b32 v27, a51
    v_mul_f32 v27, v20, v27
    v_mul_f32 v98, v20, v98
    v_mul_f32 v99, v20, v99
    v_mul_f32 v96, v20, v96
    v_mul_f32 v97, v20, v97
    v_cvt_pk_bf16_f32 v96, v96, v97
    v_cvt_pk_bf16_f32 v97, v98, v99
    v_accvgpr_read_b32 v98, a48
    v_mul_f32 v98, v20, v98
    v_accvgpr_read_b32 v99, a49
    v_mul_f32 v99, v20, v99
    v_cvt_pk_bf16_f32 v98, v98, v99
    v_cvt_pk_bf16_f32 v99, v26, v27
    v_mfma_f32_16x16x32_bf16 v[92:95], a[200:203], v[88:91], 0
    s_add_u32 s38, s35, 0
    ds_read_b64_tr_b16 a[192:193], v10 offset:1024
    v_accvgpr_read_b32 v104, a36
    v_mfma_f32_16x16x32_bf16 v[124:127], a[204:207], v[88:91], 0
    s_add_u32 s57, s33, 40960
    ds_read_b64_tr_b16 a[194:195], v10 offset:7168
    v_accvgpr_read_b32 v105, a37
    v_mfma_f32_16x16x32_bf16 v[116:119], a[204:207], v[80:83], 0
    s_cmp_lt_u32 s3, 2
    s_cselect_b32 s38, s38, s57
    v_accvgpr_read_b32 v106, a38
    v_mfma_f32_16x16x32_bf16 v[84:87], a[200:203], v[80:83], 0
    s_add_u32 m0, s49, 73728
    v_accvgpr_read_b32 v107, a39
    v_mul_f32 v104, v21, v104
    v_mfma_f32_16x16x32_bf16 v[76:79], a[200:203], v[72:75], 0
    s_add_u32 s55, s55, 4096
    ds_read_b64_tr_b16 a[196:197], v11 offset:1024
    v_mul_f32 v105, v21, v105
    v_mfma_f32_16x16x32_bf16 v[108:111], a[204:207], v[72:75], 0
    s_and_b32 s9, s9, 3
    ds_read_b64_tr_b16 a[198:199], v11 offset:7168
    v_mul_f32 v106, v21, v106
    v_mfma_f32_16x16x32_bf16 v[100:103], a[204:207], v[64:67], 0
    buffer_load_dwordx4 v4, s[12:15], s38 offen offset:0 lds
    v_mfma_f32_16x16x32_bf16 v[68:71], a[200:203], v[64:67], 0
    s_waitcnt lgkmcnt(4)
    v_mul_f32 v107, v21, v107
    v_cvt_pk_bf16_f32 v104, v104, v105
    v_mfma_f32_16x16x32_bf16 v[132:135], a[208:211], v[64:67], 0
    s_add_u32 m0, s49, 74624
    ds_read_b64_tr_b16 a[200:201], v8 offset:2048
    v_cvt_pk_bf16_f32 v105, v106, v107
    v_mfma_f32_16x16x32_bf16 v[164:167], a[212:215], v[64:67], 0
    s_lshr_b32 s72, s73, s9
    ds_read_b64_tr_b16 a[202:203], v8 offset:8192
    v_accvgpr_read_b32 v106, a52
    v_accvgpr_read_b32 v30, a54
    v_mul_f32 v30, v21, v30
    v_accvgpr_read_b32 v31, a55
    v_mul_f32 v31, v21, v31
    v_mul_f32 v106, v21, v106
    v_accvgpr_read_b32 v107, a53
    v_mul_f32 v107, v21, v107
    v_cvt_pk_bf16_f32 v106, v106, v107
    v_cvt_pk_bf16_f32 v107, v30, v31
    v_mfma_f32_16x16x32_bf16 v[172:175], a[212:215], v[72:75], 0
    buffer_load_dwordx4 v4, s[12:15], s38 offen offset:128 lds
    v_mfma_f32_16x16x32_bf16 v[140:143], a[208:211], v[72:75], 0
    s_add_u32 m0, s49, 75520
    v_accvgpr_read_b32 v112, a40
    v_accvgpr_read_b32 v113, a41
    v_mfma_f32_16x16x32_bf16 v[148:151], a[208:211], v[80:83], 0
    s_and_b32 s72, s72, 0x2000
    ds_read_b64_tr_b16 a[204:205], v9 offset:2048
    v_accvgpr_read_b32 v114, a42
    v_mfma_f32_16x16x32_bf16 v[180:183], a[212:215], v[80:83], 0
    s_mul_i32 s9, s9, 0x202000
    ds_read_b64_tr_b16 a[206:207], v9 offset:8192
    v_accvgpr_read_b32 v115, a43
    v_mfma_f32_16x16x32_bf16 v[188:191], a[212:215], v[88:91], 0
    buffer_load_dwordx4 v4, s[12:15], s38 offen offset:256 lds
    v_mfma_f32_16x16x32_bf16 v[156:159], a[208:211], v[88:91], 0
    s_waitcnt lgkmcnt(4)
    v_mul_f32 v112, v22, v112
    v_mul_f32 v113, v22, v113
    v_mfma_f32_16x16x32_bf16 v[220:223], a[192:195], v[88:91], 0
    s_add_u32 m0, s49, 76800
    ds_read_b64_tr_b16 a[208:209], v8 offset:12288
    v_mul_f32 v114, v22, v114
    v_mfma_f32_16x16x32_bf16 v[252:255], a[196:199], v[88:91], 0
    s_xor_b32 s9, s9, s72
    ds_read_b64_tr_b16 a[210:211], v8 offset:18432
    v_mul_f32 v115, v22, v115
    v_mfma_f32_16x16x32_bf16 v[244:247], a[196:199], v[80:83], 0
    buffer_store_dwordx4 v[96:99], v28, s[20:23], s55 offen offset:0 sc1
    v_mfma_f32_16x16x32_bf16 v[212:215], a[192:195], v[80:83], 0
    buffer_load_dwordx4 v5, s[12:15], s38 offen offset:0 lds
    v_accvgpr_read_b32 v24, a58
    v_mul_f32 v24, v22, v24
    v_accvgpr_read_b32 v25, a59
    v_mul_f32 v25, v22, v25
    v_cvt_pk_bf16_f32 v112, v112, v113
    v_cvt_pk_bf16_f32 v113, v114, v115
    v_accvgpr_read_b32 v114, a56
    v_mul_f32 v114, v22, v114
    v_accvgpr_read_b32 v115, a57
    v_mul_f32 v115, v22, v115
    v_cvt_pk_bf16_f32 v114, v114, v115
    v_cvt_pk_bf16_f32 v115, v24, v25
    v_mfma_f32_16x16x32_bf16 v[204:207], a[192:195], v[72:75], 0
    s_add_u32 m0, s49, 77696
    ds_read_b64_tr_b16 a[212:213], v9 offset:12288
    v_accvgpr_read_b32 v120, a44
    v_mfma_f32_16x16x32_bf16 v[236:239], a[196:199], v[72:75], 0
    s_and_b32 s9, s9, 6299648
    ds_read_b64_tr_b16 a[214:215], v9 offset:18432
    v_accvgpr_read_b32 v121, a45
    v_mfma_f32_16x16x32_bf16 v[228:231], a[196:199], v[64:67], 0
    buffer_load_dwordx4 v5, s[12:15], s38 offen offset:128 lds
    v_mfma_f32_16x16x32_bf16 v[196:199], a[192:195], v[64:67], 0
    s_waitcnt lgkmcnt(4)
    v_accvgpr_read_b32 v122, a46
    v_accvgpr_read_b32 v123, a47
    v_mfma_f32_16x16x32_bf16 v[32:35], a[200:203], v[64:67], 0
    s_xor_b32 s9, s9, s11
    ds_read_b64_tr_b16 a[192:193], v10 offset:12288
    v_mul_f32 v120, v23, v120
    v_mfma_f32_16x16x32_bf16 v[48:51], a[204:207], v[64:67], 0
    s_add_u32 m0, s49, 78592
    ds_read_b64_tr_b16 a[194:195], v10 offset:18432
    v_mul_f32 v121, v23, v121
    v_mfma_f32_16x16x32_bf16 v[52:55], a[204:207], v[72:75], 0
    buffer_load_dwordx4 v5, s[12:15], s38 offen offset:256 lds
    v_mfma_f32_16x16x32_bf16 v[36:39], a[200:203], v[72:75], 0
    s_add_u32 s10, s51, 3
    v_mul_f32 v122, v23, v122
    v_mul_f32 v123, v23, v123
    v_mfma_f32_16x16x32_bf16 v[40:43], a[200:203], v[80:83], 0
    s_and_b32 s10, s10, 3
    ds_read_b64_tr_b16 a[196:197], v11 offset:12288
    v_cvt_pk_bf16_f32 v120, v120, v121
    v_mfma_f32_16x16x32_bf16 v[56:59], a[204:207], v[80:83], 0
    s_lshr_b32 s72, s73, s10
    ds_read_b64_tr_b16 a[198:199], v11 offset:18432
    v_cvt_pk_bf16_f32 v121, v122, v123
    v_accvgpr_read_b32 v26, a62
    v_mul_f32 v26, v23, v26
    v_accvgpr_read_b32 v27, a63
    v_mul_f32 v27, v23, v27
    v_accvgpr_read_b32 v122, a60
    v_mul_f32 v122, v23, v122
    v_accvgpr_read_b32 v123, a61
    v_mul_f32 v123, v23, v123
    v_cvt_pk_bf16_f32 v122, v122, v123
    v_cvt_pk_bf16_f32 v123, v26, v27
    v_mfma_f32_16x16x32_bf16 v[60:63], a[204:207], v[88:91], 0
    s_add_u32 s38, s34, 40960
    v_accvgpr_read_b32 v128, a64
    v_accvgpr_read_b32 v129, a65
    v_mfma_f32_16x16x32_bf16 v[44:47], a[200:203], v[88:91], 0
    s_waitcnt lgkmcnt(4)
    v_accvgpr_read_b32 v130, a66
    v_accvgpr_read_b32 v131, a67
    v_mfma_f32_16x16x32_bf16 a[236:239], a[208:211], v[120:123], a[236:239]
    s_add_u32 s57, s35, 40960
    ds_read_b64_tr_b16 a[200:201], v8 offset:13312
    v_mul_f32 v128, v20, v128
    v_mfma_f32_16x16x32_bf16 a[252:255], a[212:215], v[120:123], a[252:255]
    s_cmp_lt_u32 s3, 2
    s_cselect_b32 s38, s38, s57
    ds_read_b64_tr_b16 a[202:203], v8 offset:19456
    v_mfma_f32_16x16x32_bf16 a[248:251], a[212:215], v[112:115], a[248:251]
    s_and_b32 s72, s72, 0x2000
    v_mul_f32 v129, v20, v129
    v_mul_f32 v130, v20, v130
    v_mfma_f32_16x16x32_bf16 a[232:235], a[208:211], v[112:115], a[232:235]
    s_add_u32 m0, s49, 98304
    v_mul_f32 v131, v20, v131
    v_cvt_pk_bf16_f32 v128, v128, v129
    v_mfma_f32_16x16x32_bf16 a[228:231], a[208:211], v[104:107], a[228:231]
    s_mul_i32 s10, s10, 0x202000
    ds_read_b64_tr_b16 a[204:205], v9 offset:13312
    v_cvt_pk_bf16_f32 v129, v130, v131
    v_mfma_f32_16x16x32_bf16 a[244:247], a[212:215], v[104:107], a[244:247]
    s_xor_b32 s10, s10, s72
    ds_read_b64_tr_b16 a[206:207], v9 offset:19456
    v_accvgpr_read_b32 v130, a80
    v_mfma_f32_16x16x32_bf16 a[240:243], a[212:215], v[96:99], a[240:243]
    buffer_store_dwordx4 v[104:107], v28, s[20:23], s55 offen offset:1024 sc1
    v_mfma_f32_16x16x32_bf16 a[224:227], a[208:211], v[96:99], a[224:227]
    s_waitcnt lgkmcnt(4)
    buffer_load_dwordx4 v4, s[12:15], s38 offen offset:0 lds
    v_accvgpr_read_b32 v30, a82
    v_mul_f32 v30, v20, v30
    v_accvgpr_read_b32 v31, a83
    v_mul_f32 v31, v20, v31
    v_mul_f32 v130, v20, v130
    v_accvgpr_read_b32 v131, a81
    v_mul_f32 v131, v20, v131
    v_cvt_pk_bf16_f32 v130, v130, v131
    v_cvt_pk_bf16_f32 v131, v30, v31
    v_mfma_f32_16x16x32_bf16 v[68:71], a[192:195], v[96:99], v[68:71]
    s_and_b32 s10, s10, 6299648
    ds_read_b64_tr_b16 a[208:209], v10 offset:13312
    v_accvgpr_read_b32 v136, a68
    v_mfma_f32_16x16x32_bf16 v[100:103], a[196:199], v[96:99], v[100:103]
    s_xor_b32 s10, s10, s11
    ds_read_b64_tr_b16 a[210:211], v10 offset:19456
    v_accvgpr_read_b32 v137, a69
    v_mfma_f32_16x16x32_bf16 v[108:111], a[196:199], v[104:107], v[108:111]
    s_mov_b32 s72, s7
    v_accvgpr_read_b32 v138, a70
    v_accvgpr_read_b32 v139, a71
    v_mfma_f32_16x16x32_bf16 v[76:79], a[192:195], v[104:107], v[76:79]
    s_mov_b32 s73, s7
    v_mul_f32 v136, v21, v136
    v_mul_f32 v137, v21, v137
    v_mfma_f32_16x16x32_bf16 v[84:87], a[192:195], v[112:115], v[84:87]
    s_mov_b32 s74, s7
    ds_read_b64_tr_b16 a[212:213], v11 offset:13312
    v_mul_f32 v138, v21, v138
    v_mfma_f32_16x16x32_bf16 v[116:119], a[196:199], v[112:115], v[116:119]
    s_add_u32 m0, s49, 99200
    ds_read_b64_tr_b16 a[214:215], v11 offset:19456
    v_mul_f32 v139, v21, v139
    v_mfma_f32_16x16x32_bf16 v[124:127], a[196:199], v[120:123], v[124:127]
    buffer_load_dwordx4 v4, s[12:15], s38 offen offset:128 lds
    v_mfma_f32_16x16x32_bf16 v[92:95], a[192:195], v[120:123], v[92:95]
    s_waitcnt lgkmcnt(4)
    v_cvt_pk_bf16_f32 v136, v136, v137
    v_cvt_pk_bf16_f32 v137, v138, v139
    v_mfma_f32_16x16x32_bf16 v[156:159], a[200:203], v[120:123], v[156:159]
    s_mov_b32 s75, s7
    ds_read_b64_tr_b16 a[192:193], v8 offset:14336
    v_accvgpr_read_b32 v138, a84
    v_mfma_f32_16x16x32_bf16 v[188:191], a[204:207], v[120:123], v[188:191]
    ds_read_b64_tr_b16 a[194:195], v8 offset:20480
    v_accvgpr_read_b32 v139, a85
    v_accvgpr_read_b32 v24, a86
    v_mul_f32 v24, v21, v24
    v_accvgpr_read_b32 v25, a87
    v_mul_f32 v25, v21, v25
    v_mul_f32 v138, v21, v138
    v_mul_f32 v139, v21, v139
    v_cvt_pk_bf16_f32 v138, v138, v139
    v_cvt_pk_bf16_f32 v139, v24, v25
    v_mfma_f32_16x16x32_bf16 v[180:183], a[204:207], v[112:115], v[180:183]
    v_add_u32 v10, 0, v14
    v_accvgpr_read_b32 v144, a72
    v_mfma_f32_16x16x32_bf16 v[148:151], a[200:203], v[112:115], v[148:151]
    v_accvgpr_read_b32 v145, a73
    v_accvgpr_read_b32 v146, a74
    v_mfma_f32_16x16x32_bf16 v[140:143], a[200:203], v[104:107], v[140:143]
    ds_read_b64_tr_b16 a[196:197], v9 offset:14336
    v_accvgpr_read_b32 v147, a75
    v_mfma_f32_16x16x32_bf16 v[172:175], a[204:207], v[104:107], v[172:175]
    s_waitcnt vmcnt(20)
    ds_read_b64_tr_b16 a[198:199], v9 offset:20480
    v_mul_f32 v144, v22, v144
    v_mfma_f32_16x16x32_bf16 v[164:167], a[204:207], v[96:99], v[164:167]
    s_barrier
    v_mfma_f32_16x16x32_bf16 v[132:135], a[200:203], v[96:99], v[132:135]
    s_waitcnt lgkmcnt(4)
    v_mul_f32 v145, v22, v145
    v_mul_f32 v146, v22, v146
    v_add_u32 v8, 0, v12
    v_mfma_f32_16x16x32_bf16 v[196:199], a[208:211], v[96:99], v[196:199]
    s_add_u32 m0, s49, 100096
    ds_read_b64_tr_b16 a[200:201], v8 offset:0
    v_mul_f32 v147, v22, v147
    v_mfma_f32_16x16x32_bf16 v[228:231], a[212:215], v[96:99], v[228:231]
    ds_read_b64_tr_b16 a[202:203], v8 offset:6144
    v_cvt_pk_bf16_f32 v144, v144, v145
    v_mfma_f32_16x16x32_bf16 v[236:239], a[212:215], v[104:107], v[236:239]
    buffer_store_dwordx4 v[112:115], v28, s[20:23], s55 offen offset:2048 sc1
    v_mfma_f32_16x16x32_bf16 v[204:207], a[208:211], v[104:107], v[204:207]
    buffer_load_dwordx4 v4, s[12:15], s38 offen offset:256 lds
    v_accvgpr_read_b32 v26, a90
    v_mul_f32 v26, v22, v26
    v_accvgpr_read_b32 v27, a91
    v_mul_f32 v27, v22, v27
    v_cvt_pk_bf16_f32 v145, v146, v147
    v_accvgpr_read_b32 v146, a88
    v_mul_f32 v146, v22, v146
    v_accvgpr_read_b32 v147, a89
    v_mul_f32 v147, v22, v147
    v_cvt_pk_bf16_f32 v146, v146, v147
    v_cvt_pk_bf16_f32 v147, v26, v27
    v_add_u32 v9, 0, v13
    v_mfma_f32_16x16x32_bf16 v[212:215], a[208:211], v[112:115], v[212:215]
    ds_read_b64_tr_b16 a[204:205], v9 offset:0
    v_add_u32 v11, 0, v15
    v_mfma_f32_16x16x32_bf16 v[244:247], a[212:215], v[112:115], v[244:247]
    ds_read_b64_tr_b16 a[206:207], v9 offset:6144
    v_accvgpr_read_b32 v152, a76
    v_mfma_f32_16x16x32_bf16 v[252:255], a[212:215], v[120:123], v[252:255]
    v_accvgpr_read_b32 v153, a77
    v_accvgpr_read_b32 v154, a78
    v_mfma_f32_16x16x32_bf16 v[220:223], a[208:211], v[120:123], v[220:223]
    s_waitcnt lgkmcnt(4)
    v_accvgpr_read_b32 v155, a79
    v_mul_f32 v152, v23, v152
    v_mfma_f32_16x16x32_bf16 v[44:47], a[192:195], v[120:123], v[44:47]
    ds_read_b64_tr_b16 a[208:209], v10 offset:0
    v_mul_f32 v153, v23, v153
    v_mfma_f32_16x16x32_bf16 v[60:63], a[196:199], v[120:123], v[60:63]
    s_add_u32 m0, s49, 101376
    ds_read_b64_tr_b16 a[210:211], v10 offset:6144
    v_mul_f32 v154, v23, v154
    v_mfma_f32_16x16x32_bf16 v[56:59], a[196:199], v[112:115], v[56:59]
    buffer_load_dwordx4 v5, s[12:15], s38 offen offset:0 lds
    v_mfma_f32_16x16x32_bf16 v[40:43], a[192:195], v[112:115], v[40:43]
    v_mul_f32 v155, v23, v155
    v_cvt_pk_bf16_f32 v152, v152, v153
    v_mfma_f32_16x16x32_bf16 v[36:39], a[192:195], v[104:107], v[36:39]
    ds_read_b64_tr_b16 a[212:213], v11 offset:0
    v_cvt_pk_bf16_f32 v153, v154, v155
    v_mfma_f32_16x16x32_bf16 v[52:55], a[196:199], v[104:107], v[52:55]
    ds_read_b64_tr_b16 a[214:215], v11 offset:6144
    v_accvgpr_read_b32 v154, a92
    v_accvgpr_read_b32 v30, a94
    v_mul_f32 v30, v23, v30
    v_accvgpr_read_b32 v31, a95
    v_mul_f32 v31, v23, v31
    v_mul_f32 v154, v23, v154
    v_accvgpr_read_b32 v155, a93
    v_mul_f32 v155, v23, v155
    v_cvt_pk_bf16_f32 v154, v154, v155
    v_cvt_pk_bf16_f32 v155, v30, v31
    v_mfma_f32_16x16x32_bf16 v[48:51], a[196:199], v[96:99], v[48:51]
    v_add_u32 v3, 1, v16
    v_accvgpr_read_b32 v160, a96
    v_mfma_f32_16x16x32_bf16 v[32:35], a[192:195], v[96:99], v[32:35]
    s_waitcnt lgkmcnt(4)
    v_accvgpr_read_b32 v161, a97
    v_accvgpr_read_b32 v162, a98
    v_mfma_f32_16x16x32_bf16 a[224:227], a[200:203], v[128:131], a[224:227]
    s_waitcnt vmcnt(13)
    ds_read_b64_tr_b16 a[192:193], v8 offset:1024
    v_accvgpr_read_b32 v163, a99
    v_mfma_f32_16x16x32_bf16 a[240:243], a[204:207], v[128:131], a[240:243]
    ds_read_b64_tr_b16 a[194:195], v8 offset:7168
    v_mul_f32 v160, v20, v160
    v_mfma_f32_16x16x32_bf16 a[244:247], a[204:207], v[136:139], a[244:247]
    buffer_store_dword v3, v17, s[24:27], s76 offen sc1
    v_mfma_f32_16x16x32_bf16 a[228:231], a[200:203], v[136:139], a[228:231]
    s_add_u32 m0, s49, 102272
    v_mul_f32 v161, v20, v161
    v_mul_f32 v162, v20, v162
    v_mfma_f32_16x16x32_bf16 a[232:235], a[200:203], v[144:147], a[232:235]
    ds_read_b64_tr_b16 a[196:197], v9 offset:1024
    v_mul_f32 v163, v20, v163
    v_mfma_f32_16x16x32_bf16 a[248:251], a[204:207], v[144:147], a[248:251]
    ds_read_b64_tr_b16 a[198:199], v9 offset:7168
    v_cvt_pk_bf16_f32 v160, v160, v161
    v_mfma_f32_16x16x32_bf16 a[252:255], a[204:207], v[152:155], a[252:255]
    buffer_store_dwordx4 v[120:123], v28, s[20:23], s55 offen offset:3072 sc1
    v_mfma_f32_16x16x32_bf16 a[236:239], a[200:203], v[152:155], a[236:239]
    s_waitcnt lgkmcnt(4)
    buffer_load_dwordx4 v5, s[12:15], s38 offen offset:128 lds
    v_accvgpr_read_b32 v24, a114
    v_mul_f32 v24, v20, v24
    v_accvgpr_read_b32 v25, a115
    v_mul_f32 v25, v20, v25
    v_cvt_pk_bf16_f32 v161, v162, v163
    v_accvgpr_read_b32 v162, a112
    v_mul_f32 v162, v20, v162
    v_accvgpr_read_b32 v163, a113
    v_mul_f32 v163, v20, v163
    v_cvt_pk_bf16_f32 v162, v162, v163
    v_cvt_pk_bf16_f32 v163, v24, v25
    v_mfma_f32_16x16x32_bf16 v[92:95], a[208:211], v[152:155], v[92:95]
    s_add_u32 s55, s55, 12288
    ds_read_b64_tr_b16 a[200:201], v10 offset:1024
    v_accvgpr_read_b32 v168, a100
    v_mfma_f32_16x16x32_bf16 v[124:127], a[212:215], v[152:155], v[124:127]
    ds_read_b64_tr_b16 a[202:203], v10 offset:7168
    v_accvgpr_read_b32 v169, a101
    v_mfma_f32_16x16x32_bf16 v[116:119], a[212:215], v[144:147], v[116:119]
    v_accvgpr_read_b32 v170, a102
    v_accvgpr_read_b32 v171, a103
    v_mfma_f32_16x16x32_bf16 v[84:87], a[208:211], v[144:147], v[84:87]
    v_mul_f32 v168, v21, v168
    v_mul_f32 v169, v21, v169
    v_mfma_f32_16x16x32_bf16 v[76:79], a[208:211], v[136:139], v[76:79]
    ds_read_b64_tr_b16 a[204:205], v11 offset:1024
    v_mul_f32 v170, v21, v170
    v_mfma_f32_16x16x32_bf16 v[108:111], a[212:215], v[136:139], v[108:111]
    s_add_u32 m0, s49, 103168
    ds_read_b64_tr_b16 a[206:207], v11 offset:7168
    v_mul_f32 v171, v21, v171
    v_mfma_f32_16x16x32_bf16 v[100:103], a[212:215], v[128:131], v[100:103]
    buffer_load_dwordx4 v5, s[12:15], s38 offen offset:256 lds
    v_mfma_f32_16x16x32_bf16 v[68:71], a[208:211], v[128:131], v[68:71]
    s_waitcnt lgkmcnt(4)
    v_cvt_pk_bf16_f32 v168, v168, v169
    v_cvt_pk_bf16_f32 v169, v170, v171
    v_mfma_f32_16x16x32_bf16 v[132:135], a[192:195], v[128:131], v[132:135]
    ds_read_b64_tr_b16 a[208:209], v8 offset:2048
    v_accvgpr_read_b32 v170, a116
    v_mfma_f32_16x16x32_bf16 v[164:167], a[196:199], v[128:131], v[164:167]
    ds_read_b64_tr_b16 a[210:211], v8 offset:8192
pg_8:
    s_cbranch_execz pg_12
    v_accvgpr_read_b32 v171, a117
    v_accvgpr_read_b32 v26, a118
    v_mul_f32 v26, v21, v26
    v_accvgpr_read_b32 v27, a119
    v_mul_f32 v27, v21, v27
    v_mul_f32 v170, v21, v170
    v_mul_f32 v171, v21, v171
    v_cvt_pk_bf16_f32 v170, v170, v171
    v_cvt_pk_bf16_f32 v171, v26, v27
    v_mfma_f32_16x16x32_bf16 v[172:175], a[196:199], v[136:139], v[172:175]
    s_add_u32 s38, s33, 81920
    v_accvgpr_read_b32 v176, a104
    v_accvgpr_read_b32 v177, a105
    v_mfma_f32_16x16x32_bf16 v[140:143], a[192:195], v[136:139], v[140:143]
    s_add_u32 s57, s34, 81920
    v_accvgpr_read_b32 v178, a106
    v_accvgpr_read_b32 v179, a107
    v_mfma_f32_16x16x32_bf16 v[148:151], a[192:195], v[144:147], v[148:151]
    s_cmp_lt_u32 s3, 2
    s_cselect_b32 s38, s38, s57
    ds_read_b64_tr_b16 a[212:213], v9 offset:2048
    v_mfma_f32_16x16x32_bf16 v[180:183], a[196:199], v[144:147], v[180:183]
    ds_read_b64_tr_b16 a[214:215], v9 offset:8192
    v_mul_f32 v176, v22, v176
    v_mfma_f32_16x16x32_bf16 v[188:191], a[196:199], v[152:155], v[188:191]
    buffer_store_dwordx4 v[128:131], v28, s[20:23], s55 offen offset:0 sc1
    v_mfma_f32_16x16x32_bf16 v[156:159], a[192:195], v[152:155], v[156:159]
    s_waitcnt lgkmcnt(4)
    v_mul_f32 v177, v22, v177
    v_mul_f32 v178, v22, v178
    v_mfma_f32_16x16x32_bf16 v[220:223], a[200:203], v[152:155], v[220:223]
    s_add_u32 m0, s49, 49152
    ds_read_b64_tr_b16 a[192:193], v8 offset:12288
    v_mul_f32 v179, v22, v179
    v_mfma_f32_16x16x32_bf16 v[252:255], a[204:207], v[152:155], v[252:255]
    ds_read_b64_tr_b16 a[194:195], v8 offset:18432
    v_cvt_pk_bf16_f32 v176, v176, v177
    v_mfma_f32_16x16x32_bf16 v[244:247], a[204:207], v[144:147], v[244:247]
    buffer_load_dwordx4 v4, s[12:15], s38 offen offset:0 lds
    v_mfma_f32_16x16x32_bf16 v[212:215], a[200:203], v[144:147], v[212:215]
    v_cvt_pk_bf16_f32 v177, v178, v179
    v_accvgpr_read_b32 v178, a120
    v_accvgpr_read_b32 v30, a122
    v_mul_f32 v30, v22, v30
    v_accvgpr_read_b32 v31, a123
    v_mul_f32 v31, v22, v31
    v_mul_f32 v178, v22, v178
    v_accvgpr_read_b32 v179, a121
    v_mul_f32 v179, v22, v179
    v_cvt_pk_bf16_f32 v178, v178, v179
    v_cvt_pk_bf16_f32 v179, v30, v31
    v_mfma_f32_16x16x32_bf16 v[204:207], a[200:203], v[136:139], v[204:207]
    ds_read_b64_tr_b16 a[196:197], v9 offset:12288
    v_accvgpr_read_b32 v184, a108
    v_mfma_f32_16x16x32_bf16 v[236:239], a[204:207], v[136:139], v[236:239]
    ds_read_b64_tr_b16 a[198:199], v9 offset:18432
    v_accvgpr_read_b32 v185, a109
    v_mfma_f32_16x16x32_bf16 v[228:231], a[204:207], v[128:131], v[228:231]
    v_accvgpr_read_b32 v186, a110
    v_accvgpr_read_b32 v187, a111
    v_mfma_f32_16x16x32_bf16 v[196:199], a[200:203], v[128:131], v[196:199]
    s_waitcnt lgkmcnt(4)
    v_mul_f32 v184, v23, v184
    v_mul_f32 v185, v23, v185
    v_mfma_f32_16x16x32_bf16 v[32:35], a[208:211], v[128:131], v[32:35]
    ds_read_b64_tr_b16 a[200:201], v10 offset:12288
    v_mul_f32 v186, v23, v186
    v_mfma_f32_16x16x32_bf16 v[48:51], a[212:215], v[128:131], v[48:51]
    s_add_u32 m0, s49, 50048
    ds_read_b64_tr_b16 a[202:203], v10 offset:18432
    v_mul_f32 v187, v23, v187
    v_mfma_f32_16x16x32_bf16 v[52:55], a[212:215], v[136:139], v[52:55]
    buffer_load_dwordx4 v4, s[12:15], s38 offen offset:128 lds
    v_mfma_f32_16x16x32_bf16 v[36:39], a[208:211], v[136:139], v[36:39]
    buffer_store_dwordx4 v[136:139], v28, s[20:23], s55 offen offset:1024 sc1
    v_mfma_f32_16x16x32_bf16 v[40:43], a[208:211], v[144:147], v[40:43]
    ds_read_b64_tr_b16 a[204:205], v11 offset:12288
    v_cvt_pk_bf16_f32 v184, v184, v185
    v_mfma_f32_16x16x32_bf16 v[56:59], a[212:215], v[144:147], v[56:59]
    ds_read_b64_tr_b16 a[206:207], v11 offset:18432
    v_cvt_pk_bf16_f32 v185, v186, v187
    v_accvgpr_read_b32 v24, a126
    v_mul_f32 v24, v23, v24
    v_accvgpr_read_b32 v25, a127
    v_mul_f32 v25, v23, v25
    v_accvgpr_read_b32 v186, a124
    v_mul_f32 v186, v23, v186
    v_accvgpr_read_b32 v187, a125
    v_mul_f32 v187, v23, v187
    v_cvt_pk_bf16_f32 v186, v186, v187
    v_cvt_pk_bf16_f32 v187, v24, v25
    v_mfma_f32_16x16x32_bf16 v[60:63], a[212:215], v[152:155], v[60:63]
    v_accvgpr_read_b32 v192, a128
    v_accvgpr_read_b32 v193, a129
    v_mfma_f32_16x16x32_bf16 v[44:47], a[208:211], v[152:155], v[44:47]
    s_waitcnt lgkmcnt(4)
    v_accvgpr_read_b32 v194, a130
    v_accvgpr_read_b32 v195, a131
    v_mfma_f32_16x16x32_bf16 a[236:239], a[192:195], v[184:187], a[236:239]
    ds_read_b64_tr_b16 a[208:209], v8 offset:13312
    v_mul_f32 v192, v20, v192
    v_mfma_f32_16x16x32_bf16 a[252:255], a[196:199], v[184:187], a[252:255]
    ds_read_b64_tr_b16 a[210:211], v8 offset:19456
    v_mul_f32 v193, v20, v193
    v_mfma_f32_16x16x32_bf16 a[248:251], a[196:199], v[176:179], a[248:251]
    v_mul_f32 v194, v20, v194
    v_mul_f32 v195, v20, v195
    v_mfma_f32_16x16x32_bf16 a[232:235], a[192:195], v[176:179], a[232:235]
    s_add_u32 m0, s49, 50944
    v_cvt_pk_bf16_f32 v192, v192, v193
    v_cvt_pk_bf16_f32 v193, v194, v195
    v_mfma_f32_16x16x32_bf16 a[228:231], a[192:195], v[168:171], a[228:231]
    ds_read_b64_tr_b16 a[212:213], v9 offset:13312
    v_accvgpr_read_b32 v194, a144
    v_mfma_f32_16x16x32_bf16 a[244:247], a[196:199], v[168:171], a[244:247]
    ds_read_b64_tr_b16 a[214:215], v9 offset:19456
    v_accvgpr_read_b32 v195, a145
    v_mfma_f32_16x16x32_bf16 a[240:243], a[196:199], v[160:163], a[240:243]
    buffer_load_dwordx4 v4, s[12:15], s38 offen offset:256 lds
    v_mfma_f32_16x16x32_bf16 a[224:227], a[192:195], v[160:163], a[224:227]
    s_waitcnt lgkmcnt(4)
    v_accvgpr_read_b32 v26, a146
    v_accvgpr_read_b32 v27, a147
    v_mul_f32 v26, v20, v26
    v_mul_f32 v27, v20, v27
    v_mul_f32 v194, v20, v194
    v_mul_f32 v195, v20, v195
    v_cvt_pk_bf16_f32 v194, v194, v195
    v_cvt_pk_bf16_f32 v195, v26, v27
    v_mfma_f32_16x16x32_bf16 v[68:71], a[200:203], v[160:163], v[68:71]
    ds_read_b64_tr_b16 a[192:193], v10 offset:13312
    v_accvgpr_read_b32 v200, a132
    v_mfma_f32_16x16x32_bf16 v[100:103], a[204:207], v[160:163], v[100:103]
    ds_read_b64_tr_b16 a[194:195], v10 offset:19456
    v_accvgpr_read_b32 v201, a133
    v_mfma_f32_16x16x32_bf16 v[108:111], a[204:207], v[168:171], v[108:111]
    buffer_store_dwordx4 v[144:147], v28, s[20:23], s55 offen offset:2048 sc1
    v_mfma_f32_16x16x32_bf16 v[76:79], a[200:203], v[168:171], v[76:79]
    v_accvgpr_read_b32 v202, a134
    v_accvgpr_read_b32 v203, a135
    v_mfma_f32_16x16x32_bf16 v[84:87], a[200:203], v[176:179], v[84:87]
    ds_read_b64_tr_b16 a[196:197], v11 offset:13312
    v_mul_f32 v200, v21, v200
    v_mfma_f32_16x16x32_bf16 v[116:119], a[204:207], v[176:179], v[116:119]
    s_add_u32 m0, s49, 52224
    ds_read_b64_tr_b16 a[198:199], v11 offset:19456
    v_mul_f32 v201, v21, v201
    v_mfma_f32_16x16x32_bf16 v[124:127], a[204:207], v[184:187], v[124:127]
    buffer_load_dwordx4 v5, s[12:15], s38 offen offset:0 lds
    v_mfma_f32_16x16x32_bf16 v[92:95], a[200:203], v[184:187], v[92:95]
    s_waitcnt lgkmcnt(4)
    v_mul_f32 v202, v21, v202
    v_mul_f32 v203, v21, v203
    v_mfma_f32_16x16x32_bf16 v[156:159], a[208:211], v[184:187], v[156:159]
    ds_read_b64_tr_b16 a[200:201], v8 offset:14336
    v_cvt_pk_bf16_f32 v200, v200, v201
    v_mfma_f32_16x16x32_bf16 v[188:191], a[212:215], v[184:187], v[188:191]
    ds_read_b64_tr_b16 a[202:203], v8 offset:20480
    v_cvt_pk_bf16_f32 v201, v202, v203
    v_accvgpr_read_b32 v30, a150
    v_mul_f32 v30, v21, v30
    v_accvgpr_read_b32 v31, a151
    v_mul_f32 v31, v21, v31
    v_accvgpr_read_b32 v202, a148
    v_mul_f32 v202, v21, v202
    v_accvgpr_read_b32 v203, a149
    v_mul_f32 v203, v21, v203
    v_cvt_pk_bf16_f32 v202, v202, v203
    v_cvt_pk_bf16_f32 v203, v30, v31
    v_mfma_f32_16x16x32_bf16 v[180:183], a[212:215], v[176:179], v[180:183]
    v_add_u32 v10, 122880, v14
    v_accvgpr_read_b32 v208, a136
    v_mfma_f32_16x16x32_bf16 v[148:151], a[208:211], v[176:179], v[148:151]
    v_accvgpr_read_b32 v209, a137
    v_accvgpr_read_b32 v210, a138
    v_mfma_f32_16x16x32_bf16 v[140:143], a[208:211], v[168:171], v[140:143]
    ds_read_b64_tr_b16 a[204:205], v9 offset:14336
    v_accvgpr_read_b32 v211, a139
    v_mfma_f32_16x16x32_bf16 v[172:175], a[212:215], v[168:171], v[172:175]
    s_waitcnt vmcnt(34)
    ds_read_b64_tr_b16 a[206:207], v9 offset:20480
    v_mul_f32 v208, v22, v208
    v_mfma_f32_16x16x32_bf16 v[164:167], a[212:215], v[160:163], v[164:167]
    s_barrier
    v_mfma_f32_16x16x32_bf16 v[132:135], a[208:211], v[160:163], v[132:135]
    s_waitcnt lgkmcnt(4)
    v_mul_f32 v209, v22, v209
    v_mul_f32 v210, v22, v210
    v_add_u32 v8, 122880, v12
    v_mfma_f32_16x16x32_bf16 v[196:199], a[192:195], v[160:163], v[196:199]
    s_add_u32 m0, s49, 53120
    ds_read_b64_tr_b16 a[208:209], v8 offset:0
    v_mul_f32 v211, v22, v211
    v_mfma_f32_16x16x32_bf16 v[228:231], a[196:199], v[160:163], v[228:231]
    ds_read_b64_tr_b16 a[210:211], v8 offset:6144
    v_cvt_pk_bf16_f32 v208, v208, v209
    v_mfma_f32_16x16x32_bf16 v[236:239], a[196:199], v[168:171], v[236:239]
    buffer_store_dwordx4 v[152:155], v28, s[20:23], s55 offen offset:3072 sc1
    v_mfma_f32_16x16x32_bf16 v[204:207], a[192:195], v[168:171], v[204:207]
    buffer_load_dwordx4 v5, s[12:15], s38 offen offset:128 lds
    v_accvgpr_read_b32 v24, a154
    v_mul_f32 v24, v22, v24
    v_accvgpr_read_b32 v25, a155
    v_mul_f32 v25, v22, v25
    v_cvt_pk_bf16_f32 v209, v210, v211
    v_accvgpr_read_b32 v210, a152
    v_mul_f32 v210, v22, v210
    v_accvgpr_read_b32 v211, a153
    v_mul_f32 v211, v22, v211
    v_cvt_pk_bf16_f32 v210, v210, v211
    v_cvt_pk_bf16_f32 v211, v24, v25
    v_add_u32 v9, 122880, v13
    v_mfma_f32_16x16x32_bf16 v[212:215], a[192:195], v[176:179], v[212:215]
    s_add_u32 s55, s55, 4096
    ds_read_b64_tr_b16 a[212:213], v9 offset:0
    v_add_u32 v11, 122880, v15
    v_mfma_f32_16x16x32_bf16 v[244:247], a[196:199], v[176:179], v[244:247]
    ds_read_b64_tr_b16 a[214:215], v9 offset:6144
    v_accvgpr_read_b32 v216, a140
    v_mfma_f32_16x16x32_bf16 v[252:255], a[196:199], v[184:187], v[252:255]
    v_accvgpr_read_b32 v217, a141
    v_accvgpr_read_b32 v218, a142
    v_mfma_f32_16x16x32_bf16 v[220:223], a[192:195], v[184:187], v[220:223]
    s_waitcnt lgkmcnt(4)
    v_accvgpr_read_b32 v219, a143
    v_mul_f32 v216, v23, v216
    v_mfma_f32_16x16x32_bf16 v[44:47], a[200:203], v[184:187], v[44:47]
    s_add_u32 s11, s7, 1
    ds_read_b64_tr_b16 a[192:193], v10 offset:0
    v_mul_f32 v217, v23, v217
    v_mfma_f32_16x16x32_bf16 v[60:63], a[204:207], v[184:187], v[60:63]
    s_add_u32 m0, s49, 54016
    ds_read_b64_tr_b16 a[194:195], v10 offset:6144
    v_mul_f32 v218, v23, v218
    v_mfma_f32_16x16x32_bf16 v[56:59], a[204:207], v[176:179], v[56:59]
    buffer_load_dwordx4 v5, s[12:15], s38 offen offset:256 lds
    v_mfma_f32_16x16x32_bf16 v[40:43], a[200:203], v[176:179], v[40:43]
    s_load_dwordx4 s[72:75], s[86:87], s5 glc
    v_mul_f32 v219, v23, v219
    v_cvt_pk_bf16_f32 v216, v216, v217
    v_mfma_f32_16x16x32_bf16 v[36:39], a[200:203], v[168:171], v[36:39]
    s_mov_b32 s28, s82
    ds_read_b64_tr_b16 a[196:197], v11 offset:0
    v_cvt_pk_bf16_f32 v217, v218, v219
    v_mfma_f32_16x16x32_bf16 v[52:55], a[204:207], v[168:171], v[52:55]
    s_and_b32 s29, s83, 0xffff
    ds_read_b64_tr_b16 a[198:199], v11 offset:6144
    v_accvgpr_read_b32 v218, a156
    v_accvgpr_read_b32 v26, a158
    v_mul_f32 v26, v23, v26
    v_accvgpr_read_b32 v27, a159
    v_mul_f32 v27, v23, v27
    v_mul_f32 v218, v23, v218
    v_accvgpr_read_b32 v219, a157
    v_mul_f32 v219, v23, v219
    v_cvt_pk_bf16_f32 v218, v218, v219
    v_cvt_pk_bf16_f32 v219, v26, v27
    v_mfma_f32_16x16x32_bf16 v[48:51], a[204:207], v[160:163], v[48:51]
    buffer_store_dwordx4 v[160:163], v28, s[20:23], s55 offen offset:0 sc1
    v_mfma_f32_16x16x32_bf16 v[32:35], a[200:203], v[160:163], v[32:35]
    s_waitcnt lgkmcnt(4)
    v_accvgpr_read_b32 v224, a160
    v_accvgpr_read_b32 v225, a161
    v_mfma_f32_16x16x32_bf16 a[224:227], a[208:211], v[192:195], a[224:227]
    s_add_u32 s38, s35, 81920
    ds_read_b64_tr_b16 a[200:201], v8 offset:1024
    v_add_u32 v3, 2, v16
    v_mfma_f32_16x16x32_bf16 a[240:243], a[212:215], v[192:195], a[240:243]
    s_add_u32 s57, s33, 122880
    ds_read_b64_tr_b16 a[202:203], v8 offset:7168
    v_accvgpr_read_b32 v226, a162
    v_mfma_f32_16x16x32_bf16 a[244:247], a[212:215], v[200:203], a[244:247]
    s_cmp_lt_u32 s3, 2
    s_cselect_b32 s38, s38, s57
    v_accvgpr_read_b32 v227, a163
    v_mfma_f32_16x16x32_bf16 a[228:231], a[208:211], v[200:203], a[228:231]
    s_add_u32 m0, s49, 0
    v_mul_f32 v224, v20, v224
    v_mul_f32 v225, v20, v225
    v_mfma_f32_16x16x32_bf16 a[232:235], a[208:211], v[208:211], a[232:235]
    s_waitcnt vmcnt(13)
    ds_read_b64_tr_b16 a[204:205], v9 offset:1024
    v_mul_f32 v226, v20, v226
    v_mfma_f32_16x16x32_bf16 a[248:251], a[212:215], v[208:211], a[248:251]
    s_mov_b32 s30, 1966080
    ds_read_b64_tr_b16 a[206:207], v9 offset:7168
    v_mul_f32 v227, v20, v227
    v_mfma_f32_16x16x32_bf16 a[252:255], a[212:215], v[216:219], a[252:255]
    buffer_store_dword v3, v17, s[24:27], s76 offen sc1
    v_mfma_f32_16x16x32_bf16 a[236:239], a[208:211], v[216:219], a[236:239]
    s_waitcnt lgkmcnt(4)
    buffer_load_dwordx4 v4, s[12:15], s38 offen offset:0 lds
    v_accvgpr_read_b32 v30, a178
    v_mul_f32 v30, v20, v30
    v_accvgpr_read_b32 v31, a179
    v_mul_f32 v31, v20, v31
    v_cvt_pk_bf16_f32 v224, v224, v225
    v_cvt_pk_bf16_f32 v225, v226, v227
    v_accvgpr_read_b32 v226, a176
    v_mul_f32 v226, v20, v226
    v_accvgpr_read_b32 v227, a177
    v_mul_f32 v227, v20, v227
    v_cvt_pk_bf16_f32 v226, v226, v227
    v_cvt_pk_bf16_f32 v227, v30, v31
    v_mfma_f32_16x16x32_bf16 v[92:95], a[192:195], v[216:219], v[92:95]
    s_mov_b32 s31, 0x00020000
    ds_read_b64_tr_b16 a[208:209], v10 offset:1024
    v_accvgpr_read_b32 v232, a164
    v_mfma_f32_16x16x32_bf16 v[124:127], a[196:199], v[216:219], v[124:127]
    s_mul_i32 s44, s47, 10
    ds_read_b64_tr_b16 a[210:211], v10 offset:7168
    v_accvgpr_read_b32 v233, a165
    v_mfma_f32_16x16x32_bf16 v[116:119], a[196:199], v[208:211], v[116:119]
    s_sub_u32 s44, s58, s44
    v_accvgpr_read_b32 v234, a166
    v_accvgpr_read_b32 v235, a167
    v_mfma_f32_16x16x32_bf16 v[84:87], a[192:195], v[208:211], v[84:87]
    s_lshl_b32 s62, s44, 2
    v_mul_f32 v232, v21, v232
    v_mul_f32 v233, v21, v233
    v_mfma_f32_16x16x32_bf16 v[76:79], a[192:195], v[200:203], v[76:79]
    s_add_u32 s62, s62, s3
    ds_read_b64_tr_b16 a[212:213], v11 offset:1024
    v_mul_f32 v234, v21, v234
    v_mfma_f32_16x16x32_bf16 v[108:111], a[196:199], v[200:203], v[108:111]
    s_add_u32 m0, s49, 896
    ds_read_b64_tr_b16 a[214:215], v11 offset:7168
    v_mul_f32 v235, v21, v235
    v_mfma_f32_16x16x32_bf16 v[100:103], a[196:199], v[192:195], v[100:103]
    buffer_store_dwordx4 v[168:171], v28, s[20:23], s55 offen offset:1024 sc1
    v_mfma_f32_16x16x32_bf16 v[68:71], a[192:195], v[192:195], v[68:71]
    s_waitcnt lgkmcnt(4)
    v_cvt_pk_bf16_f32 v232, v232, v233
    v_cvt_pk_bf16_f32 v233, v234, v235
    v_mfma_f32_16x16x32_bf16 v[132:135], a[200:203], v[192:195], v[132:135]
    s_sub_u32 s88, s72, s11
    ds_read_b64_tr_b16 a[192:193], v8 offset:2048
    v_accvgpr_read_b32 v234, a180
    v_mfma_f32_16x16x32_bf16 v[164:167], a[204:207], v[192:195], v[164:167]
    s_sub_u32 s89, s73, s11
    ds_read_b64_tr_b16 a[194:195], v8 offset:8192
    v_accvgpr_read_b32 v235, a181
    v_accvgpr_read_b32 v24, a182
    v_mul_f32 v24, v21, v24
    v_accvgpr_read_b32 v25, a183
    v_mul_f32 v25, v21, v25
    v_mul_f32 v234, v21, v234
    v_mul_f32 v235, v21, v235
    v_cvt_pk_bf16_f32 v234, v234, v235
    v_cvt_pk_bf16_f32 v235, v24, v25
    v_mfma_f32_16x16x32_bf16 v[172:175], a[204:207], v[200:203], v[172:175]
    buffer_load_dwordx4 v4, s[12:15], s38 offen offset:128 lds
    v_mfma_f32_16x16x32_bf16 v[140:143], a[200:203], v[200:203], v[140:143]
    s_max_u32 s88, s88, s89
    v_accvgpr_read_b32 v240, a168
    v_accvgpr_read_b32 v241, a169
    v_mfma_f32_16x16x32_bf16 v[148:151], a[200:203], v[208:211], v[148:151]
    s_sub_u32 s89, s74, s11
    ds_read_b64_tr_b16 a[196:197], v9 offset:2048
    v_accvgpr_read_b32 v242, a170
    v_mfma_f32_16x16x32_bf16 v[180:183], a[204:207], v[208:211], v[180:183]
    s_max_u32 s88, s88, s89
    ds_read_b64_tr_b16 a[198:199], v9 offset:8192
    v_accvgpr_read_b32 v243, a171
    v_mfma_f32_16x16x32_bf16 v[188:191], a[204:207], v[216:219], v[188:191]
    s_sub_u32 s89, s75, s11
    v_mul_f32 v240, v22, v240
    v_mul_f32 v241, v22, v241
    v_mfma_f32_16x16x32_bf16 v[156:159], a[200:203], v[216:219], v[156:159]
    s_waitcnt lgkmcnt(4)
    v_mul_f32 v242, v22, v242
    v_mul_f32 v243, v22, v243
    v_mfma_f32_16x16x32_bf16 v[220:223], a[208:211], v[216:219], v[220:223]
    s_add_u32 m0, s49, 1792
    ds_read_b64_tr_b16 a[200:201], v8 offset:12288
    v_cvt_pk_bf16_f32 v240, v240, v241
    v_mfma_f32_16x16x32_bf16 v[252:255], a[212:215], v[216:219], v[252:255]
    s_max_u32 s88, s88, s89
    ds_read_b64_tr_b16 a[202:203], v8 offset:18432
    v_cvt_pk_bf16_f32 v241, v242, v243
    v_mfma_f32_16x16x32_bf16 v[244:247], a[212:215], v[208:211], v[244:247]
    s_cmp_gt_u32 s88, 5
    s_cbranch_scc1 spin_o0
spin_o0_ret:
    v_accvgpr_read_b32 v242, a184
    v_mfma_f32_16x16x32_bf16 v[212:215], a[208:211], v[208:211], v[212:215]
    buffer_store_dwordx4 v[176:179], v28, s[20:23], s55 offen offset:2048 sc1
    v_accvgpr_read_b32 v26, a186
    v_mul_f32 v26, v22, v26
    v_accvgpr_read_b32 v27, a187
    v_mul_f32 v27, v22, v27
    v_mul_f32 v242, v22, v242
    v_accvgpr_read_b32 v243, a185
    v_mul_f32 v243, v22, v243
    v_cvt_pk_bf16_f32 v242, v242, v243
    v_cvt_pk_bf16_f32 v243, v26, v27
    v_mfma_f32_16x16x32_bf16 v[204:207], a[208:211], v[200:203], v[204:207]
    s_lshl_b32 s62, s62, 9
    ds_read_b64_tr_b16 a[204:205], v9 offset:12288
    v_accvgpr_read_b32 v248, a172
    v_mfma_f32_16x16x32_bf16 v[236:239], a[212:215], v[200:203], v[236:239]
    s_add_u32 s62, s62, 3670016
    ds_read_b64_tr_b16 a[206:207], v9 offset:18432
    v_accvgpr_read_b32 v249, a173
    v_mfma_f32_16x16x32_bf16 v[228:231], a[212:215], v[192:195], v[228:231]
    buffer_load_dwordx4 a[0:3], v28, s[20:23], s8 offen offset:0 sc1
    v_mfma_f32_16x16x32_bf16 v[196:199], a[208:211], v[192:195], v[196:199]
    s_waitcnt lgkmcnt(4)
    buffer_load_dwordx4 v4, s[12:15], s38 offen offset:256 lds
    v_mfma_f32_16x16x32_bf16 v[32:35], a[192:195], v[192:195], v[32:35]
    s_cmp_lt_u32 s2, 240
    s_cselect_b32 s62, s62, 0x70000000
    ds_read_b64_tr_b16 a[208:209], v10 offset:12288
    v_mfma_f32_16x16x32_bf16 v[48:51], a[196:199], v[192:195], v[48:51]
    s_add_u32 m0, s49, 3072
    ds_read_b64_tr_b16 a[210:211], v10 offset:18432
    v_accvgpr_read_b32 v250, a174
    v_mfma_f32_16x16x32_bf16 v[52:55], a[196:199], v[200:203], v[52:55]
    buffer_load_dwordx4 a[4:7], v28, s[20:23], s8 offen offset:1024 sc1
    v_mfma_f32_16x16x32_bf16 v[36:39], a[192:195], v[200:203], v[36:39]
    buffer_load_dwordx4 a[8:11], v28, s[20:23], s8 offen offset:2048 sc1
    v_mfma_f32_16x16x32_bf16 v[40:43], a[192:195], v[208:211], v[40:43]
    s_lshl_b32 s59, s47, 6
    ds_read_b64_tr_b16 a[212:213], v11 offset:12288
    v_accvgpr_read_b32 v251, a175
    v_mfma_f32_16x16x32_bf16 v[56:59], a[196:199], v[208:211], v[56:59]
    s_lshr_b32 s56, s3, 1
    ds_read_b64_tr_b16 a[214:215], v11 offset:18432
    v_mul_f32 v248, v23, v248
    v_accvgpr_read_b32 v30, a190
    v_mul_f32 v30, v23, v30
    v_accvgpr_read_b32 v31, a191
    v_mul_f32 v31, v23, v31
    v_mul_f32 v250, v23, v250
    v_mul_f32 v251, v23, v251
    v_mul_f32 v249, v23, v249
    v_cvt_pk_bf16_f32 v248, v248, v249
    v_cvt_pk_bf16_f32 v249, v250, v251
    v_accvgpr_read_b32 v250, a188
    v_mul_f32 v250, v23, v250
    v_accvgpr_read_b32 v251, a189
    v_mul_f32 v251, v23, v251
    v_cvt_pk_bf16_f32 v250, v250, v251
    v_cvt_pk_bf16_f32 v251, v30, v31
    v_mfma_f32_16x16x32_bf16 v[60:63], a[196:199], v[216:219], v[60:63]
    buffer_load_dwordx4 a[12:15], v28, s[20:23], s8 offen offset:3072 sc1
    v_mfma_f32_16x16x32_bf16 v[44:47], a[192:195], v[216:219], v[44:47]
    s_waitcnt lgkmcnt(4)
    buffer_load_dwordx4 v5, s[12:15], s38 offen offset:0 lds
    v_mfma_f32_16x16x32_bf16 a[236:239], a[200:203], v[248:251], a[236:239]
    s_add_u32 s8, s8, 4096
    ds_read_b64_tr_b16 a[192:193], v8 offset:13312
    s_lshl_b32 s56, s56, 5
    v_mfma_f32_16x16x32_bf16 a[252:255], a[204:207], v[248:251], a[252:255]
    s_add_u32 s59, s59, s56
    ds_read_b64_tr_b16 a[194:195], v8 offset:19456
    s_and_b32 s56, s3, 1
    v_mfma_f32_16x16x32_bf16 a[248:251], a[204:207], v[240:243], a[248:251]
    buffer_store_dwordx4 v[184:187], v28, s[20:23], s55 offen offset:3072 sc1
    v_mfma_f32_16x16x32_bf16 a[232:235], a[200:203], v[240:243], a[232:235]
    s_add_u32 m0, s49, 3968
    s_add_u32 s55, s55, 12288
    s_lshl_b32 s56, s56, 2
    v_mfma_f32_16x16x32_bf16 a[228:231], a[200:203], v[232:235], a[228:231]
    s_add_u32 s59, s59, s56
    ds_read_b64_tr_b16 a[196:197], v9 offset:13312
    s_mul_i32 s59, s59, 1280
    v_mfma_f32_16x16x32_bf16 a[244:247], a[204:207], v[232:235], a[244:247]
    s_lshl_b32 s44, s44, 7
    ds_read_b64_tr_b16 a[198:199], v9 offset:19456
    s_add_u32 s59, s59, s44
    v_mfma_f32_16x16x32_bf16 a[240:243], a[204:207], v[224:227], a[240:243]
    buffer_load_dwordx4 v5, s[12:15], s38 offen offset:128 lds
    v_mfma_f32_16x16x32_bf16 a[224:227], a[200:203], v[224:227], a[224:227]
    s_waitcnt lgkmcnt(4)
    s_lshl_b32 s44, s3, 11
    v_lshrrev_b32 v29, 5, v1
    v_mfma_f32_16x16x32_bf16 v[68:71], a[208:211], v[224:227], v[68:71]
    ds_read_b64_tr_b16 a[200:201], v10 offset:13312
    v_lshlrev_b32 v29, 3, v29
    v_mfma_f32_16x16x32_bf16 v[100:103], a[212:215], v[224:227], v[100:103]
    ds_read_b64_tr_b16 a[202:203], v10 offset:19456
    v_bfe_u32 v6, v1, 3, 2
    v_mfma_f32_16x16x32_bf16 v[108:111], a[212:215], v[232:235], v[108:111]
    v_add_u32 v6, v6, v29
    v_mul_u32_u24 v6, 1280, v6
    v_mfma_f32_16x16x32_bf16 v[76:79], a[208:211], v[232:235], v[76:79]
    v_lshrrev_b32 v29, 4, v1
    v_lshlrev_b32 v29, 1, v29
    v_mfma_f32_16x16x32_bf16 v[84:87], a[208:211], v[240:243], v[84:87]
    ds_read_b64_tr_b16 a[204:205], v11 offset:13312
    v_and_b32 v7, 7, v1
    v_mfma_f32_16x16x32_bf16 v[116:119], a[212:215], v[240:243], v[116:119]
    s_add_u32 m0, s49, 4864
    ds_read_b64_tr_b16 a[206:207], v11 offset:19456
    v_xor_b32 v7, v7, v29
    v_mfma_f32_16x16x32_bf16 v[124:127], a[212:215], v[248:251], v[124:127]
    buffer_load_dwordx4 a[16:19], v28, s[20:23], s9 offen offset:0 sc1
    v_mfma_f32_16x16x32_bf16 v[92:95], a[208:211], v[248:251], v[92:95]
    s_waitcnt lgkmcnt(4)
    v_lshlrev_b32 v7, 4, v7
    v_add_u32 v6, v6, v7
    v_mfma_f32_16x16x32_bf16 v[156:159], a[192:195], v[248:251], v[156:159]
    ds_read_b64_tr_b16 a[208:209], v8 offset:14336
    v_add_u32 v7, 20480, v6
    v_mfma_f32_16x16x32_bf16 v[188:191], a[196:199], v[248:251], v[188:191]
    ds_read_b64_tr_b16 a[210:211], v8 offset:20480
    v_add_u32 v29, 147456, v28
    v_mfma_f32_16x16x32_bf16 v[180:183], a[196:199], v[240:243], v[180:183]
    buffer_store_dwordx4 v[192:195], v28, s[20:23], s55 offen offset:0 sc1
    v_mfma_f32_16x16x32_bf16 v[148:151], a[192:195], v[240:243], v[148:151]
    buffer_load_dwordx4 v5, s[12:15], s38 offen offset:256 lds
    v_mfma_f32_16x16x32_bf16 v[140:143], a[192:195], v[232:235], v[140:143]
    s_mov_b32 s16, s64
    ds_read_b64_tr_b16 a[212:213], v9 offset:14336
    v_add_u32 v3, 3, v16
    v_mfma_f32_16x16x32_bf16 v[172:175], a[196:199], v[232:235], v[172:175]
    s_waitcnt vmcnt(46)
    ds_read_b64_tr_b16 a[214:215], v9 offset:20480
    v_add_u32 v10, 24576, v14
    v_mfma_f32_16x16x32_bf16 v[164:167], a[196:199], v[224:227], v[164:167]
    s_barrier
    v_mfma_f32_16x16x32_bf16 v[132:135], a[192:195], v[224:227], v[132:135]
    s_waitcnt lgkmcnt(4)
    buffer_load_dwordx4 a[20:23], v28, s[20:23], s9 offen offset:1024 sc1
    v_add_u32 v8, 24576, v12
    v_mfma_f32_16x16x32_bf16 v[196:199], a[200:203], v[224:227], v[196:199]
    s_waitcnt vmcnt(20)
    ds_read_b64_tr_b16 a[192:193], v8 offset:0
    v_add_u32 v11, 24576, v15
    v_mfma_f32_16x16x32_bf16 v[228:231], a[204:207], v[224:227], v[228:231]
    s_and_b32 s17, s65, 0xffff
    ds_read_b64_tr_b16 a[194:195], v8 offset:6144
    v_add_u32 v9, 24576, v13
    v_mfma_f32_16x16x32_bf16 v[236:239], a[204:207], v[232:235], v[236:239]
    buffer_store_dword v3, v17, s[24:27], s76 offen sc1
    v_mfma_f32_16x16x32_bf16 v[204:207], a[200:203], v[232:235], v[204:207]
    buffer_load_dwordx4 a[24:27], v28, s[20:23], s9 offen offset:2048 sc1
    v_mfma_f32_16x16x32_bf16 v[212:215], a[200:203], v[240:243], v[212:215]
    s_mov_b32 s18, 2621440
    ds_read_b64_tr_b16 a[196:197], v9 offset:0
    s_mov_b32 s19, 0x00020000
    v_mfma_f32_16x16x32_bf16 v[244:247], a[204:207], v[240:243], v[244:247]
    s_lshl_b32 s45, s52, 4
    ds_read_b64_tr_b16 a[198:199], v9 offset:6144
    s_lshl_b32 s56, s53, 1
    v_mfma_f32_16x16x32_bf16 v[252:255], a[204:207], v[248:251], v[252:255]
    buffer_load_dwordx4 a[28:31], v28, s[20:23], s9 offen offset:3072 sc1
    v_mfma_f32_16x16x32_bf16 v[220:223], a[200:203], v[248:251], v[220:223]
    s_waitcnt lgkmcnt(4)
    buffer_load_dwordx4 a[32:35], v28, s[20:23], s10 offen offset:0 sc1
    v_mfma_f32_16x16x32_bf16 v[44:47], a[208:211], v[248:251], v[44:47]
    s_add_u32 s9, s9, 4096
    ds_read_b64_tr_b16 a[200:201], v10 offset:0
    s_add_u32 s45, s45, s56
    v_mfma_f32_16x16x32_bf16 v[60:63], a[212:215], v[248:251], v[60:63]
    s_and_b32 s56, s3, 1
    ds_read_b64_tr_b16 a[202:203], v10 offset:6144
    s_add_u32 s45, s45, s56
    v_mfma_f32_16x16x32_bf16 v[56:59], a[212:215], v[240:243], v[56:59]
    buffer_store_dwordx4 v[200:203], v28, s[20:23], s55 offen offset:1024 sc1
    v_mfma_f32_16x16x32_bf16 v[40:43], a[208:211], v[240:243], v[40:43]
    buffer_load_dwordx4 a[36:39], v28, s[20:23], s10 offen offset:1024 sc1
    v_mfma_f32_16x16x32_bf16 v[36:39], a[208:211], v[232:235], v[36:39]
    s_lshl_b32 s56, s45, 4
    ds_read_b64_tr_b16 a[204:205], v11 offset:0
    v_and_b32 v20, 15, v1
    v_mfma_f32_16x16x32_bf16 v[52:55], a[212:215], v[232:235], v[52:55]
    s_waitcnt vmcnt(13)
    ds_read_b64_tr_b16 a[206:207], v11 offset:6144
    v_add_u32 v20, s56, v20
    v_mfma_f32_16x16x32_bf16 v[48:51], a[212:215], v[224:227], v[48:51]
    buffer_load_dwordx4 a[40:43], v28, s[20:23], s10 offen offset:2048 sc1
    v_mfma_f32_16x16x32_bf16 v[32:35], a[208:211], v[224:227], v[32:35]
    s_waitcnt lgkmcnt(4)
    buffer_load_dwordx4 a[44:47], v28, s[20:23], s10 offen offset:3072 sc1
    v_mfma_f32_16x16x32_bf16 a[224:227], a[192:195], a[0:3], a[224:227]
    s_add_u32 s10, s10, 4096
    ds_read_b64_tr_b16 a[208:209], v8 offset:1024
    v_bfe_u32 v21, v1, 4, 1
    v_mfma_f32_16x16x32_bf16 a[240:243], a[196:199], a[0:3], a[240:243]
    ds_read_b64_tr_b16 a[210:211], v8 offset:7168
    v_bfe_u32 v22, v1, 5, 1
    v_mfma_f32_16x16x32_bf16 a[244:247], a[196:199], a[4:7], a[244:247]
    ds_read_b128 v[64:67], v29 offset:0
    v_lshl_add_u32 v21, v21, 1, v22
    v_mfma_f32_16x16x32_bf16 a[228:231], a[192:195], a[4:7], a[228:231]
    ds_read_b128 v[72:75], v29 offset:1024
    v_mul_u32_u24 v22, 1280, v20
    v_mfma_f32_16x16x32_bf16 a[232:235], a[192:195], a[8:11], a[232:235]
    ds_read_b64_tr_b16 a[212:213], v9 offset:1024
    v_lshl_add_u32 v22, v21, 4, v22
    v_mfma_f32_16x16x32_bf16 a[248:251], a[196:199], a[8:11], a[248:251]
pg_9:
    s_cbranch_execz pg_13
    ds_read_b64_tr_b16 a[214:215], v9 offset:7168
    v_lshlrev_b32 v23, 3, v20
    v_mfma_f32_16x16x32_bf16 a[252:255], a[196:199], a[12:15], a[252:255]
    s_add_u32 s11, s7, 2
    ds_read_b128 v[80:83], v29 offset:2048
    v_lshrrev_b32 v2, 2, v1
    v_mfma_f32_16x16x32_bf16 a[236:239], a[192:195], a[12:15], a[236:239]
    s_waitcnt lgkmcnt(4)
    buffer_store_dwordx4 v[208:211], v28, s[20:23], s55 offen offset:2048 sc1
    v_mfma_f32_16x16x32_bf16 v[92:95], a[200:203], a[12:15], v[92:95]
    s_load_dwordx4 s[72:75], s[86:87], s5 glc
    ds_read_b64_tr_b16 a[192:193], v10 offset:1024
    v_lshlrev_b32 v18, 6, v2
    v_mfma_f32_16x16x32_bf16 v[124:127], a[204:207], a[12:15], v[124:127]
    s_mul_i32 s56, s51, 5
    ds_read_b64_tr_b16 a[194:195], v10 offset:7168
    v_mul_u32_u24 v2, 1280, v2
    v_mfma_f32_16x16x32_bf16 v[116:119], a[204:207], a[8:11], v[116:119]
    s_lshr_b32 s6, s3, 1
    ds_read_b128 v[88:91], v29 offset:3072
    v_and_b32 v19, 3, v1
    v_mfma_f32_16x16x32_bf16 v[84:87], a[200:203], a[8:11], v[84:87]
    s_add_u32 s41, s56, s6
    ds_read_b128 v[96:99], v29 offset:4096
    v_lshl_add_u32 v18, v19, 3, v18
    v_mfma_f32_16x16x32_bf16 v[76:79], a[200:203], a[4:7], v[76:79]
    s_add_u32 s42, s56, 2
    ds_read_b64_tr_b16 a[196:197], v11 offset:1024
    v_lshl_add_u32 v2, v19, 4, v2
    v_mfma_f32_16x16x32_bf16 v[108:111], a[204:207], a[4:7], v[108:111]
    s_add_u32 s43, s56, 4
    ds_read_b64_tr_b16 a[198:199], v11 offset:7168
    v_and_b32 v19, 16, v1
    v_mfma_f32_16x16x32_bf16 v[100:103], a[204:207], a[0:3], v[100:103]
    s_sub_u32 s43, s43, s6
    ds_read_b128 v[104:107], v29 offset:5120
    v_lshlrev_b32 v19, 1, v19
    v_mfma_f32_16x16x32_bf16 v[68:71], a[200:203], a[0:3], v[68:71]
    s_waitcnt lgkmcnt(4)
    v_xor_b32 v2, v2, v19
    v_or_b32 v18, v18, v19
    v_mfma_f32_16x16x32_bf16 v[132:135], a[208:211], a[0:3], v[132:135]
    s_andn2_b32 s6, s2, 7
    ds_read_b64_tr_b16 a[200:201], v8 offset:2048
    v_xor_b32 v19, 32, v18
    v_mfma_f32_16x16x32_bf16 v[164:167], a[212:215], a[0:3], v[164:167]
    s_lshl_b32 s6, s6, 2
    ds_read_b64_tr_b16 a[202:203], v8 offset:8192
    v_add_u32 v2, s39, v2
    v_mfma_f32_16x16x32_bf16 v[172:175], a[212:215], a[4:7], v[172:175]
    s_lshr_b32 s56, s53, 1
    ds_read_b128 v[112:115], v29 offset:6144
    s_add_u32 s6, s6, s56
    v_mfma_f32_16x16x32_bf16 v[140:143], a[208:211], a[4:7], v[140:143]
    s_lshl_b32 s6, s6, 7
    ds_read_b128 v[120:123], v29 offset:7168
    s_add_u32 s6, s6, 4194304
    v_mfma_f32_16x16x32_bf16 v[148:151], a[208:211], a[8:11], v[148:151]
    s_add_u32 s56, s51, 8
    ds_read_b64_tr_b16 a[204:205], v9 offset:2048
    s_lshr_b32 s56, s93, s56
    v_mfma_f32_16x16x32_bf16 v[180:183], a[212:215], a[8:11], v[180:183]
    s_and_b32 s56, s56, 0x2000
    ds_read_b64_tr_b16 a[206:207], v9 offset:8192
    s_xor_b32 s56, s56, s6
    v_mfma_f32_16x16x32_bf16 v[188:191], a[212:215], a[12:15], v[188:191]
    s_and_b32 s56, s56, 0x2000
    ds_read_b128 v[128:131], v29 offset:8192
    s_lshl_b32 s56, s56, 8
    v_mfma_f32_16x16x32_bf16 v[156:159], a[208:211], a[12:15], v[156:159]
    s_waitcnt lgkmcnt(4)
    buffer_store_dwordx4 v[216:219], v28, s[20:23], s55 offen offset:3072 sc1
    v_mfma_f32_16x16x32_bf16 v[220:223], a[192:195], a[12:15], v[220:223]
    s_add_u32 s55, s55, 4096
    ds_read_b64_tr_b16 a[208:209], v8 offset:12288
    s_add_u32 s6, s6, s56
    v_mfma_f32_16x16x32_bf16 v[252:255], a[196:199], a[12:15], v[252:255]
    s_lshr_b32 s48, s45, 2
    ds_read_b64_tr_b16 a[210:211], v8 offset:18432
    s_lshr_b32 s56, s48, 1
    v_mfma_f32_16x16x32_bf16 v[244:247], a[196:199], a[8:11], v[244:247]
    s_lshl_b32 s56, s56, 19
    ds_read_b128 v[136:139], v29 offset:9216
    s_and_b32 s40, s48, 1
    v_mfma_f32_16x16x32_bf16 v[212:215], a[192:195], a[8:11], v[212:215]
    s_lshl_b32 s40, s40, 12
    s_or_b32 s56, s56, s40
    s_lshl_b32 s40, s48, 10
    v_mfma_f32_16x16x32_bf16 v[204:207], a[192:195], a[4:7], v[204:207]
    s_and_b32 s40, s40, 0x2000
    ds_read_b64_tr_b16 a[212:213], v9 offset:12288
    s_or_b32 s56, s56, s40
    v_mfma_f32_16x16x32_bf16 v[236:239], a[196:199], a[4:7], v[236:239]
    s_or_b32 s56, s56, 201326592
    ds_read_b64_tr_b16 a[214:215], v9 offset:18432
    s_and_b32 s45, s45, 3
    v_mfma_f32_16x16x32_bf16 v[228:231], a[196:199], a[0:3], v[228:231]
    s_sub_u32 s88, s72, s11
    s_sub_u32 s89, s73, s11
    s_max_u32 s88, s88, s89
    v_mfma_f32_16x16x32_bf16 v[196:199], a[192:195], a[0:3], v[196:199]
    s_waitcnt lgkmcnt(4)
    s_sub_u32 s89, s74, s11
    s_max_u32 s88, s88, s89
    v_mfma_f32_16x16x32_bf16 v[32:35], a[200:203], a[0:3], v[32:35]
    s_sub_u32 s89, s75, s11
    ds_read_b64_tr_b16 a[192:193], v10 offset:12288
    s_max_u32 s88, s88, s89
    v_mfma_f32_16x16x32_bf16 v[48:51], a[204:207], a[0:3], v[48:51]
    s_lshl_b32 s45, s45, 10
    ds_read_b64_tr_b16 a[194:195], v10 offset:18432
    s_add_u32 s45, s45, s56
    v_mfma_f32_16x16x32_bf16 v[52:55], a[204:207], a[4:7], v[52:55]
    s_cmp_gt_u32 s88, 4
    s_cbranch_scc1 spin_o1
spin_o1_ret:
    s_lshl_b32 s47, s41, 14
    v_mfma_f32_16x16x32_bf16 v[36:39], a[200:203], a[4:7], v[36:39]
    buffer_store_dwordx4 v[224:227], v28, s[20:23], s55 offen offset:0 sc1
    v_mfma_f32_16x16x32_bf16 v[40:43], a[200:203], a[8:11], v[40:43]
    s_add_u32 s47, s47, s45
    ds_read_b64_tr_b16 a[196:197], v11 offset:12288
    v_add_u32 v3, 4, v16
    v_mfma_f32_16x16x32_bf16 v[56:59], a[204:207], a[8:11], v[56:59]
    s_waitcnt vmcnt(8)
    ds_read_b64_tr_b16 a[198:199], v11 offset:18432
    s_waitcnt vmcnt(16)
    v_mfma_f32_16x16x32_bf16 v[60:63], a[204:207], a[12:15], v[60:63]
    buffer_store_dword v3, v17, s[24:27], s76 offen sc1
    v_mfma_f32_16x16x32_bf16 v[44:47], a[200:203], a[12:15], v[44:47]
    s_waitcnt lgkmcnt(4)
    buffer_load_dwordx4 a[48:51], v28, s[20:23], s8 offen offset:0 sc1
    v_mfma_f32_16x16x32_bf16 a[236:239], a[208:211], a[28:31], a[236:239]
    s_lshl_b32 s41, s41, 6
    ds_read_b64_tr_b16 a[200:201], v8 offset:13312
    s_lshl_b32 s48, s42, 14
    v_mfma_f32_16x16x32_bf16 a[252:255], a[212:215], a[28:31], a[252:255]
    s_add_u32 s48, s48, s45
    ds_read_b64_tr_b16 a[202:203], v8 offset:19456
    s_lshl_b32 s42, s42, 6
    v_mfma_f32_16x16x32_bf16 a[248:251], a[212:215], a[24:27], a[248:251]
    buffer_load_dwordx4 a[52:55], v28, s[20:23], s8 offen offset:1024 sc1
    v_mfma_f32_16x16x32_bf16 a[232:235], a[208:211], a[24:27], a[232:235]
    buffer_load_dwordx4 a[56:59], v28, s[20:23], s8 offen offset:2048 sc1
    v_mfma_f32_16x16x32_bf16 a[228:231], a[208:211], a[20:23], a[228:231]
    s_lshl_b32 s40, s43, 14
    ds_read_b64_tr_b16 a[204:205], v9 offset:13312
    v_add_f32 v64, v64, v72
    v_mfma_f32_16x16x32_bf16 a[244:247], a[212:215], a[20:23], a[244:247]
    s_add_u32 s40, s40, s45
    ds_read_b64_tr_b16 a[206:207], v9 offset:19456
    v_add_f32 v65, v65, v73
    v_mfma_f32_16x16x32_bf16 a[240:243], a[212:215], a[16:19], a[240:243]
    buffer_load_dwordx4 a[60:63], v28, s[20:23], s8 offen offset:3072 sc1
    v_mfma_f32_16x16x32_bf16 a[224:227], a[208:211], a[16:19], a[224:227]
    s_waitcnt lgkmcnt(4)
    v_add_f32 v66, v66, v74
    v_add_f32 v67, v67, v75
    v_mfma_f32_16x16x32_bf16 v[68:71], a[192:195], a[16:19], v[68:71]
    s_add_u32 s8, s8, 12288
    ds_read_b64_tr_b16 a[208:209], v10 offset:13312
    v_add_f32 v64, v64, v80
    v_mfma_f32_16x16x32_bf16 v[100:103], a[196:199], a[16:19], v[100:103]
    s_lshl_b32 s43, s43, 6
    ds_read_b64_tr_b16 a[210:211], v10 offset:19456
    v_add_u32 v23, 3211264, v23
    v_mfma_f32_16x16x32_bf16 v[108:111], a[196:199], a[20:23], v[108:111]
    buffer_store_dwordx4 v[232:235], v28, s[20:23], s55 offen offset:1024 sc1
    v_mfma_f32_16x16x32_bf16 v[76:79], a[192:195], a[20:23], v[76:79]
    v_add_f32 v65, v65, v81
    v_add_f32 v66, v66, v82
    v_mfma_f32_16x16x32_bf16 v[84:87], a[192:195], a[24:27], v[84:87]
    ds_read_b64_tr_b16 a[212:213], v11 offset:13312
    v_add_f32 v67, v67, v83
    v_mfma_f32_16x16x32_bf16 v[116:119], a[196:199], a[24:27], v[116:119]
    ds_read_b64_tr_b16 a[214:215], v11 offset:19456
    v_add_f32 v64, v64, v88
    v_mfma_f32_16x16x32_bf16 v[124:127], a[196:199], a[28:31], v[124:127]
    v_add_f32 v65, v65, v89
    v_add_f32 v66, v66, v90
    v_mfma_f32_16x16x32_bf16 v[92:95], a[192:195], a[28:31], v[92:95]
    s_waitcnt lgkmcnt(4)
    v_add_f32 v67, v67, v91
    v_add_f32 v64, v64, v96
    v_mfma_f32_16x16x32_bf16 v[156:159], a[200:203], a[28:31], v[156:159]
    ds_read_b64_tr_b16 a[192:193], v8 offset:14336
    v_add_f32 v65, v65, v97
    v_mfma_f32_16x16x32_bf16 v[188:191], a[204:207], a[28:31], v[188:191]
    ds_read_b64_tr_b16 a[194:195], v8 offset:20480
    v_add_f32 v66, v66, v98
    v_mfma_f32_16x16x32_bf16 v[180:183], a[204:207], a[24:27], v[180:183]
    v_add_f32 v67, v67, v99
    v_add_f32 v64, v64, v104
    v_mfma_f32_16x16x32_bf16 v[148:151], a[200:203], a[24:27], v[148:151]
    v_add_f32 v65, v65, v105
    v_add_f32 v66, v66, v106
    v_mfma_f32_16x16x32_bf16 v[140:143], a[200:203], a[20:23], v[140:143]
    ds_read_b64_tr_b16 a[196:197], v9 offset:14336
    v_add_f32 v67, v67, v107
    v_mfma_f32_16x16x32_bf16 v[172:175], a[204:207], a[20:23], v[172:175]
    s_waitcnt vmcnt(55)
    ds_read_b64_tr_b16 a[198:199], v9 offset:20480
    v_add_f32 v64, v64, v112
    v_mfma_f32_16x16x32_bf16 v[164:167], a[204:207], a[16:19], v[164:167]
    s_barrier
    v_mfma_f32_16x16x32_bf16 v[132:135], a[200:203], a[16:19], v[132:135]
    s_waitcnt lgkmcnt(4)
    v_add_f32 v65, v65, v113
    v_add_f32 v66, v66, v114
    v_add_u32 v8, 73728, v12
    v_mfma_f32_16x16x32_bf16 v[196:199], a[208:211], a[16:19], v[196:199]
    ds_read_b64_tr_b16 a[200:201], v8 offset:0
    v_add_f32 v67, v67, v115
    v_mfma_f32_16x16x32_bf16 v[228:231], a[212:215], a[16:19], v[228:231]
    ds_read_b64_tr_b16 a[202:203], v8 offset:6144
    v_add_f32 v64, v64, v120
    v_mfma_f32_16x16x32_bf16 v[236:239], a[212:215], a[20:23], v[236:239]
    buffer_store_dwordx4 v[240:243], v28, s[20:23], s55 offen offset:2048 sc1
    v_mfma_f32_16x16x32_bf16 v[204:207], a[208:211], a[20:23], v[204:207]
    v_add_f32 v65, v65, v121
    v_add_f32 v66, v66, v122
    v_add_u32 v9, 73728, v13
    v_mfma_f32_16x16x32_bf16 v[212:215], a[208:211], a[24:27], v[212:215]
    ds_read_b64_tr_b16 a[204:205], v9 offset:0
    v_add_f32 v67, v67, v123
    v_mfma_f32_16x16x32_bf16 v[244:247], a[212:215], a[24:27], v[244:247]
    ds_read_b64_tr_b16 a[206:207], v9 offset:6144
    v_add_f32 v64, v64, v128
    v_mfma_f32_16x16x32_bf16 v[252:255], a[212:215], a[28:31], v[252:255]
    v_add_f32 v65, v65, v129
    v_add_f32 v66, v66, v130
    v_mfma_f32_16x16x32_bf16 v[220:223], a[208:211], a[28:31], v[220:223]
    s_waitcnt lgkmcnt(4)
    v_add_f32 v67, v67, v131
    v_add_f32 v64, v64, v136
    v_add_u32 v10, 73728, v14
    v_mfma_f32_16x16x32_bf16 v[44:47], a[192:195], a[28:31], v[44:47]
    ds_read_b64_tr_b16 a[208:209], v10 offset:0
    v_add_f32 v65, v65, v137
    v_mfma_f32_16x16x32_bf16 v[60:63], a[196:199], a[28:31], v[60:63]
    ds_read_b64_tr_b16 a[210:211], v10 offset:6144
    v_add_f32 v66, v66, v138
    v_mfma_f32_16x16x32_bf16 v[56:59], a[196:199], a[24:27], v[56:59]
    v_add_f32 v67, v67, v139
    v_cvt_pk_bf16_f32 v64, v64, v64
    v_mfma_f32_16x16x32_bf16 v[40:43], a[192:195], a[24:27], v[40:43]
    v_and_b32 v64, 0xffff0000, v64
    v_cvt_pk_bf16_f32 v65, v65, v65
    v_add_u32 v11, 73728, v15
    v_mfma_f32_16x16x32_bf16 v[36:39], a[192:195], a[20:23], v[36:39]
    ds_read_b64_tr_b16 a[212:213], v11 offset:0
    v_and_b32 v65, 0xffff0000, v65
    v_mfma_f32_16x16x32_bf16 v[52:55], a[196:199], a[20:23], v[52:55]
    s_waitcnt vmcnt(10)
    ds_read_b64_tr_b16 a[214:215], v11 offset:6144
    v_cvt_pk_bf16_f32 v66, v66, v66
    v_mfma_f32_16x16x32_bf16 v[48:51], a[196:199], a[16:19], v[48:51]
    buffer_store_dwordx4 v[248:251], v28, s[20:23], s55 offen offset:3072 sc1
    v_mfma_f32_16x16x32_bf16 v[32:35], a[192:195], a[16:19], v[32:35]
    s_waitcnt lgkmcnt(4)
    v_and_b32 v66, 0xffff0000, v66
    v_cvt_pk_bf16_f32 v67, v67, v67
    v_mfma_f32_16x16x32_bf16 a[224:227], a[200:203], a[32:35], a[224:227]
    s_add_u32 s55, s55, 12288
    ds_read_b64_tr_b16 a[192:193], v8 offset:1024
    v_and_b32 v67, 0xffff0000, v67
    v_mfma_f32_16x16x32_bf16 a[240:243], a[204:207], a[32:35], a[240:243]
    s_add_u32 s11, s7, 3
    ds_read_b64_tr_b16 a[194:195], v8 offset:7168
    v_mul_f32 v72, s92, v64
    v_mfma_f32_16x16x32_bf16 a[244:247], a[204:207], a[36:39], a[244:247]
    s_load_dwordx4 s[72:75], s[86:87], s5 glc
    v_exp_f32 v72, v72
    v_mfma_f32_16x16x32_bf16 a[228:231], a[200:203], a[36:39], a[228:231]
    v_add_f32 v72, 1.0, v72
    v_mfma_f32_16x16x32_bf16 a[232:235], a[200:203], a[40:43], a[232:235]
    ds_read_b64_tr_b16 a[196:197], v9 offset:1024
    v_mfma_f32_16x16x32_bf16 a[248:251], a[204:207], a[40:43], a[248:251]
    ds_read_b64_tr_b16 a[198:199], v9 offset:7168
    v_mfma_f32_16x16x32_bf16 a[252:255], a[204:207], a[44:47], a[252:255]
    v_rcp_f32 v72, v72
    v_mfma_f32_16x16x32_bf16 a[236:239], a[200:203], a[44:47], a[236:239]
    s_waitcnt lgkmcnt(4)
    v_mul_f32 v64, v64, v72
    v_cvt_pk_bf16_f32 v64, v64, v64
    v_mfma_f32_16x16x32_bf16 v[92:95], a[208:211], a[44:47], v[92:95]
    ds_read_b64_tr_b16 a[200:201], v10 offset:1024
    v_and_b32 v64, 0xffff0000, v64
    v_mfma_f32_16x16x32_bf16 v[124:127], a[212:215], a[44:47], v[124:127]
    ds_read_b64_tr_b16 a[202:203], v10 offset:7168
    v_mul_f32 v64, v64, v66
    v_mfma_f32_16x16x32_bf16 v[116:119], a[212:215], a[40:43], v[116:119]
    buffer_load_dwordx4 a[64:67], v28, s[20:23], s9 offen offset:0 sc1
    v_mfma_f32_16x16x32_bf16 v[84:87], a[208:211], a[40:43], v[84:87]
    buffer_load_dwordx4 a[68:71], v28, s[20:23], s9 offen offset:1024 sc1
    v_mfma_f32_16x16x32_bf16 v[76:79], a[208:211], a[36:39], v[76:79]
    ds_read_b64_tr_b16 a[204:205], v11 offset:1024
    v_mul_f32 v73, s92, v65
    v_mfma_f32_16x16x32_bf16 v[108:111], a[212:215], a[36:39], v[108:111]
    ds_read_b64_tr_b16 a[206:207], v11 offset:7168
    v_mfma_f32_16x16x32_bf16 v[100:103], a[212:215], a[32:35], v[100:103]
    buffer_load_dwordx4 a[72:75], v28, s[20:23], s9 offen offset:2048 sc1
    v_mfma_f32_16x16x32_bf16 v[68:71], a[208:211], a[32:35], v[68:71]
    s_waitcnt lgkmcnt(4)
    v_add_u32 v3, 5, v16
    s_waitcnt vmcnt(12)
    v_mfma_f32_16x16x32_bf16 v[132:135], a[192:195], a[32:35], v[132:135]
    s_lshr_b32 s77, s2, 3
    ds_read_b64_tr_b16 a[208:209], v8 offset:2048
    s_lshl_b32 s77, s77, 2
    v_mfma_f32_16x16x32_bf16 v[164:167], a[196:199], a[32:35], v[164:167]
    s_add_u32 s77, s77, s3
    ds_read_b64_tr_b16 a[210:211], v8 offset:8192
    s_lshr_b32 s66, s77, 5
    v_mfma_f32_16x16x32_bf16 v[172:175], a[196:199], a[36:39], v[172:175]
    buffer_store_dword v3, v17, s[24:27], s76 offen sc1
    v_mfma_f32_16x16x32_bf16 v[140:143], a[192:195], a[36:39], v[140:143]
    buffer_load_dwordx4 a[76:79], v28, s[20:23], s9 offen offset:3072 sc1
    v_mfma_f32_16x16x32_bf16 v[148:151], a[192:195], a[40:43], v[148:151]
    s_add_u32 s9, s9, 12288
    ds_read_b64_tr_b16 a[212:213], v9 offset:2048
    s_mul_i32 s66, s66, 245760
    v_mfma_f32_16x16x32_bf16 v[180:183], a[196:199], a[40:43], v[180:183]
    s_and_b32 s77, s77, 31
    ds_read_b64_tr_b16 a[214:215], v9 offset:8192
    s_mul_i32 s77, s77, 3840
    v_mfma_f32_16x16x32_bf16 v[188:191], a[196:199], a[44:47], v[188:191]
    buffer_load_dwordx4 a[80:83], v28, s[20:23], s10 offen offset:0 sc1
    v_mfma_f32_16x16x32_bf16 v[156:159], a[192:195], a[44:47], v[156:159]
    s_waitcnt lgkmcnt(4)
    v_exp_f32 v73, v73
    v_mfma_f32_16x16x32_bf16 v[220:223], a[200:203], a[44:47], v[220:223]
    s_sub_u32 s88, s72, s11
    ds_read_b64_tr_b16 a[192:193], v8 offset:12288
    v_add_f32 v73, 1.0, v73
    v_mfma_f32_16x16x32_bf16 v[252:255], a[204:207], a[44:47], v[252:255]
    s_sub_u32 s89, s73, s11
    ds_read_b64_tr_b16 a[194:195], v8 offset:18432
    v_cmp_lt_u32 s[78:79], 31, v1
    v_mfma_f32_16x16x32_bf16 v[244:247], a[204:207], a[40:43], v[244:247]
    buffer_load_dwordx4 a[84:87], v28, s[20:23], s10 offen offset:1024 sc1
    v_mfma_f32_16x16x32_bf16 v[212:215], a[200:203], a[40:43], v[212:215]
    buffer_load_dwordx4 a[88:91], v28, s[20:23], s10 offen offset:2048 sc1
    v_mfma_f32_16x16x32_bf16 v[204:207], a[200:203], a[36:39], v[204:207]
    s_max_u32 s88, s88, s89
    ds_read_b64_tr_b16 a[196:197], v9 offset:12288
    v_mov_b32 v195, s70
    v_mfma_f32_16x16x32_bf16 v[236:239], a[204:207], a[36:39], v[236:239]
    s_sub_u32 s89, s74, s11
    ds_read_b64_tr_b16 a[198:199], v9 offset:18432
    v_mov_b32 v192, s71
    v_mfma_f32_16x16x32_bf16 v[228:231], a[204:207], a[32:35], v[228:231]
    buffer_load_dwordx4 a[92:95], v28, s[20:23], s10 offen offset:3072 sc1
    v_mfma_f32_16x16x32_bf16 v[196:199], a[200:203], a[32:35], v[196:199]
    s_waitcnt lgkmcnt(4)
    v_rcp_f32 v73, v73
    v_mfma_f32_16x16x32_bf16 v[32:35], a[208:211], a[32:35], v[32:35]
    s_add_u32 s10, s10, 12288
    ds_read_b64_tr_b16 a[200:201], v10 offset:12288
    v_mul_f32 v65, v65, v73
    v_mfma_f32_16x16x32_bf16 v[48:51], a[212:215], a[32:35], v[48:51]
    s_max_u32 s88, s88, s89
    ds_read_b64_tr_b16 a[202:203], v10 offset:18432
    v_cvt_pk_bf16_f32 v65, v65, v65
    v_mfma_f32_16x16x32_bf16 v[52:55], a[212:215], a[36:39], v[52:55]
    s_sub_u32 s89, s75, s11
    v_and_b32 v65, 0xffff0000, v65
    v_mul_f32 v65, v65, v67
    v_mfma_f32_16x16x32_bf16 v[36:39], a[208:211], a[36:39], v[36:39]
    s_max_u32 s88, s88, s89
    v_cvt_pk_bf16_f32 v64, v64, v65
    v_cndmask_b32 v195, v195, v192, s[78:79]
    v_mfma_f32_16x16x32_bf16 v[40:43], a[208:211], a[40:43], v[40:43]
    s_lshl_b32 s61, s3, 8
    ds_read_b64_tr_b16 a[204:205], v11 offset:12288
    v_bfe_u32 v194, v1, 3, 2
    v_mfma_f32_16x16x32_bf16 v[56:59], a[212:215], a[40:43], v[56:59]
    s_waitcnt vmcnt(12)
    ds_read_b64_tr_b16 a[206:207], v11 offset:18432
    v_mov_b32 v192, s41
    v_mfma_f32_16x16x32_bf16 v[60:63], a[212:215], a[44:47], v[60:63]
    s_cmp_gt_u32 s88, 3
    s_cbranch_scc1 spin_o2
spin_o2_ret:
    v_mov_b32 v193, s42
    v_mfma_f32_16x16x32_bf16 v[44:47], a[208:211], a[44:47], v[44:47]
    s_waitcnt lgkmcnt(4)
    buffer_load_dwordx4 a[96:99], v28, s[20:23], s8 offen offset:0 sc1
    v_mfma_f32_16x16x32_bf16 a[236:239], a[192:195], a[60:63], a[236:239]
    s_add_u32 s61, s61, 157696
    ds_read_b64_tr_b16 a[208:209], v8 offset:13312
    v_lshlrev_b32 v80, 1, v1
    v_mfma_f32_16x16x32_bf16 a[252:255], a[196:199], a[60:63], a[252:255]
    s_add_u32 s66, s66, s77
    ds_read_b64_tr_b16 a[210:211], v8 offset:19456
    v_add_u32 v80, s61, v80
    v_mfma_f32_16x16x32_bf16 a[248:251], a[196:199], a[56:59], a[248:251]
    buffer_load_dwordx4 a[100:103], v28, s[20:23], s8 offen offset:1024 sc1
    v_mfma_f32_16x16x32_bf16 a[232:235], a[192:195], a[56:59], a[232:235]
    buffer_load_dwordx4 a[104:107], v28, s[20:23], s8 offen offset:2048 sc1
    v_mfma_f32_16x16x32_bf16 a[228:231], a[192:195], a[52:55], a[228:231]
    s_add_u32 m0, s44, 147456
    ds_read_b64_tr_b16 a[212:213], v9 offset:13312
    v_and_b32 v81, 1, v1
    v_mfma_f32_16x16x32_bf16 a[244:247], a[196:199], a[52:55], a[244:247]
    s_mul_i32 s77, s51, 320
    ds_read_b64_tr_b16 a[214:215], v9 offset:19456
    v_lshlrev_b32 v81, 7, v81
    v_mfma_f32_16x16x32_bf16 a[240:243], a[196:199], a[48:51], a[240:243]
    buffer_load_dwordx4 v6, s[28:31], s59 offen lds
    v_mfma_f32_16x16x32_bf16 a[224:227], a[192:195], a[48:51], a[224:227]
    s_waitcnt lgkmcnt(4)
    buffer_load_dwordx4 a[108:111], v28, s[20:23], s8 offen offset:3072 sc1
    v_mfma_f32_16x16x32_bf16 v[68:71], a[200:203], a[48:51], v[68:71]
    s_add_u32 s8, s8, 4096
    ds_read_b64_tr_b16 a[192:193], v10 offset:13312
    v_lshrrev_b32 v83, 4, v1
    v_mfma_f32_16x16x32_bf16 v[100:103], a[204:207], a[48:51], v[100:103]
    s_add_u32 m0, s44, 148480
    ds_read_b64_tr_b16 a[194:195], v10 offset:19456
    v_lshl_add_u32 v81, v83, 4, v81
    v_mfma_f32_16x16x32_bf16 v[108:111], a[204:207], a[52:55], v[108:111]
    buffer_load_dwordx4 v7, s[28:31], s59 offen lds
    v_mfma_f32_16x16x32_bf16 v[76:79], a[200:203], a[52:55], v[76:79]
    s_and_b32 s77, s77, 0xffffff80
    v_add_u32 v81, s61, v81
    v_bfe_u32 v83, v1, 2, 3
    v_mfma_f32_16x16x32_bf16 v[84:87], a[200:203], a[56:59], v[84:87]
    s_sub_u32 s66, s66, s77
    ds_read_b64_tr_b16 a[196:197], v11 offset:13312
    v_lshlrev_b32 v82, 7, v83
    v_mfma_f32_16x16x32_bf16 v[116:119], a[204:207], a[56:59], v[116:119]
    s_add_u32 s66, s66, 122880
    ds_read_b64_tr_b16 a[198:199], v11 offset:19456
    v_lshrrev_b32 v83, 1, v83
    v_mfma_f32_16x16x32_bf16 v[124:127], a[204:207], a[60:63], v[124:127]
    v_xor_b32 v83, s3, v83
    v_lshl_add_u32 v82, v83, 5, v82
    v_mfma_f32_16x16x32_bf16 v[92:95], a[200:203], a[60:63], v[92:95]
    s_waitcnt lgkmcnt(4)
    v_and_b32 v83, 3, v1
    v_lshl_add_u32 v82, v83, 3, v82
    v_mfma_f32_16x16x32_bf16 v[156:159], a[208:211], a[60:63], v[156:159]
    ds_read_b64_tr_b16 a[200:201], v8 offset:14336
    v_lshrrev_b32 v83, 5, v1
    v_mfma_f32_16x16x32_bf16 v[188:191], a[212:215], a[60:63], v[188:191]
    ds_read_b64_tr_b16 a[202:203], v8 offset:20480
    v_mul_u32_u24 v83, 1024, v83
    v_mfma_f32_16x16x32_bf16 v[180:183], a[212:215], a[56:59], v[180:183]
    v_add_u32 v82, v82, v83
    v_add_u32 v82, 147456, v82
    v_mfma_f32_16x16x32_bf16 v[148:151], a[208:211], a[56:59], v[148:151]
    v_lshlrev_b32 v74, 2, v1
    v_cmp_gt_u32 vcc, 16, v1
    v_mfma_f32_16x16x32_bf16 v[140:143], a[208:211], a[52:55], v[140:143]
    ds_read_b64_tr_b16 a[204:205], v9 offset:14336
    v_mov_b32 v83, 0x7ffffff0
    v_mfma_f32_16x16x32_bf16 v[172:175], a[212:215], a[52:55], v[172:175]
    s_waitcnt vmcnt(62)
    ds_read_b64_tr_b16 a[206:207], v9 offset:20480
    v_cndmask_b32 v74, v83, v74, vcc
    v_mfma_f32_16x16x32_bf16 v[164:167], a[212:215], a[48:51], v[164:167]
    s_barrier
    v_mfma_f32_16x16x32_bf16 v[132:135], a[208:211], a[48:51], v[132:135]
    s_waitcnt lgkmcnt(4)
    v_min_u32 v232, 29, v1
    v_lshlrev_b32 v232, 7, v232
    v_add_u32 v8, 98304, v12
    v_mfma_f32_16x16x32_bf16 v[196:199], a[192:195], a[48:51], v[196:199]
    ds_read_b64_tr_b16 a[208:209], v8 offset:0
    v_cmp_eq_u32 s[78:79], 1, v194
    v_mfma_f32_16x16x32_bf16 v[228:231], a[196:199], a[48:51], v[228:231]
    ds_read_b64_tr_b16 a[210:211], v8 offset:6144
    v_cndmask_b32 v192, v192, v193, s[78:79]
    v_mfma_f32_16x16x32_bf16 v[236:239], a[196:199], a[52:55], v[236:239]
    v_mov_b32 v193, s43
    v_cmp_lt_u32 s[78:79], 1, v194
    v_mfma_f32_16x16x32_bf16 v[204:207], a[192:195], a[52:55], v[204:207]
    v_add_u32 v10, 98304, v14
    v_cndmask_b32 v192, v192, v193, s[78:79]
    v_add_u32 v9, 98304, v13
    v_mfma_f32_16x16x32_bf16 v[212:215], a[192:195], a[56:59], v[212:215]
    ds_read_b64_tr_b16 a[212:213], v9 offset:0
    v_and_b32 v193, 7, v1
    v_mfma_f32_16x16x32_bf16 v[244:247], a[196:199], a[56:59], v[244:247]
    ds_read_b64_tr_b16 a[214:215], v9 offset:6144
    v_lshl_add_u32 v192, v193, 3, v192
    v_mfma_f32_16x16x32_bf16 v[252:255], a[196:199], a[60:63], v[252:255]
    s_add_u32 s11, s7, 4
    v_and_b32 v194, 0x7ff, v195
    v_sub_u32 v194, 2047, v194
    v_mfma_f32_16x16x32_bf16 v[220:223], a[192:195], a[60:63], v[220:223]
    s_waitcnt lgkmcnt(4)
    v_mul_u32_u24 v193, 1280, v194
    v_add_u32 v193, v193, v192
    v_mfma_f32_16x16x32_bf16 v[44:47], a[200:203], a[60:63], v[44:47]
    s_load_dwordx4 s[72:75], s[86:87], s5 glc
    ds_read_b64_tr_b16 a[192:193], v10 offset:0
    v_add_u32 v3, 6, v16
    v_mfma_f32_16x16x32_bf16 v[60:63], a[204:207], a[60:63], v[60:63]
    s_waitcnt vmcnt(15)
    ds_read_b64_tr_b16 a[194:195], v10 offset:6144
    v_lshlrev_b32 v194, 3, v194
    v_mfma_f32_16x16x32_bf16 v[56:59], a[204:207], a[56:59], v[56:59]
    buffer_store_dword v3, v17, s[24:27], s76 offen sc1
    v_mfma_f32_16x16x32_bf16 v[40:43], a[200:203], a[56:59], v[40:43]
    v_add_u32 v194, 3211264, v194
    v_add_u32 v11, 98304, v15
    v_mfma_f32_16x16x32_bf16 v[36:39], a[200:203], a[52:55], v[36:39]
    ds_read_b64_tr_b16 a[196:197], v11 offset:0
    v_mfma_f32_16x16x32_bf16 v[52:55], a[204:207], a[52:55], v[52:55]
    s_waitcnt vmcnt(11)
    ds_read_b64_tr_b16 a[198:199], v11 offset:6144
    v_mfma_f32_16x16x32_bf16 v[48:51], a[204:207], a[48:51], v[48:51]
    v_mfma_f32_16x16x32_bf16 v[32:35], a[200:203], a[48:51], v[32:35]
    s_waitcnt lgkmcnt(4)
    v_mfma_f32_16x16x32_bf16 a[224:227], a[208:211], a[64:67], a[224:227]
    ds_read_b64_tr_b16 a[200:201], v8 offset:1024
    v_mfma_f32_16x16x32_bf16 a[240:243], a[212:215], a[64:67], a[240:243]
    ds_read_b64_tr_b16 a[202:203], v8 offset:7168
    v_mfma_f32_16x16x32_bf16 a[244:247], a[212:215], a[68:71], a[244:247]
    buffer_load_dwordx4 a[112:115], v28, s[20:23], s9 offen offset:0 sc1
    v_mfma_f32_16x16x32_bf16 a[228:231], a[208:211], a[68:71], a[228:231]
    buffer_load_dwordx4 a[116:119], v28, s[20:23], s9 offen offset:1024 sc1
    v_mfma_f32_16x16x32_bf16 a[232:235], a[208:211], a[72:75], a[232:235]
    s_lshr_b32 s55, s54, 1
    ds_read_b64_tr_b16 a[204:205], v9 offset:1024
    v_mfma_f32_16x16x32_bf16 a[248:251], a[212:215], a[72:75], a[248:251]
    s_lshl_b32 s55, s55, 19
    ds_read_b64_tr_b16 a[206:207], v9 offset:7168
    v_mfma_f32_16x16x32_bf16 a[252:255], a[212:215], a[76:79], a[252:255]
    buffer_load_dwordx4 a[120:123], v28, s[20:23], s9 offen offset:2048 sc1
    v_mfma_f32_16x16x32_bf16 a[236:239], a[208:211], a[76:79], a[236:239]
    s_waitcnt lgkmcnt(4)
    s_and_b32 s60, s54, 1
    s_lshl_b32 s60, s60, 12
    v_mfma_f32_16x16x32_bf16 v[92:95], a[192:195], a[76:79], v[92:95]
    s_or_b32 s55, s55, s60
    ds_read_b64_tr_b16 a[208:209], v10 offset:1024
    s_lshl_b32 s60, s54, 10
    v_mfma_f32_16x16x32_bf16 v[124:127], a[196:199], a[76:79], v[124:127]
    s_and_b32 s60, s60, 0x2000
    ds_read_b64_tr_b16 a[210:211], v10 offset:7168
    s_or_b32 s55, s55, s60
    v_mfma_f32_16x16x32_bf16 v[116:119], a[196:199], a[72:75], v[116:119]
    buffer_load_dwordx4 a[124:127], v28, s[20:23], s9 offen offset:3072 sc1
    v_mfma_f32_16x16x32_bf16 v[84:87], a[192:195], a[72:75], v[84:87]
    s_add_u32 s9, s9, 4096
    s_or_b32 s55, s55, 201326592
    s_mul_i32 s60, s51, 81920
    v_mfma_f32_16x16x32_bf16 v[76:79], a[192:195], a[68:71], v[76:79]
    s_add_u32 s55, s55, s60
    ds_read_b64_tr_b16 a[212:213], v11 offset:1024
    s_mul_i32 s60, s53, 8389632
    v_mfma_f32_16x16x32_bf16 v[108:111], a[196:199], a[68:71], v[108:111]
    s_xor_b32 s55, s55, s60
    ds_read_b64_tr_b16 a[214:215], v11 offset:7168
    s_add_u32 s60, s51, 8
    v_mfma_f32_16x16x32_bf16 v[100:103], a[196:199], a[64:67], v[100:103]
    buffer_load_dwordx4 a[128:131], v28, s[20:23], s10 offen offset:0 sc1
    v_mfma_f32_16x16x32_bf16 v[68:71], a[192:195], a[64:67], v[68:71]
    s_waitcnt lgkmcnt(4)
    s_sub_u32 s88, s72, s11
    s_sub_u32 s89, s73, s11
    v_mfma_f32_16x16x32_bf16 v[132:135], a[200:203], a[64:67], v[132:135]
    s_max_u32 s88, s88, s89
    ds_read_b64_tr_b16 a[192:193], v8 offset:2048
    s_sub_u32 s89, s74, s11
    v_mfma_f32_16x16x32_bf16 v[164:167], a[204:207], a[64:67], v[164:167]
    s_max_u32 s88, s88, s89
    ds_read_b64_tr_b16 a[194:195], v8 offset:8192
    s_sub_u32 s89, s75, s11
    v_mfma_f32_16x16x32_bf16 v[172:175], a[204:207], a[68:71], v[172:175]
    buffer_load_dwordx4 a[132:135], v28, s[20:23], s10 offen offset:1024 sc1
    v_mfma_f32_16x16x32_bf16 v[140:143], a[200:203], a[68:71], v[140:143]
    buffer_load_dwordx4 a[136:139], v28, s[20:23], s10 offen offset:2048 sc1
    v_mfma_f32_16x16x32_bf16 v[148:151], a[200:203], a[72:75], v[148:151]
    s_max_u32 s88, s88, s89
    ds_read_b64_tr_b16 a[196:197], v9 offset:2048
    s_lshr_b32 s60, s93, s60
    v_mfma_f32_16x16x32_bf16 v[180:183], a[204:207], a[72:75], v[180:183]
    s_and_b32 s60, s60, 0x2000
    ds_read_b64_tr_b16 a[198:199], v9 offset:8192
    s_xor_b32 s55, s55, s60
    v_mfma_f32_16x16x32_bf16 v[188:191], a[204:207], a[76:79], v[188:191]
    s_cmp_gt_u32 s88, 2
    s_cbranch_scc1 spin_o3
spin_o3_ret:
    v_mfma_f32_16x16x32_bf16 v[156:159], a[200:203], a[76:79], v[156:159]
    s_waitcnt lgkmcnt(4)
    buffer_load_dwordx4 a[144:147], v28, s[20:23], s8 offen offset:0 sc1
    v_mfma_f32_16x16x32_bf16 v[220:223], a[208:211], a[76:79], v[220:223]
    ds_read_b64_tr_b16 a[200:201], v8 offset:12288
    v_mfma_f32_16x16x32_bf16 v[252:255], a[212:215], a[76:79], v[252:255]
    ds_read_b64_tr_b16 a[202:203], v8 offset:18432
    v_mfma_f32_16x16x32_bf16 v[244:247], a[212:215], a[72:75], v[244:247]
    buffer_load_dwordx4 a[140:143], v28, s[20:23], s10 offen offset:3072 sc1
    v_mfma_f32_16x16x32_bf16 v[212:215], a[208:211], a[72:75], v[212:215]
    buffer_load_dwordx4 a[148:151], v28, s[20:23], s8 offen offset:1024 sc1
    v_mfma_f32_16x16x32_bf16 v[204:207], a[208:211], a[68:71], v[204:207]
    s_add_u32 s10, s10, 4096
    ds_read_b64_tr_b16 a[204:205], v9 offset:12288
    v_mfma_f32_16x16x32_bf16 v[236:239], a[212:215], a[68:71], v[236:239]
    ds_read_b64_tr_b16 a[206:207], v9 offset:18432
    v_mfma_f32_16x16x32_bf16 v[228:231], a[212:215], a[64:67], v[228:231]
    buffer_load_dwordx2 v[24:25], v23, s[24:27], 0 offen sc1
    v_mfma_f32_16x16x32_bf16 v[196:199], a[208:211], a[64:67], v[196:199]
    s_waitcnt lgkmcnt(4)
    buffer_load_dwordx4 a[152:155], v28, s[20:23], s8 offen offset:2048 sc1
    v_mfma_f32_16x16x32_bf16 v[32:35], a[192:195], a[64:67], v[32:35]
    ds_read_b64_tr_b16 a[208:209], v10 offset:12288
    v_mfma_f32_16x16x32_bf16 v[48:51], a[196:199], a[64:67], v[48:51]
    ds_read_b64_tr_b16 a[210:211], v10 offset:18432
    v_mfma_f32_16x16x32_bf16 v[52:55], a[196:199], a[68:71], v[52:55]
    buffer_load_dwordx2 v[200:201], v193, s[16:19], 0 offen
    v_mfma_f32_16x16x32_bf16 v[36:39], a[192:195], a[68:71], v[36:39]
    buffer_load_dwordx4 a[156:159], v28, s[20:23], s8 offen offset:3072 sc1
    v_mfma_f32_16x16x32_bf16 v[40:43], a[192:195], a[72:75], v[40:43]
    s_add_u32 s8, s8, 12288
    ds_read_b64_tr_b16 a[212:213], v11 offset:12288
    v_mfma_f32_16x16x32_bf16 v[56:59], a[196:199], a[72:75], v[56:59]
    s_waitcnt vmcnt(21)
    ds_read_b64_tr_b16 a[214:215], v11 offset:18432
    v_mfma_f32_16x16x32_bf16 v[60:63], a[196:199], a[76:79], v[60:63]
pg_10:
    s_cbranch_execz pg_ret2
    buffer_load_dwordx4 v[144:147], v22, s[16:19], s41 offen
    v_mfma_f32_16x16x32_bf16 v[44:47], a[192:195], a[76:79], v[44:47]
    s_waitcnt lgkmcnt(4)
    buffer_load_dword a217, v232, s[12:15], s66 offen
    v_mfma_f32_16x16x32_bf16 a[236:239], a[200:203], a[92:95], a[236:239]
    ds_read_b64_tr_b16 a[192:193], v8 offset:13312
    v_mfma_f32_16x16x32_bf16 a[252:255], a[204:207], a[92:95], a[252:255]
    ds_read_b64_tr_b16 a[194:195], v8 offset:19456
    v_mfma_f32_16x16x32_bf16 a[248:251], a[204:207], a[88:91], a[248:251]
    buffer_load_dwordx2 v[202:203], v194, s[24:27], 0 offen sc1
    v_mfma_f32_16x16x32_bf16 a[232:235], a[200:203], a[88:91], a[232:235]
    buffer_load_dwordx4 v[152:155], v22, s[16:19], s42 offen
    v_mfma_f32_16x16x32_bf16 a[228:231], a[200:203], a[84:87], a[228:231]
    ds_read_b64_tr_b16 a[196:197], v9 offset:13312
    v_lshrrev_b32 v136, 5, v192
    v_mfma_f32_16x16x32_bf16 a[244:247], a[204:207], a[84:87], a[244:247]
    ds_read_b64_tr_b16 a[198:199], v9 offset:19456
    v_lshlrev_b32 v136, 9, v136
    v_mfma_f32_16x16x32_bf16 a[240:243], a[204:207], a[80:83], a[240:243]
    buffer_load_dwordx4 v[160:163], v22, s[16:19], s43 offen
    v_mfma_f32_16x16x32_bf16 a[224:227], a[200:203], a[80:83], a[224:227]
    s_waitcnt lgkmcnt(4)
    v_and_b32 v192, 31, v192
    v_lshl_add_u32 v192, v192, 1, v136
    v_mfma_f32_16x16x32_bf16 v[68:71], a[208:211], a[80:83], v[68:71]
    ds_read_b64_tr_b16 a[200:201], v10 offset:13312
    v_lshrrev_b32 v193, 5, v1
    v_mfma_f32_16x16x32_bf16 v[100:103], a[212:215], a[80:83], v[100:103]
    ds_read_b64_tr_b16 a[202:203], v10 offset:19456
    v_lshl_add_u32 v192, v193, 8, v192
    v_mfma_f32_16x16x32_bf16 v[108:111], a[212:215], a[84:87], v[108:111]
    v_and_b32 v195, 0xffff0000, v195
    v_ashrrev_i32 v193, 31, v195
    v_mfma_f32_16x16x32_bf16 v[76:79], a[208:211], a[84:87], v[76:79]
    v_not_b32 v193, v193
    v_or_b32 v193, 0x80000000, v193
    v_mfma_f32_16x16x32_bf16 v[84:87], a[208:211], a[88:91], v[84:87]
    ds_read_b64_tr_b16 a[204:205], v11 offset:13312
    v_xor_b32 v195, v195, v193
    v_mfma_f32_16x16x32_bf16 v[116:119], a[212:215], a[88:91], v[116:119]
    ds_read_b64_tr_b16 a[206:207], v11 offset:19456
    v_and_b32 v195, 0xffff0000, v195
    v_mfma_f32_16x16x32_bf16 v[124:127], a[212:215], a[92:95], v[124:127]
    v_mul_f32 v195, s92, v195
    v_add_u32 v10, 49152, v14
    v_mfma_f32_16x16x32_bf16 v[92:95], a[208:211], a[92:95], v[92:95]
    s_waitcnt lgkmcnt(4)
    v_exp_f32 v195, v195
    v_mfma_f32_16x16x32_bf16 v[156:159], a[192:195], a[92:95], v[156:159]
    ds_read_b64_tr_b16 a[208:209], v8 offset:14336
    v_add_f32 v195, 1.0, v195
    v_mfma_f32_16x16x32_bf16 v[188:191], a[196:199], a[92:95], v[188:191]
    ds_read_b64_tr_b16 a[210:211], v8 offset:20480
    v_add_u32 v11, 49152, v15
    v_mfma_f32_16x16x32_bf16 v[180:183], a[196:199], a[88:91], v[180:183]
    v_rcp_f32 v195, v195
    v_mfma_f32_16x16x32_bf16 v[148:151], a[192:195], a[88:91], v[148:151]
    v_cvt_pk_bf16_f32 v195, v195, v195
    v_and_b32 v195, 0xffff0000, v195
    v_mfma_f32_16x16x32_bf16 v[140:143], a[192:195], a[84:87], v[140:143]
    ds_read_b64_tr_b16 a[212:213], v9 offset:14336
    v_add_u32 v8, 49152, v12
    v_mfma_f32_16x16x32_bf16 v[172:175], a[196:199], a[84:87], v[172:175]
    s_waitcnt vmcnt(20)
    ds_read_b64_tr_b16 a[214:215], v9 offset:20480
    v_mfma_f32_16x16x32_bf16 v[164:167], a[196:199], a[80:83], v[164:167]
    s_barrier
    v_mfma_f32_16x16x32_bf16 v[132:135], a[192:195], a[80:83], v[132:135]
    s_waitcnt lgkmcnt(4)
    v_add_u32 v9, 49152, v13
    s_add_u32 s11, s7, 5
    v_mfma_f32_16x16x32_bf16 v[196:199], a[200:203], a[80:83], v[196:199]
    s_load_dwordx4 s[72:75], s[86:87], s5 glc
    ds_read_b64_tr_b16 a[192:193], v8 offset:0
    v_mfma_f32_16x16x32_bf16 v[228:231], a[204:207], a[80:83], v[228:231]
    ds_read_b64_tr_b16 a[194:195], v8 offset:6144
    v_mfma_f32_16x16x32_bf16 v[236:239], a[204:207], a[84:87], v[236:239]
    v_mfma_f32_16x16x32_bf16 v[204:207], a[200:203], a[84:87], v[204:207]
    v_mfma_f32_16x16x32_bf16 v[212:215], a[200:203], a[88:91], v[212:215]
    ds_read_b64_tr_b16 a[196:197], v9 offset:0
    v_mfma_f32_16x16x32_bf16 v[244:247], a[204:207], a[88:91], v[244:247]
    ds_read_b64_tr_b16 a[198:199], v9 offset:6144
    v_mfma_f32_16x16x32_bf16 v[252:255], a[204:207], a[92:95], v[252:255]
    ds_write_b16 v80, v64
    v_mfma_f32_16x16x32_bf16 v[220:223], a[200:203], a[92:95], v[220:223]
    s_waitcnt lgkmcnt(4)
    ds_write_b16_d16_hi v80, v64 offset:128
    v_mfma_f32_16x16x32_bf16 v[44:47], a[208:211], a[92:95], v[44:47]
    ds_read_b64_tr_b16 a[200:201], v10 offset:0
    v_mfma_f32_16x16x32_bf16 v[60:63], a[212:215], a[92:95], v[60:63]
    ds_read_b64_tr_b16 a[202:203], v10 offset:6144
    v_mfma_f32_16x16x32_bf16 v[56:59], a[212:215], a[88:91], v[56:59]
    ds_read_b128 v[88:91], v81
    v_mfma_f32_16x16x32_bf16 v[40:43], a[208:211], a[88:91], v[40:43]
    buffer_load_dwordx4 a[160:163], v28, s[20:23], s9 offen offset:0 sc1
    v_mfma_f32_16x16x32_bf16 v[36:39], a[208:211], a[84:87], v[36:39]
    ds_read_b64_tr_b16 a[204:205], v11 offset:0
    v_mfma_f32_16x16x32_bf16 v[52:55], a[212:215], a[84:87], v[52:55]
    s_waitcnt vmcnt(22)
    ds_read_b64_tr_b16 a[206:207], v11 offset:6144
    v_mfma_f32_16x16x32_bf16 v[48:51], a[212:215], a[80:83], v[48:51]
    ds_read_b128 v[96:99], v81 offset:64
    v_mfma_f32_16x16x32_bf16 v[32:35], a[208:211], a[80:83], v[32:35]
    s_waitcnt lgkmcnt(4)
    ds_read_b64_tr_b16 v[104:105], v82
    v_mfma_f32_16x16x32_bf16 a[224:227], a[192:195], a[96:99], a[224:227]
    ds_read_b64_tr_b16 a[208:209], v8 offset:1024
    v_mfma_f32_16x16x32_bf16 a[240:243], a[196:199], a[96:99], a[240:243]
    ds_read_b64_tr_b16 a[210:211], v8 offset:7168
    v_mfma_f32_16x16x32_bf16 a[244:247], a[196:199], a[100:103], a[244:247]
    ds_read_b64_tr_b16 v[106:107], v82 offset:2048
    v_mfma_f32_16x16x32_bf16 a[228:231], a[192:195], a[100:103], a[228:231]
    buffer_load_dwordx4 a[164:167], v28, s[20:23], s9 offen offset:1024 sc1
    v_mfma_f32_16x16x32_bf16 a[232:235], a[192:195], a[104:107], a[232:235]
    s_add_u32 m0, s36, 122880
    ds_read_b64_tr_b16 a[212:213], v9 offset:1024
    s_add_u32 s38, s34, 122880
    v_mfma_f32_16x16x32_bf16 a[248:251], a[196:199], a[104:107], a[248:251]
    s_add_u32 s57, s35, 122880
    ds_read_b64_tr_b16 a[214:215], v9 offset:7168
    s_cmp_lt_u32 s3, 2
    s_cselect_b32 s38, s38, s57
    v_mfma_f32_16x16x32_bf16 a[252:255], a[196:199], a[108:111], a[252:255]
    s_sub_u32 s88, s72, s11
    ds_read_b64_tr_b16 v[112:113], v82 offset:4096
    s_sub_u32 s89, s73, s11
    v_mfma_f32_16x16x32_bf16 a[236:239], a[192:195], a[108:111], a[236:239]
    s_waitcnt lgkmcnt(4)
    ds_read_b64_tr_b16 v[114:115], v82 offset:6144
    s_max_u32 s88, s88, s89
    v_mfma_f32_16x16x32_bf16 v[92:95], a[200:203], a[108:111], v[92:95]
    s_sub_u32 s89, s74, s11
    ds_read_b64_tr_b16 a[192:193], v10 offset:1024
    s_max_u32 s88, s88, s89
    v_mfma_f32_16x16x32_bf16 v[124:127], a[204:207], a[108:111], v[124:127]
    s_sub_u32 s89, s75, s11
    ds_read_b64_tr_b16 a[194:195], v10 offset:7168
    s_max_u32 s88, s88, s89
    v_mfma_f32_16x16x32_bf16 v[116:119], a[204:207], a[104:107], v[116:119]
    s_cmp_gt_u32 s88, 1
    s_cbranch_scc1 spin_o4
spin_o4_ret:
    v_mfma_f32_16x16x32_bf16 v[84:87], a[200:203], a[104:107], v[84:87]
    buffer_load_dwordx4 a[168:171], v28, s[20:23], s9 offen offset:2048 sc1
    v_mfma_f32_16x16x32_bf16 v[76:79], a[200:203], a[100:103], v[76:79]
    ds_read_b64_tr_b16 a[196:197], v11 offset:1024
    v_mfma_f32_16x16x32_bf16 v[108:111], a[204:207], a[100:103], v[108:111]
    ds_read_b64_tr_b16 a[198:199], v11 offset:7168
    v_mfma_f32_16x16x32_bf16 v[100:103], a[204:207], a[96:99], v[100:103]
    buffer_load_dwordx4 a[172:175], v28, s[20:23], s9 offen offset:3072 sc1
    v_mfma_f32_16x16x32_bf16 v[68:71], a[200:203], a[96:99], v[68:71]
    s_waitcnt lgkmcnt(4)
    buffer_load_dwordx4 a[176:179], v28, s[20:23], s10 offen offset:0 sc1
    v_mfma_f32_16x16x32_bf16 v[132:135], a[208:211], a[96:99], v[132:135]
    s_add_u32 s9, s9, 12288
    ds_read_b64_tr_b16 a[200:201], v8 offset:2048
    v_mfma_f32_16x16x32_bf16 v[164:167], a[212:215], a[96:99], v[164:167]
    ds_read_b64_tr_b16 a[202:203], v8 offset:8192
    v_mfma_f32_16x16x32_bf16 v[172:175], a[212:215], a[100:103], v[172:175]
    buffer_load_dwordx4 a[180:183], v28, s[20:23], s10 offen offset:1024 sc1
    v_mfma_f32_16x16x32_bf16 v[140:143], a[208:211], a[100:103], v[140:143]
    buffer_load_dwordx4 v2, s[12:15], s38 offen lds
    v_mfma_f32_16x16x32_bf16 v[148:151], a[208:211], a[104:107], v[148:151]
    s_add_u32 m0, s36, 126976
    ds_read_b64_tr_b16 a[204:205], v9 offset:2048
    s_add_u32 s38, s33, 163840
    v_mfma_f32_16x16x32_bf16 v[180:183], a[212:215], a[104:107], v[180:183]
    s_add_u32 s57, s34, 163840
    ds_read_b64_tr_b16 a[206:207], v9 offset:8192
    s_cmp_lt_u32 s3, 2
    s_cselect_b32 s38, s38, s57
    v_mfma_f32_16x16x32_bf16 v[188:191], a[212:215], a[108:111], v[188:191]
    v_mfma_f32_16x16x32_bf16 v[120:123], v[88:91], v[104:107], 0
    v_mfma_f32_16x16x32_bf16 v[120:123], v[96:99], v[112:115], v[120:123]
    v_mfma_f32_16x16x32_bf16 v[156:159], a[208:211], a[108:111], v[156:159]
    s_waitcnt lgkmcnt(4)
    buffer_load_dwordx4 a[184:187], v28, s[20:23], s10 offen offset:2048 sc1
    v_mfma_f32_16x16x32_bf16 v[220:223], a[192:195], a[108:111], v[220:223]
    ds_read_b64_tr_b16 a[208:209], v8 offset:12288
    v_mfma_f32_16x16x32_bf16 v[252:255], a[196:199], a[108:111], v[252:255]
    ds_read_b64_tr_b16 a[210:211], v8 offset:18432
    v_mfma_f32_16x16x32_bf16 v[244:247], a[196:199], a[104:107], v[244:247]
    buffer_load_dwordx4 a[0:3], v28, s[20:23], s8 offen offset:0 sc1
    v_mfma_f32_16x16x32_bf16 v[212:215], a[192:195], a[104:107], v[212:215]
    buffer_load_dwordx4 a[188:191], v28, s[20:23], s10 offen offset:3072 sc1
    v_mfma_f32_16x16x32_bf16 v[204:207], a[192:195], a[100:103], v[204:207]
    s_add_u32 s10, s10, 12288
    ds_read_b64_tr_b16 a[212:213], v9 offset:12288
    v_mfma_f32_16x16x32_bf16 v[236:239], a[196:199], a[100:103], v[236:239]
    ds_read_b64_tr_b16 a[214:215], v9 offset:18432
    v_mfma_f32_16x16x32_bf16 v[228:231], a[196:199], a[96:99], v[228:231]
    buffer_load_dwordx4 a[4:7], v28, s[20:23], s8 offen offset:1024 sc1
    v_mfma_f32_16x16x32_bf16 v[196:199], a[192:195], a[96:99], v[196:199]
    s_waitcnt lgkmcnt(4)
    buffer_load_dwordx4 a[8:11], v28, s[20:23], s8 offen offset:2048 sc1
    v_mfma_f32_16x16x32_bf16 v[32:35], a[200:203], a[96:99], v[32:35]
    ds_read_b64_tr_b16 a[192:193], v10 offset:12288
    v_mfma_f32_16x16x32_bf16 v[48:51], a[204:207], a[96:99], v[48:51]
    ds_read_b64_tr_b16 a[194:195], v10 offset:18432
    v_mfma_f32_16x16x32_bf16 v[52:55], a[204:207], a[100:103], v[52:55]
    buffer_load_dwordx4 v2, s[12:15], s38 offen lds
    v_mfma_f32_16x16x32_bf16 v[36:39], a[200:203], a[100:103], v[36:39]
    buffer_load_dwordx4 a[12:15], v28, s[20:23], s8 offen offset:3072 sc1
    v_mfma_f32_16x16x32_bf16 v[40:43], a[200:203], a[104:107], v[40:43]
    s_add_u32 m0, s36, 131072
    ds_read_b64_tr_b16 a[196:197], v11 offset:12288
    s_add_u32 s38, s35, 163840
    v_mfma_f32_16x16x32_bf16 v[56:59], a[204:207], a[104:107], v[56:59]
    s_waitcnt vmcnt(29)
    ds_read_b64_tr_b16 a[198:199], v11 offset:18432
    s_add_u32 s57, s33, 204800
    v_mfma_f32_16x16x32_bf16 v[60:63], a[204:207], a[108:111], v[60:63]
    buffer_atomic_add_f32 v120, v74, s[24:27], s62 offen
    v_mfma_f32_16x16x32_bf16 v[44:47], a[200:203], a[108:111], v[44:47]
    s_waitcnt lgkmcnt(4)
    buffer_atomic_add_f32 v121, v74, s[24:27], s62 offen offset:256
    v_mfma_f32_16x16x32_bf16 a[236:239], a[208:211], a[124:127], a[236:239]
    s_cmp_lt_u32 s3, 2
    s_cselect_b32 s38, s38, s57
    ds_read_b64_tr_b16 a[200:201], v8 offset:13312
    v_mfma_f32_16x16x32_bf16 a[252:255], a[212:215], a[124:127], a[252:255]
    s_add_u32 s8, s8, 4096
    ds_read_b64_tr_b16 a[202:203], v8 offset:19456
    v_mov_b32 v122, 1
    v_mfma_f32_16x16x32_bf16 a[248:251], a[212:215], a[120:123], a[248:251]
    buffer_load_dwordx4 v2, s[12:15], s38 offen lds
    v_mfma_f32_16x16x32_bf16 a[232:235], a[208:211], a[120:123], a[232:235]
    s_add_u32 m0, s36, 135168
    v_min_u32 v123, 1, v1
    v_lshlrev_b32 v123, 30, v123
    v_mfma_f32_16x16x32_bf16 a[228:231], a[208:211], a[116:119], a[228:231]
    s_add_u32 s38, s34, 204800
    ds_read_b64_tr_b16 a[204:205], v9 offset:13312
    s_add_u32 s57, s35, 204800
    v_mfma_f32_16x16x32_bf16 a[244:247], a[212:215], a[116:119], a[244:247]
    s_cmp_lt_u32 s3, 2
    s_cselect_b32 s38, s38, s57
    ds_read_b64_tr_b16 a[206:207], v9 offset:19456
    v_mfma_f32_16x16x32_bf16 a[240:243], a[212:215], a[112:115], a[240:243]
    buffer_load_dwordx4 v2, s[12:15], s38 offen lds
    v_mfma_f32_16x16x32_bf16 a[224:227], a[208:211], a[112:115], a[224:227]
    s_waitcnt lgkmcnt(4)
    s_waitcnt vmcnt(18)
    v_lshlrev_b32 v248, 16, v200
    v_mfma_f32_16x16x32_bf16 v[68:71], a[192:195], a[112:115], v[68:71]
    ds_read_b64_tr_b16 a[208:209], v10 offset:13312
    v_and_b32 v249, 0xffff0000, v200
    v_mfma_f32_16x16x32_bf16 v[100:103], a[196:199], a[112:115], v[100:103]
    ds_read_b64_tr_b16 a[210:211], v10 offset:19456
    v_sub_f32 v248, v248, v202
    v_mfma_f32_16x16x32_bf16 v[108:111], a[196:199], a[116:119], v[108:111]
    v_sub_f32 v249, v249, v202
    v_cvt_pk_bf16_f32 v193, v248, v249
    v_mfma_f32_16x16x32_bf16 v[76:79], a[192:195], a[116:119], v[76:79]
    v_lshlrev_b32 v248, 16, v193
    v_and_b32 v249, 0xffff0000, v193
    v_mfma_f32_16x16x32_bf16 v[84:87], a[192:195], a[120:123], v[84:87]
    ds_read_b64_tr_b16 a[212:213], v11 offset:13312
    v_mul_f32 v248, v248, v203
    v_mfma_f32_16x16x32_bf16 v[116:119], a[196:199], a[120:123], v[116:119]
    ds_read_b64_tr_b16 a[214:215], v11 offset:19456
    v_mul_f32 v249, v249, v203
    v_mfma_f32_16x16x32_bf16 v[124:127], a[196:199], a[124:127], v[124:127]
    s_add_u32 s11, s7, 6
    v_cvt_pk_bf16_f32 v193, v248, v249
    v_lshlrev_b32 v248, 16, v193
    v_mfma_f32_16x16x32_bf16 v[92:95], a[192:195], a[124:127], v[92:95]
    s_waitcnt lgkmcnt(4)
    v_and_b32 v249, 0xffff0000, v193
    v_lshlrev_b32 v250, 16, v201
    v_mfma_f32_16x16x32_bf16 v[156:159], a[200:203], a[124:127], v[156:159]
    s_load_dwordx4 s[72:75], s[86:87], s5 glc
    ds_read_b64_tr_b16 a[192:193], v8 offset:14336
    v_and_b32 v251, 0xffff0000, v201
    v_mfma_f32_16x16x32_bf16 v[188:191], a[204:207], a[124:127], v[188:191]
    ds_read_b64_tr_b16 a[194:195], v8 offset:20480
    v_sub_f32 v250, v250, v202
    v_mfma_f32_16x16x32_bf16 v[180:183], a[204:207], a[120:123], v[180:183]
    v_sub_f32 v251, v251, v202
    v_cvt_pk_bf16_f32 v193, v250, v251
    v_mfma_f32_16x16x32_bf16 v[148:151], a[200:203], a[120:123], v[148:151]
    v_lshlrev_b32 v250, 16, v193
    v_and_b32 v251, 0xffff0000, v193
    v_mfma_f32_16x16x32_bf16 v[140:143], a[200:203], a[116:119], v[140:143]
    ds_read_b64_tr_b16 a[196:197], v9 offset:14336
    v_mul_f32 v250, v250, v203
    v_mfma_f32_16x16x32_bf16 v[172:175], a[204:207], a[116:119], v[172:175]
    s_waitcnt vmcnt(63)
    ds_read_b64_tr_b16 a[198:199], v9 offset:20480
    v_mul_f32 v251, v251, v203
    v_mfma_f32_16x16x32_bf16 v[164:167], a[204:207], a[112:115], v[164:167]
    s_barrier
    v_mfma_f32_16x16x32_bf16 v[132:135], a[200:203], a[112:115], v[132:135]
    s_waitcnt lgkmcnt(4)
    v_cvt_pk_bf16_f32 v193, v250, v251
    v_lshlrev_b32 v250, 16, v193
    v_add_u32 v8, 0, v12
    v_mfma_f32_16x16x32_bf16 v[196:199], a[208:211], a[112:115], v[196:199]
    ds_read_b64_tr_b16 a[200:201], v8 offset:0
    v_and_b32 v251, 0xffff0000, v193
    v_mfma_f32_16x16x32_bf16 v[228:231], a[212:215], a[112:115], v[228:231]
    ds_read_b64_tr_b16 a[202:203], v8 offset:6144
    v_lshlrev_b32 v26, 16, v144
    v_mfma_f32_16x16x32_bf16 v[236:239], a[212:215], a[116:119], v[236:239]
    buffer_load_dwordx4 a[16:19], v28, s[20:23], s9 offen offset:0 sc1
    v_mfma_f32_16x16x32_bf16 v[204:207], a[208:211], a[116:119], v[204:207]
    buffer_load_dwordx4 a[20:23], v28, s[20:23], s9 offen offset:1024 sc1
    v_add_u32 v9, 0, v13
    v_mfma_f32_16x16x32_bf16 v[212:215], a[208:211], a[120:123], v[212:215]
    s_add_u32 m0, s36, 24576
    ds_read_b64_tr_b16 a[204:205], v9 offset:0
    v_and_b32 v27, 0xffff0000, v144
    v_mfma_f32_16x16x32_bf16 v[244:247], a[212:215], a[120:123], v[244:247]
    s_add_u32 s38, s34, 122944
    ds_read_b64_tr_b16 a[206:207], v9 offset:6144
    v_sub_f32 v26, v26, v24
    v_mfma_f32_16x16x32_bf16 v[252:255], a[212:215], a[124:127], v[252:255]
    buffer_load_dwordx4 a[24:27], v28, s[20:23], s9 offen offset:2048 sc1
    v_mfma_f32_16x16x32_bf16 v[220:223], a[208:211], a[124:127], v[220:223]
    s_waitcnt lgkmcnt(4)
    v_sub_f32 v27, v27, v24
    v_cvt_pk_bf16_f32 v29, v26, v27
    v_add_u32 v10, 0, v14
    v_mfma_f32_16x16x32_bf16 v[44:47], a[192:195], a[124:127], v[44:47]
    s_add_u32 s57, s35, 122944
    ds_read_b64_tr_b16 a[208:209], v10 offset:0
    v_lshlrev_b32 v26, 16, v29
    v_mfma_f32_16x16x32_bf16 v[60:63], a[196:199], a[124:127], v[60:63]
    s_cmp_lt_u32 s3, 2
    s_cselect_b32 s38, s38, s57
    ds_read_b64_tr_b16 a[210:211], v10 offset:6144
    v_mfma_f32_16x16x32_bf16 v[56:59], a[196:199], a[120:123], v[56:59]
    buffer_load_dwordx4 a[28:31], v28, s[20:23], s9 offen offset:3072 sc1
    v_mfma_f32_16x16x32_bf16 v[40:43], a[192:195], a[120:123], v[40:43]
    buffer_load_dwordx4 v2, s[12:15], s38 offen lds
    v_add_u32 v11, 0, v15
    v_mfma_f32_16x16x32_bf16 v[36:39], a[192:195], a[116:119], v[36:39]
    s_add_u32 s9, s9, 4096
    ds_read_b64_tr_b16 a[212:213], v11 offset:0
    v_and_b32 v27, 0xffff0000, v29
    v_mfma_f32_16x16x32_bf16 v[52:55], a[196:199], a[116:119], v[52:55]
    s_waitcnt vmcnt(33)
    ds_read_b64_tr_b16 a[214:215], v11 offset:6144
    v_mul_f32 v26, v26, v25
    v_mfma_f32_16x16x32_bf16 v[48:51], a[196:199], a[112:115], v[48:51]
    buffer_load_dwordx4 a[32:35], v28, s[20:23], s10 offen offset:0 sc1
    v_mfma_f32_16x16x32_bf16 v[32:35], a[192:195], a[112:115], v[32:35]
    s_waitcnt lgkmcnt(4)
    v_mul_f32 v27, v27, v25
    v_cvt_pk_bf16_f32 v29, v26, v27
    v_mfma_f32_16x16x32_bf16 a[224:227], a[200:203], a[128:131], a[224:227]
    s_add_u32 m0, s36, 28672
    ds_read_b64_tr_b16 a[192:193], v8 offset:1024
    v_lshlrev_b32 v26, 16, v29
    v_mfma_f32_16x16x32_bf16 a[240:243], a[204:207], a[128:131], a[240:243]
    s_add_u32 s38, s33, 163904
    ds_read_b64_tr_b16 a[194:195], v8 offset:7168
    v_and_b32 v27, 0xffff0000, v29
    v_mfma_f32_16x16x32_bf16 a[244:247], a[204:207], a[132:135], a[244:247]
    buffer_load_dwordx4 a[36:39], v28, s[20:23], s10 offen offset:1024 sc1
    v_mfma_f32_16x16x32_bf16 a[228:231], a[200:203], a[132:135], a[228:231]
    buffer_load_dwordx4 a[40:43], v28, s[20:23], s10 offen offset:2048 sc1
    v_mfma_f32_16x16x32_bf16 a[232:235], a[200:203], a[136:139], a[232:235]
    s_add_u32 s57, s34, 163904
    ds_read_b64_tr_b16 a[196:197], v9 offset:1024
    v_mul_f32 v30, s92, v26
    v_mfma_f32_16x16x32_bf16 a[248:251], a[204:207], a[136:139], a[248:251]
    s_cmp_lt_u32 s3, 2
    s_cselect_b32 s38, s38, s57
    ds_read_b64_tr_b16 a[198:199], v9 offset:7168
    v_mfma_f32_16x16x32_bf16 a[252:255], a[204:207], a[140:143], a[252:255]
    buffer_load_dwordx4 v2, s[12:15], s38 offen lds
    v_mfma_f32_16x16x32_bf16 a[236:239], a[200:203], a[140:143], a[236:239]
    s_waitcnt lgkmcnt(4)
    buffer_load_dwordx4 a[44:47], v28, s[20:23], s10 offen offset:3072 sc1
    v_mfma_f32_16x16x32_bf16 v[92:95], a[208:211], a[140:143], v[92:95]
    s_add_u32 m0, s36, 32768
    ds_read_b64_tr_b16 a[200:201], v10 offset:1024
    v_mul_f32 v31, s92, v27
    v_mfma_f32_16x16x32_bf16 v[124:127], a[212:215], a[140:143], v[124:127]
    s_add_u32 s38, s35, 163904
    ds_read_b64_tr_b16 a[202:203], v10 offset:7168
    s_add_u32 s57, s33, 204864
    v_mfma_f32_16x16x32_bf16 v[116:119], a[212:215], a[136:139], v[116:119]
    s_cmp_lt_u32 s3, 2
    s_cselect_b32 s38, s38, s57
    s_add_u32 s10, s10, 4096
    v_mfma_f32_16x16x32_bf16 v[84:87], a[208:211], a[136:139], v[84:87]
    s_sub_u32 s88, s72, s11
    v_exp_f32 v30, v30
    v_mfma_f32_16x16x32_bf16 v[76:79], a[208:211], a[132:135], v[76:79]
    s_sub_u32 s89, s73, s11
    ds_read_b64_tr_b16 a[204:205], v11 offset:1024
    s_max_u32 s88, s88, s89
    v_mfma_f32_16x16x32_bf16 v[108:111], a[212:215], a[132:135], v[108:111]
    s_sub_u32 s89, s74, s11
    ds_read_b64_tr_b16 a[206:207], v11 offset:7168
    s_max_u32 s88, s88, s89
    v_mfma_f32_16x16x32_bf16 v[100:103], a[212:215], a[128:131], v[100:103]
    buffer_load_dwordx4 v2, s[12:15], s38 offen lds
    v_mfma_f32_16x16x32_bf16 v[68:71], a[208:211], a[128:131], v[68:71]
    s_waitcnt lgkmcnt(4)
    v_exp_f32 v31, v31
    v_mfma_f32_16x16x32_bf16 v[132:135], a[192:195], a[128:131], v[132:135]
    s_sub_u32 s89, s75, s11
    ds_read_b64_tr_b16 a[208:209], v8 offset:2048
    v_add_f32 v30, 1.0, v30
    v_mfma_f32_16x16x32_bf16 v[164:167], a[196:199], a[128:131], v[164:167]
    s_max_u32 s88, s88, s89
    ds_read_b64_tr_b16 a[210:211], v8 offset:8192
    v_add_f32 v31, 1.0, v31
    v_mfma_f32_16x16x32_bf16 v[172:175], a[196:199], a[132:135], v[172:175]
    s_cmp_gt_u32 s88, 0
    s_cbranch_scc1 spin_o5
spin_o5_ret:
    s_add_u32 m0, s36, 36864
    v_mfma_f32_16x16x32_bf16 v[140:143], a[192:195], a[132:135], v[140:143]
    buffer_load_dwordx4 a[48:51], v28, s[20:23], s8 offen offset:0 sc1
    v_mfma_f32_16x16x32_bf16 v[148:151], a[192:195], a[136:139], v[148:151]
    s_add_u32 s38, s34, 204864
    ds_read_b64_tr_b16 a[212:213], v9 offset:2048
    s_add_u32 s57, s35, 204864
    v_mfma_f32_16x16x32_bf16 v[180:183], a[196:199], a[136:139], v[180:183]
    s_cmp_lt_u32 s3, 2
    s_cselect_b32 s38, s38, s57
    ds_read_b64_tr_b16 a[214:215], v9 offset:8192
    v_mfma_f32_16x16x32_bf16 v[188:191], a[196:199], a[140:143], v[188:191]
    buffer_load_dwordx4 a[52:55], v28, s[20:23], s8 offen offset:1024 sc1
    v_mfma_f32_16x16x32_bf16 v[156:159], a[192:195], a[140:143], v[156:159]
    s_waitcnt lgkmcnt(4)
    buffer_load_dwordx4 a[56:59], v28, s[20:23], s8 offen offset:2048 sc1
    v_mfma_f32_16x16x32_bf16 v[220:223], a[200:203], a[140:143], v[220:223]
    ds_read_b64_tr_b16 a[192:193], v8 offset:12288
    v_mfma_f32_16x16x32_bf16 v[252:255], a[204:207], a[140:143], v[252:255]
    ds_read_b64_tr_b16 a[194:195], v8 offset:18432
    v_mfma_f32_16x16x32_bf16 v[244:247], a[204:207], a[136:139], v[244:247]
    buffer_load_dwordx4 a[60:63], v28, s[20:23], s8 offen offset:3072 sc1
    v_mfma_f32_16x16x32_bf16 v[212:215], a[200:203], a[136:139], v[212:215]
    buffer_load_dwordx4 v2, s[12:15], s38 offen lds
    v_mfma_f32_16x16x32_bf16 v[204:207], a[200:203], a[132:135], v[204:207]
    s_add_u32 s8, s8, 12288
    ds_read_b64_tr_b16 a[196:197], v9 offset:12288
    v_mfma_f32_16x16x32_bf16 v[236:239], a[204:207], a[132:135], v[236:239]
    ds_read_b64_tr_b16 a[198:199], v9 offset:18432
    v_mfma_f32_16x16x32_bf16 v[228:231], a[204:207], a[128:131], v[228:231]
    s_waitcnt vmcnt(18)
    v_rcp_f32 v30, v30
    v_mfma_f32_16x16x32_bf16 v[196:199], a[200:203], a[128:131], v[196:199]
    s_waitcnt lgkmcnt(4)
    v_rcp_f32 v31, v31
    v_mfma_f32_16x16x32_bf16 v[32:35], a[208:211], a[128:131], v[32:35]
    ds_read_b64_tr_b16 a[200:201], v10 offset:12288
    v_mul_f32 v26, v26, v30
    v_mfma_f32_16x16x32_bf16 v[48:51], a[212:215], a[128:131], v[48:51]
    ds_read_b64_tr_b16 a[202:203], v10 offset:18432
    v_mul_f32 v27, v27, v31
    v_mfma_f32_16x16x32_bf16 v[52:55], a[212:215], a[132:135], v[52:55]
    buffer_atomic_add v122, v123, s[24:27], s62 offen offset:128
    v_mfma_f32_16x16x32_bf16 v[36:39], a[208:211], a[132:135], v[36:39]
    v_cvt_pk_bf16_f32 v168, v26, v27
    v_lshlrev_b32 v26, 16, v145
    v_mfma_f32_16x16x32_bf16 v[40:43], a[208:211], a[136:139], v[40:43]
    ds_read_b64_tr_b16 a[204:205], v11 offset:12288
    v_and_b32 v27, 0xffff0000, v145
    v_mfma_f32_16x16x32_bf16 v[56:59], a[212:215], a[136:139], v[56:59]
    s_waitcnt vmcnt(40)
    ds_read_b64_tr_b16 a[206:207], v11 offset:18432
    v_sub_f32 v26, v26, v24
    v_mfma_f32_16x16x32_bf16 v[60:63], a[212:215], a[140:143], v[60:63]
    v_sub_f32 v27, v27, v24
    v_cvt_pk_bf16_f32 v29, v26, v27
    v_mfma_f32_16x16x32_bf16 v[44:47], a[208:211], a[140:143], v[44:47]
    s_waitcnt lgkmcnt(4)
    v_lshlrev_b32 v26, 16, v29
    v_and_b32 v27, 0xffff0000, v29
    v_mfma_f32_16x16x32_bf16 a[236:239], a[192:195], a[156:159], a[236:239]
    ds_read_b64_tr_b16 a[208:209], v8 offset:13312
    v_mul_f32 v26, v26, v25
    v_mfma_f32_16x16x32_bf16 a[252:255], a[196:199], a[156:159], a[252:255]
    ds_read_b64_tr_b16 a[210:211], v8 offset:19456
    v_mul_f32 v27, v27, v25
    v_mfma_f32_16x16x32_bf16 a[248:251], a[196:199], a[152:155], a[248:251]
    v_cvt_pk_bf16_f32 v29, v26, v27
    v_lshlrev_b32 v26, 16, v29
    v_mfma_f32_16x16x32_bf16 a[232:235], a[192:195], a[152:155], a[232:235]
    v_and_b32 v27, 0xffff0000, v29
    v_mul_f32 v30, s92, v26
    v_mfma_f32_16x16x32_bf16 a[228:231], a[192:195], a[148:151], a[228:231]
    s_lshl_b32 s77, s3, 1
    s_add_u32 s77, s77, 0
    s_cmp_eq_u32 s77, s53
    s_cselect_b32 s77, 0x7ffffff0, 0
    ds_read_b64_tr_b16 a[212:213], v9 offset:13312
    v_mfma_f32_16x16x32_bf16 a[244:247], a[196:199], a[148:151], a[244:247]
    ds_read_b64_tr_b16 a[214:215], v9 offset:19456
    v_mul_f32 v31, s92, v27
    v_mfma_f32_16x16x32_bf16 a[240:243], a[196:199], a[144:147], a[240:243]
    v_exp_f32 v30, v30
    v_mfma_f32_16x16x32_bf16 a[224:227], a[192:195], a[144:147], a[224:227]
    s_waitcnt lgkmcnt(4)
    v_exp_f32 v31, v31
    v_mfma_f32_16x16x32_bf16 v[68:71], a[200:203], a[144:147], v[68:71]
    ds_read_b64_tr_b16 a[192:193], v10 offset:13312
    v_add_f32 v30, 1.0, v30
    v_mfma_f32_16x16x32_bf16 v[100:103], a[204:207], a[144:147], v[100:103]
    ds_read_b64_tr_b16 a[194:195], v10 offset:19456
    v_add_f32 v31, 1.0, v31
    v_mfma_f32_16x16x32_bf16 v[108:111], a[204:207], a[148:151], v[108:111]
    v_rcp_f32 v30, v30
    v_mfma_f32_16x16x32_bf16 v[76:79], a[200:203], a[148:151], v[76:79]
    v_rcp_f32 v31, v31
    v_mfma_f32_16x16x32_bf16 v[84:87], a[200:203], a[152:155], v[84:87]
    s_add_u32 m0, s36, 73728
    ds_read_b64_tr_b16 a[196:197], v11 offset:13312
    v_mul_f32 v26, v26, v30
    v_mfma_f32_16x16x32_bf16 v[116:119], a[204:207], a[152:155], v[116:119]
    s_add_u32 s38, s34, 123008
    ds_read_b64_tr_b16 a[198:199], v11 offset:19456
    v_mul_f32 v27, v27, v31
    v_mfma_f32_16x16x32_bf16 v[124:127], a[204:207], a[156:159], v[124:127]
    s_add_u32 s57, s35, 123008
    v_cvt_pk_bf16_f32 v169, v26, v27
    v_lshlrev_b32 v26, 16, v146
    v_mfma_f32_16x16x32_bf16 v[92:95], a[200:203], a[156:159], v[92:95]
    s_waitcnt lgkmcnt(4)
    v_and_b32 v27, 0xffff0000, v146
    v_sub_f32 v26, v26, v24
    v_mfma_f32_16x16x32_bf16 v[156:159], a[208:211], a[156:159], v[156:159]
    s_cmp_lt_u32 s3, 2
    s_cselect_b32 s38, s38, s57
    ds_read_b64_tr_b16 a[200:201], v8 offset:14336
    v_mfma_f32_16x16x32_bf16 v[188:191], a[212:215], a[156:159], v[188:191]
    ds_read_b64_tr_b16 a[202:203], v8 offset:20480
    v_sub_f32 v27, v27, v24
    v_mfma_f32_16x16x32_bf16 v[180:183], a[212:215], a[152:155], v[180:183]
    buffer_load_dwordx4 a[64:67], v28, s[20:23], s9 offen offset:0 sc1
    v_mfma_f32_16x16x32_bf16 v[148:151], a[208:211], a[152:155], v[148:151]
    buffer_load_dwordx4 v2, s[12:15], s38 offen lds
    v_mfma_f32_16x16x32_bf16 v[140:143], a[208:211], a[148:151], v[140:143]
    ds_read_b64_tr_b16 a[204:205], v9 offset:14336
    v_cvt_pk_bf16_f32 v29, v26, v27
    v_mfma_f32_16x16x32_bf16 v[172:175], a[212:215], a[148:151], v[172:175]
    s_waitcnt vmcnt(19)
    ds_read_b64_tr_b16 a[206:207], v9 offset:20480
    v_lshlrev_b32 v26, 16, v29
    v_mfma_f32_16x16x32_bf16 v[164:167], a[212:215], a[144:147], v[164:167]
    s_barrier
    v_mfma_f32_16x16x32_bf16 v[132:135], a[208:211], a[144:147], v[132:135]
    s_waitcnt lgkmcnt(4)
    buffer_load_dwordx4 a[68:71], v28, s[20:23], s9 offen offset:1024 sc1
    v_add_u32 v8, 122880, v18
    v_mfma_f32_16x16x32_bf16 v[196:199], a[192:195], a[144:147], v[196:199]
    s_add_u32 m0, s36, 77824
    ds_read_b64_tr_b16 a[208:209], v8 offset:0
    v_and_b32 v27, 0xffff0000, v29
    v_mfma_f32_16x16x32_bf16 v[228:231], a[196:199], a[144:147], v[228:231]
    s_add_u32 s38, s33, 163968
    ds_read_b64_tr_b16 a[210:211], v8 offset:1024
    v_mul_f32 v26, v26, v25
    v_mfma_f32_16x16x32_bf16 v[236:239], a[196:199], a[148:151], v[236:239]
    buffer_load_dwordx4 a[72:75], v28, s[20:23], s9 offen offset:2048 sc1
    v_mfma_f32_16x16x32_bf16 v[204:207], a[192:195], a[148:151], v[204:207]
    buffer_load_dwordx4 a[76:79], v28, s[20:23], s9 offen offset:3072 sc1
    v_add_u32 v9, 122880, v19
    v_mfma_f32_16x16x32_bf16 v[212:215], a[192:195], a[152:155], v[212:215]
    s_add_u32 s57, s34, 163968
    ds_read_b64_tr_b16 a[212:213], v9 offset:0
    v_mul_f32 v27, v27, v25
    v_mfma_f32_16x16x32_bf16 v[244:247], a[196:199], a[152:155], v[244:247]
    s_cmp_lt_u32 s3, 2
    s_cselect_b32 s38, s38, s57
    ds_read_b64_tr_b16 a[214:215], v9 offset:1024
    v_mfma_f32_16x16x32_bf16 v[252:255], a[196:199], a[156:159], v[252:255]
    buffer_load_dwordx4 v2, s[12:15], s38 offen lds
    v_mfma_f32_16x16x32_bf16 v[220:223], a[192:195], a[156:159], v[220:223]
    s_waitcnt lgkmcnt(4)
    buffer_load_dwordx4 a[80:83], v28, s[20:23], s10 offen offset:0 sc1
    v_mfma_f32_16x16x32_bf16 v[44:47], a[200:203], a[156:159], v[44:47]
    s_add_u32 m0, s36, 81920
    ds_read_b64_tr_b16 a[192:193], v8 offset:2048
    v_cvt_pk_bf16_f32 v29, v26, v27
    v_mfma_f32_16x16x32_bf16 v[60:63], a[204:207], a[156:159], v[60:63]
    s_add_u32 s38, s35, 163968
    ds_read_b64_tr_b16 a[194:195], v8 offset:3072
    v_lshlrev_b32 v26, 16, v29
    v_mfma_f32_16x16x32_bf16 v[56:59], a[204:207], a[152:155], v[56:59]
pg_11:
    s_cbranch_execz pg_ret2
    buffer_load_dwordx4 a[84:87], v28, s[20:23], s10 offen offset:1024 sc1
    v_mfma_f32_16x16x32_bf16 v[40:43], a[200:203], a[152:155], v[40:43]
    buffer_load_dwordx4 a[88:91], v28, s[20:23], s10 offen offset:2048 sc1
    v_mfma_f32_16x16x32_bf16 v[36:39], a[200:203], a[148:151], v[36:39]
    s_add_u32 s57, s33, 204928
    ds_read_b64_tr_b16 a[196:197], v9 offset:2048
    v_and_b32 v27, 0xffff0000, v29
    v_mfma_f32_16x16x32_bf16 v[52:55], a[204:207], a[148:151], v[52:55]
    s_waitcnt vmcnt(40)
    ds_read_b64_tr_b16 a[198:199], v9 offset:3072
    v_mul_f32 v30, s92, v26
    v_mfma_f32_16x16x32_bf16 v[48:51], a[204:207], a[144:147], v[48:51]
    buffer_load_dwordx4 a[92:95], v28, s[20:23], s10 offen offset:3072 sc1
    v_mfma_f32_16x16x32_bf16 v[32:35], a[200:203], a[144:147], v[32:35]
    s_waitcnt lgkmcnt(4)
    v_mul_f32 v31, s92, v27
    v_or_b32 v6, s77, v28
    v_mfma_f32_16x16x32_bf16 a[224:227], a[208:211], a[160:163], a[224:227]
    s_cmp_lt_u32 s3, 2
    s_cselect_b32 s38, s38, s57
    ds_read_b64_tr_b16 a[200:201], v8 offset:4096
    v_mfma_f32_16x16x32_bf16 a[240:243], a[212:215], a[160:163], a[240:243]
    s_add_u32 s9, s9, 12288
    ds_read_b64_tr_b16 a[202:203], v8 offset:5120
    s_add_u32 s10, s10, 12288
    v_mfma_f32_16x16x32_bf16 a[244:247], a[212:215], a[164:167], a[244:247]
    buffer_load_dwordx4 v2, s[12:15], s38 offen lds
    v_mfma_f32_16x16x32_bf16 a[228:231], a[208:211], a[164:167], a[228:231]
    s_add_u32 m0, s36, 86016
    v_exp_f32 v30, v30
    v_mfma_f32_16x16x32_bf16 a[232:235], a[208:211], a[168:171], a[232:235]
    s_add_u32 s38, s34, 204928
    ds_read_b64_tr_b16 a[204:205], v9 offset:4096
    s_add_u32 s57, s35, 204928
    v_mfma_f32_16x16x32_bf16 a[248:251], a[212:215], a[168:171], a[248:251]
    s_waitcnt vmcnt(36)
    ds_read_b64_tr_b16 a[206:207], v9 offset:5120
    s_cmp_lt_u32 s3, 2
    s_cselect_b32 s38, s38, s57
    v_mfma_f32_16x16x32_bf16 a[252:255], a[212:215], a[172:175], a[252:255]
    s_and_b32 s56, s70, 0x7ff
    v_exp_f32 v31, v31
    v_mfma_f32_16x16x32_bf16 a[236:239], a[208:211], a[172:175], a[236:239]
    s_waitcnt lgkmcnt(4)
    v_add_f32 v30, 1.0, v30
    v_add_f32 v31, 1.0, v31
    v_mfma_f32_16x16x32_bf16 a[236:239], a[192:195], a[188:191], a[236:239]
    s_sub_u32 s56, 2047, s56
    ds_read_b64_tr_b16 a[208:209], v8 offset:6144
    v_cmp_eq_u32 s[78:79], s56, v20
    v_mfma_f32_16x16x32_bf16 a[252:255], a[196:199], a[188:191], a[252:255]
    s_and_b32 s56, s71, 0x7ff
    ds_read_b64_tr_b16 a[210:211], v8 offset:7168
    s_sub_u32 s56, 2047, s56
    v_mfma_f32_16x16x32_bf16 a[248:251], a[196:199], a[184:187], a[248:251]
    buffer_load_dwordx4 v2, s[12:15], s38 offen lds
    v_mfma_f32_16x16x32_bf16 a[232:235], a[192:195], a[184:187], a[232:235]
    s_lshl_b32 s77, s3, 1
    s_add_u32 s77, s77, 1
    s_cmp_eq_u32 s77, s53
    s_cselect_b32 s77, 0x7ffffff0, 0
    v_mfma_f32_16x16x32_bf16 a[228:231], a[192:195], a[180:183], a[228:231]
    ds_read_b64_tr_b16 a[212:213], v9 offset:6144
    v_cmp_eq_u32 s[80:81], s56, v20
    v_mfma_f32_16x16x32_bf16 a[244:247], a[196:199], a[180:183], a[244:247]
    s_waitcnt vmcnt(33)
    ds_read_b64_tr_b16 a[214:215], v9 offset:7168
    v_or_b32 v7, s77, v28
    v_mfma_f32_16x16x32_bf16 a[240:243], a[196:199], a[176:179], a[240:243]
    s_cmp_ge_u32 s3, 2
    s_cselect_b32 s68, 0, 0xff00
    s_lshl_b32 s69, 0x10101, s53
    s_or_b32 s68, s68, s69
    s_sub_u32 s48, s48, s47
    s_xor_b32 s40, s47, 0x2000
    v_mfma_f32_16x16x32_bf16 a[224:227], a[192:195], a[176:179], a[224:227]
    s_waitcnt lgkmcnt(4)
    v_and_b32 v3, 7, v1
    v_lshlrev_b32 v3, 9, v3
    v_mfma_f32_16x16x32_bf16 a[224:227], a[200:203], a[0:3], a[224:227]
    ds_read_b64_tr_b16 a[192:193], v8 offset:8192
    v_bfe_u32 v4, v1, 3, 2
    v_mfma_f32_16x16x32_bf16 a[240:243], a[204:207], a[0:3], a[240:243]
    ds_read_b64_tr_b16 a[194:195], v8 offset:9216
    v_min_u32 v4, 2, v4
    v_mfma_f32_16x16x32_bf16 a[244:247], a[204:207], a[4:7], a[244:247]
    s_lshr_b32 s56, s3, 1
    v_rcp_f32 v30, v30
    v_mfma_f32_16x16x32_bf16 a[228:231], a[200:203], a[4:7], a[228:231]
    s_sub_u32 s46, 2, s56
    v_mul_u32_u24 v5, s46, v4
    v_and_b32 v15, 4, v5
    v_mfma_f32_16x16x32_bf16 a[232:235], a[200:203], a[8:11], a[232:235]
    ds_read_b64_tr_b16 a[196:197], v9 offset:8192
    v_add_u32 v3, v3, v15
    v_mfma_f32_16x16x32_bf16 a[248:251], a[204:207], a[8:11], a[248:251]
    s_waitcnt vmcnt(25)
    ds_read_b64_tr_b16 a[198:199], v9 offset:9216
    s_add_u32 s56, s56, s7
    v_mfma_f32_16x16x32_bf16 a[252:255], a[204:207], a[12:15], a[252:255]
    s_add_u32 s56, s56, 1
    v_add_u32 v5, s56, v5
    s_lshl_b32 s37, s3, 2
    v_mfma_f32_16x16x32_bf16 a[236:239], a[200:203], a[12:15], a[236:239]
    s_waitcnt lgkmcnt(4)
    v_rcp_f32 v31, v31
    v_mfma_f32_16x16x32_bf16 a[236:239], a[208:211], a[28:31], a[236:239]
    s_lshr_b32 s37, 0x5310, s37
    ds_read_b64_tr_b16 a[200:201], v8 offset:10240
    v_mul_f32 v26, v26, v30
    v_mfma_f32_16x16x32_bf16 a[252:255], a[212:215], a[28:31], a[252:255]
    s_and_b32 s37, s37, 7
    ds_read_b64_tr_b16 a[202:203], v8 offset:11264
    v_mul_f32 v27, v27, v31
    v_mfma_f32_16x16x32_bf16 a[248:251], a[212:215], a[24:27], a[248:251]
    s_mul_i32 s37, s37, 24576
    v_add_u32 v4, s37, v28
    v_cvt_pk_bf16_f32 v170, v26, v27
    v_mfma_f32_16x16x32_bf16 a[232:235], a[208:211], a[24:27], a[232:235]
    s_lshl_b32 s56, s3, 9
    v_lshlrev_b32 v26, 16, v147
    v_and_b32 v27, 0xffff0000, v147
    v_mfma_f32_16x16x32_bf16 a[228:231], a[208:211], a[20:23], a[228:231]
    s_add_u32 s56, s56, 159744
    ds_read_b64_tr_b16 a[204:205], v9 offset:10240
    v_lshlrev_b32 v138, 3, v1
    v_mfma_f32_16x16x32_bf16 a[244:247], a[212:215], a[20:23], a[244:247]
    s_waitcnt vmcnt(19)
    ds_read_b64_tr_b16 a[206:207], v9 offset:11264
    v_add_u32 v138, s56, v138
    v_mfma_f32_16x16x32_bf16 a[240:243], a[212:215], a[16:19], a[240:243]
    v_mov_b32 v139, 256
    v_cndmask_b32 v139, 0, v139, s[80:81]
    v_mfma_f32_16x16x32_bf16 a[224:227], a[208:211], a[16:19], a[224:227]
    s_waitcnt lgkmcnt(4)
    v_lshl_add_u32 v139, v21, 4, v139
    v_add_u32 v139, s56, v139
    v_mfma_f32_16x16x32_bf16 a[224:227], a[192:195], a[32:35], a[224:227]
    s_mov_b32 s59, 3670016
    ds_read_b64_tr_b16 a[208:209], v8 offset:12288
    v_sub_f32 v26, v26, v24
    v_mfma_f32_16x16x32_bf16 a[240:243], a[196:199], a[32:35], a[240:243]
    s_or_b64 s[88:89], s[78:79], s[80:81]
    s_cselect_b32 s59, s59, 0x70000000
    ds_read_b64_tr_b16 a[210:211], v8 offset:13312
    v_mfma_f32_16x16x32_bf16 a[244:247], a[196:199], a[36:39], a[244:247]
    v_sub_f32 v27, v27, v24
    v_cvt_pk_bf16_f32 v29, v26, v27
    v_mfma_f32_16x16x32_bf16 a[228:231], a[192:195], a[36:39], a[228:231]
    v_lshlrev_b32 v26, 16, v29
    v_and_b32 v27, 0xffff0000, v29
    v_mfma_f32_16x16x32_bf16 a[232:235], a[192:195], a[40:43], a[232:235]
    s_add_u32 m0, s36, 98304
    ds_read_b64_tr_b16 a[212:213], v9 offset:12288
    v_mul_f32 v26, v26, v25
    v_mfma_f32_16x16x32_bf16 a[248:251], a[196:199], a[40:43], a[248:251]
    s_waitcnt vmcnt(14)
    ds_read_b64_tr_b16 a[214:215], v9 offset:13312
    v_mul_f32 v27, v27, v25
    v_mfma_f32_16x16x32_bf16 a[252:255], a[196:199], a[44:47], a[252:255]
    s_add_u32 s38, s34, 123072
    v_cvt_pk_bf16_f32 v29, v26, v27
    v_lshlrev_b32 v26, 16, v29
    v_mfma_f32_16x16x32_bf16 a[236:239], a[192:195], a[44:47], a[236:239]
    s_waitcnt lgkmcnt(4)
    v_and_b32 v27, 0xffff0000, v29
    v_mul_f32 v30, s92, v26
    v_mfma_f32_16x16x32_bf16 a[236:239], a[200:203], a[60:63], a[236:239]
    s_add_u32 s57, s35, 123072
    ds_read_b64_tr_b16 a[192:193], v8 offset:14336
    v_mul_f32 v31, s92, v27
    v_mfma_f32_16x16x32_bf16 a[252:255], a[204:207], a[60:63], a[252:255]
    s_cmp_lt_u32 s3, 2
    s_cselect_b32 s38, s38, s57
    ds_read_b64_tr_b16 a[194:195], v8 offset:15360
    v_mfma_f32_16x16x32_bf16 a[248:251], a[204:207], a[56:59], a[248:251]
    buffer_load_dwordx4 v2, s[12:15], s38 offen lds
    v_mfma_f32_16x16x32_bf16 a[232:235], a[200:203], a[56:59], a[232:235]
    v_exp_f32 v30, v30
    v_mfma_f32_16x16x32_bf16 a[228:231], a[200:203], a[52:55], a[228:231]
    ds_read_b64_tr_b16 a[196:197], v9 offset:14336
    v_add_u32 v8, 24576, v18
    v_mfma_f32_16x16x32_bf16 a[244:247], a[204:207], a[52:55], a[244:247]
    s_waitcnt vmcnt(14)
    s_waitcnt vmcnt(8)
    ds_read_b64_tr_b16 a[198:199], v9 offset:15360
    v_mfma_f32_16x16x32_bf16 a[240:243], a[204:207], a[48:51], a[240:243]
    s_barrier
    v_mfma_f32_16x16x32_bf16 a[224:227], a[200:203], a[48:51], a[224:227]
    s_waitcnt lgkmcnt(4)
    v_exp_f32 v31, v31
    v_mfma_f32_16x16x32_bf16 a[224:227], a[208:211], a[64:67], a[224:227]
    s_add_u32 m0, s36, 102400
    ds_read_b64_tr_b16 a[200:201], v8 offset:0
    v_add_f32 v30, 1.0, v30
    v_mfma_f32_16x16x32_bf16 a[240:243], a[212:215], a[64:67], a[240:243]
    s_add_u32 s38, s33, 164032
    ds_read_b64_tr_b16 a[202:203], v8 offset:1024
    v_add_f32 v31, 1.0, v31
    v_mfma_f32_16x16x32_bf16 a[244:247], a[212:215], a[68:71], a[244:247]
    s_add_u32 s57, s34, 164032
    v_rcp_f32 v30, v30
    v_mfma_f32_16x16x32_bf16 a[228:231], a[208:211], a[68:71], a[228:231]
    s_cmp_lt_u32 s3, 2
    s_cselect_b32 s38, s38, s57
    v_add_u32 v9, 24576, v19
    v_mfma_f32_16x16x32_bf16 a[232:235], a[208:211], a[72:75], a[232:235]
    ds_read_b64_tr_b16 a[204:205], v9 offset:0
    v_mfma_f32_16x16x32_bf16 a[248:251], a[212:215], a[72:75], a[248:251]
    s_waitcnt vmcnt(3)
    ds_read_b64_tr_b16 a[206:207], v9 offset:1024
    v_mfma_f32_16x16x32_bf16 a[252:255], a[212:215], a[76:79], a[252:255]
    buffer_load_dwordx4 v2, s[12:15], s38 offen lds
    v_mfma_f32_16x16x32_bf16 a[236:239], a[208:211], a[76:79], a[236:239]
    s_waitcnt lgkmcnt(4)
    v_rcp_f32 v31, v31
    v_mfma_f32_16x16x32_bf16 a[236:239], a[192:195], a[92:95], a[236:239]
    s_add_u32 m0, s36, 106496
    ds_read_b64_tr_b16 a[208:209], v8 offset:2048
    v_mul_f32 v26, v26, v30
    v_mfma_f32_16x16x32_bf16 a[252:255], a[196:199], a[92:95], a[252:255]
    s_add_u32 s38, s35, 164032
    ds_read_b64_tr_b16 a[210:211], v8 offset:3072
    v_mul_f32 v27, v27, v31
    v_mfma_f32_16x16x32_bf16 a[248:251], a[196:199], a[88:91], a[248:251]
    s_add_u32 s57, s33, 204992
    v_cvt_pk_bf16_f32 v171, v26, v27
    v_lshlrev_b32 v26, 16, v152
    v_mfma_f32_16x16x32_bf16 a[232:235], a[192:195], a[88:91], a[232:235]
    s_cmp_lt_u32 s3, 2
    s_cselect_b32 s38, s38, s57
    v_and_b32 v27, 0xffff0000, v152
    v_mfma_f32_16x16x32_bf16 a[228:231], a[192:195], a[84:87], a[228:231]
    ds_read_b64_tr_b16 a[212:213], v9 offset:2048
    v_sub_f32 v26, v26, v24
    v_mfma_f32_16x16x32_bf16 a[244:247], a[196:199], a[84:87], a[244:247]
    ds_read_b64_tr_b16 a[214:215], v9 offset:3072
    v_sub_f32 v27, v27, v24
    v_mfma_f32_16x16x32_bf16 a[240:243], a[196:199], a[80:83], a[240:243]
    buffer_load_dwordx4 v2, s[12:15], s38 offen lds
    v_mfma_f32_16x16x32_bf16 a[224:227], a[192:195], a[80:83], a[224:227]
    s_waitcnt lgkmcnt(4)
    v_cvt_pk_bf16_f32 v29, v26, v27
    v_lshlrev_b32 v26, 16, v29
    v_mfma_f32_16x16x32_bf16 v[68:71], a[200:203], a[160:163], v[68:71]
    ds_read_b64_tr_b16 a[192:193], v8 offset:4096
    v_and_b32 v27, 0xffff0000, v29
    v_mfma_f32_16x16x32_bf16 v[100:103], a[204:207], a[160:163], v[100:103]
    ds_read_b64_tr_b16 a[194:195], v8 offset:5120
    v_mul_f32 v26, v26, v25
    v_mfma_f32_16x16x32_bf16 v[108:111], a[204:207], a[164:167], v[108:111]
    s_add_u32 m0, s36, 110592
    v_mul_f32 v27, v27, v25
    v_cvt_pk_bf16_f32 v29, v26, v27
    v_mfma_f32_16x16x32_bf16 v[76:79], a[200:203], a[164:167], v[76:79]
    s_add_u32 s38, s34, 204992
    v_lshlrev_b32 v26, 16, v29
    v_and_b32 v27, 0xffff0000, v29
    v_mfma_f32_16x16x32_bf16 v[84:87], a[200:203], a[168:171], v[84:87]
    s_add_u32 s57, s35, 204992
    ds_read_b64_tr_b16 a[196:197], v9 offset:4096
    v_mul_f32 v30, s92, v26
    v_mfma_f32_16x16x32_bf16 v[116:119], a[204:207], a[168:171], v[116:119]
    s_cmp_lt_u32 s3, 2
    s_cselect_b32 s38, s38, s57
    ds_read_b64_tr_b16 a[198:199], v9 offset:5120
    v_mfma_f32_16x16x32_bf16 v[124:127], a[204:207], a[172:175], v[124:127]
    v_accvgpr_read_b32 v64, a224
    v_accvgpr_read_b32 v65, a225
    v_mfma_f32_16x16x32_bf16 v[92:95], a[200:203], a[172:175], v[92:95]
    s_waitcnt lgkmcnt(4)
    v_accvgpr_read_b32 v66, a226
    v_accvgpr_read_b32 v67, a227
    v_mfma_f32_16x16x32_bf16 v[92:95], a[208:211], a[188:191], v[92:95]
    ds_read_b64_tr_b16 a[200:201], v8 offset:6144
    v_accvgpr_read_b32 v72, a240
    v_mfma_f32_16x16x32_bf16 v[124:127], a[212:215], a[188:191], v[124:127]
    ds_read_b64_tr_b16 a[202:203], v8 offset:7168
    v_accvgpr_read_b32 v73, a241
    v_mfma_f32_16x16x32_bf16 v[116:119], a[212:215], a[184:187], v[116:119]
    buffer_load_dwordx4 v2, s[12:15], s38 offen lds
    v_mfma_f32_16x16x32_bf16 v[84:87], a[208:211], a[184:187], v[84:87]
    v_accvgpr_read_b32 v74, a242
    v_accvgpr_read_b32 v75, a243
    v_mfma_f32_16x16x32_bf16 v[76:79], a[208:211], a[180:183], v[76:79]
    ds_read_b64_tr_b16 a[204:205], v9 offset:6144
    v_cvt_pk_bf16_f32 v64, v64, v65
    v_mfma_f32_16x16x32_bf16 v[108:111], a[212:215], a[180:183], v[108:111]
    ds_read_b64_tr_b16 a[206:207], v9 offset:7168
    v_cvt_pk_bf16_f32 v65, v66, v67
    v_mfma_f32_16x16x32_bf16 v[100:103], a[212:215], a[176:179], v[100:103]
    v_cvt_pk_bf16_f32 v66, v72, v73
    v_cvt_pk_bf16_f32 v67, v74, v75
    v_mfma_f32_16x16x32_bf16 v[68:71], a[208:211], a[176:179], v[68:71]
    s_waitcnt lgkmcnt(4)
    buffer_store_dwordx4 v[64:67], v6, s[24:27], s55 offen sc1
    v_mfma_f32_16x16x32_bf16 v[68:71], a[192:195], a[0:3], v[68:71]
    s_xor_b32 s55, s55, 1024
    ds_read_b64_tr_b16 a[208:209], v8 offset:8192
    v_accvgpr_read_b32 v80, a228
    v_mfma_f32_16x16x32_bf16 v[100:103], a[196:199], a[0:3], v[100:103]
    ds_read_b64_tr_b16 a[210:211], v8 offset:9216
    v_accvgpr_read_b32 v81, a229
    v_mfma_f32_16x16x32_bf16 v[108:111], a[196:199], a[4:7], v[108:111]
    v_accvgpr_read_b32 v82, a230
    v_accvgpr_read_b32 v83, a231
    v_mfma_f32_16x16x32_bf16 v[76:79], a[192:195], a[4:7], v[76:79]
    v_accvgpr_read_b32 v88, a244
    v_accvgpr_read_b32 v89, a245
    v_mfma_f32_16x16x32_bf16 v[84:87], a[192:195], a[8:11], v[84:87]
    ds_read_b64_tr_b16 a[212:213], v9 offset:8192
    v_accvgpr_read_b32 v90, a246
    v_mfma_f32_16x16x32_bf16 v[116:119], a[196:199], a[8:11], v[116:119]
    ds_read_b64_tr_b16 a[214:215], v9 offset:9216
    v_accvgpr_read_b32 v91, a247
    v_mfma_f32_16x16x32_bf16 v[124:127], a[196:199], a[12:15], v[124:127]
    v_cvt_pk_bf16_f32 v80, v80, v81
    v_cvt_pk_bf16_f32 v81, v82, v83
    v_mfma_f32_16x16x32_bf16 v[92:95], a[192:195], a[12:15], v[92:95]
    s_waitcnt lgkmcnt(4)
    v_cvt_pk_bf16_f32 v82, v88, v89
    v_cvt_pk_bf16_f32 v83, v90, v91
    v_mfma_f32_16x16x32_bf16 v[92:95], a[200:203], a[28:31], v[92:95]
    ds_read_b64_tr_b16 a[192:193], v8 offset:10240
    v_accvgpr_read_b32 v96, a232
    v_mfma_f32_16x16x32_bf16 v[124:127], a[204:207], a[28:31], v[124:127]
    ds_read_b64_tr_b16 a[194:195], v8 offset:11264
    v_accvgpr_read_b32 v97, a233
    v_mfma_f32_16x16x32_bf16 v[116:119], a[204:207], a[24:27], v[116:119]
    buffer_store_dwordx4 v[80:83], v6, s[24:27], s55 offen sc1
    v_mfma_f32_16x16x32_bf16 v[84:87], a[200:203], a[24:27], v[84:87]
    s_xor_b32 s55, s55, 3072
    v_accvgpr_read_b32 v98, a234
    v_accvgpr_read_b32 v99, a235
    v_mfma_f32_16x16x32_bf16 v[76:79], a[200:203], a[20:23], v[76:79]
    ds_read_b64_tr_b16 a[196:197], v9 offset:10240
    v_accvgpr_read_b32 v104, a248
    v_mfma_f32_16x16x32_bf16 v[108:111], a[204:207], a[20:23], v[108:111]
    ds_read_b64_tr_b16 a[198:199], v9 offset:11264
    v_accvgpr_read_b32 v105, a249
    v_mfma_f32_16x16x32_bf16 v[100:103], a[204:207], a[16:19], v[100:103]
    v_accvgpr_read_b32 v106, a250
    v_accvgpr_read_b32 v107, a251
    v_mfma_f32_16x16x32_bf16 v[68:71], a[200:203], a[16:19], v[68:71]
    s_waitcnt lgkmcnt(4)
    v_cvt_pk_bf16_f32 v96, v96, v97
    v_cvt_pk_bf16_f32 v97, v98, v99
    v_mfma_f32_16x16x32_bf16 v[68:71], a[208:211], a[32:35], v[68:71]
    ds_read_b64_tr_b16 a[200:201], v8 offset:12288
    v_cvt_pk_bf16_f32 v98, v104, v105
    v_mfma_f32_16x16x32_bf16 v[100:103], a[212:215], a[32:35], v[100:103]
    ds_read_b64_tr_b16 a[202:203], v8 offset:13312
    v_cvt_pk_bf16_f32 v99, v106, v107
    v_mfma_f32_16x16x32_bf16 v[108:111], a[212:215], a[36:39], v[108:111]
    buffer_store_dwordx4 v[96:99], v7, s[24:27], s55 offen sc1
    v_mfma_f32_16x16x32_bf16 v[76:79], a[208:211], a[36:39], v[76:79]
    s_xor_b32 s55, s55, 1024
    v_accvgpr_read_b32 v112, a236
    v_accvgpr_read_b32 v113, a237
    v_mfma_f32_16x16x32_bf16 v[84:87], a[208:211], a[40:43], v[84:87]
    s_add_u32 m0, s36, 49152
    ds_read_b64_tr_b16 a[204:205], v9 offset:12288
    v_accvgpr_read_b32 v114, a238
    v_mfma_f32_16x16x32_bf16 v[116:119], a[212:215], a[40:43], v[116:119]
    s_add_u32 s38, s34, 123136
    ds_read_b64_tr_b16 a[206:207], v9 offset:13312
    v_accvgpr_read_b32 v115, a239
    v_mfma_f32_16x16x32_bf16 v[124:127], a[212:215], a[44:47], v[124:127]
    s_add_u32 s57, s35, 123136
    v_accvgpr_read_b32 v120, a252
    v_accvgpr_read_b32 v121, a253
    v_mfma_f32_16x16x32_bf16 v[92:95], a[208:211], a[44:47], v[92:95]
    s_waitcnt lgkmcnt(4)
    v_accvgpr_read_b32 v122, a254
    v_accvgpr_read_b32 v123, a255
    v_mfma_f32_16x16x32_bf16 v[92:95], a[192:195], a[60:63], v[92:95]
    s_cmp_lt_u32 s3, 2
    s_cselect_b32 s38, s38, s57
    ds_read_b64_tr_b16 a[208:209], v8 offset:14336
    v_mfma_f32_16x16x32_bf16 v[124:127], a[196:199], a[60:63], v[124:127]
    ds_read_b64_tr_b16 a[210:211], v8 offset:15360
    v_cvt_pk_bf16_f32 v112, v112, v113
    v_mfma_f32_16x16x32_bf16 v[116:119], a[196:199], a[56:59], v[116:119]
    buffer_load_dwordx4 v2, s[12:15], s38 offen lds
    v_mfma_f32_16x16x32_bf16 v[84:87], a[192:195], a[56:59], v[84:87]
    v_cvt_pk_bf16_f32 v113, v114, v115
    v_cvt_pk_bf16_f32 v114, v120, v121
    v_mfma_f32_16x16x32_bf16 v[76:79], a[192:195], a[52:55], v[76:79]
    ds_read_b64_tr_b16 a[212:213], v9 offset:14336
    v_cvt_pk_bf16_f32 v115, v122, v123
    v_mfma_f32_16x16x32_bf16 v[108:111], a[196:199], a[52:55], v[108:111]
    s_waitcnt vmcnt(8)
    ds_read_b64_tr_b16 a[214:215], v9 offset:15360
    v_mul_f32 v31, s92, v27
    v_mfma_f32_16x16x32_bf16 v[100:103], a[196:199], a[48:51], v[100:103]
    s_barrier
    v_mfma_f32_16x16x32_bf16 v[68:71], a[192:195], a[48:51], v[68:71]
    s_waitcnt lgkmcnt(4)
    buffer_store_dwordx4 v[112:115], v7, s[24:27], s55 offen sc1
    v_add_u32 v8, 73728, v18
    v_mfma_f32_16x16x32_bf16 v[68:71], a[200:203], a[64:67], v[68:71]
    s_add_u32 m0, s36, 53248
    ds_read_b64_tr_b16 a[192:193], v8 offset:0
    v_and_b32 v14, 15, v1
    v_mfma_f32_16x16x32_bf16 v[100:103], a[204:207], a[64:67], v[100:103]
    s_add_u32 s38, s33, 164096
    ds_read_b64_tr_b16 a[194:195], v8 offset:1024
    v_lshl_add_u32 v14, s3, 4, v14
    v_mfma_f32_16x16x32_bf16 v[108:111], a[204:207], a[68:71], v[108:111]
    s_add_u32 s57, s34, 164096
    v_exp_f32 v30, v30
    v_mfma_f32_16x16x32_bf16 v[76:79], a[200:203], a[68:71], v[76:79]
    s_cmp_lt_u32 s3, 2
    s_cselect_b32 s38, s38, s57
    v_lshlrev_b32 v14, 6, v14
    v_add_u32 v9, 73728, v19
    v_mfma_f32_16x16x32_bf16 v[84:87], a[200:203], a[72:75], v[84:87]
    s_xor_b32 s55, s55, 3072
    ds_read_b64_tr_b16 a[196:197], v9 offset:0
    s_add_u32 s55, s55, 16384
    v_mfma_f32_16x16x32_bf16 v[116:119], a[204:207], a[72:75], v[116:119]
    ds_read_b64_tr_b16 a[198:199], v9 offset:1024
    v_mfma_f32_16x16x32_bf16 v[124:127], a[204:207], a[76:79], v[124:127]
    s_getpc_b64 s[8:9]
ct5:
    s_add_u32 s8, s8, post_code-ct5
    s_addc_u32 s9, s9, 0
    global_load_dword a216, v14, s[8:9]
    v_mfma_f32_16x16x32_bf16 v[92:95], a[200:203], a[76:79], v[92:95]
    s_waitcnt lgkmcnt(4)
    buffer_load_dwordx4 v2, s[12:15], s38 offen lds
    v_mfma_f32_16x16x32_bf16 v[92:95], a[208:211], a[92:95], v[92:95]
    s_add_u32 m0, s36, 57344
    ds_read_b64_tr_b16 a[200:201], v8 offset:2048
    s_add_u32 s38, s35, 164096
    v_mfma_f32_16x16x32_bf16 v[124:127], a[212:215], a[92:95], v[124:127]
    s_add_u32 s57, s33, 205056
    ds_read_b64_tr_b16 a[202:203], v8 offset:3072
    s_cmp_lt_u32 s3, 2
    s_cselect_b32 s38, s38, s57
    v_mfma_f32_16x16x32_bf16 v[116:119], a[212:215], a[88:91], v[116:119]
    v_exp_f32 v31, v31
    v_mfma_f32_16x16x32_bf16 v[84:87], a[208:211], a[88:91], v[84:87]
    v_add_f32 v30, 1.0, v30
    v_add_f32 v31, 1.0, v31
    v_mfma_f32_16x16x32_bf16 v[76:79], a[208:211], a[84:87], v[76:79]
    ds_read_b64_tr_b16 a[204:205], v9 offset:2048
    v_mfma_f32_16x16x32_bf16 v[108:111], a[212:215], a[84:87], v[108:111]
    ds_read_b64_tr_b16 a[206:207], v9 offset:3072
    v_mfma_f32_16x16x32_bf16 v[100:103], a[212:215], a[80:83], v[100:103]
    buffer_load_dwordx4 v2, s[12:15], s38 offen lds
    v_mfma_f32_16x16x32_bf16 v[68:71], a[208:211], a[80:83], v[68:71]
    s_waitcnt lgkmcnt(4)
    v_rcp_f32 v30, v30
    v_mfma_f32_16x16x32_bf16 v[132:135], a[192:195], a[160:163], v[132:135]
    ds_read_b64_tr_b16 a[208:209], v8 offset:4096
    v_mfma_f32_16x16x32_bf16 v[164:167], a[196:199], a[160:163], v[164:167]
    ds_read_b64_tr_b16 a[210:211], v8 offset:5120
    v_mfma_f32_16x16x32_bf16 v[172:175], a[196:199], a[164:167], v[172:175]
    s_add_u32 m0, s36, 61440
    v_rcp_f32 v31, v31
    v_mfma_f32_16x16x32_bf16 v[140:143], a[192:195], a[164:167], v[140:143]
    s_add_u32 s38, s34, 205056
    v_mul_f32 v26, v26, v30
    v_mul_f32 v27, v27, v31
    v_mfma_f32_16x16x32_bf16 v[148:151], a[192:195], a[168:171], v[148:151]
    s_add_u32 s57, s35, 205056
    ds_read_b64_tr_b16 a[212:213], v9 offset:4096
    v_cvt_pk_bf16_f32 v176, v26, v27
    v_mfma_f32_16x16x32_bf16 v[180:183], a[196:199], a[168:171], v[180:183]
    s_cmp_lt_u32 s3, 2
    s_cselect_b32 s38, s38, s57
    ds_read_b64_tr_b16 a[214:215], v9 offset:5120
    v_mfma_f32_16x16x32_bf16 v[188:191], a[196:199], a[172:175], v[188:191]
    v_cvt_pk_bf16_f32 v68, v68, v69
    v_cvt_pk_bf16_f32 v69, v70, v71
    v_mfma_f32_16x16x32_bf16 v[156:159], a[192:195], a[172:175], v[156:159]
    s_waitcnt lgkmcnt(4)
    v_cvt_pk_bf16_f32 v70, v100, v101
    v_cvt_pk_bf16_f32 v71, v102, v103
    v_mfma_f32_16x16x32_bf16 v[156:159], a[200:203], a[188:191], v[156:159]
    ds_read_b64_tr_b16 a[192:193], v8 offset:6144
    v_cvt_pk_bf16_f32 v76, v76, v77
    v_mfma_f32_16x16x32_bf16 v[188:191], a[204:207], a[188:191], v[188:191]
    ds_read_b64_tr_b16 a[194:195], v8 offset:7168
    v_cvt_pk_bf16_f32 v77, v78, v79
    v_mfma_f32_16x16x32_bf16 v[180:183], a[204:207], a[184:187], v[180:183]
    buffer_store_dwordx4 v[68:71], v6, s[24:27], s55 offen sc1
    v_mfma_f32_16x16x32_bf16 v[148:151], a[200:203], a[184:187], v[148:151]
    buffer_load_dwordx4 v2, s[12:15], s38 offen lds
    v_mfma_f32_16x16x32_bf16 v[140:143], a[200:203], a[180:183], v[140:143]
    s_xor_b32 s55, s55, 1024
    ds_read_b64_tr_b16 a[196:197], v9 offset:6144
    v_cvt_pk_bf16_f32 v78, v108, v109
    v_mfma_f32_16x16x32_bf16 v[172:175], a[204:207], a[180:183], v[172:175]
    ds_read_b64_tr_b16 a[198:199], v9 offset:7168
    v_cvt_pk_bf16_f32 v79, v110, v111
    v_mfma_f32_16x16x32_bf16 v[164:167], a[204:207], a[176:179], v[164:167]
    v_cvt_pk_bf16_f32 v84, v84, v85
    v_cvt_pk_bf16_f32 v85, v86, v87
    v_mfma_f32_16x16x32_bf16 v[132:135], a[200:203], a[176:179], v[132:135]
    s_waitcnt lgkmcnt(4)
    v_cvt_pk_bf16_f32 v86, v116, v117
    v_cvt_pk_bf16_f32 v87, v118, v119
    v_mfma_f32_16x16x32_bf16 v[132:135], a[208:211], a[0:3], v[132:135]
    ds_read_b64_tr_b16 a[200:201], v8 offset:8192
    v_cvt_pk_bf16_f32 v92, v92, v93
    v_mfma_f32_16x16x32_bf16 v[164:167], a[212:215], a[0:3], v[164:167]
    ds_read_b64_tr_b16 a[202:203], v8 offset:9216
    v_cvt_pk_bf16_f32 v93, v94, v95
    v_mfma_f32_16x16x32_bf16 v[172:175], a[212:215], a[4:7], v[172:175]
    buffer_store_dwordx4 v[76:79], v6, s[24:27], s55 offen sc1
    v_mfma_f32_16x16x32_bf16 v[140:143], a[208:211], a[4:7], v[140:143]
    s_xor_b32 s55, s55, 3072
    v_cvt_pk_bf16_f32 v94, v124, v125
    v_cvt_pk_bf16_f32 v95, v126, v127
    v_mfma_f32_16x16x32_bf16 v[148:151], a[208:211], a[8:11], v[148:151]
    ds_read_b64_tr_b16 a[204:205], v9 offset:8192
    v_lshlrev_b32 v26, 16, v153
    v_mfma_f32_16x16x32_bf16 v[180:183], a[212:215], a[8:11], v[180:183]
    ds_read_b64_tr_b16 a[206:207], v9 offset:9216
    v_and_b32 v27, 0xffff0000, v153
    v_mfma_f32_16x16x32_bf16 v[188:191], a[212:215], a[12:15], v[188:191]
    v_sub_f32 v26, v26, v24
    v_sub_f32 v27, v27, v24
    v_mfma_f32_16x16x32_bf16 v[156:159], a[208:211], a[12:15], v[156:159]
    s_waitcnt lgkmcnt(4)
    v_cvt_pk_bf16_f32 v29, v26, v27
    v_lshlrev_b32 v26, 16, v29
    v_mfma_f32_16x16x32_bf16 v[156:159], a[192:195], a[28:31], v[156:159]
    ds_read_b64_tr_b16 a[208:209], v8 offset:10240
    v_and_b32 v27, 0xffff0000, v29
    v_mfma_f32_16x16x32_bf16 v[188:191], a[196:199], a[28:31], v[188:191]
    ds_read_b64_tr_b16 a[210:211], v8 offset:11264
    v_mul_f32 v26, v26, v25
    v_mfma_f32_16x16x32_bf16 v[180:183], a[196:199], a[24:27], v[180:183]
    v_mul_f32 v27, v27, v25
    v_cvt_pk_bf16_f32 v29, v26, v27
    v_mfma_f32_16x16x32_bf16 v[148:151], a[192:195], a[24:27], v[148:151]
    v_lshlrev_b32 v26, 16, v29
    v_and_b32 v27, 0xffff0000, v29
    v_mfma_f32_16x16x32_bf16 v[140:143], a[192:195], a[20:23], v[140:143]
    ds_read_b64_tr_b16 a[212:213], v9 offset:10240
    v_mul_f32 v30, s92, v26
    v_mfma_f32_16x16x32_bf16 v[172:175], a[196:199], a[20:23], v[172:175]
    ds_read_b64_tr_b16 a[214:215], v9 offset:11264
    v_mul_f32 v31, s92, v27
    v_mfma_f32_16x16x32_bf16 v[164:167], a[196:199], a[16:19], v[164:167]
    buffer_store_dwordx4 v[84:87], v7, s[24:27], s55 offen sc1
    v_mfma_f32_16x16x32_bf16 v[132:135], a[192:195], a[16:19], v[132:135]
    s_waitcnt lgkmcnt(4)
    v_exp_f32 v30, v30
    v_mfma_f32_16x16x32_bf16 v[132:135], a[200:203], a[32:35], v[132:135]
    s_xor_b32 s55, s55, 1024
    ds_read_b64_tr_b16 a[192:193], v8 offset:12288
    v_mfma_f32_16x16x32_bf16 v[164:167], a[204:207], a[32:35], v[164:167]
    ds_read_b64_tr_b16 a[194:195], v8 offset:13312
    v_mfma_f32_16x16x32_bf16 v[172:175], a[204:207], a[36:39], v[172:175]
    v_exp_f32 v31, v31
    v_mfma_f32_16x16x32_bf16 v[140:143], a[200:203], a[36:39], v[140:143]
    v_add_f32 v30, 1.0, v30
    v_add_f32 v31, 1.0, v31
    v_mfma_f32_16x16x32_bf16 v[148:151], a[200:203], a[40:43], v[148:151]
    ds_read_b64_tr_b16 a[196:197], v9 offset:12288
    v_bfe_u32 v224, v1, 3, 1
    v_mfma_f32_16x16x32_bf16 v[180:183], a[204:207], a[40:43], v[180:183]
    ds_read_b64_tr_b16 a[198:199], v9 offset:13312
    v_lshlrev_b32 v224, 1, v224
    v_mfma_f32_16x16x32_bf16 v[188:191], a[204:207], a[44:47], v[188:191]
    v_rcp_f32 v30, v30
    v_mfma_f32_16x16x32_bf16 v[156:159], a[200:203], a[44:47], v[156:159]
    s_waitcnt lgkmcnt(4)
    v_rcp_f32 v31, v31
    v_mfma_f32_16x16x32_bf16 v[156:159], a[208:211], a[60:63], v[156:159]
    ds_read_b64_tr_b16 a[200:201], v8 offset:14336
    v_mul_f32 v26, v26, v30
    v_mfma_f32_16x16x32_bf16 v[188:191], a[212:215], a[60:63], v[188:191]
    ds_read_b64_tr_b16 a[202:203], v8 offset:15360
    v_mul_f32 v27, v27, v31
    v_mfma_f32_16x16x32_bf16 v[180:183], a[212:215], a[56:59], v[180:183]
    buffer_load_dword v137, v136, s[24:27], s59 offen offset:128 sc1
    v_mfma_f32_16x16x32_bf16 v[148:151], a[208:211], a[56:59], v[148:151]
    buffer_store_dwordx4 v[92:95], v7, s[24:27], s55 offen sc1
    v_mfma_f32_16x16x32_bf16 v[140:143], a[208:211], a[52:55], v[140:143]
    s_xor_b32 s55, s55, 3072
    ds_read_b64_tr_b16 a[204:205], v9 offset:14336
    v_cvt_pk_bf16_f32 v177, v26, v27
    v_mfma_f32_16x16x32_bf16 v[172:175], a[212:215], a[52:55], v[172:175]
    s_waitcnt vmcnt(14)
    ds_read_b64_tr_b16 a[206:207], v9 offset:15360
    v_lshlrev_b32 v26, 16, v154
    v_mfma_f32_16x16x32_bf16 v[164:167], a[212:215], a[48:51], v[164:167]
pg_12:
    s_cbranch_execz pg_ret2
    s_barrier
    v_mfma_f32_16x16x32_bf16 v[132:135], a[208:211], a[48:51], v[132:135]
    s_waitcnt lgkmcnt(4)
    v_and_b32 v27, 0xffff0000, v154
    v_sub_f32 v26, v26, v24
    v_add_u32 v8, 98304, v18
    v_mfma_f32_16x16x32_bf16 v[132:135], a[192:195], a[64:67], v[132:135]
    s_add_u32 s55, s55, 16384
    ds_read_b64_tr_b16 a[208:209], v8 offset:0
    v_sub_f32 v27, v27, v24
    v_mfma_f32_16x16x32_bf16 v[164:167], a[196:199], a[64:67], v[164:167]
    ds_read_b64_tr_b16 a[210:211], v8 offset:1024
    v_cvt_pk_bf16_f32 v29, v26, v27
    v_mfma_f32_16x16x32_bf16 v[172:175], a[196:199], a[68:71], v[172:175]
    buffer_load_dword v23, v3, s[24:27], s6 offen sc1
    v_mfma_f32_16x16x32_bf16 v[140:143], a[192:195], a[68:71], v[140:143]
    v_lshlrev_b32 v26, 16, v29
    v_and_b32 v27, 0xffff0000, v29
    v_add_u32 v9, 98304, v19
    v_mfma_f32_16x16x32_bf16 v[148:151], a[192:195], a[72:75], v[148:151]
    ds_read_b64_tr_b16 a[212:213], v9 offset:0
    v_mul_f32 v26, v26, v25
    v_mfma_f32_16x16x32_bf16 v[180:183], a[196:199], a[72:75], v[180:183]
    ds_read_b64_tr_b16 a[214:215], v9 offset:1024
    v_mul_f32 v27, v27, v25
    v_mfma_f32_16x16x32_bf16 v[188:191], a[196:199], a[76:79], v[188:191]
    v_cvt_pk_bf16_f32 v29, v26, v27
    v_lshlrev_b32 v26, 16, v29
    v_mfma_f32_16x16x32_bf16 v[156:159], a[192:195], a[76:79], v[156:159]
    s_waitcnt lgkmcnt(4)
    v_and_b32 v27, 0xffff0000, v29
    v_mul_f32 v30, s92, v26
    v_mfma_f32_16x16x32_bf16 v[156:159], a[200:203], a[92:95], v[156:159]
    ds_read_b64_tr_b16 a[192:193], v8 offset:2048
    v_mul_f32 v31, s92, v27
    v_mfma_f32_16x16x32_bf16 v[188:191], a[204:207], a[92:95], v[188:191]
    ds_read_b64_tr_b16 a[194:195], v8 offset:3072
    v_lshrrev_b32 v225, 4, v1
    v_mfma_f32_16x16x32_bf16 v[180:183], a[204:207], a[88:91], v[180:183]
    v_exp_f32 v30, v30
    v_mfma_f32_16x16x32_bf16 v[148:151], a[200:203], a[88:91], v[148:151]
    v_exp_f32 v31, v31
    v_mfma_f32_16x16x32_bf16 v[140:143], a[200:203], a[84:87], v[140:143]
    ds_read_b64_tr_b16 a[196:197], v9 offset:2048
    v_add_f32 v30, 1.0, v30
    v_mfma_f32_16x16x32_bf16 v[172:175], a[204:207], a[84:87], v[172:175]
    ds_read_b64_tr_b16 a[198:199], v9 offset:3072
    v_add_f32 v31, 1.0, v31
    v_mfma_f32_16x16x32_bf16 v[164:167], a[204:207], a[80:83], v[164:167]
    v_add_u32 v128, 1, v16
    v_sub_u32 v224, v225, v224
    v_mfma_f32_16x16x32_bf16 v[132:135], a[200:203], a[80:83], v[132:135]
    s_waitcnt lgkmcnt(4)
    v_rcp_f32 v30, v30
    v_mfma_f32_16x16x32_bf16 v[196:199], a[208:211], a[160:163], v[196:199]
    s_waitcnt vmcnt(10)
    ds_read_b64_tr_b16 a[200:201], v8 offset:4096
    v_and_b32 v225, 1, v1
    v_mfma_f32_16x16x32_bf16 v[228:231], a[212:215], a[160:163], v[228:231]
    ds_read_b64_tr_b16 a[202:203], v8 offset:5120
    v_lshlrev_b32 v225, 4, v225
    v_mfma_f32_16x16x32_bf16 v[236:239], a[212:215], a[164:167], v[236:239]
    buffer_store_dword v128, v17, s[24:27], s67 offen offset:0 sc1
    v_mfma_f32_16x16x32_bf16 v[204:207], a[208:211], a[164:167], v[204:207]
    v_rcp_f32 v31, v31
    v_mfma_f32_16x16x32_bf16 v[212:215], a[208:211], a[168:171], v[212:215]
    ds_read_b64_tr_b16 a[204:205], v9 offset:4096
    v_mul_f32 v26, v26, v30
    v_mfma_f32_16x16x32_bf16 v[244:247], a[212:215], a[168:171], v[244:247]
    ds_read_b64_tr_b16 a[206:207], v9 offset:5120
    v_mul_f32 v27, v27, v31
    v_mfma_f32_16x16x32_bf16 v[252:255], a[212:215], a[172:175], v[252:255]
    v_cvt_pk_bf16_f32 v132, v132, v133
    v_cvt_pk_bf16_f32 v133, v134, v135
    v_mfma_f32_16x16x32_bf16 v[220:223], a[208:211], a[172:175], v[220:223]
    s_waitcnt lgkmcnt(4)
    v_cvt_pk_bf16_f32 v134, v164, v165
    v_cvt_pk_bf16_f32 v135, v166, v167
    v_mfma_f32_16x16x32_bf16 v[220:223], a[192:195], a[188:191], v[220:223]
    ds_read_b64_tr_b16 a[208:209], v8 offset:6144
    v_cvt_pk_bf16_f32 v140, v140, v141
    v_mfma_f32_16x16x32_bf16 v[252:255], a[196:199], a[188:191], v[252:255]
    ds_read_b64_tr_b16 a[210:211], v8 offset:7168
    v_cvt_pk_bf16_f32 v141, v142, v143
    v_mfma_f32_16x16x32_bf16 v[244:247], a[196:199], a[184:187], v[244:247]
    buffer_store_dwordx4 v[132:135], v6, s[24:27], s55 offen sc1
    v_mfma_f32_16x16x32_bf16 v[212:215], a[192:195], a[184:187], v[212:215]
    s_xor_b32 s55, s55, 1024
    v_cvt_pk_bf16_f32 v142, v172, v173
    v_cvt_pk_bf16_f32 v143, v174, v175
    v_mfma_f32_16x16x32_bf16 v[204:207], a[192:195], a[180:183], v[204:207]
    ds_read_b64_tr_b16 a[212:213], v9 offset:6144
    v_cvt_pk_bf16_f32 v148, v148, v149
    v_mfma_f32_16x16x32_bf16 v[236:239], a[196:199], a[180:183], v[236:239]
    ds_read_b64_tr_b16 a[214:215], v9 offset:7168
    v_cvt_pk_bf16_f32 v149, v150, v151
    v_mfma_f32_16x16x32_bf16 v[228:231], a[196:199], a[176:179], v[228:231]
    v_cvt_pk_bf16_f32 v150, v180, v181
    v_cvt_pk_bf16_f32 v151, v182, v183
    v_mfma_f32_16x16x32_bf16 v[196:199], a[192:195], a[176:179], v[196:199]
    s_waitcnt lgkmcnt(4)
    v_cvt_pk_bf16_f32 v156, v156, v157
    v_cvt_pk_bf16_f32 v157, v158, v159
    v_mfma_f32_16x16x32_bf16 v[196:199], a[200:203], a[0:3], v[196:199]
    ds_read_b64_tr_b16 a[192:193], v8 offset:8192
    v_cvt_pk_bf16_f32 v158, v188, v189
    v_mfma_f32_16x16x32_bf16 v[228:231], a[204:207], a[0:3], v[228:231]
    ds_read_b64_tr_b16 a[194:195], v8 offset:9216
    v_cvt_pk_bf16_f32 v159, v190, v191
    v_mfma_f32_16x16x32_bf16 v[236:239], a[204:207], a[4:7], v[236:239]
    buffer_store_dwordx4 v[140:143], v6, s[24:27], s55 offen sc1
    v_mfma_f32_16x16x32_bf16 v[204:207], a[200:203], a[4:7], v[204:207]
    s_xor_b32 s55, s55, 3072
    v_cvt_pk_bf16_f32 v178, v26, v27
    v_lshlrev_b32 v26, 16, v155
    v_mfma_f32_16x16x32_bf16 v[212:215], a[200:203], a[8:11], v[212:215]
    ds_read_b64_tr_b16 a[196:197], v9 offset:8192
    v_and_b32 v27, 0xffff0000, v155
    v_mfma_f32_16x16x32_bf16 v[244:247], a[204:207], a[8:11], v[244:247]
    ds_read_b64_tr_b16 a[198:199], v9 offset:9216
    v_sub_f32 v26, v26, v24
    v_mfma_f32_16x16x32_bf16 v[252:255], a[204:207], a[12:15], v[252:255]
    s_waitcnt vmcnt(3)
    v_sub_u32 v15, v23, v5
    v_cmp_ge_u32 vcc, 4, v15
    v_mfma_f32_16x16x32_bf16 v[220:223], a[200:203], a[12:15], v[220:223]
    s_waitcnt lgkmcnt(4)
    v_sub_f32 v27, v27, v24
    v_cvt_pk_bf16_f32 v29, v26, v27
    v_mfma_f32_16x16x32_bf16 v[220:223], a[208:211], a[28:31], v[220:223]
    s_and_b32 s69, vcc_lo, 0xffffff
    ds_read_b64_tr_b16 a[200:201], v8 offset:10240
    v_lshlrev_b32 v26, 16, v29
    v_mfma_f32_16x16x32_bf16 v[252:255], a[212:215], a[28:31], v[252:255]
    s_andn2_b32 s69, s69, s68
    ds_read_b64_tr_b16 a[202:203], v8 offset:11264
    v_and_b32 v27, 0xffff0000, v29
    v_mfma_f32_16x16x32_bf16 v[244:247], a[212:215], a[24:27], v[244:247]
    s_or_b32 s68, s68, s69
    v_mul_f32 v26, v26, v25
    v_mul_f32 v27, v27, v25
    v_mfma_f32_16x16x32_bf16 v[212:215], a[208:211], a[24:27], v[212:215]
    s_add_u32 m0, s37, 0
    v_cvt_pk_bf16_f32 v29, v26, v27
    v_lshlrev_b32 v26, 16, v29
    v_mfma_f32_16x16x32_bf16 v[204:207], a[208:211], a[20:23], v[204:207]
    s_waitcnt vmcnt(5)
    ds_read_b64_tr_b16 a[204:205], v9 offset:10240
    v_cmp_ne_u32 s[78:79], 24, v137
    v_mfma_f32_16x16x32_bf16 v[236:239], a[212:215], a[20:23], v[236:239]
    s_cmp_eq_u64 s[78:79], 0
    s_cselect_b32 s44, s59, 0x70000000
    ds_read_b64_tr_b16 a[206:207], v9 offset:11264
    v_mfma_f32_16x16x32_bf16 v[228:231], a[212:215], a[16:19], v[228:231]
    buffer_load_dwordx4 v[240:243], v192, s[24:27], s44 offen sc1
    v_mfma_f32_16x16x32_bf16 v[196:199], a[208:211], a[16:19], v[196:199]
    s_waitcnt lgkmcnt(4)
    v_and_b32 v27, 0xffff0000, v29
    v_mul_f32 v30, s92, v26
    v_mfma_f32_16x16x32_bf16 v[196:199], a[192:195], a[32:35], v[196:199]
    s_bitcmp1_b32 s93, 13
    s_cselect_b32 s56, s40, s47
    s_xor_b32 s56, s56, 0
    ds_read_b64_tr_b16 a[208:209], v8 offset:12288
    v_mfma_f32_16x16x32_bf16 v[228:231], a[196:199], a[32:35], v[228:231]
    s_bitcmp1_b32 s69, 0
    s_cselect_b32 s56, s56, 0x70000000
    s_cselect_b32 m0, m0, 0x30000
    ds_read_b64_tr_b16 a[210:211], v8 offset:13312
    v_mfma_f32_16x16x32_bf16 v[236:239], a[196:199], a[36:39], v[236:239]
    buffer_load_dwordx4 v28, s[24:27], s56 offen sc1 lds
    v_mfma_f32_16x16x32_bf16 v[204:207], a[192:195], a[36:39], v[204:207]
    buffer_store_dwordx4 v[148:151], v7, s[24:27], s55 offen sc1
    v_mfma_f32_16x16x32_bf16 v[212:215], a[192:195], a[40:43], v[212:215]
    s_add_u32 m0, s37, 1024
    ds_read_b64_tr_b16 a[212:213], v9 offset:12288
    v_mul_f32 v31, s92, v27
    v_mfma_f32_16x16x32_bf16 v[244:247], a[196:199], a[40:43], v[244:247]
    s_bitcmp1_b32 s93, 14
    s_cselect_b32 s56, s40, s47
    s_xor_b32 s56, s56, 8389632
    ds_read_b64_tr_b16 a[214:215], v9 offset:13312
    v_mfma_f32_16x16x32_bf16 v[252:255], a[196:199], a[44:47], v[252:255]
    s_bitcmp1_b32 s69, 1
    s_cselect_b32 s56, s56, 0x70000000
    s_cselect_b32 m0, m0, 0x30000
    v_mfma_f32_16x16x32_bf16 v[220:223], a[192:195], a[44:47], v[220:223]
    s_waitcnt lgkmcnt(4)
    buffer_load_dwordx4 v28, s[24:27], s56 offen sc1 lds
    v_mfma_f32_16x16x32_bf16 v[220:223], a[200:203], a[60:63], v[220:223]
    s_add_u32 m0, s37, 2048
    ds_read_b64_tr_b16 a[192:193], v8 offset:14336
    v_mov_b32 v226, 0x3f80
    v_mfma_f32_16x16x32_bf16 v[252:255], a[204:207], a[60:63], v[252:255]
    s_bitcmp1_b32 s93, 15
    s_cselect_b32 s56, s40, s47
    s_xor_b32 s56, s56, 16779264
    ds_read_b64_tr_b16 a[194:195], v8 offset:15360
    v_mfma_f32_16x16x32_bf16 v[244:247], a[204:207], a[56:59], v[244:247]
    s_bitcmp1_b32 s69, 2
    s_cselect_b32 s56, s56, 0x70000000
    s_cselect_b32 m0, m0, 0x30000
    v_mfma_f32_16x16x32_bf16 v[212:215], a[200:203], a[56:59], v[212:215]
    buffer_load_dwordx4 v28, s[24:27], s56 offen sc1 lds
    v_mfma_f32_16x16x32_bf16 v[204:207], a[200:203], a[52:55], v[204:207]
    s_add_u32 m0, s37, 3072
    ds_read_b64_tr_b16 a[196:197], v9 offset:14336
    v_lshlrev_b32 v225, v225, v226
    v_mfma_f32_16x16x32_bf16 v[236:239], a[204:207], a[52:55], v[236:239]
    s_waitcnt vmcnt(13)
    ds_read_b64_tr_b16 a[198:199], v9 offset:15360
    v_bfe_u32 v226, v1, 1, 2
    v_mfma_f32_16x16x32_bf16 v[228:231], a[204:207], a[48:51], v[228:231]
    s_barrier
    v_mfma_f32_16x16x32_bf16 v[196:199], a[200:203], a[48:51], v[196:199]
    s_waitcnt lgkmcnt(4)
    v_exp_f32 v30, v30
    v_add_u32 v8, 49152, v18
    v_mfma_f32_16x16x32_bf16 v[196:199], a[208:211], a[64:67], v[196:199]
    s_bitcmp1_b32 s93, 16
    s_cselect_b32 s56, s40, s47
    s_xor_b32 s56, s56, 25168896
    ds_read_b64_tr_b16 a[200:201], v8 offset:0
    v_mfma_f32_16x16x32_bf16 v[228:231], a[212:215], a[64:67], v[228:231]
    s_bitcmp1_b32 s69, 3
    s_cselect_b32 s56, s56, 0x70000000
    s_cselect_b32 m0, m0, 0x30000
    ds_read_b64_tr_b16 a[202:203], v8 offset:1024
    v_mfma_f32_16x16x32_bf16 v[236:239], a[212:215], a[68:71], v[236:239]
    buffer_load_dwordx4 v28, s[24:27], s56 offen sc1 lds
    v_mfma_f32_16x16x32_bf16 v[204:207], a[208:211], a[68:71], v[204:207]
    s_add_u32 m0, s37, 4096
    v_exp_f32 v31, v31
    v_add_u32 v9, 49152, v19
    v_mfma_f32_16x16x32_bf16 v[212:215], a[208:211], a[72:75], v[212:215]
    s_bitcmp1_b32 s93, 17
    s_cselect_b32 s56, s40, s47
    s_xor_b32 s56, s56, 33558528
    ds_read_b64_tr_b16 a[204:205], v9 offset:0
    v_mfma_f32_16x16x32_bf16 v[244:247], a[212:215], a[72:75], v[244:247]
    s_bitcmp1_b32 s69, 4
    s_cselect_b32 s56, s56, 0x70000000
    s_cselect_b32 m0, m0, 0x30000
    ds_read_b64_tr_b16 a[206:207], v9 offset:1024
    v_mfma_f32_16x16x32_bf16 v[252:255], a[212:215], a[76:79], v[252:255]
    buffer_load_dwordx4 v28, s[24:27], s56 offen sc1 lds
    v_mfma_f32_16x16x32_bf16 v[220:223], a[208:211], a[76:79], v[220:223]
    s_waitcnt lgkmcnt(4)
    v_add_f32 v30, 1.0, v30
    v_add_f32 v31, 1.0, v31
    v_mfma_f32_16x16x32_bf16 v[220:223], a[192:195], a[92:95], v[220:223]
    s_add_u32 m0, s37, 5120
    ds_read_b64_tr_b16 a[208:209], v8 offset:2048
    v_lshl_add_u32 v226, v224, 2, v226
    v_mfma_f32_16x16x32_bf16 v[252:255], a[196:199], a[92:95], v[252:255]
    s_bitcmp1_b32 s93, 18
    s_cselect_b32 s56, s40, s47
    s_xor_b32 s56, s56, 41948160
    ds_read_b64_tr_b16 a[210:211], v8 offset:3072
    v_mfma_f32_16x16x32_bf16 v[244:247], a[196:199], a[88:91], v[244:247]
    s_bitcmp1_b32 s69, 5
    s_cselect_b32 s56, s56, 0x70000000
    s_cselect_b32 m0, m0, 0x30000
    v_mfma_f32_16x16x32_bf16 v[212:215], a[192:195], a[88:91], v[212:215]
    buffer_load_dwordx4 v28, s[24:27], s56 offen sc1 lds
    v_mfma_f32_16x16x32_bf16 v[204:207], a[192:195], a[84:87], v[204:207]
    s_add_u32 m0, s37, 6144
    ds_read_b64_tr_b16 a[212:213], v9 offset:2048
    v_cmp_eq_u32 s[10:11], 0, v226
    v_mfma_f32_16x16x32_bf16 v[236:239], a[196:199], a[84:87], v[236:239]
    s_bitcmp1_b32 s93, 19
    s_cselect_b32 s56, s40, s47
    s_xor_b32 s56, s56, 50337792
    ds_read_b64_tr_b16 a[214:215], v9 offset:3072
    v_mfma_f32_16x16x32_bf16 v[228:231], a[196:199], a[80:83], v[228:231]
    s_bitcmp1_b32 s69, 6
    s_cselect_b32 s56, s56, 0x70000000
    s_cselect_b32 m0, m0, 0x30000
    v_mfma_f32_16x16x32_bf16 v[196:199], a[192:195], a[80:83], v[196:199]
    s_waitcnt lgkmcnt(4)
    buffer_load_dwordx4 v28, s[24:27], s56 offen sc1 lds
    v_mfma_f32_16x16x32_bf16 v[32:35], a[200:203], a[160:163], v[32:35]
    s_add_u32 m0, s37, 7168
    ds_read_b64_tr_b16 a[192:193], v8 offset:4096
    v_add_u32 v129, 2, v16
    v_mfma_f32_16x16x32_bf16 v[48:51], a[204:207], a[160:163], v[48:51]
    s_waitcnt vmcnt(13)
    ds_read_b64_tr_b16 a[194:195], v8 offset:5120
    v_cndmask_b32 v208, 0, v225, s[10:11]
    v_mfma_f32_16x16x32_bf16 v[52:55], a[204:207], a[164:167], v[52:55]
    buffer_store_dword v129, v17, s[24:27], s67 offen offset:0 sc1
    v_mfma_f32_16x16x32_bf16 v[36:39], a[200:203], a[164:167], v[36:39]
    s_bitcmp1_b32 s93, 20
    s_cselect_b32 s56, s40, s47
    s_xor_b32 s56, s56, 58727424
    v_mfma_f32_16x16x32_bf16 v[40:43], a[200:203], a[168:171], v[40:43]
    s_bitcmp1_b32 s69, 7
    s_cselect_b32 s56, s56, 0x70000000
    s_cselect_b32 m0, m0, 0x30000
    ds_read_b64_tr_b16 a[196:197], v9 offset:4096
    v_mfma_f32_16x16x32_bf16 v[56:59], a[204:207], a[168:171], v[56:59]
    s_xor_b32 s55, s55, 1024
    ds_read_b64_tr_b16 a[198:199], v9 offset:5120
    v_cmp_eq_u32 s[10:11], 1, v226
    v_mfma_f32_16x16x32_bf16 v[60:63], a[204:207], a[172:175], v[60:63]
    buffer_load_dwordx4 v28, s[24:27], s56 offen sc1 lds
    v_mfma_f32_16x16x32_bf16 v[44:47], a[200:203], a[172:175], v[44:47]
    s_waitcnt lgkmcnt(4)
    buffer_store_dwordx4 v[156:159], v7, s[24:27], s55 offen sc1
    v_mfma_f32_16x16x32_bf16 v[44:47], a[208:211], a[188:191], v[44:47]
    s_and_b32 s69, s69, 16776960
    s_andn2_b32 s68, s68, s69
    ds_read_b64_tr_b16 a[200:201], v8 offset:6144
    v_mfma_f32_16x16x32_bf16 v[60:63], a[212:215], a[188:191], v[60:63]
    s_xor_b32 s55, s55, 3072
    ds_read_b64_tr_b16 a[202:203], v8 offset:7168
    v_cvt_pk_bf16_f32 v196, v196, v197
    v_mfma_f32_16x16x32_bf16 v[56:59], a[212:215], a[184:187], v[56:59]
    s_add_u32 s55, s55, 16384
    v_cvt_pk_bf16_f32 v197, v198, v199
    v_cvt_pk_bf16_f32 v198, v228, v229
    v_mfma_f32_16x16x32_bf16 v[40:43], a[208:211], a[184:187], v[40:43]
    v_cvt_pk_bf16_f32 v199, v230, v231
    v_cvt_pk_bf16_f32 v204, v204, v205
    v_mfma_f32_16x16x32_bf16 v[36:39], a[208:211], a[180:183], v[36:39]
    ds_read_b64_tr_b16 a[204:205], v9 offset:6144
    v_cvt_pk_bf16_f32 v205, v206, v207
    v_mfma_f32_16x16x32_bf16 v[52:55], a[212:215], a[180:183], v[52:55]
    ds_read_b64_tr_b16 a[206:207], v9 offset:7168
    v_cvt_pk_bf16_f32 v206, v236, v237
    v_mfma_f32_16x16x32_bf16 v[48:51], a[212:215], a[176:179], v[48:51]
    buffer_store_dwordx4 v[196:199], v6, s[24:27], s55 offen sc1
    v_mfma_f32_16x16x32_bf16 v[32:35], a[208:211], a[176:179], v[32:35]
    s_waitcnt lgkmcnt(4)
    v_cvt_pk_bf16_f32 v207, v238, v239
    v_cvt_pk_bf16_f32 v212, v212, v213
    v_mfma_f32_16x16x32_bf16 v[32:35], a[192:195], a[0:3], v[32:35]
    s_xor_b32 s55, s55, 1024
    ds_read_b64_tr_b16 a[208:209], v8 offset:8192
    v_cvt_pk_bf16_f32 v213, v214, v215
    v_mfma_f32_16x16x32_bf16 v[48:51], a[196:199], a[0:3], v[48:51]
    ds_read_b64_tr_b16 a[210:211], v8 offset:9216
    v_cvt_pk_bf16_f32 v214, v244, v245
    v_mfma_f32_16x16x32_bf16 v[52:55], a[196:199], a[4:7], v[52:55]
    buffer_store_dwordx4 v[204:207], v6, s[24:27], s55 offen sc1
    v_mfma_f32_16x16x32_bf16 v[36:39], a[192:195], a[4:7], v[36:39]
    s_xor_b32 s55, s55, 3072
    v_cvt_pk_bf16_f32 v215, v246, v247
    v_cvt_pk_bf16_f32 v220, v220, v221
    v_mfma_f32_16x16x32_bf16 v[40:43], a[192:195], a[8:11], v[40:43]
    ds_read_b64_tr_b16 a[212:213], v9 offset:8192
    v_cvt_pk_bf16_f32 v221, v222, v223
    v_mfma_f32_16x16x32_bf16 v[56:59], a[196:199], a[8:11], v[56:59]
    ds_read_b64_tr_b16 a[214:215], v9 offset:9216
    v_cvt_pk_bf16_f32 v222, v252, v253
    v_mfma_f32_16x16x32_bf16 v[60:63], a[196:199], a[12:15], v[60:63]
    v_cvt_pk_bf16_f32 v223, v254, v255
    v_cndmask_b32 v209, 0, v225, s[10:11]
    v_mfma_f32_16x16x32_bf16 v[44:47], a[192:195], a[12:15], v[44:47]
    s_waitcnt lgkmcnt(4)
    v_rcp_f32 v30, v30
    v_mfma_f32_16x16x32_bf16 v[44:47], a[200:203], a[28:31], v[44:47]
    ds_read_b64_tr_b16 a[192:193], v8 offset:10240
    v_cmp_eq_u32 s[10:11], 2, v226
    v_mfma_f32_16x16x32_bf16 v[60:63], a[204:207], a[28:31], v[60:63]
    ds_read_b64_tr_b16 a[194:195], v8 offset:11264
    v_cndmask_b32 v210, 0, v225, s[10:11]
    v_mfma_f32_16x16x32_bf16 v[56:59], a[204:207], a[24:27], v[56:59]
    v_rcp_f32 v31, v31
    v_mfma_f32_16x16x32_bf16 v[40:43], a[200:203], a[24:27], v[40:43]
    v_mul_f32 v26, v26, v30
    v_mul_f32 v27, v27, v31
    v_mfma_f32_16x16x32_bf16 v[36:39], a[200:203], a[20:23], v[36:39]
    ds_read_b64_tr_b16 a[196:197], v9 offset:10240
    v_cvt_pk_bf16_f32 v179, v26, v27
    v_mfma_f32_16x16x32_bf16 v[52:55], a[204:207], a[20:23], v[52:55]
    ds_read_b64_tr_b16 a[198:199], v9 offset:11264
    v_lshlrev_b32 v26, 16, v160
    v_mfma_f32_16x16x32_bf16 v[48:51], a[204:207], a[16:19], v[48:51]
    buffer_store_dwordx4 v[212:215], v7, s[24:27], s55 offen sc1
    v_mfma_f32_16x16x32_bf16 v[32:35], a[200:203], a[16:19], v[32:35]
    s_waitcnt lgkmcnt(4)
    v_and_b32 v27, 0xffff0000, v160
    v_sub_f32 v26, v26, v24
    v_mfma_f32_16x16x32_bf16 v[32:35], a[208:211], a[32:35], v[32:35]
    s_xor_b32 s55, s55, 1024
    ds_read_b64_tr_b16 a[200:201], v8 offset:12288
    v_sub_f32 v27, v27, v24
    v_mfma_f32_16x16x32_bf16 v[48:51], a[212:215], a[32:35], v[48:51]
    ds_read_b64_tr_b16 a[202:203], v8 offset:13312
    v_cvt_pk_bf16_f32 v29, v26, v27
    v_mfma_f32_16x16x32_bf16 v[52:55], a[212:215], a[36:39], v[52:55]
    v_lshlrev_b32 v26, 16, v29
    v_and_b32 v27, 0xffff0000, v29
    v_mfma_f32_16x16x32_bf16 v[36:39], a[208:211], a[36:39], v[36:39]
    v_mul_f32 v26, v26, v25
    v_mul_f32 v27, v27, v25
    v_mfma_f32_16x16x32_bf16 v[40:43], a[208:211], a[40:43], v[40:43]
    ds_read_b64_tr_b16 a[204:205], v9 offset:12288
    v_cvt_pk_bf16_f32 v29, v26, v27
    v_mfma_f32_16x16x32_bf16 v[56:59], a[212:215], a[40:43], v[56:59]
    ds_read_b64_tr_b16 a[206:207], v9 offset:13312
    v_lshlrev_b32 v26, 16, v29
    v_mfma_f32_16x16x32_bf16 v[60:63], a[212:215], a[44:47], v[60:63]
    v_and_b32 v27, 0xffff0000, v29
    v_mul_f32 v30, s92, v26
    v_mfma_f32_16x16x32_bf16 v[44:47], a[208:211], a[44:47], v[44:47]
    s_waitcnt lgkmcnt(4)
    v_mul_f32 v31, s92, v27
    v_cmp_eq_u32 s[10:11], 3, v226
    v_mfma_f32_16x16x32_bf16 v[44:47], a[192:195], a[60:63], v[44:47]
    ds_read_b64_tr_b16 a[208:209], v8 offset:14336
    v_cndmask_b32 v211, 0, v225, s[10:11]
    v_mfma_f32_16x16x32_bf16 v[60:63], a[196:199], a[60:63], v[60:63]
    ds_read_b64_tr_b16 a[210:211], v8 offset:15360
    v_cmp_eq_u32 s[10:11], 4, v226
    v_mfma_f32_16x16x32_bf16 v[56:59], a[196:199], a[56:59], v[56:59]
    buffer_store_dwordx4 v[220:223], v7, s[24:27], s55 offen sc1
    v_mfma_f32_16x16x32_bf16 v[40:43], a[192:195], a[56:59], v[40:43]
    s_xor_b32 s55, s55, 3072
    v_exp_f32 v30, v30
    v_mfma_f32_16x16x32_bf16 v[36:39], a[192:195], a[52:55], v[36:39]
    s_add_u32 s55, s55, 16384
    ds_read_b64_tr_b16 a[212:213], v9 offset:14336
    v_cndmask_b32 v216, 0, v225, s[10:11]
    v_mfma_f32_16x16x32_bf16 v[52:55], a[196:199], a[52:55], v[52:55]
    ds_read_b64_tr_b16 a[214:215], v9 offset:15360
    v_cmp_eq_u32 s[10:11], 5, v226
    v_mfma_f32_16x16x32_bf16 v[48:51], a[196:199], a[48:51], v[48:51]
    buffer_load_dword v23, v3, s[24:27], s6 offen sc1
    v_mfma_f32_16x16x32_bf16 v[32:35], a[192:195], a[48:51], v[32:35]
    s_waitcnt lgkmcnt(4)
    v_exp_f32 v31, v31
    v_mfma_f32_16x16x32_bf16 v[32:35], a[200:203], a[64:67], v[32:35]
    v_add_f32 v30, 1.0, v30
    v_add_f32 v31, 1.0, v31
    v_mfma_f32_16x16x32_bf16 v[48:51], a[204:207], a[64:67], v[48:51]
    v_rcp_f32 v30, v30
    v_mfma_f32_16x16x32_bf16 v[52:55], a[204:207], a[68:71], v[52:55]
    v_rcp_f32 v31, v31
    v_mfma_f32_16x16x32_bf16 v[36:39], a[200:203], a[68:71], v[36:39]
    v_mul_f32 v26, v26, v30
    v_mul_f32 v27, v27, v31
    v_mfma_f32_16x16x32_bf16 v[40:43], a[200:203], a[72:75], v[40:43]
    v_cvt_pk_bf16_f32 v184, v26, v27
    v_lshlrev_b32 v26, 16, v161
    v_mfma_f32_16x16x32_bf16 v[56:59], a[204:207], a[72:75], v[56:59]
    v_and_b32 v27, 0xffff0000, v161
    v_sub_f32 v26, v26, v24
    v_mfma_f32_16x16x32_bf16 v[60:63], a[204:207], a[76:79], v[60:63]
    v_sub_f32 v27, v27, v24
    v_cvt_pk_bf16_f32 v29, v26, v27
    v_mfma_f32_16x16x32_bf16 v[44:47], a[200:203], a[76:79], v[44:47]
    s_waitcnt lgkmcnt(0)
    v_lshlrev_b32 v26, 16, v29
    v_and_b32 v27, 0xffff0000, v29
    v_mfma_f32_16x16x32_bf16 v[44:47], a[208:211], a[92:95], v[44:47]
    v_mul_f32 v26, v26, v25
    v_mul_f32 v27, v27, v25
    v_mfma_f32_16x16x32_bf16 v[60:63], a[212:215], a[92:95], v[60:63]
    v_cvt_pk_bf16_f32 v29, v26, v27
    v_lshlrev_b32 v26, 16, v29
    v_mfma_f32_16x16x32_bf16 v[56:59], a[212:215], a[88:91], v[56:59]
    v_and_b32 v27, 0xffff0000, v29
    v_mul_f32 v30, s92, v26
    v_mfma_f32_16x16x32_bf16 v[40:43], a[208:211], a[88:91], v[40:43]
    v_mul_f32 v31, s92, v27
    v_cndmask_b32 v217, 0, v225, s[10:11]
    v_mfma_f32_16x16x32_bf16 v[36:39], a[208:211], a[84:87], v[36:39]
    v_exp_f32 v30, v30
    v_mfma_f32_16x16x32_bf16 v[52:55], a[212:215], a[84:87], v[52:55]
    v_exp_f32 v31, v31
    v_mfma_f32_16x16x32_bf16 v[48:51], a[212:215], a[80:83], v[48:51]
    v_add_f32 v30, 1.0, v30
    v_add_f32 v31, 1.0, v31
    v_mfma_f32_16x16x32_bf16 v[32:35], a[208:211], a[80:83], v[32:35]
    v_rcp_f32 v30, v30
    s_nop 7
    v_cvt_pk_bf16_f32 v32, v32, v33
    v_cvt_pk_bf16_f32 v33, v34, v35
    v_cvt_pk_bf16_f32 v34, v48, v49
    v_cvt_pk_bf16_f32 v35, v50, v51
    buffer_store_dwordx4 v[32:35], v6, s[24:27], s55 offen sc1
    s_xor_b32 s55, s55, 1024
    v_cvt_pk_bf16_f32 v36, v36, v37
    v_cvt_pk_bf16_f32 v37, v38, v39
    v_cvt_pk_bf16_f32 v38, v52, v53
    v_cvt_pk_bf16_f32 v39, v54, v55
    buffer_store_dwordx4 v[36:39], v6, s[24:27], s55 offen sc1
    s_xor_b32 s55, s55, 3072
    v_cvt_pk_bf16_f32 v40, v40, v41
    v_cvt_pk_bf16_f32 v41, v42, v43
    v_cvt_pk_bf16_f32 v42, v56, v57
    v_cvt_pk_bf16_f32 v43, v58, v59
    buffer_store_dwordx4 v[40:43], v7, s[24:27], s55 offen sc1
    s_xor_b32 s55, s55, 1024
    v_cvt_pk_bf16_f32 v44, v44, v45
    v_cvt_pk_bf16_f32 v45, v46, v47
    v_cvt_pk_bf16_f32 v46, v60, v61
    v_cvt_pk_bf16_f32 v47, v62, v63
    buffer_store_dwordx4 v[44:47], v7, s[24:27], s55 offen sc1
    s_xor_b32 s55, s55, 3072
    s_add_u32 s55, s55, 16384
    v_rcp_f32 v31, v31
    v_cmp_eq_u32 s[10:11], 6, v226
    v_mul_f32 v26, v26, v30
    v_mul_f32 v27, v27, v31
    v_cvt_pk_bf16_f32 v185, v26, v27
    v_lshlrev_b32 v26, 16, v162
    v_and_b32 v27, 0xffff0000, v162
    v_sub_f32 v26, v26, v24
    v_sub_f32 v27, v27, v24
    v_cvt_pk_bf16_f32 v29, v26, v27
    v_lshlrev_b32 v26, 16, v29
    v_and_b32 v27, 0xffff0000, v29
    v_mul_f32 v26, v26, v25
    v_mul_f32 v27, v27, v25
    v_cvt_pk_bf16_f32 v29, v26, v27
    v_lshlrev_b32 v26, 16, v29
    v_and_b32 v27, 0xffff0000, v29
    v_mul_f32 v30, s92, v26
    v_mul_f32 v31, s92, v27
    v_exp_f32 v30, v30
    v_exp_f32 v31, v31
    v_cndmask_b32 v218, 0, v225, s[10:11]
    v_add_f32 v30, 1.0, v30
    v_add_f32 v31, 1.0, v31
    v_rcp_f32 v30, v30
    v_rcp_f32 v31, v31
    v_cmp_eq_u32 s[10:11], 7, v226
    v_mul_f32 v26, v26, v30
    v_mul_f32 v27, v27, v31
    v_cvt_pk_bf16_f32 v186, v26, v27
    v_lshlrev_b32 v26, 16, v163
    v_and_b32 v27, 0xffff0000, v163
    v_sub_f32 v26, v26, v24
    v_sub_f32 v27, v27, v24
    v_cvt_pk_bf16_f32 v29, v26, v27
    v_lshlrev_b32 v26, 16, v29
    v_and_b32 v27, 0xffff0000, v29
    v_mul_f32 v26, v26, v25
    v_mul_f32 v27, v27, v25
    v_cvt_pk_bf16_f32 v29, v26, v27
    v_lshlrev_b32 v26, 16, v29
    v_and_b32 v27, 0xffff0000, v29
    v_mul_f32 v30, s92, v26
    v_mul_f32 v31, s92, v27
    v_exp_f32 v30, v30
    v_exp_f32 v31, v31
    v_cndmask_b32 v219, 0, v225, s[10:11]
    v_add_f32 v30, 1.0, v30
    v_add_f32 v31, 1.0, v31
    v_rcp_f32 v30, v30
    v_rcp_f32 v31, v31
    s_add_u32 s10, s86, s6
    s_addc_u32 s11, s87, 0
    v_mul_f32 v26, v26, v30
    v_mul_f32 v27, v27, v31
    v_cvt_pk_bf16_f32 v187, v26, v27
post_code:
    s_cmp_ge_u32 s3, 2
    s_cselect_b32 s60, 0, 0xff00
    s_mov_b32 s45, 1
    s_andn2_b32 s55, s68, s60
    s_waitcnt vmcnt(4)
    v_add_u32 v131, 4, v16
    buffer_store_dword v131, v17, s[24:27], s67 offen offset:0 sc1
    v_add_u32 v128, 5, v16
    v_sub_u32 v15, v23, v5
    v_cmp_ge_u32 vcc, 4, v15
    s_and_b32 s69, vcc_lo, 0xffffff
    s_andn2_b32 s69, s69, s68
    s_or_b32 s68, s68, s69
    s_and_b32 s8, s69, 0xff00ff
    s_andn2_b32 s69, s69, s8
    s_bcnt1_i32_b32 s9, s8
    s_cmp_eq_u32 s8, 0
    s_cbranch_scc1 e0_issued
e0_iss:
    s_ff1_i32_b32 s56, s8
    s_bitset0_b32 s8, s56
    s_lshr_b32 s57, s56, 3
    s_mul_i32 s57, s57, s48
    s_lshl_b32 s39, s56, 10
    s_add_u32 m0, s37, s39
    s_and_b32 s56, s56, 7
    s_lshr_b32 s39, s93, s56
    s_and_b32 s39, s39, 0x2000
    s_mul_i32 s56, s56, 8389632
    s_add_u32 s57, s57, s47
    s_xor_b32 s56, s56, s39
    s_xor_b32 s56, s56, s57
    buffer_load_dwordx4 v28, s[24:27], s56 offen sc1 lds
    s_cmp_lg_u32 s8, 0
    s_cbranch_scc1 e0_iss
e0_issued:
    s_mov_b32 s32, s84
    s_and_b32 s33, s85, 0xffff
    s_mov_b32 s34, 2621440
    s_mov_b32 s35, 0x00020000
    s_lshr_b32 s56, s53, 1
    s_cmp_eq_u32 s56, s3
    s_cbranch_scc0 own_share_ret
    s_lshl_b32 s56, s53, 10
    v_add_u32 v8, s56, v28
    v_add_u32 v11, 122880, v8
    v_add_u32 v10, 73728, v8
    v_add_u32 v9, 24576, v8
pg_13:
    s_cbranch_execz pg_ret2
    v_add_u32 v8, 0, v8
    s_bitcmp1_b32 s53, 0
    s_cbranch_scc1 own_odd
    ds_write_b128 v8, v[32:35] offset:16384
    ds_write_b128 v9, v[36:39] offset:16384
    ds_write_b128 v10, v[196:199] offset:16384
    ds_write_b128 v11, v[204:207] offset:16384
    ds_write_b128 v10, v[132:135] offset:8192
    ds_write_b128 v11, v[140:143] offset:8192
    ds_write_b128 v10, v[68:71] offset:0
    ds_write_b128 v11, v[76:79] offset:0
    ds_write_b128 v8, v[64:67] offset:0
    ds_write_b128 v9, v[80:83] offset:0
    s_branch own_share_ret
own_odd:
    ds_write_b128 v8, v[40:43] offset:16384
    ds_write_b128 v9, v[44:47] offset:16384
    ds_write_b128 v10, v[212:215] offset:16384
    ds_write_b128 v11, v[220:223] offset:16384
    ds_write_b128 v10, v[148:151] offset:8192
    ds_write_b128 v11, v[156:159] offset:8192
    ds_write_b128 v10, v[84:87] offset:0
    ds_write_b128 v11, v[92:95] offset:0
    ds_write_b128 v8, v[96:99] offset:0
    ds_write_b128 v9, v[112:115] offset:0
own_share_ret:
    s_cmp_ge_u32 s9, 14
    s_waitcnt vmcnt(15)
    s_cbranch_scc1 w4_done
    s_cmp_ge_u32 s9, 13
    s_waitcnt vmcnt(14)
    s_cbranch_scc1 w4_done
    s_cmp_ge_u32 s9, 12
    s_waitcnt vmcnt(13)
    s_cbranch_scc1 w4_done
    s_cmp_ge_u32 s9, 11
    s_waitcnt vmcnt(12)
    s_cbranch_scc1 w4_done
    s_cmp_ge_u32 s9, 10
    s_waitcnt vmcnt(11)
    s_cbranch_scc1 w4_done
    s_cmp_ge_u32 s9, 9
    s_waitcnt vmcnt(10)
    s_cbranch_scc1 w4_done
    s_cmp_ge_u32 s9, 8
    s_waitcnt vmcnt(9)
    s_cbranch_scc1 w4_done
    s_cmp_ge_u32 s9, 7
    s_waitcnt vmcnt(8)
    s_cbranch_scc1 w4_done
    s_cmp_ge_u32 s9, 6
    s_waitcnt vmcnt(7)
    s_cbranch_scc1 w4_done
    s_cmp_ge_u32 s9, 5
    s_waitcnt vmcnt(6)
    s_cbranch_scc1 w4_done
    s_cmp_ge_u32 s9, 4
    s_waitcnt vmcnt(5)
    s_cbranch_scc1 w4_done
    s_cmp_ge_u32 s9, 3
    s_waitcnt vmcnt(4)
    s_cbranch_scc1 w4_done
    s_cmp_ge_u32 s9, 2
    s_waitcnt vmcnt(3)
    s_cbranch_scc1 w4_done
    s_cmp_ge_u32 s9, 1
    s_waitcnt vmcnt(2)
    s_cbranch_scc1 w4_done
    s_waitcnt vmcnt(1)
w4_done:
    buffer_store_dword v128, v17, s[24:27], s67 offen offset:4 sc1
    s_branch ev_first
ev_loop:
    s_cmp_ge_u32 s9, 2
    s_waitcnt vmcnt(2)
    s_cbranch_scc1 ev_w
    s_cmp_eq_u32 s9, 1
    s_waitcnt vmcnt(1)
    s_cbranch_scc1 ev_w
    s_waitcnt vmcnt(0)
ev_w:
    s_andn2_b32 s55, s68, s60
    v_sub_u32 v15, v23, v5
    v_cmp_ge_u32 vcc, 4, v15
    s_and_b32 s69, vcc_lo, 0xffffff
    s_andn2_b32 s69, s69, s68
    s_or_b32 s68, s68, s69
ev_first:
    s_cmp_eq_u32 s69, 0
    s_cbranch_scc1 ev_issued
ev_iss:
    s_ff1_i32_b32 s56, s69
    s_bitset0_b32 s69, s56
    s_lshr_b32 s57, s56, 3
    s_mul_i32 s57, s57, s48
    s_lshl_b32 s39, s56, 10
    s_add_u32 m0, s37, s39
    s_and_b32 s56, s56, 7
    s_lshr_b32 s39, s93, s56
    s_and_b32 s39, s39, 0x2000
    s_mul_i32 s56, s56, 8389632
    s_add_u32 s57, s57, s47
    s_xor_b32 s56, s56, s39
    s_xor_b32 s56, s56, s57
    buffer_load_dwordx4 v28, s[24:27], s56 offen sc1 lds
    s_cmp_lg_u32 s69, 0
    s_cbranch_scc1 ev_iss
ev_issued:
    s_mov_b32 s9, 0
    s_cmp_eq_u32 s68, 0xffffff
    s_cbranch_scc1 ev_nopoll
    s_xor_b32 exec_lo, s68, 0xffffff
    s_mov_b32 exec_hi, 0
    buffer_load_dword v23, v3, s[24:27], s6 offen sc1
    s_mov_b64 exec, -1
ev_nopoll:
    s_cmp_eq_u32 s45, 0
    s_cbranch_scc1 ev_sel
    s_mov_b32 s45, 0
    s_waitcnt lgkmcnt(0)
    s_barrier
    s_cmp_lg_u64 s[88:89], 0
    s_cbranch_scc1 routed
routed_ret:
ev_sel:
    s_bfe_u32 s56, s55, 524288
    s_cmp_eq_u32 s56, 0xff
    s_cbranch_scc0 ev_r0
    s_or_b32 s60, s60, 255
    s_andn2_b32 s55, s55, 255
    s_mov_b32 s38, s41
    ds_read_b128 v[132:135], v4 offset:0
    ds_read_b128 v[140:143], v4 offset:1024
    ds_read_b128 v[148:151], v4 offset:2048
    ds_read_b128 v[156:159], v4 offset:3072
    ds_read_b128 v[164:167], v4 offset:4096
    ds_read_b128 v[172:175], v4 offset:5120
    ds_read_b128 v[180:183], v4 offset:6144
    ds_read_b128 v[188:191], v4 offset:7168
    v_lshlrev_b32 v84, 16, v168
    v_and_b32 v85, 0xffff0000, v168
    v_lshlrev_b32 v100, 16, v144
    v_and_b32 v101, 0xffff0000, v144
    v_lshlrev_b32 v86, 16, v169
    v_and_b32 v87, 0xffff0000, v169
    v_lshlrev_b32 v102, 16, v145
    v_and_b32 v103, 0xffff0000, v145
    v_lshlrev_b32 v92, 16, v170
    v_and_b32 v93, 0xffff0000, v170
    v_lshlrev_b32 v108, 16, v146
    v_and_b32 v109, 0xffff0000, v146
    v_lshlrev_b32 v94, 16, v171
    v_and_b32 v95, 0xffff0000, v171
    v_lshlrev_b32 v110, 16, v147
    v_and_b32 v111, 0xffff0000, v147
    s_branch ev_go
ev_r0:
    s_bfe_u32 s56, s55, 524296
    s_cmp_eq_u32 s56, 0xff
    s_cbranch_scc0 ev_r1
    s_or_b32 s60, s60, 65280
    s_andn2_b32 s55, s55, 65280
    s_mov_b32 s38, s42
    ds_read_b128 v[132:135], v4 offset:8192
    ds_read_b128 v[140:143], v4 offset:9216
    ds_read_b128 v[148:151], v4 offset:10240
    ds_read_b128 v[156:159], v4 offset:11264
    ds_read_b128 v[164:167], v4 offset:12288
    ds_read_b128 v[172:175], v4 offset:13312
    ds_read_b128 v[180:183], v4 offset:14336
    ds_read_b128 v[188:191], v4 offset:15360
    v_lshlrev_b32 v84, 16, v176
    v_and_b32 v85, 0xffff0000, v176
    v_lshlrev_b32 v100, 16, v152
    v_and_b32 v101, 0xffff0000, v152
    v_lshlrev_b32 v86, 16, v177
    v_and_b32 v87, 0xffff0000, v177
    v_lshlrev_b32 v102, 16, v153
    v_and_b32 v103, 0xffff0000, v153
    v_lshlrev_b32 v92, 16, v178
    v_and_b32 v93, 0xffff0000, v178
    v_lshlrev_b32 v108, 16, v154
    v_and_b32 v109, 0xffff0000, v154
    v_lshlrev_b32 v94, 16, v179
    v_and_b32 v95, 0xffff0000, v179
    v_lshlrev_b32 v110, 16, v155
    v_and_b32 v111, 0xffff0000, v155
    s_branch ev_go
ev_r1:
    s_bfe_u32 s56, s55, 524304
    s_cmp_eq_u32 s56, 0xff
    s_cbranch_scc0 ev_r2
    s_or_b32 s60, s60, 16711680
    s_andn2_b32 s55, s55, 16711680
    s_mov_b32 s38, s43
    ds_read_b128 v[132:135], v4 offset:16384
    ds_read_b128 v[140:143], v4 offset:17408
    ds_read_b128 v[148:151], v4 offset:18432
    ds_read_b128 v[156:159], v4 offset:19456
    ds_read_b128 v[164:167], v4 offset:20480
    ds_read_b128 v[172:175], v4 offset:21504
    ds_read_b128 v[180:183], v4 offset:22528
    ds_read_b128 v[188:191], v4 offset:23552
    v_lshlrev_b32 v84, 16, v184
    v_and_b32 v85, 0xffff0000, v184
    v_lshlrev_b32 v100, 16, v160
    v_and_b32 v101, 0xffff0000, v160
    v_lshlrev_b32 v86, 16, v185
    v_and_b32 v87, 0xffff0000, v185
    v_lshlrev_b32 v102, 16, v161
    v_and_b32 v103, 0xffff0000, v161
    v_lshlrev_b32 v92, 16, v186
    v_and_b32 v93, 0xffff0000, v186
    v_lshlrev_b32 v108, 16, v162
    v_and_b32 v109, 0xffff0000, v162
    v_lshlrev_b32 v94, 16, v187
    v_and_b32 v95, 0xffff0000, v187
    v_lshlrev_b32 v110, 16, v163
    v_and_b32 v111, 0xffff0000, v163
    s_branch ev_go
ev_r2:
    s_cmp_eq_u32 s60, 0xffffff
    s_cbranch_scc1 ev_done
    s_add_u32 s101, s101, 1
    s_cmp_gt_u32 s101, 0x2000000
    s_cbranch_scc0 ev_loop
    s_branch ev_done
ev_go:
    s_waitcnt lgkmcnt(7)
    v_mfma_f32_16x16x32_bf16 v[68:71], v[208:211], v[132:135], 0
    v_mfma_f32_16x16x32_bf16 v[76:79], v[216:219], v[132:135], 0
    s_waitcnt lgkmcnt(6)
    v_mfma_f32_16x16x32_bf16 v[68:71], v[208:211], v[140:143], v[68:71]
    v_mfma_f32_16x16x32_bf16 v[76:79], v[216:219], v[140:143], v[76:79]
    s_waitcnt lgkmcnt(5)
    v_mfma_f32_16x16x32_bf16 v[68:71], v[208:211], v[148:151], v[68:71]
    v_mfma_f32_16x16x32_bf16 v[76:79], v[216:219], v[148:151], v[76:79]
    s_waitcnt lgkmcnt(4)
    v_mfma_f32_16x16x32_bf16 v[68:71], v[208:211], v[156:159], v[68:71]
    v_mfma_f32_16x16x32_bf16 v[76:79], v[216:219], v[156:159], v[76:79]
    s_waitcnt lgkmcnt(3)
    v_mfma_f32_16x16x32_bf16 v[68:71], v[208:211], v[164:167], v[68:71]
    v_mfma_f32_16x16x32_bf16 v[76:79], v[216:219], v[164:167], v[76:79]
    s_waitcnt lgkmcnt(2)
    v_mfma_f32_16x16x32_bf16 v[68:71], v[208:211], v[172:175], v[68:71]
    v_mfma_f32_16x16x32_bf16 v[76:79], v[216:219], v[172:175], v[76:79]
    s_waitcnt lgkmcnt(1)
    v_mfma_f32_16x16x32_bf16 v[68:71], v[208:211], v[180:183], v[68:71]
    v_mfma_f32_16x16x32_bf16 v[76:79], v[216:219], v[180:183], v[76:79]
    s_waitcnt lgkmcnt(0)
    v_mfma_f32_16x16x32_bf16 v[68:71], v[208:211], v[188:191], v[68:71]
    v_mfma_f32_16x16x32_bf16 v[76:79], v[216:219], v[188:191], v[76:79]
    s_nop 6
    v_cvt_pk_bf16_f32 v116, v68, v69
    v_cvt_pk_bf16_f32 v117, v70, v71
    v_cvt_pk_bf16_f32 v118, v76, v77
    v_cvt_pk_bf16_f32 v119, v78, v79
    v_lshlrev_b32 v68, 16, v116
    v_and_b32 v69, 0xffff0000, v116
    v_lshlrev_b32 v70, 16, v117
    v_and_b32 v71, 0xffff0000, v117
    v_lshlrev_b32 v76, 16, v118
    v_and_b32 v77, 0xffff0000, v118
    v_lshlrev_b32 v78, 16, v119
    v_and_b32 v79, 0xffff0000, v119
    v_pk_mul_f32 v[68:69], v[68:69], v[84:85]
    v_pk_mul_f32 v[70:71], v[70:71], v[86:87]
    v_pk_mul_f32 v[76:77], v[76:77], v[92:93]
    v_pk_mul_f32 v[78:79], v[78:79], v[94:95]
    v_cvt_pk_bf16_f32 v116, v68, v69
    v_cvt_pk_bf16_f32 v117, v70, v71
    v_cvt_pk_bf16_f32 v118, v76, v77
    v_cvt_pk_bf16_f32 v119, v78, v79
    v_lshlrev_b32 v68, 16, v116
    v_and_b32 v69, 0xffff0000, v116
    v_lshlrev_b32 v70, 16, v117
    v_and_b32 v71, 0xffff0000, v117
    v_lshlrev_b32 v76, 16, v118
    v_and_b32 v77, 0xffff0000, v118
    v_lshlrev_b32 v78, 16, v119
    v_and_b32 v79, 0xffff0000, v119
    v_pk_add_f32 v[68:69], v[68:69], v[100:101]
    v_pk_add_f32 v[70:71], v[70:71], v[102:103]
    v_pk_add_f32 v[76:77], v[76:77], v[108:109]
    v_pk_add_f32 v[78:79], v[78:79], v[110:111]
    v_cvt_pk_bf16_f32 v124, v68, v69
    v_cvt_pk_bf16_f32 v125, v70, v71
    v_cvt_pk_bf16_f32 v126, v76, v77
    v_cvt_pk_bf16_f32 v127, v78, v79
    buffer_store_dwordx4 v[124:127], v22, s[32:35], s38 offen sc1
    s_add_u32 s9, s9, 1
    s_cmp_lg_u32 s60, 0xffffff
    s_cbranch_scc1 ev_sel
ev_done:
    s_or_b32 s56, s2, s3
    s_cmp_eq_u32 s56, 0
    s_cselect_b32 s56, 0, 0x7ffffff0
    s_add_u32 s56, s56, 3203072
    buffer_store_dword v16, v17, s[24:27], s56 offen
main_fin:
main_end:
    s_endpgm
spin_o0:
    s_load_dwordx4 s[72:75], s[86:87], s5 glc
    s_add_u32 s101, s101, 1
    s_cmp_gt_u32 s101, 0x2000000
    s_waitcnt lgkmcnt(0)
    s_cbranch_scc1 spin_o0_ret
    s_sub_u32 s88, s72, s11
    s_sub_u32 s89, s73, s11
    s_max_u32 s88, s88, s89
    s_sub_u32 s89, s74, s11
    s_max_u32 s88, s88, s89
    s_sub_u32 s89, s75, s11
    s_max_u32 s88, s88, s89
    s_cmp_gt_u32 s88, 5
    s_cbranch_scc1 spin_o0
    s_branch spin_o0_ret
spin_o1:
    s_load_dwordx4 s[72:75], s[86:87], s5 glc
    s_add_u32 s101, s101, 1
    s_cmp_gt_u32 s101, 0x2000000
    s_waitcnt lgkmcnt(0)
    s_cbranch_scc1 spin_o1_ret
    s_sub_u32 s88, s72, s11
    s_sub_u32 s89, s73, s11
    s_max_u32 s88, s88, s89
    s_sub_u32 s89, s74, s11
    s_max_u32 s88, s88, s89
    s_sub_u32 s89, s75, s11
    s_max_u32 s88, s88, s89
    s_cmp_gt_u32 s88, 4
    s_cbranch_scc1 spin_o1
    s_branch spin_o1_ret
spin_o2:
    s_load_dwordx4 s[72:75], s[86:87], s5 glc
    s_add_u32 s101, s101, 1
    s_cmp_gt_u32 s101, 0x2000000
    s_waitcnt lgkmcnt(0)
    s_cbranch_scc1 spin_o2_ret
    s_sub_u32 s88, s72, s11
    s_sub_u32 s89, s73, s11
    s_max_u32 s88, s88, s89
    s_sub_u32 s89, s74, s11
    s_max_u32 s88, s88, s89
    s_sub_u32 s89, s75, s11
    s_max_u32 s88, s88, s89
    s_cmp_gt_u32 s88, 3
    s_cbranch_scc1 spin_o2
    s_branch spin_o2_ret
spin_o3:
    s_load_dwordx4 s[72:75], s[86:87], s5 glc
    s_add_u32 s101, s101, 1
    s_cmp_gt_u32 s101, 0x2000000
    s_waitcnt lgkmcnt(0)
    s_cbranch_scc1 spin_o3_ret
    s_sub_u32 s88, s72, s11
    s_sub_u32 s89, s73, s11
    s_max_u32 s88, s88, s89
    s_sub_u32 s89, s74, s11
    s_max_u32 s88, s88, s89
    s_sub_u32 s89, s75, s11
    s_max_u32 s88, s88, s89
    s_cmp_gt_u32 s88, 2
    s_cbranch_scc1 spin_o3
    s_branch spin_o3_ret
spin_o4:
    s_load_dwordx4 s[72:75], s[86:87], s5 glc
    s_add_u32 s101, s101, 1
    s_cmp_gt_u32 s101, 0x2000000
    s_waitcnt lgkmcnt(0)
    s_cbranch_scc1 spin_o4_ret
    s_sub_u32 s88, s72, s11
    s_sub_u32 s89, s73, s11
    s_max_u32 s88, s88, s89
    s_sub_u32 s89, s74, s11
    s_max_u32 s88, s88, s89
    s_sub_u32 s89, s75, s11
    s_max_u32 s88, s88, s89
    s_cmp_gt_u32 s88, 1
    s_cbranch_scc1 spin_o4
    s_branch spin_o4_ret
spin_o5:
    s_load_dwordx4 s[72:75], s[86:87], s5 glc
    s_add_u32 s101, s101, 1
    s_cmp_gt_u32 s101, 0x2000000
    s_waitcnt lgkmcnt(0)
    s_cbranch_scc1 spin_o5_ret
    s_sub_u32 s88, s72, s11
    s_sub_u32 s89, s73, s11
    s_max_u32 s88, s88, s89
    s_sub_u32 s89, s74, s11
    s_max_u32 s88, s88, s89
    s_sub_u32 s89, s75, s11
    s_max_u32 s88, s88, s89
    s_cmp_gt_u32 s88, 0
    s_cbranch_scc1 spin_o5
    s_branch spin_o5_ret
routed:
    s_cmp_eq_u32 s44, s59
    s_cbranch_scc0 spin_y
spin_y_ret:
    v_cvt_pk_bf16_f32 v200, v240, v241
    v_cvt_pk_bf16_f32 v201, v242, v243
    v_lshlrev_b32 v240, 16, v200
    v_and_b32 v241, 0xffff0000, v200
    v_lshlrev_b32 v242, 16, v201
    v_and_b32 v243, 0xffff0000, v201
    v_mul_f32 v240, v240, v195
    v_mul_f32 v241, v241, v195
    v_mul_f32 v242, v242, v195
    v_mul_f32 v243, v243, v195
    v_cvt_pk_bf16_f32 v200, v240, v241
    v_cvt_pk_bf16_f32 v201, v242, v243
    v_lshlrev_b32 v240, 16, v200
    v_and_b32 v241, 0xffff0000, v200
    v_lshlrev_b32 v242, 16, v201
    v_and_b32 v243, 0xffff0000, v201
    v_add_f32 v240, v240, v248
    v_add_f32 v241, v241, v249
    v_add_f32 v242, v242, v250
    v_add_f32 v243, v243, v251
    v_cvt_pk_bf16_f32 v200, v240, v241
    v_cvt_pk_bf16_f32 v201, v242, v243
    v_lshlrev_b32 v240, 16, v200
    v_and_b32 v241, 0xffff0000, v200
    v_lshlrev_b32 v242, 16, v201
    v_and_b32 v243, 0xffff0000, v201
    v_mul_f32 v200, s92, v240
    v_mul_f32 v201, s92, v241
    v_mul_f32 v202, s92, v242
    v_mul_f32 v203, s92, v243
    v_exp_f32 v200, v200
    v_exp_f32 v201, v201
    v_exp_f32 v202, v202
    v_exp_f32 v203, v203
    v_add_f32 v200, 1.0, v200
    v_add_f32 v201, 1.0, v201
    v_add_f32 v202, 1.0, v202
    v_add_f32 v203, 1.0, v203
    v_rcp_f32 v200, v200
    v_rcp_f32 v201, v201
    v_rcp_f32 v202, v202
    v_rcp_f32 v203, v203
    v_mul_f32 v240, v240, v200
    v_mul_f32 v241, v241, v201
    v_mul_f32 v242, v242, v202
    v_mul_f32 v243, v243, v203
    v_cvt_pk_bf16_f32 v240, v240, v241
    v_cvt_pk_bf16_f32 v241, v242, v243
    ds_write_b64 v138, v[240:241]
    s_mov_b64 exec, s[88:89]
    ds_read_b128 v[168:171], v139 offset:0
    ds_read_b128 v[176:179], v139 offset:64
    ds_read_b128 v[184:187], v139 offset:128
    s_waitcnt lgkmcnt(0)
    s_mov_b64 exec, -1
    s_branch routed_ret
spin_y:
    s_add_u32 s101, s101, 1
    s_cmp_gt_u32 s101, 0x2000000
    s_cbranch_scc1 spin_y_x
    buffer_load_dword v137, v136, s[24:27], s59 offen offset:128 sc1
    s_waitcnt vmcnt(0)
    v_cmp_ne_u32 vcc, 24, v137
    s_cbranch_vccnz spin_y
spin_y_x:
    buffer_load_dwordx4 v[240:243], v192, s[24:27], s59 offen sc1
    s_waitcnt vmcnt(0)
    s_branch spin_y_ret
spin_rec:
    s_add_u32 s101, s101, 1
    s_cmp_gt_u32 s101, 0x2000000
    s_cbranch_scc1 spin_rec_x
    buffer_load_dwordx4 v[32:35], v17, s[24:27], s47 offen offset:0 sc1
    buffer_load_dwordx4 v[36:39], v17, s[24:27], s47 offen offset:1024 sc1
    buffer_load_dwordx4 v[40:43], v17, s[24:27], s47 offen offset:2048 sc1
    buffer_load_dwordx4 v[44:47], v17, s[24:27], s47 offen offset:3072 sc1
    s_waitcnt vmcnt(0)
    v_xor_b32 v34, s7, v34
    v_xor_b32 v38, s7, v38
    v_xor_b32 v42, s7, v42
    v_xor_b32 v46, s7, v46
    v_or3_b32 v34, v34, v38, v42
    v_or_b32 v34, v34, v46
    v_cmp_ne_u32 vcc, 0, v34
    s_cbranch_vccnz spin_rec
spin_rec_x:
    s_branch spin_rec_ret
spin_gu:
    s_add_u32 s101, s101, 1
    s_cmp_gt_u32 s101, 0x2000000
    s_cbranch_scc1 spin_gu_x
    buffer_load_dword v61, v60, s[24:27], s37 offen sc1
    s_waitcnt vmcnt(0)
    v_cmp_ne_u32 vcc, s7, v61
    s_cbranch_vccnz spin_gu
spin_gu_x:
    s_branch spin_gu_ret
rare_p:
    s_nop 7
    s_nop 7
    v_max3_f32 v56, v68, v69, v70
    v_max3_f32 v56, v56, v71, v100
    v_max3_f32 v56, v56, v101, v102
    v_max3_f32 v56, v56, v103, 0
    v_mov_b32 v58, v56
    s_nop 1
    v_permlane16_swap_b32 v56, v58
    s_nop 1
    v_max_f32 v56, v56, v58
    v_mov_b32 v58, v56
    s_nop 1
    v_permlane32_swap_b32 v56, v58
    s_nop 1
    v_max_f32 v56, v56, v58
    v_exp_f32 v57, -v56
    v_sub_f32 v32, v32, v56
    v_sub_f32 v33, v33, v56
    v_sub_f32 v34, v34, v56
    v_sub_f32 v35, v35, v56
    v_mul_f32 v20, v20, v57
    v_sub_f32 v68, v68, v56
    v_sub_f32 v69, v69, v56
    v_sub_f32 v70, v70, v56
    v_sub_f32 v71, v71, v56
    v_sub_f32 v100, v100, v56
    v_sub_f32 v101, v101, v56
    v_sub_f32 v102, v102, v56
    v_sub_f32 v103, v103, v56
    v_sub_f32 v132, v132, v56
    v_sub_f32 v133, v133, v56
    v_sub_f32 v134, v134, v56
    v_sub_f32 v135, v135, v56
    v_sub_f32 v164, v164, v56
    v_sub_f32 v165, v165, v56
    v_sub_f32 v166, v166, v56
    v_sub_f32 v167, v167, v56
    v_accvgpr_read_b32 v48, a0
    v_accvgpr_read_b32 v49, a1
    v_accvgpr_read_b32 v50, a2
    v_accvgpr_read_b32 v51, a3
    v_mul_f32 v48, v48, v57
    v_mul_f32 v49, v49, v57
    v_mul_f32 v50, v50, v57
    v_mul_f32 v51, v51, v57
    v_accvgpr_write_b32 a0, v48
    v_accvgpr_write_b32 a1, v49
    v_accvgpr_write_b32 a2, v50
    v_accvgpr_write_b32 a3, v51
    v_accvgpr_read_b32 v48, a16
    v_accvgpr_read_b32 v49, a17
    v_accvgpr_read_b32 v50, a18
    v_accvgpr_read_b32 v51, a19
    v_mul_f32 v48, v48, v57
    v_mul_f32 v49, v49, v57
    v_mul_f32 v50, v50, v57
    v_mul_f32 v51, v51, v57
    v_accvgpr_write_b32 a16, v48
    v_accvgpr_write_b32 a17, v49
    v_accvgpr_write_b32 a18, v50
    v_accvgpr_write_b32 a19, v51
    v_accvgpr_read_b32 v48, a32
    v_accvgpr_read_b32 v49, a33
    v_accvgpr_read_b32 v50, a34
    v_accvgpr_read_b32 v51, a35
    v_mul_f32 v48, v48, v57
    v_mul_f32 v49, v49, v57
    v_mul_f32 v50, v50, v57
    v_mul_f32 v51, v51, v57
    v_accvgpr_write_b32 a32, v48
    v_accvgpr_write_b32 a33, v49
    v_accvgpr_write_b32 a34, v50
    v_accvgpr_write_b32 a35, v51
    v_accvgpr_read_b32 v48, a48
    v_accvgpr_read_b32 v49, a49
    v_accvgpr_read_b32 v50, a50
    v_accvgpr_read_b32 v51, a51
    v_mul_f32 v48, v48, v57
    v_mul_f32 v49, v49, v57
    v_mul_f32 v50, v50, v57
    v_mul_f32 v51, v51, v57
    v_accvgpr_write_b32 a48, v48
    v_accvgpr_write_b32 a49, v49
    v_accvgpr_write_b32 a50, v50
    v_accvgpr_write_b32 a51, v51
    v_accvgpr_read_b32 v48, a64
    v_accvgpr_read_b32 v49, a65
    v_accvgpr_read_b32 v50, a66
    v_accvgpr_read_b32 v51, a67
    v_mul_f32 v48, v48, v57
    v_mul_f32 v49, v49, v57
    v_mul_f32 v50, v50, v57
    v_mul_f32 v51, v51, v57
    v_accvgpr_write_b32 a64, v48
    v_accvgpr_write_b32 a65, v49
    v_accvgpr_write_b32 a66, v50
    v_accvgpr_write_b32 a67, v51
    v_accvgpr_read_b32 v48, a80
    v_accvgpr_read_b32 v49, a81
    v_accvgpr_read_b32 v50, a82
    v_accvgpr_read_b32 v51, a83
    v_mul_f32 v48, v48, v57
    v_mul_f32 v49, v49, v57
    v_mul_f32 v50, v50, v57
    v_mul_f32 v51, v51, v57
    v_accvgpr_write_b32 a80, v48
    v_accvgpr_write_b32 a81, v49
    v_accvgpr_write_b32 a82, v50
    v_accvgpr_write_b32 a83, v51
    v_accvgpr_read_b32 v48, a96
    v_accvgpr_read_b32 v49, a97
    v_accvgpr_read_b32 v50, a98
    v_accvgpr_read_b32 v51, a99
    v_mul_f32 v48, v48, v57
    v_mul_f32 v49, v49, v57
    v_mul_f32 v50, v50, v57
    v_mul_f32 v51, v51, v57
    v_accvgpr_write_b32 a96, v48
    v_accvgpr_write_b32 a97, v49
    v_accvgpr_write_b32 a98, v50
    v_accvgpr_write_b32 a99, v51
    v_accvgpr_read_b32 v48, a112
    v_accvgpr_read_b32 v49, a113
    v_accvgpr_read_b32 v50, a114
    v_accvgpr_read_b32 v51, a115
    v_mul_f32 v48, v48, v57
    v_mul_f32 v49, v49, v57
    v_mul_f32 v50, v50, v57
    v_mul_f32 v51, v51, v57
    v_accvgpr_write_b32 a112, v48
    v_accvgpr_write_b32 a113, v49
    v_accvgpr_write_b32 a114, v50
    v_accvgpr_write_b32 a115, v51
    v_accvgpr_read_b32 v48, a128
    v_accvgpr_read_b32 v49, a129
    v_accvgpr_read_b32 v50, a130
    v_accvgpr_read_b32 v51, a131
    v_mul_f32 v48, v48, v57
    v_mul_f32 v49, v49, v57
    v_mul_f32 v50, v50, v57
    v_mul_f32 v51, v51, v57
    v_accvgpr_write_b32 a128, v48
    v_accvgpr_write_b32 a129, v49
    v_accvgpr_write_b32 a130, v50
    v_accvgpr_write_b32 a131, v51
    v_accvgpr_read_b32 v48, a144
    v_accvgpr_read_b32 v49, a145
    v_accvgpr_read_b32 v50, a146
    v_accvgpr_read_b32 v51, a147
    v_mul_f32 v48, v48, v57
    v_mul_f32 v49, v49, v57
    v_mul_f32 v50, v50, v57
    v_mul_f32 v51, v51, v57
    v_accvgpr_write_b32 a144, v48
    v_accvgpr_write_b32 a145, v49
    v_accvgpr_write_b32 a146, v50
    v_accvgpr_write_b32 a147, v51
    v_accvgpr_read_b32 v48, a160
    v_accvgpr_read_b32 v49, a161
    v_accvgpr_read_b32 v50, a162
    v_accvgpr_read_b32 v51, a163
    v_mul_f32 v48, v48, v57
    v_mul_f32 v49, v49, v57
    v_mul_f32 v50, v50, v57
    v_mul_f32 v51, v51, v57
    v_accvgpr_write_b32 a160, v48
    v_accvgpr_write_b32 a161, v49
    v_accvgpr_write_b32 a162, v50
    v_accvgpr_write_b32 a163, v51
    v_accvgpr_read_b32 v48, a176
    v_accvgpr_read_b32 v49, a177
    v_accvgpr_read_b32 v50, a178
    v_accvgpr_read_b32 v51, a179
    v_mul_f32 v48, v48, v57
    v_mul_f32 v49, v49, v57
    v_mul_f32 v50, v50, v57
    v_mul_f32 v51, v51, v57
    v_accvgpr_write_b32 a176, v48
    v_accvgpr_write_b32 a177, v49
    v_accvgpr_write_b32 a178, v50
    v_accvgpr_write_b32 a179, v51
    v_exp_f32 v48, v68
    v_exp_f32 v49, v69
    v_exp_f32 v50, v70
    v_exp_f32 v51, v71
    v_exp_f32 v52, v100
    v_exp_f32 v53, v101
    v_exp_f32 v54, v102
    v_exp_f32 v55, v103
    s_nop 0
    v_cvt_pk_bf16_f32 v196, v48, v49
    v_cvt_pk_bf16_f32 v197, v50, v51
    v_cvt_pk_bf16_f32 v198, v52, v53
    v_cvt_pk_bf16_f32 v199, v54, v55
    v_add_f32 v24, v48, v49
    v_add_f32 v24, v24, v50
    v_add_f32 v24, v24, v51
    v_add_f32 v24, v24, v52
    v_add_f32 v24, v24, v53
    v_add_f32 v24, v24, v54
    v_add_f32 v24, v24, v55
    v_max3_f32 v56, v76, v77, v78
    v_max3_f32 v56, v56, v79, v108
    v_max3_f32 v56, v56, v109, v110
    v_max3_f32 v56, v56, v111, 0
    v_mov_b32 v58, v56
    s_nop 1
    v_permlane16_swap_b32 v56, v58
    s_nop 1
    v_max_f32 v56, v56, v58
    v_mov_b32 v58, v56
    s_nop 1
    v_permlane32_swap_b32 v56, v58
    s_nop 1
    v_max_f32 v56, v56, v58
    v_exp_f32 v57, -v56
    v_sub_f32 v36, v36, v56
    v_sub_f32 v37, v37, v56
    v_sub_f32 v38, v38, v56
    v_sub_f32 v39, v39, v56
    v_mul_f32 v21, v21, v57
    v_sub_f32 v76, v76, v56
    v_sub_f32 v77, v77, v56
    v_sub_f32 v78, v78, v56
    v_sub_f32 v79, v79, v56
    v_sub_f32 v108, v108, v56
    v_sub_f32 v109, v109, v56
    v_sub_f32 v110, v110, v56
    v_sub_f32 v111, v111, v56
    v_sub_f32 v140, v140, v56
    v_sub_f32 v141, v141, v56
    v_sub_f32 v142, v142, v56
    v_sub_f32 v143, v143, v56
    v_sub_f32 v172, v172, v56
    v_sub_f32 v173, v173, v56
    v_sub_f32 v174, v174, v56
    v_sub_f32 v175, v175, v56
    v_accvgpr_read_b32 v48, a4
    v_accvgpr_read_b32 v49, a5
    v_accvgpr_read_b32 v50, a6
    v_accvgpr_read_b32 v51, a7
    v_mul_f32 v48, v48, v57
    v_mul_f32 v49, v49, v57
    v_mul_f32 v50, v50, v57
    v_mul_f32 v51, v51, v57
    v_accvgpr_write_b32 a4, v48
    v_accvgpr_write_b32 a5, v49
    v_accvgpr_write_b32 a6, v50
    v_accvgpr_write_b32 a7, v51
    v_accvgpr_read_b32 v48, a20
    v_accvgpr_read_b32 v49, a21
    v_accvgpr_read_b32 v50, a22
    v_accvgpr_read_b32 v51, a23
    v_mul_f32 v48, v48, v57
    v_mul_f32 v49, v49, v57
    v_mul_f32 v50, v50, v57
    v_mul_f32 v51, v51, v57
    v_accvgpr_write_b32 a20, v48
    v_accvgpr_write_b32 a21, v49
    v_accvgpr_write_b32 a22, v50
    v_accvgpr_write_b32 a23, v51
    v_accvgpr_read_b32 v48, a36
    v_accvgpr_read_b32 v49, a37
    v_accvgpr_read_b32 v50, a38
    v_accvgpr_read_b32 v51, a39
    v_mul_f32 v48, v48, v57
    v_mul_f32 v49, v49, v57
    v_mul_f32 v50, v50, v57
    v_mul_f32 v51, v51, v57
    v_accvgpr_write_b32 a36, v48
    v_accvgpr_write_b32 a37, v49
    v_accvgpr_write_b32 a38, v50
    v_accvgpr_write_b32 a39, v51
    v_accvgpr_read_b32 v48, a52
    v_accvgpr_read_b32 v49, a53
    v_accvgpr_read_b32 v50, a54
    v_accvgpr_read_b32 v51, a55
    v_mul_f32 v48, v48, v57
    v_mul_f32 v49, v49, v57
    v_mul_f32 v50, v50, v57
    v_mul_f32 v51, v51, v57
    v_accvgpr_write_b32 a52, v48
    v_accvgpr_write_b32 a53, v49
    v_accvgpr_write_b32 a54, v50
    v_accvgpr_write_b32 a55, v51
    v_accvgpr_read_b32 v48, a68
    v_accvgpr_read_b32 v49, a69
    v_accvgpr_read_b32 v50, a70
    v_accvgpr_read_b32 v51, a71
    v_mul_f32 v48, v48, v57
    v_mul_f32 v49, v49, v57
    v_mul_f32 v50, v50, v57
    v_mul_f32 v51, v51, v57
    v_accvgpr_write_b32 a68, v48
    v_accvgpr_write_b32 a69, v49
    v_accvgpr_write_b32 a70, v50
    v_accvgpr_write_b32 a71, v51
    v_accvgpr_read_b32 v48, a84
    v_accvgpr_read_b32 v49, a85
    v_accvgpr_read_b32 v50, a86
    v_accvgpr_read_b32 v51, a87
    v_mul_f32 v48, v48, v57
    v_mul_f32 v49, v49, v57
    v_mul_f32 v50, v50, v57
    v_mul_f32 v51, v51, v57
    v_accvgpr_write_b32 a84, v48
    v_accvgpr_write_b32 a85, v49
    v_accvgpr_write_b32 a86, v50
    v_accvgpr_write_b32 a87, v51
    v_accvgpr_read_b32 v48, a100
    v_accvgpr_read_b32 v49, a101
    v_accvgpr_read_b32 v50, a102
    v_accvgpr_read_b32 v51, a103
    v_mul_f32 v48, v48, v57
    v_mul_f32 v49, v49, v57
    v_mul_f32 v50, v50, v57
    v_mul_f32 v51, v51, v57
    v_accvgpr_write_b32 a100, v48
    v_accvgpr_write_b32 a101, v49
    v_accvgpr_write_b32 a102, v50
    v_accvgpr_write_b32 a103, v51
    v_accvgpr_read_b32 v48, a116
    v_accvgpr_read_b32 v49, a117
    v_accvgpr_read_b32 v50, a118
    v_accvgpr_read_b32 v51, a119
    v_mul_f32 v48, v48, v57
    v_mul_f32 v49, v49, v57
    v_mul_f32 v50, v50, v57
    v_mul_f32 v51, v51, v57
    v_accvgpr_write_b32 a116, v48
    v_accvgpr_write_b32 a117, v49
    v_accvgpr_write_b32 a118, v50
    v_accvgpr_write_b32 a119, v51
    v_accvgpr_read_b32 v48, a132
    v_accvgpr_read_b32 v49, a133
    v_accvgpr_read_b32 v50, a134
    v_accvgpr_read_b32 v51, a135
    v_mul_f32 v48, v48, v57
    v_mul_f32 v49, v49, v57
    v_mul_f32 v50, v50, v57
    v_mul_f32 v51, v51, v57
    v_accvgpr_write_b32 a132, v48
    v_accvgpr_write_b32 a133, v49
    v_accvgpr_write_b32 a134, v50
    v_accvgpr_write_b32 a135, v51
    v_accvgpr_read_b32 v48, a148
    v_accvgpr_read_b32 v49, a149
    v_accvgpr_read_b32 v50, a150
    v_accvgpr_read_b32 v51, a151
    v_mul_f32 v48, v48, v57
    v_mul_f32 v49, v49, v57
    v_mul_f32 v50, v50, v57
    v_mul_f32 v51, v51, v57
    v_accvgpr_write_b32 a148, v48
    v_accvgpr_write_b32 a149, v49
    v_accvgpr_write_b32 a150, v50
    v_accvgpr_write_b32 a151, v51
    v_accvgpr_read_b32 v48, a164
    v_accvgpr_read_b32 v49, a165
    v_accvgpr_read_b32 v50, a166
    v_accvgpr_read_b32 v51, a167
    v_mul_f32 v48, v48, v57
    v_mul_f32 v49, v49, v57
    v_mul_f32 v50, v50, v57
    v_mul_f32 v51, v51, v57
    v_accvgpr_write_b32 a164, v48
    v_accvgpr_write_b32 a165, v49
    v_accvgpr_write_b32 a166, v50
    v_accvgpr_write_b32 a167, v51
    v_accvgpr_read_b32 v48, a180
    v_accvgpr_read_b32 v49, a181
    v_accvgpr_read_b32 v50, a182
    v_accvgpr_read_b32 v51, a183
    v_mul_f32 v48, v48, v57
    v_mul_f32 v49, v49, v57
    v_mul_f32 v50, v50, v57
    v_mul_f32 v51, v51, v57
    v_accvgpr_write_b32 a180, v48
    v_accvgpr_write_b32 a181, v49
    v_accvgpr_write_b32 a182, v50
    v_accvgpr_write_b32 a183, v51
    v_exp_f32 v48, v76
    v_exp_f32 v49, v77
    v_exp_f32 v50, v78
    v_exp_f32 v51, v79
    v_exp_f32 v52, v108
    v_exp_f32 v53, v109
    v_exp_f32 v54, v110
    v_exp_f32 v55, v111
    s_nop 0
    v_cvt_pk_bf16_f32 v204, v48, v49
    v_cvt_pk_bf16_f32 v205, v50, v51
    v_cvt_pk_bf16_f32 v206, v52, v53
    v_cvt_pk_bf16_f32 v207, v54, v55
    v_add_f32 v25, v48, v49
    v_add_f32 v25, v25, v50
    v_add_f32 v25, v25, v51
    v_add_f32 v25, v25, v52
    v_add_f32 v25, v25, v53
    v_add_f32 v25, v25, v54
    v_add_f32 v25, v25, v55
    v_max3_f32 v56, v84, v85, v86
    v_max3_f32 v56, v56, v87, v116
    v_max3_f32 v56, v56, v117, v118
    v_max3_f32 v56, v56, v119, 0
    v_mov_b32 v58, v56
    s_nop 1
    v_permlane16_swap_b32 v56, v58
    s_nop 1
    v_max_f32 v56, v56, v58
    v_mov_b32 v58, v56
    s_nop 1
    v_permlane32_swap_b32 v56, v58
    s_nop 1
    v_max_f32 v56, v56, v58
    v_exp_f32 v57, -v56
    v_sub_f32 v40, v40, v56
    v_sub_f32 v41, v41, v56
    v_sub_f32 v42, v42, v56
    v_sub_f32 v43, v43, v56
    v_mul_f32 v22, v22, v57
    v_sub_f32 v84, v84, v56
    v_sub_f32 v85, v85, v56
    v_sub_f32 v86, v86, v56
    v_sub_f32 v87, v87, v56
    v_sub_f32 v116, v116, v56
    v_sub_f32 v117, v117, v56
    v_sub_f32 v118, v118, v56
    v_sub_f32 v119, v119, v56
    v_sub_f32 v148, v148, v56
    v_sub_f32 v149, v149, v56
    v_sub_f32 v150, v150, v56
    v_sub_f32 v151, v151, v56
    v_sub_f32 v180, v180, v56
    v_sub_f32 v181, v181, v56
    v_sub_f32 v182, v182, v56
    v_sub_f32 v183, v183, v56
    v_accvgpr_read_b32 v48, a8
    v_accvgpr_read_b32 v49, a9
    v_accvgpr_read_b32 v50, a10
    v_accvgpr_read_b32 v51, a11
    v_mul_f32 v48, v48, v57
    v_mul_f32 v49, v49, v57
    v_mul_f32 v50, v50, v57
    v_mul_f32 v51, v51, v57
    v_accvgpr_write_b32 a8, v48
    v_accvgpr_write_b32 a9, v49
    v_accvgpr_write_b32 a10, v50
    v_accvgpr_write_b32 a11, v51
    v_accvgpr_read_b32 v48, a24
    v_accvgpr_read_b32 v49, a25
    v_accvgpr_read_b32 v50, a26
    v_accvgpr_read_b32 v51, a27
    v_mul_f32 v48, v48, v57
    v_mul_f32 v49, v49, v57
    v_mul_f32 v50, v50, v57
    v_mul_f32 v51, v51, v57
    v_accvgpr_write_b32 a24, v48
    v_accvgpr_write_b32 a25, v49
    v_accvgpr_write_b32 a26, v50
    v_accvgpr_write_b32 a27, v51
    v_accvgpr_read_b32 v48, a40
    v_accvgpr_read_b32 v49, a41
    v_accvgpr_read_b32 v50, a42
    v_accvgpr_read_b32 v51, a43
    v_mul_f32 v48, v48, v57
    v_mul_f32 v49, v49, v57
    v_mul_f32 v50, v50, v57
    v_mul_f32 v51, v51, v57
    v_accvgpr_write_b32 a40, v48
    v_accvgpr_write_b32 a41, v49
    v_accvgpr_write_b32 a42, v50
    v_accvgpr_write_b32 a43, v51
    v_accvgpr_read_b32 v48, a56
    v_accvgpr_read_b32 v49, a57
    v_accvgpr_read_b32 v50, a58
    v_accvgpr_read_b32 v51, a59
    v_mul_f32 v48, v48, v57
    v_mul_f32 v49, v49, v57
    v_mul_f32 v50, v50, v57
    v_mul_f32 v51, v51, v57
    v_accvgpr_write_b32 a56, v48
    v_accvgpr_write_b32 a57, v49
    v_accvgpr_write_b32 a58, v50
    v_accvgpr_write_b32 a59, v51
    v_accvgpr_read_b32 v48, a72
    v_accvgpr_read_b32 v49, a73
    v_accvgpr_read_b32 v50, a74
    v_accvgpr_read_b32 v51, a75
    v_mul_f32 v48, v48, v57
    v_mul_f32 v49, v49, v57
    v_mul_f32 v50, v50, v57
    v_mul_f32 v51, v51, v57
    v_accvgpr_write_b32 a72, v48
    v_accvgpr_write_b32 a73, v49
    v_accvgpr_write_b32 a74, v50
    v_accvgpr_write_b32 a75, v51
    v_accvgpr_read_b32 v48, a88
    v_accvgpr_read_b32 v49, a89
    v_accvgpr_read_b32 v50, a90
    v_accvgpr_read_b32 v51, a91
    v_mul_f32 v48, v48, v57
    v_mul_f32 v49, v49, v57
    v_mul_f32 v50, v50, v57
    v_mul_f32 v51, v51, v57
    v_accvgpr_write_b32 a88, v48
    v_accvgpr_write_b32 a89, v49
    v_accvgpr_write_b32 a90, v50
    v_accvgpr_write_b32 a91, v51
    v_accvgpr_read_b32 v48, a104
    v_accvgpr_read_b32 v49, a105
    v_accvgpr_read_b32 v50, a106
    v_accvgpr_read_b32 v51, a107
    v_mul_f32 v48, v48, v57
    v_mul_f32 v49, v49, v57
    v_mul_f32 v50, v50, v57
    v_mul_f32 v51, v51, v57
    v_accvgpr_write_b32 a104, v48
    v_accvgpr_write_b32 a105, v49
    v_accvgpr_write_b32 a106, v50
    v_accvgpr_write_b32 a107, v51
    v_accvgpr_read_b32 v48, a120
    v_accvgpr_read_b32 v49, a121
    v_accvgpr_read_b32 v50, a122
    v_accvgpr_read_b32 v51, a123
    v_mul_f32 v48, v48, v57
    v_mul_f32 v49, v49, v57
    v_mul_f32 v50, v50, v57
    v_mul_f32 v51, v51, v57
    v_accvgpr_write_b32 a120, v48
    v_accvgpr_write_b32 a121, v49
    v_accvgpr_write_b32 a122, v50
    v_accvgpr_write_b32 a123, v51
    v_accvgpr_read_b32 v48, a136
    v_accvgpr_read_b32 v49, a137
    v_accvgpr_read_b32 v50, a138
    v_accvgpr_read_b32 v51, a139
    v_mul_f32 v48, v48, v57
    v_mul_f32 v49, v49, v57
    v_mul_f32 v50, v50, v57
    v_mul_f32 v51, v51, v57
    v_accvgpr_write_b32 a136, v48
    v_accvgpr_write_b32 a137, v49
    v_accvgpr_write_b32 a138, v50
    v_accvgpr_write_b32 a139, v51
    v_accvgpr_read_b32 v48, a152
    v_accvgpr_read_b32 v49, a153
    v_accvgpr_read_b32 v50, a154
    v_accvgpr_read_b32 v51, a155
    v_mul_f32 v48, v48, v57
    v_mul_f32 v49, v49, v57
    v_mul_f32 v50, v50, v57
    v_mul_f32 v51, v51, v57
    v_accvgpr_write_b32 a152, v48
    v_accvgpr_write_b32 a153, v49
    v_accvgpr_write_b32 a154, v50
    v_accvgpr_write_b32 a155, v51
    v_accvgpr_read_b32 v48, a168
    v_accvgpr_read_b32 v49, a169
    v_accvgpr_read_b32 v50, a170
    v_accvgpr_read_b32 v51, a171
    v_mul_f32 v48, v48, v57
    v_mul_f32 v49, v49, v57
    v_mul_f32 v50, v50, v57
    v_mul_f32 v51, v51, v57
    v_accvgpr_write_b32 a168, v48
    v_accvgpr_write_b32 a169, v49
    v_accvgpr_write_b32 a170, v50
    v_accvgpr_write_b32 a171, v51
    v_accvgpr_read_b32 v48, a184
    v_accvgpr_read_b32 v49, a185
    v_accvgpr_read_b32 v50, a186
    v_accvgpr_read_b32 v51, a187
    v_mul_f32 v48, v48, v57
    v_mul_f32 v49, v49, v57
    v_mul_f32 v50, v50, v57
    v_mul_f32 v51, v51, v57
    v_accvgpr_write_b32 a184, v48
    v_accvgpr_write_b32 a185, v49
    v_accvgpr_write_b32 a186, v50
    v_accvgpr_write_b32 a187, v51
    v_exp_f32 v48, v84
    v_exp_f32 v49, v85
    v_exp_f32 v50, v86
    v_exp_f32 v51, v87
    v_exp_f32 v52, v116
    v_exp_f32 v53, v117
    v_exp_f32 v54, v118
    v_exp_f32 v55, v119
    s_nop 0
    v_cvt_pk_bf16_f32 v212, v48, v49
    v_cvt_pk_bf16_f32 v213, v50, v51
    v_cvt_pk_bf16_f32 v214, v52, v53
    v_cvt_pk_bf16_f32 v215, v54, v55
    v_add_f32 v26, v48, v49
    v_add_f32 v26, v26, v50
    v_add_f32 v26, v26, v51
    v_add_f32 v26, v26, v52
    v_add_f32 v26, v26, v53
    v_add_f32 v26, v26, v54
    v_add_f32 v26, v26, v55
    v_max3_f32 v56, v92, v93, v94
    v_max3_f32 v56, v56, v95, v124
    v_max3_f32 v56, v56, v125, v126
    v_max3_f32 v56, v56, v127, 0
    v_mov_b32 v58, v56
    s_nop 1
    v_permlane16_swap_b32 v56, v58
    s_nop 1
    v_max_f32 v56, v56, v58
    v_mov_b32 v58, v56
    s_nop 1
    v_permlane32_swap_b32 v56, v58
    s_nop 1
    v_max_f32 v56, v56, v58
    v_exp_f32 v57, -v56
    v_sub_f32 v44, v44, v56
    v_sub_f32 v45, v45, v56
    v_sub_f32 v46, v46, v56
    v_sub_f32 v47, v47, v56
    v_mul_f32 v23, v23, v57
    v_sub_f32 v92, v92, v56
    v_sub_f32 v93, v93, v56
    v_sub_f32 v94, v94, v56
    v_sub_f32 v95, v95, v56
    v_sub_f32 v124, v124, v56
    v_sub_f32 v125, v125, v56
    v_sub_f32 v126, v126, v56
    v_sub_f32 v127, v127, v56
    v_sub_f32 v156, v156, v56
    v_sub_f32 v157, v157, v56
    v_sub_f32 v158, v158, v56
    v_sub_f32 v159, v159, v56
    v_sub_f32 v188, v188, v56
    v_sub_f32 v189, v189, v56
    v_sub_f32 v190, v190, v56
    v_sub_f32 v191, v191, v56
    v_accvgpr_read_b32 v48, a12
    v_accvgpr_read_b32 v49, a13
    v_accvgpr_read_b32 v50, a14
    v_accvgpr_read_b32 v51, a15
    v_mul_f32 v48, v48, v57
    v_mul_f32 v49, v49, v57
    v_mul_f32 v50, v50, v57
    v_mul_f32 v51, v51, v57
    v_accvgpr_write_b32 a12, v48
    v_accvgpr_write_b32 a13, v49
    v_accvgpr_write_b32 a14, v50
    v_accvgpr_write_b32 a15, v51
    v_accvgpr_read_b32 v48, a28
    v_accvgpr_read_b32 v49, a29
    v_accvgpr_read_b32 v50, a30
    v_accvgpr_read_b32 v51, a31
    v_mul_f32 v48, v48, v57
    v_mul_f32 v49, v49, v57
    v_mul_f32 v50, v50, v57
    v_mul_f32 v51, v51, v57
    v_accvgpr_write_b32 a28, v48
    v_accvgpr_write_b32 a29, v49
    v_accvgpr_write_b32 a30, v50
    v_accvgpr_write_b32 a31, v51
    v_accvgpr_read_b32 v48, a44
    v_accvgpr_read_b32 v49, a45
    v_accvgpr_read_b32 v50, a46
    v_accvgpr_read_b32 v51, a47
    v_mul_f32 v48, v48, v57
    v_mul_f32 v49, v49, v57
    v_mul_f32 v50, v50, v57
    v_mul_f32 v51, v51, v57
    v_accvgpr_write_b32 a44, v48
    v_accvgpr_write_b32 a45, v49
    v_accvgpr_write_b32 a46, v50
    v_accvgpr_write_b32 a47, v51
    v_accvgpr_read_b32 v48, a60
    v_accvgpr_read_b32 v49, a61
    v_accvgpr_read_b32 v50, a62
    v_accvgpr_read_b32 v51, a63
    v_mul_f32 v48, v48, v57
    v_mul_f32 v49, v49, v57
    v_mul_f32 v50, v50, v57
    v_mul_f32 v51, v51, v57
    v_accvgpr_write_b32 a60, v48
    v_accvgpr_write_b32 a61, v49
    v_accvgpr_write_b32 a62, v50
    v_accvgpr_write_b32 a63, v51
    v_accvgpr_read_b32 v48, a76
    v_accvgpr_read_b32 v49, a77
    v_accvgpr_read_b32 v50, a78
    v_accvgpr_read_b32 v51, a79
    v_mul_f32 v48, v48, v57
    v_mul_f32 v49, v49, v57
    v_mul_f32 v50, v50, v57
    v_mul_f32 v51, v51, v57
    v_accvgpr_write_b32 a76, v48
    v_accvgpr_write_b32 a77, v49
    v_accvgpr_write_b32 a78, v50
    v_accvgpr_write_b32 a79, v51
    v_accvgpr_read_b32 v48, a92
    v_accvgpr_read_b32 v49, a93
    v_accvgpr_read_b32 v50, a94
    v_accvgpr_read_b32 v51, a95
    v_mul_f32 v48, v48, v57
    v_mul_f32 v49, v49, v57
    v_mul_f32 v50, v50, v57
    v_mul_f32 v51, v51, v57
    v_accvgpr_write_b32 a92, v48
    v_accvgpr_write_b32 a93, v49
    v_accvgpr_write_b32 a94, v50
    v_accvgpr_write_b32 a95, v51
    v_accvgpr_read_b32 v48, a108
    v_accvgpr_read_b32 v49, a109
    v_accvgpr_read_b32 v50, a110
    v_accvgpr_read_b32 v51, a111
    v_mul_f32 v48, v48, v57
    v_mul_f32 v49, v49, v57
    v_mul_f32 v50, v50, v57
    v_mul_f32 v51, v51, v57
    v_accvgpr_write_b32 a108, v48
    v_accvgpr_write_b32 a109, v49
    v_accvgpr_write_b32 a110, v50
    v_accvgpr_write_b32 a111, v51
    v_accvgpr_read_b32 v48, a124
    v_accvgpr_read_b32 v49, a125
    v_accvgpr_read_b32 v50, a126
    v_accvgpr_read_b32 v51, a127
    v_mul_f32 v48, v48, v57
    v_mul_f32 v49, v49, v57
    v_mul_f32 v50, v50, v57
    v_mul_f32 v51, v51, v57
    v_accvgpr_write_b32 a124, v48
    v_accvgpr_write_b32 a125, v49
    v_accvgpr_write_b32 a126, v50
    v_accvgpr_write_b32 a127, v51
    v_accvgpr_read_b32 v48, a140
    v_accvgpr_read_b32 v49, a141
    v_accvgpr_read_b32 v50, a142
    v_accvgpr_read_b32 v51, a143
    v_mul_f32 v48, v48, v57
    v_mul_f32 v49, v49, v57
    v_mul_f32 v50, v50, v57
    v_mul_f32 v51, v51, v57
    v_accvgpr_write_b32 a140, v48
    v_accvgpr_write_b32 a141, v49
    v_accvgpr_write_b32 a142, v50
    v_accvgpr_write_b32 a143, v51
    v_accvgpr_read_b32 v48, a156
    v_accvgpr_read_b32 v49, a157
    v_accvgpr_read_b32 v50, a158
    v_accvgpr_read_b32 v51, a159
    v_mul_f32 v48, v48, v57
    v_mul_f32 v49, v49, v57
    v_mul_f32 v50, v50, v57
    v_mul_f32 v51, v51, v57
    v_accvgpr_write_b32 a156, v48
    v_accvgpr_write_b32 a157, v49
    v_accvgpr_write_b32 a158, v50
    v_accvgpr_write_b32 a159, v51
    v_accvgpr_read_b32 v48, a172
    v_accvgpr_read_b32 v49, a173
    v_accvgpr_read_b32 v50, a174
    v_accvgpr_read_b32 v51, a175
    v_mul_f32 v48, v48, v57
    v_mul_f32 v49, v49, v57
    v_mul_f32 v50, v50, v57
    v_mul_f32 v51, v51, v57
    v_accvgpr_write_b32 a172, v48
    v_accvgpr_write_b32 a173, v49
    v_accvgpr_write_b32 a174, v50
    v_accvgpr_write_b32 a175, v51
    v_accvgpr_read_b32 v48, a188
    v_accvgpr_read_b32 v49, a189
    v_accvgpr_read_b32 v50, a190
    v_accvgpr_read_b32 v51, a191
    v_mul_f32 v48, v48, v57
    v_mul_f32 v49, v49, v57
    v_mul_f32 v50, v50, v57
    v_mul_f32 v51, v51, v57
    v_accvgpr_write_b32 a188, v48
    v_accvgpr_write_b32 a189, v49
    v_accvgpr_write_b32 a190, v50
    v_accvgpr_write_b32 a191, v51
    v_exp_f32 v48, v92
    v_exp_f32 v49, v93
    v_exp_f32 v50, v94
    v_exp_f32 v51, v95
    v_exp_f32 v52, v124
    v_exp_f32 v53, v125
    v_exp_f32 v54, v126
    v_exp_f32 v55, v127
    s_nop 0
    v_cvt_pk_bf16_f32 v220, v48, v49
    v_cvt_pk_bf16_f32 v221, v50, v51
    v_cvt_pk_bf16_f32 v222, v52, v53
    v_cvt_pk_bf16_f32 v223, v54, v55
    v_add_f32 v27, v48, v49
    v_add_f32 v27, v27, v50
    v_add_f32 v27, v27, v51
    v_add_f32 v27, v27, v52
    v_add_f32 v27, v27, v53
    v_add_f32 v27, v27, v54
    v_add_f32 v27, v27, v55
    s_nop 1
    s_branch rare_p_ret
rare_a:
    s_nop 7
    s_nop 7
    v_max3_f32 v56, v132, v133, v134
    v_max3_f32 v56, v56, v135, v164
    v_max3_f32 v56, v56, v165, v166
    v_max3_f32 v56, v56, v167, 0
    v_mov_b32 v58, v56
    s_nop 1
    v_permlane16_swap_b32 v56, v58
    s_nop 1
    v_max_f32 v56, v56, v58
    v_mov_b32 v58, v56
    s_nop 1
    v_permlane32_swap_b32 v56, v58
    s_nop 1
    v_max_f32 v56, v56, v58
    v_exp_f32 v57, -v56
    v_sub_f32 v32, v32, v56
    v_sub_f32 v33, v33, v56
    v_sub_f32 v34, v34, v56
    v_sub_f32 v35, v35, v56
    v_mul_f32 v20, v20, v57
    v_sub_f32 v132, v132, v56
    v_sub_f32 v133, v133, v56
    v_sub_f32 v134, v134, v56
    v_sub_f32 v135, v135, v56
    v_sub_f32 v164, v164, v56
    v_sub_f32 v165, v165, v56
    v_sub_f32 v166, v166, v56
    v_sub_f32 v167, v167, v56
    v_sub_f32 v68, v68, v56
    v_sub_f32 v69, v69, v56
    v_sub_f32 v70, v70, v56
    v_sub_f32 v71, v71, v56
    v_sub_f32 v100, v100, v56
    v_sub_f32 v101, v101, v56
    v_sub_f32 v102, v102, v56
    v_sub_f32 v103, v103, v56
    v_accvgpr_read_b32 v48, a0
    v_accvgpr_read_b32 v49, a1
    v_accvgpr_read_b32 v50, a2
    v_accvgpr_read_b32 v51, a3
    v_mul_f32 v48, v48, v57
    v_mul_f32 v49, v49, v57
    v_mul_f32 v50, v50, v57
    v_mul_f32 v51, v51, v57
    v_accvgpr_write_b32 a0, v48
    v_accvgpr_write_b32 a1, v49
    v_accvgpr_write_b32 a2, v50
    v_accvgpr_write_b32 a3, v51
    v_accvgpr_read_b32 v48, a16
    v_accvgpr_read_b32 v49, a17
    v_accvgpr_read_b32 v50, a18
    v_accvgpr_read_b32 v51, a19
    v_mul_f32 v48, v48, v57
    v_mul_f32 v49, v49, v57
    v_mul_f32 v50, v50, v57
    v_mul_f32 v51, v51, v57
    v_accvgpr_write_b32 a16, v48
    v_accvgpr_write_b32 a17, v49
    v_accvgpr_write_b32 a18, v50
    v_accvgpr_write_b32 a19, v51
    v_accvgpr_read_b32 v48, a32
    v_accvgpr_read_b32 v49, a33
    v_accvgpr_read_b32 v50, a34
    v_accvgpr_read_b32 v51, a35
    v_mul_f32 v48, v48, v57
    v_mul_f32 v49, v49, v57
    v_mul_f32 v50, v50, v57
    v_mul_f32 v51, v51, v57
    v_accvgpr_write_b32 a32, v48
    v_accvgpr_write_b32 a33, v49
    v_accvgpr_write_b32 a34, v50
    v_accvgpr_write_b32 a35, v51
    v_accvgpr_read_b32 v48, a48
    v_accvgpr_read_b32 v49, a49
    v_accvgpr_read_b32 v50, a50
    v_accvgpr_read_b32 v51, a51
    v_mul_f32 v48, v48, v57
    v_mul_f32 v49, v49, v57
    v_mul_f32 v50, v50, v57
    v_mul_f32 v51, v51, v57
    v_accvgpr_write_b32 a48, v48
    v_accvgpr_write_b32 a49, v49
    v_accvgpr_write_b32 a50, v50
    v_accvgpr_write_b32 a51, v51
    v_accvgpr_read_b32 v48, a64
    v_accvgpr_read_b32 v49, a65
    v_accvgpr_read_b32 v50, a66
    v_accvgpr_read_b32 v51, a67
    v_mul_f32 v48, v48, v57
    v_mul_f32 v49, v49, v57
    v_mul_f32 v50, v50, v57
    v_mul_f32 v51, v51, v57
    v_accvgpr_write_b32 a64, v48
    v_accvgpr_write_b32 a65, v49
    v_accvgpr_write_b32 a66, v50
    v_accvgpr_write_b32 a67, v51
    v_accvgpr_read_b32 v48, a80
    v_accvgpr_read_b32 v49, a81
    v_accvgpr_read_b32 v50, a82
    v_accvgpr_read_b32 v51, a83
    v_mul_f32 v48, v48, v57
    v_mul_f32 v49, v49, v57
    v_mul_f32 v50, v50, v57
    v_mul_f32 v51, v51, v57
    v_accvgpr_write_b32 a80, v48
    v_accvgpr_write_b32 a81, v49
    v_accvgpr_write_b32 a82, v50
    v_accvgpr_write_b32 a83, v51
    v_accvgpr_read_b32 v48, a96
    v_accvgpr_read_b32 v49, a97
    v_accvgpr_read_b32 v50, a98
    v_accvgpr_read_b32 v51, a99
    v_mul_f32 v48, v48, v57
    v_mul_f32 v49, v49, v57
    v_mul_f32 v50, v50, v57
    v_mul_f32 v51, v51, v57
    v_accvgpr_write_b32 a96, v48
    v_accvgpr_write_b32 a97, v49
    v_accvgpr_write_b32 a98, v50
    v_accvgpr_write_b32 a99, v51
    v_accvgpr_read_b32 v48, a112
    v_accvgpr_read_b32 v49, a113
    v_accvgpr_read_b32 v50, a114
    v_accvgpr_read_b32 v51, a115
    v_mul_f32 v48, v48, v57
    v_mul_f32 v49, v49, v57
    v_mul_f32 v50, v50, v57
    v_mul_f32 v51, v51, v57
    v_accvgpr_write_b32 a112, v48
    v_accvgpr_write_b32 a113, v49
    v_accvgpr_write_b32 a114, v50
    v_accvgpr_write_b32 a115, v51
    v_accvgpr_read_b32 v48, a128
    v_accvgpr_read_b32 v49, a129
    v_accvgpr_read_b32 v50, a130
    v_accvgpr_read_b32 v51, a131
    v_mul_f32 v48, v48, v57
    v_mul_f32 v49, v49, v57
    v_mul_f32 v50, v50, v57
    v_mul_f32 v51, v51, v57
    v_accvgpr_write_b32 a128, v48
    v_accvgpr_write_b32 a129, v49
    v_accvgpr_write_b32 a130, v50
    v_accvgpr_write_b32 a131, v51
    v_accvgpr_read_b32 v48, a144
    v_accvgpr_read_b32 v49, a145
    v_accvgpr_read_b32 v50, a146
    v_accvgpr_read_b32 v51, a147
    v_mul_f32 v48, v48, v57
    v_mul_f32 v49, v49, v57
    v_mul_f32 v50, v50, v57
    v_mul_f32 v51, v51, v57
    v_accvgpr_write_b32 a144, v48
    v_accvgpr_write_b32 a145, v49
    v_accvgpr_write_b32 a146, v50
    v_accvgpr_write_b32 a147, v51
    v_accvgpr_read_b32 v48, a160
    v_accvgpr_read_b32 v49, a161
    v_accvgpr_read_b32 v50, a162
    v_accvgpr_read_b32 v51, a163
    v_mul_f32 v48, v48, v57
    v_mul_f32 v49, v49, v57
    v_mul_f32 v50, v50, v57
    v_mul_f32 v51, v51, v57
    v_accvgpr_write_b32 a160, v48
    v_accvgpr_write_b32 a161, v49
    v_accvgpr_write_b32 a162, v50
    v_accvgpr_write_b32 a163, v51
    v_accvgpr_read_b32 v48, a176
    v_accvgpr_read_b32 v49, a177
    v_accvgpr_read_b32 v50, a178
    v_accvgpr_read_b32 v51, a179
    v_mul_f32 v48, v48, v57
    v_mul_f32 v49, v49, v57
    v_mul_f32 v50, v50, v57
    v_mul_f32 v51, v51, v57
    v_accvgpr_write_b32 a176, v48
    v_accvgpr_write_b32 a177, v49
    v_accvgpr_write_b32 a178, v50
    v_accvgpr_write_b32 a179, v51
    v_exp_f32 v48, v132
    v_exp_f32 v49, v133
    v_exp_f32 v50, v134
    v_exp_f32 v51, v135
    v_exp_f32 v52, v164
    v_exp_f32 v53, v165
    v_exp_f32 v54, v166
    v_exp_f32 v55, v167
    s_nop 0
    v_cvt_pk_bf16_f32 v228, v48, v49
    v_cvt_pk_bf16_f32 v229, v50, v51
    v_cvt_pk_bf16_f32 v230, v52, v53
    v_cvt_pk_bf16_f32 v231, v54, v55
    v_add_f32 v24, v48, v49
    v_add_f32 v24, v24, v50
    v_add_f32 v24, v24, v51
    v_add_f32 v24, v24, v52
    v_add_f32 v24, v24, v53
    v_add_f32 v24, v24, v54
    v_add_f32 v24, v24, v55
    v_max3_f32 v56, v140, v141, v142
    v_max3_f32 v56, v56, v143, v172
    v_max3_f32 v56, v56, v173, v174
    v_max3_f32 v56, v56, v175, 0
    v_mov_b32 v58, v56
    s_nop 1
    v_permlane16_swap_b32 v56, v58
    s_nop 1
    v_max_f32 v56, v56, v58
    v_mov_b32 v58, v56
    s_nop 1
    v_permlane32_swap_b32 v56, v58
    s_nop 1
    v_max_f32 v56, v56, v58
    v_exp_f32 v57, -v56
    v_sub_f32 v36, v36, v56
    v_sub_f32 v37, v37, v56
    v_sub_f32 v38, v38, v56
    v_sub_f32 v39, v39, v56
    v_mul_f32 v21, v21, v57
    v_sub_f32 v140, v140, v56
    v_sub_f32 v141, v141, v56
    v_sub_f32 v142, v142, v56
    v_sub_f32 v143, v143, v56
    v_sub_f32 v172, v172, v56
    v_sub_f32 v173, v173, v56
    v_sub_f32 v174, v174, v56
    v_sub_f32 v175, v175, v56
    v_sub_f32 v76, v76, v56
    v_sub_f32 v77, v77, v56
    v_sub_f32 v78, v78, v56
    v_sub_f32 v79, v79, v56
    v_sub_f32 v108, v108, v56
    v_sub_f32 v109, v109, v56
    v_sub_f32 v110, v110, v56
    v_sub_f32 v111, v111, v56
    v_accvgpr_read_b32 v48, a4
    v_accvgpr_read_b32 v49, a5
    v_accvgpr_read_b32 v50, a6
    v_accvgpr_read_b32 v51, a7
    v_mul_f32 v48, v48, v57
    v_mul_f32 v49, v49, v57
    v_mul_f32 v50, v50, v57
    v_mul_f32 v51, v51, v57
    v_accvgpr_write_b32 a4, v48
    v_accvgpr_write_b32 a5, v49
    v_accvgpr_write_b32 a6, v50
    v_accvgpr_write_b32 a7, v51
    v_accvgpr_read_b32 v48, a20
    v_accvgpr_read_b32 v49, a21
    v_accvgpr_read_b32 v50, a22
    v_accvgpr_read_b32 v51, a23
    v_mul_f32 v48, v48, v57
    v_mul_f32 v49, v49, v57
    v_mul_f32 v50, v50, v57
    v_mul_f32 v51, v51, v57
    v_accvgpr_write_b32 a20, v48
    v_accvgpr_write_b32 a21, v49
    v_accvgpr_write_b32 a22, v50
    v_accvgpr_write_b32 a23, v51
    v_accvgpr_read_b32 v48, a36
    v_accvgpr_read_b32 v49, a37
    v_accvgpr_read_b32 v50, a38
    v_accvgpr_read_b32 v51, a39
    v_mul_f32 v48, v48, v57
    v_mul_f32 v49, v49, v57
    v_mul_f32 v50, v50, v57
    v_mul_f32 v51, v51, v57
    v_accvgpr_write_b32 a36, v48
    v_accvgpr_write_b32 a37, v49
    v_accvgpr_write_b32 a38, v50
    v_accvgpr_write_b32 a39, v51
    v_accvgpr_read_b32 v48, a52
    v_accvgpr_read_b32 v49, a53
    v_accvgpr_read_b32 v50, a54
    v_accvgpr_read_b32 v51, a55
    v_mul_f32 v48, v48, v57
    v_mul_f32 v49, v49, v57
    v_mul_f32 v50, v50, v57
    v_mul_f32 v51, v51, v57
    v_accvgpr_write_b32 a52, v48
    v_accvgpr_write_b32 a53, v49
    v_accvgpr_write_b32 a54, v50
    v_accvgpr_write_b32 a55, v51
    v_accvgpr_read_b32 v48, a68
    v_accvgpr_read_b32 v49, a69
    v_accvgpr_read_b32 v50, a70
    v_accvgpr_read_b32 v51, a71
    v_mul_f32 v48, v48, v57
    v_mul_f32 v49, v49, v57
    v_mul_f32 v50, v50, v57
    v_mul_f32 v51, v51, v57
    v_accvgpr_write_b32 a68, v48
    v_accvgpr_write_b32 a69, v49
    v_accvgpr_write_b32 a70, v50
    v_accvgpr_write_b32 a71, v51
    v_accvgpr_read_b32 v48, a84
    v_accvgpr_read_b32 v49, a85
    v_accvgpr_read_b32 v50, a86
    v_accvgpr_read_b32 v51, a87
    v_mul_f32 v48, v48, v57
    v_mul_f32 v49, v49, v57
    v_mul_f32 v50, v50, v57
    v_mul_f32 v51, v51, v57
    v_accvgpr_write_b32 a84, v48
    v_accvgpr_write_b32 a85, v49
    v_accvgpr_write_b32 a86, v50
    v_accvgpr_write_b32 a87, v51
    v_accvgpr_read_b32 v48, a100
    v_accvgpr_read_b32 v49, a101
    v_accvgpr_read_b32 v50, a102
    v_accvgpr_read_b32 v51, a103
    v_mul_f32 v48, v48, v57
    v_mul_f32 v49, v49, v57
    v_mul_f32 v50, v50, v57
    v_mul_f32 v51, v51, v57
    v_accvgpr_write_b32 a100, v48
    v_accvgpr_write_b32 a101, v49
    v_accvgpr_write_b32 a102, v50
    v_accvgpr_write_b32 a103, v51
    v_accvgpr_read_b32 v48, a116
    v_accvgpr_read_b32 v49, a117
    v_accvgpr_read_b32 v50, a118
    v_accvgpr_read_b32 v51, a119
    v_mul_f32 v48, v48, v57
    v_mul_f32 v49, v49, v57
    v_mul_f32 v50, v50, v57
    v_mul_f32 v51, v51, v57
    v_accvgpr_write_b32 a116, v48
    v_accvgpr_write_b32 a117, v49
    v_accvgpr_write_b32 a118, v50
    v_accvgpr_write_b32 a119, v51
    v_accvgpr_read_b32 v48, a132
    v_accvgpr_read_b32 v49, a133
    v_accvgpr_read_b32 v50, a134
    v_accvgpr_read_b32 v51, a135
    v_mul_f32 v48, v48, v57
    v_mul_f32 v49, v49, v57
    v_mul_f32 v50, v50, v57
    v_mul_f32 v51, v51, v57
    v_accvgpr_write_b32 a132, v48
    v_accvgpr_write_b32 a133, v49
    v_accvgpr_write_b32 a134, v50
    v_accvgpr_write_b32 a135, v51
    v_accvgpr_read_b32 v48, a148
    v_accvgpr_read_b32 v49, a149
    v_accvgpr_read_b32 v50, a150
    v_accvgpr_read_b32 v51, a151
    v_mul_f32 v48, v48, v57
    v_mul_f32 v49, v49, v57
    v_mul_f32 v50, v50, v57
    v_mul_f32 v51, v51, v57
    v_accvgpr_write_b32 a148, v48
    v_accvgpr_write_b32 a149, v49
    v_accvgpr_write_b32 a150, v50
    v_accvgpr_write_b32 a151, v51
    v_accvgpr_read_b32 v48, a164
    v_accvgpr_read_b32 v49, a165
    v_accvgpr_read_b32 v50, a166
    v_accvgpr_read_b32 v51, a167
    v_mul_f32 v48, v48, v57
    v_mul_f32 v49, v49, v57
    v_mul_f32 v50, v50, v57
    v_mul_f32 v51, v51, v57
    v_accvgpr_write_b32 a164, v48
    v_accvgpr_write_b32 a165, v49
    v_accvgpr_write_b32 a166, v50
    v_accvgpr_write_b32 a167, v51
    v_accvgpr_read_b32 v48, a180
    v_accvgpr_read_b32 v49, a181
    v_accvgpr_read_b32 v50, a182
    v_accvgpr_read_b32 v51, a183
    v_mul_f32 v48, v48, v57
    v_mul_f32 v49, v49, v57
    v_mul_f32 v50, v50, v57
    v_mul_f32 v51, v51, v57
    v_accvgpr_write_b32 a180, v48
    v_accvgpr_write_b32 a181, v49
    v_accvgpr_write_b32 a182, v50
    v_accvgpr_write_b32 a183, v51
    v_exp_f32 v48, v140
    v_exp_f32 v49, v141
    v_exp_f32 v50, v142
    v_exp_f32 v51, v143
    v_exp_f32 v52, v172
    v_exp_f32 v53, v173
    v_exp_f32 v54, v174
    v_exp_f32 v55, v175
    s_nop 0
    v_cvt_pk_bf16_f32 v236, v48, v49
    v_cvt_pk_bf16_f32 v237, v50, v51
    v_cvt_pk_bf16_f32 v238, v52, v53
    v_cvt_pk_bf16_f32 v239, v54, v55
    v_add_f32 v25, v48, v49
    v_add_f32 v25, v25, v50
    v_add_f32 v25, v25, v51
    v_add_f32 v25, v25, v52
    v_add_f32 v25, v25, v53
    v_add_f32 v25, v25, v54
    v_add_f32 v25, v25, v55
    v_max3_f32 v56, v148, v149, v150
    v_max3_f32 v56, v56, v151, v180
    v_max3_f32 v56, v56, v181, v182
    v_max3_f32 v56, v56, v183, 0
    v_mov_b32 v58, v56
    s_nop 1
    v_permlane16_swap_b32 v56, v58
    s_nop 1
    v_max_f32 v56, v56, v58
    v_mov_b32 v58, v56
    s_nop 1
    v_permlane32_swap_b32 v56, v58
    s_nop 1
    v_max_f32 v56, v56, v58
    v_exp_f32 v57, -v56
    v_sub_f32 v40, v40, v56
    v_sub_f32 v41, v41, v56
    v_sub_f32 v42, v42, v56
    v_sub_f32 v43, v43, v56
    v_mul_f32 v22, v22, v57
    v_sub_f32 v148, v148, v56
    v_sub_f32 v149, v149, v56
    v_sub_f32 v150, v150, v56
    v_sub_f32 v151, v151, v56
    v_sub_f32 v180, v180, v56
    v_sub_f32 v181, v181, v56
    v_sub_f32 v182, v182, v56
    v_sub_f32 v183, v183, v56
    v_sub_f32 v84, v84, v56
    v_sub_f32 v85, v85, v56
    v_sub_f32 v86, v86, v56
    v_sub_f32 v87, v87, v56
    v_sub_f32 v116, v116, v56
    v_sub_f32 v117, v117, v56
    v_sub_f32 v118, v118, v56
    v_sub_f32 v119, v119, v56
    v_accvgpr_read_b32 v48, a8
    v_accvgpr_read_b32 v49, a9
    v_accvgpr_read_b32 v50, a10
    v_accvgpr_read_b32 v51, a11
    v_mul_f32 v48, v48, v57
    v_mul_f32 v49, v49, v57
    v_mul_f32 v50, v50, v57
    v_mul_f32 v51, v51, v57
    v_accvgpr_write_b32 a8, v48
    v_accvgpr_write_b32 a9, v49
    v_accvgpr_write_b32 a10, v50
    v_accvgpr_write_b32 a11, v51
    v_accvgpr_read_b32 v48, a24
    v_accvgpr_read_b32 v49, a25
    v_accvgpr_read_b32 v50, a26
    v_accvgpr_read_b32 v51, a27
    v_mul_f32 v48, v48, v57
    v_mul_f32 v49, v49, v57
    v_mul_f32 v50, v50, v57
    v_mul_f32 v51, v51, v57
    v_accvgpr_write_b32 a24, v48
    v_accvgpr_write_b32 a25, v49
    v_accvgpr_write_b32 a26, v50
    v_accvgpr_write_b32 a27, v51
    v_accvgpr_read_b32 v48, a40
    v_accvgpr_read_b32 v49, a41
    v_accvgpr_read_b32 v50, a42
    v_accvgpr_read_b32 v51, a43
    v_mul_f32 v48, v48, v57
    v_mul_f32 v49, v49, v57
    v_mul_f32 v50, v50, v57
    v_mul_f32 v51, v51, v57
    v_accvgpr_write_b32 a40, v48
    v_accvgpr_write_b32 a41, v49
    v_accvgpr_write_b32 a42, v50
    v_accvgpr_write_b32 a43, v51
    v_accvgpr_read_b32 v48, a56
    v_accvgpr_read_b32 v49, a57
    v_accvgpr_read_b32 v50, a58
    v_accvgpr_read_b32 v51, a59
    v_mul_f32 v48, v48, v57
    v_mul_f32 v49, v49, v57
    v_mul_f32 v50, v50, v57
    v_mul_f32 v51, v51, v57
    v_accvgpr_write_b32 a56, v48
    v_accvgpr_write_b32 a57, v49
    v_accvgpr_write_b32 a58, v50
    v_accvgpr_write_b32 a59, v51
    v_accvgpr_read_b32 v48, a72
    v_accvgpr_read_b32 v49, a73
    v_accvgpr_read_b32 v50, a74
    v_accvgpr_read_b32 v51, a75
    v_mul_f32 v48, v48, v57
    v_mul_f32 v49, v49, v57
    v_mul_f32 v50, v50, v57
    v_mul_f32 v51, v51, v57
    v_accvgpr_write_b32 a72, v48
    v_accvgpr_write_b32 a73, v49
    v_accvgpr_write_b32 a74, v50
    v_accvgpr_write_b32 a75, v51
    v_accvgpr_read_b32 v48, a88
    v_accvgpr_read_b32 v49, a89
    v_accvgpr_read_b32 v50, a90
    v_accvgpr_read_b32 v51, a91
    v_mul_f32 v48, v48, v57
    v_mul_f32 v49, v49, v57
    v_mul_f32 v50, v50, v57
    v_mul_f32 v51, v51, v57
    v_accvgpr_write_b32 a88, v48
    v_accvgpr_write_b32 a89, v49
    v_accvgpr_write_b32 a90, v50
    v_accvgpr_write_b32 a91, v51
    v_accvgpr_read_b32 v48, a104
    v_accvgpr_read_b32 v49, a105
    v_accvgpr_read_b32 v50, a106
    v_accvgpr_read_b32 v51, a107
    v_mul_f32 v48, v48, v57
    v_mul_f32 v49, v49, v57
    v_mul_f32 v50, v50, v57
    v_mul_f32 v51, v51, v57
    v_accvgpr_write_b32 a104, v48
    v_accvgpr_write_b32 a105, v49
    v_accvgpr_write_b32 a106, v50
    v_accvgpr_write_b32 a107, v51
    v_accvgpr_read_b32 v48, a120
    v_accvgpr_read_b32 v49, a121
    v_accvgpr_read_b32 v50, a122
    v_accvgpr_read_b32 v51, a123
    v_mul_f32 v48, v48, v57
    v_mul_f32 v49, v49, v57
    v_mul_f32 v50, v50, v57
    v_mul_f32 v51, v51, v57
    v_accvgpr_write_b32 a120, v48
    v_accvgpr_write_b32 a121, v49
    v_accvgpr_write_b32 a122, v50
    v_accvgpr_write_b32 a123, v51
    v_accvgpr_read_b32 v48, a136
    v_accvgpr_read_b32 v49, a137
    v_accvgpr_read_b32 v50, a138
    v_accvgpr_read_b32 v51, a139
    v_mul_f32 v48, v48, v57
    v_mul_f32 v49, v49, v57
    v_mul_f32 v50, v50, v57
    v_mul_f32 v51, v51, v57
    v_accvgpr_write_b32 a136, v48
    v_accvgpr_write_b32 a137, v49
    v_accvgpr_write_b32 a138, v50
    v_accvgpr_write_b32 a139, v51
    v_accvgpr_read_b32 v48, a152
    v_accvgpr_read_b32 v49, a153
    v_accvgpr_read_b32 v50, a154
    v_accvgpr_read_b32 v51, a155
    v_mul_f32 v48, v48, v57
    v_mul_f32 v49, v49, v57
    v_mul_f32 v50, v50, v57
    v_mul_f32 v51, v51, v57
    v_accvgpr_write_b32 a152, v48
    v_accvgpr_write_b32 a153, v49
    v_accvgpr_write_b32 a154, v50
    v_accvgpr_write_b32 a155, v51
    v_accvgpr_read_b32 v48, a168
    v_accvgpr_read_b32 v49, a169
    v_accvgpr_read_b32 v50, a170
    v_accvgpr_read_b32 v51, a171
    v_mul_f32 v48, v48, v57
    v_mul_f32 v49, v49, v57
    v_mul_f32 v50, v50, v57
    v_mul_f32 v51, v51, v57
    v_accvgpr_write_b32 a168, v48
    v_accvgpr_write_b32 a169, v49
    v_accvgpr_write_b32 a170, v50
    v_accvgpr_write_b32 a171, v51
    v_accvgpr_read_b32 v48, a184
    v_accvgpr_read_b32 v49, a185
    v_accvgpr_read_b32 v50, a186
    v_accvgpr_read_b32 v51, a187
    v_mul_f32 v48, v48, v57
    v_mul_f32 v49, v49, v57
    v_mul_f32 v50, v50, v57
    v_mul_f32 v51, v51, v57
    v_accvgpr_write_b32 a184, v48
    v_accvgpr_write_b32 a185, v49
    v_accvgpr_write_b32 a186, v50
    v_accvgpr_write_b32 a187, v51
    v_exp_f32 v48, v148
    v_exp_f32 v49, v149
    v_exp_f32 v50, v150
    v_exp_f32 v51, v151
    v_exp_f32 v52, v180
    v_exp_f32 v53, v181
    v_exp_f32 v54, v182
    v_exp_f32 v55, v183
    s_nop 0
    v_cvt_pk_bf16_f32 v244, v48, v49
    v_cvt_pk_bf16_f32 v245, v50, v51
    v_cvt_pk_bf16_f32 v246, v52, v53
    v_cvt_pk_bf16_f32 v247, v54, v55
    v_add_f32 v26, v48, v49
    v_add_f32 v26, v26, v50
    v_add_f32 v26, v26, v51
    v_add_f32 v26, v26, v52
    v_add_f32 v26, v26, v53
    v_add_f32 v26, v26, v54
    v_add_f32 v26, v26, v55
    v_max3_f32 v56, v156, v157, v158
    v_max3_f32 v56, v56, v159, v188
    v_max3_f32 v56, v56, v189, v190
    v_max3_f32 v56, v56, v191, 0
    v_mov_b32 v58, v56
    s_nop 1
    v_permlane16_swap_b32 v56, v58
    s_nop 1
    v_max_f32 v56, v56, v58
    v_mov_b32 v58, v56
    s_nop 1
    v_permlane32_swap_b32 v56, v58
    s_nop 1
    v_max_f32 v56, v56, v58
    v_exp_f32 v57, -v56
    v_sub_f32 v44, v44, v56
    v_sub_f32 v45, v45, v56
    v_sub_f32 v46, v46, v56
    v_sub_f32 v47, v47, v56
    v_mul_f32 v23, v23, v57
    v_sub_f32 v156, v156, v56
    v_sub_f32 v157, v157, v56
    v_sub_f32 v158, v158, v56
    v_sub_f32 v159, v159, v56
    v_sub_f32 v188, v188, v56
    v_sub_f32 v189, v189, v56
    v_sub_f32 v190, v190, v56
    v_sub_f32 v191, v191, v56
    v_sub_f32 v92, v92, v56
    v_sub_f32 v93, v93, v56
    v_sub_f32 v94, v94, v56
    v_sub_f32 v95, v95, v56
    v_sub_f32 v124, v124, v56
    v_sub_f32 v125, v125, v56
    v_sub_f32 v126, v126, v56
    v_sub_f32 v127, v127, v56
    v_accvgpr_read_b32 v48, a12
    v_accvgpr_read_b32 v49, a13
    v_accvgpr_read_b32 v50, a14
    v_accvgpr_read_b32 v51, a15
    v_mul_f32 v48, v48, v57
    v_mul_f32 v49, v49, v57
    v_mul_f32 v50, v50, v57
    v_mul_f32 v51, v51, v57
    v_accvgpr_write_b32 a12, v48
    v_accvgpr_write_b32 a13, v49
    v_accvgpr_write_b32 a14, v50
    v_accvgpr_write_b32 a15, v51
    v_accvgpr_read_b32 v48, a28
    v_accvgpr_read_b32 v49, a29
    v_accvgpr_read_b32 v50, a30
    v_accvgpr_read_b32 v51, a31
    v_mul_f32 v48, v48, v57
    v_mul_f32 v49, v49, v57
    v_mul_f32 v50, v50, v57
    v_mul_f32 v51, v51, v57
    v_accvgpr_write_b32 a28, v48
    v_accvgpr_write_b32 a29, v49
    v_accvgpr_write_b32 a30, v50
    v_accvgpr_write_b32 a31, v51
    v_accvgpr_read_b32 v48, a44
    v_accvgpr_read_b32 v49, a45
    v_accvgpr_read_b32 v50, a46
    v_accvgpr_read_b32 v51, a47
    v_mul_f32 v48, v48, v57
    v_mul_f32 v49, v49, v57
    v_mul_f32 v50, v50, v57
    v_mul_f32 v51, v51, v57
    v_accvgpr_write_b32 a44, v48
    v_accvgpr_write_b32 a45, v49
    v_accvgpr_write_b32 a46, v50
    v_accvgpr_write_b32 a47, v51
    v_accvgpr_read_b32 v48, a60
    v_accvgpr_read_b32 v49, a61
    v_accvgpr_read_b32 v50, a62
    v_accvgpr_read_b32 v51, a63
    v_mul_f32 v48, v48, v57
    v_mul_f32 v49, v49, v57
    v_mul_f32 v50, v50, v57
    v_mul_f32 v51, v51, v57
    v_accvgpr_write_b32 a60, v48
    v_accvgpr_write_b32 a61, v49
    v_accvgpr_write_b32 a62, v50
    v_accvgpr_write_b32 a63, v51
    v_accvgpr_read_b32 v48, a76
    v_accvgpr_read_b32 v49, a77
    v_accvgpr_read_b32 v50, a78
    v_accvgpr_read_b32 v51, a79
    v_mul_f32 v48, v48, v57
    v_mul_f32 v49, v49, v57
    v_mul_f32 v50, v50, v57
    v_mul_f32 v51, v51, v57
    v_accvgpr_write_b32 a76, v48
    v_accvgpr_write_b32 a77, v49
    v_accvgpr_write_b32 a78, v50
    v_accvgpr_write_b32 a79, v51
    v_accvgpr_read_b32 v48, a92
    v_accvgpr_read_b32 v49, a93
    v_accvgpr_read_b32 v50, a94
    v_accvgpr_read_b32 v51, a95
    v_mul_f32 v48, v48, v57
    v_mul_f32 v49, v49, v57
    v_mul_f32 v50, v50, v57
    v_mul_f32 v51, v51, v57
    v_accvgpr_write_b32 a92, v48
    v_accvgpr_write_b32 a93, v49
    v_accvgpr_write_b32 a94, v50
    v_accvgpr_write_b32 a95, v51
    v_accvgpr_read_b32 v48, a108
    v_accvgpr_read_b32 v49, a109
    v_accvgpr_read_b32 v50, a110
    v_accvgpr_read_b32 v51, a111
    v_mul_f32 v48, v48, v57
    v_mul_f32 v49, v49, v57
    v_mul_f32 v50, v50, v57
    v_mul_f32 v51, v51, v57
    v_accvgpr_write_b32 a108, v48
    v_accvgpr_write_b32 a109, v49
    v_accvgpr_write_b32 a110, v50
    v_accvgpr_write_b32 a111, v51
    v_accvgpr_read_b32 v48, a124
    v_accvgpr_read_b32 v49, a125
    v_accvgpr_read_b32 v50, a126
    v_accvgpr_read_b32 v51, a127
    v_mul_f32 v48, v48, v57
    v_mul_f32 v49, v49, v57
    v_mul_f32 v50, v50, v57
    v_mul_f32 v51, v51, v57
    v_accvgpr_write_b32 a124, v48
    v_accvgpr_write_b32 a125, v49
    v_accvgpr_write_b32 a126, v50
    v_accvgpr_write_b32 a127, v51
    v_accvgpr_read_b32 v48, a140
    v_accvgpr_read_b32 v49, a141
    v_accvgpr_read_b32 v50, a142
    v_accvgpr_read_b32 v51, a143
    v_mul_f32 v48, v48, v57
    v_mul_f32 v49, v49, v57
    v_mul_f32 v50, v50, v57
    v_mul_f32 v51, v51, v57
    v_accvgpr_write_b32 a140, v48
    v_accvgpr_write_b32 a141, v49
    v_accvgpr_write_b32 a142, v50
    v_accvgpr_write_b32 a143, v51
    v_accvgpr_read_b32 v48, a156
    v_accvgpr_read_b32 v49, a157
    v_accvgpr_read_b32 v50, a158
    v_accvgpr_read_b32 v51, a159
    v_mul_f32 v48, v48, v57
    v_mul_f32 v49, v49, v57
    v_mul_f32 v50, v50, v57
    v_mul_f32 v51, v51, v57
    v_accvgpr_write_b32 a156, v48
    v_accvgpr_write_b32 a157, v49
    v_accvgpr_write_b32 a158, v50
    v_accvgpr_write_b32 a159, v51
    v_accvgpr_read_b32 v48, a172
    v_accvgpr_read_b32 v49, a173
    v_accvgpr_read_b32 v50, a174
    v_accvgpr_read_b32 v51, a175
    v_mul_f32 v48, v48, v57
    v_mul_f32 v49, v49, v57
    v_mul_f32 v50, v50, v57
    v_mul_f32 v51, v51, v57
    v_accvgpr_write_b32 a172, v48
    v_accvgpr_write_b32 a173, v49
    v_accvgpr_write_b32 a174, v50
    v_accvgpr_write_b32 a175, v51
    v_accvgpr_read_b32 v48, a188
    v_accvgpr_read_b32 v49, a189
    v_accvgpr_read_b32 v50, a190
    v_accvgpr_read_b32 v51, a191
    v_mul_f32 v48, v48, v57
    v_mul_f32 v49, v49, v57
    v_mul_f32 v50, v50, v57
    v_mul_f32 v51, v51, v57
    v_accvgpr_write_b32 a188, v48
    v_accvgpr_write_b32 a189, v49
    v_accvgpr_write_b32 a190, v50
    v_accvgpr_write_b32 a191, v51
    v_exp_f32 v48, v156
    v_exp_f32 v49, v157
    v_exp_f32 v50, v158
    v_exp_f32 v51, v159
    v_exp_f32 v52, v188
    v_exp_f32 v53, v189
    v_exp_f32 v54, v190
    v_exp_f32 v55, v191
    s_nop 0
    v_cvt_pk_bf16_f32 v252, v48, v49
    v_cvt_pk_bf16_f32 v253, v50, v51
    v_cvt_pk_bf16_f32 v254, v52, v53
    v_cvt_pk_bf16_f32 v255, v54, v55
    v_add_f32 v27, v48, v49
    v_add_f32 v27, v27, v50
    v_add_f32 v27, v27, v51
    v_add_f32 v27, v27, v52
    v_add_f32 v27, v27, v53
    v_add_f32 v27, v27, v54
    v_add_f32 v27, v27, v55
    s_nop 1
    s_branch rare_a_ret
rare_b:
    s_nop 7
    s_nop 7
    v_max3_f32 v56, v68, v69, v70
    v_max3_f32 v56, v56, v71, v100
    v_max3_f32 v56, v56, v101, v102
    v_max3_f32 v56, v56, v103, 0
    v_mov_b32 v58, v56
    s_nop 1
    v_permlane16_swap_b32 v56, v58
    s_nop 1
    v_max_f32 v56, v56, v58
    v_mov_b32 v58, v56
    s_nop 1
    v_permlane32_swap_b32 v56, v58
    s_nop 1
    v_max_f32 v56, v56, v58
    v_exp_f32 v57, -v56
    v_sub_f32 v32, v32, v56
    v_sub_f32 v33, v33, v56
    v_sub_f32 v34, v34, v56
    v_sub_f32 v35, v35, v56
    v_mul_f32 v20, v20, v57
    v_sub_f32 v68, v68, v56
    v_sub_f32 v69, v69, v56
    v_sub_f32 v70, v70, v56
    v_sub_f32 v71, v71, v56
    v_sub_f32 v100, v100, v56
    v_sub_f32 v101, v101, v56
    v_sub_f32 v102, v102, v56
    v_sub_f32 v103, v103, v56
    v_sub_f32 v132, v132, v56
    v_sub_f32 v133, v133, v56
    v_sub_f32 v134, v134, v56
    v_sub_f32 v135, v135, v56
    v_sub_f32 v164, v164, v56
    v_sub_f32 v165, v165, v56
    v_sub_f32 v166, v166, v56
    v_sub_f32 v167, v167, v56
    v_accvgpr_read_b32 v48, a0
    v_accvgpr_read_b32 v49, a1
    v_accvgpr_read_b32 v50, a2
    v_accvgpr_read_b32 v51, a3
    v_mul_f32 v48, v48, v57
    v_mul_f32 v49, v49, v57
    v_mul_f32 v50, v50, v57
    v_mul_f32 v51, v51, v57
    v_accvgpr_write_b32 a0, v48
    v_accvgpr_write_b32 a1, v49
    v_accvgpr_write_b32 a2, v50
    v_accvgpr_write_b32 a3, v51
    v_accvgpr_read_b32 v48, a16
    v_accvgpr_read_b32 v49, a17
    v_accvgpr_read_b32 v50, a18
    v_accvgpr_read_b32 v51, a19
    v_mul_f32 v48, v48, v57
    v_mul_f32 v49, v49, v57
    v_mul_f32 v50, v50, v57
    v_mul_f32 v51, v51, v57
    v_accvgpr_write_b32 a16, v48
    v_accvgpr_write_b32 a17, v49
    v_accvgpr_write_b32 a18, v50
    v_accvgpr_write_b32 a19, v51
    v_accvgpr_read_b32 v48, a32
    v_accvgpr_read_b32 v49, a33
    v_accvgpr_read_b32 v50, a34
    v_accvgpr_read_b32 v51, a35
    v_mul_f32 v48, v48, v57
    v_mul_f32 v49, v49, v57
    v_mul_f32 v50, v50, v57
    v_mul_f32 v51, v51, v57
    v_accvgpr_write_b32 a32, v48
    v_accvgpr_write_b32 a33, v49
    v_accvgpr_write_b32 a34, v50
    v_accvgpr_write_b32 a35, v51
    v_accvgpr_read_b32 v48, a48
    v_accvgpr_read_b32 v49, a49
    v_accvgpr_read_b32 v50, a50
    v_accvgpr_read_b32 v51, a51
    v_mul_f32 v48, v48, v57
    v_mul_f32 v49, v49, v57
    v_mul_f32 v50, v50, v57
    v_mul_f32 v51, v51, v57
    v_accvgpr_write_b32 a48, v48
    v_accvgpr_write_b32 a49, v49
    v_accvgpr_write_b32 a50, v50
    v_accvgpr_write_b32 a51, v51
    v_accvgpr_read_b32 v48, a64
    v_accvgpr_read_b32 v49, a65
    v_accvgpr_read_b32 v50, a66
    v_accvgpr_read_b32 v51, a67
    v_mul_f32 v48, v48, v57
    v_mul_f32 v49, v49, v57
    v_mul_f32 v50, v50, v57
    v_mul_f32 v51, v51, v57
    v_accvgpr_write_b32 a64, v48
    v_accvgpr_write_b32 a65, v49
    v_accvgpr_write_b32 a66, v50
    v_accvgpr_write_b32 a67, v51
    v_accvgpr_read_b32 v48, a80
    v_accvgpr_read_b32 v49, a81
    v_accvgpr_read_b32 v50, a82
    v_accvgpr_read_b32 v51, a83
    v_mul_f32 v48, v48, v57
    v_mul_f32 v49, v49, v57
    v_mul_f32 v50, v50, v57
    v_mul_f32 v51, v51, v57
    v_accvgpr_write_b32 a80, v48
    v_accvgpr_write_b32 a81, v49
    v_accvgpr_write_b32 a82, v50
    v_accvgpr_write_b32 a83, v51
    v_accvgpr_read_b32 v48, a96
    v_accvgpr_read_b32 v49, a97
    v_accvgpr_read_b32 v50, a98
    v_accvgpr_read_b32 v51, a99
    v_mul_f32 v48, v48, v57
    v_mul_f32 v49, v49, v57
    v_mul_f32 v50, v50, v57
    v_mul_f32 v51, v51, v57
    v_accvgpr_write_b32 a96, v48
    v_accvgpr_write_b32 a97, v49
    v_accvgpr_write_b32 a98, v50
    v_accvgpr_write_b32 a99, v51
    v_accvgpr_read_b32 v48, a112
    v_accvgpr_read_b32 v49, a113
    v_accvgpr_read_b32 v50, a114
    v_accvgpr_read_b32 v51, a115
    v_mul_f32 v48, v48, v57
    v_mul_f32 v49, v49, v57
    v_mul_f32 v50, v50, v57
    v_mul_f32 v51, v51, v57
    v_accvgpr_write_b32 a112, v48
    v_accvgpr_write_b32 a113, v49
    v_accvgpr_write_b32 a114, v50
    v_accvgpr_write_b32 a115, v51
    v_accvgpr_read_b32 v48, a128
    v_accvgpr_read_b32 v49, a129
    v_accvgpr_read_b32 v50, a130
    v_accvgpr_read_b32 v51, a131
    v_mul_f32 v48, v48, v57
    v_mul_f32 v49, v49, v57
    v_mul_f32 v50, v50, v57
    v_mul_f32 v51, v51, v57
    v_accvgpr_write_b32 a128, v48
    v_accvgpr_write_b32 a129, v49
    v_accvgpr_write_b32 a130, v50
    v_accvgpr_write_b32 a131, v51
    v_accvgpr_read_b32 v48, a144
    v_accvgpr_read_b32 v49, a145
    v_accvgpr_read_b32 v50, a146
    v_accvgpr_read_b32 v51, a147
    v_mul_f32 v48, v48, v57
    v_mul_f32 v49, v49, v57
    v_mul_f32 v50, v50, v57
    v_mul_f32 v51, v51, v57
    v_accvgpr_write_b32 a144, v48
    v_accvgpr_write_b32 a145, v49
    v_accvgpr_write_b32 a146, v50
    v_accvgpr_write_b32 a147, v51
    v_accvgpr_read_b32 v48, a160
    v_accvgpr_read_b32 v49, a161
    v_accvgpr_read_b32 v50, a162
    v_accvgpr_read_b32 v51, a163
    v_mul_f32 v48, v48, v57
    v_mul_f32 v49, v49, v57
    v_mul_f32 v50, v50, v57
    v_mul_f32 v51, v51, v57
    v_accvgpr_write_b32 a160, v48
    v_accvgpr_write_b32 a161, v49
    v_accvgpr_write_b32 a162, v50
    v_accvgpr_write_b32 a163, v51
    v_accvgpr_read_b32 v48, a176
    v_accvgpr_read_b32 v49, a177
    v_accvgpr_read_b32 v50, a178
    v_accvgpr_read_b32 v51, a179
    v_mul_f32 v48, v48, v57
    v_mul_f32 v49, v49, v57
    v_mul_f32 v50, v50, v57
    v_mul_f32 v51, v51, v57
    v_accvgpr_write_b32 a176, v48
    v_accvgpr_write_b32 a177, v49
    v_accvgpr_write_b32 a178, v50
    v_accvgpr_write_b32 a179, v51
    v_exp_f32 v48, v68
    v_exp_f32 v49, v69
    v_exp_f32 v50, v70
    v_exp_f32 v51, v71
    v_exp_f32 v52, v100
    v_exp_f32 v53, v101
    v_exp_f32 v54, v102
    v_exp_f32 v55, v103
    s_nop 0
    v_cvt_pk_bf16_f32 v196, v48, v49
    v_cvt_pk_bf16_f32 v197, v50, v51
    v_cvt_pk_bf16_f32 v198, v52, v53
    v_cvt_pk_bf16_f32 v199, v54, v55
    v_add_f32 v24, v48, v49
    v_add_f32 v24, v24, v50
    v_add_f32 v24, v24, v51
    v_add_f32 v24, v24, v52
    v_add_f32 v24, v24, v53
    v_add_f32 v24, v24, v54
    v_add_f32 v24, v24, v55
    v_max3_f32 v56, v76, v77, v78
    v_max3_f32 v56, v56, v79, v108
    v_max3_f32 v56, v56, v109, v110
    v_max3_f32 v56, v56, v111, 0
    v_mov_b32 v58, v56
    s_nop 1
    v_permlane16_swap_b32 v56, v58
    s_nop 1
    v_max_f32 v56, v56, v58
    v_mov_b32 v58, v56
    s_nop 1
    v_permlane32_swap_b32 v56, v58
    s_nop 1
    v_max_f32 v56, v56, v58
    v_exp_f32 v57, -v56
    v_sub_f32 v36, v36, v56
    v_sub_f32 v37, v37, v56
    v_sub_f32 v38, v38, v56
    v_sub_f32 v39, v39, v56
    v_mul_f32 v21, v21, v57
    v_sub_f32 v76, v76, v56
    v_sub_f32 v77, v77, v56
    v_sub_f32 v78, v78, v56
    v_sub_f32 v79, v79, v56
    v_sub_f32 v108, v108, v56
    v_sub_f32 v109, v109, v56
    v_sub_f32 v110, v110, v56
    v_sub_f32 v111, v111, v56
    v_sub_f32 v140, v140, v56
    v_sub_f32 v141, v141, v56
    v_sub_f32 v142, v142, v56
    v_sub_f32 v143, v143, v56
    v_sub_f32 v172, v172, v56
    v_sub_f32 v173, v173, v56
    v_sub_f32 v174, v174, v56
    v_sub_f32 v175, v175, v56
    v_accvgpr_read_b32 v48, a4
    v_accvgpr_read_b32 v49, a5
    v_accvgpr_read_b32 v50, a6
    v_accvgpr_read_b32 v51, a7
    v_mul_f32 v48, v48, v57
    v_mul_f32 v49, v49, v57
    v_mul_f32 v50, v50, v57
    v_mul_f32 v51, v51, v57
    v_accvgpr_write_b32 a4, v48
    v_accvgpr_write_b32 a5, v49
    v_accvgpr_write_b32 a6, v50
    v_accvgpr_write_b32 a7, v51
    v_accvgpr_read_b32 v48, a20
    v_accvgpr_read_b32 v49, a21
    v_accvgpr_read_b32 v50, a22
    v_accvgpr_read_b32 v51, a23
    v_mul_f32 v48, v48, v57
    v_mul_f32 v49, v49, v57
    v_mul_f32 v50, v50, v57
    v_mul_f32 v51, v51, v57
    v_accvgpr_write_b32 a20, v48
    v_accvgpr_write_b32 a21, v49
    v_accvgpr_write_b32 a22, v50
    v_accvgpr_write_b32 a23, v51
    v_accvgpr_read_b32 v48, a36
    v_accvgpr_read_b32 v49, a37
    v_accvgpr_read_b32 v50, a38
    v_accvgpr_read_b32 v51, a39
    v_mul_f32 v48, v48, v57
    v_mul_f32 v49, v49, v57
    v_mul_f32 v50, v50, v57
    v_mul_f32 v51, v51, v57
    v_accvgpr_write_b32 a36, v48
    v_accvgpr_write_b32 a37, v49
    v_accvgpr_write_b32 a38, v50
    v_accvgpr_write_b32 a39, v51
    v_accvgpr_read_b32 v48, a52
    v_accvgpr_read_b32 v49, a53
    v_accvgpr_read_b32 v50, a54
    v_accvgpr_read_b32 v51, a55
    v_mul_f32 v48, v48, v57
    v_mul_f32 v49, v49, v57
    v_mul_f32 v50, v50, v57
    v_mul_f32 v51, v51, v57
    v_accvgpr_write_b32 a52, v48
    v_accvgpr_write_b32 a53, v49
    v_accvgpr_write_b32 a54, v50
    v_accvgpr_write_b32 a55, v51
    v_accvgpr_read_b32 v48, a68
    v_accvgpr_read_b32 v49, a69
    v_accvgpr_read_b32 v50, a70
    v_accvgpr_read_b32 v51, a71
    v_mul_f32 v48, v48, v57
    v_mul_f32 v49, v49, v57
    v_mul_f32 v50, v50, v57
    v_mul_f32 v51, v51, v57
    v_accvgpr_write_b32 a68, v48
    v_accvgpr_write_b32 a69, v49
    v_accvgpr_write_b32 a70, v50
    v_accvgpr_write_b32 a71, v51
    v_accvgpr_read_b32 v48, a84
    v_accvgpr_read_b32 v49, a85
    v_accvgpr_read_b32 v50, a86
    v_accvgpr_read_b32 v51, a87
    v_mul_f32 v48, v48, v57
    v_mul_f32 v49, v49, v57
    v_mul_f32 v50, v50, v57
    v_mul_f32 v51, v51, v57
    v_accvgpr_write_b32 a84, v48
    v_accvgpr_write_b32 a85, v49
    v_accvgpr_write_b32 a86, v50
    v_accvgpr_write_b32 a87, v51
    v_accvgpr_read_b32 v48, a100
    v_accvgpr_read_b32 v49, a101
    v_accvgpr_read_b32 v50, a102
    v_accvgpr_read_b32 v51, a103
    v_mul_f32 v48, v48, v57
    v_mul_f32 v49, v49, v57
    v_mul_f32 v50, v50, v57
    v_mul_f32 v51, v51, v57
    v_accvgpr_write_b32 a100, v48
    v_accvgpr_write_b32 a101, v49
    v_accvgpr_write_b32 a102, v50
    v_accvgpr_write_b32 a103, v51
    v_accvgpr_read_b32 v48, a116
    v_accvgpr_read_b32 v49, a117
    v_accvgpr_read_b32 v50, a118
    v_accvgpr_read_b32 v51, a119
    v_mul_f32 v48, v48, v57
    v_mul_f32 v49, v49, v57
    v_mul_f32 v50, v50, v57
    v_mul_f32 v51, v51, v57
    v_accvgpr_write_b32 a116, v48
    v_accvgpr_write_b32 a117, v49
    v_accvgpr_write_b32 a118, v50
    v_accvgpr_write_b32 a119, v51
    v_accvgpr_read_b32 v48, a132
    v_accvgpr_read_b32 v49, a133
    v_accvgpr_read_b32 v50, a134
    v_accvgpr_read_b32 v51, a135
    v_mul_f32 v48, v48, v57
    v_mul_f32 v49, v49, v57
    v_mul_f32 v50, v50, v57
    v_mul_f32 v51, v51, v57
    v_accvgpr_write_b32 a132, v48
    v_accvgpr_write_b32 a133, v49
    v_accvgpr_write_b32 a134, v50
    v_accvgpr_write_b32 a135, v51
    v_accvgpr_read_b32 v48, a148
    v_accvgpr_read_b32 v49, a149
    v_accvgpr_read_b32 v50, a150
    v_accvgpr_read_b32 v51, a151
    v_mul_f32 v48, v48, v57
    v_mul_f32 v49, v49, v57
    v_mul_f32 v50, v50, v57
    v_mul_f32 v51, v51, v57
    v_accvgpr_write_b32 a148, v48
    v_accvgpr_write_b32 a149, v49
    v_accvgpr_write_b32 a150, v50
    v_accvgpr_write_b32 a151, v51
    v_accvgpr_read_b32 v48, a164
    v_accvgpr_read_b32 v49, a165
    v_accvgpr_read_b32 v50, a166
    v_accvgpr_read_b32 v51, a167
    v_mul_f32 v48, v48, v57
    v_mul_f32 v49, v49, v57
    v_mul_f32 v50, v50, v57
    v_mul_f32 v51, v51, v57
    v_accvgpr_write_b32 a164, v48
    v_accvgpr_write_b32 a165, v49
    v_accvgpr_write_b32 a166, v50
    v_accvgpr_write_b32 a167, v51
    v_accvgpr_read_b32 v48, a180
    v_accvgpr_read_b32 v49, a181
    v_accvgpr_read_b32 v50, a182
    v_accvgpr_read_b32 v51, a183
    v_mul_f32 v48, v48, v57
    v_mul_f32 v49, v49, v57
    v_mul_f32 v50, v50, v57
    v_mul_f32 v51, v51, v57
    v_accvgpr_write_b32 a180, v48
    v_accvgpr_write_b32 a181, v49
    v_accvgpr_write_b32 a182, v50
    v_accvgpr_write_b32 a183, v51
    v_exp_f32 v48, v76
    v_exp_f32 v49, v77
    v_exp_f32 v50, v78
    v_exp_f32 v51, v79
    v_exp_f32 v52, v108
    v_exp_f32 v53, v109
    v_exp_f32 v54, v110
    v_exp_f32 v55, v111
    s_nop 0
    v_cvt_pk_bf16_f32 v204, v48, v49
    v_cvt_pk_bf16_f32 v205, v50, v51
    v_cvt_pk_bf16_f32 v206, v52, v53
    v_cvt_pk_bf16_f32 v207, v54, v55
    v_add_f32 v25, v48, v49
    v_add_f32 v25, v25, v50
    v_add_f32 v25, v25, v51
    v_add_f32 v25, v25, v52
    v_add_f32 v25, v25, v53
    v_add_f32 v25, v25, v54
    v_add_f32 v25, v25, v55
    v_max3_f32 v56, v84, v85, v86
    v_max3_f32 v56, v56, v87, v116
    v_max3_f32 v56, v56, v117, v118
    v_max3_f32 v56, v56, v119, 0
    v_mov_b32 v58, v56
    s_nop 1
    v_permlane16_swap_b32 v56, v58
    s_nop 1
    v_max_f32 v56, v56, v58
    v_mov_b32 v58, v56
    s_nop 1
    v_permlane32_swap_b32 v56, v58
    s_nop 1
    v_max_f32 v56, v56, v58
    v_exp_f32 v57, -v56
    v_sub_f32 v40, v40, v56
    v_sub_f32 v41, v41, v56
    v_sub_f32 v42, v42, v56
    v_sub_f32 v43, v43, v56
    v_mul_f32 v22, v22, v57
    v_sub_f32 v84, v84, v56
    v_sub_f32 v85, v85, v56
    v_sub_f32 v86, v86, v56
    v_sub_f32 v87, v87, v56
    v_sub_f32 v116, v116, v56
    v_sub_f32 v117, v117, v56
    v_sub_f32 v118, v118, v56
    v_sub_f32 v119, v119, v56
    v_sub_f32 v148, v148, v56
    v_sub_f32 v149, v149, v56
    v_sub_f32 v150, v150, v56
    v_sub_f32 v151, v151, v56
    v_sub_f32 v180, v180, v56
    v_sub_f32 v181, v181, v56
    v_sub_f32 v182, v182, v56
    v_sub_f32 v183, v183, v56
    v_accvgpr_read_b32 v48, a8
    v_accvgpr_read_b32 v49, a9
    v_accvgpr_read_b32 v50, a10
    v_accvgpr_read_b32 v51, a11
    v_mul_f32 v48, v48, v57
    v_mul_f32 v49, v49, v57
    v_mul_f32 v50, v50, v57
    v_mul_f32 v51, v51, v57
    v_accvgpr_write_b32 a8, v48
    v_accvgpr_write_b32 a9, v49
    v_accvgpr_write_b32 a10, v50
    v_accvgpr_write_b32 a11, v51
    v_accvgpr_read_b32 v48, a24
    v_accvgpr_read_b32 v49, a25
    v_accvgpr_read_b32 v50, a26
    v_accvgpr_read_b32 v51, a27
    v_mul_f32 v48, v48, v57
    v_mul_f32 v49, v49, v57
    v_mul_f32 v50, v50, v57
    v_mul_f32 v51, v51, v57
    v_accvgpr_write_b32 a24, v48
    v_accvgpr_write_b32 a25, v49
    v_accvgpr_write_b32 a26, v50
    v_accvgpr_write_b32 a27, v51
    v_accvgpr_read_b32 v48, a40
    v_accvgpr_read_b32 v49, a41
    v_accvgpr_read_b32 v50, a42
    v_accvgpr_read_b32 v51, a43
    v_mul_f32 v48, v48, v57
    v_mul_f32 v49, v49, v57
    v_mul_f32 v50, v50, v57
    v_mul_f32 v51, v51, v57
    v_accvgpr_write_b32 a40, v48
    v_accvgpr_write_b32 a41, v49
    v_accvgpr_write_b32 a42, v50
    v_accvgpr_write_b32 a43, v51
    v_accvgpr_read_b32 v48, a56
    v_accvgpr_read_b32 v49, a57
    v_accvgpr_read_b32 v50, a58
    v_accvgpr_read_b32 v51, a59
    v_mul_f32 v48, v48, v57
    v_mul_f32 v49, v49, v57
    v_mul_f32 v50, v50, v57
    v_mul_f32 v51, v51, v57
    v_accvgpr_write_b32 a56, v48
    v_accvgpr_write_b32 a57, v49
    v_accvgpr_write_b32 a58, v50
    v_accvgpr_write_b32 a59, v51
    v_accvgpr_read_b32 v48, a72
    v_accvgpr_read_b32 v49, a73
    v_accvgpr_read_b32 v50, a74
    v_accvgpr_read_b32 v51, a75
    v_mul_f32 v48, v48, v57
    v_mul_f32 v49, v49, v57
    v_mul_f32 v50, v50, v57
    v_mul_f32 v51, v51, v57
    v_accvgpr_write_b32 a72, v48
    v_accvgpr_write_b32 a73, v49
    v_accvgpr_write_b32 a74, v50
    v_accvgpr_write_b32 a75, v51
    v_accvgpr_read_b32 v48, a88
    v_accvgpr_read_b32 v49, a89
    v_accvgpr_read_b32 v50, a90
    v_accvgpr_read_b32 v51, a91
    v_mul_f32 v48, v48, v57
    v_mul_f32 v49, v49, v57
    v_mul_f32 v50, v50, v57
    v_mul_f32 v51, v51, v57
    v_accvgpr_write_b32 a88, v48
    v_accvgpr_write_b32 a89, v49
    v_accvgpr_write_b32 a90, v50
    v_accvgpr_write_b32 a91, v51
    v_accvgpr_read_b32 v48, a104
    v_accvgpr_read_b32 v49, a105
    v_accvgpr_read_b32 v50, a106
    v_accvgpr_read_b32 v51, a107
    v_mul_f32 v48, v48, v57
    v_mul_f32 v49, v49, v57
    v_mul_f32 v50, v50, v57
    v_mul_f32 v51, v51, v57
    v_accvgpr_write_b32 a104, v48
    v_accvgpr_write_b32 a105, v49
    v_accvgpr_write_b32 a106, v50
    v_accvgpr_write_b32 a107, v51
    v_accvgpr_read_b32 v48, a120
    v_accvgpr_read_b32 v49, a121
    v_accvgpr_read_b32 v50, a122
    v_accvgpr_read_b32 v51, a123
    v_mul_f32 v48, v48, v57
    v_mul_f32 v49, v49, v57
    v_mul_f32 v50, v50, v57
    v_mul_f32 v51, v51, v57
    v_accvgpr_write_b32 a120, v48
    v_accvgpr_write_b32 a121, v49
    v_accvgpr_write_b32 a122, v50
    v_accvgpr_write_b32 a123, v51
    v_accvgpr_read_b32 v48, a136
    v_accvgpr_read_b32 v49, a137
    v_accvgpr_read_b32 v50, a138
    v_accvgpr_read_b32 v51, a139
    v_mul_f32 v48, v48, v57
    v_mul_f32 v49, v49, v57
    v_mul_f32 v50, v50, v57
    v_mul_f32 v51, v51, v57
    v_accvgpr_write_b32 a136, v48
    v_accvgpr_write_b32 a137, v49
    v_accvgpr_write_b32 a138, v50
    v_accvgpr_write_b32 a139, v51
    v_accvgpr_read_b32 v48, a152
    v_accvgpr_read_b32 v49, a153
    v_accvgpr_read_b32 v50, a154
    v_accvgpr_read_b32 v51, a155
    v_mul_f32 v48, v48, v57
    v_mul_f32 v49, v49, v57
    v_mul_f32 v50, v50, v57
    v_mul_f32 v51, v51, v57
    v_accvgpr_write_b32 a152, v48
    v_accvgpr_write_b32 a153, v49
    v_accvgpr_write_b32 a154, v50
    v_accvgpr_write_b32 a155, v51
    v_accvgpr_read_b32 v48, a168
    v_accvgpr_read_b32 v49, a169
    v_accvgpr_read_b32 v50, a170
    v_accvgpr_read_b32 v51, a171
    v_mul_f32 v48, v48, v57
    v_mul_f32 v49, v49, v57
    v_mul_f32 v50, v50, v57
    v_mul_f32 v51, v51, v57
    v_accvgpr_write_b32 a168, v48
    v_accvgpr_write_b32 a169, v49
    v_accvgpr_write_b32 a170, v50
    v_accvgpr_write_b32 a171, v51
    v_accvgpr_read_b32 v48, a184
    v_accvgpr_read_b32 v49, a185
    v_accvgpr_read_b32 v50, a186
    v_accvgpr_read_b32 v51, a187
    v_mul_f32 v48, v48, v57
    v_mul_f32 v49, v49, v57
    v_mul_f32 v50, v50, v57
    v_mul_f32 v51, v51, v57
    v_accvgpr_write_b32 a184, v48
    v_accvgpr_write_b32 a185, v49
    v_accvgpr_write_b32 a186, v50
    v_accvgpr_write_b32 a187, v51
    v_exp_f32 v48, v84
    v_exp_f32 v49, v85
    v_exp_f32 v50, v86
    v_exp_f32 v51, v87
    v_exp_f32 v52, v116
    v_exp_f32 v53, v117
    v_exp_f32 v54, v118
    v_exp_f32 v55, v119
    s_nop 0
    v_cvt_pk_bf16_f32 v212, v48, v49
    v_cvt_pk_bf16_f32 v213, v50, v51
    v_cvt_pk_bf16_f32 v214, v52, v53
    v_cvt_pk_bf16_f32 v215, v54, v55
    v_add_f32 v26, v48, v49
    v_add_f32 v26, v26, v50
    v_add_f32 v26, v26, v51
    v_add_f32 v26, v26, v52
    v_add_f32 v26, v26, v53
    v_add_f32 v26, v26, v54
    v_add_f32 v26, v26, v55
    v_max3_f32 v56, v92, v93, v94
    v_max3_f32 v56, v56, v95, v124
    v_max3_f32 v56, v56, v125, v126
    v_max3_f32 v56, v56, v127, 0
    v_mov_b32 v58, v56
    s_nop 1
    v_permlane16_swap_b32 v56, v58
    s_nop 1
    v_max_f32 v56, v56, v58
    v_mov_b32 v58, v56
    s_nop 1
    v_permlane32_swap_b32 v56, v58
    s_nop 1
    v_max_f32 v56, v56, v58
    v_exp_f32 v57, -v56
    v_sub_f32 v44, v44, v56
    v_sub_f32 v45, v45, v56
    v_sub_f32 v46, v46, v56
    v_sub_f32 v47, v47, v56
    v_mul_f32 v23, v23, v57
    v_sub_f32 v92, v92, v56
    v_sub_f32 v93, v93, v56
    v_sub_f32 v94, v94, v56
    v_sub_f32 v95, v95, v56
    v_sub_f32 v124, v124, v56
    v_sub_f32 v125, v125, v56
    v_sub_f32 v126, v126, v56
    v_sub_f32 v127, v127, v56
    v_sub_f32 v156, v156, v56
    v_sub_f32 v157, v157, v56
    v_sub_f32 v158, v158, v56
    v_sub_f32 v159, v159, v56
    v_sub_f32 v188, v188, v56
    v_sub_f32 v189, v189, v56
    v_sub_f32 v190, v190, v56
    v_sub_f32 v191, v191, v56
    v_accvgpr_read_b32 v48, a12
    v_accvgpr_read_b32 v49, a13
    v_accvgpr_read_b32 v50, a14
    v_accvgpr_read_b32 v51, a15
    v_mul_f32 v48, v48, v57
    v_mul_f32 v49, v49, v57
    v_mul_f32 v50, v50, v57
    v_mul_f32 v51, v51, v57
    v_accvgpr_write_b32 a12, v48
    v_accvgpr_write_b32 a13, v49
    v_accvgpr_write_b32 a14, v50
    v_accvgpr_write_b32 a15, v51
    v_accvgpr_read_b32 v48, a28
    v_accvgpr_read_b32 v49, a29
    v_accvgpr_read_b32 v50, a30
    v_accvgpr_read_b32 v51, a31
    v_mul_f32 v48, v48, v57
    v_mul_f32 v49, v49, v57
    v_mul_f32 v50, v50, v57
    v_mul_f32 v51, v51, v57
    v_accvgpr_write_b32 a28, v48
    v_accvgpr_write_b32 a29, v49
    v_accvgpr_write_b32 a30, v50
    v_accvgpr_write_b32 a31, v51
    v_accvgpr_read_b32 v48, a44
    v_accvgpr_read_b32 v49, a45
    v_accvgpr_read_b32 v50, a46
    v_accvgpr_read_b32 v51, a47
    v_mul_f32 v48, v48, v57
    v_mul_f32 v49, v49, v57
    v_mul_f32 v50, v50, v57
    v_mul_f32 v51, v51, v57
    v_accvgpr_write_b32 a44, v48
    v_accvgpr_write_b32 a45, v49
    v_accvgpr_write_b32 a46, v50
    v_accvgpr_write_b32 a47, v51
    v_accvgpr_read_b32 v48, a60
    v_accvgpr_read_b32 v49, a61
    v_accvgpr_read_b32 v50, a62
    v_accvgpr_read_b32 v51, a63
    v_mul_f32 v48, v48, v57
    v_mul_f32 v49, v49, v57
    v_mul_f32 v50, v50, v57
    v_mul_f32 v51, v51, v57
    v_accvgpr_write_b32 a60, v48
    v_accvgpr_write_b32 a61, v49
    v_accvgpr_write_b32 a62, v50
    v_accvgpr_write_b32 a63, v51
    v_accvgpr_read_b32 v48, a76
    v_accvgpr_read_b32 v49, a77
    v_accvgpr_read_b32 v50, a78
    v_accvgpr_read_b32 v51, a79
    v_mul_f32 v48, v48, v57
    v_mul_f32 v49, v49, v57
    v_mul_f32 v50, v50, v57
    v_mul_f32 v51, v51, v57
    v_accvgpr_write_b32 a76, v48
    v_accvgpr_write_b32 a77, v49
    v_accvgpr_write_b32 a78, v50
    v_accvgpr_write_b32 a79, v51
    v_accvgpr_read_b32 v48, a92
    v_accvgpr_read_b32 v49, a93
    v_accvgpr_read_b32 v50, a94
    v_accvgpr_read_b32 v51, a95
    v_mul_f32 v48, v48, v57
    v_mul_f32 v49, v49, v57
    v_mul_f32 v50, v50, v57
    v_mul_f32 v51, v51, v57
    v_accvgpr_write_b32 a92, v48
    v_accvgpr_write_b32 a93, v49
    v_accvgpr_write_b32 a94, v50
    v_accvgpr_write_b32 a95, v51
    v_accvgpr_read_b32 v48, a108
    v_accvgpr_read_b32 v49, a109
    v_accvgpr_read_b32 v50, a110
    v_accvgpr_read_b32 v51, a111
    v_mul_f32 v48, v48, v57
    v_mul_f32 v49, v49, v57
    v_mul_f32 v50, v50, v57
    v_mul_f32 v51, v51, v57
    v_accvgpr_write_b32 a108, v48
    v_accvgpr_write_b32 a109, v49
    v_accvgpr_write_b32 a110, v50
    v_accvgpr_write_b32 a111, v51
    v_accvgpr_read_b32 v48, a124
    v_accvgpr_read_b32 v49, a125
    v_accvgpr_read_b32 v50, a126
    v_accvgpr_read_b32 v51, a127
    v_mul_f32 v48, v48, v57
    v_mul_f32 v49, v49, v57
    v_mul_f32 v50, v50, v57
    v_mul_f32 v51, v51, v57
    v_accvgpr_write_b32 a124, v48
    v_accvgpr_write_b32 a125, v49
    v_accvgpr_write_b32 a126, v50
    v_accvgpr_write_b32 a127, v51
    v_accvgpr_read_b32 v48, a140
    v_accvgpr_read_b32 v49, a141
    v_accvgpr_read_b32 v50, a142
    v_accvgpr_read_b32 v51, a143
    v_mul_f32 v48, v48, v57
    v_mul_f32 v49, v49, v57
    v_mul_f32 v50, v50, v57
    v_mul_f32 v51, v51, v57
    v_accvgpr_write_b32 a140, v48
    v_accvgpr_write_b32 a141, v49
    v_accvgpr_write_b32 a142, v50
    v_accvgpr_write_b32 a143, v51
    v_accvgpr_read_b32 v48, a156
    v_accvgpr_read_b32 v49, a157
    v_accvgpr_read_b32 v50, a158
    v_accvgpr_read_b32 v51, a159
    v_mul_f32 v48, v48, v57
    v_mul_f32 v49, v49, v57
    v_mul_f32 v50, v50, v57
    v_mul_f32 v51, v51, v57
    v_accvgpr_write_b32 a156, v48
    v_accvgpr_write_b32 a157, v49
    v_accvgpr_write_b32 a158, v50
    v_accvgpr_write_b32 a159, v51
    v_accvgpr_read_b32 v48, a172
    v_accvgpr_read_b32 v49, a173
    v_accvgpr_read_b32 v50, a174
    v_accvgpr_read_b32 v51, a175
    v_mul_f32 v48, v48, v57
    v_mul_f32 v49, v49, v57
    v_mul_f32 v50, v50, v57
    v_mul_f32 v51, v51, v57
    v_accvgpr_write_b32 a172, v48
    v_accvgpr_write_b32 a173, v49
    v_accvgpr_write_b32 a174, v50
    v_accvgpr_write_b32 a175, v51
    v_accvgpr_read_b32 v48, a188
    v_accvgpr_read_b32 v49, a189
    v_accvgpr_read_b32 v50, a190
    v_accvgpr_read_b32 v51, a191
    v_mul_f32 v48, v48, v57
    v_mul_f32 v49, v49, v57
    v_mul_f32 v50, v50, v57
    v_mul_f32 v51, v51, v57
    v_accvgpr_write_b32 a188, v48
    v_accvgpr_write_b32 a189, v49
    v_accvgpr_write_b32 a190, v50
    v_accvgpr_write_b32 a191, v51
    v_exp_f32 v48, v92
    v_exp_f32 v49, v93
    v_exp_f32 v50, v94
    v_exp_f32 v51, v95
    v_exp_f32 v52, v124
    v_exp_f32 v53, v125
    v_exp_f32 v54, v126
    v_exp_f32 v55, v127
    s_nop 0
    v_cvt_pk_bf16_f32 v220, v48, v49
    v_cvt_pk_bf16_f32 v221, v50, v51
    v_cvt_pk_bf16_f32 v222, v52, v53
    v_cvt_pk_bf16_f32 v223, v54, v55
    v_add_f32 v27, v48, v49
    v_add_f32 v27, v27, v50
    v_add_f32 v27, v27, v51
    v_add_f32 v27, v27, v52
    v_add_f32 v27, v27, v53
    v_add_f32 v27, v27, v54
    v_add_f32 v27, v27, v55
    s_nop 1
    s_branch rare_b_ret
rare_e:
    s_nop 7
    s_nop 7
    v_max3_f32 v56, v132, v133, v134
    v_max3_f32 v56, v56, v135, v164
    v_max3_f32 v56, v56, v165, v166
    v_max3_f32 v56, v56, v167, 0
    v_mov_b32 v58, v56
    s_nop 1
    v_permlane16_swap_b32 v56, v58
    s_nop 1
    v_max_f32 v56, v56, v58
    v_mov_b32 v58, v56
    s_nop 1
    v_permlane32_swap_b32 v56, v58
    s_nop 1
    v_max_f32 v56, v56, v58
    v_exp_f32 v57, -v56
    v_sub_f32 v32, v32, v56
    v_sub_f32 v33, v33, v56
    v_sub_f32 v34, v34, v56
    v_sub_f32 v35, v35, v56
    v_mul_f32 v20, v20, v57
    v_sub_f32 v132, v132, v56
    v_sub_f32 v133, v133, v56
    v_sub_f32 v134, v134, v56
    v_sub_f32 v135, v135, v56
    v_sub_f32 v164, v164, v56
    v_sub_f32 v165, v165, v56
    v_sub_f32 v166, v166, v56
    v_sub_f32 v167, v167, v56
    v_accvgpr_read_b32 v48, a0
    v_accvgpr_read_b32 v49, a1
    v_accvgpr_read_b32 v50, a2
    v_accvgpr_read_b32 v51, a3
    v_mul_f32 v48, v48, v57
    v_mul_f32 v49, v49, v57
    v_mul_f32 v50, v50, v57
    v_mul_f32 v51, v51, v57
    v_accvgpr_write_b32 a0, v48
    v_accvgpr_write_b32 a1, v49
    v_accvgpr_write_b32 a2, v50
    v_accvgpr_write_b32 a3, v51
    v_accvgpr_read_b32 v48, a16
    v_accvgpr_read_b32 v49, a17
    v_accvgpr_read_b32 v50, a18
    v_accvgpr_read_b32 v51, a19
    v_mul_f32 v48, v48, v57
    v_mul_f32 v49, v49, v57
    v_mul_f32 v50, v50, v57
    v_mul_f32 v51, v51, v57
    v_accvgpr_write_b32 a16, v48
    v_accvgpr_write_b32 a17, v49
    v_accvgpr_write_b32 a18, v50
    v_accvgpr_write_b32 a19, v51
    v_accvgpr_read_b32 v48, a32
    v_accvgpr_read_b32 v49, a33
    v_accvgpr_read_b32 v50, a34
    v_accvgpr_read_b32 v51, a35
    v_mul_f32 v48, v48, v57
    v_mul_f32 v49, v49, v57
    v_mul_f32 v50, v50, v57
    v_mul_f32 v51, v51, v57
    v_accvgpr_write_b32 a32, v48
    v_accvgpr_write_b32 a33, v49
    v_accvgpr_write_b32 a34, v50
    v_accvgpr_write_b32 a35, v51
    v_accvgpr_read_b32 v48, a48
    v_accvgpr_read_b32 v49, a49
    v_accvgpr_read_b32 v50, a50
    v_accvgpr_read_b32 v51, a51
    v_mul_f32 v48, v48, v57
    v_mul_f32 v49, v49, v57
    v_mul_f32 v50, v50, v57
    v_mul_f32 v51, v51, v57
    v_accvgpr_write_b32 a48, v48
    v_accvgpr_write_b32 a49, v49
    v_accvgpr_write_b32 a50, v50
    v_accvgpr_write_b32 a51, v51
    v_accvgpr_read_b32 v48, a64
    v_accvgpr_read_b32 v49, a65
    v_accvgpr_read_b32 v50, a66
    v_accvgpr_read_b32 v51, a67
    v_mul_f32 v48, v48, v57
    v_mul_f32 v49, v49, v57
    v_mul_f32 v50, v50, v57
    v_mul_f32 v51, v51, v57
    v_accvgpr_write_b32 a64, v48
    v_accvgpr_write_b32 a65, v49
    v_accvgpr_write_b32 a66, v50
    v_accvgpr_write_b32 a67, v51
    v_accvgpr_read_b32 v48, a80
    v_accvgpr_read_b32 v49, a81
    v_accvgpr_read_b32 v50, a82
    v_accvgpr_read_b32 v51, a83
    v_mul_f32 v48, v48, v57
    v_mul_f32 v49, v49, v57
    v_mul_f32 v50, v50, v57
    v_mul_f32 v51, v51, v57
    v_accvgpr_write_b32 a80, v48
    v_accvgpr_write_b32 a81, v49
    v_accvgpr_write_b32 a82, v50
    v_accvgpr_write_b32 a83, v51
    v_accvgpr_read_b32 v48, a96
    v_accvgpr_read_b32 v49, a97
    v_accvgpr_read_b32 v50, a98
    v_accvgpr_read_b32 v51, a99
    v_mul_f32 v48, v48, v57
    v_mul_f32 v49, v49, v57
    v_mul_f32 v50, v50, v57
    v_mul_f32 v51, v51, v57
    v_accvgpr_write_b32 a96, v48
    v_accvgpr_write_b32 a97, v49
    v_accvgpr_write_b32 a98, v50
    v_accvgpr_write_b32 a99, v51
    v_accvgpr_read_b32 v48, a112
    v_accvgpr_read_b32 v49, a113
    v_accvgpr_read_b32 v50, a114
    v_accvgpr_read_b32 v51, a115
    v_mul_f32 v48, v48, v57
    v_mul_f32 v49, v49, v57
    v_mul_f32 v50, v50, v57
    v_mul_f32 v51, v51, v57
    v_accvgpr_write_b32 a112, v48
    v_accvgpr_write_b32 a113, v49
    v_accvgpr_write_b32 a114, v50
    v_accvgpr_write_b32 a115, v51
    v_accvgpr_read_b32 v48, a128
    v_accvgpr_read_b32 v49, a129
    v_accvgpr_read_b32 v50, a130
    v_accvgpr_read_b32 v51, a131
    v_mul_f32 v48, v48, v57
    v_mul_f32 v49, v49, v57
    v_mul_f32 v50, v50, v57
    v_mul_f32 v51, v51, v57
    v_accvgpr_write_b32 a128, v48
    v_accvgpr_write_b32 a129, v49
    v_accvgpr_write_b32 a130, v50
    v_accvgpr_write_b32 a131, v51
    v_accvgpr_read_b32 v48, a144
    v_accvgpr_read_b32 v49, a145
    v_accvgpr_read_b32 v50, a146
    v_accvgpr_read_b32 v51, a147
    v_mul_f32 v48, v48, v57
    v_mul_f32 v49, v49, v57
    v_mul_f32 v50, v50, v57
    v_mul_f32 v51, v51, v57
    v_accvgpr_write_b32 a144, v48
    v_accvgpr_write_b32 a145, v49
    v_accvgpr_write_b32 a146, v50
    v_accvgpr_write_b32 a147, v51
    v_accvgpr_read_b32 v48, a160
    v_accvgpr_read_b32 v49, a161
    v_accvgpr_read_b32 v50, a162
    v_accvgpr_read_b32 v51, a163
    v_mul_f32 v48, v48, v57
    v_mul_f32 v49, v49, v57
    v_mul_f32 v50, v50, v57
    v_mul_f32 v51, v51, v57
    v_accvgpr_write_b32 a160, v48
    v_accvgpr_write_b32 a161, v49
    v_accvgpr_write_b32 a162, v50
    v_accvgpr_write_b32 a163, v51
    v_accvgpr_read_b32 v48, a176
    v_accvgpr_read_b32 v49, a177
    v_accvgpr_read_b32 v50, a178
    v_accvgpr_read_b32 v51, a179
    v_mul_f32 v48, v48, v57
    v_mul_f32 v49, v49, v57
    v_mul_f32 v50, v50, v57
    v_mul_f32 v51, v51, v57
    v_accvgpr_write_b32 a176, v48
    v_accvgpr_write_b32 a177, v49
    v_accvgpr_write_b32 a178, v50
    v_accvgpr_write_b32 a179, v51
    v_exp_f32 v48, v132
    v_exp_f32 v49, v133
    v_exp_f32 v50, v134
    v_exp_f32 v51, v135
    v_exp_f32 v52, v164
    v_exp_f32 v53, v165
    v_exp_f32 v54, v166
    v_exp_f32 v55, v167
    s_nop 0
    v_cvt_pk_bf16_f32 v228, v48, v49
    v_cvt_pk_bf16_f32 v229, v50, v51
    v_cvt_pk_bf16_f32 v230, v52, v53
    v_cvt_pk_bf16_f32 v231, v54, v55
    v_add_f32 v24, v48, v49
    v_add_f32 v24, v24, v50
    v_add_f32 v24, v24, v51
    v_add_f32 v24, v24, v52
    v_add_f32 v24, v24, v53
    v_add_f32 v24, v24, v54
    v_add_f32 v24, v24, v55
    v_max3_f32 v56, v140, v141, v142
    v_max3_f32 v56, v56, v143, v172
    v_max3_f32 v56, v56, v173, v174
    v_max3_f32 v56, v56, v175, 0
    v_mov_b32 v58, v56
    s_nop 1
    v_permlane16_swap_b32 v56, v58
    s_nop 1
    v_max_f32 v56, v56, v58
    v_mov_b32 v58, v56
    s_nop 1
    v_permlane32_swap_b32 v56, v58
    s_nop 1
    v_max_f32 v56, v56, v58
    v_exp_f32 v57, -v56
    v_sub_f32 v36, v36, v56
    v_sub_f32 v37, v37, v56
    v_sub_f32 v38, v38, v56
    v_sub_f32 v39, v39, v56
    v_mul_f32 v21, v21, v57
    v_sub_f32 v140, v140, v56
    v_sub_f32 v141, v141, v56
    v_sub_f32 v142, v142, v56
    v_sub_f32 v143, v143, v56
    v_sub_f32 v172, v172, v56
    v_sub_f32 v173, v173, v56
    v_sub_f32 v174, v174, v56
    v_sub_f32 v175, v175, v56
    v_accvgpr_read_b32 v48, a4
    v_accvgpr_read_b32 v49, a5
    v_accvgpr_read_b32 v50, a6
    v_accvgpr_read_b32 v51, a7
    v_mul_f32 v48, v48, v57
    v_mul_f32 v49, v49, v57
    v_mul_f32 v50, v50, v57
    v_mul_f32 v51, v51, v57
    v_accvgpr_write_b32 a4, v48
    v_accvgpr_write_b32 a5, v49
    v_accvgpr_write_b32 a6, v50
    v_accvgpr_write_b32 a7, v51
    v_accvgpr_read_b32 v48, a20
    v_accvgpr_read_b32 v49, a21
    v_accvgpr_read_b32 v50, a22
    v_accvgpr_read_b32 v51, a23
    v_mul_f32 v48, v48, v57
    v_mul_f32 v49, v49, v57
    v_mul_f32 v50, v50, v57
    v_mul_f32 v51, v51, v57
    v_accvgpr_write_b32 a20, v48
    v_accvgpr_write_b32 a21, v49
    v_accvgpr_write_b32 a22, v50
    v_accvgpr_write_b32 a23, v51
    v_accvgpr_read_b32 v48, a36
    v_accvgpr_read_b32 v49, a37
    v_accvgpr_read_b32 v50, a38
    v_accvgpr_read_b32 v51, a39
    v_mul_f32 v48, v48, v57
    v_mul_f32 v49, v49, v57
    v_mul_f32 v50, v50, v57
    v_mul_f32 v51, v51, v57
    v_accvgpr_write_b32 a36, v48
    v_accvgpr_write_b32 a37, v49
    v_accvgpr_write_b32 a38, v50
    v_accvgpr_write_b32 a39, v51
    v_accvgpr_read_b32 v48, a52
    v_accvgpr_read_b32 v49, a53
    v_accvgpr_read_b32 v50, a54
    v_accvgpr_read_b32 v51, a55
    v_mul_f32 v48, v48, v57
    v_mul_f32 v49, v49, v57
    v_mul_f32 v50, v50, v57
    v_mul_f32 v51, v51, v57
    v_accvgpr_write_b32 a52, v48
    v_accvgpr_write_b32 a53, v49
    v_accvgpr_write_b32 a54, v50
    v_accvgpr_write_b32 a55, v51
    v_accvgpr_read_b32 v48, a68
    v_accvgpr_read_b32 v49, a69
    v_accvgpr_read_b32 v50, a70
    v_accvgpr_read_b32 v51, a71
    v_mul_f32 v48, v48, v57
    v_mul_f32 v49, v49, v57
    v_mul_f32 v50, v50, v57
    v_mul_f32 v51, v51, v57
    v_accvgpr_write_b32 a68, v48
    v_accvgpr_write_b32 a69, v49
    v_accvgpr_write_b32 a70, v50
    v_accvgpr_write_b32 a71, v51
    v_accvgpr_read_b32 v48, a84
    v_accvgpr_read_b32 v49, a85
    v_accvgpr_read_b32 v50, a86
    v_accvgpr_read_b32 v51, a87
    v_mul_f32 v48, v48, v57
    v_mul_f32 v49, v49, v57
    v_mul_f32 v50, v50, v57
    v_mul_f32 v51, v51, v57
    v_accvgpr_write_b32 a84, v48
    v_accvgpr_write_b32 a85, v49
    v_accvgpr_write_b32 a86, v50
    v_accvgpr_write_b32 a87, v51
    v_accvgpr_read_b32 v48, a100
    v_accvgpr_read_b32 v49, a101
    v_accvgpr_read_b32 v50, a102
    v_accvgpr_read_b32 v51, a103
    v_mul_f32 v48, v48, v57
    v_mul_f32 v49, v49, v57
    v_mul_f32 v50, v50, v57
    v_mul_f32 v51, v51, v57
    v_accvgpr_write_b32 a100, v48
    v_accvgpr_write_b32 a101, v49
    v_accvgpr_write_b32 a102, v50
    v_accvgpr_write_b32 a103, v51
    v_accvgpr_read_b32 v48, a116
    v_accvgpr_read_b32 v49, a117
    v_accvgpr_read_b32 v50, a118
    v_accvgpr_read_b32 v51, a119
    v_mul_f32 v48, v48, v57
    v_mul_f32 v49, v49, v57
    v_mul_f32 v50, v50, v57
    v_mul_f32 v51, v51, v57
    v_accvgpr_write_b32 a116, v48
    v_accvgpr_write_b32 a117, v49
    v_accvgpr_write_b32 a118, v50
    v_accvgpr_write_b32 a119, v51
    v_accvgpr_read_b32 v48, a132
    v_accvgpr_read_b32 v49, a133
    v_accvgpr_read_b32 v50, a134
    v_accvgpr_read_b32 v51, a135
    v_mul_f32 v48, v48, v57
    v_mul_f32 v49, v49, v57
    v_mul_f32 v50, v50, v57
    v_mul_f32 v51, v51, v57
    v_accvgpr_write_b32 a132, v48
    v_accvgpr_write_b32 a133, v49
    v_accvgpr_write_b32 a134, v50
    v_accvgpr_write_b32 a135, v51
    v_accvgpr_read_b32 v48, a148
    v_accvgpr_read_b32 v49, a149
    v_accvgpr_read_b32 v50, a150
    v_accvgpr_read_b32 v51, a151
    v_mul_f32 v48, v48, v57
    v_mul_f32 v49, v49, v57
    v_mul_f32 v50, v50, v57
    v_mul_f32 v51, v51, v57
    v_accvgpr_write_b32 a148, v48
    v_accvgpr_write_b32 a149, v49
    v_accvgpr_write_b32 a150, v50
    v_accvgpr_write_b32 a151, v51
    v_accvgpr_read_b32 v48, a164
    v_accvgpr_read_b32 v49, a165
    v_accvgpr_read_b32 v50, a166
    v_accvgpr_read_b32 v51, a167
    v_mul_f32 v48, v48, v57
    v_mul_f32 v49, v49, v57
    v_mul_f32 v50, v50, v57
    v_mul_f32 v51, v51, v57
    v_accvgpr_write_b32 a164, v48
    v_accvgpr_write_b32 a165, v49
    v_accvgpr_write_b32 a166, v50
    v_accvgpr_write_b32 a167, v51
    v_accvgpr_read_b32 v48, a180
    v_accvgpr_read_b32 v49, a181
    v_accvgpr_read_b32 v50, a182
    v_accvgpr_read_b32 v51, a183
    v_mul_f32 v48, v48, v57
    v_mul_f32 v49, v49, v57
    v_mul_f32 v50, v50, v57
    v_mul_f32 v51, v51, v57
    v_accvgpr_write_b32 a180, v48
    v_accvgpr_write_b32 a181, v49
    v_accvgpr_write_b32 a182, v50
    v_accvgpr_write_b32 a183, v51
    v_exp_f32 v48, v140
    v_exp_f32 v49, v141
    v_exp_f32 v50, v142
    v_exp_f32 v51, v143
    v_exp_f32 v52, v172
    v_exp_f32 v53, v173
    v_exp_f32 v54, v174
    v_exp_f32 v55, v175
    s_nop 0
    v_cvt_pk_bf16_f32 v236, v48, v49
    v_cvt_pk_bf16_f32 v237, v50, v51
    v_cvt_pk_bf16_f32 v238, v52, v53
    v_cvt_pk_bf16_f32 v239, v54, v55
    v_add_f32 v25, v48, v49
    v_add_f32 v25, v25, v50
    v_add_f32 v25, v25, v51
    v_add_f32 v25, v25, v52
    v_add_f32 v25, v25, v53
    v_add_f32 v25, v25, v54
    v_add_f32 v25, v25, v55
    v_max3_f32 v56, v148, v149, v150
    v_max3_f32 v56, v56, v151, v180
    v_max3_f32 v56, v56, v181, v182
    v_max3_f32 v56, v56, v183, 0
    v_mov_b32 v58, v56
    s_nop 1
    v_permlane16_swap_b32 v56, v58
    s_nop 1
    v_max_f32 v56, v56, v58
    v_mov_b32 v58, v56
    s_nop 1
    v_permlane32_swap_b32 v56, v58
    s_nop 1
    v_max_f32 v56, v56, v58
    v_exp_f32 v57, -v56
    v_sub_f32 v40, v40, v56
    v_sub_f32 v41, v41, v56
    v_sub_f32 v42, v42, v56
    v_sub_f32 v43, v43, v56
    v_mul_f32 v22, v22, v57
    v_sub_f32 v148, v148, v56
    v_sub_f32 v149, v149, v56
    v_sub_f32 v150, v150, v56
    v_sub_f32 v151, v151, v56
    v_sub_f32 v180, v180, v56
    v_sub_f32 v181, v181, v56
    v_sub_f32 v182, v182, v56
    v_sub_f32 v183, v183, v56
    v_accvgpr_read_b32 v48, a8
    v_accvgpr_read_b32 v49, a9
    v_accvgpr_read_b32 v50, a10
    v_accvgpr_read_b32 v51, a11
    v_mul_f32 v48, v48, v57
    v_mul_f32 v49, v49, v57
    v_mul_f32 v50, v50, v57
    v_mul_f32 v51, v51, v57
    v_accvgpr_write_b32 a8, v48
    v_accvgpr_write_b32 a9, v49
    v_accvgpr_write_b32 a10, v50
    v_accvgpr_write_b32 a11, v51
    v_accvgpr_read_b32 v48, a24
    v_accvgpr_read_b32 v49, a25
    v_accvgpr_read_b32 v50, a26
    v_accvgpr_read_b32 v51, a27
    v_mul_f32 v48, v48, v57
    v_mul_f32 v49, v49, v57
    v_mul_f32 v50, v50, v57
    v_mul_f32 v51, v51, v57
    v_accvgpr_write_b32 a24, v48
    v_accvgpr_write_b32 a25, v49
    v_accvgpr_write_b32 a26, v50
    v_accvgpr_write_b32 a27, v51
    v_accvgpr_read_b32 v48, a40
    v_accvgpr_read_b32 v49, a41
    v_accvgpr_read_b32 v50, a42
    v_accvgpr_read_b32 v51, a43
    v_mul_f32 v48, v48, v57
    v_mul_f32 v49, v49, v57
    v_mul_f32 v50, v50, v57
    v_mul_f32 v51, v51, v57
    v_accvgpr_write_b32 a40, v48
    v_accvgpr_write_b32 a41, v49
    v_accvgpr_write_b32 a42, v50
    v_accvgpr_write_b32 a43, v51
    v_accvgpr_read_b32 v48, a56
    v_accvgpr_read_b32 v49, a57
    v_accvgpr_read_b32 v50, a58
    v_accvgpr_read_b32 v51, a59
    v_mul_f32 v48, v48, v57
    v_mul_f32 v49, v49, v57
    v_mul_f32 v50, v50, v57
    v_mul_f32 v51, v51, v57
    v_accvgpr_write_b32 a56, v48
    v_accvgpr_write_b32 a57, v49
    v_accvgpr_write_b32 a58, v50
    v_accvgpr_write_b32 a59, v51
    v_accvgpr_read_b32 v48, a72
    v_accvgpr_read_b32 v49, a73
    v_accvgpr_read_b32 v50, a74
    v_accvgpr_read_b32 v51, a75
    v_mul_f32 v48, v48, v57
    v_mul_f32 v49, v49, v57
    v_mul_f32 v50, v50, v57
    v_mul_f32 v51, v51, v57
    v_accvgpr_write_b32 a72, v48
    v_accvgpr_write_b32 a73, v49
    v_accvgpr_write_b32 a74, v50
    v_accvgpr_write_b32 a75, v51
    v_accvgpr_read_b32 v48, a88
    v_accvgpr_read_b32 v49, a89
    v_accvgpr_read_b32 v50, a90
    v_accvgpr_read_b32 v51, a91
    v_mul_f32 v48, v48, v57
    v_mul_f32 v49, v49, v57
    v_mul_f32 v50, v50, v57
    v_mul_f32 v51, v51, v57
    v_accvgpr_write_b32 a88, v48
    v_accvgpr_write_b32 a89, v49
    v_accvgpr_write_b32 a90, v50
    v_accvgpr_write_b32 a91, v51
    v_accvgpr_read_b32 v48, a104
    v_accvgpr_read_b32 v49, a105
    v_accvgpr_read_b32 v50, a106
    v_accvgpr_read_b32 v51, a107
    v_mul_f32 v48, v48, v57
    v_mul_f32 v49, v49, v57
    v_mul_f32 v50, v50, v57
    v_mul_f32 v51, v51, v57
    v_accvgpr_write_b32 a104, v48
    v_accvgpr_write_b32 a105, v49
    v_accvgpr_write_b32 a106, v50
    v_accvgpr_write_b32 a107, v51
    v_accvgpr_read_b32 v48, a120
    v_accvgpr_read_b32 v49, a121
    v_accvgpr_read_b32 v50, a122
    v_accvgpr_read_b32 v51, a123
    v_mul_f32 v48, v48, v57
    v_mul_f32 v49, v49, v57
    v_mul_f32 v50, v50, v57
    v_mul_f32 v51, v51, v57
    v_accvgpr_write_b32 a120, v48
    v_accvgpr_write_b32 a121, v49
    v_accvgpr_write_b32 a122, v50
    v_accvgpr_write_b32 a123, v51
    v_accvgpr_read_b32 v48, a136
    v_accvgpr_read_b32 v49, a137
    v_accvgpr_read_b32 v50, a138
    v_accvgpr_read_b32 v51, a139
    v_mul_f32 v48, v48, v57
    v_mul_f32 v49, v49, v57
    v_mul_f32 v50, v50, v57
    v_mul_f32 v51, v51, v57
    v_accvgpr_write_b32 a136, v48
    v_accvgpr_write_b32 a137, v49
    v_accvgpr_write_b32 a138, v50
    v_accvgpr_write_b32 a139, v51
    v_accvgpr_read_b32 v48, a152
    v_accvgpr_read_b32 v49, a153
    v_accvgpr_read_b32 v50, a154
    v_accvgpr_read_b32 v51, a155
    v_mul_f32 v48, v48, v57
    v_mul_f32 v49, v49, v57
    v_mul_f32 v50, v50, v57
    v_mul_f32 v51, v51, v57
    v_accvgpr_write_b32 a152, v48
    v_accvgpr_write_b32 a153, v49
    v_accvgpr_write_b32 a154, v50
    v_accvgpr_write_b32 a155, v51
    v_accvgpr_read_b32 v48, a168
    v_accvgpr_read_b32 v49, a169
    v_accvgpr_read_b32 v50, a170
    v_accvgpr_read_b32 v51, a171
    v_mul_f32 v48, v48, v57
    v_mul_f32 v49, v49, v57
    v_mul_f32 v50, v50, v57
    v_mul_f32 v51, v51, v57
    v_accvgpr_write_b32 a168, v48
    v_accvgpr_write_b32 a169, v49
    v_accvgpr_write_b32 a170, v50
    v_accvgpr_write_b32 a171, v51
    v_accvgpr_read_b32 v48, a184
    v_accvgpr_read_b32 v49, a185
    v_accvgpr_read_b32 v50, a186
    v_accvgpr_read_b32 v51, a187
    v_mul_f32 v48, v48, v57
    v_mul_f32 v49, v49, v57
    v_mul_f32 v50, v50, v57
    v_mul_f32 v51, v51, v57
    v_accvgpr_write_b32 a184, v48
    v_accvgpr_write_b32 a185, v49
    v_accvgpr_write_b32 a186, v50
    v_accvgpr_write_b32 a187, v51
    v_exp_f32 v48, v148
    v_exp_f32 v49, v149
    v_exp_f32 v50, v150
    v_exp_f32 v51, v151
    v_exp_f32 v52, v180
    v_exp_f32 v53, v181
    v_exp_f32 v54, v182
    v_exp_f32 v55, v183
    s_nop 0
    v_cvt_pk_bf16_f32 v244, v48, v49
    v_cvt_pk_bf16_f32 v245, v50, v51
    v_cvt_pk_bf16_f32 v246, v52, v53
    v_cvt_pk_bf16_f32 v247, v54, v55
    v_add_f32 v26, v48, v49
    v_add_f32 v26, v26, v50
    v_add_f32 v26, v26, v51
    v_add_f32 v26, v26, v52
    v_add_f32 v26, v26, v53
    v_add_f32 v26, v26, v54
    v_add_f32 v26, v26, v55
    v_max3_f32 v56, v156, v157, v158
    v_max3_f32 v56, v56, v159, v188
    v_max3_f32 v56, v56, v189, v190
    v_max3_f32 v56, v56, v191, 0
    v_mov_b32 v58, v56
    s_nop 1
    v_permlane16_swap_b32 v56, v58
    s_nop 1
    v_max_f32 v56, v56, v58
    v_mov_b32 v58, v56
    s_nop 1
    v_permlane32_swap_b32 v56, v58
    s_nop 1
    v_max_f32 v56, v56, v58
    v_exp_f32 v57, -v56
    v_sub_f32 v44, v44, v56
    v_sub_f32 v45, v45, v56
    v_sub_f32 v46, v46, v56
    v_sub_f32 v47, v47, v56
    v_mul_f32 v23, v23, v57
    v_sub_f32 v156, v156, v56
    v_sub_f32 v157, v157, v56
    v_sub_f32 v158, v158, v56
    v_sub_f32 v159, v159, v56
    v_sub_f32 v188, v188, v56
    v_sub_f32 v189, v189, v56
    v_sub_f32 v190, v190, v56
    v_sub_f32 v191, v191, v56
    v_accvgpr_read_b32 v48, a12
    v_accvgpr_read_b32 v49, a13
    v_accvgpr_read_b32 v50, a14
    v_accvgpr_read_b32 v51, a15
    v_mul_f32 v48, v48, v57
    v_mul_f32 v49, v49, v57
    v_mul_f32 v50, v50, v57
    v_mul_f32 v51, v51, v57
    v_accvgpr_write_b32 a12, v48
    v_accvgpr_write_b32 a13, v49
    v_accvgpr_write_b32 a14, v50
    v_accvgpr_write_b32 a15, v51
    v_accvgpr_read_b32 v48, a28
    v_accvgpr_read_b32 v49, a29
    v_accvgpr_read_b32 v50, a30
    v_accvgpr_read_b32 v51, a31
    v_mul_f32 v48, v48, v57
    v_mul_f32 v49, v49, v57
    v_mul_f32 v50, v50, v57
    v_mul_f32 v51, v51, v57
    v_accvgpr_write_b32 a28, v48
    v_accvgpr_write_b32 a29, v49
    v_accvgpr_write_b32 a30, v50
    v_accvgpr_write_b32 a31, v51
    v_accvgpr_read_b32 v48, a44
    v_accvgpr_read_b32 v49, a45
    v_accvgpr_read_b32 v50, a46
    v_accvgpr_read_b32 v51, a47
    v_mul_f32 v48, v48, v57
    v_mul_f32 v49, v49, v57
    v_mul_f32 v50, v50, v57
    v_mul_f32 v51, v51, v57
    v_accvgpr_write_b32 a44, v48
    v_accvgpr_write_b32 a45, v49
    v_accvgpr_write_b32 a46, v50
    v_accvgpr_write_b32 a47, v51
    v_accvgpr_read_b32 v48, a60
    v_accvgpr_read_b32 v49, a61
    v_accvgpr_read_b32 v50, a62
    v_accvgpr_read_b32 v51, a63
    v_mul_f32 v48, v48, v57
    v_mul_f32 v49, v49, v57
    v_mul_f32 v50, v50, v57
    v_mul_f32 v51, v51, v57
    v_accvgpr_write_b32 a60, v48
    v_accvgpr_write_b32 a61, v49
    v_accvgpr_write_b32 a62, v50
    v_accvgpr_write_b32 a63, v51
    v_accvgpr_read_b32 v48, a76
    v_accvgpr_read_b32 v49, a77
    v_accvgpr_read_b32 v50, a78
    v_accvgpr_read_b32 v51, a79
    v_mul_f32 v48, v48, v57
    v_mul_f32 v49, v49, v57
    v_mul_f32 v50, v50, v57
    v_mul_f32 v51, v51, v57
    v_accvgpr_write_b32 a76, v48
    v_accvgpr_write_b32 a77, v49
    v_accvgpr_write_b32 a78, v50
    v_accvgpr_write_b32 a79, v51
    v_accvgpr_read_b32 v48, a92
    v_accvgpr_read_b32 v49, a93
    v_accvgpr_read_b32 v50, a94
    v_accvgpr_read_b32 v51, a95
    v_mul_f32 v48, v48, v57
    v_mul_f32 v49, v49, v57
    v_mul_f32 v50, v50, v57
    v_mul_f32 v51, v51, v57
    v_accvgpr_write_b32 a92, v48
    v_accvgpr_write_b32 a93, v49
    v_accvgpr_write_b32 a94, v50
    v_accvgpr_write_b32 a95, v51
    v_accvgpr_read_b32 v48, a108
    v_accvgpr_read_b32 v49, a109
    v_accvgpr_read_b32 v50, a110
    v_accvgpr_read_b32 v51, a111
    v_mul_f32 v48, v48, v57
    v_mul_f32 v49, v49, v57
    v_mul_f32 v50, v50, v57
    v_mul_f32 v51, v51, v57
    v_accvgpr_write_b32 a108, v48
    v_accvgpr_write_b32 a109, v49
    v_accvgpr_write_b32 a110, v50
    v_accvgpr_write_b32 a111, v51
    v_accvgpr_read_b32 v48, a124
    v_accvgpr_read_b32 v49, a125
    v_accvgpr_read_b32 v50, a126
    v_accvgpr_read_b32 v51, a127
    v_mul_f32 v48, v48, v57
    v_mul_f32 v49, v49, v57
    v_mul_f32 v50, v50, v57
    v_mul_f32 v51, v51, v57
    v_accvgpr_write_b32 a124, v48
    v_accvgpr_write_b32 a125, v49
    v_accvgpr_write_b32 a126, v50
    v_accvgpr_write_b32 a127, v51
    v_accvgpr_read_b32 v48, a140
    v_accvgpr_read_b32 v49, a141
    v_accvgpr_read_b32 v50, a142
    v_accvgpr_read_b32 v51, a143
    v_mul_f32 v48, v48, v57
    v_mul_f32 v49, v49, v57
    v_mul_f32 v50, v50, v57
    v_mul_f32 v51, v51, v57
    v_accvgpr_write_b32 a140, v48
    v_accvgpr_write_b32 a141, v49
    v_accvgpr_write_b32 a142, v50
    v_accvgpr_write_b32 a143, v51
    v_accvgpr_read_b32 v48, a156
    v_accvgpr_read_b32 v49, a157
    v_accvgpr_read_b32 v50, a158
    v_accvgpr_read_b32 v51, a159
    v_mul_f32 v48, v48, v57
    v_mul_f32 v49, v49, v57
    v_mul_f32 v50, v50, v57
    v_mul_f32 v51, v51, v57
    v_accvgpr_write_b32 a156, v48
    v_accvgpr_write_b32 a157, v49
    v_accvgpr_write_b32 a158, v50
    v_accvgpr_write_b32 a159, v51
    v_accvgpr_read_b32 v48, a172
    v_accvgpr_read_b32 v49, a173
    v_accvgpr_read_b32 v50, a174
    v_accvgpr_read_b32 v51, a175
    v_mul_f32 v48, v48, v57
    v_mul_f32 v49, v49, v57
    v_mul_f32 v50, v50, v57
    v_mul_f32 v51, v51, v57
    v_accvgpr_write_b32 a172, v48
    v_accvgpr_write_b32 a173, v49
    v_accvgpr_write_b32 a174, v50
    v_accvgpr_write_b32 a175, v51
    v_accvgpr_read_b32 v48, a188
    v_accvgpr_read_b32 v49, a189
    v_accvgpr_read_b32 v50, a190
    v_accvgpr_read_b32 v51, a191
    v_mul_f32 v48, v48, v57
    v_mul_f32 v49, v49, v57
    v_mul_f32 v50, v50, v57
    v_mul_f32 v51, v51, v57
    v_accvgpr_write_b32 a188, v48
    v_accvgpr_write_b32 a189, v49
    v_accvgpr_write_b32 a190, v50
    v_accvgpr_write_b32 a191, v51
    v_exp_f32 v48, v156
    v_exp_f32 v49, v157
    v_exp_f32 v50, v158
    v_exp_f32 v51, v159
    v_exp_f32 v52, v188
    v_exp_f32 v53, v189
    v_exp_f32 v54, v190
    v_exp_f32 v55, v191
    s_nop 0
    v_cvt_pk_bf16_f32 v252, v48, v49
    v_cvt_pk_bf16_f32 v253, v50, v51
    v_cvt_pk_bf16_f32 v254, v52, v53
    v_cvt_pk_bf16_f32 v255, v54, v55
    v_add_f32 v27, v48, v49
    v_add_f32 v27, v27, v50
    v_add_f32 v27, v27, v51
    v_add_f32 v27, v27, v52
    v_add_f32 v27, v27, v53
    v_add_f32 v27, v27, v54
    v_add_f32 v27, v27, v55
    s_nop 1
    s_branch rare_e_ret
.section .rodata,"a"
.p2align 6
.amdhsa_kernel recurrent_scan__sliding_block_cached__moe_arch_mod__prompt_kernel
  .amdhsa_next_free_vgpr 512
  .amdhsa_next_free_sgpr 102
  .amdhsa_accum_offset 256
  .amdhsa_group_segment_fixed_size 0
  .amdhsa_kernarg_size 104
  .amdhsa_user_sgpr_count 2
  .amdhsa_user_sgpr_kernarg_segment_ptr 1
  .amdhsa_system_sgpr_workgroup_id_x 1
  .amdhsa_float_denorm_mode_32 3
.end_amdhsa_kernel
```

```asm
; @launch grid=(256,1,1) block=(256,1,1) lds=163840
.amdgcn_target "amdgcn-amd-amdhsa--gfx950"
.text
.globl recurrent_scan__sliding_block_cached__moe_arch_mod__prompt_kernel
.p2align 8
.type recurrent_scan__sliding_block_cached__moe_arch_mod__prompt_kernel,@function
recurrent_scan__sliding_block_cached__moe_arch_mod__prompt_kernel:
    s_cmp_ge_u32 s2, 256
    s_cbranch_scc1 main_end
    s_load_dwordx16 s[64:79], s[0:1], 0
    s_load_dwordx4 s[80:83], s[0:1], 64
    s_load_dwordx2 s[84:85], s[0:1], 80
    s_load_dwordx2 s[86:87], s[0:1], 96
    s_lshr_b32 s56, s2, 3
    s_lshl_b32 s56, s56, 11
    v_lshrrev_b32 v17, 4, v0
    v_lshlrev_b32 v17, 7, v17
    v_add_u32 v17, s56, v17
    s_getpc_b64 s[88:89]
    global_load_dword a220, v17, s[88:89]
    v_lshrrev_b32 v17, 6, v0
    v_lshlrev_b32 v17, 12, v17
    v_and_b32 v1, 63, v0
    v_lshl_add_u32 v17, v1, 4, v17
    v_and_b32 v1, 63, v0
    v_lshrrev_b32 v29, 6, v0
    v_mov_b32 v16, v0
    v_readfirstlane_b32 s3, v29
    s_and_b32 s53, s2, 7
    s_lshr_b32 s52, s2, 5
    s_bfe_u32 s51, s2, 0x20003
    s_lshl_b32 s50, s53, 2
    s_add_u32 s50, s50, s51
    s_lshl_b32 s60, s2, 3
    s_lshl_b32 s56, s3, 1
    s_add_u32 s60, s60, s56
    v_bfe_u32 v240, v1, 2, 1
    v_add_u32 v240, s60, v240
    v_lshrrev_b32 v241, 3, v1
    v_lshlrev_b32 v241, 6, v241
    v_and_b32 v29, 3, v1
    v_lshl_add_u32 v241, v29, 4, v241
    v_mul_u32_u24 v242, 1280, v240
    v_add_u32 v242, v242, v241
    v_lshrrev_b32 v29, 4, v1
    v_lshlrev_b32 v29, 1, v29
    v_and_b32 v7, 7, v1
    v_xor_b32 v7, v7, v29
    v_lshlrev_b32 v7, 4, v7
    v_lshrrev_b32 v29, 5, v1
    v_lshlrev_b32 v29, 3, v29
    v_bfe_u32 v5, v1, 3, 2
    v_add_u32 v5, v5, v29
    v_mul_u32_u24 v2, 12288, v5
    v_add_u32 v2, v2, v7
    v_add_u32 v3, 196608, v2
    s_lshl_b32 s54, s52, 2
    s_add_u32 s54, s54, s3
    s_mul_i32 s49, s3, 6144
    s_lshr_b32 s59, s3, 1
    s_lshl_b32 s59, s59, 5
    s_and_b32 s56, s3, 1
    s_lshl_b32 s56, s56, 2
    s_add_u32 s59, s59, s56
    s_mul_i32 s36, s59, 12288
    s_mov_b32 s37, 786432
    s_add_u32 s45, s51, s52
    s_and_b32 s45, s45, 3
    s_lshl_b32 s45, s45, 2
    s_lshr_b32 s45, 0x5050, s45
    s_and_b32 s45, s45, 15
    s_mul_i32 s56, s45, 786432
    s_add_u32 s36, s36, s56
    s_lshl_b32 s45, s45, 13
    s_lshr_b32 s56, s2, 3
    s_lshl_b32 s56, s56, 8
    v_add_u32 v22, s56, v16
    s_mov_b32 s56, 357913942
    v_mul_hi_u32 v23, s56, v22
    v_mul_u32_u24 v24, 12, v23
    v_sub_u32 v24, v22, v24
    v_mul_u32_u24 v23, 12288, v23
    v_lshl_add_u32 v23, v24, 7, v23
    s_mul_i32 s40, s51, 384
    s_sub_u32 s40, 1572864, s40
    v_lshlrev_b32 v24, 7, v1
    s_mul_i32 s47, s50, 786432
    s_add_u32 s47, s47, 589824
    s_lshl_b32 s48, s52, 13
    s_mul_i32 s56, s50, 384
    s_sub_u32 s57, 7864320, s56
    s_waitcnt lgkmcnt(0)
    s_mov_b32 s12, s64
    s_and_b32 s13, s65, 0xffff
    s_mov_b32 s14, 2621440
    s_mov_b32 s15, 0x00020000
    s_mov_b32 s16, s76
    s_and_b32 s17, s77, 0xffff
    s_mov_b32 s18, 1280
    s_mov_b32 s19, 0x00020000
    buffer_load_dwordx4 v[64:67], v242, s[12:15], 0 offen
    buffer_load_dwordx4 v[68:71], v242, s[12:15], 0 offen offset:512
    buffer_load_dwordx4 v[72:75], v242, s[12:15], 0 offen offset:1024
    v_mov_b32 v25, 3203072
    global_load_dword v26, v25, s[86:87] sc1
    s_lshr_b32 s44, s2, 3
    s_lshl_b32 s44, s44, 7
    s_add_u32 s44, s44, 4784128
    s_load_dword s92, s[86:87], s44 glc
    s_lshr_b32 s58, s2, 4
    s_lshl_b32 s58, s58, 14
    s_and_b32 s44, s2, 15
    s_lshl_b32 s44, s44, 2
    s_add_u32 s44, s44, s3
    s_lshl_b32 s44, s44, 7
    s_add_u32 s58, s58, s44
    s_add_u32 s58, s58, 4456448
    v_and_b32 v27, 31, v1
    v_lshlrev_b32 v27, 2, v27
    v_lshrrev_b32 v25, 5, v1
    v_lshl_add_u32 v27, v25, 13, v27
    v_add_u32 v27, s58, v27
    v_mov_b32 v25, 0
    global_store_dword v27, v25, s[86:87] sc1
    buffer_load_dwordx4 v[76:79], v241, s[16:19], 0 offen offset:0
    buffer_load_dwordx4 v[80:83], v241, s[16:19], 0 offen offset:512
    buffer_load_dwordx4 v[84:87], v241, s[16:19], 0 offen offset:1024
    s_add_u32 s8, s70, s56
    s_addc_u32 s9, s71, 0
    s_and_b32 s9, s9, 0xffff
    s_mov_b32 s10, s57
    s_mov_b32 s11, 0x00020000
    s_add_u32 m0, s49, 49152
    s_nop 0
    buffer_load_dwordx4 v2, s[8:11], s36 offen offset:0 lds
    s_add_u32 m0, s49, 50048
    s_nop 0
    buffer_load_dwordx4 v2, s[8:11], s36 offen offset:128 lds
    s_add_u32 m0, s49, 50944
    s_nop 0
    buffer_load_dwordx4 v2, s[8:11], s36 offen offset:256 lds
    s_add_u32 m0, s49, 52224
    s_nop 0
    buffer_load_dwordx4 v3, s[8:11], s36 offen offset:0 lds
    s_add_u32 m0, s49, 53120
    s_nop 0
    buffer_load_dwordx4 v3, s[8:11], s36 offen offset:128 lds
    s_add_u32 m0, s49, 54016
    s_nop 0
    buffer_load_dwordx4 v3, s[8:11], s36 offen offset:256 lds
    s_add_u32 s36, s36, s37
    s_sub_u32 s55, s36, 7864320
    s_min_u32 s36, s36, s55
    s_mov_b32 s24, s86
    s_and_b32 s25, s87, 0xffff
    s_mov_b32 s26, 268435456
    s_mov_b32 s27, 0x00020000
    s_lshl_b32 s56, s2, 2
    s_add_u32 s56, s56, s3
    s_cmp_lt_u32 s56, 20
    s_cselect_b32 s57, 0, 0x70000000
    s_add_u32 s57, s57, 3670016
    s_lshl_b32 s56, s56, 10
    s_add_u32 s56, s56, s57
    v_mov_b32 v160, 0
    v_mov_b32 v161, 0
    v_mov_b32 v162, 0
    v_mov_b32 v163, 0
    v_lshlrev_b32 v164, 4, v1
    buffer_store_dwordx4 v[160:163], v164, s[24:27], s56 offen sc1
    v_lshrrev_b32 v243, 6, v240
    v_mul_u32_u24 v243, 81920, v243
    v_bfe_u32 v29, v240, 4, 2
    v_lshl_add_u32 v243, v29, 10, v243
    v_and_b32 v29, 15, v240
    v_lshl_add_u32 v243, v29, 6, v243
    v_lshrrev_b32 v29, 3, v1
    v_lshl_add_u32 v243, v29, 12, v243
    v_and_b32 v29, 3, v1
    v_lshl_add_u32 v243, v29, 4, v243
    s_mov_b32 s38, 0x3acccccd
    s_mov_b32 s39, 0x3727c5ac
    s_mov_b32 s41, 0
    s_mov_b32 s42, 32768
    s_mov_b32 s43, 65536
    v_bfe_u32 v29, v1, 2, 3
    v_lshlrev_b32 v12, 7, v29
    v_lshrrev_b32 v29, 1, v29
    v_xor_b32 v29, 0, v29
    v_lshl_add_u32 v12, v29, 5, v12
    v_and_b32 v29, 3, v1
    v_lshl_add_u32 v12, v29, 3, v12
    v_lshrrev_b32 v29, 5, v1
    v_mul_u32_u24 v29, 3072, v29
    v_add_u32 v12, v12, v29
    v_xor_b32 v13, 32, v12
    v_xor_b32 v14, 64, v12
    v_xor_b32 v15, 96, v12
    v_add_u32 v8, 49152, v12
    v_add_u32 v9, 49152, v13
    v_add_u32 v10, 49152, v14
    v_add_u32 v11, 49152, v15
    v_and_b32 v28, 15, v1
    v_lshlrev_b32 v28, 6, v28
    v_lshrrev_b32 v29, 4, v1
    v_lshl_add_u32 v28, v29, 4, v28
    s_mul_i32 s56, s54, 81920
    s_add_u32 s56, s56, 0
    s_add_u32 s20, s86, s56
    s_addc_u32 s21, s87, 0
    s_and_b32 s21, s21, 0xffff
    s_mov_b32 s22, 81920
    s_mov_b32 s23, 0x00020000
    s_lshl_b32 s46, s54, 7
    s_add_u32 s46, s46, 4784128
    s_mov_b32 s101, 0
    s_bitcmp1_b32 s53, 1
    s_cselect_b32 s56, 0x4000, 0
    s_add_u32 s46, s46, s56
    s_and_b32 s56, s53, 1
    s_lshl_b32 s56, s56, 12
    s_add_u32 s46, s46, s56
    s_load_dword s47, s[86:87], s46 glc
    s_load_dword s48, s[86:87], s46 offset:0x2000 glc
    s_lshr_b32 s6, s2, 3
    s_lshl_b32 s6, s6, 7
    s_lshl_b32 s56, s53, 2
    s_add_u32 s6, s6, s56
    s_add_u32 s6, s6, 4784128
    s_cmp_eq_u32 s3, 0
    s_cselect_b32 s6, s6, 0x70000000
    v_lshlrev_b32 v20, 12, v1
    s_mov_b64 exec, 0
    s_cmp_eq_u32 s3, 0
    s_cbranch_scc1 pg_0
    s_cmp_eq_u32 s3, 1
    s_cbranch_scc1 pg_1
    s_cmp_eq_u32 s3, 2
    s_cbranch_scc1 pg_2
    s_cmp_eq_u32 s3, 3
    s_cbranch_scc1 pg_3
pg_ret:
    s_mov_b64 exec, -1
    s_waitcnt vmcnt(12)
    v_lshlrev_b32 v96, 16, v64
    v_and_b32 v97, 0xffff0000, v64
    v_lshlrev_b32 v98, 16, v65
    v_and_b32 v99, 0xffff0000, v65
    v_lshlrev_b32 v100, 16, v66
    v_and_b32 v101, 0xffff0000, v66
    v_lshlrev_b32 v102, 16, v67
    v_and_b32 v103, 0xffff0000, v67
    v_lshlrev_b32 v104, 16, v68
    v_and_b32 v105, 0xffff0000, v68
    v_lshlrev_b32 v106, 16, v69
    v_and_b32 v107, 0xffff0000, v69
    v_lshlrev_b32 v108, 16, v70
    v_and_b32 v109, 0xffff0000, v70
    v_lshlrev_b32 v110, 16, v71
    v_and_b32 v111, 0xffff0000, v71
    v_lshlrev_b32 v112, 16, v72
    v_and_b32 v113, 0xffff0000, v72
    v_lshlrev_b32 v114, 16, v73
    v_and_b32 v115, 0xffff0000, v73
    v_lshlrev_b32 v116, 16, v74
    v_and_b32 v117, 0xffff0000, v74
    v_lshlrev_b32 v118, 16, v75
    v_and_b32 v119, 0xffff0000, v75
    v_pk_add_f32 v[120:121], v[96:97], v[98:99]
    v_pk_add_f32 v[122:123], v[100:101], v[102:103]
    v_pk_add_f32 v[120:121], v[120:121], v[104:105]
    v_pk_add_f32 v[122:123], v[122:123], v[106:107]
    v_pk_add_f32 v[120:121], v[120:121], v[108:109]
    v_pk_add_f32 v[122:123], v[122:123], v[110:111]
    s_mov_b32 exec_hi, 0
    v_pk_add_f32 v[120:121], v[120:121], v[112:113]
    v_pk_add_f32 v[122:123], v[122:123], v[114:115]
    v_pk_add_f32 v[120:121], v[120:121], v[116:117]
    v_pk_add_f32 v[122:123], v[122:123], v[118:119]
    s_mov_b64 exec, -1
    v_pk_add_f32 v[120:121], v[120:121], v[122:123]
    v_add_f32 v120, v120, v121
    s_nop 1
    v_add_f32_dpp v120, v120, v120 quad_perm:[1,0,3,2] row_mask:0xf bank_mask:0xf
    s_nop 1
    v_add_f32_dpp v120, v120, v120 quad_perm:[2,3,0,1] row_mask:0xf bank_mask:0xf
    s_nop 1
    v_add_f32_dpp v120, v120, v120 row_ror:8 row_mask:0xf bank_mask:0xf
    v_mov_b32 v124, v120
    s_nop 1
    v_permlane16_swap_b32 v120, v124
    s_nop 1
    v_add_f32 v120, v120, v124
    v_mov_b32 v124, v120
    s_nop 1
    v_permlane32_swap_b32 v120, v124
    s_nop 1
    v_add_f32 v120, v120, v124
    v_mul_f32 v126, s38, v120
    v_mul_f32 v128, s38, -v120
    v_mul_f32 v129, s38, -v120
    v_pk_add_f32 v[132:133], v[96:97], v[128:129]
    v_pk_mul_f32 v[120:121], v[132:133], v[132:133]
    v_pk_add_f32 v[134:135], v[98:99], v[128:129]
    v_pk_mul_f32 v[122:123], v[134:135], v[134:135]
    v_pk_add_f32 v[136:137], v[100:101], v[128:129]
    v_pk_fma_f32 v[120:121], v[136:137], v[136:137], v[120:121]
    v_pk_add_f32 v[138:139], v[102:103], v[128:129]
    v_pk_fma_f32 v[122:123], v[138:139], v[138:139], v[122:123]
    v_pk_add_f32 v[132:133], v[104:105], v[128:129]
    v_pk_fma_f32 v[120:121], v[132:133], v[132:133], v[120:121]
    v_pk_add_f32 v[134:135], v[106:107], v[128:129]
    v_pk_fma_f32 v[122:123], v[134:135], v[134:135], v[122:123]
    v_pk_add_f32 v[136:137], v[108:109], v[128:129]
    v_pk_fma_f32 v[120:121], v[136:137], v[136:137], v[120:121]
    v_pk_add_f32 v[138:139], v[110:111], v[128:129]
    v_pk_fma_f32 v[122:123], v[138:139], v[138:139], v[122:123]
    s_mov_b32 exec_hi, 0
    v_pk_add_f32 v[132:133], v[112:113], v[128:129]
    v_pk_fma_f32 v[120:121], v[132:133], v[132:133], v[120:121]
    v_pk_add_f32 v[134:135], v[114:115], v[128:129]
    v_pk_fma_f32 v[122:123], v[134:135], v[134:135], v[122:123]
    v_pk_add_f32 v[136:137], v[116:117], v[128:129]
    v_pk_fma_f32 v[120:121], v[136:137], v[136:137], v[120:121]
    v_pk_add_f32 v[138:139], v[118:119], v[128:129]
    v_pk_fma_f32 v[122:123], v[138:139], v[138:139], v[122:123]
    s_mov_b64 exec, -1
    v_pk_add_f32 v[120:121], v[120:121], v[122:123]
    v_add_f32 v120, v120, v121
    s_nop 1
    v_add_f32_dpp v120, v120, v120 quad_perm:[1,0,3,2] row_mask:0xf bank_mask:0xf
    s_nop 1
    v_add_f32_dpp v120, v120, v120 quad_perm:[2,3,0,1] row_mask:0xf bank_mask:0xf
    s_nop 1
    v_add_f32_dpp v120, v120, v120 row_ror:8 row_mask:0xf bank_mask:0xf
    v_mov_b32 v124, v120
    s_nop 1
    v_permlane16_swap_b32 v120, v124
    s_nop 1
    v_add_f32 v120, v120, v124
    v_mov_b32 v124, v120
    s_nop 1
    v_permlane32_swap_b32 v120, v124
    s_nop 1
    v_add_f32 v120, v120, v124
    v_mul_f32 v130, s38, v120
    v_cvt_pk_bf16_f32 v126, v126, v126
    v_and_b32 v126, 0xffff0000, v126
    v_cvt_pk_bf16_f32 v130, v130, v130
    v_and_b32 v130, 0xffff0000, v130
    v_add_f32 v130, s39, v130
    v_cvt_pk_bf16_f32 v130, v130, v130
    v_and_b32 v130, 0xffff0000, v130
    v_sqrt_f32 v130, v130
    v_sub_f32 v128, 0, v126
    v_cvt_pk_bf16_f32 v130, v130, v130
    v_and_b32 v130, 0xffff0000, v130
    v_rcp_f32 v127, v130
    v_sub_f32 v129, 0, v126
    v_mul_f32 v120, 0x3dd53b95, v127
    v_mul_f32 v121, 0x3dd53b95, v127
    v_mov_b32 v130, v127
    v_mov_b32 v131, v127
    v_pk_add_f32 v[96:97], v[96:97], v[128:129]
    v_pk_mul_f32 v[132:133], v[96:97], v[120:121]
    v_cvt_pk_bf16_f32 v144, v132, v133
    v_pk_add_f32 v[98:99], v[98:99], v[128:129]
    v_pk_mul_f32 v[134:135], v[98:99], v[120:121]
    v_cvt_pk_bf16_f32 v145, v134, v135
    v_pk_add_f32 v[100:101], v[100:101], v[128:129]
    v_pk_mul_f32 v[136:137], v[100:101], v[120:121]
    v_cvt_pk_bf16_f32 v146, v136, v137
    v_pk_add_f32 v[102:103], v[102:103], v[128:129]
    v_pk_mul_f32 v[138:139], v[102:103], v[120:121]
    v_cvt_pk_bf16_f32 v147, v138, v139
    buffer_store_dwordx4 v[144:147], v243, s[24:27], s41 offen sc1
    v_pk_add_f32 v[104:105], v[104:105], v[128:129]
    v_pk_mul_f32 v[132:133], v[104:105], v[120:121]
    v_cvt_pk_bf16_f32 v148, v132, v133
    v_pk_add_f32 v[106:107], v[106:107], v[128:129]
    v_pk_mul_f32 v[134:135], v[106:107], v[120:121]
    v_cvt_pk_bf16_f32 v149, v134, v135
    v_pk_add_f32 v[108:109], v[108:109], v[128:129]
    v_pk_mul_f32 v[136:137], v[108:109], v[120:121]
    v_cvt_pk_bf16_f32 v150, v136, v137
    v_pk_add_f32 v[110:111], v[110:111], v[128:129]
    v_pk_mul_f32 v[138:139], v[110:111], v[120:121]
    v_cvt_pk_bf16_f32 v151, v138, v139
    buffer_store_dwordx4 v[148:151], v243, s[24:27], s42 offen sc1
    v_pk_add_f32 v[112:113], v[112:113], v[128:129]
    v_pk_mul_f32 v[132:133], v[112:113], v[120:121]
    v_cvt_pk_bf16_f32 v152, v132, v133
    v_pk_add_f32 v[114:115], v[114:115], v[128:129]
    v_pk_mul_f32 v[134:135], v[114:115], v[120:121]
    v_cvt_pk_bf16_f32 v153, v134, v135
    v_pk_add_f32 v[116:117], v[116:117], v[128:129]
    v_pk_mul_f32 v[136:137], v[116:117], v[120:121]
    v_cvt_pk_bf16_f32 v154, v136, v137
    v_pk_add_f32 v[118:119], v[118:119], v[128:129]
    v_pk_mul_f32 v[138:139], v[118:119], v[120:121]
    v_cvt_pk_bf16_f32 v155, v138, v139
    s_mov_b32 exec_hi, 0
    buffer_store_dwordx4 v[152:155], v243, s[24:27], s43 offen sc1
    s_mov_b64 exec, -1
    s_branch pg_start
    .p2align 12
pg_0:
    s_cbranch_execz pg_ret
pg_start:
    s_waitcnt vmcnt(10)
    v_readfirstlane_b32 s7, v26
    v_cvt_pk_bf16_f32 v64, v96, v97
    v_lshlrev_b32 v96, 16, v64
    v_and_b32 v97, 0xffff0000, v64
    v_pk_mul_f32 v[96:97], v[96:97], v[130:131]
    v_cvt_pk_bf16_f32 v64, v96, v97
    v_lshlrev_b32 v96, 16, v64
    v_and_b32 v97, 0xffff0000, v64
    v_lshlrev_b32 v132, 16, v76
    v_and_b32 v133, 0xffff0000, v76
    v_pk_mul_f32 v[120:121], v[96:97], v[132:133]
    s_add_u32 m0, s49, 73728
    s_nop 0
    buffer_load_dwordx4 v2, s[8:11], s36 offen offset:0 lds
    s_add_u32 m0, s49, 74624
    s_nop 0
    buffer_load_dwordx4 v2, s[8:11], s36 offen offset:128 lds
    v_cvt_pk_bf16_f32 v65, v98, v99
    v_lshlrev_b32 v98, 16, v65
    v_and_b32 v99, 0xffff0000, v65
    v_pk_mul_f32 v[98:99], v[98:99], v[130:131]
    v_cvt_pk_bf16_f32 v65, v98, v99
    v_lshlrev_b32 v98, 16, v65
    v_and_b32 v99, 0xffff0000, v65
    v_lshlrev_b32 v134, 16, v77
    v_and_b32 v135, 0xffff0000, v77
    v_pk_mul_f32 v[122:123], v[98:99], v[134:135]
    s_add_u32 m0, s49, 75520
    s_nop 0
    buffer_load_dwordx4 v2, s[8:11], s36 offen offset:256 lds
    s_add_u32 m0, s49, 76800
    s_nop 0
    buffer_load_dwordx4 v3, s[8:11], s36 offen offset:0 lds
    v_cvt_pk_bf16_f32 v66, v100, v101
    v_lshlrev_b32 v100, 16, v66
    v_and_b32 v101, 0xffff0000, v66
    v_pk_mul_f32 v[100:101], v[100:101], v[130:131]
    v_cvt_pk_bf16_f32 v66, v100, v101
    v_lshlrev_b32 v100, 16, v66
    v_and_b32 v101, 0xffff0000, v66
    v_lshlrev_b32 v136, 16, v78
    v_and_b32 v137, 0xffff0000, v78
    v_pk_fma_f32 v[120:121], v[100:101], v[136:137], v[120:121]
    s_add_u32 m0, s49, 77696
    s_nop 0
    buffer_load_dwordx4 v3, s[8:11], s36 offen offset:128 lds
    s_add_u32 m0, s49, 78592
    s_nop 0
    buffer_load_dwordx4 v3, s[8:11], s36 offen offset:256 lds
    s_add_u32 s36, s36, s37
    s_sub_u32 s55, s36, 7864320
    s_min_u32 s36, s36, s55
    v_cvt_pk_bf16_f32 v67, v102, v103
    v_lshlrev_b32 v102, 16, v67
    v_and_b32 v103, 0xffff0000, v67
    v_pk_mul_f32 v[102:103], v[102:103], v[130:131]
    v_cvt_pk_bf16_f32 v67, v102, v103
    v_lshlrev_b32 v102, 16, v67
    v_and_b32 v103, 0xffff0000, v67
    v_lshlrev_b32 v138, 16, v79
    v_and_b32 v139, 0xffff0000, v79
    v_pk_fma_f32 v[122:123], v[102:103], v[138:139], v[122:123]
    s_add_u32 m0, s49, 98304
    s_nop 0
    buffer_load_dwordx4 v2, s[8:11], s36 offen offset:0 lds
    s_add_u32 m0, s49, 99200
    s_nop 0
    buffer_load_dwordx4 v2, s[8:11], s36 offen offset:128 lds
    v_cvt_pk_bf16_f32 v68, v104, v105
    v_lshlrev_b32 v104, 16, v68
    v_and_b32 v105, 0xffff0000, v68
    v_pk_mul_f32 v[104:105], v[104:105], v[130:131]
    v_cvt_pk_bf16_f32 v68, v104, v105
    v_lshlrev_b32 v104, 16, v68
    v_and_b32 v105, 0xffff0000, v68
    v_lshlrev_b32 v132, 16, v80
    v_and_b32 v133, 0xffff0000, v80
    v_pk_fma_f32 v[120:121], v[104:105], v[132:133], v[120:121]
    s_add_u32 m0, s49, 100096
    s_nop 0
    buffer_load_dwordx4 v2, s[8:11], s36 offen offset:256 lds
    s_add_u32 m0, s49, 101376
    s_nop 0
    buffer_load_dwordx4 v3, s[8:11], s36 offen offset:0 lds
    s_waitcnt vmcnt(10) lgkmcnt(0)
    s_lshr_b32 s7, s7, 4
    s_mul_i32 s7, s7, 0x2c9277b5
    s_add_u32 s7, s7, 0x6c564b05
    s_lshl_b32 s7, s7, 4
    s_barrier
    v_mov_b32 v21, s7
    s_mov_b64 exec, 255
    buffer_store_dword v21, v20, s[24:27], s6 offen sc1
    s_mov_b64 exec, 0x11
    v_lshlrev_b32 v29, 3, v240
    s_mov_b32 s56, 3211264
    buffer_store_dwordx2 v[126:127], v29, s[24:27], s56 offen sc1
    s_mov_b64 exec, -1
    v_cvt_pk_bf16_f32 v69, v106, v107
    v_lshlrev_b32 v106, 16, v69
    v_and_b32 v107, 0xffff0000, v69
    v_pk_mul_f32 v[106:107], v[106:107], v[130:131]
    v_cvt_pk_bf16_f32 v69, v106, v107
    v_lshlrev_b32 v106, 16, v69
    v_and_b32 v107, 0xffff0000, v69
    v_lshlrev_b32 v134, 16, v81
    v_and_b32 v135, 0xffff0000, v81
    v_pk_fma_f32 v[122:123], v[106:107], v[134:135], v[122:123]
    s_add_u32 m0, s49, 102272
    s_nop 0
    buffer_load_dwordx4 v3, s[8:11], s36 offen offset:128 lds
    s_add_u32 m0, s49, 103168
    s_nop 0
    buffer_load_dwordx4 v3, s[8:11], s36 offen offset:256 lds
    s_add_u32 s36, s36, s37
    s_sub_u32 s55, s36, 7864320
    s_min_u32 s36, s36, s55
    v_cvt_pk_bf16_f32 v70, v108, v109
    v_lshlrev_b32 v108, 16, v70
    v_and_b32 v109, 0xffff0000, v70
    v_pk_mul_f32 v[108:109], v[108:109], v[130:131]
    v_cvt_pk_bf16_f32 v70, v108, v109
    v_lshlrev_b32 v108, 16, v70
    v_and_b32 v109, 0xffff0000, v70
    v_lshlrev_b32 v136, 16, v82
    v_and_b32 v137, 0xffff0000, v82
    v_pk_fma_f32 v[120:121], v[108:109], v[136:137], v[120:121]
    s_add_u32 m0, s49, 122880
    s_nop 0
    buffer_load_dwordx4 v2, s[8:11], s36 offen offset:0 lds
    s_add_u32 m0, s49, 123776
    s_nop 0
    buffer_load_dwordx4 v2, s[8:11], s36 offen offset:128 lds
    v_cvt_pk_bf16_f32 v71, v110, v111
    v_lshlrev_b32 v110, 16, v71
    v_and_b32 v111, 0xffff0000, v71
    v_pk_mul_f32 v[110:111], v[110:111], v[130:131]
    v_cvt_pk_bf16_f32 v71, v110, v111
    v_lshlrev_b32 v110, 16, v71
    v_and_b32 v111, 0xffff0000, v71
    v_lshlrev_b32 v138, 16, v83
    v_and_b32 v139, 0xffff0000, v83
    v_pk_fma_f32 v[122:123], v[110:111], v[138:139], v[122:123]
    s_add_u32 m0, s49, 124672
    s_nop 0
    buffer_load_dwordx4 v2, s[8:11], s36 offen offset:256 lds
    s_add_u32 m0, s49, 125952
    s_nop 0
    buffer_load_dwordx4 v3, s[8:11], s36 offen offset:0 lds
    s_mov_b32 exec_hi, 0
    v_cvt_pk_bf16_f32 v72, v112, v113
    v_lshlrev_b32 v112, 16, v72
    v_and_b32 v113, 0xffff0000, v72
    v_pk_mul_f32 v[112:113], v[112:113], v[130:131]
    v_cvt_pk_bf16_f32 v72, v112, v113
    v_lshlrev_b32 v112, 16, v72
    v_and_b32 v113, 0xffff0000, v72
    v_lshlrev_b32 v132, 16, v84
    v_and_b32 v133, 0xffff0000, v84
    v_pk_fma_f32 v[120:121], v[112:113], v[132:133], v[120:121]
    s_waitcnt lgkmcnt(0)
    s_mov_b32 s63, -1
    s_load_dword s4, s[86:87], s58 offset:0x2000 glc
    s_load_dword s63, s[86:87], s58 glc
    s_waitcnt lgkmcnt(1)
    v_cvt_pk_bf16_f32 v73, v114, v115
    v_lshlrev_b32 v114, 16, v73
    v_and_b32 v115, 0xffff0000, v73
    v_pk_mul_f32 v[114:115], v[114:115], v[130:131]
    v_cvt_pk_bf16_f32 v73, v114, v115
    v_lshlrev_b32 v114, 16, v73
    v_and_b32 v115, 0xffff0000, v73
    v_lshlrev_b32 v134, 16, v85
    v_and_b32 v135, 0xffff0000, v85
    v_pk_fma_f32 v[122:123], v[114:115], v[134:135], v[122:123]
    s_and_b32 s93, s63, 0x2000
    s_add_u32 s46, s46, s93
    s_getreg_b32 s61, hwreg(HW_REG_XCC_ID, 2, 1)
    s_mul_i32 s61, s61, 0x6000
    s_lshl_b32 s93, s93, 1
    s_xor_b32 s93, s93, s61
    v_cvt_pk_bf16_f32 v74, v116, v117
    v_lshlrev_b32 v116, 16, v74
    v_and_b32 v117, 0xffff0000, v74
    v_pk_mul_f32 v[116:117], v[116:117], v[130:131]
    v_cvt_pk_bf16_f32 v74, v116, v117
    v_lshlrev_b32 v116, 16, v74
    v_and_b32 v117, 0xffff0000, v74
    v_lshlrev_b32 v136, 16, v86
    v_and_b32 v137, 0xffff0000, v86
    v_pk_fma_f32 v[120:121], v[116:117], v[136:137], v[120:121]
    v_cvt_pk_bf16_f32 v75, v118, v119
    v_lshlrev_b32 v118, 16, v75
    v_and_b32 v119, 0xffff0000, v75
    v_pk_mul_f32 v[118:119], v[118:119], v[130:131]
    v_cvt_pk_bf16_f32 v75, v118, v119
    v_lshlrev_b32 v118, 16, v75
    v_and_b32 v119, 0xffff0000, v75
    v_lshlrev_b32 v138, 16, v87
    v_and_b32 v139, 0xffff0000, v87
    v_pk_fma_f32 v[122:123], v[118:119], v[138:139], v[122:123]
    s_mov_b64 exec, -1
    v_pk_add_f32 v[120:121], v[120:121], v[122:123]
    v_add_f32 v120, v120, v121
    s_nop 1
    v_add_f32_dpp v120, v120, v120 quad_perm:[1,0,3,2] row_mask:0xf bank_mask:0xf
    s_nop 1
    v_add_f32_dpp v120, v120, v120 quad_perm:[2,3,0,1] row_mask:0xf bank_mask:0xf
    s_nop 1
    v_add_f32_dpp v120, v120, v120 row_ror:8 row_mask:0xf bank_mask:0xf
    v_mov_b32 v124, v120
    s_nop 1
    v_permlane16_swap_b32 v120, v124
    s_nop 1
    v_add_f32 v120, v120, v124
    v_mov_b32 v124, v120
    s_nop 1
    v_permlane32_swap_b32 v120, v124
    s_nop 1
    v_add_f32 v120, v120, v124
    v_cvt_pk_bf16_f32 v120, v120, v120
    v_and_b32 v120, 0xffff0000, v120
    v_ashrrev_i32 v122, 31, v120
    v_or_b32 v122, 0x80000000, v122
    v_xor_b32 v120, v120, v122
    v_and_b32 v120, 0xffff0000, v120
    v_sub_u32 v122, 2047, v240
    v_or_b32 v120, v120, v122
    s_nop 1
    v_mov_b32_dpp v121, v120 row_ror:4 row_mask:0xf bank_mask:0xf
    v_mov_b32 v122, s7
    v_mov_b32 v123, s93
    s_lshl_b32 s56, s2, 2
    s_add_u32 s56, s56, s3
    s_lshl_b32 s56, s56, 4
    s_add_u32 s56, s56, 3162112
    v_mov_b32 v29, 0
    s_mov_b64 exec, 1
    s_waitcnt vmcnt(6)
    buffer_store_dwordx4 v[120:123], v29, s[24:27], s56 offen sc1
    s_mov_b64 exec, -1
    s_add_u32 m0, s49, 126848
    s_nop 0
    buffer_load_dwordx4 v3, s[8:11], s36 offen offset:128 lds
    s_add_u32 m0, s49, 127744
    s_nop 0
    buffer_load_dwordx4 v3, s[8:11], s36 offen offset:256 lds
    s_add_u32 s36, s36, s37
    s_sub_u32 s55, s36, 7864320
    s_min_u32 s36, s36, s55
spin_ln:
    s_load_dwordx8 s[28:35], s[86:87], s46 glc
    s_add_u32 s101, s101, 1
    s_cmp_gt_u32 s101, 0x2000000
    s_cselect_b32 s57, 0, -1
    s_waitcnt lgkmcnt(0)
    s_xor_b32 s56, s28, s7
    s_xor_b32 s29, s29, s7
    s_or_b32 s56, s56, s29
    s_xor_b32 s30, s30, s7
    s_or_b32 s56, s56, s30
    s_xor_b32 s31, s31, s7
    s_or_b32 s56, s56, s31
    s_xor_b32 s32, s32, s7
    s_or_b32 s56, s56, s32
    s_xor_b32 s33, s33, s7
    s_or_b32 s56, s56, s33
    s_xor_b32 s34, s34, s7
    s_or_b32 s56, s56, s34
    s_xor_b32 s35, s35, s7
    s_or_b32 s56, s56, s35
    s_and_b32 s56, s56, s57
    s_cbranch_scc1 spin_ln
z_skip:
    s_add_u32 s46, s45, 0
    s_sub_u32 s5, s46, 81920
    s_min_u32 s46, s46, s5
    buffer_load_dwordx4 a[0:3], v28, s[20:23], s46 offen offset:0 sc1
    buffer_load_dwordx4 a[4:7], v28, s[20:23], s46 offen offset:1024 sc1
    buffer_load_dwordx4 a[8:11], v28, s[20:23], s46 offen offset:2048 sc1
    buffer_load_dwordx4 a[12:15], v28, s[20:23], s46 offen offset:3072 sc1
    s_add_u32 s46, s45, 4096
    s_sub_u32 s5, s46, 81920
    s_min_u32 s46, s46, s5
    buffer_load_dwordx4 a[16:19], v28, s[20:23], s46 offen offset:0 sc1
    buffer_load_dwordx4 a[20:23], v28, s[20:23], s46 offen offset:1024 sc1
    buffer_load_dwordx4 a[24:27], v28, s[20:23], s46 offen offset:2048 sc1
    buffer_load_dwordx4 a[28:31], v28, s[20:23], s46 offen offset:3072 sc1
    s_mov_b64 exec, 0
    s_cmp_eq_u32 s3, 0
    s_cbranch_scc1 pg_4
    s_cmp_eq_u32 s3, 1
    s_cbranch_scc1 pg_5
    s_cmp_eq_u32 s3, 2
    s_cbranch_scc1 pg_6
    s_cmp_eq_u32 s3, 3
    s_cbranch_scc1 pg_7
pg_ret2:
    s_mov_b64 exec, -1
    s_waitcnt vmcnt(33)
    s_barrier
    ds_read_b64_tr_b16 a[192:193], v8 offset:0
    ds_read_b64_tr_b16 a[194:195], v8 offset:6144
    ds_read_b64_tr_b16 a[196:197], v9 offset:0
    ds_read_b64_tr_b16 a[198:199], v9 offset:6144
    ds_read_b64_tr_b16 a[200:201], v10 offset:0
    ds_read_b64_tr_b16 a[202:203], v10 offset:6144
    ds_read_b64_tr_b16 a[204:205], v11 offset:0
    ds_read_b64_tr_b16 a[206:207], v11 offset:6144
    s_waitcnt lgkmcnt(4)
    s_waitcnt vmcnt(4)
head_code:
    v_mfma_f32_16x16x32_bf16 v[64:67], a[192:195], a[0:3], 0
    s_add_u32 s46, s45, 8192
    ds_read_b64_tr_b16 a[208:209], v8 offset:1024
    s_sub_u32 s77, s46, 81920
    v_mfma_f32_16x16x32_bf16 v[68:71], a[196:199], a[0:3], 0
    s_min_u32 s46, s46, s77
    ds_read_b64_tr_b16 a[210:211], v8 offset:7168
    v_mfma_f32_16x16x32_bf16 v[76:79], a[196:199], a[4:7], 0
    buffer_load_dwordx4 a[32:35], v28, s[20:23], s46 offen offset:0 sc1
    v_mfma_f32_16x16x32_bf16 v[72:75], a[192:195], a[4:7], 0
    v_mfma_f32_16x16x32_bf16 v[80:83], a[192:195], a[8:11], 0
    ds_read_b64_tr_b16 a[212:213], v9 offset:1024
    v_mfma_f32_16x16x32_bf16 v[84:87], a[196:199], a[8:11], 0
    ds_read_b64_tr_b16 a[214:215], v9 offset:7168
    v_mfma_f32_16x16x32_bf16 v[92:95], a[196:199], a[12:15], 0
    v_mfma_f32_16x16x32_bf16 v[88:91], a[192:195], a[12:15], 0
    s_waitcnt lgkmcnt(4)
    v_mfma_f32_16x16x32_bf16 v[120:123], a[200:203], a[12:15], 0
    ds_read_b64_tr_b16 a[192:193], v10 offset:1024
    v_mul_u32_u24 v56, 3072, v5
    v_mfma_f32_16x16x32_bf16 v[124:127], a[204:207], a[12:15], 0
    ds_read_b64_tr_b16 a[194:195], v10 offset:7168
    v_add_u32 v56, v56, v7
    v_mfma_f32_16x16x32_bf16 v[116:119], a[204:207], a[8:11], 0
    buffer_load_dwordx4 a[36:39], v28, s[20:23], s46 offen offset:1024 sc1
    v_mfma_f32_16x16x32_bf16 v[112:115], a[200:203], a[8:11], 0
    v_add_u32 v57, 49152, v56
    v_lshrrev_b32 v29, 3, v1
    v_mfma_f32_16x16x32_bf16 v[104:107], a[200:203], a[4:7], 0
    ds_read_b64_tr_b16 a[196:197], v11 offset:1024
    v_mul_u32_u24 v62, 1280, v29
    v_mfma_f32_16x16x32_bf16 v[108:111], a[204:207], a[4:7], 0
    ds_read_b64_tr_b16 a[198:199], v11 offset:7168
    v_add_u32 v62, v62, v7
    v_mfma_f32_16x16x32_bf16 v[100:103], a[204:207], a[0:3], 0
    v_add_u32 v63, 10240, v62
    v_mul_u32_u24 v31, 384, v29
    v_mfma_f32_16x16x32_bf16 v[96:99], a[200:203], a[0:3], 0
    s_waitcnt lgkmcnt(4)
    v_add_u32 v6, v31, v7
    v_add_u32 v7, 3072, v6
    v_mfma_f32_16x16x32_bf16 v[128:131], a[208:211], a[0:3], 0
    ds_read_b64_tr_b16 a[200:201], v8 offset:2048
    v_bfe_u32 v29, v1, 4, 1
    v_mfma_f32_16x16x32_bf16 v[132:135], a[212:215], a[0:3], 0
    ds_read_b64_tr_b16 a[202:203], v8 offset:8192
    v_bfe_u32 v30, v1, 5, 1
    v_mfma_f32_16x16x32_bf16 v[140:143], a[212:215], a[4:7], 0
    buffer_load_dwordx4 a[40:43], v28, s[20:23], s46 offen offset:2048 sc1
    v_mfma_f32_16x16x32_bf16 v[136:139], a[208:211], a[4:7], 0
    v_lshl_add_u32 v29, v29, 1, v30
    v_and_b32 v30, 7, v1
    v_mfma_f32_16x16x32_bf16 v[144:147], a[208:211], a[8:11], 0
    ds_read_b64_tr_b16 a[204:205], v9 offset:2048
    v_xor_b32 v30, v30, v29
    v_mfma_f32_16x16x32_bf16 v[148:151], a[212:215], a[8:11], 0
    ds_read_b64_tr_b16 a[206:207], v9 offset:8192
    v_lshl_add_u32 v4, v30, 4, v31
    v_mfma_f32_16x16x32_bf16 v[156:159], a[212:215], a[12:15], 0
    buffer_load_dwordx4 a[44:47], v28, s[20:23], s46 offen offset:3072 sc1
    v_mfma_f32_16x16x32_bf16 v[152:155], a[208:211], a[12:15], 0
    s_waitcnt lgkmcnt(4)
    v_xor_b32 v30, 4, v30
    v_lshl_add_u32 v5, v30, 4, v31
    v_mfma_f32_16x16x32_bf16 v[184:187], a[192:195], a[12:15], 0
    s_add_u32 s46, s45, 12288
    ds_read_b64_tr_b16 a[208:209], v10 offset:2048
    v_add_u32 v5, 3072, v5
    v_mfma_f32_16x16x32_bf16 v[188:191], a[196:199], a[12:15], 0
    s_sub_u32 s77, s46, 81920
    ds_read_b64_tr_b16 a[210:211], v10 offset:8192
    v_bfe_u32 v30, v1, 1, 1
    v_mfma_f32_16x16x32_bf16 v[180:183], a[196:199], a[8:11], 0
    s_min_u32 s46, s46, s77
    v_bfe_u32 v31, v1, 2, 1
    v_lshl_add_u32 v30, v30, 1, v31
    v_mfma_f32_16x16x32_bf16 v[176:179], a[192:195], a[8:11], 0
    v_bfe_u32 v31, v1, 3, 1
    v_lshl_add_u32 v30, v31, 2, v30
    v_mfma_f32_16x16x32_bf16 v[168:171], a[192:195], a[4:7], 0
    ds_read_b64_tr_b16 a[212:213], v11 offset:2048
    v_xor_b32 v30, v30, v29
    v_mfma_f32_16x16x32_bf16 v[172:175], a[196:199], a[4:7], 0
    ds_read_b64_tr_b16 a[214:215], v11 offset:8192
    v_lshlrev_b32 v30, 4, v30
    v_mfma_f32_16x16x32_bf16 v[164:167], a[196:199], a[0:3], 0
    buffer_load_dwordx4 a[48:51], v28, s[20:23], s46 offen offset:0 sc1
    v_mfma_f32_16x16x32_bf16 v[160:163], a[192:195], a[0:3], 0
    s_waitcnt lgkmcnt(4)
    v_mul_u32_u24 v31, 3072, v31
    v_and_b32 v29, 7, v1
    v_mfma_f32_16x16x32_bf16 v[192:195], a[200:203], a[0:3], 0
    ds_read_b64_tr_b16 a[192:193], v8 offset:12288
    v_lshl_add_u32 v31, v29, 7, v31
    v_mfma_f32_16x16x32_bf16 v[196:199], a[204:207], a[0:3], 0
    ds_read_b64_tr_b16 a[194:195], v8 offset:18432
    v_subrev_u32 v31, s49, v31
    v_mfma_f32_16x16x32_bf16 v[204:207], a[204:207], a[4:7], 0
    buffer_load_dwordx4 a[52:55], v28, s[20:23], s46 offen offset:1024 sc1
    v_mfma_f32_16x16x32_bf16 v[200:203], a[200:203], a[4:7], 0
    v_add_u32 v18, v31, v30
    v_xor_b32 v30, 64, v30
    v_mfma_f32_16x16x32_bf16 v[208:211], a[200:203], a[8:11], 0
    ds_read_b64_tr_b16 a[196:197], v9 offset:12288
    v_add_u32 v19, v31, v30
    v_mfma_f32_16x16x32_bf16 v[212:215], a[204:207], a[8:11], 0
    s_mul_i32 s56, s50, 786432
    ds_read_b64_tr_b16 a[198:199], v9 offset:18432
    s_add_u32 s56, s56, 589824
    v_mfma_f32_16x16x32_bf16 v[220:223], a[204:207], a[12:15], 0
    s_add_u32 s12, s66, s56
    s_addc_u32 s13, s67, 0
    s_and_b32 s13, s13, 0xffff
    v_mfma_f32_16x16x32_bf16 v[216:219], a[200:203], a[12:15], 0
    s_waitcnt lgkmcnt(4)
    s_mov_b32 s14, 196608
    s_mov_b32 s15, 0x00020000
    v_mfma_f32_16x16x32_bf16 v[248:251], a[208:211], a[12:15], 0
    s_add_u32 s16, s68, s56
    s_addc_u32 s17, s69, 0
    ds_read_b64_tr_b16 a[200:201], v10 offset:12288
    v_mfma_f32_16x16x32_bf16 v[252:255], a[212:215], a[12:15], 0
    s_and_b32 s17, s17, 0xffff
    ds_read_b64_tr_b16 a[202:203], v10 offset:18432
    s_mov_b32 s18, 196608
    v_mfma_f32_16x16x32_bf16 v[244:247], a[212:215], a[8:11], 0
    buffer_load_dwordx4 a[56:59], v28, s[20:23], s46 offen offset:2048 sc1
    v_mfma_f32_16x16x32_bf16 v[240:243], a[208:211], a[8:11], 0
    s_mov_b32 s19, 0x00020000
    s_mov_b32 s28, s78
    s_and_b32 s29, s79, 0xffff
    v_mfma_f32_16x16x32_bf16 v[232:235], a[208:211], a[4:7], 0
    s_mov_b32 s30, 1966080
    ds_read_b64_tr_b16 a[204:205], v11 offset:12288
    s_mov_b32 s31, 0x00020000
    v_mfma_f32_16x16x32_bf16 v[236:239], a[212:215], a[4:7], 0
    s_waitcnt vmcnt(7)
    ds_read_b64_tr_b16 a[206:207], v11 offset:18432
    s_mov_b32 s32, s80
    v_mfma_f32_16x16x32_bf16 v[228:231], a[212:215], a[0:3], 0
    s_and_b32 s33, s81, 0xffff
    s_mov_b32 s34, 1966080
    s_mov_b32 s35, 0x00020000
    v_mfma_f32_16x16x32_bf16 v[224:227], a[208:211], a[0:3], 0
    s_waitcnt lgkmcnt(4)
    s_mov_b32 s5, s58
    s_min_u32 s58, s2, 239
    v_mfma_f32_16x16x32_bf16 v[64:67], a[192:195], a[16:19], v[64:67]
    s_mul_hi_u32 s56, s58, 178956971
    ds_read_b64_tr_b16 a[208:209], v8 offset:13312
    s_mul_i32 s57, s56, 24
    v_mfma_f32_16x16x32_bf16 v[68:71], a[196:199], a[16:19], v[68:71]
    s_sub_u32 s57, s58, s57
    ds_read_b64_tr_b16 a[210:211], v8 offset:19456
    s_lshl_b32 s60, s56, 6
    v_mfma_f32_16x16x32_bf16 v[76:79], a[196:199], a[20:23], v[76:79]
    buffer_load_dwordx4 a[60:63], v28, s[20:23], s46 offen offset:3072 sc1
    v_mfma_f32_16x16x32_bf16 v[72:75], a[192:195], a[20:23], v[72:75]
    s_add_u32 s46, s45, 16384
    s_sub_u32 s77, s46, 81920
    s_min_u32 s46, s46, s77
    v_mfma_f32_16x16x32_bf16 v[80:83], a[192:195], a[24:27], v[80:83]
    s_add_u32 s60, s60, s59
    ds_read_b64_tr_b16 a[212:213], v9 offset:13312
    s_mul_i32 s60, s60, 3072
    v_mfma_f32_16x16x32_bf16 v[84:87], a[196:199], a[24:27], v[84:87]
    s_lshl_b32 s44, s57, 7
    ds_read_b64_tr_b16 a[214:215], v9 offset:19456
    s_add_u32 s60, s60, s44
    v_mfma_f32_16x16x32_bf16 v[92:95], a[196:199], a[28:31], v[92:95]
    buffer_load_dwordx4 a[64:67], v28, s[20:23], s46 offen offset:0 sc1
    v_mfma_f32_16x16x32_bf16 v[88:91], a[192:195], a[28:31], v[88:91]
    s_waitcnt lgkmcnt(4)
    s_lshl_b32 s61, s56, 7
    s_mul_i32 s62, s56, 1536
    v_mfma_f32_16x16x32_bf16 v[120:123], a[200:203], a[28:31], v[120:123]
    s_lshl_b32 s44, s57, 6
    ds_read_b64_tr_b16 a[192:193], v10 offset:13312
    s_add_u32 s62, s62, s44
    v_mfma_f32_16x16x32_bf16 v[124:127], a[204:207], a[28:31], v[124:127]
    s_lshl_b32 s44, s3, 4
    ds_read_b64_tr_b16 a[194:195], v10 offset:19456
    s_add_u32 s62, s62, s44
    v_mfma_f32_16x16x32_bf16 v[116:119], a[204:207], a[24:27], v[116:119]
    s_lshl_b32 s62, s62, 4
    s_add_u32 s62, s62, 3276800
    s_lshl_b32 s4, s2, 8
    v_mfma_f32_16x16x32_bf16 v[112:115], a[200:203], a[24:27], v[112:115]
    s_lshl_b32 s44, s3, 2
    s_add_u32 s4, s4, s44
    s_add_u32 s4, s4, 268369920
    v_mfma_f32_16x16x32_bf16 v[104:107], a[200:203], a[20:23], v[104:107]
    s_mov_b32 s92, 0xbfb8aa3b
    ds_read_b64_tr_b16 a[196:197], v11 offset:13312
    s_lshl_b32 s44, s3, 12
    v_mfma_f32_16x16x32_bf16 v[108:111], a[204:207], a[20:23], v[108:111]
    s_mov_b32 s38, s49
    ds_read_b64_tr_b16 a[198:199], v11 offset:19456
    s_mov_b32 s40, s49
    v_mfma_f32_16x16x32_bf16 v[100:103], a[204:207], a[16:19], v[100:103]
    buffer_load_dwordx4 a[68:71], v28, s[20:23], s46 offen offset:1024 sc1
    v_mfma_f32_16x16x32_bf16 v[96:99], a[200:203], a[16:19], v[96:99]
    s_waitcnt lgkmcnt(4)
    s_mov_b32 s39, 24576
    s_mov_b32 s47, 3162112
    v_mfma_f32_16x16x32_bf16 v[128:131], a[208:211], a[16:19], v[128:131]
    s_mov_b32 s88, 0xaaaaaaaa
    ds_read_b64_tr_b16 a[200:201], v8 offset:14336
    s_mov_b32 s89, 0xaaaaaaaa
    v_mfma_f32_16x16x32_bf16 v[132:135], a[212:215], a[16:19], v[132:135]
    ds_read_b64_tr_b16 a[202:203], v8 offset:20480
    v_mfma_f32_16x16x32_bf16 v[140:143], a[212:215], a[20:23], v[140:143]
    v_add_u32 v8, 73728, v12
    v_mfma_f32_16x16x32_bf16 v[136:139], a[208:211], a[20:23], v[136:139]
    buffer_load_dwordx4 a[72:75], v28, s[20:23], s46 offen offset:2048 sc1
    v_mfma_f32_16x16x32_bf16 v[144:147], a[208:211], a[24:27], v[144:147]
    ds_read_b64_tr_b16 a[204:205], v9 offset:14336
    v_mfma_f32_16x16x32_bf16 v[148:151], a[212:215], a[24:27], v[148:151]
    ds_read_b64_tr_b16 a[206:207], v9 offset:20480
    v_mfma_f32_16x16x32_bf16 v[156:159], a[212:215], a[28:31], v[156:159]
    v_add_u32 v9, 73728, v13
    v_mfma_f32_16x16x32_bf16 v[152:155], a[208:211], a[28:31], v[152:155]
    s_waitcnt lgkmcnt(4)
    v_mfma_f32_16x16x32_bf16 v[184:187], a[192:195], a[28:31], v[184:187]
    ds_read_b64_tr_b16 a[208:209], v10 offset:14336
    v_mfma_f32_16x16x32_bf16 v[188:191], a[196:199], a[28:31], v[188:191]
    ds_read_b64_tr_b16 a[210:211], v10 offset:20480
    v_mfma_f32_16x16x32_bf16 v[180:183], a[196:199], a[24:27], v[180:183]
    buffer_load_dwordx4 a[76:79], v28, s[20:23], s46 offen offset:3072 sc1
    v_mfma_f32_16x16x32_bf16 v[176:179], a[192:195], a[24:27], v[176:179]
    v_add_u32 v10, 73728, v14
    v_mfma_f32_16x16x32_bf16 v[168:171], a[192:195], a[20:23], v[168:171]
    s_add_u32 s46, s45, 20480
    ds_read_b64_tr_b16 a[212:213], v11 offset:14336
    s_sub_u32 s77, s46, 81920
    v_mfma_f32_16x16x32_bf16 v[172:175], a[196:199], a[20:23], v[172:175]
    s_waitcnt vmcnt(35)
    ds_read_b64_tr_b16 a[214:215], v11 offset:20480
    s_min_u32 s46, s46, s77
    v_mfma_f32_16x16x32_bf16 v[164:167], a[196:199], a[16:19], v[164:167]
    s_barrier
    v_mfma_f32_16x16x32_bf16 v[160:163], a[192:195], a[16:19], v[160:163]
    s_waitcnt lgkmcnt(4)
    v_add_u32 v11, 73728, v15
    v_mfma_f32_16x16x32_bf16 v[192:195], a[200:203], a[16:19], v[192:195]
    ds_read_b64_tr_b16 a[192:193], v8 offset:0
    v_mfma_f32_16x16x32_bf16 v[196:199], a[204:207], a[16:19], v[196:199]
    ds_read_b64_tr_b16 a[194:195], v8 offset:6144
    v_mfma_f32_16x16x32_bf16 v[204:207], a[204:207], a[20:23], v[204:207]
    buffer_load_dwordx4 a[80:83], v28, s[20:23], s46 offen offset:0 sc1
    v_mfma_f32_16x16x32_bf16 v[200:203], a[200:203], a[20:23], v[200:203]
    v_mfma_f32_16x16x32_bf16 v[208:211], a[200:203], a[24:27], v[208:211]
    ds_read_b64_tr_b16 a[196:197], v8 offset:12288
    v_mfma_f32_16x16x32_bf16 v[212:215], a[204:207], a[24:27], v[212:215]
    ds_read_b64_tr_b16 a[198:199], v8 offset:18432
    v_mfma_f32_16x16x32_bf16 v[220:223], a[204:207], a[28:31], v[220:223]
    buffer_load_dwordx4 a[84:87], v28, s[20:23], s46 offen offset:1024 sc1
    v_mfma_f32_16x16x32_bf16 v[216:219], a[200:203], a[28:31], v[216:219]
    s_waitcnt lgkmcnt(4)
    v_mfma_f32_16x16x32_bf16 v[248:251], a[208:211], a[28:31], v[248:251]
    ds_read_b64_tr_b16 a[200:201], v9 offset:0
    v_mfma_f32_16x16x32_bf16 v[252:255], a[212:215], a[28:31], v[252:255]
    ds_read_b64_tr_b16 a[202:203], v9 offset:6144
    v_mfma_f32_16x16x32_bf16 v[244:247], a[212:215], a[24:27], v[244:247]
    v_mfma_f32_16x16x32_bf16 v[240:243], a[208:211], a[24:27], v[240:243]
    v_mfma_f32_16x16x32_bf16 v[232:235], a[208:211], a[20:23], v[232:235]
    ds_read_b64_tr_b16 a[204:205], v9 offset:12288
    v_mfma_f32_16x16x32_bf16 v[236:239], a[212:215], a[20:23], v[236:239]
    s_waitcnt vmcnt(10)
    s_waitcnt vmcnt(6)
    ds_read_b64_tr_b16 a[206:207], v9 offset:18432
    v_mfma_f32_16x16x32_bf16 v[228:231], a[212:215], a[16:19], v[228:231]
    buffer_load_dwordx4 a[88:91], v28, s[20:23], s46 offen offset:2048 sc1
    v_mfma_f32_16x16x32_bf16 v[224:227], a[208:211], a[16:19], v[224:227]
    s_waitcnt lgkmcnt(4)
    v_mfma_f32_16x16x32_bf16 v[64:67], a[192:195], a[32:35], v[64:67]
    ds_read_b64_tr_b16 a[208:209], v10 offset:0
    v_mfma_f32_16x16x32_bf16 v[64:67], a[196:199], a[48:51], v[64:67]
    ds_read_b64_tr_b16 a[210:211], v10 offset:6144
    v_mfma_f32_16x16x32_bf16 v[72:75], a[196:199], a[52:55], v[72:75]
    v_mfma_f32_16x16x32_bf16 v[72:75], a[192:195], a[36:39], v[72:75]
    buffer_load_dwordx4 a[92:95], v28, s[20:23], s46 offen offset:3072 sc1
    v_mfma_f32_16x16x32_bf16 v[80:83], a[192:195], a[40:43], v[80:83]
    ds_read_b64_tr_b16 a[212:213], v10 offset:12288
    v_mfma_f32_16x16x32_bf16 v[80:83], a[196:199], a[56:59], v[80:83]
    ds_read_b64_tr_b16 a[214:215], v10 offset:18432
    v_mfma_f32_16x16x32_bf16 v[88:91], a[196:199], a[60:63], v[88:91]
    s_add_u32 s46, s45, 24576
    s_sub_u32 s77, s46, 81920
    s_min_u32 s46, s46, s77
    v_mfma_f32_16x16x32_bf16 v[88:91], a[192:195], a[44:47], v[88:91]
    s_waitcnt lgkmcnt(4)
    v_mfma_f32_16x16x32_bf16 v[92:95], a[200:203], a[44:47], v[92:95]
    ds_read_b64_tr_b16 a[192:193], v11 offset:0
    v_mfma_f32_16x16x32_bf16 v[92:95], a[204:207], a[60:63], v[92:95]
    ds_read_b64_tr_b16 a[194:195], v11 offset:6144
    v_mfma_f32_16x16x32_bf16 v[84:87], a[204:207], a[56:59], v[84:87]
    buffer_load_dwordx4 a[96:99], v28, s[20:23], s46 offen offset:0 sc1
    v_mfma_f32_16x16x32_bf16 v[84:87], a[200:203], a[40:43], v[84:87]
    v_mfma_f32_16x16x32_bf16 v[76:79], a[200:203], a[36:39], v[76:79]
    ds_read_b64_tr_b16 a[196:197], v11 offset:12288
    v_mfma_f32_16x16x32_bf16 v[76:79], a[204:207], a[52:55], v[76:79]
    ds_read_b64_tr_b16 a[198:199], v11 offset:18432
    v_mfma_f32_16x16x32_bf16 v[68:71], a[204:207], a[48:51], v[68:71]
    v_mfma_f32_16x16x32_bf16 v[68:71], a[200:203], a[32:35], v[68:71]
pg_1:
    s_cbranch_execz pg_ret
    s_waitcnt lgkmcnt(4)
    v_mfma_f32_16x16x32_bf16 v[96:99], a[208:211], a[32:35], v[96:99]
    ds_read_b64_tr_b16 a[200:201], v8 offset:1024
    v_mfma_f32_16x16x32_bf16 v[96:99], a[212:215], a[48:51], v[96:99]
    ds_read_b64_tr_b16 a[202:203], v8 offset:7168
    v_mfma_f32_16x16x32_bf16 v[104:107], a[212:215], a[52:55], v[104:107]
    buffer_load_dwordx4 a[100:103], v28, s[20:23], s46 offen offset:1024 sc1
    v_mfma_f32_16x16x32_bf16 v[104:107], a[208:211], a[36:39], v[104:107]
    v_mfma_f32_16x16x32_bf16 v[112:115], a[208:211], a[40:43], v[112:115]
    ds_read_b64_tr_b16 a[204:205], v8 offset:13312
    v_mfma_f32_16x16x32_bf16 v[112:115], a[212:215], a[56:59], v[112:115]
    ds_read_b64_tr_b16 a[206:207], v8 offset:19456
    v_mfma_f32_16x16x32_bf16 v[120:123], a[212:215], a[60:63], v[120:123]
    v_mfma_f32_16x16x32_bf16 v[120:123], a[208:211], a[44:47], v[120:123]
    s_waitcnt lgkmcnt(4)
    v_mfma_f32_16x16x32_bf16 v[124:127], a[192:195], a[44:47], v[124:127]
    ds_read_b64_tr_b16 a[208:209], v9 offset:1024
    v_mfma_f32_16x16x32_bf16 v[124:127], a[196:199], a[60:63], v[124:127]
    ds_read_b64_tr_b16 a[210:211], v9 offset:7168
    v_mfma_f32_16x16x32_bf16 v[116:119], a[196:199], a[56:59], v[116:119]
    buffer_load_dwordx4 a[104:107], v28, s[20:23], s46 offen offset:2048 sc1
    v_mfma_f32_16x16x32_bf16 v[116:119], a[192:195], a[40:43], v[116:119]
    v_mfma_f32_16x16x32_bf16 v[108:111], a[192:195], a[36:39], v[108:111]
    ds_read_b64_tr_b16 a[212:213], v9 offset:13312
    v_mfma_f32_16x16x32_bf16 v[108:111], a[196:199], a[52:55], v[108:111]
    ds_read_b64_tr_b16 a[214:215], v9 offset:19456
    v_mfma_f32_16x16x32_bf16 v[100:103], a[196:199], a[48:51], v[100:103]
    buffer_load_dwordx4 a[108:111], v28, s[20:23], s46 offen offset:3072 sc1
    v_mfma_f32_16x16x32_bf16 v[100:103], a[192:195], a[32:35], v[100:103]
    s_waitcnt lgkmcnt(4)
    v_mfma_f32_16x16x32_bf16 v[128:131], a[200:203], a[32:35], v[128:131]
    ds_read_b64_tr_b16 a[192:193], v10 offset:1024
    v_mfma_f32_16x16x32_bf16 v[128:131], a[204:207], a[48:51], v[128:131]
    ds_read_b64_tr_b16 a[194:195], v10 offset:7168
    v_mfma_f32_16x16x32_bf16 v[136:139], a[204:207], a[52:55], v[136:139]
    v_mfma_f32_16x16x32_bf16 v[136:139], a[200:203], a[36:39], v[136:139]
    s_add_u32 m0, s49, 0
    v_mfma_f32_16x16x32_bf16 v[144:147], a[200:203], a[40:43], v[144:147]
    ds_read_b64_tr_b16 a[196:197], v10 offset:13312
    v_mfma_f32_16x16x32_bf16 v[144:147], a[204:207], a[56:59], v[144:147]
    ds_read_b64_tr_b16 a[198:199], v10 offset:19456
    v_mfma_f32_16x16x32_bf16 v[152:155], a[204:207], a[60:63], v[152:155]
    buffer_load_dwordx4 v2, s[8:11], s36 offen offset:0 lds
    v_mfma_f32_16x16x32_bf16 v[152:155], a[200:203], a[44:47], v[152:155]
    s_waitcnt lgkmcnt(4)
    v_mfma_f32_16x16x32_bf16 v[156:159], a[208:211], a[44:47], v[156:159]
    ds_read_b64_tr_b16 a[200:201], v11 offset:1024
    v_mfma_f32_16x16x32_bf16 v[156:159], a[212:215], a[60:63], v[156:159]
    s_add_u32 m0, s49, 896
    ds_read_b64_tr_b16 a[202:203], v11 offset:7168
    v_mfma_f32_16x16x32_bf16 v[148:151], a[212:215], a[56:59], v[148:151]
    buffer_load_dwordx4 v2, s[8:11], s36 offen offset:128 lds
    v_mfma_f32_16x16x32_bf16 v[148:151], a[208:211], a[40:43], v[148:151]
    v_mfma_f32_16x16x32_bf16 v[140:143], a[208:211], a[36:39], v[140:143]
    ds_read_b64_tr_b16 a[204:205], v11 offset:13312
    v_mfma_f32_16x16x32_bf16 v[140:143], a[212:215], a[52:55], v[140:143]
    ds_read_b64_tr_b16 a[206:207], v11 offset:19456
    v_mfma_f32_16x16x32_bf16 v[132:135], a[212:215], a[48:51], v[132:135]
    v_mfma_f32_16x16x32_bf16 v[132:135], a[208:211], a[32:35], v[132:135]
    s_waitcnt lgkmcnt(4)
    v_mfma_f32_16x16x32_bf16 v[160:163], a[192:195], a[32:35], v[160:163]
    s_add_u32 m0, s49, 1792
    ds_read_b64_tr_b16 a[208:209], v8 offset:2048
    v_mfma_f32_16x16x32_bf16 v[160:163], a[196:199], a[48:51], v[160:163]
    ds_read_b64_tr_b16 a[210:211], v8 offset:8192
    v_mfma_f32_16x16x32_bf16 v[168:171], a[196:199], a[52:55], v[168:171]
    buffer_load_dwordx4 v2, s[8:11], s36 offen offset:256 lds
    v_mfma_f32_16x16x32_bf16 v[168:171], a[192:195], a[36:39], v[168:171]
    v_mfma_f32_16x16x32_bf16 v[176:179], a[192:195], a[40:43], v[176:179]
    ds_read_b64_tr_b16 a[212:213], v8 offset:14336
    v_mfma_f32_16x16x32_bf16 v[176:179], a[196:199], a[56:59], v[176:179]
    ds_read_b64_tr_b16 a[214:215], v8 offset:20480
    v_mfma_f32_16x16x32_bf16 v[184:187], a[196:199], a[60:63], v[184:187]
    s_add_u32 m0, s49, 3072
    v_add_u32 v8, 98304, v12
    v_mfma_f32_16x16x32_bf16 v[184:187], a[192:195], a[44:47], v[184:187]
    s_waitcnt lgkmcnt(4)
    v_mfma_f32_16x16x32_bf16 v[188:191], a[200:203], a[44:47], v[188:191]
    ds_read_b64_tr_b16 a[192:193], v9 offset:2048
    v_mfma_f32_16x16x32_bf16 v[188:191], a[204:207], a[60:63], v[188:191]
    ds_read_b64_tr_b16 a[194:195], v9 offset:8192
    v_mfma_f32_16x16x32_bf16 v[180:183], a[204:207], a[56:59], v[180:183]
    buffer_load_dwordx4 v3, s[8:11], s36 offen offset:0 lds
    v_mfma_f32_16x16x32_bf16 v[180:183], a[200:203], a[40:43], v[180:183]
    v_mfma_f32_16x16x32_bf16 v[172:175], a[200:203], a[36:39], v[172:175]
    ds_read_b64_tr_b16 a[196:197], v9 offset:14336
    v_mfma_f32_16x16x32_bf16 v[172:175], a[204:207], a[52:55], v[172:175]
    s_add_u32 m0, s49, 3968
    ds_read_b64_tr_b16 a[198:199], v9 offset:20480
    v_mfma_f32_16x16x32_bf16 v[164:167], a[204:207], a[48:51], v[164:167]
    buffer_load_dwordx4 v3, s[8:11], s36 offen offset:128 lds
    v_mfma_f32_16x16x32_bf16 v[164:167], a[200:203], a[32:35], v[164:167]
    s_waitcnt lgkmcnt(4)
    v_add_u32 v9, 98304, v13
    v_mfma_f32_16x16x32_bf16 v[192:195], a[208:211], a[32:35], v[192:195]
    ds_read_b64_tr_b16 a[200:201], v10 offset:2048
    v_mfma_f32_16x16x32_bf16 v[192:195], a[212:215], a[48:51], v[192:195]
    ds_read_b64_tr_b16 a[202:203], v10 offset:8192
    v_mfma_f32_16x16x32_bf16 v[200:203], a[212:215], a[52:55], v[200:203]
    v_mfma_f32_16x16x32_bf16 v[200:203], a[208:211], a[36:39], v[200:203]
    s_add_u32 m0, s49, 4864
    v_mfma_f32_16x16x32_bf16 v[208:211], a[208:211], a[40:43], v[208:211]
    ds_read_b64_tr_b16 a[204:205], v10 offset:14336
    v_mfma_f32_16x16x32_bf16 v[208:211], a[212:215], a[56:59], v[208:211]
    ds_read_b64_tr_b16 a[206:207], v10 offset:20480
    v_mfma_f32_16x16x32_bf16 v[216:219], a[212:215], a[60:63], v[216:219]
    buffer_load_dwordx4 v3, s[8:11], s36 offen offset:256 lds
    v_mfma_f32_16x16x32_bf16 v[216:219], a[208:211], a[44:47], v[216:219]
    s_waitcnt lgkmcnt(4)
    v_add_u32 v10, 98304, v14
    s_add_u32 s36, s36, s37
    v_mfma_f32_16x16x32_bf16 v[220:223], a[192:195], a[44:47], v[220:223]
    s_sub_u32 s55, s36, 7864320
    ds_read_b64_tr_b16 a[208:209], v11 offset:2048
    s_min_u32 s36, s36, s55
    v_mfma_f32_16x16x32_bf16 v[220:223], a[196:199], a[60:63], v[220:223]
    s_add_u32 s46, s45, 28672
    ds_read_b64_tr_b16 a[210:211], v11 offset:8192
    s_sub_u32 s77, s46, 81920
    v_mfma_f32_16x16x32_bf16 v[212:215], a[196:199], a[56:59], v[212:215]
    s_min_u32 s46, s46, s77
    v_mfma_f32_16x16x32_bf16 v[212:215], a[192:195], a[40:43], v[212:215]
    buffer_load_dwordx4 a[112:115], v28, s[20:23], s46 offen offset:0 sc1
    v_mfma_f32_16x16x32_bf16 v[204:207], a[192:195], a[36:39], v[204:207]
    ds_read_b64_tr_b16 a[212:213], v11 offset:14336
    v_mfma_f32_16x16x32_bf16 v[204:207], a[196:199], a[52:55], v[204:207]
    s_waitcnt vmcnt(42)
    ds_read_b64_tr_b16 a[214:215], v11 offset:20480
    v_mfma_f32_16x16x32_bf16 v[196:199], a[196:199], a[48:51], v[196:199]
    s_barrier
    v_mfma_f32_16x16x32_bf16 v[196:199], a[192:195], a[32:35], v[196:199]
    s_waitcnt lgkmcnt(4)
    v_add_u32 v11, 98304, v15
    v_mfma_f32_16x16x32_bf16 v[224:227], a[200:203], a[32:35], v[224:227]
    ds_read_b64_tr_b16 a[192:193], v8 offset:0
    v_mfma_f32_16x16x32_bf16 v[224:227], a[204:207], a[48:51], v[224:227]
    ds_read_b64_tr_b16 a[194:195], v8 offset:6144
    v_mfma_f32_16x16x32_bf16 v[232:235], a[204:207], a[52:55], v[232:235]
    buffer_load_dwordx4 a[116:119], v28, s[20:23], s46 offen offset:1024 sc1
    v_mfma_f32_16x16x32_bf16 v[232:235], a[200:203], a[36:39], v[232:235]
    v_mfma_f32_16x16x32_bf16 v[240:243], a[200:203], a[40:43], v[240:243]
    ds_read_b64_tr_b16 a[196:197], v8 offset:12288
    v_mov_b32 v23, 0
    v_mfma_f32_16x16x32_bf16 v[240:243], a[204:207], a[56:59], v[240:243]
    ds_read_b64_tr_b16 a[198:199], v8 offset:18432
    v_mfma_f32_16x16x32_bf16 v[248:251], a[204:207], a[60:63], v[248:251]
    buffer_load_dword a218, v23, s[24:27], s4 offen offset:128 sc1
    v_mfma_f32_16x16x32_bf16 v[248:251], a[200:203], a[44:47], v[248:251]
    s_waitcnt lgkmcnt(4)
    v_mfma_f32_16x16x32_bf16 v[252:255], a[208:211], a[44:47], v[252:255]
    ds_read_b64_tr_b16 a[200:201], v9 offset:0
    v_mfma_f32_16x16x32_bf16 v[252:255], a[212:215], a[60:63], v[252:255]
    ds_read_b64_tr_b16 a[202:203], v9 offset:6144
    v_mfma_f32_16x16x32_bf16 v[244:247], a[212:215], a[56:59], v[244:247]
    buffer_load_dwordx4 a[120:123], v28, s[20:23], s46 offen offset:2048 sc1
    v_mfma_f32_16x16x32_bf16 v[244:247], a[208:211], a[40:43], v[244:247]
    v_mfma_f32_16x16x32_bf16 v[236:239], a[208:211], a[36:39], v[236:239]
    ds_read_b64_tr_b16 a[204:205], v9 offset:12288
    v_mfma_f32_16x16x32_bf16 v[236:239], a[212:215], a[52:55], v[236:239]
    s_waitcnt vmcnt(18)
    s_waitcnt vmcnt(14)
    ds_read_b64_tr_b16 a[206:207], v9 offset:18432
    v_mfma_f32_16x16x32_bf16 v[228:231], a[212:215], a[48:51], v[228:231]
    buffer_load_dwordx4 a[124:127], v28, s[20:23], s46 offen offset:3072 sc1
    v_mfma_f32_16x16x32_bf16 v[228:231], a[208:211], a[32:35], v[228:231]
    s_waitcnt lgkmcnt(4)
    v_mfma_f32_16x16x32_bf16 v[64:67], a[192:195], a[64:67], v[64:67]
    ds_read_b64_tr_b16 a[208:209], v10 offset:0
    v_mfma_f32_16x16x32_bf16 v[64:67], a[196:199], a[80:83], v[64:67]
    s_add_u32 s46, s45, 32768
    ds_read_b64_tr_b16 a[210:211], v10 offset:6144
    s_sub_u32 s77, s46, 81920
    v_mfma_f32_16x16x32_bf16 v[72:75], a[196:199], a[84:87], v[72:75]
    s_min_u32 s46, s46, s77
    v_mfma_f32_16x16x32_bf16 v[72:75], a[192:195], a[68:71], v[72:75]
    v_mfma_f32_16x16x32_bf16 v[80:83], a[192:195], a[72:75], v[80:83]
    ds_read_b64_tr_b16 a[212:213], v10 offset:12288
    v_mfma_f32_16x16x32_bf16 v[80:83], a[196:199], a[88:91], v[80:83]
    ds_read_b64_tr_b16 a[214:215], v10 offset:18432
    v_mfma_f32_16x16x32_bf16 v[88:91], a[196:199], a[92:95], v[88:91]
    buffer_load_dwordx4 a[128:131], v28, s[20:23], s46 offen offset:0 sc1
    v_mfma_f32_16x16x32_bf16 v[88:91], a[192:195], a[76:79], v[88:91]
    s_waitcnt lgkmcnt(4)
    v_mfma_f32_16x16x32_bf16 v[92:95], a[200:203], a[76:79], v[92:95]
    ds_read_b64_tr_b16 a[192:193], v11 offset:0
    v_mfma_f32_16x16x32_bf16 v[92:95], a[204:207], a[92:95], v[92:95]
    ds_read_b64_tr_b16 a[194:195], v11 offset:6144
    v_mfma_f32_16x16x32_bf16 v[84:87], a[204:207], a[88:91], v[84:87]
    v_mfma_f32_16x16x32_bf16 v[84:87], a[200:203], a[72:75], v[84:87]
    buffer_load_dwordx4 a[132:135], v28, s[20:23], s46 offen offset:1024 sc1
    v_mfma_f32_16x16x32_bf16 v[76:79], a[200:203], a[68:71], v[76:79]
    ds_read_b64_tr_b16 a[196:197], v11 offset:12288
    v_mfma_f32_16x16x32_bf16 v[76:79], a[204:207], a[84:87], v[76:79]
    ds_read_b64_tr_b16 a[198:199], v11 offset:18432
    v_mfma_f32_16x16x32_bf16 v[68:71], a[204:207], a[80:83], v[68:71]
    v_mfma_f32_16x16x32_bf16 v[68:71], a[200:203], a[64:67], v[68:71]
    s_waitcnt lgkmcnt(4)
    v_mfma_f32_16x16x32_bf16 v[96:99], a[208:211], a[64:67], v[96:99]
    ds_read_b64_tr_b16 a[200:201], v8 offset:1024
    v_mfma_f32_16x16x32_bf16 v[96:99], a[212:215], a[80:83], v[96:99]
    ds_read_b64_tr_b16 a[202:203], v8 offset:7168
    v_mfma_f32_16x16x32_bf16 v[104:107], a[212:215], a[84:87], v[104:107]
    buffer_load_dwordx4 a[136:139], v28, s[20:23], s46 offen offset:2048 sc1
    v_mfma_f32_16x16x32_bf16 v[104:107], a[208:211], a[68:71], v[104:107]
    v_mfma_f32_16x16x32_bf16 v[112:115], a[208:211], a[72:75], v[112:115]
    ds_read_b64_tr_b16 a[204:205], v8 offset:13312
    v_mfma_f32_16x16x32_bf16 v[112:115], a[212:215], a[88:91], v[112:115]
    ds_read_b64_tr_b16 a[206:207], v8 offset:19456
    v_mfma_f32_16x16x32_bf16 v[120:123], a[212:215], a[92:95], v[120:123]
    v_mfma_f32_16x16x32_bf16 v[120:123], a[208:211], a[76:79], v[120:123]
    s_waitcnt lgkmcnt(4)
    v_mfma_f32_16x16x32_bf16 v[124:127], a[192:195], a[76:79], v[124:127]
    ds_read_b64_tr_b16 a[208:209], v9 offset:1024
    v_mfma_f32_16x16x32_bf16 v[124:127], a[196:199], a[92:95], v[124:127]
    ds_read_b64_tr_b16 a[210:211], v9 offset:7168
    v_mfma_f32_16x16x32_bf16 v[116:119], a[196:199], a[88:91], v[116:119]
    buffer_load_dwordx4 a[140:143], v28, s[20:23], s46 offen offset:3072 sc1
    v_mfma_f32_16x16x32_bf16 v[116:119], a[192:195], a[72:75], v[116:119]
    v_mfma_f32_16x16x32_bf16 v[108:111], a[192:195], a[68:71], v[108:111]
    ds_read_b64_tr_b16 a[212:213], v9 offset:13312
    v_mfma_f32_16x16x32_bf16 v[108:111], a[196:199], a[84:87], v[108:111]
    ds_read_b64_tr_b16 a[214:215], v9 offset:19456
    v_mfma_f32_16x16x32_bf16 v[100:103], a[196:199], a[80:83], v[100:103]
    s_add_u32 m0, s49, 24576
    v_mfma_f32_16x16x32_bf16 v[100:103], a[192:195], a[64:67], v[100:103]
    s_waitcnt lgkmcnt(4)
    v_mfma_f32_16x16x32_bf16 v[128:131], a[200:203], a[64:67], v[128:131]
    ds_read_b64_tr_b16 a[192:193], v10 offset:1024
    v_mfma_f32_16x16x32_bf16 v[128:131], a[204:207], a[80:83], v[128:131]
    ds_read_b64_tr_b16 a[194:195], v10 offset:7168
    v_mfma_f32_16x16x32_bf16 v[136:139], a[204:207], a[84:87], v[136:139]
    buffer_load_dwordx4 v2, s[8:11], s36 offen offset:0 lds
    v_mfma_f32_16x16x32_bf16 v[136:139], a[200:203], a[68:71], v[136:139]
    v_mfma_f32_16x16x32_bf16 v[144:147], a[200:203], a[72:75], v[144:147]
    s_add_u32 m0, s49, 25472
    ds_read_b64_tr_b16 a[196:197], v10 offset:13312
    v_mfma_f32_16x16x32_bf16 v[144:147], a[204:207], a[88:91], v[144:147]
    ds_read_b64_tr_b16 a[198:199], v10 offset:19456
    v_mfma_f32_16x16x32_bf16 v[152:155], a[204:207], a[92:95], v[152:155]
    buffer_load_dwordx4 v2, s[8:11], s36 offen offset:128 lds
    v_mfma_f32_16x16x32_bf16 v[152:155], a[200:203], a[76:79], v[152:155]
    s_waitcnt lgkmcnt(4)
    v_mfma_f32_16x16x32_bf16 v[156:159], a[208:211], a[76:79], v[156:159]
    ds_read_b64_tr_b16 a[200:201], v11 offset:1024
    v_mfma_f32_16x16x32_bf16 v[156:159], a[212:215], a[92:95], v[156:159]
    ds_read_b64_tr_b16 a[202:203], v11 offset:7168
    v_mfma_f32_16x16x32_bf16 v[148:151], a[212:215], a[88:91], v[148:151]
    buffer_load_dwordx4 v[32:35], v17, s[24:27], s47 offen offset:0 sc1
    v_mfma_f32_16x16x32_bf16 v[148:151], a[208:211], a[72:75], v[148:151]
    s_add_u32 m0, s49, 26368
    v_mfma_f32_16x16x32_bf16 v[140:143], a[208:211], a[68:71], v[140:143]
    ds_read_b64_tr_b16 a[204:205], v11 offset:13312
    v_mfma_f32_16x16x32_bf16 v[140:143], a[212:215], a[84:87], v[140:143]
    ds_read_b64_tr_b16 a[206:207], v11 offset:19456
    v_mfma_f32_16x16x32_bf16 v[132:135], a[212:215], a[80:83], v[132:135]
    buffer_load_dwordx4 v2, s[8:11], s36 offen offset:256 lds
    v_mfma_f32_16x16x32_bf16 v[132:135], a[208:211], a[64:67], v[132:135]
    s_waitcnt lgkmcnt(4)
    v_mfma_f32_16x16x32_bf16 v[160:163], a[192:195], a[64:67], v[160:163]
    ds_read_b64_tr_b16 a[208:209], v8 offset:2048
    v_mfma_f32_16x16x32_bf16 v[160:163], a[196:199], a[80:83], v[160:163]
    s_add_u32 m0, s49, 27648
    ds_read_b64_tr_b16 a[210:211], v8 offset:8192
    v_mfma_f32_16x16x32_bf16 v[168:171], a[196:199], a[84:87], v[168:171]
    buffer_load_dwordx4 v3, s[8:11], s36 offen offset:0 lds
    v_mfma_f32_16x16x32_bf16 v[168:171], a[192:195], a[68:71], v[168:171]
    v_mfma_f32_16x16x32_bf16 v[176:179], a[192:195], a[72:75], v[176:179]
    ds_read_b64_tr_b16 a[212:213], v8 offset:14336
    v_mfma_f32_16x16x32_bf16 v[176:179], a[196:199], a[88:91], v[176:179]
    ds_read_b64_tr_b16 a[214:215], v8 offset:20480
    v_mfma_f32_16x16x32_bf16 v[184:187], a[196:199], a[92:95], v[184:187]
    buffer_load_dwordx4 v[36:39], v17, s[24:27], s47 offen offset:1024 sc1
    v_mfma_f32_16x16x32_bf16 v[184:187], a[192:195], a[76:79], v[184:187]
    s_waitcnt lgkmcnt(4)
    v_add_u32 v8, 122880, v12
    v_mfma_f32_16x16x32_bf16 v[188:191], a[200:203], a[76:79], v[188:191]
    s_add_u32 m0, s49, 28544
    ds_read_b64_tr_b16 a[192:193], v9 offset:2048
    v_mfma_f32_16x16x32_bf16 v[188:191], a[204:207], a[92:95], v[188:191]
    ds_read_b64_tr_b16 a[194:195], v9 offset:8192
    v_mfma_f32_16x16x32_bf16 v[180:183], a[204:207], a[88:91], v[180:183]
    buffer_load_dwordx4 v3, s[8:11], s36 offen offset:128 lds
    v_mfma_f32_16x16x32_bf16 v[180:183], a[200:203], a[72:75], v[180:183]
    v_mfma_f32_16x16x32_bf16 v[172:175], a[200:203], a[68:71], v[172:175]
    ds_read_b64_tr_b16 a[196:197], v9 offset:14336
    v_mfma_f32_16x16x32_bf16 v[172:175], a[204:207], a[84:87], v[172:175]
    ds_read_b64_tr_b16 a[198:199], v9 offset:20480
    v_mfma_f32_16x16x32_bf16 v[164:167], a[204:207], a[80:83], v[164:167]
    s_add_u32 m0, s49, 29440
    v_add_u32 v9, 122880, v13
    v_mfma_f32_16x16x32_bf16 v[164:167], a[200:203], a[64:67], v[164:167]
    s_waitcnt lgkmcnt(4)
    v_mfma_f32_16x16x32_bf16 v[192:195], a[208:211], a[64:67], v[192:195]
    ds_read_b64_tr_b16 a[200:201], v10 offset:2048
    v_mfma_f32_16x16x32_bf16 v[192:195], a[212:215], a[80:83], v[192:195]
    ds_read_b64_tr_b16 a[202:203], v10 offset:8192
    v_mfma_f32_16x16x32_bf16 v[200:203], a[212:215], a[84:87], v[200:203]
    buffer_load_dwordx4 v3, s[8:11], s36 offen offset:256 lds
    v_mfma_f32_16x16x32_bf16 v[200:203], a[208:211], a[68:71], v[200:203]
    buffer_load_dwordx4 v[40:43], v17, s[24:27], s47 offen offset:2048 sc1
    v_mfma_f32_16x16x32_bf16 v[208:211], a[208:211], a[72:75], v[208:211]
    s_add_u32 s36, s36, s37
    ds_read_b64_tr_b16 a[204:205], v10 offset:14336
    s_sub_u32 s55, s36, 7864320
    v_mfma_f32_16x16x32_bf16 v[208:211], a[212:215], a[88:91], v[208:211]
    s_min_u32 s36, s36, s55
    ds_read_b64_tr_b16 a[206:207], v10 offset:20480
    s_add_u32 s46, s45, 36864
    v_mfma_f32_16x16x32_bf16 v[216:219], a[212:215], a[92:95], v[216:219]
    s_sub_u32 s77, s46, 81920
    v_add_u32 v10, 122880, v14
    s_min_u32 s46, s46, s77
    v_mfma_f32_16x16x32_bf16 v[216:219], a[208:211], a[76:79], v[216:219]
    s_waitcnt lgkmcnt(4)
    v_mfma_f32_16x16x32_bf16 v[220:223], a[192:195], a[76:79], v[220:223]
    ds_read_b64_tr_b16 a[208:209], v11 offset:2048
    v_mfma_f32_16x16x32_bf16 v[220:223], a[196:199], a[92:95], v[220:223]
    ds_read_b64_tr_b16 a[210:211], v11 offset:8192
    v_mfma_f32_16x16x32_bf16 v[212:215], a[196:199], a[88:91], v[212:215]
    buffer_load_dwordx4 a[144:147], v28, s[20:23], s46 offen offset:0 sc1
    v_mfma_f32_16x16x32_bf16 v[212:215], a[192:195], a[72:75], v[212:215]
    v_mfma_f32_16x16x32_bf16 v[204:207], a[192:195], a[68:71], v[204:207]
    ds_read_b64_tr_b16 a[212:213], v11 offset:14336
    v_mfma_f32_16x16x32_bf16 v[204:207], a[196:199], a[84:87], v[204:207]
    s_waitcnt vmcnt(53)
    ds_read_b64_tr_b16 a[214:215], v11 offset:20480
    v_mfma_f32_16x16x32_bf16 v[196:199], a[196:199], a[80:83], v[196:199]
    s_barrier
    v_mfma_f32_16x16x32_bf16 v[196:199], a[192:195], a[64:67], v[196:199]
    s_waitcnt lgkmcnt(4)
    buffer_load_dwordx4 a[148:151], v28, s[20:23], s46 offen offset:1024 sc1
    v_mfma_f32_16x16x32_bf16 v[224:227], a[200:203], a[64:67], v[224:227]
    ds_read_b64_tr_b16 a[192:193], v8 offset:0
    v_add_u32 v11, 122880, v15
    v_mfma_f32_16x16x32_bf16 v[224:227], a[204:207], a[80:83], v[224:227]
    ds_read_b64_tr_b16 a[194:195], v8 offset:6144
    v_mfma_f32_16x16x32_bf16 v[232:235], a[204:207], a[84:87], v[232:235]
    buffer_load_dwordx4 v[44:47], v17, s[24:27], s47 offen offset:3072 sc1
    v_mfma_f32_16x16x32_bf16 v[232:235], a[200:203], a[68:71], v[232:235]
    buffer_load_dwordx4 a[152:155], v28, s[20:23], s46 offen offset:2048 sc1
    v_mfma_f32_16x16x32_bf16 v[240:243], a[200:203], a[72:75], v[240:243]
    ds_read_b64_tr_b16 a[196:197], v8 offset:12288
    v_mfma_f32_16x16x32_bf16 v[240:243], a[204:207], a[88:91], v[240:243]
    ds_read_b64_tr_b16 a[198:199], v8 offset:18432
    v_mfma_f32_16x16x32_bf16 v[248:251], a[204:207], a[92:95], v[248:251]
    v_mfma_f32_16x16x32_bf16 v[248:251], a[200:203], a[76:79], v[248:251]
    s_waitcnt lgkmcnt(4)
    v_mfma_f32_16x16x32_bf16 v[252:255], a[208:211], a[76:79], v[252:255]
    ds_read_b64_tr_b16 a[200:201], v9 offset:0
    v_mfma_f32_16x16x32_bf16 v[252:255], a[212:215], a[92:95], v[252:255]
    ds_read_b64_tr_b16 a[202:203], v9 offset:6144
    v_mfma_f32_16x16x32_bf16 v[244:247], a[212:215], a[88:91], v[244:247]
    buffer_load_dwordx4 a[156:159], v28, s[20:23], s46 offen offset:3072 sc1
    v_mfma_f32_16x16x32_bf16 v[244:247], a[208:211], a[72:75], v[244:247]
    v_mfma_f32_16x16x32_bf16 v[236:239], a[208:211], a[68:71], v[236:239]
    s_add_u32 s46, s45, 40960
    ds_read_b64_tr_b16 a[204:205], v9 offset:12288
    s_sub_u32 s77, s46, 81920
    v_mfma_f32_16x16x32_bf16 v[236:239], a[212:215], a[84:87], v[236:239]
    s_waitcnt vmcnt(29)
    s_waitcnt vmcnt(18)
    ds_read_b64_tr_b16 a[206:207], v9 offset:18432
    v_mfma_f32_16x16x32_bf16 v[228:231], a[212:215], a[80:83], v[228:231]
    s_min_u32 s46, s46, s77
    v_mfma_f32_16x16x32_bf16 v[228:231], a[208:211], a[64:67], v[228:231]
    s_waitcnt lgkmcnt(4)
    v_mfma_f32_16x16x32_bf16 v[64:67], a[192:195], a[96:99], v[64:67]
    ds_read_b64_tr_b16 a[208:209], v10 offset:0
    v_mfma_f32_16x16x32_bf16 v[64:67], a[196:199], a[112:115], v[64:67]
    ds_read_b64_tr_b16 a[210:211], v10 offset:6144
    v_mfma_f32_16x16x32_bf16 v[72:75], a[196:199], a[116:119], v[72:75]
    buffer_load_dwordx4 a[160:163], v28, s[20:23], s46 offen offset:0 sc1
    v_mfma_f32_16x16x32_bf16 v[72:75], a[192:195], a[100:103], v[72:75]
    v_mfma_f32_16x16x32_bf16 v[80:83], a[192:195], a[104:107], v[80:83]
    ds_read_b64_tr_b16 a[212:213], v10 offset:12288
    v_mfma_f32_16x16x32_bf16 v[80:83], a[196:199], a[120:123], v[80:83]
    ds_read_b64_tr_b16 a[214:215], v10 offset:18432
    v_mfma_f32_16x16x32_bf16 v[88:91], a[196:199], a[124:127], v[88:91]
    buffer_load_dwordx4 a[164:167], v28, s[20:23], s46 offen offset:1024 sc1
    v_mfma_f32_16x16x32_bf16 v[88:91], a[192:195], a[108:111], v[88:91]
    s_waitcnt lgkmcnt(4)
    v_mfma_f32_16x16x32_bf16 v[92:95], a[200:203], a[108:111], v[92:95]
    ds_read_b64_tr_b16 a[192:193], v11 offset:0
    v_mfma_f32_16x16x32_bf16 v[92:95], a[204:207], a[124:127], v[92:95]
    ds_read_b64_tr_b16 a[194:195], v11 offset:6144
    v_mfma_f32_16x16x32_bf16 v[84:87], a[204:207], a[120:123], v[84:87]
    v_mfma_f32_16x16x32_bf16 v[84:87], a[200:203], a[104:107], v[84:87]
    v_mfma_f32_16x16x32_bf16 v[76:79], a[200:203], a[100:103], v[76:79]
    ds_read_b64_tr_b16 a[196:197], v11 offset:12288
    v_mfma_f32_16x16x32_bf16 v[76:79], a[204:207], a[116:119], v[76:79]
    ds_read_b64_tr_b16 a[198:199], v11 offset:18432
    v_mfma_f32_16x16x32_bf16 v[68:71], a[204:207], a[112:115], v[68:71]
    buffer_load_dwordx4 a[168:171], v28, s[20:23], s46 offen offset:2048 sc1
    v_mfma_f32_16x16x32_bf16 v[68:71], a[200:203], a[96:99], v[68:71]
    s_waitcnt lgkmcnt(4)
    v_mfma_f32_16x16x32_bf16 v[96:99], a[208:211], a[96:99], v[96:99]
    ds_read_b64_tr_b16 a[200:201], v8 offset:1024
    v_mfma_f32_16x16x32_bf16 v[96:99], a[212:215], a[112:115], v[96:99]
    ds_read_b64_tr_b16 a[202:203], v8 offset:7168
    v_mfma_f32_16x16x32_bf16 v[104:107], a[212:215], a[116:119], v[104:107]
    v_mfma_f32_16x16x32_bf16 v[104:107], a[208:211], a[100:103], v[104:107]
    buffer_load_dwordx4 a[172:175], v28, s[20:23], s46 offen offset:3072 sc1
    v_mfma_f32_16x16x32_bf16 v[112:115], a[208:211], a[104:107], v[112:115]
    ds_read_b64_tr_b16 a[204:205], v8 offset:13312
    v_mfma_f32_16x16x32_bf16 v[112:115], a[212:215], a[120:123], v[112:115]
    ds_read_b64_tr_b16 a[206:207], v8 offset:19456
    v_mfma_f32_16x16x32_bf16 v[120:123], a[212:215], a[124:127], v[120:123]
    v_mfma_f32_16x16x32_bf16 v[120:123], a[208:211], a[108:111], v[120:123]
    s_waitcnt lgkmcnt(4)
    v_mfma_f32_16x16x32_bf16 v[124:127], a[192:195], a[108:111], v[124:127]
    ds_read_b64_tr_b16 a[208:209], v9 offset:1024
    v_mfma_f32_16x16x32_bf16 v[124:127], a[196:199], a[124:127], v[124:127]
    s_add_u32 m0, s49, 49152
    ds_read_b64_tr_b16 a[210:211], v9 offset:7168
    v_mfma_f32_16x16x32_bf16 v[116:119], a[196:199], a[120:123], v[116:119]
    buffer_load_dwordx4 v2, s[8:11], s36 offen offset:0 lds
    v_mfma_f32_16x16x32_bf16 v[116:119], a[192:195], a[104:107], v[116:119]
    v_mfma_f32_16x16x32_bf16 v[108:111], a[192:195], a[100:103], v[108:111]
    ds_read_b64_tr_b16 a[212:213], v9 offset:13312
    v_mfma_f32_16x16x32_bf16 v[108:111], a[196:199], a[116:119], v[108:111]
    ds_read_b64_tr_b16 a[214:215], v9 offset:19456
    v_mfma_f32_16x16x32_bf16 v[100:103], a[196:199], a[112:115], v[100:103]
    v_mfma_f32_16x16x32_bf16 v[100:103], a[192:195], a[96:99], v[100:103]
    s_waitcnt lgkmcnt(4)
    s_add_u32 m0, s49, 50048
    v_mfma_f32_16x16x32_bf16 v[128:131], a[200:203], a[96:99], v[128:131]
    ds_read_b64_tr_b16 a[192:193], v10 offset:1024
    v_mfma_f32_16x16x32_bf16 v[128:131], a[204:207], a[112:115], v[128:131]
    ds_read_b64_tr_b16 a[194:195], v10 offset:7168
    v_mfma_f32_16x16x32_bf16 v[136:139], a[204:207], a[116:119], v[136:139]
    buffer_load_dwordx4 v2, s[8:11], s36 offen offset:128 lds
    v_mfma_f32_16x16x32_bf16 v[136:139], a[200:203], a[100:103], v[136:139]
    v_mfma_f32_16x16x32_bf16 v[144:147], a[200:203], a[104:107], v[144:147]
    ds_read_b64_tr_b16 a[196:197], v10 offset:13312
    v_mfma_f32_16x16x32_bf16 v[144:147], a[204:207], a[120:123], v[144:147]
    ds_read_b64_tr_b16 a[198:199], v10 offset:19456
    v_mfma_f32_16x16x32_bf16 v[152:155], a[204:207], a[124:127], v[152:155]
    s_add_u32 m0, s49, 50944
    v_mfma_f32_16x16x32_bf16 v[152:155], a[200:203], a[108:111], v[152:155]
    s_waitcnt lgkmcnt(4)
    v_mfma_f32_16x16x32_bf16 v[156:159], a[208:211], a[108:111], v[156:159]
    ds_read_b64_tr_b16 a[200:201], v11 offset:1024
    v_mfma_f32_16x16x32_bf16 v[156:159], a[212:215], a[124:127], v[156:159]
    ds_read_b64_tr_b16 a[202:203], v11 offset:7168
    v_mfma_f32_16x16x32_bf16 v[148:151], a[212:215], a[120:123], v[148:151]
    buffer_load_dwordx4 v2, s[8:11], s36 offen offset:256 lds
    v_mfma_f32_16x16x32_bf16 v[148:151], a[208:211], a[104:107], v[148:151]
    v_mfma_f32_16x16x32_bf16 v[140:143], a[208:211], a[100:103], v[140:143]
    s_add_u32 m0, s49, 52224
    ds_read_b64_tr_b16 a[204:205], v11 offset:13312
    v_mfma_f32_16x16x32_bf16 v[140:143], a[212:215], a[116:119], v[140:143]
    ds_read_b64_tr_b16 a[206:207], v11 offset:19456
    v_mfma_f32_16x16x32_bf16 v[132:135], a[212:215], a[112:115], v[132:135]
    buffer_load_dwordx4 v3, s[8:11], s36 offen offset:0 lds
    v_mfma_f32_16x16x32_bf16 v[132:135], a[208:211], a[96:99], v[132:135]
    s_waitcnt lgkmcnt(4)
    v_mfma_f32_16x16x32_bf16 v[160:163], a[192:195], a[96:99], v[160:163]
    ds_read_b64_tr_b16 a[208:209], v8 offset:2048
    v_mfma_f32_16x16x32_bf16 v[160:163], a[196:199], a[112:115], v[160:163]
    ds_read_b64_tr_b16 a[210:211], v8 offset:8192
    v_mfma_f32_16x16x32_bf16 v[168:171], a[196:199], a[116:119], v[168:171]
    v_mfma_f32_16x16x32_bf16 v[168:171], a[192:195], a[100:103], v[168:171]
    s_add_u32 m0, s49, 53120
    v_mfma_f32_16x16x32_bf16 v[176:179], a[192:195], a[104:107], v[176:179]
    ds_read_b64_tr_b16 a[212:213], v8 offset:14336
    v_mfma_f32_16x16x32_bf16 v[176:179], a[196:199], a[120:123], v[176:179]
    ds_read_b64_tr_b16 a[214:215], v8 offset:20480
    v_mfma_f32_16x16x32_bf16 v[184:187], a[196:199], a[124:127], v[184:187]
    buffer_load_dwordx4 v3, s[8:11], s36 offen offset:128 lds
    v_mfma_f32_16x16x32_bf16 v[184:187], a[192:195], a[108:111], v[184:187]
    s_waitcnt lgkmcnt(4)
    v_add_u32 v8, 0, v12
    v_mfma_f32_16x16x32_bf16 v[188:191], a[200:203], a[108:111], v[188:191]
    ds_read_b64_tr_b16 a[192:193], v9 offset:2048
    v_mfma_f32_16x16x32_bf16 v[188:191], a[204:207], a[124:127], v[188:191]
    s_add_u32 m0, s49, 54016
    ds_read_b64_tr_b16 a[194:195], v9 offset:8192
    v_mfma_f32_16x16x32_bf16 v[180:183], a[204:207], a[120:123], v[180:183]
    buffer_load_dwordx4 v3, s[8:11], s36 offen offset:256 lds
    v_mfma_f32_16x16x32_bf16 v[180:183], a[200:203], a[104:107], v[180:183]
    s_add_u32 s36, s36, s37
    s_sub_u32 s55, s36, 7864320
    s_min_u32 s36, s36, s55
    v_mfma_f32_16x16x32_bf16 v[172:175], a[200:203], a[100:103], v[172:175]
    ds_read_b64_tr_b16 a[196:197], v9 offset:14336
    v_mfma_f32_16x16x32_bf16 v[172:175], a[204:207], a[116:119], v[172:175]
    s_add_u32 s46, s45, 45056
    ds_read_b64_tr_b16 a[198:199], v9 offset:20480
    s_sub_u32 s77, s46, 81920
    v_mfma_f32_16x16x32_bf16 v[164:167], a[204:207], a[112:115], v[164:167]
    s_min_u32 s46, s46, s77
    v_add_u32 v9, 0, v13
    v_mfma_f32_16x16x32_bf16 v[164:167], a[200:203], a[96:99], v[164:167]
    s_waitcnt lgkmcnt(4)
    v_mfma_f32_16x16x32_bf16 v[192:195], a[208:211], a[96:99], v[192:195]
    ds_read_b64_tr_b16 a[200:201], v10 offset:2048
    v_mfma_f32_16x16x32_bf16 v[192:195], a[212:215], a[112:115], v[192:195]
    ds_read_b64_tr_b16 a[202:203], v10 offset:8192
    v_mfma_f32_16x16x32_bf16 v[200:203], a[212:215], a[116:119], v[200:203]
    buffer_load_dwordx4 a[176:179], v28, s[20:23], s46 offen offset:0 sc1
    v_mfma_f32_16x16x32_bf16 v[200:203], a[208:211], a[100:103], v[200:203]
    v_mfma_f32_16x16x32_bf16 v[208:211], a[208:211], a[104:107], v[208:211]
    ds_read_b64_tr_b16 a[204:205], v10 offset:14336
    v_mfma_f32_16x16x32_bf16 v[208:211], a[212:215], a[120:123], v[208:211]
    ds_read_b64_tr_b16 a[206:207], v10 offset:20480
    v_mfma_f32_16x16x32_bf16 v[216:219], a[212:215], a[124:127], v[216:219]
    v_add_u32 v10, 0, v14
    v_mfma_f32_16x16x32_bf16 v[216:219], a[208:211], a[108:111], v[216:219]
    s_waitcnt lgkmcnt(4)
    v_mfma_f32_16x16x32_bf16 v[220:223], a[192:195], a[108:111], v[220:223]
    s_waitcnt vmcnt(13)
    ds_read_b64_tr_b16 a[208:209], v11 offset:2048
    v_xor_b32 v34, s7, v34
    v_mfma_f32_16x16x32_bf16 v[220:223], a[196:199], a[124:127], v[220:223]
    ds_read_b64_tr_b16 a[210:211], v11 offset:8192
    v_xor_b32 v38, s7, v38
    v_mfma_f32_16x16x32_bf16 v[212:215], a[196:199], a[120:123], v[212:215]
    buffer_load_dwordx4 a[180:183], v28, s[20:23], s46 offen offset:1024 sc1
    v_mfma_f32_16x16x32_bf16 v[212:215], a[192:195], a[104:107], v[212:215]
    v_xor_b32 v42, s7, v42
    v_xor_b32 v46, s7, v46
    v_mfma_f32_16x16x32_bf16 v[204:207], a[192:195], a[100:103], v[204:207]
    ds_read_b64_tr_b16 a[212:213], v11 offset:14336
    v_or3_b32 v34, v34, v38, v42
    v_mfma_f32_16x16x32_bf16 v[204:207], a[196:199], a[116:119], v[204:207]
    s_waitcnt vmcnt(35)
    ds_read_b64_tr_b16 a[214:215], v11 offset:20480
    v_or_b32 v34, v34, v46
    v_mfma_f32_16x16x32_bf16 v[196:199], a[196:199], a[112:115], v[196:199]
    s_barrier
    v_mfma_f32_16x16x32_bf16 v[196:199], a[192:195], a[96:99], v[196:199]
    s_waitcnt lgkmcnt(4)
    v_cmp_ne_u32 vcc, 0, v34
    v_add_u32 v11, 0, v15
    v_mfma_f32_16x16x32_bf16 v[224:227], a[200:203], a[96:99], v[224:227]
    ds_read_b64_tr_b16 a[192:193], v8 offset:0
    v_mfma_f32_16x16x32_bf16 v[224:227], a[204:207], a[112:115], v[224:227]
    ds_read_b64_tr_b16 a[194:195], v8 offset:6144
    v_mfma_f32_16x16x32_bf16 v[232:235], a[204:207], a[116:119], v[232:235]
    s_cbranch_vccnz spin_rec
spin_rec_ret:
    v_max_u32 v20, v32, v33
    v_mfma_f32_16x16x32_bf16 v[232:235], a[200:203], a[100:103], v[232:235]
    buffer_load_dwordx4 a[184:187], v28, s[20:23], s46 offen offset:2048 sc1
    v_mfma_f32_16x16x32_bf16 v[240:243], a[200:203], a[104:107], v[240:243]
    ds_read_b64_tr_b16 a[196:197], v8 offset:12288
    v_min_u32 v21, v32, v33
    v_mfma_f32_16x16x32_bf16 v[240:243], a[204:207], a[120:123], v[240:243]
    ds_read_b64_tr_b16 a[198:199], v8 offset:18432
    v_med3_u32 v21, v20, v21, v36
    v_mfma_f32_16x16x32_bf16 v[248:251], a[204:207], a[124:127], v[248:251]
pg_2:
    s_cbranch_execz pg_ret
    buffer_load_dwordx4 a[188:191], v28, s[20:23], s46 offen offset:3072 sc1
    v_mfma_f32_16x16x32_bf16 v[248:251], a[200:203], a[108:111], v[248:251]
    s_waitcnt lgkmcnt(4)
    v_max_u32 v20, v20, v36
    v_med3_u32 v21, v20, v21, v37
    v_mfma_f32_16x16x32_bf16 v[252:255], a[208:211], a[108:111], v[252:255]
    s_add_u32 s46, s45, 49152
    ds_read_b64_tr_b16 a[200:201], v9 offset:0
    v_max_u32 v20, v20, v37
    v_mfma_f32_16x16x32_bf16 v[252:255], a[212:215], a[124:127], v[252:255]
    s_sub_u32 s77, s46, 81920
    ds_read_b64_tr_b16 a[202:203], v9 offset:6144
    v_med3_u32 v21, v20, v21, v40
    v_mfma_f32_16x16x32_bf16 v[244:247], a[212:215], a[120:123], v[244:247]
    s_min_u32 s46, s46, s77
    v_max_u32 v20, v20, v40
    v_med3_u32 v21, v20, v21, v41
    v_mfma_f32_16x16x32_bf16 v[244:247], a[208:211], a[104:107], v[244:247]
    buffer_load_dwordx4 a[0:3], v28, s[20:23], s46 offen offset:0 sc1
    v_mfma_f32_16x16x32_bf16 v[236:239], a[208:211], a[100:103], v[236:239]
    ds_read_b64_tr_b16 a[204:205], v9 offset:12288
    v_max_u32 v20, v20, v41
    v_mfma_f32_16x16x32_bf16 v[236:239], a[212:215], a[116:119], v[236:239]
    s_waitcnt vmcnt(29)
    s_waitcnt vmcnt(15)
    ds_read_b64_tr_b16 a[206:207], v9 offset:18432
    v_mfma_f32_16x16x32_bf16 v[228:231], a[212:215], a[112:115], v[228:231]
    v_med3_u32 v21, v20, v21, v44
    v_max_u32 v20, v20, v44
    v_mfma_f32_16x16x32_bf16 v[228:231], a[208:211], a[96:99], v[228:231]
    s_waitcnt lgkmcnt(4)
    v_med3_u32 v21, v20, v21, v45
    v_max_u32 v20, v20, v45
    v_mfma_f32_16x16x32_bf16 v[64:67], a[192:195], a[128:131], v[64:67]
    ds_read_b64_tr_b16 a[208:209], v10 offset:0
    v_mov_b32_dpp v22, v20 row_ror:8 row_mask:0xf bank_mask:0xf
    v_mfma_f32_16x16x32_bf16 v[64:67], a[196:199], a[144:147], v[64:67]
    ds_read_b64_tr_b16 a[210:211], v10 offset:6144
    v_mov_b32_dpp v23, v21 row_ror:8 row_mask:0xf bank_mask:0xf
    v_mfma_f32_16x16x32_bf16 v[72:75], a[196:199], a[148:151], v[72:75]
    buffer_load_dwordx4 a[4:7], v28, s[20:23], s46 offen offset:1024 sc1
    v_mfma_f32_16x16x32_bf16 v[72:75], a[192:195], a[132:135], v[72:75]
    v_min_u32 v24, v20, v22
    v_max_u32 v20, v20, v22
    v_mfma_f32_16x16x32_bf16 v[80:83], a[192:195], a[136:139], v[80:83]
    ds_read_b64_tr_b16 a[212:213], v10 offset:12288
    v_max3_u32 v21, v24, v21, v23
    v_mfma_f32_16x16x32_bf16 v[80:83], a[196:199], a[152:155], v[80:83]
    ds_read_b64_tr_b16 a[214:215], v10 offset:18432
    v_mov_b32_dpp v22, v20 row_ror:4 row_mask:0xf bank_mask:0xf
    v_mfma_f32_16x16x32_bf16 v[88:91], a[196:199], a[156:159], v[88:91]
    v_mov_b32_dpp v23, v21 row_ror:4 row_mask:0xf bank_mask:0xf
    v_min_u32 v24, v20, v22
    v_mfma_f32_16x16x32_bf16 v[88:91], a[192:195], a[140:143], v[88:91]
    s_waitcnt lgkmcnt(4)
    v_max_u32 v20, v20, v22
    v_max3_u32 v21, v24, v21, v23
    v_mfma_f32_16x16x32_bf16 v[92:95], a[200:203], a[140:143], v[92:95]
    ds_read_b64_tr_b16 a[192:193], v11 offset:0
    v_mov_b32_dpp v22, v20 row_ror:2 row_mask:0xf bank_mask:0xf
    v_mfma_f32_16x16x32_bf16 v[92:95], a[204:207], a[156:159], v[92:95]
    ds_read_b64_tr_b16 a[194:195], v11 offset:6144
    v_mov_b32_dpp v23, v21 row_ror:2 row_mask:0xf bank_mask:0xf
    v_mfma_f32_16x16x32_bf16 v[84:87], a[204:207], a[152:155], v[84:87]
    buffer_load_dwordx4 a[8:11], v28, s[20:23], s46 offen offset:2048 sc1
    v_mfma_f32_16x16x32_bf16 v[84:87], a[200:203], a[136:139], v[84:87]
    v_min_u32 v24, v20, v22
    v_max_u32 v20, v20, v22
    v_mfma_f32_16x16x32_bf16 v[76:79], a[200:203], a[132:135], v[76:79]
    ds_read_b64_tr_b16 a[196:197], v11 offset:12288
    v_max3_u32 v21, v24, v21, v23
    v_mfma_f32_16x16x32_bf16 v[76:79], a[204:207], a[148:151], v[76:79]
    ds_read_b64_tr_b16 a[198:199], v11 offset:18432
    v_mov_b32_dpp v22, v20 row_ror:1 row_mask:0xf bank_mask:0xf
    v_mfma_f32_16x16x32_bf16 v[68:71], a[204:207], a[144:147], v[68:71]
    buffer_load_dwordx4 a[12:15], v28, s[20:23], s46 offen offset:3072 sc1
    v_mfma_f32_16x16x32_bf16 v[68:71], a[200:203], a[128:131], v[68:71]
    s_waitcnt lgkmcnt(4)
    v_mov_b32_dpp v23, v21 row_ror:1 row_mask:0xf bank_mask:0xf
    v_min_u32 v24, v20, v22
    v_mfma_f32_16x16x32_bf16 v[96:99], a[208:211], a[128:131], v[96:99]
    s_andn2_b32 s88, s2, 7
    ds_read_b64_tr_b16 a[200:201], v8 offset:1024
    v_max_u32 v20, v20, v22
    v_mfma_f32_16x16x32_bf16 v[96:99], a[212:215], a[144:147], v[96:99]
    s_lshl_b32 s88, s88, 2
    ds_read_b64_tr_b16 a[202:203], v8 offset:7168
    v_max3_u32 v21, v24, v21, v23
    v_mfma_f32_16x16x32_bf16 v[104:107], a[212:215], a[148:151], v[104:107]
    s_lshr_b32 s89, s53, 1
    v_mov_b32 v22, v20
    v_mov_b32 v23, v21
    v_mfma_f32_16x16x32_bf16 v[104:107], a[208:211], a[132:135], v[104:107]
    s_add_u32 s88, s88, s89
    v_permlane16_swap_b32 v20, v22
    v_mfma_f32_16x16x32_bf16 v[112:115], a[208:211], a[136:139], v[112:115]
    s_add_u32 m0, s49, 73728
    ds_read_b64_tr_b16 a[204:205], v8 offset:13312
    v_lshl_add_u32 v60, v1, 2, s88
    v_mfma_f32_16x16x32_bf16 v[112:115], a[212:215], a[152:155], v[112:115]
    s_andn2_b32 s88, s2, 0x18
    ds_read_b64_tr_b16 a[206:207], v8 offset:19456
    v_accvgpr_write_b32 a96, 0
    v_mfma_f32_16x16x32_bf16 v[120:123], a[212:215], a[156:159], v[120:123]
    buffer_load_dwordx4 v2, s[8:11], s36 offen offset:0 lds
    v_mfma_f32_16x16x32_bf16 v[120:123], a[208:211], a[140:143], v[120:123]
    s_waitcnt lgkmcnt(4)
    v_permlane16_swap_b32 v21, v23
    v_mfma_f32_16x16x32_bf16 v[124:127], a[192:195], a[140:143], v[124:127]
    s_lshl_b32 s88, s88, 2
    ds_read_b64_tr_b16 a[208:209], v9 offset:1024
    v_min_u32 v24, v20, v22
    v_mfma_f32_16x16x32_bf16 v[124:127], a[196:199], a[156:159], v[124:127]
    s_add_u32 s88, s88, s3
    ds_read_b64_tr_b16 a[210:211], v9 offset:7168
    v_max_u32 v20, v20, v22
    v_mfma_f32_16x16x32_bf16 v[116:119], a[196:199], a[152:155], v[116:119]
    s_add_u32 m0, s49, 74624
    v_max3_u32 v21, v24, v21, v23
    v_mov_b32 v22, v20
    v_mfma_f32_16x16x32_bf16 v[116:119], a[192:195], a[136:139], v[116:119]
    buffer_load_dwordx4 v2, s[8:11], s36 offen offset:128 lds
    v_mfma_f32_16x16x32_bf16 v[108:111], a[192:195], a[132:135], v[108:111]
    ds_read_b64_tr_b16 a[212:213], v9 offset:13312
    v_mov_b32 v23, v21
    v_mfma_f32_16x16x32_bf16 v[108:111], a[196:199], a[148:151], v[108:111]
    ds_read_b64_tr_b16 a[214:215], v9 offset:19456
    v_and_b32 v61, 3, v1
    v_mfma_f32_16x16x32_bf16 v[100:103], a[196:199], a[144:147], v[100:103]
    v_permlane32_swap_b32 v20, v22
    v_mfma_f32_16x16x32_bf16 v[100:103], a[192:195], a[128:131], v[100:103]
    s_waitcnt lgkmcnt(4)
    v_permlane32_swap_b32 v21, v23
    v_mfma_f32_16x16x32_bf16 v[128:131], a[200:203], a[128:131], v[128:131]
    ds_read_b64_tr_b16 a[192:193], v10 offset:1024
    v_min_u32 v24, v20, v22
    v_mfma_f32_16x16x32_bf16 v[128:131], a[204:207], a[144:147], v[128:131]
    s_add_u32 m0, s49, 75520
    ds_read_b64_tr_b16 a[194:195], v10 offset:7168
    v_max_u32 v20, v20, v22
    v_mfma_f32_16x16x32_bf16 v[136:139], a[204:207], a[148:151], v[136:139]
    buffer_load_dwordx4 v2, s[8:11], s36 offen offset:256 lds
    v_mfma_f32_16x16x32_bf16 v[136:139], a[200:203], a[132:135], v[136:139]
    v_max3_u32 v21, v24, v21, v23
    v_lshl_add_u32 v61, v61, 5, s88
    v_mfma_f32_16x16x32_bf16 v[144:147], a[200:203], a[136:139], v[144:147]
    s_lshl_b32 s56, s3, 3
    ds_read_b64_tr_b16 a[196:197], v10 offset:13312
    v_cmp_gt_u32 s[88:89], 8, v1
    v_mfma_f32_16x16x32_bf16 v[144:147], a[204:207], a[152:155], v[144:147]
    s_add_u32 s56, s56, 147456
    ds_read_b64_tr_b16 a[198:199], v10 offset:19456
    v_mov_b32 v22, s56
    v_mfma_f32_16x16x32_bf16 v[152:155], a[204:207], a[156:159], v[152:155]
    v_mov_b32 v23, 147456
    v_cndmask_b32 v60, v61, v60, s[88:89]
    v_mfma_f32_16x16x32_bf16 v[152:155], a[200:203], a[140:143], v[152:155]
    s_waitcnt lgkmcnt(4)
    v_lshlrev_b32 v61, 2, v1
    v_cmp_gt_u32 s[88:89], 12, v1
    v_mfma_f32_16x16x32_bf16 v[156:159], a[208:211], a[140:143], v[156:159]
    s_add_u32 m0, s49, 76800
    ds_read_b64_tr_b16 a[200:201], v11 offset:1024
    v_cndmask_b32 v60, v61, v60, s[88:89]
    v_mfma_f32_16x16x32_bf16 v[156:159], a[212:215], a[156:159], v[156:159]
    ds_read_b64_tr_b16 a[202:203], v11 offset:7168
    v_lshlrev_b32 v60, 4, v60
    v_mfma_f32_16x16x32_bf16 v[148:151], a[212:215], a[152:155], v[148:151]
    buffer_load_dwordx4 v3, s[8:11], s36 offen offset:0 lds
    v_mfma_f32_16x16x32_bf16 v[148:151], a[208:211], a[136:139], v[148:151]
    v_accvgpr_write_b32 a97, 0
    v_accvgpr_write_b32 a98, 0
    v_mfma_f32_16x16x32_bf16 v[140:143], a[208:211], a[132:135], v[140:143]
    ds_read_b64_tr_b16 a[204:205], v11 offset:13312
    v_accvgpr_write_b32 a99, 0
    v_mfma_f32_16x16x32_bf16 v[140:143], a[212:215], a[148:151], v[140:143]
    ds_read_b64_tr_b16 a[206:207], v11 offset:19456
    v_accvgpr_write_b32 a100, 0
    v_mfma_f32_16x16x32_bf16 v[132:135], a[212:215], a[144:147], v[132:135]
    s_add_u32 m0, s49, 77696
    v_accvgpr_write_b32 a101, 0
    v_accvgpr_write_b32 a102, 0
    v_mfma_f32_16x16x32_bf16 v[132:135], a[208:211], a[128:131], v[132:135]
    s_waitcnt lgkmcnt(4)
    v_accvgpr_write_b32 a103, 0
    v_accvgpr_write_b32 a104, 0
    v_mfma_f32_16x16x32_bf16 v[160:163], a[192:195], a[128:131], v[160:163]
    ds_read_b64_tr_b16 a[208:209], v8 offset:2048
    v_accvgpr_write_b32 a105, 0
    v_mfma_f32_16x16x32_bf16 v[160:163], a[196:199], a[144:147], v[160:163]
    ds_read_b64_tr_b16 a[210:211], v8 offset:8192
    v_accvgpr_write_b32 a106, 0
    v_mfma_f32_16x16x32_bf16 v[168:171], a[196:199], a[148:151], v[168:171]
    buffer_load_dwordx4 v3, s[8:11], s36 offen offset:128 lds
    v_mfma_f32_16x16x32_bf16 v[168:171], a[192:195], a[132:135], v[168:171]
    v_accvgpr_write_b32 a107, 0
    v_accvgpr_write_b32 a108, 0
    v_mfma_f32_16x16x32_bf16 v[176:179], a[192:195], a[136:139], v[176:179]
    s_add_u32 m0, s49, 78592
    ds_read_b64_tr_b16 a[212:213], v8 offset:14336
    v_accvgpr_write_b32 a109, 0
    v_mfma_f32_16x16x32_bf16 v[176:179], a[196:199], a[152:155], v[176:179]
    ds_read_b64_tr_b16 a[214:215], v8 offset:20480
    v_accvgpr_write_b32 a110, 0
    v_mfma_f32_16x16x32_bf16 v[184:187], a[196:199], a[156:159], v[184:187]
    buffer_load_dwordx4 v3, s[8:11], s36 offen offset:256 lds
    v_mfma_f32_16x16x32_bf16 v[184:187], a[192:195], a[140:143], v[184:187]
    s_waitcnt lgkmcnt(4)
    v_accvgpr_write_b32 a111, 0
    v_accvgpr_write_b32 a112, 0
    v_mfma_f32_16x16x32_bf16 v[188:191], a[200:203], a[140:143], v[188:191]
    s_add_u32 s36, s36, s37
    ds_read_b64_tr_b16 a[192:193], v9 offset:2048
    v_accvgpr_write_b32 a113, 0
    v_mfma_f32_16x16x32_bf16 v[188:191], a[204:207], a[156:159], v[188:191]
    s_sub_u32 s55, s36, 7864320
    ds_read_b64_tr_b16 a[194:195], v9 offset:8192
    v_accvgpr_write_b32 a114, 0
    v_mfma_f32_16x16x32_bf16 v[180:183], a[204:207], a[152:155], v[180:183]
    s_min_u32 s36, s36, s55
    ds_write_b64 v22, v[20:21]
    v_accvgpr_write_b32 a115, 0
    v_mfma_f32_16x16x32_bf16 v[180:183], a[200:203], a[136:139], v[180:183]
    s_add_u32 s46, s45, 53248
    v_accvgpr_write_b32 a116, 0
    v_accvgpr_write_b32 a117, 0
    v_mfma_f32_16x16x32_bf16 v[172:175], a[200:203], a[132:135], v[172:175]
    s_sub_u32 s77, s46, 81920
    ds_read_b64_tr_b16 a[196:197], v9 offset:14336
    v_accvgpr_write_b32 a118, 0
    v_mfma_f32_16x16x32_bf16 v[172:175], a[204:207], a[148:151], v[172:175]
    s_min_u32 s46, s46, s77
    ds_read_b64_tr_b16 a[198:199], v9 offset:20480
    v_accvgpr_write_b32 a119, 0
    v_mfma_f32_16x16x32_bf16 v[164:167], a[204:207], a[144:147], v[164:167]
    buffer_load_dwordx4 a[16:19], v28, s[20:23], s46 offen offset:0 sc1
    v_mfma_f32_16x16x32_bf16 v[164:167], a[200:203], a[128:131], v[164:167]
    s_waitcnt lgkmcnt(4)
    v_accvgpr_write_b32 a120, 0
    v_accvgpr_write_b32 a121, 0
    v_mfma_f32_16x16x32_bf16 v[192:195], a[208:211], a[128:131], v[192:195]
    ds_read_b64_tr_b16 a[200:201], v10 offset:2048
    v_accvgpr_write_b32 a122, 0
    v_mfma_f32_16x16x32_bf16 v[192:195], a[212:215], a[144:147], v[192:195]
    ds_read_b64_tr_b16 a[202:203], v10 offset:8192
    v_accvgpr_write_b32 a123, 0
    v_mfma_f32_16x16x32_bf16 v[200:203], a[212:215], a[148:151], v[200:203]
    buffer_load_dwordx4 a[20:23], v28, s[20:23], s46 offen offset:1024 sc1
    v_mfma_f32_16x16x32_bf16 v[200:203], a[208:211], a[132:135], v[200:203]
    v_accvgpr_write_b32 a124, 0
    v_accvgpr_write_b32 a125, 0
    v_mfma_f32_16x16x32_bf16 v[208:211], a[208:211], a[136:139], v[208:211]
    ds_read_b64_tr_b16 a[204:205], v10 offset:14336
    v_accvgpr_write_b32 a126, 0
    v_mfma_f32_16x16x32_bf16 v[208:211], a[212:215], a[152:155], v[208:211]
    ds_read_b64_tr_b16 a[206:207], v10 offset:20480
    v_accvgpr_write_b32 a127, 0
    v_mfma_f32_16x16x32_bf16 v[216:219], a[212:215], a[156:159], v[216:219]
    v_add_u32 v8, 24576, v12
    v_add_u32 v9, 24576, v13
    v_mfma_f32_16x16x32_bf16 v[216:219], a[208:211], a[140:143], v[216:219]
    s_waitcnt lgkmcnt(4)
    v_add_u32 v10, 24576, v14
    v_mfma_f32_16x16x32_bf16 v[220:223], a[192:195], a[140:143], v[220:223]
    ds_read_b64_tr_b16 a[208:209], v11 offset:2048
    v_mfma_f32_16x16x32_bf16 v[220:223], a[196:199], a[156:159], v[220:223]
    ds_read_b64_tr_b16 a[210:211], v11 offset:8192
    v_mfma_f32_16x16x32_bf16 v[212:215], a[196:199], a[152:155], v[212:215]
    buffer_load_dwordx4 a[24:27], v28, s[20:23], s46 offen offset:2048 sc1
    v_mfma_f32_16x16x32_bf16 v[212:215], a[192:195], a[136:139], v[212:215]
    v_mfma_f32_16x16x32_bf16 v[204:207], a[192:195], a[132:135], v[204:207]
    ds_read_b64_tr_b16 a[212:213], v11 offset:14336
    v_mfma_f32_16x16x32_bf16 v[204:207], a[196:199], a[148:151], v[204:207]
    s_waitcnt vmcnt(33)
    ds_read_b64_tr_b16 a[214:215], v11 offset:20480
    v_mfma_f32_16x16x32_bf16 v[196:199], a[196:199], a[144:147], v[196:199]
    s_barrier
    v_mfma_f32_16x16x32_bf16 v[196:199], a[192:195], a[128:131], v[196:199]
    s_waitcnt lgkmcnt(4)
    v_add_u32 v11, 24576, v15
    v_mfma_f32_16x16x32_bf16 v[224:227], a[200:203], a[128:131], v[224:227]
    ds_read_b64_tr_b16 a[192:193], v8 offset:0
    v_mfma_f32_16x16x32_bf16 v[224:227], a[204:207], a[144:147], v[224:227]
    ds_read_b64_tr_b16 a[194:195], v8 offset:6144
    v_mfma_f32_16x16x32_bf16 v[232:235], a[204:207], a[148:151], v[232:235]
    ds_read_b128 v[32:35], v23
    v_mfma_f32_16x16x32_bf16 v[232:235], a[200:203], a[132:135], v[232:235]
    ds_read_b128 v[36:39], v23 offset:16
    v_mfma_f32_16x16x32_bf16 v[240:243], a[200:203], a[136:139], v[240:243]
    ds_read_b64_tr_b16 a[196:197], v8 offset:12288
    v_mfma_f32_16x16x32_bf16 v[240:243], a[204:207], a[152:155], v[240:243]
    ds_read_b64_tr_b16 a[198:199], v8 offset:18432
    v_mfma_f32_16x16x32_bf16 v[248:251], a[204:207], a[156:159], v[248:251]
    buffer_load_dwordx4 a[28:31], v28, s[20:23], s46 offen offset:3072 sc1
    v_mfma_f32_16x16x32_bf16 v[248:251], a[200:203], a[140:143], v[248:251]
    s_waitcnt lgkmcnt(4)
    s_add_u32 s46, s45, 57344
    s_sub_u32 s77, s46, 81920
    v_mfma_f32_16x16x32_bf16 v[252:255], a[208:211], a[140:143], v[252:255]
    s_min_u32 s46, s46, s77
    ds_read_b64_tr_b16 a[200:201], v9 offset:0
    v_mfma_f32_16x16x32_bf16 v[252:255], a[212:215], a[156:159], v[252:255]
    ds_read_b64_tr_b16 a[202:203], v9 offset:6144
    v_mfma_f32_16x16x32_bf16 v[244:247], a[212:215], a[152:155], v[244:247]
    buffer_load_dwordx4 a[32:35], v28, s[20:23], s46 offen offset:0 sc1
    v_mfma_f32_16x16x32_bf16 v[244:247], a[208:211], a[136:139], v[244:247]
    v_mfma_f32_16x16x32_bf16 v[236:239], a[208:211], a[132:135], v[236:239]
    ds_read_b64_tr_b16 a[204:205], v9 offset:12288
    v_mfma_f32_16x16x32_bf16 v[236:239], a[212:215], a[148:151], v[236:239]
    s_waitcnt vmcnt(25)
    s_waitcnt vmcnt(15)
    ds_read_b64_tr_b16 a[206:207], v9 offset:18432
    v_mfma_f32_16x16x32_bf16 v[228:231], a[212:215], a[144:147], v[228:231]
    buffer_load_dwordx4 a[36:39], v28, s[20:23], s46 offen offset:1024 sc1
    v_mfma_f32_16x16x32_bf16 v[228:231], a[208:211], a[128:131], v[228:231]
    s_waitcnt lgkmcnt(4)
    v_mfma_f32_16x16x32_bf16 v[64:67], a[192:195], a[160:163], v[64:67]
    ds_read_b64_tr_b16 a[208:209], v10 offset:0
    v_mfma_f32_16x16x32_bf16 v[64:67], a[196:199], a[176:179], v[64:67]
    ds_read_b64_tr_b16 a[210:211], v10 offset:6144
    v_accvgpr_write_b32 a128, 0
    v_mfma_f32_16x16x32_bf16 v[72:75], a[196:199], a[180:183], v[72:75]
    v_accvgpr_write_b32 a129, 0
    v_mfma_f32_16x16x32_bf16 v[72:75], a[192:195], a[164:167], v[72:75]
    buffer_load_dwordx4 a[40:43], v28, s[20:23], s46 offen offset:2048 sc1
    v_mfma_f32_16x16x32_bf16 v[80:83], a[192:195], a[168:171], v[80:83]
    ds_read_b64_tr_b16 a[212:213], v10 offset:12288
    v_max_u32 v20, v32, v33
    v_mfma_f32_16x16x32_bf16 v[80:83], a[196:199], a[184:187], v[80:83]
    ds_read_b64_tr_b16 a[214:215], v10 offset:18432
    v_min_u32 v21, v32, v33
    v_mfma_f32_16x16x32_bf16 v[88:91], a[196:199], a[188:191], v[88:91]
    v_med3_u32 v21, v20, v21, v34
    v_max_u32 v20, v20, v34
    v_mfma_f32_16x16x32_bf16 v[88:91], a[192:195], a[172:175], v[88:91]
    s_waitcnt lgkmcnt(4)
    v_med3_u32 v21, v20, v21, v35
    v_max_u32 v20, v20, v35
    v_mfma_f32_16x16x32_bf16 v[92:95], a[200:203], a[172:175], v[92:95]
    ds_read_b64_tr_b16 a[192:193], v11 offset:0
    v_med3_u32 v21, v20, v21, v36
    v_mfma_f32_16x16x32_bf16 v[92:95], a[204:207], a[188:191], v[92:95]
    ds_read_b64_tr_b16 a[194:195], v11 offset:6144
    v_max_u32 v20, v20, v36
    v_mfma_f32_16x16x32_bf16 v[84:87], a[204:207], a[184:187], v[84:87]
    buffer_load_dwordx4 a[44:47], v28, s[20:23], s46 offen offset:3072 sc1
    v_mfma_f32_16x16x32_bf16 v[84:87], a[200:203], a[168:171], v[84:87]
    v_med3_u32 v21, v20, v21, v37
    v_max_u32 v20, v20, v37
    v_mfma_f32_16x16x32_bf16 v[76:79], a[200:203], a[164:167], v[76:79]
    ds_read_b64_tr_b16 a[196:197], v11 offset:12288
    v_med3_u32 v21, v20, v21, v38
    v_mfma_f32_16x16x32_bf16 v[76:79], a[204:207], a[180:183], v[76:79]
    ds_read_b64_tr_b16 a[198:199], v11 offset:18432
    v_max_u32 v20, v20, v38
    v_mfma_f32_16x16x32_bf16 v[68:71], a[204:207], a[176:179], v[68:71]
    v_med3_u32 v21, v20, v21, v39
    v_max_u32 v20, v20, v39
    v_mfma_f32_16x16x32_bf16 v[68:71], a[200:203], a[160:163], v[68:71]
    s_waitcnt lgkmcnt(4)
    v_and_b32 v22, 1, v1
    v_cmp_eq_u32 vcc, 1, v22
    v_mfma_f32_16x16x32_bf16 v[96:99], a[208:211], a[160:163], v[96:99]
    s_add_u32 m0, s49, 98304
    ds_read_b64_tr_b16 a[200:201], v8 offset:1024
    v_readfirstlane_b32 s70, v20
    v_mfma_f32_16x16x32_bf16 v[96:99], a[212:215], a[176:179], v[96:99]
    ds_read_b64_tr_b16 a[202:203], v8 offset:7168
    v_readfirstlane_b32 s71, v21
    v_mfma_f32_16x16x32_bf16 v[104:107], a[212:215], a[180:183], v[104:107]
    buffer_load_dwordx4 v2, s[8:11], s36 offen offset:0 lds
    v_mfma_f32_16x16x32_bf16 v[104:107], a[208:211], a[164:167], v[104:107]
    v_cndmask_b32 v22, v20, v21, vcc
    v_and_b32 v22, 0x7ff, v22
    v_mfma_f32_16x16x32_bf16 v[112:115], a[208:211], a[168:171], v[112:115]
    ds_read_b64_tr_b16 a[204:205], v8 offset:13312
    v_sub_u32 v22, 2047, v22
    v_mfma_f32_16x16x32_bf16 v[112:115], a[212:215], a[184:187], v[112:115]
    s_add_u32 m0, s49, 99200
    ds_read_b64_tr_b16 a[206:207], v8 offset:19456
    v_mul_u32_u24 v23, 1280, v22
    v_mfma_f32_16x16x32_bf16 v[120:123], a[212:215], a[188:191], v[120:123]
    buffer_load_dwordx4 v2, s[8:11], s36 offen offset:128 lds
    v_mfma_f32_16x16x32_bf16 v[120:123], a[208:211], a[172:175], v[120:123]
    s_waitcnt lgkmcnt(4)
    v_lshrrev_b32 v24, 4, v1
    v_lshl_add_u32 v23, v24, 4, v23
    v_mfma_f32_16x16x32_bf16 v[124:127], a[192:195], a[172:175], v[124:127]
    ds_read_b64_tr_b16 a[208:209], v9 offset:1024
    v_add_u32 v23, s61, v23
    v_mfma_f32_16x16x32_bf16 v[124:127], a[196:199], a[188:191], v[124:127]
    ds_read_b64_tr_b16 a[210:211], v9 offset:7168
    v_lshlrev_b32 v24, 3, v22
    v_mfma_f32_16x16x32_bf16 v[116:119], a[196:199], a[184:187], v[116:119]
    s_mov_b32 s56, 3211264
    v_accvgpr_write_b32 a130, 0
    v_accvgpr_write_b32 a131, 0
    v_mfma_f32_16x16x32_bf16 v[116:119], a[192:195], a[168:171], v[116:119]
    v_accvgpr_write_b32 a132, 0
    v_accvgpr_write_b32 a133, 0
    v_mfma_f32_16x16x32_bf16 v[108:111], a[192:195], a[164:167], v[108:111]
    s_add_u32 m0, s49, 100096
    ds_read_b64_tr_b16 a[212:213], v9 offset:13312
    v_accvgpr_write_b32 a134, 0
    v_mfma_f32_16x16x32_bf16 v[108:111], a[196:199], a[180:183], v[108:111]
    ds_read_b64_tr_b16 a[214:215], v9 offset:19456
    v_accvgpr_write_b32 a135, 0
    v_mfma_f32_16x16x32_bf16 v[100:103], a[196:199], a[176:179], v[100:103]
    buffer_load_dwordx4 v2, s[8:11], s36 offen offset:256 lds
    v_mfma_f32_16x16x32_bf16 v[100:103], a[192:195], a[160:163], v[100:103]
    s_waitcnt lgkmcnt(4)
    v_accvgpr_write_b32 a136, 0
    v_accvgpr_write_b32 a137, 0
    v_mfma_f32_16x16x32_bf16 v[128:131], a[200:203], a[160:163], v[128:131]
    ds_read_b64_tr_b16 a[192:193], v10 offset:1024
    v_accvgpr_write_b32 a138, 0
    v_mfma_f32_16x16x32_bf16 v[128:131], a[204:207], a[176:179], v[128:131]
    ds_read_b64_tr_b16 a[194:195], v10 offset:7168
    v_accvgpr_write_b32 a139, 0
    v_mfma_f32_16x16x32_bf16 v[136:139], a[204:207], a[180:183], v[136:139]
    s_add_u32 m0, s49, 101376
    v_accvgpr_write_b32 a140, 0
    v_accvgpr_write_b32 a141, 0
    v_mfma_f32_16x16x32_bf16 v[136:139], a[200:203], a[164:167], v[136:139]
    buffer_load_dwordx4 v3, s[8:11], s36 offen offset:0 lds
    v_mfma_f32_16x16x32_bf16 v[144:147], a[200:203], a[168:171], v[144:147]
    ds_read_b64_tr_b16 a[196:197], v10 offset:13312
    v_accvgpr_write_b32 a142, 0
    v_mfma_f32_16x16x32_bf16 v[144:147], a[204:207], a[184:187], v[144:147]
    ds_read_b64_tr_b16 a[198:199], v10 offset:19456
    v_accvgpr_write_b32 a143, 0
    v_mfma_f32_16x16x32_bf16 v[152:155], a[204:207], a[188:191], v[152:155]
    v_accvgpr_write_b32 a144, 0
    v_accvgpr_write_b32 a145, 0
    v_mfma_f32_16x16x32_bf16 v[152:155], a[200:203], a[172:175], v[152:155]
    s_waitcnt lgkmcnt(4)
    v_accvgpr_write_b32 a146, 0
    v_accvgpr_write_b32 a147, 0
    v_mfma_f32_16x16x32_bf16 v[156:159], a[208:211], a[172:175], v[156:159]
    ds_read_b64_tr_b16 a[200:201], v11 offset:1024
    v_accvgpr_write_b32 a148, 0
    v_mfma_f32_16x16x32_bf16 v[156:159], a[212:215], a[188:191], v[156:159]
    s_add_u32 m0, s49, 102272
    ds_read_b64_tr_b16 a[202:203], v11 offset:7168
    v_accvgpr_write_b32 a149, 0
    v_mfma_f32_16x16x32_bf16 v[148:151], a[212:215], a[184:187], v[148:151]
    buffer_load_dwordx4 v3, s[8:11], s36 offen offset:128 lds
    v_mfma_f32_16x16x32_bf16 v[148:151], a[208:211], a[168:171], v[148:151]
    v_accvgpr_write_b32 a150, 0
    v_accvgpr_write_b32 a151, 0
    v_mfma_f32_16x16x32_bf16 v[140:143], a[208:211], a[164:167], v[140:143]
    ds_read_b64_tr_b16 a[204:205], v11 offset:13312
    v_accvgpr_write_b32 a152, 0
    v_mfma_f32_16x16x32_bf16 v[140:143], a[212:215], a[180:183], v[140:143]
    ds_read_b64_tr_b16 a[206:207], v11 offset:19456
    v_accvgpr_write_b32 a153, 0
    v_mfma_f32_16x16x32_bf16 v[132:135], a[212:215], a[176:179], v[132:135]
    v_accvgpr_write_b32 a154, 0
    v_accvgpr_write_b32 a155, 0
    v_mfma_f32_16x16x32_bf16 v[132:135], a[208:211], a[160:163], v[132:135]
    s_waitcnt lgkmcnt(4)
    v_accvgpr_write_b32 a156, 0
    v_accvgpr_write_b32 a157, 0
    v_mfma_f32_16x16x32_bf16 v[160:163], a[192:195], a[160:163], v[160:163]
    s_add_u32 m0, s49, 103168
    ds_read_b64_tr_b16 a[208:209], v8 offset:2048
    v_accvgpr_write_b32 a158, 0
    v_mfma_f32_16x16x32_bf16 v[160:163], a[196:199], a[176:179], v[160:163]
    ds_read_b64_tr_b16 a[210:211], v8 offset:8192
    v_accvgpr_write_b32 a159, 0
    v_mfma_f32_16x16x32_bf16 v[168:171], a[196:199], a[180:183], v[168:171]
    buffer_load_dwordx4 v3, s[8:11], s36 offen offset:256 lds
    v_mfma_f32_16x16x32_bf16 v[168:171], a[192:195], a[164:167], v[168:171]
    s_add_u32 s36, s36, s37
    s_sub_u32 s55, s36, 7864320
    s_min_u32 s36, s36, s55
    v_mfma_f32_16x16x32_bf16 v[176:179], a[192:195], a[168:171], v[176:179]
    s_add_u32 s46, s45, 61440
    ds_read_b64_tr_b16 a[212:213], v8 offset:14336
    s_sub_u32 s77, s46, 81920
    v_mfma_f32_16x16x32_bf16 v[176:179], a[196:199], a[184:187], v[176:179]
    s_min_u32 s46, s46, s77
    ds_read_b64_tr_b16 a[214:215], v8 offset:20480
    v_mfma_f32_16x16x32_bf16 v[184:187], a[196:199], a[188:191], v[184:187]
    v_add_u32 v8, 49152, v12
    v_mfma_f32_16x16x32_bf16 v[184:187], a[192:195], a[172:175], v[184:187]
    s_waitcnt lgkmcnt(4)
    v_mfma_f32_16x16x32_bf16 v[188:191], a[200:203], a[172:175], v[188:191]
    ds_read_b64_tr_b16 a[192:193], v9 offset:2048
    v_mfma_f32_16x16x32_bf16 v[188:191], a[204:207], a[188:191], v[188:191]
    ds_read_b64_tr_b16 a[194:195], v9 offset:8192
    v_mfma_f32_16x16x32_bf16 v[180:183], a[204:207], a[184:187], v[180:183]
    buffer_load_dwordx4 a[48:51], v28, s[20:23], s46 offen offset:0 sc1
    v_mfma_f32_16x16x32_bf16 v[180:183], a[200:203], a[168:171], v[180:183]
    v_mfma_f32_16x16x32_bf16 v[172:175], a[200:203], a[164:167], v[172:175]
    ds_read_b64_tr_b16 a[196:197], v9 offset:14336
    v_mfma_f32_16x16x32_bf16 v[172:175], a[204:207], a[180:183], v[172:175]
    ds_read_b64_tr_b16 a[198:199], v9 offset:20480
    v_mfma_f32_16x16x32_bf16 v[164:167], a[204:207], a[176:179], v[164:167]
    buffer_load_dwordx4 a[52:55], v28, s[20:23], s46 offen offset:1024 sc1
    v_mfma_f32_16x16x32_bf16 v[164:167], a[200:203], a[160:163], v[164:167]
    s_waitcnt lgkmcnt(4)
    v_add_u32 v9, 49152, v13
    v_mfma_f32_16x16x32_bf16 v[192:195], a[208:211], a[160:163], v[192:195]
    ds_read_b64_tr_b16 a[200:201], v10 offset:2048
    v_mfma_f32_16x16x32_bf16 v[192:195], a[212:215], a[176:179], v[192:195]
    ds_read_b64_tr_b16 a[202:203], v10 offset:8192
    v_mfma_f32_16x16x32_bf16 v[200:203], a[212:215], a[180:183], v[200:203]
    v_mfma_f32_16x16x32_bf16 v[200:203], a[208:211], a[164:167], v[200:203]
    v_mfma_f32_16x16x32_bf16 v[208:211], a[208:211], a[168:171], v[208:211]
    ds_read_b64_tr_b16 a[204:205], v10 offset:14336
    v_mfma_f32_16x16x32_bf16 v[208:211], a[212:215], a[184:187], v[208:211]
    ds_read_b64_tr_b16 a[206:207], v10 offset:20480
    v_mfma_f32_16x16x32_bf16 v[216:219], a[212:215], a[188:191], v[216:219]
    buffer_load_dwordx4 a[56:59], v28, s[20:23], s46 offen offset:2048 sc1
    v_mfma_f32_16x16x32_bf16 v[216:219], a[208:211], a[172:175], v[216:219]
    s_waitcnt lgkmcnt(4)
    v_add_u32 v10, 49152, v14
    v_mfma_f32_16x16x32_bf16 v[220:223], a[192:195], a[172:175], v[220:223]
    ds_read_b64_tr_b16 a[208:209], v11 offset:2048
    v_mfma_f32_16x16x32_bf16 v[220:223], a[196:199], a[188:191], v[220:223]
    ds_read_b64_tr_b16 a[210:211], v11 offset:8192
    v_mfma_f32_16x16x32_bf16 v[212:215], a[196:199], a[184:187], v[212:215]
    buffer_load_dwordx4 a[60:63], v28, s[20:23], s46 offen offset:3072 sc1
    v_mfma_f32_16x16x32_bf16 v[212:215], a[192:195], a[168:171], v[212:215]
    v_mfma_f32_16x16x32_bf16 v[204:207], a[192:195], a[164:167], v[204:207]
    ds_read_b64_tr_b16 a[212:213], v11 offset:14336
    v_mfma_f32_16x16x32_bf16 v[204:207], a[196:199], a[180:183], v[204:207]
    s_waitcnt vmcnt(32)
    ds_read_b64_tr_b16 a[214:215], v11 offset:20480
    v_mfma_f32_16x16x32_bf16 v[196:199], a[196:199], a[176:179], v[196:199]
    s_barrier
    v_mfma_f32_16x16x32_bf16 v[196:199], a[192:195], a[160:163], v[196:199]
    s_waitcnt lgkmcnt(4)
    global_load_dwordx4 v[48:51], v23, s[64:65]
    v_mfma_f32_16x16x32_bf16 v[224:227], a[200:203], a[160:163], v[224:227]
    ds_read_b64_tr_b16 a[192:193], v8 offset:0
    v_add_u32 v11, 49152, v15
    v_mfma_f32_16x16x32_bf16 v[224:227], a[204:207], a[176:179], v[224:227]
    s_add_u32 m0, s44, 147456
    ds_read_b64_tr_b16 a[194:195], v8 offset:6144
    v_mfma_f32_16x16x32_bf16 v[232:235], a[204:207], a[180:183], v[232:235]
    global_load_dwordx4 v[52:55], v23, s[64:65] offset:64
    v_mfma_f32_16x16x32_bf16 v[232:235], a[200:203], a[164:167], v[232:235]
    buffer_load_dwordx2 v[40:41], v24, s[24:27], s56 offen sc1
    v_mfma_f32_16x16x32_bf16 v[240:243], a[200:203], a[168:171], v[240:243]
    ds_read_b64_tr_b16 a[196:197], v8 offset:12288
    v_bfe_u32 v26, v1, 2, 3
    v_mfma_f32_16x16x32_bf16 v[240:243], a[204:207], a[184:187], v[240:243]
    ds_read_b64_tr_b16 a[198:199], v8 offset:18432
    v_lshlrev_b32 v25, 7, v26
    v_mfma_f32_16x16x32_bf16 v[248:251], a[204:207], a[188:191], v[248:251]
    buffer_load_dword v61, v60, s[24:27], s47 offen offset:12 sc1
    v_mfma_f32_16x16x32_bf16 v[248:251], a[200:203], a[172:175], v[248:251]
    s_waitcnt lgkmcnt(4)
    buffer_load_dwordx4 v56, s[28:31], s60 offen lds
    v_mfma_f32_16x16x32_bf16 v[252:255], a[208:211], a[172:175], v[252:255]
    s_add_u32 m0, s44, 148480
    ds_read_b64_tr_b16 a[200:201], v9 offset:0
    v_lshrrev_b32 v26, 1, v26
    v_mfma_f32_16x16x32_bf16 v[252:255], a[212:215], a[188:191], v[252:255]
    ds_read_b64_tr_b16 a[202:203], v9 offset:6144
    v_xor_b32 v26, s3, v26
    v_mfma_f32_16x16x32_bf16 v[244:247], a[212:215], a[184:187], v[244:247]
pg_3:
    s_cbranch_execz pg_ret
    buffer_load_dwordx4 v56, s[32:35], s60 offen lds
    v_mfma_f32_16x16x32_bf16 v[244:247], a[208:211], a[168:171], v[244:247]
    s_add_u32 m0, s44, 149504
    v_lshl_add_u32 v25, v26, 5, v25
    v_and_b32 v26, 3, v1
    v_mfma_f32_16x16x32_bf16 v[236:239], a[208:211], a[164:167], v[236:239]
    ds_read_b64_tr_b16 a[204:205], v9 offset:12288
    v_lshl_add_u32 v25, v26, 3, v25
    v_mfma_f32_16x16x32_bf16 v[236:239], a[212:215], a[180:183], v[236:239]
    s_waitcnt vmcnt(30)
    s_waitcnt vmcnt(20)
    ds_read_b64_tr_b16 a[206:207], v9 offset:18432
    v_mfma_f32_16x16x32_bf16 v[228:231], a[212:215], a[176:179], v[228:231]
    buffer_load_dwordx4 v57, s[28:31], s60 offen lds
    v_mfma_f32_16x16x32_bf16 v[228:231], a[208:211], a[160:163], v[228:231]
    s_waitcnt lgkmcnt(4)
    v_lshrrev_b32 v26, 5, v1
    v_mul_u32_u24 v26, 2048, v26
    v_mfma_f32_16x16x32_bf16 v[64:67], a[192:195], a[0:3], v[64:67]
    s_add_u32 m0, s44, 150528
    ds_read_b64_tr_b16 a[208:209], v10 offset:0
    v_add_u32 v25, v25, v26
    v_mfma_f32_16x16x32_bf16 v[64:67], a[196:199], a[16:19], v[64:67]
    ds_read_b64_tr_b16 a[210:211], v10 offset:6144
    v_add_u32 v25, 147456, v25
    v_mfma_f32_16x16x32_bf16 v[72:75], a[196:199], a[20:23], v[72:75]
    buffer_load_dwordx4 v57, s[32:35], s60 offen lds
    v_mfma_f32_16x16x32_bf16 v[72:75], a[192:195], a[4:7], v[72:75]
    v_lshlrev_b32 v26, 4, v1
    v_cmp_gt_u32 vcc, 16, v1
    v_mfma_f32_16x16x32_bf16 v[80:83], a[192:195], a[8:11], v[80:83]
    ds_read_b64_tr_b16 a[212:213], v10 offset:12288
    v_mov_b32 v27, 0x7ffffff0
    v_mfma_f32_16x16x32_bf16 v[80:83], a[196:199], a[24:27], v[80:83]
    ds_read_b64_tr_b16 a[214:215], v10 offset:18432
    v_cndmask_b32 v26, v27, v26, vcc
    v_mfma_f32_16x16x32_bf16 v[88:91], a[196:199], a[28:31], v[88:91]
    v_accvgpr_write_b32 a160, 0
    v_mfma_f32_16x16x32_bf16 v[88:91], a[192:195], a[12:15], v[88:91]
    s_waitcnt lgkmcnt(4)
    v_accvgpr_write_b32 a161, 0
    v_mfma_f32_16x16x32_bf16 v[92:95], a[200:203], a[12:15], v[92:95]
    s_add_u32 s46, s45, 65536
    ds_read_b64_tr_b16 a[192:193], v11 offset:0
    v_accvgpr_write_b32 a162, 0
    v_mfma_f32_16x16x32_bf16 v[92:95], a[204:207], a[28:31], v[92:95]
    s_sub_u32 s77, s46, 81920
    ds_read_b64_tr_b16 a[194:195], v11 offset:6144
    v_accvgpr_write_b32 a163, 0
    v_mfma_f32_16x16x32_bf16 v[84:87], a[204:207], a[24:27], v[84:87]
    s_min_u32 s46, s46, s77
    v_accvgpr_write_b32 a164, 0
    v_mfma_f32_16x16x32_bf16 v[84:87], a[200:203], a[8:11], v[84:87]
    buffer_load_dwordx4 a[64:67], v28, s[20:23], s46 offen offset:0 sc1
    v_mfma_f32_16x16x32_bf16 v[76:79], a[200:203], a[4:7], v[76:79]
    ds_read_b64_tr_b16 a[196:197], v11 offset:12288
    v_accvgpr_write_b32 a165, 0
    v_mfma_f32_16x16x32_bf16 v[76:79], a[204:207], a[20:23], v[76:79]
    ds_read_b64_tr_b16 a[198:199], v11 offset:18432
    v_accvgpr_write_b32 a166, 0
    v_mfma_f32_16x16x32_bf16 v[68:71], a[204:207], a[16:19], v[68:71]
    v_accvgpr_write_b32 a167, 0
    v_mfma_f32_16x16x32_bf16 v[68:71], a[200:203], a[0:3], v[68:71]
    s_waitcnt lgkmcnt(4)
    v_accvgpr_write_b32 a168, 0
    v_mfma_f32_16x16x32_bf16 v[96:99], a[208:211], a[0:3], v[96:99]
    ds_read_b64_tr_b16 a[200:201], v8 offset:1024
    v_accvgpr_write_b32 a169, 0
    v_mfma_f32_16x16x32_bf16 v[96:99], a[212:215], a[16:19], v[96:99]
    ds_read_b64_tr_b16 a[202:203], v8 offset:7168
    v_accvgpr_write_b32 a170, 0
    v_mfma_f32_16x16x32_bf16 v[104:107], a[212:215], a[20:23], v[104:107]
    buffer_load_dwordx4 a[68:71], v28, s[20:23], s46 offen offset:1024 sc1
    v_mfma_f32_16x16x32_bf16 v[104:107], a[208:211], a[4:7], v[104:107]
    v_accvgpr_write_b32 a171, 0
    v_accvgpr_write_b32 a172, 0
    v_mfma_f32_16x16x32_bf16 v[112:115], a[208:211], a[8:11], v[112:115]
    ds_read_b64_tr_b16 a[204:205], v8 offset:13312
    v_accvgpr_write_b32 a173, 0
    v_mfma_f32_16x16x32_bf16 v[112:115], a[212:215], a[24:27], v[112:115]
    ds_read_b64_tr_b16 a[206:207], v8 offset:19456
    v_accvgpr_write_b32 a174, 0
    v_mfma_f32_16x16x32_bf16 v[120:123], a[212:215], a[28:31], v[120:123]
    v_accvgpr_write_b32 a175, 0
    v_accvgpr_write_b32 a176, 0
    v_mfma_f32_16x16x32_bf16 v[120:123], a[208:211], a[12:15], v[120:123]
    s_waitcnt lgkmcnt(4)
    v_accvgpr_write_b32 a177, 0
    v_accvgpr_write_b32 a178, 0
    v_mfma_f32_16x16x32_bf16 v[124:127], a[192:195], a[12:15], v[124:127]
    ds_read_b64_tr_b16 a[208:209], v9 offset:1024
    v_accvgpr_write_b32 a179, 0
    v_mfma_f32_16x16x32_bf16 v[124:127], a[196:199], a[28:31], v[124:127]
    ds_read_b64_tr_b16 a[210:211], v9 offset:7168
    v_accvgpr_write_b32 a180, 0
    v_mfma_f32_16x16x32_bf16 v[116:119], a[196:199], a[24:27], v[116:119]
    buffer_load_dwordx4 a[72:75], v28, s[20:23], s46 offen offset:2048 sc1
    v_mfma_f32_16x16x32_bf16 v[116:119], a[192:195], a[8:11], v[116:119]
    v_accvgpr_write_b32 a181, 0
    v_accvgpr_write_b32 a182, 0
    v_mfma_f32_16x16x32_bf16 v[108:111], a[192:195], a[4:7], v[108:111]
    ds_read_b64_tr_b16 a[212:213], v9 offset:13312
    v_accvgpr_write_b32 a183, 0
    v_mfma_f32_16x16x32_bf16 v[108:111], a[196:199], a[20:23], v[108:111]
    ds_read_b64_tr_b16 a[214:215], v9 offset:19456
    v_accvgpr_write_b32 a184, 0
    v_mfma_f32_16x16x32_bf16 v[100:103], a[196:199], a[16:19], v[100:103]
    buffer_load_dwordx4 a[76:79], v28, s[20:23], s46 offen offset:3072 sc1
    v_mfma_f32_16x16x32_bf16 v[100:103], a[192:195], a[0:3], v[100:103]
    s_waitcnt lgkmcnt(4)
    v_accvgpr_write_b32 a185, 0
    v_accvgpr_write_b32 a186, 0
    v_mfma_f32_16x16x32_bf16 v[128:131], a[200:203], a[0:3], v[128:131]
    ds_read_b64_tr_b16 a[192:193], v10 offset:1024
    v_accvgpr_write_b32 a187, 0
    v_mfma_f32_16x16x32_bf16 v[128:131], a[204:207], a[16:19], v[128:131]
    ds_read_b64_tr_b16 a[194:195], v10 offset:7168
    v_accvgpr_write_b32 a188, 0
    v_mfma_f32_16x16x32_bf16 v[136:139], a[204:207], a[20:23], v[136:139]
    v_accvgpr_write_b32 a189, 0
    v_accvgpr_write_b32 a190, 0
    v_mfma_f32_16x16x32_bf16 v[136:139], a[200:203], a[4:7], v[136:139]
    v_accvgpr_write_b32 a191, 0
    v_mfma_f32_16x16x32_bf16 v[144:147], a[200:203], a[8:11], v[144:147]
    s_add_u32 m0, s49, 122880
    ds_read_b64_tr_b16 a[196:197], v10 offset:13312
    v_mfma_f32_16x16x32_bf16 v[144:147], a[204:207], a[24:27], v[144:147]
    ds_read_b64_tr_b16 a[198:199], v10 offset:19456
    v_mfma_f32_16x16x32_bf16 v[152:155], a[204:207], a[28:31], v[152:155]
    buffer_load_dwordx4 v2, s[8:11], s36 offen offset:0 lds
    v_mfma_f32_16x16x32_bf16 v[152:155], a[200:203], a[12:15], v[152:155]
    s_waitcnt lgkmcnt(4)
    v_mfma_f32_16x16x32_bf16 v[156:159], a[208:211], a[12:15], v[156:159]
    ds_read_b64_tr_b16 a[200:201], v11 offset:1024
    v_mfma_f32_16x16x32_bf16 v[156:159], a[212:215], a[28:31], v[156:159]
    ds_read_b64_tr_b16 a[202:203], v11 offset:7168
    v_mfma_f32_16x16x32_bf16 v[148:151], a[212:215], a[24:27], v[148:151]
    s_add_u32 m0, s49, 123776
    v_mfma_f32_16x16x32_bf16 v[148:151], a[208:211], a[8:11], v[148:151]
    buffer_load_dwordx4 v2, s[8:11], s36 offen offset:128 lds
    v_mfma_f32_16x16x32_bf16 v[140:143], a[208:211], a[4:7], v[140:143]
    ds_read_b64_tr_b16 a[204:205], v11 offset:13312
    v_mfma_f32_16x16x32_bf16 v[140:143], a[212:215], a[20:23], v[140:143]
    ds_read_b64_tr_b16 a[206:207], v11 offset:19456
    v_mfma_f32_16x16x32_bf16 v[132:135], a[212:215], a[16:19], v[132:135]
    v_mfma_f32_16x16x32_bf16 v[132:135], a[208:211], a[0:3], v[132:135]
    s_waitcnt lgkmcnt(4)
    v_mfma_f32_16x16x32_bf16 v[160:163], a[192:195], a[0:3], v[160:163]
    ds_read_b64_tr_b16 a[208:209], v8 offset:2048
    v_mfma_f32_16x16x32_bf16 v[160:163], a[196:199], a[16:19], v[160:163]
    s_add_u32 m0, s49, 124672
    ds_read_b64_tr_b16 a[210:211], v8 offset:8192
    v_mfma_f32_16x16x32_bf16 v[168:171], a[196:199], a[20:23], v[168:171]
    buffer_load_dwordx4 v2, s[8:11], s36 offen offset:256 lds
    v_mfma_f32_16x16x32_bf16 v[168:171], a[192:195], a[4:7], v[168:171]
    v_mfma_f32_16x16x32_bf16 v[176:179], a[192:195], a[8:11], v[176:179]
    ds_read_b64_tr_b16 a[212:213], v8 offset:14336
    v_mfma_f32_16x16x32_bf16 v[176:179], a[196:199], a[24:27], v[176:179]
    ds_read_b64_tr_b16 a[214:215], v8 offset:20480
    v_mfma_f32_16x16x32_bf16 v[184:187], a[196:199], a[28:31], v[184:187]
    v_add_u32 v8, 73728, v12
    v_mfma_f32_16x16x32_bf16 v[184:187], a[192:195], a[12:15], v[184:187]
    s_waitcnt lgkmcnt(4)
    s_add_u32 m0, s49, 125952
    v_mfma_f32_16x16x32_bf16 v[188:191], a[200:203], a[12:15], v[188:191]
    ds_read_b64_tr_b16 a[192:193], v9 offset:2048
    v_mfma_f32_16x16x32_bf16 v[188:191], a[204:207], a[28:31], v[188:191]
    ds_read_b64_tr_b16 a[194:195], v9 offset:8192
    v_mfma_f32_16x16x32_bf16 v[180:183], a[204:207], a[24:27], v[180:183]
    buffer_load_dwordx4 v3, s[8:11], s36 offen offset:0 lds
    v_mfma_f32_16x16x32_bf16 v[180:183], a[200:203], a[8:11], v[180:183]
    v_mfma_f32_16x16x32_bf16 v[172:175], a[200:203], a[4:7], v[172:175]
    ds_read_b64_tr_b16 a[196:197], v9 offset:14336
    v_mfma_f32_16x16x32_bf16 v[172:175], a[204:207], a[20:23], v[172:175]
    ds_read_b64_tr_b16 a[198:199], v9 offset:20480
    v_mfma_f32_16x16x32_bf16 v[164:167], a[204:207], a[16:19], v[164:167]
    s_add_u32 m0, s49, 126848
    v_add_u32 v9, 73728, v13
    v_mfma_f32_16x16x32_bf16 v[164:167], a[200:203], a[0:3], v[164:167]
    s_waitcnt lgkmcnt(4)
    v_mfma_f32_16x16x32_bf16 v[192:195], a[208:211], a[0:3], v[192:195]
    ds_read_b64_tr_b16 a[200:201], v10 offset:2048
    v_mfma_f32_16x16x32_bf16 v[192:195], a[212:215], a[16:19], v[192:195]
    ds_read_b64_tr_b16 a[202:203], v10 offset:8192
    v_mfma_f32_16x16x32_bf16 v[200:203], a[212:215], a[20:23], v[200:203]
    buffer_load_dwordx4 v3, s[8:11], s36 offen offset:128 lds
    v_mfma_f32_16x16x32_bf16 v[200:203], a[208:211], a[4:7], v[200:203]
    v_mfma_f32_16x16x32_bf16 v[208:211], a[208:211], a[8:11], v[208:211]
    s_add_u32 m0, s49, 127744
    ds_read_b64_tr_b16 a[204:205], v10 offset:14336
    v_mfma_f32_16x16x32_bf16 v[208:211], a[212:215], a[24:27], v[208:211]
    ds_read_b64_tr_b16 a[206:207], v10 offset:20480
    v_mfma_f32_16x16x32_bf16 v[216:219], a[212:215], a[28:31], v[216:219]
    buffer_load_dwordx4 v3, s[8:11], s36 offen offset:256 lds
    v_mfma_f32_16x16x32_bf16 v[216:219], a[208:211], a[12:15], v[216:219]
    s_waitcnt lgkmcnt(4)
    v_add_u32 v10, 73728, v14
    s_add_u32 s36, s36, s37
    v_mfma_f32_16x16x32_bf16 v[220:223], a[192:195], a[12:15], v[220:223]
    s_sub_u32 s55, s36, 7864320
    ds_read_b64_tr_b16 a[208:209], v11 offset:2048
    s_min_u32 s36, s36, s55
    v_mfma_f32_16x16x32_bf16 v[220:223], a[196:199], a[28:31], v[220:223]
    s_add_u32 s46, s45, 69632
    ds_read_b64_tr_b16 a[210:211], v11 offset:8192
    s_sub_u32 s77, s46, 81920
    v_mfma_f32_16x16x32_bf16 v[212:215], a[196:199], a[24:27], v[212:215]
    s_min_u32 s46, s46, s77
    v_mfma_f32_16x16x32_bf16 v[212:215], a[192:195], a[8:11], v[212:215]
    v_mfma_f32_16x16x32_bf16 v[204:207], a[192:195], a[4:7], v[204:207]
    ds_read_b64_tr_b16 a[212:213], v11 offset:14336
    v_mfma_f32_16x16x32_bf16 v[204:207], a[196:199], a[20:23], v[204:207]
    s_waitcnt vmcnt(36)
    ds_read_b64_tr_b16 a[214:215], v11 offset:20480
    v_mfma_f32_16x16x32_bf16 v[196:199], a[196:199], a[16:19], v[196:199]
    s_barrier
    v_mfma_f32_16x16x32_bf16 v[196:199], a[192:195], a[0:3], v[196:199]
    s_waitcnt lgkmcnt(4)
    buffer_load_dwordx4 a[80:83], v28, s[20:23], s46 offen offset:0 sc1
    v_mfma_f32_16x16x32_bf16 v[224:227], a[200:203], a[0:3], v[224:227]
    ds_read_b64_tr_b16 a[192:193], v8 offset:0
    v_add_u32 v11, 73728, v15
    v_mfma_f32_16x16x32_bf16 v[224:227], a[204:207], a[16:19], v[224:227]
    ds_read_b64_tr_b16 a[194:195], v8 offset:6144
    v_mfma_f32_16x16x32_bf16 v[232:235], a[204:207], a[20:23], v[232:235]
    buffer_load_dwordx4 a[84:87], v28, s[20:23], s46 offen offset:1024 sc1
    v_mfma_f32_16x16x32_bf16 v[232:235], a[200:203], a[4:7], v[232:235]
    v_mfma_f32_16x16x32_bf16 v[240:243], a[200:203], a[8:11], v[240:243]
    ds_read_b64_tr_b16 a[196:197], v8 offset:12288
    v_mfma_f32_16x16x32_bf16 v[240:243], a[204:207], a[24:27], v[240:243]
    ds_read_b64_tr_b16 a[198:199], v8 offset:18432
    v_mfma_f32_16x16x32_bf16 v[248:251], a[204:207], a[28:31], v[248:251]
    v_mfma_f32_16x16x32_bf16 v[248:251], a[200:203], a[12:15], v[248:251]
    s_waitcnt lgkmcnt(4)
    v_mfma_f32_16x16x32_bf16 v[252:255], a[208:211], a[12:15], v[252:255]
    ds_read_b64_tr_b16 a[200:201], v9 offset:0
    v_mfma_f32_16x16x32_bf16 v[252:255], a[212:215], a[28:31], v[252:255]
    ds_read_b64_tr_b16 a[202:203], v9 offset:6144
    v_mfma_f32_16x16x32_bf16 v[244:247], a[212:215], a[24:27], v[244:247]
    buffer_load_dwordx4 a[88:91], v28, s[20:23], s46 offen offset:2048 sc1
    v_mfma_f32_16x16x32_bf16 v[244:247], a[208:211], a[8:11], v[244:247]
    v_mfma_f32_16x16x32_bf16 v[236:239], a[208:211], a[4:7], v[236:239]
    ds_read_b64_tr_b16 a[204:205], v9 offset:12288
    v_mfma_f32_16x16x32_bf16 v[236:239], a[212:215], a[20:23], v[236:239]
    s_waitcnt vmcnt(31)
    s_waitcnt vmcnt(21)
    ds_read_b64_tr_b16 a[206:207], v9 offset:18432
    v_mfma_f32_16x16x32_bf16 v[228:231], a[212:215], a[16:19], v[228:231]
    v_mfma_f32_16x16x32_bf16 v[228:231], a[208:211], a[0:3], v[228:231]
    s_waitcnt lgkmcnt(4)
    v_mfma_f32_16x16x32_bf16 v[64:67], a[192:195], a[32:35], v[64:67]
    ds_read_b64_tr_b16 a[208:209], v10 offset:0
    v_mfma_f32_16x16x32_bf16 v[64:67], a[196:199], a[48:51], v[64:67]
    ds_read_b64_tr_b16 a[210:211], v10 offset:6144
    v_accvgpr_write_b32 a0, 0
    v_mfma_f32_16x16x32_bf16 v[72:75], a[196:199], a[52:55], v[72:75]
    buffer_load_dwordx4 a[92:95], v28, s[20:23], s46 offen offset:3072 sc1
    v_mfma_f32_16x16x32_bf16 v[72:75], a[192:195], a[36:39], v[72:75]
    s_add_u32 s46, s45, 73728
    v_accvgpr_write_b32 a1, 0
    v_mfma_f32_16x16x32_bf16 v[80:83], a[192:195], a[40:43], v[80:83]
    s_sub_u32 s77, s46, 81920
    ds_read_b64_tr_b16 a[212:213], v10 offset:12288
    v_accvgpr_write_b32 a2, 0
    v_mfma_f32_16x16x32_bf16 v[80:83], a[196:199], a[56:59], v[80:83]
    s_min_u32 s46, s46, s77
    ds_read_b64_tr_b16 a[214:215], v10 offset:18432
    v_accvgpr_write_b32 a3, 0
    v_mfma_f32_16x16x32_bf16 v[88:91], a[196:199], a[60:63], v[88:91]
    buffer_load_dwordx4 a[224:227], v28, s[20:23], s46 offen offset:0 sc1
    v_mfma_f32_16x16x32_bf16 v[88:91], a[192:195], a[44:47], v[88:91]
    s_waitcnt lgkmcnt(4)
    v_accvgpr_write_b32 a4, 0
    v_mfma_f32_16x16x32_bf16 v[92:95], a[200:203], a[44:47], v[92:95]
    s_waitcnt vmcnt(20)
    ds_read_b64_tr_b16 a[192:193], v11 offset:0
    v_lshlrev_b32 v42, 16, v48
    v_mfma_f32_16x16x32_bf16 v[92:95], a[204:207], a[60:63], v[92:95]
    ds_read_b64_tr_b16 a[194:195], v11 offset:6144
    v_and_b32 v43, 0xffff0000, v48
    v_mfma_f32_16x16x32_bf16 v[84:87], a[204:207], a[56:59], v[84:87]
    v_sub_f32 v42, v42, v40
    v_sub_f32 v43, v43, v40
    v_mfma_f32_16x16x32_bf16 v[84:87], a[200:203], a[40:43], v[84:87]
    v_cvt_pk_bf16_f32 v44, v42, v43
    v_lshlrev_b32 v42, 16, v44
    v_mfma_f32_16x16x32_bf16 v[76:79], a[200:203], a[36:39], v[76:79]
    ds_read_b64_tr_b16 a[196:197], v11 offset:12288
    v_and_b32 v43, 0xffff0000, v44
    v_mfma_f32_16x16x32_bf16 v[76:79], a[204:207], a[52:55], v[76:79]
    ds_read_b64_tr_b16 a[198:199], v11 offset:18432
    v_mul_f32 v42, v42, v41
    v_mfma_f32_16x16x32_bf16 v[68:71], a[204:207], a[48:51], v[68:71]
    buffer_load_dwordx4 a[228:231], v28, s[20:23], s46 offen offset:1024 sc1
    v_mfma_f32_16x16x32_bf16 v[68:71], a[200:203], a[32:35], v[68:71]
    s_waitcnt lgkmcnt(4)
    v_mul_f32 v43, v43, v41
    v_cvt_pk_bf16_f32 v48, v42, v43
    v_mfma_f32_16x16x32_bf16 v[96:99], a[208:211], a[32:35], v[96:99]
    ds_read_b64_tr_b16 a[200:201], v8 offset:1024
    v_lshlrev_b32 v42, 16, v49
    v_mfma_f32_16x16x32_bf16 v[96:99], a[212:215], a[48:51], v[96:99]
    ds_read_b64_tr_b16 a[202:203], v8 offset:7168
    v_and_b32 v43, 0xffff0000, v49
    v_mfma_f32_16x16x32_bf16 v[104:107], a[212:215], a[52:55], v[104:107]
    s_waitcnt vmcnt(20)
    v_sub_f32 v42, v42, v40
    v_sub_f32 v43, v43, v40
    v_mfma_f32_16x16x32_bf16 v[104:107], a[208:211], a[36:39], v[104:107]
    buffer_load_dwordx4 a[232:235], v28, s[20:23], s46 offen offset:2048 sc1
    v_mfma_f32_16x16x32_bf16 v[112:115], a[208:211], a[40:43], v[112:115]
    ds_read_b64_tr_b16 a[204:205], v8 offset:13312
    v_cvt_pk_bf16_f32 v44, v42, v43
    v_mfma_f32_16x16x32_bf16 v[112:115], a[212:215], a[56:59], v[112:115]
    ds_read_b64_tr_b16 a[206:207], v8 offset:19456
    v_lshlrev_b32 v42, 16, v44
    v_mfma_f32_16x16x32_bf16 v[120:123], a[212:215], a[60:63], v[120:123]
    v_and_b32 v43, 0xffff0000, v44
    v_mul_f32 v42, v42, v41
    v_mfma_f32_16x16x32_bf16 v[120:123], a[208:211], a[44:47], v[120:123]
    s_waitcnt lgkmcnt(4)
    v_mul_f32 v43, v43, v41
    v_cvt_pk_bf16_f32 v49, v42, v43
    v_mfma_f32_16x16x32_bf16 v[124:127], a[192:195], a[44:47], v[124:127]
    ds_read_b64_tr_b16 a[208:209], v9 offset:1024
    v_lshlrev_b32 v42, 16, v50
    v_mfma_f32_16x16x32_bf16 v[124:127], a[196:199], a[60:63], v[124:127]
    ds_read_b64_tr_b16 a[210:211], v9 offset:7168
    v_and_b32 v43, 0xffff0000, v50
    v_mfma_f32_16x16x32_bf16 v[116:119], a[196:199], a[56:59], v[116:119]
    buffer_load_dwordx4 a[236:239], v28, s[20:23], s46 offen offset:3072 sc1
    v_mfma_f32_16x16x32_bf16 v[116:119], a[192:195], a[40:43], v[116:119]
    v_sub_f32 v42, v42, v40
    v_sub_f32 v43, v43, v40
    v_mfma_f32_16x16x32_bf16 v[108:111], a[192:195], a[36:39], v[108:111]
    s_add_u32 s46, s45, 77824
    ds_read_b64_tr_b16 a[212:213], v9 offset:13312
    v_cvt_pk_bf16_f32 v44, v42, v43
    v_mfma_f32_16x16x32_bf16 v[108:111], a[196:199], a[52:55], v[108:111]
    s_sub_u32 s77, s46, 81920
    ds_read_b64_tr_b16 a[214:215], v9 offset:19456
    v_lshlrev_b32 v42, 16, v44
    v_mfma_f32_16x16x32_bf16 v[100:103], a[196:199], a[48:51], v[100:103]
    s_min_u32 s46, s46, s77
    v_and_b32 v43, 0xffff0000, v44
    v_mul_f32 v42, v42, v41
    v_mfma_f32_16x16x32_bf16 v[100:103], a[192:195], a[32:35], v[100:103]
    s_waitcnt lgkmcnt(4)
    v_mul_f32 v43, v43, v41
    v_cvt_pk_bf16_f32 v50, v42, v43
    v_mfma_f32_16x16x32_bf16 v[128:131], a[200:203], a[32:35], v[128:131]
    ds_read_b64_tr_b16 a[192:193], v10 offset:1024
    v_lshlrev_b32 v42, 16, v51
    v_mfma_f32_16x16x32_bf16 v[128:131], a[204:207], a[48:51], v[128:131]
    ds_read_b64_tr_b16 a[194:195], v10 offset:7168
    v_and_b32 v43, 0xffff0000, v51
    v_mfma_f32_16x16x32_bf16 v[136:139], a[204:207], a[52:55], v[136:139]
    buffer_load_dwordx4 a[240:243], v28, s[20:23], s46 offen offset:0 sc1
    v_mfma_f32_16x16x32_bf16 v[136:139], a[200:203], a[36:39], v[136:139]
    v_sub_f32 v42, v42, v40
    v_sub_f32 v43, v43, v40
    v_mfma_f32_16x16x32_bf16 v[144:147], a[200:203], a[40:43], v[144:147]
    ds_read_b64_tr_b16 a[196:197], v10 offset:13312
    v_cvt_pk_bf16_f32 v44, v42, v43
    v_mfma_f32_16x16x32_bf16 v[144:147], a[204:207], a[56:59], v[144:147]
    ds_read_b64_tr_b16 a[198:199], v10 offset:19456
    v_lshlrev_b32 v42, 16, v44
    v_mfma_f32_16x16x32_bf16 v[152:155], a[204:207], a[60:63], v[152:155]
    buffer_load_dwordx4 a[244:247], v28, s[20:23], s46 offen offset:1024 sc1
    v_mfma_f32_16x16x32_bf16 v[152:155], a[200:203], a[44:47], v[152:155]
    s_waitcnt lgkmcnt(4)
    v_and_b32 v43, 0xffff0000, v44
    v_mul_f32 v42, v42, v41
    v_mfma_f32_16x16x32_bf16 v[156:159], a[208:211], a[44:47], v[156:159]
    ds_read_b64_tr_b16 a[200:201], v11 offset:1024
    v_mul_f32 v43, v43, v41
    v_mfma_f32_16x16x32_bf16 v[156:159], a[212:215], a[60:63], v[156:159]
    ds_read_b64_tr_b16 a[202:203], v11 offset:7168
    v_cvt_pk_bf16_f32 v51, v42, v43
    v_mfma_f32_16x16x32_bf16 v[148:151], a[212:215], a[56:59], v[148:151]
    v_lshlrev_b32 v42, 16, v52
    v_and_b32 v43, 0xffff0000, v52
    v_mfma_f32_16x16x32_bf16 v[148:151], a[208:211], a[40:43], v[148:151]
    v_sub_f32 v42, v42, v40
    v_sub_f32 v43, v43, v40
    v_mfma_f32_16x16x32_bf16 v[140:143], a[208:211], a[36:39], v[140:143]
    ds_read_b64_tr_b16 a[204:205], v11 offset:13312
    v_cvt_pk_bf16_f32 v44, v42, v43
    v_mfma_f32_16x16x32_bf16 v[140:143], a[212:215], a[52:55], v[140:143]
    ds_read_b64_tr_b16 a[206:207], v11 offset:19456
    v_lshlrev_b32 v42, 16, v44
    v_mfma_f32_16x16x32_bf16 v[132:135], a[212:215], a[48:51], v[132:135]
    buffer_load_dwordx4 a[248:251], v28, s[20:23], s46 offen offset:2048 sc1
    v_mfma_f32_16x16x32_bf16 v[132:135], a[208:211], a[32:35], v[132:135]
    s_waitcnt lgkmcnt(4)
    v_and_b32 v43, 0xffff0000, v44
    v_mul_f32 v42, v42, v41
    v_mfma_f32_16x16x32_bf16 v[160:163], a[192:195], a[32:35], v[160:163]
    ds_read_b64_tr_b16 a[208:209], v8 offset:2048
    v_mul_f32 v43, v43, v41
    v_mfma_f32_16x16x32_bf16 v[160:163], a[196:199], a[48:51], v[160:163]
    ds_read_b64_tr_b16 a[210:211], v8 offset:8192
    v_cvt_pk_bf16_f32 v52, v42, v43
    v_mfma_f32_16x16x32_bf16 v[168:171], a[196:199], a[52:55], v[168:171]
    v_lshlrev_b32 v42, 16, v53
    v_and_b32 v43, 0xffff0000, v53
    v_mfma_f32_16x16x32_bf16 v[168:171], a[192:195], a[36:39], v[168:171]
    buffer_load_dwordx4 a[252:255], v28, s[20:23], s46 offen offset:3072 sc1
    v_mfma_f32_16x16x32_bf16 v[176:179], a[192:195], a[40:43], v[176:179]
    ds_read_b64_tr_b16 a[212:213], v8 offset:14336
    v_sub_f32 v42, v42, v40
    v_mfma_f32_16x16x32_bf16 v[176:179], a[196:199], a[56:59], v[176:179]
    ds_read_b64_tr_b16 a[214:215], v8 offset:20480
    v_sub_f32 v43, v43, v40
    v_mfma_f32_16x16x32_bf16 v[184:187], a[196:199], a[60:63], v[184:187]
    v_cvt_pk_bf16_f32 v44, v42, v43
    v_lshlrev_b32 v42, 16, v44
    v_mfma_f32_16x16x32_bf16 v[184:187], a[192:195], a[44:47], v[184:187]
    s_waitcnt lgkmcnt(4)
    v_and_b32 v43, 0xffff0000, v44
    v_mul_f32 v42, v42, v41
    v_mfma_f32_16x16x32_bf16 v[188:191], a[200:203], a[44:47], v[188:191]
    ds_read_b64_tr_b16 a[192:193], v9 offset:2048
    v_mul_f32 v43, v43, v41
    v_mfma_f32_16x16x32_bf16 v[188:191], a[204:207], a[60:63], v[188:191]
    s_add_u32 m0, s49, 0
    ds_read_b64_tr_b16 a[194:195], v9 offset:8192
    v_cvt_pk_bf16_f32 v53, v42, v43
    v_mfma_f32_16x16x32_bf16 v[180:183], a[204:207], a[56:59], v[180:183]
    buffer_load_dwordx4 v4, s[12:15], s38 offen offset:0 lds
    v_mfma_f32_16x16x32_bf16 v[180:183], a[200:203], a[40:43], v[180:183]
    v_lshlrev_b32 v42, 16, v54
    v_and_b32 v43, 0xffff0000, v54
    v_mfma_f32_16x16x32_bf16 v[172:175], a[200:203], a[36:39], v[172:175]
    ds_read_b64_tr_b16 a[196:197], v9 offset:14336
    v_sub_f32 v42, v42, v40
    v_mfma_f32_16x16x32_bf16 v[172:175], a[204:207], a[52:55], v[172:175]
    ds_read_b64_tr_b16 a[198:199], v9 offset:20480
    v_sub_f32 v43, v43, v40
    v_mfma_f32_16x16x32_bf16 v[164:167], a[204:207], a[48:51], v[164:167]
    v_cvt_pk_bf16_f32 v44, v42, v43
    v_lshlrev_b32 v42, 16, v44
    v_mfma_f32_16x16x32_bf16 v[164:167], a[200:203], a[32:35], v[164:167]
    s_waitcnt lgkmcnt(4)
    v_and_b32 v43, 0xffff0000, v44
    v_mul_f32 v42, v42, v41
    v_mfma_f32_16x16x32_bf16 v[192:195], a[208:211], a[32:35], v[192:195]
    s_add_u32 m0, s49, 896
    ds_read_b64_tr_b16 a[200:201], v10 offset:2048
    v_mul_f32 v43, v43, v41
    v_mfma_f32_16x16x32_bf16 v[192:195], a[212:215], a[48:51], v[192:195]
    ds_read_b64_tr_b16 a[202:203], v10 offset:8192
    v_cvt_pk_bf16_f32 v54, v42, v43
    v_mfma_f32_16x16x32_bf16 v[200:203], a[212:215], a[52:55], v[200:203]
    buffer_load_dwordx4 v4, s[12:15], s38 offen offset:128 lds
    v_mfma_f32_16x16x32_bf16 v[200:203], a[208:211], a[36:39], v[200:203]
    v_lshlrev_b32 v42, 16, v55
    v_and_b32 v43, 0xffff0000, v55
    v_mfma_f32_16x16x32_bf16 v[208:211], a[208:211], a[40:43], v[208:211]
    ds_read_b64_tr_b16 a[204:205], v10 offset:14336
    v_sub_f32 v42, v42, v40
    v_mfma_f32_16x16x32_bf16 v[208:211], a[212:215], a[56:59], v[208:211]
    ds_read_b64_tr_b16 a[206:207], v10 offset:20480
    v_sub_f32 v43, v43, v40
    v_mfma_f32_16x16x32_bf16 v[216:219], a[212:215], a[60:63], v[216:219]
    s_add_u32 m0, s49, 1792
    v_cvt_pk_bf16_f32 v44, v42, v43
    v_lshlrev_b32 v42, 16, v44
    v_mfma_f32_16x16x32_bf16 v[216:219], a[208:211], a[44:47], v[216:219]
    s_waitcnt lgkmcnt(4)
    v_and_b32 v43, 0xffff0000, v44
    v_mul_f32 v42, v42, v41
    v_mfma_f32_16x16x32_bf16 v[220:223], a[192:195], a[44:47], v[220:223]
    ds_read_b64_tr_b16 a[208:209], v11 offset:2048
    v_mul_f32 v43, v43, v41
    v_mfma_f32_16x16x32_bf16 v[220:223], a[196:199], a[60:63], v[220:223]
    ds_read_b64_tr_b16 a[210:211], v11 offset:8192
    v_cvt_pk_bf16_f32 v55, v42, v43
    v_mfma_f32_16x16x32_bf16 v[212:215], a[196:199], a[56:59], v[212:215]
    buffer_load_dwordx4 v4, s[12:15], s38 offen offset:256 lds
    v_mfma_f32_16x16x32_bf16 v[212:215], a[192:195], a[40:43], v[212:215]
    v_lshrrev_b32 v60, 14, v61
    v_and_b32 v61, 0x2000, v61
    v_mfma_f32_16x16x32_bf16 v[204:207], a[192:195], a[36:39], v[204:207]
    s_add_u32 m0, s49, 3072
    ds_read_b64_tr_b16 a[212:213], v11 offset:14336
    v_cmp_ne_u32 s[88:89], 0, v60
    v_mfma_f32_16x16x32_bf16 v[204:207], a[196:199], a[52:55], v[204:207]
    s_waitcnt vmcnt(25)
    ds_read_b64_tr_b16 a[214:215], v11 offset:20480
    v_accvgpr_write_b32 a5, 0
    v_mfma_f32_16x16x32_bf16 v[196:199], a[196:199], a[48:51], v[196:199]
    s_barrier
    v_mfma_f32_16x16x32_bf16 v[196:199], a[192:195], a[32:35], v[196:199]
    s_waitcnt lgkmcnt(4)
    buffer_load_dwordx4 v5, s[12:15], s38 offen offset:0 lds
    v_add_u32 v8, 98304, v12
    v_mfma_f32_16x16x32_bf16 v[224:227], a[200:203], a[32:35], v[224:227]
    s_lshr_b64 s[88:89], s[88:89], 12
    ds_read_b64_tr_b16 a[192:193], v8 offset:0
    v_accvgpr_write_b32 a6, 0
    v_mfma_f32_16x16x32_bf16 v[224:227], a[204:207], a[48:51], v[224:227]
    s_bcnt1_i32_b64 s93, s[88:89]
    ds_read_b64_tr_b16 a[194:195], v8 offset:6144
    v_cmp_ne_u32 s[88:89], 0, v61
    v_mfma_f32_16x16x32_bf16 v[232:235], a[204:207], a[52:55], v[232:235]
    s_cmp_gt_u32 s93, 26
    s_cselect_b32 s93, -1, 0
    v_accvgpr_write_b32 a7, 0
    v_mfma_f32_16x16x32_bf16 v[232:235], a[200:203], a[36:39], v[232:235]
    s_add_u32 m0, s49, 3968
    v_accvgpr_write_b32 a8, 0
    v_accvgpr_write_b32 a9, 0
    v_mfma_f32_16x16x32_bf16 v[240:243], a[200:203], a[40:43], v[240:243]
    s_xor_b32 s88, s88, s93
    ds_read_b64_tr_b16 a[196:197], v8 offset:12288
    v_accvgpr_write_b32 a10, 0
    v_mfma_f32_16x16x32_bf16 v[240:243], a[204:207], a[56:59], v[240:243]
    s_and_b32 s88, s88, 0xfff
    ds_read_b64_tr_b16 a[198:199], v8 offset:18432
    v_accvgpr_write_b32 a11, 0
    v_mfma_f32_16x16x32_bf16 v[248:251], a[204:207], a[60:63], v[248:251]
    buffer_load_dwordx4 v5, s[12:15], s38 offen offset:128 lds
    v_mfma_f32_16x16x32_bf16 v[248:251], a[200:203], a[44:47], v[248:251]
    s_waitcnt lgkmcnt(4)
    v_accvgpr_write_b32 a12, 0
    v_accvgpr_write_b32 a13, 0
    v_add_u32 v9, 98304, v13
    v_mfma_f32_16x16x32_bf16 v[252:255], a[208:211], a[44:47], v[252:255]
    s_lshl_b32 s93, s88, 13
    ds_read_b64_tr_b16 a[200:201], v9 offset:0
    v_accvgpr_write_b32 a14, 0
    v_mfma_f32_16x16x32_bf16 v[252:255], a[212:215], a[60:63], v[252:255]
    s_add_u32 m0, s49, 4864
    ds_read_b64_tr_b16 a[202:203], v9 offset:6144
    v_accvgpr_write_b32 a15, 0
    v_mfma_f32_16x16x32_bf16 v[244:247], a[212:215], a[56:59], v[244:247]
    buffer_load_dwordx4 v5, s[12:15], s38 offen offset:256 lds
    v_mfma_f32_16x16x32_bf16 v[244:247], a[208:211], a[40:43], v[244:247]
    s_add_u32 s38, s38, 24576
    v_accvgpr_write_b32 a16, 0
    v_accvgpr_write_b32 a17, 0
    v_mfma_f32_16x16x32_bf16 v[236:239], a[208:211], a[36:39], v[236:239]
    s_add_u32 s88, s51, 8
    ds_read_b64_tr_b16 a[204:205], v9 offset:12288
    v_accvgpr_write_b32 a18, 0
    v_mfma_f32_16x16x32_bf16 v[236:239], a[212:215], a[52:55], v[236:239]
    s_waitcnt vmcnt(24)
    s_waitcnt vmcnt(14)
    ds_read_b64_tr_b16 a[206:207], v9 offset:18432
    v_mfma_f32_16x16x32_bf16 v[228:231], a[212:215], a[48:51], v[228:231]
    s_lshr_b32 s88, s93, s88
    v_accvgpr_write_b32 a19, 0
    v_accvgpr_write_b32 a20, 0
    v_mfma_f32_16x16x32_bf16 v[228:231], a[208:211], a[32:35], v[228:231]
    s_waitcnt lgkmcnt(4)
    v_accvgpr_write_b32 a21, 0
    v_accvgpr_write_b32 a22, 0
    v_add_u32 v10, 98304, v14
    v_mfma_f32_16x16x32_bf16 v[64:67], a[192:195], a[64:67], v[64:67]
pg_4:
    s_cbranch_execz pg_8
    s_add_u32 m0, s49, 24576
    ds_read_b64_tr_b16 a[208:209], v10 offset:0
    v_accvgpr_write_b32 a23, 0
    v_mfma_f32_16x16x32_bf16 v[64:67], a[196:199], a[80:83], v[64:67]
    s_and_b32 s88, s88, 0x2000
    ds_read_b64_tr_b16 a[210:211], v10 offset:6144
    v_accvgpr_write_b32 a24, 0
    v_mfma_f32_16x16x32_bf16 v[72:75], a[196:199], a[84:87], v[72:75]
    s_add_u32 s5, s5, s88
    ds_read_b64_tr_b16 v[32:33], v25 offset:0
    v_accvgpr_write_b32 a25, 0
    v_mfma_f32_16x16x32_bf16 v[72:75], a[192:195], a[68:71], v[72:75]
    s_lshl_b32 s88, s52, 15
    ds_read_b64_tr_b16 v[34:35], v25 offset:4096
    v_accvgpr_write_b32 a26, 0
    v_mfma_f32_16x16x32_bf16 v[80:83], a[192:195], a[72:75], v[80:83]
    s_lshl_b32 s89, s53, 9
    ds_read_b64_tr_b16 a[212:213], v10 offset:12288
    v_accvgpr_write_b32 a27, 0
    v_mfma_f32_16x16x32_bf16 v[80:83], a[196:199], a[88:91], v[80:83]
    s_add_u32 s88, s88, s89
    ds_read_b64_tr_b16 a[214:215], v10 offset:18432
    v_accvgpr_write_b32 a28, 0
    v_mfma_f32_16x16x32_bf16 v[88:91], a[196:199], a[92:95], v[88:91]
    s_lshl_b32 s89, s3, 7
    ds_read_b64_tr_b16 v[36:37], v25 offset:1024
    v_accvgpr_write_b32 a29, 0
    v_mfma_f32_16x16x32_bf16 v[88:91], a[192:195], a[76:79], v[88:91]
    s_waitcnt lgkmcnt(4)
    buffer_load_dwordx4 v4, s[12:15], s38 offen offset:0 lds
    v_add_u32 v11, 98304, v15
    v_mfma_f32_16x16x32_bf16 v[92:95], a[200:203], a[76:79], v[92:95]
    s_add_u32 m0, s49, 25472
    ds_read_b64_tr_b16 a[192:193], v11 offset:0
    v_accvgpr_write_b32 a30, 0
    v_mfma_f32_16x16x32_bf16 v[92:95], a[204:207], a[92:95], v[92:95]
    s_add_u32 s88, s88, s89
    ds_read_b64_tr_b16 a[194:195], v11 offset:6144
    v_accvgpr_write_b32 a31, 0
    v_mfma_f32_16x16x32_bf16 v[84:87], a[204:207], a[88:91], v[84:87]
    s_add_u32 s88, s88, 4456452
    ds_read_b64_tr_b16 v[38:39], v25 offset:5120
    v_accvgpr_write_b32 a32, 0
    v_mfma_f32_16x16x32_bf16 v[84:87], a[200:203], a[72:75], v[84:87]
    s_lshr_b32 s89, s93, 8
    ds_read_b64_tr_b16 v[40:41], v25 offset:8192
    v_lshrrev_b32 v60, v1, s89
    v_mfma_f32_16x16x32_bf16 v[76:79], a[200:203], a[68:71], v[76:79]
    ds_read_b64_tr_b16 a[196:197], v11 offset:12288
    v_and_b32 v60, 0x2000, v60
    v_mfma_f32_16x16x32_bf16 v[76:79], a[204:207], a[84:87], v[76:79]
    ds_read_b64_tr_b16 a[198:199], v11 offset:18432
    v_add_u32 v60, s88, v60
    v_mfma_f32_16x16x32_bf16 v[68:71], a[204:207], a[80:83], v[68:71]
    ds_read_b64_tr_b16 v[42:43], v25 offset:12288
    v_bfe_u32 v61, v1, 1, 1
    v_mfma_f32_16x16x32_bf16 v[68:71], a[200:203], a[64:67], v[68:71]
    s_waitcnt lgkmcnt(4)
    buffer_load_dwordx4 v4, s[12:15], s38 offen offset:128 lds
    v_mfma_f32_16x16x32_bf16 v[96:99], a[208:211], a[64:67], v[96:99]
    s_add_u32 m0, s49, 26368
    ds_read_b64_tr_b16 a[200:201], v8 offset:1024
    v_lshl_add_u32 v60, v61, 14, v60
    v_mfma_f32_16x16x32_bf16 v[96:99], a[212:215], a[80:83], v[96:99]
    ds_read_b64_tr_b16 a[202:203], v8 offset:7168
    v_and_b32 v61, 1, v1
    v_mfma_f32_16x16x32_bf16 v[104:107], a[212:215], a[84:87], v[104:107]
    ds_read_b64_tr_b16 v[44:45], v25 offset:9216
    v_lshl_add_u32 v60, v61, 12, v60
    v_mfma_f32_16x16x32_bf16 v[104:107], a[208:211], a[68:71], v[104:107]
    ds_read_b64_tr_b16 v[46:47], v25 offset:13312
    v_lshrrev_b32 v61, 2, v1
    v_mfma_f32_16x16x32_bf16 v[112:115], a[208:211], a[72:75], v[112:115]
    ds_read_b64_tr_b16 a[204:205], v8 offset:13312
    v_min_u32 v61, 1, v61
    v_mfma_f32_16x16x32_bf16 v[112:115], a[212:215], a[88:91], v[112:115]
    ds_read_b64_tr_b16 a[206:207], v8 offset:19456
    v_lshl_or_b32 v60, v61, 30, v60
    v_mfma_f32_16x16x32_bf16 v[120:123], a[212:215], a[92:95], v[120:123]
    buffer_load_dwordx4 v4, s[12:15], s38 offen offset:256 lds
    v_accvgpr_write_b32 a223, v60
    v_mfma_f32_16x16x32_bf16 v[120:123], a[208:211], a[76:79], v[120:123]
    s_waitcnt lgkmcnt(4)
    v_accvgpr_write_b32 a33, 0
    v_accvgpr_write_b32 a34, 0
    v_mfma_f32_16x16x32_bf16 v[124:127], a[192:195], a[76:79], v[124:127]
    s_add_u32 m0, s49, 27648
    ds_read_b64_tr_b16 a[208:209], v9 offset:1024
    v_accvgpr_write_b32 a35, 0
    v_mfma_f32_16x16x32_bf16 v[124:127], a[196:199], a[92:95], v[124:127]
    s_mul_hi_u32 s47, s58, 429496730
    ds_read_b64_tr_b16 a[210:211], v9 offset:7168
    v_accvgpr_write_b32 a36, 0
    v_mfma_f32_16x16x32_bf16 v[116:119], a[196:199], a[88:91], v[116:119]
    buffer_load_dwordx4 v5, s[12:15], s38 offen offset:0 lds
    v_mfma_f32_16x16x32_bf16 v[116:119], a[192:195], a[72:75], v[116:119]
    s_add_u32 m0, s49, 28544
    v_accvgpr_write_b32 a37, 0
    v_accvgpr_write_b32 a38, 0
    v_mfma_f32_16x16x32_bf16 v[108:111], a[192:195], a[68:71], v[108:111]
    s_lshl_b32 s37, s47, 8
    ds_read_b64_tr_b16 a[212:213], v9 offset:13312
    v_accvgpr_write_b32 a39, 0
    v_mfma_f32_16x16x32_bf16 v[108:111], a[196:199], a[84:87], v[108:111]
    s_add_u32 s37, s37, 268370064
    ds_read_b64_tr_b16 a[214:215], v9 offset:19456
    v_accvgpr_write_b32 a40, 0
    v_mfma_f32_16x16x32_bf16 v[100:103], a[196:199], a[80:83], v[100:103]
    buffer_load_dwordx4 v5, s[12:15], s38 offen offset:128 lds
    v_mfma_f32_16x16x32_bf16 v[100:103], a[192:195], a[64:67], v[100:103]
    s_waitcnt lgkmcnt(4)
    v_accvgpr_write_b32 a41, 0
    v_accvgpr_write_b32 a42, 0
    v_mfma_f32_16x16x32_bf16 v[128:131], a[200:203], a[64:67], v[128:131]
    s_add_u32 m0, s49, 29440
    ds_read_b64_tr_b16 a[192:193], v10 offset:1024
    v_accvgpr_write_b32 a43, 0
    v_mfma_f32_16x16x32_bf16 v[128:131], a[204:207], a[80:83], v[128:131]
    s_mov_b32 s32, s82
    ds_read_b64_tr_b16 a[194:195], v10 offset:7168
    v_accvgpr_write_b32 a44, 0
    v_mfma_f32_16x16x32_bf16 v[136:139], a[204:207], a[84:87], v[136:139]
    v_mfma_f32_16x16x32_bf16 v[20:23], v[48:51], v[32:35], 0
    v_mfma_f32_16x16x32_bf16 v[58:61], v[48:51], v[36:39], 0
    v_mfma_f32_16x16x32_bf16 v[20:23], v[52:55], v[40:43], v[20:23]
    v_mfma_f32_16x16x32_bf16 v[58:61], v[52:55], v[44:47], v[58:61]
    v_mfma_f32_16x16x32_bf16 v[136:139], a[200:203], a[68:71], v[136:139]
    buffer_load_dwordx4 v5, s[12:15], s38 offen offset:256 lds
    v_mfma_f32_16x16x32_bf16 v[144:147], a[200:203], a[72:75], v[144:147]
    s_add_u32 s38, s38, 24576
    ds_read_b64_tr_b16 a[196:197], v10 offset:13312
    v_accvgpr_write_b32 a45, 0
    v_mfma_f32_16x16x32_bf16 v[144:147], a[204:207], a[88:91], v[144:147]
    s_and_b32 s33, s83, 0xffff
    ds_read_b64_tr_b16 a[198:199], v10 offset:19456
    v_accvgpr_write_b32 a46, 0
    v_mfma_f32_16x16x32_bf16 v[152:155], a[204:207], a[92:95], v[152:155]
    s_mov_b32 s34, 1966080
    v_accvgpr_write_b32 a47, 0
    v_accvgpr_write_b32 a48, 0
    v_mfma_f32_16x16x32_bf16 v[152:155], a[200:203], a[76:79], v[152:155]
    s_waitcnt lgkmcnt(4)
    v_accvgpr_write_b32 a49, 0
    v_accvgpr_write_b32 a50, 0
    v_mfma_f32_16x16x32_bf16 v[156:159], a[208:211], a[76:79], v[156:159]
    s_add_u32 m0, s49, 73728
    ds_read_b64_tr_b16 a[200:201], v11 offset:1024
    v_accvgpr_write_b32 a51, 0
    v_mfma_f32_16x16x32_bf16 v[156:159], a[212:215], a[92:95], v[156:159]
    s_mov_b32 s35, 0x00020000
    ds_read_b64_tr_b16 a[202:203], v11 offset:7168
    v_accvgpr_write_b32 a52, 0
    v_mfma_f32_16x16x32_bf16 v[148:151], a[212:215], a[88:91], v[148:151]
    buffer_load_dwordx4 v6, s[16:19], s40 offen offset:0 lds
    v_mfma_f32_16x16x32_bf16 v[148:151], a[208:211], a[72:75], v[148:151]
    s_mul_i32 s60, s47, 80640
    v_accvgpr_write_b32 a53, 0
    v_accvgpr_write_b32 a54, 0
    v_mfma_f32_16x16x32_bf16 v[140:143], a[208:211], a[68:71], v[140:143]
    s_lshl_b32 s56, s58, 7
    ds_read_b64_tr_b16 a[204:205], v11 offset:13312
    v_accvgpr_write_b32 a55, 0
    v_mfma_f32_16x16x32_bf16 v[140:143], a[212:215], a[84:87], v[140:143]
    s_add_u32 m0, s49, 74624
    ds_read_b64_tr_b16 a[206:207], v11 offset:19456
    v_accvgpr_write_b32 a56, 0
    v_mfma_f32_16x16x32_bf16 v[132:135], a[212:215], a[80:83], v[132:135]
    buffer_load_dwordx4 v6, s[16:19], s40 offen offset:128 lds
    v_mfma_f32_16x16x32_bf16 v[132:135], a[208:211], a[64:67], v[132:135]
    s_waitcnt lgkmcnt(4)
    v_accvgpr_write_b32 a57, 0
    v_accvgpr_write_b32 a58, 0
    v_mfma_f32_16x16x32_bf16 v[160:163], a[192:195], a[64:67], v[160:163]
    s_add_u32 s60, s60, s56
    ds_read_b64_tr_b16 a[208:209], v8 offset:2048
    v_accvgpr_write_b32 a59, 0
    v_mfma_f32_16x16x32_bf16 v[160:163], a[196:199], a[80:83], v[160:163]
    s_mul_i32 s56, s53, 983040
    ds_read_b64_tr_b16 a[210:211], v8 offset:8192
    v_accvgpr_write_b32 a60, 0
    v_mfma_f32_16x16x32_bf16 v[168:171], a[196:199], a[84:87], v[168:171]
    s_add_u32 s28, s72, s56
    s_addc_u32 s29, s73, 0
    v_accvgpr_write_b32 a61, 0
    v_mfma_f32_16x16x32_bf16 v[168:171], a[192:195], a[68:71], v[168:171]
    s_and_b32 s29, s29, 0xffff
    v_accvgpr_write_b32 a62, 0
    v_accvgpr_write_b32 a63, 0
    v_mfma_f32_16x16x32_bf16 v[176:179], a[192:195], a[72:75], v[176:179]
    s_add_u32 m0, s49, 75520
    ds_read_b64_tr_b16 a[212:213], v8 offset:14336
    v_mov_b32 v22, v58
    v_mfma_f32_16x16x32_bf16 v[176:179], a[196:199], a[88:91], v[176:179]
    s_mov_b32 s30, 983040
    ds_read_b64_tr_b16 a[214:215], v8 offset:20480
    v_mov_b32 v23, v59
    v_mfma_f32_16x16x32_bf16 v[184:187], a[196:199], a[92:95], v[184:187]
    buffer_store_dwordx4 v[20:23], v26, s[24:27], s62 offen sc1
    v_mfma_f32_16x16x32_bf16 v[184:187], a[192:195], a[76:79], v[184:187]
    s_waitcnt lgkmcnt(4)
    buffer_load_dwordx4 v6, s[16:19], s40 offen offset:256 lds
    v_mfma_f32_16x16x32_bf16 v[188:191], a[200:203], a[76:79], v[188:191]
    s_mov_b32 s31, 0x00020000
    ds_read_b64_tr_b16 a[192:193], v9 offset:2048
    v_add_u32 v8, 122880, v12
    v_mfma_f32_16x16x32_bf16 v[188:191], a[204:207], a[92:95], v[188:191]
    s_lshr_b32 s48, s2, 3
    ds_read_b64_tr_b16 a[194:195], v9 offset:8192
    s_lshl_b32 s48, s48, 2
    v_mfma_f32_16x16x32_bf16 v[180:183], a[204:207], a[88:91], v[180:183]
    s_add_u32 m0, s49, 76800
    s_add_u32 s48, s48, s3
    s_mul_i32 s6, s48, 7680
    v_mfma_f32_16x16x32_bf16 v[180:183], a[200:203], a[72:75], v[180:183]
    buffer_load_dwordx4 v7, s[16:19], s40 offen offset:0 lds
    v_mfma_f32_16x16x32_bf16 v[172:175], a[200:203], a[68:71], v[172:175]
    ds_read_b64_tr_b16 a[196:197], v9 offset:14336
    v_lshlrev_b32 v16, 7, v16
    v_mfma_f32_16x16x32_bf16 v[172:175], a[204:207], a[84:87], v[172:175]
    s_lshl_b32 s57, s51, 8
    ds_read_b64_tr_b16 a[198:199], v9 offset:20480
    s_add_u32 s56, s56, s57
    v_mfma_f32_16x16x32_bf16 v[164:167], a[204:207], a[80:83], v[164:167]
    s_lshr_b32 s63, s51, 1
    v_add_u32 v9, 122880, v13
    s_lshl_b32 s63, s63, 7
    v_mfma_f32_16x16x32_bf16 v[164:167], a[200:203], a[64:67], v[164:167]
    s_waitcnt lgkmcnt(4)
    s_add_u32 s63, s63, 768
    s_sub_u32 s63, s63, s57
    v_mfma_f32_16x16x32_bf16 v[192:195], a[208:211], a[64:67], v[192:195]
    s_mov_b32 s66, 0
    ds_read_b64_tr_b16 a[200:201], v10 offset:2048
    s_sub_u32 s57, 7864320, s56
    v_mfma_f32_16x16x32_bf16 v[192:195], a[212:215], a[80:83], v[192:195]
    s_add_u32 m0, s49, 77696
    ds_read_b64_tr_b16 a[202:203], v10 offset:8192
    s_add_u32 s8, s72, s56
    s_addc_u32 s9, s73, 0
    v_mfma_f32_16x16x32_bf16 v[200:203], a[212:215], a[84:87], v[200:203]
    buffer_load_dwordx4 v7, s[16:19], s40 offen offset:128 lds
    v_mfma_f32_16x16x32_bf16 v[200:203], a[208:211], a[68:71], v[200:203]
    s_and_b32 s9, s9, 0xffff
    s_mov_b32 s10, s57
    s_mov_b32 s11, 0x00020000
    v_mfma_f32_16x16x32_bf16 v[208:211], a[208:211], a[72:75], v[208:211]
    s_mul_i32 s36, s51, 245760
    ds_read_b64_tr_b16 a[204:205], v10 offset:14336
    s_mul_i32 s56, s3, 20480
    v_mfma_f32_16x16x32_bf16 v[208:211], a[212:215], a[88:91], v[208:211]
    s_add_u32 s36, s36, s56
    ds_read_b64_tr_b16 a[206:207], v10 offset:20480
    s_lshl_b32 s59, s53, 23
    v_mfma_f32_16x16x32_bf16 v[216:219], a[212:215], a[92:95], v[216:219]
    s_add_u32 s59, s59, 16777216
    v_add_u32 v10, 122880, v14
    s_add_u32 s20, s86, s59
    s_addc_u32 s21, s87, 0
    v_mfma_f32_16x16x32_bf16 v[216:219], a[208:211], a[76:79], v[216:219]
    s_waitcnt lgkmcnt(4)
    s_add_u32 m0, s49, 78592
    s_and_b32 s21, s21, 0xffff
    v_mfma_f32_16x16x32_bf16 v[220:223], a[192:195], a[76:79], v[220:223]
    s_mov_b32 s22, 8388608
    ds_read_b64_tr_b16 a[208:209], v11 offset:2048
    s_mov_b32 s23, 0x00020000
    v_mfma_f32_16x16x32_bf16 v[220:223], a[196:199], a[92:95], v[220:223]
    s_add_u32 s55, s51, 8
    ds_read_b64_tr_b16 a[210:211], v11 offset:8192
    s_lshr_b32 s55, s93, s55
    v_mfma_f32_16x16x32_bf16 v[212:215], a[196:199], a[88:91], v[212:215]
    buffer_load_dwordx4 v7, s[16:19], s40 offen offset:256 lds
    v_mfma_f32_16x16x32_bf16 v[212:215], a[192:195], a[72:75], v[212:215]
    s_add_u32 s40, s40, 24576
    s_and_b32 s55, s55, 0x2000
    s_lshl_b32 s59, s54, 16
    v_mfma_f32_16x16x32_bf16 v[204:207], a[192:195], a[68:71], v[204:207]
    s_or_b32 s55, s55, s59
    ds_read_b64_tr_b16 a[212:213], v11 offset:14336
    s_and_b32 s59, s3, 1
    v_mfma_f32_16x16x32_bf16 v[204:207], a[196:199], a[84:87], v[204:207]
    s_waitcnt vmcnt(31)
    ds_read_b64_tr_b16 a[214:215], v11 offset:20480
    s_lshl_b32 s59, s59, 14
    v_mfma_f32_16x16x32_bf16 v[196:199], a[196:199], a[80:83], v[196:199]
    s_barrier
    v_mfma_f32_16x16x32_bf16 v[196:199], a[192:195], a[64:67], v[196:199]
    s_waitcnt lgkmcnt(4)
    v_add_u32 v11, 122880, v15
    s_or_b32 s55, s55, s59
    v_mfma_f32_16x16x32_bf16 v[224:227], a[200:203], a[64:67], v[224:227]
    s_mul_i32 s59, s51, 0x202000
    ds_read_b64_tr_b16 a[192:193], v8 offset:0
    s_and_b32 s59, s59, 6299648
    v_mfma_f32_16x16x32_bf16 v[224:227], a[204:207], a[80:83], v[224:227]
    s_xor_b32 s55, s55, s59
    ds_read_b64_tr_b16 a[194:195], v8 offset:6144
    v_lshlrev_b32 v2, 7, v1
    v_mfma_f32_16x16x32_bf16 v[232:235], a[204:207], a[84:87], v[232:235]
    v_and_b32 v3, 3, v1
    v_lshlrev_b32 v3, 11, v3
    v_mfma_f32_16x16x32_bf16 v[232:235], a[200:203], a[68:71], v[232:235]
    v_lshlrev_b32 v28, 4, v1
    v_mov_b32 v31, v16
    v_mfma_f32_16x16x32_bf16 v[240:243], a[200:203], a[72:75], v[240:243]
    s_mov_b32 s41, s49
    ds_read_b64_tr_b16 a[196:197], v8 offset:12288
    s_add_u32 s42, s49, 24576
    v_mfma_f32_16x16x32_bf16 v[240:243], a[204:207], a[88:91], v[240:243]
    s_add_u32 s43, s49, 49152
    ds_read_b64_tr_b16 a[198:199], v8 offset:18432
    s_mov_b32 s45, 6
    v_mfma_f32_16x16x32_bf16 v[248:251], a[204:207], a[92:95], v[248:251]
    s_sub_u32 s56, 73728, s49
    v_add_u32 v16, s49, v18
    v_add_u32 v17, s49, v19
    v_mfma_f32_16x16x32_bf16 v[248:251], a[200:203], a[76:79], v[248:251]
    s_waitcnt lgkmcnt(4)
    v_mfma_f32_16x16x32_bf16 v[252:255], a[208:211], a[76:79], v[252:255]
    ds_read_b64_tr_b16 a[200:201], v9 offset:0
    v_mfma_f32_16x16x32_bf16 v[252:255], a[212:215], a[92:95], v[252:255]
    ds_read_b64_tr_b16 a[202:203], v9 offset:6144
    v_mfma_f32_16x16x32_bf16 v[244:247], a[212:215], a[88:91], v[244:247]
    v_mfma_f32_16x16x32_bf16 v[244:247], a[208:211], a[72:75], v[244:247]
    v_mfma_f32_16x16x32_bf16 v[236:239], a[208:211], a[68:71], v[236:239]
    ds_read_b64_tr_b16 a[204:205], v9 offset:12288
    v_mfma_f32_16x16x32_bf16 v[236:239], a[212:215], a[84:87], v[236:239]
    s_waitcnt vmcnt(23)
    s_waitcnt vmcnt(19)
    ds_read_b64_tr_b16 a[206:207], v9 offset:18432
    v_mfma_f32_16x16x32_bf16 v[228:231], a[212:215], a[80:83], v[228:231]
    v_mfma_f32_16x16x32_bf16 v[228:231], a[208:211], a[64:67], v[228:231]
    s_waitcnt lgkmcnt(4)
    v_mfma_f32_16x16x32_bf16 v[64:67], a[192:195], a[224:227], v[64:67]
    ds_read_b64_tr_b16 a[208:209], v10 offset:0
    v_add_u32 v12, s56, v12
    v_mfma_f32_16x16x32_bf16 v[64:67], a[196:199], a[240:243], v[64:67]
    ds_read_b64_tr_b16 a[210:211], v10 offset:6144
    v_add_u32 v13, s56, v13
    v_mfma_f32_16x16x32_bf16 v[72:75], a[196:199], a[244:247], v[72:75]
    v_add_u32 v14, s56, v14
    v_add_u32 v15, s56, v15
    v_mfma_f32_16x16x32_bf16 v[72:75], a[192:195], a[228:231], v[72:75]
    v_mov_b32 v30, 0x47800000
    v_mov_b32 v20, 0
    v_mfma_f32_16x16x32_bf16 v[80:83], a[192:195], a[232:235], v[80:83]
    ds_read_b64_tr_b16 a[212:213], v10 offset:12288
    v_mov_b32 v21, 0
    v_mfma_f32_16x16x32_bf16 v[80:83], a[196:199], a[248:251], v[80:83]
    ds_read_b64_tr_b16 a[214:215], v10 offset:18432
    v_mov_b32 v22, 0
    v_mfma_f32_16x16x32_bf16 v[88:91], a[196:199], a[252:255], v[88:91]
    v_mov_b32 v23, 0
    v_mfma_f32_16x16x32_bf16 v[88:91], a[192:195], a[236:239], v[88:91]
    s_waitcnt lgkmcnt(4)
    v_accvgpr_write_b32 a64, 0
    v_mfma_f32_16x16x32_bf16 v[92:95], a[200:203], a[236:239], v[92:95]
    ds_read_b64_tr_b16 a[192:193], v11 offset:0
    v_accvgpr_write_b32 a65, 0
    v_mfma_f32_16x16x32_bf16 v[92:95], a[204:207], a[252:255], v[92:95]
    ds_read_b64_tr_b16 a[194:195], v11 offset:6144
    v_accvgpr_write_b32 a66, 0
    v_mfma_f32_16x16x32_bf16 v[84:87], a[204:207], a[248:251], v[84:87]
    s_getpc_b64 s[74:75]
ct3:
    s_add_u32 s74, s74, at_switch-ct3
    s_addc_u32 s75, s75, 0
    global_load_dword a222, v2, s[74:75]
    v_mfma_f32_16x16x32_bf16 v[84:87], a[200:203], a[232:235], v[84:87]
    v_min_u32 v2, 15, v1
    v_mfma_f32_16x16x32_bf16 v[76:79], a[200:203], a[228:231], v[76:79]
    s_lshl_b32 s59, s3, 4
    ds_read_b64_tr_b16 a[196:197], v11 offset:12288
    v_add_u32 v2, s59, v2
    v_mfma_f32_16x16x32_bf16 v[76:79], a[204:207], a[244:247], v[76:79]
    ds_read_b64_tr_b16 a[198:199], v11 offset:18432
    v_mul_u32_u24 v2, 1280, v2
    v_mfma_f32_16x16x32_bf16 v[68:71], a[204:207], a[240:243], v[68:71]
    buffer_load_dword a217, v2, s[32:35], s60 offen
    v_mfma_f32_16x16x32_bf16 v[68:71], a[200:203], a[224:227], v[68:71]
    s_waitcnt lgkmcnt(4)
    v_and_b32 v2, 1, v1
    v_lshlrev_b32 v2, 7, v2
    v_mfma_f32_16x16x32_bf16 v[96:99], a[208:211], a[224:227], v[96:99]
    s_lshl_b32 s59, s48, 8
    ds_read_b64_tr_b16 a[200:201], v8 offset:1024
    v_add_u32 v2, s59, v2
    v_mfma_f32_16x16x32_bf16 v[96:99], a[212:215], a[240:243], v[96:99]
    ds_read_b64_tr_b16 a[202:203], v8 offset:7168
    v_accvgpr_write_b32 a67, 0
    v_mfma_f32_16x16x32_bf16 v[104:107], a[212:215], a[244:247], v[104:107]
    v_accvgpr_write_b32 a68, 0
    v_accvgpr_write_b32 a69, 0
    v_mfma_f32_16x16x32_bf16 v[104:107], a[208:211], a[228:231], v[104:107]
    v_accvgpr_write_b32 a70, 0
    v_accvgpr_write_b32 a71, 0
    v_mfma_f32_16x16x32_bf16 v[112:115], a[208:211], a[232:235], v[112:115]
    ds_read_b64_tr_b16 a[204:205], v8 offset:13312
    v_accvgpr_write_b32 a72, 0
    v_mfma_f32_16x16x32_bf16 v[112:115], a[212:215], a[248:251], v[112:115]
    ds_read_b64_tr_b16 a[206:207], v8 offset:19456
    v_accvgpr_write_b32 a73, 0
    v_mfma_f32_16x16x32_bf16 v[120:123], a[212:215], a[252:255], v[120:123]
    s_getpc_b64 s[74:75]
ct4:
    s_add_u32 s74, s74, tail_code-ct4
    s_addc_u32 s75, s75, 0
    global_load_dword a218, v2, s[74:75]
    v_mfma_f32_16x16x32_bf16 v[120:123], a[208:211], a[236:239], v[120:123]
    s_waitcnt lgkmcnt(4)
    v_accvgpr_write_b32 a74, 0
    v_accvgpr_write_b32 a75, 0
    v_mfma_f32_16x16x32_bf16 v[124:127], a[192:195], a[236:239], v[124:127]
    ds_read_b64_tr_b16 a[208:209], v9 offset:1024
    v_accvgpr_write_b32 a76, 0
    v_mfma_f32_16x16x32_bf16 v[124:127], a[196:199], a[252:255], v[124:127]
    ds_read_b64_tr_b16 a[210:211], v9 offset:7168
    v_accvgpr_write_b32 a77, 0
    v_mfma_f32_16x16x32_bf16 v[116:119], a[196:199], a[248:251], v[116:119]
    v_accvgpr_write_b32 a78, 0
    v_accvgpr_write_b32 a79, 0
    v_mfma_f32_16x16x32_bf16 v[116:119], a[192:195], a[232:235], v[116:119]
    v_accvgpr_write_b32 a80, 0
    v_accvgpr_write_b32 a81, 0
    v_mfma_f32_16x16x32_bf16 v[108:111], a[192:195], a[228:231], v[108:111]
    ds_read_b64_tr_b16 a[212:213], v9 offset:13312
    v_accvgpr_write_b32 a82, 0
    v_mfma_f32_16x16x32_bf16 v[108:111], a[196:199], a[244:247], v[108:111]
    ds_read_b64_tr_b16 a[214:215], v9 offset:19456
    v_accvgpr_write_b32 a83, 0
    v_mfma_f32_16x16x32_bf16 v[100:103], a[196:199], a[240:243], v[100:103]
    v_accvgpr_write_b32 a84, 0
    v_accvgpr_write_b32 a85, 0
    v_mfma_f32_16x16x32_bf16 v[100:103], a[192:195], a[224:227], v[100:103]
    s_waitcnt lgkmcnt(4)
    v_accvgpr_write_b32 a86, 0
    v_accvgpr_write_b32 a87, 0
    v_mfma_f32_16x16x32_bf16 v[128:131], a[200:203], a[224:227], v[128:131]
    ds_read_b64_tr_b16 a[192:193], v10 offset:1024
    v_accvgpr_write_b32 a88, 0
    v_mfma_f32_16x16x32_bf16 v[128:131], a[204:207], a[240:243], v[128:131]
    ds_read_b64_tr_b16 a[194:195], v10 offset:7168
    v_accvgpr_write_b32 a89, 0
    v_mfma_f32_16x16x32_bf16 v[136:139], a[204:207], a[244:247], v[136:139]
    v_accvgpr_write_b32 a90, 0
    v_accvgpr_write_b32 a91, 0
    v_mfma_f32_16x16x32_bf16 v[136:139], a[200:203], a[228:231], v[136:139]
    v_accvgpr_write_b32 a92, 0
    v_accvgpr_write_b32 a93, 0
    v_mfma_f32_16x16x32_bf16 v[144:147], a[200:203], a[232:235], v[144:147]
    ds_read_b64_tr_b16 a[196:197], v10 offset:13312
    v_accvgpr_write_b32 a94, 0
    v_mfma_f32_16x16x32_bf16 v[144:147], a[204:207], a[248:251], v[144:147]
    ds_read_b64_tr_b16 a[198:199], v10 offset:19456
    v_accvgpr_write_b32 a95, 0
    v_mfma_f32_16x16x32_bf16 v[152:155], a[204:207], a[252:255], v[152:155]
    v_and_b32 v31, 3, v1
    v_lshlrev_b32 v31, 7, v31
    v_mfma_f32_16x16x32_bf16 v[152:155], a[200:203], a[236:239], v[152:155]
    s_waitcnt lgkmcnt(4)
    v_cvt_pk_bf16_f32 v64, v64, v65
    v_cvt_pk_bf16_f32 v65, v66, v67
    v_mfma_f32_16x16x32_bf16 v[156:159], a[208:211], a[236:239], v[156:159]
    s_lshl_b32 s59, s48, 9
    ds_read_b64_tr_b16 a[200:201], v11 offset:1024
    v_cvt_pk_bf16_f32 v66, v68, v69
    v_mfma_f32_16x16x32_bf16 v[156:159], a[212:215], a[252:255], v[156:159]
    s_and_b32 s59, s59, 0x7fff
    ds_read_b64_tr_b16 a[202:203], v11 offset:7168
    v_add_u32 v31, s59, v31
    v_mfma_f32_16x16x32_bf16 v[148:151], a[212:215], a[248:251], v[148:151]
    v_permlane16_swap_b32 v64, v66
    v_mfma_f32_16x16x32_bf16 v[148:151], a[208:211], a[232:235], v[148:151]
    v_min_u32 v2, 11, v1
    v_lshlrev_b32 v2, 7, v2
    v_mfma_f32_16x16x32_bf16 v[140:143], a[208:211], a[228:231], v[140:143]
    ds_read_b64_tr_b16 a[204:205], v11 offset:13312
    v_cvt_pk_bf16_f32 v67, v70, v71
    v_mfma_f32_16x16x32_bf16 v[140:143], a[212:215], a[244:247], v[140:143]
    ds_read_b64_tr_b16 a[206:207], v11 offset:19456
    v_cvt_pk_bf16_f32 v72, v72, v73
    v_mfma_f32_16x16x32_bf16 v[132:135], a[212:215], a[240:243], v[132:135]
    v_permlane16_swap_b32 v65, v67
    v_mfma_f32_16x16x32_bf16 v[132:135], a[208:211], a[224:227], v[132:135]
    s_waitcnt lgkmcnt(4)
    v_cvt_pk_bf16_f32 v73, v74, v75
    v_cvt_pk_bf16_f32 v74, v76, v77
    v_mfma_f32_16x16x32_bf16 v[160:163], a[192:195], a[224:227], v[160:163]
    ds_read_b64_tr_b16 a[208:209], v8 offset:2048
    v_cvt_pk_bf16_f32 v75, v78, v79
    v_mfma_f32_16x16x32_bf16 v[160:163], a[196:199], a[240:243], v[160:163]
    ds_read_b64_tr_b16 a[210:211], v8 offset:8192
    v_cvt_pk_bf16_f32 v80, v80, v81
    v_mfma_f32_16x16x32_bf16 v[168:171], a[196:199], a[244:247], v[168:171]
    v_permlane16_swap_b32 v72, v74
    v_mfma_f32_16x16x32_bf16 v[168:171], a[192:195], a[228:231], v[168:171]
    v_permlane16_swap_b32 v73, v75
    v_mfma_f32_16x16x32_bf16 v[176:179], a[192:195], a[232:235], v[176:179]
    ds_read_b64_tr_b16 a[212:213], v8 offset:14336
    v_cvt_pk_bf16_f32 v81, v82, v83
    v_mfma_f32_16x16x32_bf16 v[176:179], a[196:199], a[248:251], v[176:179]
    ds_read_b64_tr_b16 a[214:215], v8 offset:20480
    v_cvt_pk_bf16_f32 v82, v84, v85
    v_mfma_f32_16x16x32_bf16 v[184:187], a[196:199], a[252:255], v[184:187]
    v_cvt_pk_bf16_f32 v83, v86, v87
    v_cvt_pk_bf16_f32 v88, v88, v89
    v_mfma_f32_16x16x32_bf16 v[184:187], a[192:195], a[236:239], v[184:187]
    s_waitcnt lgkmcnt(4)
    v_permlane16_swap_b32 v80, v82
    v_mfma_f32_16x16x32_bf16 v[188:191], a[200:203], a[236:239], v[188:191]
    ds_read_b64_tr_b16 a[192:193], v9 offset:2048
    v_cvt_pk_bf16_f32 v89, v90, v91
    v_mfma_f32_16x16x32_bf16 v[188:191], a[204:207], a[252:255], v[188:191]
    ds_read_b64_tr_b16 a[194:195], v9 offset:8192
    v_cvt_pk_bf16_f32 v90, v92, v93
    v_mfma_f32_16x16x32_bf16 v[180:183], a[204:207], a[248:251], v[180:183]
    v_permlane16_swap_b32 v81, v83
    v_mfma_f32_16x16x32_bf16 v[180:183], a[200:203], a[232:235], v[180:183]
    v_permlane16_swap_b32 v88, v90
    v_mfma_f32_16x16x32_bf16 v[172:175], a[200:203], a[228:231], v[172:175]
    ds_read_b64_tr_b16 a[196:197], v9 offset:14336
    v_cvt_pk_bf16_f32 v91, v94, v95
    v_mfma_f32_16x16x32_bf16 v[172:175], a[204:207], a[244:247], v[172:175]
    ds_read_b64_tr_b16 a[198:199], v9 offset:20480
    v_cvt_pk_bf16_f32 v96, v96, v97
    v_mfma_f32_16x16x32_bf16 v[164:167], a[204:207], a[240:243], v[164:167]
    v_permlane16_swap_b32 v89, v91
    v_mfma_f32_16x16x32_bf16 v[164:167], a[200:203], a[224:227], v[164:167]
    s_waitcnt lgkmcnt(4)
    v_cvt_pk_bf16_f32 v97, v98, v99
    v_cvt_pk_bf16_f32 v98, v100, v101
    v_mfma_f32_16x16x32_bf16 v[192:195], a[208:211], a[224:227], v[192:195]
    ds_read_b64_tr_b16 a[200:201], v10 offset:2048
    v_cvt_pk_bf16_f32 v99, v102, v103
    v_mfma_f32_16x16x32_bf16 v[192:195], a[212:215], a[240:243], v[192:195]
    ds_read_b64_tr_b16 a[202:203], v10 offset:8192
    v_cvt_pk_bf16_f32 v104, v104, v105
    v_mfma_f32_16x16x32_bf16 v[200:203], a[212:215], a[244:247], v[200:203]
    v_permlane16_swap_b32 v96, v98
    v_mfma_f32_16x16x32_bf16 v[200:203], a[208:211], a[228:231], v[200:203]
    v_permlane16_swap_b32 v97, v99
    v_mfma_f32_16x16x32_bf16 v[208:211], a[208:211], a[232:235], v[208:211]
    ds_read_b64_tr_b16 a[204:205], v10 offset:14336
    v_cvt_pk_bf16_f32 v105, v106, v107
    v_mfma_f32_16x16x32_bf16 v[208:211], a[212:215], a[248:251], v[208:211]
    ds_read_b64_tr_b16 a[206:207], v10 offset:20480
    v_cvt_pk_bf16_f32 v106, v108, v109
    v_mfma_f32_16x16x32_bf16 v[216:219], a[212:215], a[252:255], v[216:219]
    v_cvt_pk_bf16_f32 v107, v110, v111
    v_cvt_pk_bf16_f32 v112, v112, v113
    v_mfma_f32_16x16x32_bf16 v[216:219], a[208:211], a[236:239], v[216:219]
    s_waitcnt lgkmcnt(4)
    v_permlane16_swap_b32 v104, v106
    v_mfma_f32_16x16x32_bf16 v[220:223], a[192:195], a[236:239], v[220:223]
    ds_read_b64_tr_b16 a[208:209], v11 offset:2048
    v_cvt_pk_bf16_f32 v113, v114, v115
    v_mfma_f32_16x16x32_bf16 v[220:223], a[196:199], a[252:255], v[220:223]
    ds_read_b64_tr_b16 a[210:211], v11 offset:8192
    v_cvt_pk_bf16_f32 v114, v116, v117
    v_mfma_f32_16x16x32_bf16 v[212:215], a[196:199], a[248:251], v[212:215]
    v_permlane16_swap_b32 v105, v107
    v_mfma_f32_16x16x32_bf16 v[212:215], a[192:195], a[232:235], v[212:215]
    v_permlane16_swap_b32 v112, v114
    v_mfma_f32_16x16x32_bf16 v[204:207], a[192:195], a[228:231], v[204:207]
    ds_read_b64_tr_b16 a[212:213], v11 offset:14336
    v_cvt_pk_bf16_f32 v115, v118, v119
    v_mfma_f32_16x16x32_bf16 v[204:207], a[196:199], a[244:247], v[204:207]
    s_waitcnt vmcnt(16)
    ds_read_b64_tr_b16 a[214:215], v11 offset:20480
    v_cvt_pk_bf16_f32 v120, v120, v121
    v_mfma_f32_16x16x32_bf16 v[196:199], a[196:199], a[240:243], v[196:199]
pg_5:
    s_cbranch_execz pg_9
    s_barrier
    v_mfma_f32_16x16x32_bf16 v[196:199], a[192:195], a[224:227], v[196:199]
    s_waitcnt lgkmcnt(4)
    v_permlane16_swap_b32 v113, v115
    v_mfma_f32_16x16x32_bf16 v[224:227], a[200:203], a[224:227], v[224:227]
    s_add_u32 m0, s49, 49152
    ds_read_b128 a[192:195], v16 offset:0
    v_cvt_pk_bf16_f32 v121, v122, v123
    v_mfma_f32_16x16x32_bf16 v[224:227], a[204:207], a[240:243], v[224:227]
    buffer_load_dwordx4 v4, s[12:15], s38 offen offset:0 lds
    v_mfma_f32_16x16x32_bf16 v[232:235], a[204:207], a[244:247], v[232:235]
    v_cvt_pk_bf16_f32 v122, v124, v125
    v_cvt_pk_bf16_f32 v123, v126, v127
    v_mfma_f32_16x16x32_bf16 v[232:235], a[200:203], a[228:231], v[232:235]
    v_permlane16_swap_b32 v120, v122
    v_mfma_f32_16x16x32_bf16 v[240:243], a[200:203], a[232:235], v[240:243]
    ds_read_b128 a[196:199], v17 offset:0
    v_cvt_pk_bf16_f32 v128, v128, v129
    v_mfma_f32_16x16x32_bf16 v[240:243], a[204:207], a[248:251], v[240:243]
    s_add_u32 m0, s49, 50048
    v_permlane16_swap_b32 v121, v123
    v_mfma_f32_16x16x32_bf16 v[248:251], a[204:207], a[252:255], v[248:251]
    buffer_load_dwordx4 v4, s[12:15], s38 offen offset:128 lds
    v_mfma_f32_16x16x32_bf16 v[248:251], a[200:203], a[236:239], v[248:251]
    s_waitcnt lgkmcnt(2)
    v_cvt_pk_bf16_f32 v129, v130, v131
    v_cvt_pk_bf16_f32 v130, v132, v133
    v_mfma_f32_16x16x32_bf16 v[252:255], a[208:211], a[236:239], v[252:255]
    ds_read_b128 a[200:203], v16 offset:1024
    v_cvt_pk_bf16_f32 v131, v134, v135
    v_mfma_f32_16x16x32_bf16 v[252:255], a[212:215], a[252:255], v[252:255]
    v_permlane16_swap_b32 v128, v130
    v_mfma_f32_16x16x32_bf16 v[244:247], a[212:215], a[248:251], v[244:247]
    v_permlane16_swap_b32 v129, v131
    v_mfma_f32_16x16x32_bf16 v[244:247], a[208:211], a[232:235], v[244:247]
    v_cvt_pk_bf16_f32 v136, v136, v137
    v_cvt_pk_bf16_f32 v137, v138, v139
    v_mfma_f32_16x16x32_bf16 v[236:239], a[208:211], a[228:231], v[236:239]
    s_add_u32 m0, s49, 50944
    ds_read_b128 a[204:207], v17 offset:1024
    v_cvt_pk_bf16_f32 v138, v140, v141
    v_mfma_f32_16x16x32_bf16 v[236:239], a[212:215], a[244:247], v[236:239]
    buffer_load_dwordx4 v4, s[12:15], s38 offen offset:256 lds
    v_mfma_f32_16x16x32_bf16 v[228:231], a[212:215], a[240:243], v[228:231]
    v_permlane16_swap_b32 v136, v138
    v_mfma_f32_16x16x32_bf16 v[228:231], a[208:211], a[224:227], v[228:231]
    s_waitcnt lgkmcnt(2)
    v_cvt_pk_bf16_f32 v139, v142, v143
    v_cvt_pk_bf16_f32 v144, v144, v145
    v_mfma_f32_16x16x32_bf16 v[68:71], a[192:195], v[64:67], 0
    ds_read_b128 a[208:211], v16 offset:2048
    v_cvt_pk_bf16_f32 v145, v146, v147
    v_mfma_f32_16x16x32_bf16 v[68:71], a[196:199], v[96:99], v[68:71]
    v_permlane16_swap_b32 v137, v139
    v_mfma_f32_16x16x32_bf16 v[76:79], a[196:199], v[104:107], 0
    s_add_u32 m0, s49, 52224
    v_cvt_pk_bf16_f32 v146, v148, v149
    v_cvt_pk_bf16_f32 v147, v150, v151
    v_mfma_f32_16x16x32_bf16 v[76:79], a[192:195], v[72:75], v[76:79]
    buffer_load_dwordx4 v5, s[12:15], s38 offen offset:0 lds
    v_mfma_f32_16x16x32_bf16 v[84:87], a[192:195], v[80:83], 0
    ds_read_b128 a[212:215], v17 offset:2048
    v_cvt_pk_bf16_f32 v152, v152, v153
    v_mfma_f32_16x16x32_bf16 v[84:87], a[196:199], v[112:115], v[84:87]
    v_permlane16_swap_b32 v144, v146
    v_permlane16_swap_b32 v145, v147
    v_cvt_pk_bf16_f32 v153, v154, v155
    v_cvt_pk_bf16_f32 v154, v156, v157
    v_cvt_pk_bf16_f32 v155, v158, v159
    v_mov_b32 v26, s7
    v_permlane16_swap_b32 v152, v154
    v_permlane16_swap_b32 v153, v155
    v_cvt_pk_bf16_f32 v160, v160, v161
    v_cvt_pk_bf16_f32 v161, v162, v163
    v_cvt_pk_bf16_f32 v162, v164, v165
    v_min_u32 v27, 1, v1
    v_lshlrev_b32 v27, 30, v27
    v_permlane16_swap_b32 v160, v162
    v_cvt_pk_bf16_f32 v163, v166, v167
    s_waitcnt vmcnt(11)
    v_cvt_pk_bf16_f32 v168, v168, v169
    v_permlane16_swap_b32 v161, v163
    v_cvt_pk_bf16_f32 v169, v170, v171
    v_cvt_pk_bf16_f32 v170, v172, v173
    v_cvt_pk_bf16_f32 v171, v174, v175
    v_cvt_pk_bf16_f32 v176, v176, v177
    v_permlane16_swap_b32 v168, v170
    v_permlane16_swap_b32 v169, v171
    v_cvt_pk_bf16_f32 v177, v178, v179
    v_cvt_pk_bf16_f32 v178, v180, v181
    v_cvt_pk_bf16_f32 v179, v182, v183
    v_cvt_pk_bf16_f32 v184, v184, v185
    v_permlane16_swap_b32 v176, v178
    v_permlane16_swap_b32 v177, v179
    v_cvt_pk_bf16_f32 v185, v186, v187
    v_cvt_pk_bf16_f32 v186, v188, v189
    v_cvt_pk_bf16_f32 v187, v190, v191
    v_cvt_pk_bf16_f32 v192, v192, v193
    v_permlane16_swap_b32 v184, v186
    v_permlane16_swap_b32 v185, v187
    v_mfma_f32_16x16x32_bf16 v[92:95], a[196:199], v[120:123], 0
    buffer_store_dword v26, v27, s[24:27], s4 offen offset:144 sc1
    v_mfma_f32_16x16x32_bf16 v[92:95], a[192:195], v[88:91], v[92:95]
    s_waitcnt lgkmcnt(2)
    v_cvt_pk_bf16_f32 v193, v194, v195
    v_cvt_pk_bf16_f32 v194, v196, v197
    v_mfma_f32_16x16x32_bf16 v[92:95], a[200:203], v[152:155], v[92:95]
    ds_read_b128 a[192:195], v16 offset:6144
    v_cvt_pk_bf16_f32 v195, v198, v199
    v_mfma_f32_16x16x32_bf16 v[92:95], a[204:207], v[184:187], v[92:95]
    s_add_u32 m0, s49, 53120
    v_permlane16_swap_b32 v192, v194
    v_mfma_f32_16x16x32_bf16 v[84:87], a[204:207], v[176:179], v[84:87]
    buffer_load_dwordx4 v5, s[12:15], s38 offen offset:128 lds
    v_mfma_f32_16x16x32_bf16 v[84:87], a[200:203], v[144:147], v[84:87]
    v_permlane16_swap_b32 v193, v195
    v_mfma_f32_16x16x32_bf16 v[76:79], a[200:203], v[136:139], v[76:79]
    ds_read_b128 a[196:199], v17 offset:6144
    v_cvt_pk_bf16_f32 v200, v200, v201
    v_mfma_f32_16x16x32_bf16 v[76:79], a[204:207], v[168:171], v[76:79]
    v_cvt_pk_bf16_f32 v201, v202, v203
    v_cvt_pk_bf16_f32 v202, v204, v205
    v_cvt_pk_bf16_f32 v203, v206, v207
    v_cvt_pk_bf16_f32 v208, v208, v209
    v_permlane16_swap_b32 v200, v202
    v_permlane16_swap_b32 v201, v203
    v_cvt_pk_bf16_f32 v209, v210, v211
    v_cvt_pk_bf16_f32 v210, v212, v213
    v_cvt_pk_bf16_f32 v211, v214, v215
    v_cvt_pk_bf16_f32 v216, v216, v217
    v_permlane16_swap_b32 v208, v210
    v_permlane16_swap_b32 v209, v211
    v_cvt_pk_bf16_f32 v217, v218, v219
    v_cvt_pk_bf16_f32 v218, v220, v221
    v_cvt_pk_bf16_f32 v219, v222, v223
    v_cvt_pk_bf16_f32 v224, v224, v225
    v_permlane16_swap_b32 v216, v218
    v_permlane16_swap_b32 v217, v219
    v_cvt_pk_bf16_f32 v225, v226, v227
    v_cvt_pk_bf16_f32 v226, v228, v229
    v_cvt_pk_bf16_f32 v227, v230, v231
    v_cvt_pk_bf16_f32 v232, v232, v233
    v_permlane16_swap_b32 v224, v226
    v_permlane16_swap_b32 v225, v227
    v_cvt_pk_bf16_f32 v233, v234, v235
    v_cvt_pk_bf16_f32 v234, v236, v237
    v_cvt_pk_bf16_f32 v235, v238, v239
    v_cvt_pk_bf16_f32 v240, v240, v241
    v_permlane16_swap_b32 v232, v234
    v_permlane16_swap_b32 v233, v235
    v_cvt_pk_bf16_f32 v241, v242, v243
    v_cvt_pk_bf16_f32 v242, v244, v245
    v_cvt_pk_bf16_f32 v243, v246, v247
    v_cvt_pk_bf16_f32 v248, v248, v249
    v_permlane16_swap_b32 v240, v242
    v_permlane16_swap_b32 v241, v243
    v_cvt_pk_bf16_f32 v249, v250, v251
    v_cvt_pk_bf16_f32 v250, v252, v253
    v_cvt_pk_bf16_f32 v251, v254, v255
    s_nop 0
    v_permlane16_swap_b32 v248, v250
    v_permlane16_swap_b32 v249, v251
    v_mfma_f32_16x16x32_bf16 v[68:71], a[204:207], v[160:163], v[68:71]
    v_mfma_f32_16x16x32_bf16 v[68:71], a[200:203], v[128:131], v[68:71]
    s_waitcnt lgkmcnt(2)
    s_add_u32 m0, s49, 54016
    v_mfma_f32_16x16x32_bf16 v[68:71], a[208:211], v[192:195], v[68:71]
    ds_read_b128 a[200:203], v16 offset:7168
    v_mfma_f32_16x16x32_bf16 v[68:71], a[212:215], v[224:227], v[68:71]
    buffer_load_dwordx4 v5, s[12:15], s38 offen offset:256 lds
    v_mfma_f32_16x16x32_bf16 v[76:79], a[212:215], v[232:235], v[76:79]
    s_add_u32 s38, s38, 24576
    v_mfma_f32_16x16x32_bf16 v[76:79], a[208:211], v[200:203], v[76:79]
    v_mfma_f32_16x16x32_bf16 v[84:87], a[208:211], v[208:211], v[84:87]
    ds_read_b128 a[204:207], v17 offset:7168
    v_mfma_f32_16x16x32_bf16 v[84:87], a[212:215], v[240:243], v[84:87]
    v_mfma_f32_16x16x32_bf16 v[92:95], a[212:215], v[248:251], v[92:95]
    v_mfma_f32_16x16x32_bf16 v[92:95], a[208:211], v[216:219], v[92:95]
    s_waitcnt lgkmcnt(2)
    v_mfma_f32_16x16x32_bf16 v[124:127], a[192:195], v[88:91], 0
    ds_read_b128 a[208:211], v16 offset:8192
    v_mfma_f32_16x16x32_bf16 v[124:127], a[196:199], v[120:123], v[124:127]
    v_mfma_f32_16x16x32_bf16 v[116:119], a[196:199], v[112:115], 0
    v_mfma_f32_16x16x32_bf16 v[116:119], a[192:195], v[80:83], v[116:119]
    v_mfma_f32_16x16x32_bf16 v[108:111], a[192:195], v[72:75], 0
    ds_read_b128 a[212:215], v17 offset:8192
    v_mfma_f32_16x16x32_bf16 v[108:111], a[196:199], v[104:107], v[108:111]
    s_add_u32 m0, s49, 98304
    v_max3_f32 v56, v68, v69, v70
    v_max_f32 v56, v56, v71
    v_mfma_f32_16x16x32_bf16 v[100:103], a[196:199], v[96:99], 0
    buffer_load_dwordx4 v6, s[16:19], s40 offen offset:0 lds
    v_mfma_f32_16x16x32_bf16 v[100:103], a[192:195], v[64:67], v[100:103]
    s_waitcnt lgkmcnt(2)
    v_mov_b32 v48, v56
    v_max3_f32 v57, v76, v77, v78
    v_mfma_f32_16x16x32_bf16 v[100:103], a[200:203], v[128:131], v[100:103]
    ds_read_b128 a[192:195], v16 offset:12288
    v_max_f32 v57, v57, v79
    v_mfma_f32_16x16x32_bf16 v[100:103], a[204:207], v[160:163], v[100:103]
    v_permlane16_swap_b32 v56, v48
    v_mfma_f32_16x16x32_bf16 v[108:111], a[204:207], v[168:171], v[108:111]
    v_max_f32 v56, v56, v48
    v_mov_b32 v48, v56
    v_mfma_f32_16x16x32_bf16 v[108:111], a[200:203], v[136:139], v[108:111]
    s_add_u32 m0, s49, 99200
    v_permlane32_swap_b32 v56, v48
    v_mfma_f32_16x16x32_bf16 v[116:119], a[200:203], v[144:147], v[116:119]
    ds_read_b128 a[196:199], v17 offset:12288
    v_max_f32 v56, v56, v48
    v_mfma_f32_16x16x32_bf16 v[116:119], a[204:207], v[176:179], v[116:119]
    buffer_load_dwordx4 v6, s[16:19], s40 offen offset:128 lds
    v_mfma_f32_16x16x32_bf16 v[124:127], a[204:207], v[184:187], v[124:127]
    v_sub_f32 v32, 0, v56
    v_sub_f32 v33, 0, v56
    v_mfma_f32_16x16x32_bf16 v[124:127], a[200:203], v[152:155], v[124:127]
    s_waitcnt lgkmcnt(2)
    v_sub_f32 v34, 0, v56
    v_sub_f32 v35, 0, v56
    v_mfma_f32_16x16x32_bf16 v[124:127], a[208:211], v[216:219], v[124:127]
    ds_read_b128 a[200:203], v16 offset:13312
    v_mov_b32 v49, v57
    v_mfma_f32_16x16x32_bf16 v[124:127], a[212:215], v[248:251], v[124:127]
    v_max3_f32 v58, v84, v85, v86
    v_max_f32 v58, v58, v87
    v_mfma_f32_16x16x32_bf16 v[116:119], a[212:215], v[240:243], v[116:119]
    s_add_u32 m0, s49, 100096
    v_permlane16_swap_b32 v57, v49
    v_mfma_f32_16x16x32_bf16 v[116:119], a[208:211], v[208:211], v[116:119]
    buffer_load_dwordx4 v6, s[16:19], s40 offen offset:256 lds
    v_mfma_f32_16x16x32_bf16 v[108:111], a[208:211], v[200:203], v[108:111]
    ds_read_b128 a[204:207], v17 offset:13312
    v_max_f32 v57, v57, v49
    v_mfma_f32_16x16x32_bf16 v[108:111], a[212:215], v[232:235], v[108:111]
    v_mov_b32 v49, v57
    v_mov_b32 v50, v58
    v_max3_f32 v59, v92, v93, v94
    v_permlane32_swap_b32 v57, v49
    v_permlane16_swap_b32 v58, v50
    v_max_f32 v57, v57, v49
    v_sub_f32 v36, 0, v57
    v_sub_f32 v37, 0, v57
    v_sub_f32 v38, 0, v57
    v_sub_f32 v39, 0, v57
    v_max_f32 v58, v58, v50
    v_mov_b32 v50, v58
    v_max_f32 v59, v59, v95
    v_mov_b32 v51, v59
    v_permlane32_swap_b32 v58, v50
    s_nop 0
    v_max_f32 v58, v58, v50
    v_sub_f32 v40, 0, v58
    v_sub_f32 v41, 0, v58
    v_sub_f32 v42, 0, v58
    v_sub_f32 v43, 0, v58
    v_permlane16_swap_b32 v59, v51
    s_nop 0
    v_max_f32 v59, v59, v51
    v_mov_b32 v51, v59
    s_nop 0
    s_nop 0
    v_permlane32_swap_b32 v59, v51
    s_nop 0
    v_max_f32 v59, v59, v51
    v_sub_f32 v44, 0, v59
    v_sub_f32 v45, 0, v59
    v_sub_f32 v46, 0, v59
    v_sub_f32 v47, 0, v59
    v_mfma_f32_16x16x32_bf16 v[100:103], a[212:215], v[224:227], v[100:103]
    v_sub_f32 v68, v68, v56
    v_sub_f32 v69, v69, v56
    v_mfma_f32_16x16x32_bf16 v[100:103], a[208:211], v[192:195], v[100:103]
    s_waitcnt lgkmcnt(2)
    v_exp_f32 v48, v68
    v_mfma_f32_16x16x32_bf16 v[132:135], a[192:195], v[64:67], v[32:35]
    s_add_u32 m0, s49, 101376
    ds_read_b128 a[208:211], v16 offset:14336
    v_sub_f32 v70, v70, v56
    v_mfma_f32_16x16x32_bf16 v[132:135], a[196:199], v[96:99], v[132:135]
    buffer_load_dwordx4 v7, s[16:19], s40 offen offset:0 lds
    v_mfma_f32_16x16x32_bf16 v[140:143], a[196:199], v[104:107], v[36:39]
    v_exp_f32 v49, v69
    v_mfma_f32_16x16x32_bf16 v[140:143], a[192:195], v[72:75], v[140:143]
    v_exp_f32 v50, v70
    v_mfma_f32_16x16x32_bf16 v[148:151], a[192:195], v[80:83], v[40:43]
    ds_read_b128 a[212:215], v17 offset:14336
    v_sub_f32 v71, v71, v56
    v_mfma_f32_16x16x32_bf16 v[148:151], a[196:199], v[112:115], v[148:151]
    v_exp_f32 v51, v71
    v_mfma_f32_16x16x32_bf16 v[156:159], a[196:199], v[120:123], v[44:47]
    v_sub_f32 v100, v100, v56
    v_cvt_pk_bf16_f32 v196, v48, v49
    v_mfma_f32_16x16x32_bf16 v[156:159], a[192:195], v[88:91], v[156:159]
    s_waitcnt lgkmcnt(2)
    v_exp_f32 v52, v100
    v_mfma_f32_16x16x32_bf16 v[156:159], a[200:203], v[152:155], v[156:159]
    s_add_u32 m0, s49, 102272
    ds_read_b128 a[192:195], v16 offset:18432
    v_add_f32 v24, v48, v49
    v_mfma_f32_16x16x32_bf16 v[156:159], a[204:207], v[184:187], v[156:159]
    buffer_load_dwordx4 v7, s[16:19], s40 offen offset:128 lds
    v_mfma_f32_16x16x32_bf16 v[148:151], a[204:207], v[176:179], v[148:151]
    v_sub_f32 v101, v101, v56
    v_sub_f32 v102, v102, v56
    v_mfma_f32_16x16x32_bf16 v[148:151], a[200:203], v[144:147], v[148:151]
    v_exp_f32 v53, v101
    v_mfma_f32_16x16x32_bf16 v[140:143], a[200:203], v[136:139], v[140:143]
    ds_read_b128 a[196:199], v17 offset:18432
    v_add_f32 v24, v24, v50
    v_mfma_f32_16x16x32_bf16 v[140:143], a[204:207], v[168:171], v[140:143]
    s_add_u32 m0, s49, 103168
    v_exp_f32 v54, v102
    v_mfma_f32_16x16x32_bf16 v[132:135], a[204:207], v[160:163], v[132:135]
    buffer_load_dwordx4 v7, s[16:19], s40 offen offset:256 lds
    v_mfma_f32_16x16x32_bf16 v[132:135], a[200:203], v[128:131], v[132:135]
    s_waitcnt lgkmcnt(2)
    v_sub_f32 v103, v103, v56
    v_cvt_pk_bf16_f32 v197, v50, v51
    v_mfma_f32_16x16x32_bf16 v[132:135], a[208:211], v[192:195], v[132:135]
    s_add_u32 s40, s40, 24576
    ds_read_b128 a[200:203], v16 offset:19456
    v_add_f32 v24, v24, v51
    v_mfma_f32_16x16x32_bf16 v[132:135], a[212:215], v[224:227], v[132:135]
    v_exp_f32 v55, v103
    v_mfma_f32_16x16x32_bf16 v[140:143], a[212:215], v[232:235], v[140:143]
    v_sub_f32 v76, v76, v57
    v_sub_f32 v77, v77, v57
    v_mfma_f32_16x16x32_bf16 v[140:143], a[208:211], v[200:203], v[140:143]
    v_exp_f32 v48, v76
    v_mfma_f32_16x16x32_bf16 v[148:151], a[208:211], v[208:211], v[148:151]
    ds_read_b128 a[204:207], v17 offset:19456
    v_add_f32 v24, v24, v52
    v_mfma_f32_16x16x32_bf16 v[148:151], a[212:215], v[240:243], v[148:151]
    v_exp_f32 v49, v77
    v_mfma_f32_16x16x32_bf16 v[156:159], a[212:215], v[248:251], v[156:159]
    v_sub_f32 v78, v78, v57
    v_cvt_pk_bf16_f32 v198, v52, v53
    v_mfma_f32_16x16x32_bf16 v[156:159], a[208:211], v[216:219], v[156:159]
    s_waitcnt lgkmcnt(2)
    v_exp_f32 v50, v78
    v_mfma_f32_16x16x32_bf16 v[188:191], a[192:195], v[88:91], v[44:47]
    ds_read_b128 a[208:211], v16 offset:20480
    v_add_f32 v24, v24, v53
    v_mfma_f32_16x16x32_bf16 v[188:191], a[196:199], v[120:123], v[188:191]
    v_sub_f32 v79, v79, v57
    v_sub_f32 v108, v108, v57
    v_mfma_f32_16x16x32_bf16 v[180:183], a[196:199], v[112:115], v[40:43]
    v_exp_f32 v51, v79
    v_mfma_f32_16x16x32_bf16 v[180:183], a[192:195], v[80:83], v[180:183]
    v_add_f32 v24, v24, v54
    v_sub_f32 v109, v109, v57
    v_mfma_f32_16x16x32_bf16 v[172:175], a[192:195], v[72:75], v[36:39]
    ds_read_b128 a[212:215], v17 offset:20480
    v_cvt_pk_bf16_f32 v199, v54, v55
    v_mfma_f32_16x16x32_bf16 v[172:175], a[196:199], v[104:107], v[172:175]
    s_waitcnt vmcnt(16)
    v_exp_f32 v52, v108
    v_mfma_f32_16x16x32_bf16 v[164:167], a[196:199], v[96:99], v[32:35]
    s_barrier
    v_mfma_f32_16x16x32_bf16 v[164:167], a[192:195], v[64:67], v[164:167]
    s_waitcnt lgkmcnt(2)
    v_add_f32 v24, v24, v55
    v_sub_f32 v110, v110, v57
    v_add_u32 v16, s42, v18
    v_mfma_f32_16x16x32_bf16 v[164:167], a[200:203], v[128:131], v[164:167]
    ds_read_b128 a[224:227], v16 offset:0
    v_sub_f32 v111, v111, v57
    v_mfma_f32_16x16x32_bf16 v[164:167], a[204:207], v[160:163], v[164:167]
    v_exp_f32 v53, v109
    v_add_u32 v17, s42, v19
    v_mfma_f32_16x16x32_bf16 v[172:175], a[204:207], v[168:171], v[172:175]
    ds_read_b128 a[228:231], v17 offset:0
    v_sub_f32 v84, v84, v58
    v_mfma_f32_16x16x32_bf16 v[172:175], a[200:203], v[136:139], v[172:175]
    v_exp_f32 v54, v110
    v_mfma_f32_16x16x32_bf16 v[180:183], a[200:203], v[144:147], v[180:183]
    ds_read_b128 a[232:235], v16 offset:1024
    v_cvt_pk_bf16_f32 v204, v48, v49
    v_mfma_f32_16x16x32_bf16 v[180:183], a[204:207], v[176:179], v[180:183]
    v_exp_f32 v55, v111
    v_mfma_f32_16x16x32_bf16 v[188:191], a[204:207], v[184:187], v[188:191]
    ds_read_b128 a[236:239], v17 offset:1024
    v_add_f32 v25, v48, v49
    v_mfma_f32_16x16x32_bf16 v[188:191], a[200:203], v[152:155], v[188:191]
    s_waitcnt lgkmcnt(4)
    v_sub_f32 v85, v85, v58
    v_sub_f32 v86, v86, v58
    v_mfma_f32_16x16x32_bf16 v[188:191], a[208:211], v[216:219], v[188:191]
    ds_read_b128 a[240:243], v16 offset:2048
    v_add_f32 v25, v25, v50
    v_mfma_f32_16x16x32_bf16 v[188:191], a[212:215], v[248:251], v[188:191]
    v_exp_f32 v48, v84
    v_mfma_f32_16x16x32_bf16 v[180:183], a[212:215], v[240:243], v[180:183]
    ds_read_b128 a[244:247], v17 offset:2048
    v_sub_f32 v87, v87, v58
    v_mfma_f32_16x16x32_bf16 v[180:183], a[208:211], v[208:211], v[180:183]
    v_cvt_pk_bf16_f32 v205, v50, v51
    v_add_f32 v25, v25, v51
    v_mfma_f32_16x16x32_bf16 v[172:175], a[208:211], v[200:203], v[172:175]
    v_sub_f32 v116, v116, v58
    v_sub_f32 v117, v117, v58
    v_mfma_f32_16x16x32_bf16 v[172:175], a[212:215], v[232:235], v[172:175]
    v_exp_f32 v49, v85
    v_mfma_f32_16x16x32_bf16 v[164:167], a[212:215], v[224:227], v[164:167]
    v_exp_f32 v50, v86
    v_mfma_f32_16x16x32_bf16 v[164:167], a[208:211], v[192:195], v[164:167]
    v_add_f32 v25, v25, v52
    v_cvt_pk_bf16_f32 v206, v52, v53
    v_cvt_pk_bf16_f32 v207, v54, v55
    v_add_f32 v25, v25, v53
    v_add_f32 v25, v25, v54
    v_add_f32 v25, v25, v55
    v_cvt_pk_bf16_f32 v212, v48, v49
    v_exp_f32 v51, v87
    v_sub_f32 v118, v118, v58
    v_cvt_pk_bf16_f32 v213, v50, v51
    v_exp_f32 v52, v116
    v_exp_f32 v53, v117
    v_sub_f32 v119, v119, v58
    v_cvt_pk_bf16_f32 v214, v52, v53
    v_exp_f32 v54, v118
    v_exp_f32 v55, v119
    v_sub_f32 v92, v92, v59
    v_cvt_pk_bf16_f32 v215, v54, v55
    v_add_f32 v26, v48, v49
    v_add_f32 v26, v26, v50
    v_add_f32 v26, v26, v51
    v_add_f32 v26, v26, v52
    v_add_f32 v26, v26, v53
    v_add_f32 v26, v26, v54
    v_add_f32 v26, v26, v55
    v_max3_f32 v29, v24, v25, v26
    v_exp_f32 v48, v92
    v_sub_f32 v93, v93, v59
    v_exp_f32 v49, v93
    v_sub_f32 v94, v94, v59
    v_cvt_pk_bf16_f32 v220, v48, v49
    v_exp_f32 v50, v94
    v_sub_f32 v95, v95, v59
    v_exp_f32 v51, v95
    v_sub_f32 v124, v124, v59
    v_cvt_pk_bf16_f32 v221, v50, v51
    v_exp_f32 v52, v124
    v_sub_f32 v125, v125, v59
    v_exp_f32 v53, v125
    v_sub_f32 v126, v126, v59
    v_cvt_pk_bf16_f32 v222, v52, v53
    v_exp_f32 v54, v126
    v_sub_f32 v127, v127, v59
    v_exp_f32 v55, v127
    v_add_f32 v27, v48, v49
    v_cvt_pk_bf16_f32 v223, v54, v55
    v_add_f32 v27, v27, v50
    v_add_f32 v27, v27, v51
    v_add_f32 v27, v27, v52
    v_add_f32 v27, v27, v53
    v_add_f32 v27, v27, v54
    v_add_f32 v27, v27, v55
    v_max_f32 v29, v29, v27
    v_cmp_nle_f32 vcc, v29, v30
    s_cbranch_vccnz rare_p
rare_p_ret:
    s_waitcnt lgkmcnt(0)
    s_mov_b64 s[88:89], s[12:13]
    s_mov_b32 s57, s38
    v_mov_b32 v58, v4
    v_mov_b32 v59, v5
at_switch:
    s_cmp_eq_u32 s45, 0
    s_cbranch_scc1 at_sw2
    s_mov_b32 s76, s63
    s_mov_b32 s12, s8
    s_mov_b32 s13, s9
    s_mov_b32 s14, s10
    s_mov_b32 s38, s36
    s_mov_b32 s39, 81920
    v_mov_b32 v4, v62
    v_mov_b32 v5, v63
    v_lshrrev_b32 v60, 2, v1
    v_min_u32 v60, 9, v60
    v_mul_u32_u24 v60, 6144, v60
    v_lshrrev_b32 v57, 9, v3
    v_add_u32 v60, v60, v57
    v_and_b32 v57, 15, v1
    v_lshl_add_u32 v57, s3, 4, v57
    v_mul_u32_u24 v57, 1280, v57
    s_getpc_b64 s[74:75]
ct1:
    s_add_u32 s74, s74, tail_code-ct1
    s_addc_u32 s75, s75, 0
    s_cmp_eq_u32 s45, 1
    s_cbranch_scc0 at_dry
    global_load_dword a219, v31, s[74:75]
    buffer_load_dword a217, v57, s[32:35], s60 offen
    buffer_load_dword v61, v60, s[24:27], s37 offen sc1
    s_branch at_switch_ret
at_sw2:
    s_mov_b32 s16, s8
    s_mov_b32 s17, s9
    s_mov_b32 s18, s10
    s_add_u32 s40, s38, s39
    s_mov_b32 s66, s63
    v_mov_b32 v6, v62
    v_mov_b32 v7, v63
    s_branch at_switch_ret
at_dry:
    s_mov_b32 s76, 0
    s_mov_b64 s[12:13], s[88:89]
    s_mov_b32 s14, 196608
    s_mov_b32 s38, s57
    s_mov_b32 s39, 24576
    v_mov_b32 v4, v58
    v_mov_b32 v5, v59
    .p2align 6
at_loop:
    v_mfma_f32_16x16x32_bf16 v[68:71], a[224:227], v[64:67], v[32:35]
    ds_read_b128 a[192:195], v16 offset:6144
    v_add_f32 v20, v20, v24
    v_mfma_f32_16x16x32_bf16 v[68:71], a[228:231], v[96:99], v[68:71]
    s_cmp_le_u32 s45, 1
    s_cbranch_scc1 at_switch
at_switch_ret:
    v_add_f32 v21, v21, v25
    v_mfma_f32_16x16x32_bf16 v[68:71], a[232:235], v[128:131], v[68:71]
    s_add_u32 s77, s38, s76
    v_add_f32 v22, v22, v26
    v_add_f32 v23, v23, v27
    v_mfma_f32_16x16x32_bf16 v[68:71], a[236:239], v[160:163], v[68:71]
    ds_read_b128 a[196:199], v17 offset:6144
    v_add_u32 v8, s41, v12
    v_mfma_f32_16x16x32_bf16 v[68:71], a[240:243], v[192:195], v[68:71]
    v_exp_f32 v48, v132
    v_mfma_f32_16x16x32_bf16 v[68:71], a[244:247], v[224:227], v[68:71]
    s_add_u32 m0, s41, 0
    v_exp_f32 v49, v133
    v_mfma_f32_16x16x32_bf16 v[76:79], a[244:247], v[232:235], v[36:39]
    ds_read_b128 a[200:203], v16 offset:7168
    v_cvt_pk_bf16_f32 v228, v48, v49
    v_mfma_f32_16x16x32_bf16 v[76:79], a[240:243], v[200:203], v[76:79]
    buffer_load_dwordx4 v4, s[12:15], s38 offen offset:0 lds
    v_mfma_f32_16x16x32_bf16 v[76:79], a[236:239], v[168:171], v[76:79]
    v_exp_f32 v50, v134
    v_mfma_f32_16x16x32_bf16 v[76:79], a[232:235], v[136:139], v[76:79]
    ds_read_b128 a[204:207], v17 offset:7168
    v_add_f32 v24, v48, v49
    v_mfma_f32_16x16x32_bf16 v[76:79], a[228:231], v[104:107], v[76:79]
    v_exp_f32 v51, v135
    v_mfma_f32_16x16x32_bf16 v[76:79], a[224:227], v[72:75], v[76:79]
    v_exp_f32 v52, v164
    v_mfma_f32_16x16x32_bf16 v[84:87], a[224:227], v[80:83], v[40:43]
    ds_read_b128 a[208:211], v16 offset:8192
    v_add_u32 v9, s41, v13
    v_mfma_f32_16x16x32_bf16 v[84:87], a[228:231], v[112:115], v[84:87]
    v_exp_f32 v53, v165
    v_mfma_f32_16x16x32_bf16 v[84:87], a[232:235], v[144:147], v[84:87]
    v_exp_f32 v54, v166
    v_mfma_f32_16x16x32_bf16 v[84:87], a[236:239], v[176:179], v[84:87]
    ds_read_b128 a[212:215], v17 offset:8192
    v_add_f32 v24, v24, v50
    v_mfma_f32_16x16x32_bf16 v[84:87], a[240:243], v[208:211], v[84:87]
    v_exp_f32 v55, v167
    v_mfma_f32_16x16x32_bf16 v[84:87], a[244:247], v[240:243], v[84:87]
    s_add_u32 m0, s41, 896
    v_add_u32 v10, s41, v14
    v_cvt_pk_bf16_f32 v229, v50, v51
    v_mfma_f32_16x16x32_bf16 v[92:95], a[244:247], v[248:251], v[44:47]
    buffer_load_dwordx4 v4, s[12:15], s38 offen offset:128 lds
    v_mfma_f32_16x16x32_bf16 v[92:95], a[240:243], v[216:219], v[92:95]
    v_add_f32 v24, v24, v51
    v_add_u32 v11, s41, v15
    v_mfma_f32_16x16x32_bf16 v[92:95], a[236:239], v[184:187], v[92:95]
    v_exp_f32 v48, v140
    v_mfma_f32_16x16x32_bf16 v[92:95], a[232:235], v[152:155], v[92:95]
    v_add_f32 v24, v24, v52
    v_cvt_pk_bf16_f32 v230, v52, v53
    v_mfma_f32_16x16x32_bf16 v[92:95], a[228:231], v[120:123], v[92:95]
    v_exp_f32 v49, v141
    v_mfma_f32_16x16x32_bf16 v[92:95], a[224:227], v[88:91], v[92:95]
    s_waitcnt lgkmcnt(0)
    v_add_f32 v24, v24, v53
    v_add_f32 v24, v24, v54
    v_mfma_f32_16x16x32_bf16 v[124:127], a[192:195], v[88:91], v[44:47]
    ds_read_b64_tr_b16 a[224:225], v8 offset:0
    v_cvt_pk_bf16_f32 v231, v54, v55
    v_mfma_f32_16x16x32_bf16 v[124:127], a[196:199], v[120:123], v[124:127]
    ds_read_b64_tr_b16 a[226:227], v8 offset:6144
    v_add_f32 v24, v24, v55
    v_mfma_f32_16x16x32_bf16 v[124:127], a[200:203], v[152:155], v[124:127]
    v_exp_f32 v50, v142
    v_mfma_f32_16x16x32_bf16 v[124:127], a[204:207], v[184:187], v[124:127]
    ds_read_b64_tr_b16 a[228:229], v9 offset:0
    v_cvt_pk_bf16_f32 v236, v48, v49
    v_mfma_f32_16x16x32_bf16 v[124:127], a[208:211], v[216:219], v[124:127]
    ds_read_b64_tr_b16 a[230:231], v9 offset:6144
    v_add_f32 v25, v48, v49
    v_mfma_f32_16x16x32_bf16 v[124:127], a[212:215], v[248:251], v[124:127]
    v_exp_f32 v51, v143
    v_mfma_f32_16x16x32_bf16 v[116:119], a[212:215], v[240:243], v[40:43]
    ds_read_b64_tr_b16 a[232:233], v10 offset:0
    v_add_f32 v25, v25, v50
    v_mfma_f32_16x16x32_bf16 v[116:119], a[208:211], v[208:211], v[116:119]
    s_add_u32 m0, s41, 1792
    ds_read_b64_tr_b16 a[234:235], v10 offset:6144
    v_cvt_pk_bf16_f32 v237, v50, v51
    v_mfma_f32_16x16x32_bf16 v[116:119], a[204:207], v[176:179], v[116:119]
    buffer_load_dwordx4 v4, s[12:15], s77 offen offset:256 lds
    v_mfma_f32_16x16x32_bf16 v[116:119], a[200:203], v[144:147], v[116:119]
    ds_read_b64_tr_b16 a[236:237], v11 offset:0
    v_add_f32 v25, v25, v51
    v_mfma_f32_16x16x32_bf16 v[116:119], a[196:199], v[112:115], v[116:119]
    ds_read_b64_tr_b16 a[238:239], v11 offset:6144
    v_mfma_f32_16x16x32_bf16 v[116:119], a[192:195], v[80:83], v[116:119]
    v_exp_f32 v52, v172
    v_mfma_f32_16x16x32_bf16 v[108:111], a[192:195], v[72:75], v[36:39]
    ds_read_b64_tr_b16 a[240:241], v8 offset:1024
    v_add_f32 v25, v25, v52
    v_mfma_f32_16x16x32_bf16 v[108:111], a[196:199], v[104:107], v[108:111]
    ds_read_b64_tr_b16 a[242:243], v8 offset:7168
    v_mfma_f32_16x16x32_bf16 v[108:111], a[200:203], v[136:139], v[108:111]
    v_exp_f32 v53, v173
    v_mfma_f32_16x16x32_bf16 v[108:111], a[204:207], v[168:171], v[108:111]
    ds_read_b64_tr_b16 a[244:245], v9 offset:1024
    v_cvt_pk_bf16_f32 v238, v52, v53
    v_mfma_f32_16x16x32_bf16 v[108:111], a[208:211], v[200:203], v[108:111]
    ds_read_b64_tr_b16 a[246:247], v9 offset:7168
    v_add_f32 v25, v25, v53
    v_mfma_f32_16x16x32_bf16 v[108:111], a[212:215], v[232:235], v[108:111]
    v_exp_f32 v54, v174
    v_mfma_f32_16x16x32_bf16 v[100:103], a[212:215], v[224:227], v[32:35]
    v_exp_f32 v55, v175
    v_mfma_f32_16x16x32_bf16 v[100:103], a[208:211], v[192:195], v[100:103]
    v_exp_f32 v48, v148
    v_mfma_f32_16x16x32_bf16 v[100:103], a[204:207], v[160:163], v[100:103]
    v_exp_f32 v49, v149
    v_mfma_f32_16x16x32_bf16 v[100:103], a[200:203], v[128:131], v[100:103]
    s_add_u32 m0, s41, 3072
    v_exp_f32 v50, v150
    v_mfma_f32_16x16x32_bf16 v[100:103], a[196:199], v[96:99], v[100:103]
    buffer_load_dwordx4 v5, s[12:15], s38 offen offset:0 lds
    v_mfma_f32_16x16x32_bf16 v[100:103], a[192:195], v[64:67], v[100:103]
    s_waitcnt lgkmcnt(0)
    v_add_f32 v25, v25, v54
    v_cvt_pk_bf16_f32 v239, v54, v55
    v_mfma_f32_16x16x32_bf16 a[0:3], a[224:227], v[196:199], a[0:3]
    ds_read_b64_tr_b16 a[192:193], v10 offset:1024
    v_add_f32 v25, v25, v55
    v_mfma_f32_16x16x32_bf16 a[16:19], a[228:231], v[196:199], a[16:19]
    ds_read_b64_tr_b16 a[194:195], v10 offset:7168
    v_cvt_pk_bf16_f32 v244, v48, v49
    v_mfma_f32_16x16x32_bf16 a[32:35], a[232:235], v[196:199], a[32:35]
    v_exp_f32 v51, v151
    v_mfma_f32_16x16x32_bf16 a[48:51], a[236:239], v[196:199], a[48:51]
    ds_read_b64_tr_b16 a[196:197], v11 offset:1024
    v_add_f32 v26, v48, v49
    v_mfma_f32_16x16x32_bf16 a[64:67], a[240:243], v[196:199], a[64:67]
    ds_read_b64_tr_b16 a[198:199], v11 offset:7168
    v_add_f32 v26, v26, v50
    v_mfma_f32_16x16x32_bf16 a[80:83], a[244:247], v[196:199], a[80:83]
    v_exp_f32 v52, v180
    v_mfma_f32_16x16x32_bf16 a[84:87], a[244:247], v[204:207], a[84:87]
    ds_read_b64_tr_b16 a[200:201], v8 offset:2048
    v_cvt_pk_bf16_f32 v245, v50, v51
    v_mfma_f32_16x16x32_bf16 a[68:71], a[240:243], v[204:207], a[68:71]
    ds_read_b64_tr_b16 a[202:203], v8 offset:8192
    v_add_f32 v26, v26, v51
    v_mfma_f32_16x16x32_bf16 a[52:55], a[236:239], v[204:207], a[52:55]
pg_6:
    s_cbranch_execz pg_10
    v_exp_f32 v53, v181
    v_mfma_f32_16x16x32_bf16 a[36:39], a[232:235], v[204:207], a[36:39]
    ds_read_b64_tr_b16 a[204:205], v9 offset:2048
    v_add_f32 v26, v26, v52
    v_mfma_f32_16x16x32_bf16 a[20:23], a[228:231], v[204:207], a[20:23]
    ds_read_b64_tr_b16 a[206:207], v9 offset:8192
    v_cvt_pk_bf16_f32 v246, v52, v53
    v_mfma_f32_16x16x32_bf16 a[4:7], a[224:227], v[204:207], a[4:7]
    s_add_u32 m0, s41, 3968
    v_exp_f32 v54, v182
    v_mfma_f32_16x16x32_bf16 a[8:11], a[224:227], v[212:215], a[8:11]
    ds_read_b64_tr_b16 a[208:209], v10 offset:2048
    v_add_f32 v26, v26, v53
    v_mfma_f32_16x16x32_bf16 a[24:27], a[228:231], v[212:215], a[24:27]
    ds_read_b64_tr_b16 a[210:211], v10 offset:8192
    v_add_f32 v26, v26, v54
    v_mfma_f32_16x16x32_bf16 a[40:43], a[232:235], v[212:215], a[40:43]
    buffer_load_dwordx4 v5, s[12:15], s38 offen offset:128 lds
    v_mfma_f32_16x16x32_bf16 a[56:59], a[236:239], v[212:215], a[56:59]
    ds_read_b64_tr_b16 a[212:213], v11 offset:2048
    v_mfma_f32_16x16x32_bf16 a[72:75], a[240:243], v[212:215], a[72:75]
    ds_read_b64_tr_b16 a[214:215], v11 offset:8192
    v_mfma_f32_16x16x32_bf16 a[88:91], a[244:247], v[212:215], a[88:91]
    v_exp_f32 v55, v183
    v_mfma_f32_16x16x32_bf16 a[92:95], a[244:247], v[220:223], a[92:95]
    v_exp_f32 v48, v156
    v_mfma_f32_16x16x32_bf16 a[76:79], a[240:243], v[220:223], a[76:79]
    v_exp_f32 v49, v157
    v_mfma_f32_16x16x32_bf16 a[60:63], a[236:239], v[220:223], a[60:63]
    v_exp_f32 v50, v158
    v_mfma_f32_16x16x32_bf16 a[44:47], a[232:235], v[220:223], a[44:47]
    v_exp_f32 v51, v159
    v_mfma_f32_16x16x32_bf16 a[28:31], a[228:231], v[220:223], a[28:31]
    v_cvt_pk_bf16_f32 v247, v54, v55
    v_add_f32 v26, v26, v55
    v_mfma_f32_16x16x32_bf16 a[12:15], a[224:227], v[220:223], a[12:15]
    s_waitcnt lgkmcnt(0)
    v_exp_f32 v52, v188
    v_mfma_f32_16x16x32_bf16 a[108:111], a[192:195], v[220:223], a[108:111]
    ds_read_b128 a[224:227], v16 offset:12288
    v_cvt_pk_bf16_f32 v252, v48, v49
    v_mfma_f32_16x16x32_bf16 a[124:127], a[196:199], v[220:223], a[124:127]
    s_add_u32 m0, s41, 4864
    v_exp_f32 v53, v189
    v_mfma_f32_16x16x32_bf16 a[140:143], a[200:203], v[220:223], a[140:143]
    buffer_load_dwordx4 v5, s[12:15], s77 offen offset:256 lds
    v_mfma_f32_16x16x32_bf16 a[156:159], a[204:207], v[220:223], a[156:159]
    ds_read_b128 a[228:231], v17 offset:12288
    v_add_f32 v27, v48, v49
    v_mfma_f32_16x16x32_bf16 a[172:175], a[208:211], v[220:223], a[172:175]
    s_add_u32 s38, s38, s39
    v_exp_f32 v54, v190
    v_mfma_f32_16x16x32_bf16 a[188:191], a[212:215], v[220:223], a[188:191]
    s_add_u32 s77, s40, s66
    v_add_f32 v27, v27, v50
    v_cvt_pk_bf16_f32 v253, v50, v51
    v_mfma_f32_16x16x32_bf16 a[184:187], a[212:215], v[212:215], a[184:187]
    ds_read_b128 a[232:235], v16 offset:13312
    v_add_f32 v27, v27, v51
    v_mfma_f32_16x16x32_bf16 a[168:171], a[208:211], v[212:215], a[168:171]
    v_exp_f32 v55, v191
    v_mfma_f32_16x16x32_bf16 a[152:155], a[204:207], v[212:215], a[152:155]
    v_add_f32 v27, v27, v52
    v_mfma_f32_16x16x32_bf16 a[136:139], a[200:203], v[212:215], a[136:139]
    ds_read_b128 a[236:239], v17 offset:13312
    v_cvt_pk_bf16_f32 v254, v52, v53
    v_mfma_f32_16x16x32_bf16 a[120:123], a[196:199], v[212:215], a[120:123]
    v_add_f32 v27, v27, v53
    v_mfma_f32_16x16x32_bf16 a[104:107], a[192:195], v[212:215], a[104:107]
    v_add_f32 v27, v27, v54
    v_mfma_f32_16x16x32_bf16 a[100:103], a[192:195], v[204:207], a[100:103]
    ds_read_b128 a[240:243], v16 offset:14336
    v_cvt_pk_bf16_f32 v255, v54, v55
    v_mfma_f32_16x16x32_bf16 a[116:119], a[196:199], v[204:207], a[116:119]
    v_add_f32 v27, v27, v55
    v_mfma_f32_16x16x32_bf16 a[132:135], a[200:203], v[204:207], a[132:135]
    v_max3_f32 v29, v24, v25, v26
    v_mfma_f32_16x16x32_bf16 a[148:151], a[204:207], v[204:207], a[148:151]
    s_add_u32 m0, s43, 73728
    ds_read_b128 a[244:247], v17 offset:14336
    v_max_f32 v29, v29, v27
    v_mfma_f32_16x16x32_bf16 a[164:167], a[208:211], v[204:207], a[164:167]
    buffer_load_dwordx4 v6, s[16:19], s40 offen offset:0 lds
    v_mfma_f32_16x16x32_bf16 a[180:183], a[212:215], v[204:207], a[180:183]
    v_cmp_nle_f32 vcc, v29, v30
    v_mfma_f32_16x16x32_bf16 a[176:179], a[212:215], v[196:199], a[176:179]
    v_mfma_f32_16x16x32_bf16 a[160:163], a[208:211], v[196:199], a[160:163]
    v_mfma_f32_16x16x32_bf16 a[144:147], a[204:207], v[196:199], a[144:147]
    v_mfma_f32_16x16x32_bf16 a[128:131], a[200:203], v[196:199], a[128:131]
    v_mfma_f32_16x16x32_bf16 a[112:115], a[196:199], v[196:199], a[112:115]
    v_mfma_f32_16x16x32_bf16 a[96:99], a[192:195], v[196:199], a[96:99]
    s_waitcnt lgkmcnt(0)
    s_cbranch_vccnz rare_a
rare_a_ret:
    v_mfma_f32_16x16x32_bf16 v[132:135], a[224:227], v[64:67], v[32:35]
    ds_read_b128 a[192:195], v16 offset:18432
    v_add_f32 v20, v20, v24
    v_mfma_f32_16x16x32_bf16 v[132:135], a[228:231], v[96:99], v[132:135]
    v_add_f32 v21, v21, v25
    v_add_f32 v22, v22, v26
    v_mfma_f32_16x16x32_bf16 v[132:135], a[232:235], v[128:131], v[132:135]
    v_add_f32 v23, v23, v27
    v_mfma_f32_16x16x32_bf16 v[132:135], a[236:239], v[160:163], v[132:135]
    ds_read_b128 a[196:199], v17 offset:18432
    v_mfma_f32_16x16x32_bf16 v[132:135], a[240:243], v[192:195], v[132:135]
    v_exp_f32 v48, v68
    v_mfma_f32_16x16x32_bf16 v[132:135], a[244:247], v[224:227], v[132:135]
    s_add_u32 m0, s43, 74624
    v_exp_f32 v49, v69
    v_mfma_f32_16x16x32_bf16 v[140:143], a[244:247], v[232:235], v[36:39]
    ds_read_b128 a[200:203], v16 offset:19456
    v_cvt_pk_bf16_f32 v196, v48, v49
    v_mfma_f32_16x16x32_bf16 v[140:143], a[240:243], v[200:203], v[140:143]
    buffer_load_dwordx4 v6, s[16:19], s40 offen offset:128 lds
    v_mfma_f32_16x16x32_bf16 v[140:143], a[236:239], v[168:171], v[140:143]
    v_exp_f32 v50, v70
    v_mfma_f32_16x16x32_bf16 v[140:143], a[232:235], v[136:139], v[140:143]
    ds_read_b128 a[204:207], v17 offset:19456
    v_add_f32 v24, v48, v49
    v_mfma_f32_16x16x32_bf16 v[140:143], a[228:231], v[104:107], v[140:143]
    v_exp_f32 v51, v71
    v_mfma_f32_16x16x32_bf16 v[140:143], a[224:227], v[72:75], v[140:143]
    v_exp_f32 v52, v100
    v_mfma_f32_16x16x32_bf16 v[148:151], a[224:227], v[80:83], v[40:43]
    ds_read_b128 a[208:211], v16 offset:20480
    v_add_f32 v24, v24, v50
    v_mfma_f32_16x16x32_bf16 v[148:151], a[228:231], v[112:115], v[148:151]
    v_exp_f32 v53, v101
    v_mfma_f32_16x16x32_bf16 v[148:151], a[232:235], v[144:147], v[148:151]
    v_exp_f32 v54, v102
    v_mfma_f32_16x16x32_bf16 v[148:151], a[236:239], v[176:179], v[148:151]
    ds_read_b128 a[212:215], v17 offset:20480
    v_cvt_pk_bf16_f32 v197, v50, v51
    v_mfma_f32_16x16x32_bf16 v[148:151], a[240:243], v[208:211], v[148:151]
    v_exp_f32 v55, v103
    v_mfma_f32_16x16x32_bf16 v[148:151], a[244:247], v[240:243], v[148:151]
    v_add_f32 v24, v24, v51
    v_add_f32 v24, v24, v52
    v_mfma_f32_16x16x32_bf16 v[156:159], a[244:247], v[248:251], v[44:47]
    v_exp_f32 v48, v76
    v_mfma_f32_16x16x32_bf16 v[156:159], a[240:243], v[216:219], v[156:159]
    s_add_u32 m0, s43, 75520
    v_exp_f32 v49, v77
    v_mfma_f32_16x16x32_bf16 v[156:159], a[236:239], v[184:187], v[156:159]
    buffer_load_dwordx4 v6, s[16:19], s77 offen offset:256 lds
    v_mfma_f32_16x16x32_bf16 v[156:159], a[232:235], v[152:155], v[156:159]
    v_cvt_pk_bf16_f32 v198, v52, v53
    v_add_f32 v24, v24, v53
    v_mfma_f32_16x16x32_bf16 v[156:159], a[228:231], v[120:123], v[156:159]
    v_exp_f32 v50, v78
    v_mfma_f32_16x16x32_bf16 v[156:159], a[224:227], v[88:91], v[156:159]
    s_waitcnt lgkmcnt(0)
    v_add_f32 v24, v24, v54
    v_cvt_pk_bf16_f32 v199, v54, v55
    v_mfma_f32_16x16x32_bf16 v[188:191], a[192:195], v[88:91], v[44:47]
    ds_read_b64_tr_b16 a[224:225], v8 offset:12288
    v_add_f32 v24, v24, v55
    v_mfma_f32_16x16x32_bf16 v[188:191], a[196:199], v[120:123], v[188:191]
    ds_read_b64_tr_b16 a[226:227], v8 offset:18432
    v_cvt_pk_bf16_f32 v204, v48, v49
    v_mfma_f32_16x16x32_bf16 v[188:191], a[200:203], v[152:155], v[188:191]
    v_exp_f32 v51, v79
    v_mfma_f32_16x16x32_bf16 v[188:191], a[204:207], v[184:187], v[188:191]
    ds_read_b64_tr_b16 a[228:229], v9 offset:12288
    v_add_f32 v25, v48, v49
    v_mfma_f32_16x16x32_bf16 v[188:191], a[208:211], v[216:219], v[188:191]
    ds_read_b64_tr_b16 a[230:231], v9 offset:18432
    v_add_f32 v25, v25, v50
    v_mfma_f32_16x16x32_bf16 v[188:191], a[212:215], v[248:251], v[188:191]
    v_exp_f32 v52, v108
    v_mfma_f32_16x16x32_bf16 v[180:183], a[212:215], v[240:243], v[40:43]
    ds_read_b64_tr_b16 a[232:233], v10 offset:12288
    v_cvt_pk_bf16_f32 v205, v50, v51
    v_mfma_f32_16x16x32_bf16 v[180:183], a[208:211], v[208:211], v[180:183]
    ds_read_b64_tr_b16 a[234:235], v10 offset:18432
    v_add_f32 v25, v25, v51
    v_mfma_f32_16x16x32_bf16 v[180:183], a[204:207], v[176:179], v[180:183]
    v_exp_f32 v53, v109
    v_mfma_f32_16x16x32_bf16 v[180:183], a[200:203], v[144:147], v[180:183]
    s_add_u32 m0, s43, 76800
    ds_read_b64_tr_b16 a[236:237], v11 offset:12288
    v_add_f32 v25, v25, v52
    v_mfma_f32_16x16x32_bf16 v[180:183], a[196:199], v[112:115], v[180:183]
    ds_read_b64_tr_b16 a[238:239], v11 offset:18432
    v_cvt_pk_bf16_f32 v206, v52, v53
    v_mfma_f32_16x16x32_bf16 v[180:183], a[192:195], v[80:83], v[180:183]
    buffer_load_dwordx4 v7, s[16:19], s40 offen offset:0 lds
    v_mfma_f32_16x16x32_bf16 v[172:175], a[192:195], v[72:75], v[36:39]
    ds_read_b64_tr_b16 a[240:241], v8 offset:13312
    v_add_f32 v25, v25, v53
    v_mfma_f32_16x16x32_bf16 v[172:175], a[196:199], v[104:107], v[172:175]
    ds_read_b64_tr_b16 a[242:243], v8 offset:19456
    v_add_u32 v16, s43, v18
    v_mfma_f32_16x16x32_bf16 v[172:175], a[200:203], v[136:139], v[172:175]
    v_exp_f32 v54, v110
    v_mfma_f32_16x16x32_bf16 v[172:175], a[204:207], v[168:171], v[172:175]
    ds_read_b64_tr_b16 a[244:245], v9 offset:13312
    v_add_f32 v25, v25, v54
    v_mfma_f32_16x16x32_bf16 v[172:175], a[208:211], v[200:203], v[172:175]
    ds_read_b64_tr_b16 a[246:247], v9 offset:19456
    v_add_u32 v17, s43, v19
    v_mfma_f32_16x16x32_bf16 v[172:175], a[212:215], v[232:235], v[172:175]
    v_exp_f32 v55, v111
    v_mfma_f32_16x16x32_bf16 v[164:167], a[212:215], v[224:227], v[32:35]
    v_exp_f32 v48, v84
    v_mfma_f32_16x16x32_bf16 v[164:167], a[208:211], v[192:195], v[164:167]
    v_exp_f32 v49, v85
    v_mfma_f32_16x16x32_bf16 v[164:167], a[204:207], v[160:163], v[164:167]
    v_exp_f32 v50, v86
    v_mfma_f32_16x16x32_bf16 v[164:167], a[200:203], v[128:131], v[164:167]
    v_exp_f32 v51, v87
    v_mfma_f32_16x16x32_bf16 v[164:167], a[196:199], v[96:99], v[164:167]
    v_cvt_pk_bf16_f32 v207, v54, v55
    v_add_f32 v25, v25, v55
    v_mfma_f32_16x16x32_bf16 v[164:167], a[192:195], v[64:67], v[164:167]
    s_waitcnt lgkmcnt(0)
    v_exp_f32 v52, v116
    v_mfma_f32_16x16x32_bf16 a[0:3], a[224:227], v[228:231], a[0:3]
    s_add_u32 m0, s43, 77696
    ds_read_b64_tr_b16 a[192:193], v10 offset:13312
    v_cvt_pk_bf16_f32 v212, v48, v49
    v_mfma_f32_16x16x32_bf16 a[16:19], a[228:231], v[228:231], a[16:19]
    ds_read_b64_tr_b16 a[194:195], v10 offset:19456
    v_add_f32 v26, v48, v49
    v_mfma_f32_16x16x32_bf16 a[32:35], a[232:235], v[228:231], a[32:35]
    buffer_load_dwordx4 v7, s[16:19], s40 offen offset:128 lds
    v_mfma_f32_16x16x32_bf16 a[48:51], a[236:239], v[228:231], a[48:51]
    ds_read_b64_tr_b16 a[196:197], v11 offset:13312
    v_add_f32 v26, v26, v50
    v_mfma_f32_16x16x32_bf16 a[64:67], a[240:243], v[228:231], a[64:67]
    ds_read_b64_tr_b16 a[198:199], v11 offset:19456
    v_cvt_pk_bf16_f32 v213, v50, v51
    v_mfma_f32_16x16x32_bf16 a[80:83], a[244:247], v[228:231], a[80:83]
    v_exp_f32 v53, v117
    v_mfma_f32_16x16x32_bf16 a[84:87], a[244:247], v[236:239], a[84:87]
    ds_read_b64_tr_b16 a[200:201], v8 offset:14336
    v_add_f32 v26, v26, v51
    v_mfma_f32_16x16x32_bf16 a[68:71], a[240:243], v[236:239], a[68:71]
    ds_read_b64_tr_b16 a[202:203], v8 offset:20480
    v_add_f32 v26, v26, v52
    v_mfma_f32_16x16x32_bf16 a[52:55], a[236:239], v[236:239], a[52:55]
    v_exp_f32 v54, v118
    v_mfma_f32_16x16x32_bf16 a[36:39], a[232:235], v[236:239], a[36:39]
    ds_read_b64_tr_b16 a[204:205], v9 offset:14336
    v_cvt_pk_bf16_f32 v214, v52, v53
    v_mfma_f32_16x16x32_bf16 a[20:23], a[228:231], v[236:239], a[20:23]
    ds_read_b64_tr_b16 a[206:207], v9 offset:20480
    v_add_f32 v26, v26, v53
    v_mfma_f32_16x16x32_bf16 a[4:7], a[224:227], v[236:239], a[4:7]
    v_exp_f32 v55, v119
    v_mfma_f32_16x16x32_bf16 a[8:11], a[224:227], v[244:247], a[8:11]
    ds_read_b64_tr_b16 a[208:209], v10 offset:14336
    v_add_f32 v26, v26, v54
    v_mfma_f32_16x16x32_bf16 a[24:27], a[228:231], v[244:247], a[24:27]
    s_add_u32 m0, s43, 78592
    ds_read_b64_tr_b16 a[210:211], v10 offset:20480
    v_cvt_pk_bf16_f32 v215, v54, v55
    v_mfma_f32_16x16x32_bf16 a[40:43], a[232:235], v[244:247], a[40:43]
    buffer_load_dwordx4 v7, s[16:19], s77 offen offset:256 lds
    v_mfma_f32_16x16x32_bf16 a[56:59], a[236:239], v[244:247], a[56:59]
    ds_read_b64_tr_b16 a[212:213], v11 offset:14336
    v_add_f32 v26, v26, v55
    v_mfma_f32_16x16x32_bf16 a[72:75], a[240:243], v[244:247], a[72:75]
    s_add_u32 s40, s40, 24576
    ds_read_b64_tr_b16 a[214:215], v11 offset:20480
    v_max3_f32 v29, v24, v25, v26
    v_mfma_f32_16x16x32_bf16 a[88:91], a[244:247], v[244:247], a[88:91]
    v_exp_f32 v48, v92
    v_mfma_f32_16x16x32_bf16 a[92:95], a[244:247], v[252:255], a[92:95]
    v_exp_f32 v49, v93
    v_mfma_f32_16x16x32_bf16 a[76:79], a[240:243], v[252:255], a[76:79]
    v_exp_f32 v50, v94
    v_mfma_f32_16x16x32_bf16 a[60:63], a[236:239], v[252:255], a[60:63]
    v_exp_f32 v51, v95
    v_mfma_f32_16x16x32_bf16 a[44:47], a[232:235], v[252:255], a[44:47]
    s_waitcnt vmcnt(12)
    v_exp_f32 v52, v124
    v_mfma_f32_16x16x32_bf16 a[28:31], a[228:231], v[252:255], a[28:31]
    s_barrier
    v_mfma_f32_16x16x32_bf16 a[12:15], a[224:227], v[252:255], a[12:15]
    s_waitcnt lgkmcnt(0)
    v_exp_f32 v53, v125
    v_mfma_f32_16x16x32_bf16 a[108:111], a[192:195], v[252:255], a[108:111]
    ds_read_b128 a[224:227], v16 offset:0
    v_cvt_pk_bf16_f32 v220, v48, v49
    v_mfma_f32_16x16x32_bf16 a[124:127], a[196:199], v[252:255], a[124:127]
    v_add_f32 v27, v48, v49
    v_mfma_f32_16x16x32_bf16 a[140:143], a[200:203], v[252:255], a[140:143]
    v_exp_f32 v54, v126
    v_mfma_f32_16x16x32_bf16 a[156:159], a[204:207], v[252:255], a[156:159]
    ds_read_b128 a[228:231], v17 offset:0
    v_add_f32 v27, v27, v50
    v_mfma_f32_16x16x32_bf16 a[172:175], a[208:211], v[252:255], a[172:175]
    v_exp_f32 v55, v127
    v_mfma_f32_16x16x32_bf16 a[188:191], a[212:215], v[252:255], a[188:191]
    v_cvt_pk_bf16_f32 v221, v50, v51
    v_add_f32 v27, v27, v51
    v_mfma_f32_16x16x32_bf16 a[184:187], a[212:215], v[244:247], a[184:187]
    ds_read_b128 a[232:235], v16 offset:1024
    v_add_f32 v27, v27, v52
    v_mfma_f32_16x16x32_bf16 a[168:171], a[208:211], v[244:247], a[168:171]
    v_cvt_pk_bf16_f32 v222, v52, v53
    v_mfma_f32_16x16x32_bf16 a[152:155], a[204:207], v[244:247], a[152:155]
    v_add_f32 v27, v27, v53
    v_mfma_f32_16x16x32_bf16 a[136:139], a[200:203], v[244:247], a[136:139]
    ds_read_b128 a[236:239], v17 offset:1024
    v_add_f32 v27, v27, v54
    v_mfma_f32_16x16x32_bf16 a[120:123], a[196:199], v[244:247], a[120:123]
    buffer_load_dword a216, v2, s[28:31], s6 offen
    v_mfma_f32_16x16x32_bf16 a[104:107], a[192:195], v[244:247], a[104:107]
    s_add_u32 s6, s6, 1536
    v_cvt_pk_bf16_f32 v223, v54, v55
    v_mfma_f32_16x16x32_bf16 a[100:103], a[192:195], v[236:239], a[100:103]
    s_mov_b32 s44, s41
    ds_read_b128 a[240:243], v16 offset:2048
    v_add_f32 v27, v27, v55
    v_mfma_f32_16x16x32_bf16 a[116:119], a[196:199], v[236:239], a[116:119]
    s_mov_b32 s41, s42
    v_max_f32 v29, v29, v27
    v_mfma_f32_16x16x32_bf16 a[132:135], a[200:203], v[236:239], a[132:135]
    s_mov_b32 s42, s43
    v_cmp_nle_f32 vcc, v29, v30
    s_mov_b32 s43, s44
    v_mfma_f32_16x16x32_bf16 a[148:151], a[204:207], v[236:239], a[148:151]
    s_sub_u32 s45, s45, 1
    ds_read_b128 a[244:247], v17 offset:2048
    v_mfma_f32_16x16x32_bf16 a[164:167], a[208:211], v[236:239], a[164:167]
    v_mfma_f32_16x16x32_bf16 a[180:183], a[212:215], v[236:239], a[180:183]
    v_mfma_f32_16x16x32_bf16 a[176:179], a[212:215], v[228:231], a[176:179]
    v_mfma_f32_16x16x32_bf16 a[160:163], a[208:211], v[228:231], a[160:163]
    v_mfma_f32_16x16x32_bf16 a[144:147], a[204:207], v[228:231], a[144:147]
    v_mfma_f32_16x16x32_bf16 a[128:131], a[200:203], v[228:231], a[128:131]
    v_mfma_f32_16x16x32_bf16 a[112:115], a[196:199], v[228:231], a[112:115]
    s_waitcnt lgkmcnt(0)
    v_mfma_f32_16x16x32_bf16 a[96:99], a[192:195], v[228:231], a[96:99]
    s_cbranch_vccnz rare_b
rare_b_ret:
    s_cbranch_scc0 at_loop
tail_code:
    v_add_u32 v8, s41, v12
    v_add_u32 v9, s41, v13
    v_add_u32 v10, s41, v14
    v_add_u32 v11, s41, v15
    s_waitcnt lgkmcnt(0)
    ds_read_b64_tr_b16 a[192:193], v8 offset:0
    ds_read_b64_tr_b16 a[194:195], v8 offset:6144
    ds_read_b64_tr_b16 a[196:197], v9 offset:0
    ds_read_b64_tr_b16 a[198:199], v9 offset:6144
    ds_read_b64_tr_b16 a[200:201], v10 offset:0
    ds_read_b64_tr_b16 a[202:203], v10 offset:6144
    ds_read_b64_tr_b16 a[204:205], v11 offset:0
    ds_read_b64_tr_b16 a[206:207], v11 offset:6144
    s_waitcnt lgkmcnt(4)
    v_mfma_f32_16x16x32_bf16 a[0:3], a[192:195], v[196:199], a[0:3]
    s_waitcnt vmcnt(26)
    ds_read_b64_tr_b16 a[208:209], v8 offset:1024
    v_cmp_ne_u32 vcc, s7, v61
    v_mfma_f32_16x16x32_bf16 a[16:19], a[196:199], v[196:199], a[16:19]
    s_and_b32 s59, s51, 1
    ds_read_b64_tr_b16 a[210:211], v8 offset:7168
    v_add_f32 v20, v20, v24
    v_mfma_f32_16x16x32_bf16 a[20:23], a[196:199], v[204:207], a[20:23]
    s_cbranch_vccnz spin_gu
spin_gu_ret:
    v_add_f32 v21, v21, v25
    v_mfma_f32_16x16x32_bf16 a[4:7], a[192:195], v[204:207], a[4:7]
    s_lshl_b32 s61, s47, 10
    v_add_f32 v22, v22, v26
    v_add_f32 v23, v23, v27
    v_mfma_f32_16x16x32_bf16 a[8:11], a[192:195], v[212:215], a[8:11]
    s_add_u32 s61, s61, 3276800
    ds_read_b64_tr_b16 a[212:213], v9 offset:1024
    s_add_u32 s56, s3, 0
    v_mfma_f32_16x16x32_bf16 a[24:27], a[196:199], v[212:215], a[24:27]
    s_min_u32 s56, s56, 9
    ds_read_b64_tr_b16 a[214:215], v9 offset:7168
    s_mul_i32 s57, s56, 24576
    v_mfma_f32_16x16x32_bf16 a[28:31], a[196:199], v[220:223], a[28:31]
    s_add_u32 s57, s57, s61
    v_exp_f32 v48, v132
    v_mfma_f32_16x16x32_bf16 a[12:15], a[192:195], v[220:223], a[12:15]
    s_waitcnt lgkmcnt(4)
    v_exp_f32 v49, v133
    v_mfma_f32_16x16x32_bf16 a[44:47], a[200:203], v[220:223], a[44:47]
    s_lshl_b32 s56, s56, 10
    ds_read_b64_tr_b16 a[192:193], v10 offset:1024
    v_cvt_pk_bf16_f32 v228, v48, v49
    v_mfma_f32_16x16x32_bf16 a[60:63], a[204:207], v[220:223], a[60:63]
    s_add_u32 m0, s56, 147456
    ds_read_b64_tr_b16 a[194:195], v10 offset:7168
    v_add_f32 v24, v48, v49
    v_mfma_f32_16x16x32_bf16 a[56:59], a[204:207], v[212:215], a[56:59]
    buffer_load_dwordx4 v28, s[24:27], s57 offen sc1 lds
    v_mfma_f32_16x16x32_bf16 a[40:43], a[200:203], v[212:215], a[40:43]
    s_add_u32 s56, s3, 4
    v_exp_f32 v50, v134
    v_mfma_f32_16x16x32_bf16 a[36:39], a[200:203], v[204:207], a[36:39]
    s_min_u32 s56, s56, 9
    ds_read_b64_tr_b16 a[196:197], v11 offset:1024
    v_add_f32 v24, v24, v50
    v_mfma_f32_16x16x32_bf16 a[52:55], a[204:207], v[204:207], a[52:55]
    s_mul_i32 s57, s56, 24576
    ds_read_b64_tr_b16 a[198:199], v11 offset:7168
    s_add_u32 s57, s57, s61
    v_mfma_f32_16x16x32_bf16 a[48:51], a[204:207], v[196:199], a[48:51]
    s_lshl_b32 s56, s56, 10
    v_exp_f32 v51, v135
    v_mfma_f32_16x16x32_bf16 a[32:35], a[200:203], v[196:199], a[32:35]
    s_waitcnt lgkmcnt(4)
    v_exp_f32 v52, v164
    v_mfma_f32_16x16x32_bf16 a[64:67], a[208:211], v[196:199], a[64:67]
    s_add_u32 m0, s56, 147456
    ds_read_b64_tr_b16 a[200:201], v8 offset:2048
    v_cvt_pk_bf16_f32 v229, v50, v51
    v_mfma_f32_16x16x32_bf16 a[80:83], a[212:215], v[196:199], a[80:83]
    s_lshl_b32 s59, s59, 6
    ds_read_b64_tr_b16 a[202:203], v8 offset:8192
    v_add_f32 v24, v24, v51
    v_mfma_f32_16x16x32_bf16 a[84:87], a[212:215], v[204:207], a[84:87]
    buffer_load_dwordx4 v28, s[24:27], s57 offen sc1 lds
    v_mfma_f32_16x16x32_bf16 a[68:71], a[208:211], v[204:207], a[68:71]
    s_add_u32 s56, s3, 8
    v_exp_f32 v53, v165
    v_mfma_f32_16x16x32_bf16 a[72:75], a[208:211], v[212:215], a[72:75]
    s_min_u32 s56, s56, 9
    ds_read_b64_tr_b16 a[204:205], v9 offset:2048
    v_add_f32 v24, v24, v52
    v_mfma_f32_16x16x32_bf16 a[88:91], a[212:215], v[212:215], a[88:91]
    s_mul_i32 s57, s56, 24576
    ds_read_b64_tr_b16 a[206:207], v9 offset:8192
    v_cvt_pk_bf16_f32 v230, v52, v53
    v_mfma_f32_16x16x32_bf16 a[92:95], a[212:215], v[220:223], a[92:95]
    s_add_u32 s57, s57, s61
    v_exp_f32 v54, v166
    v_mfma_f32_16x16x32_bf16 a[76:79], a[208:211], v[220:223], a[76:79]
    s_waitcnt lgkmcnt(4)
    v_exp_f32 v55, v167
    v_mfma_f32_16x16x32_bf16 a[108:111], a[192:195], v[220:223], a[108:111]
    s_lshl_b32 s56, s56, 10
    ds_read_b64_tr_b16 a[208:209], v10 offset:2048
    v_add_f32 v24, v24, v53
    v_mfma_f32_16x16x32_bf16 a[124:127], a[196:199], v[220:223], a[124:127]
    s_add_u32 m0, s56, 147456
    ds_read_b64_tr_b16 a[210:211], v10 offset:8192
    v_add_f32 v24, v24, v54
    v_mfma_f32_16x16x32_bf16 a[120:123], a[196:199], v[212:215], a[120:123]
    buffer_load_dwordx4 v28, s[24:27], s57 offen sc1 lds
    v_mfma_f32_16x16x32_bf16 a[104:107], a[192:195], v[212:215], a[104:107]
    s_sub_u32 s44, s49, 73728
    v_add_u32 v12, s44, v12
    v_add_u32 v13, s44, v13
    v_mfma_f32_16x16x32_bf16 a[100:103], a[192:195], v[204:207], a[100:103]
    ds_read_b64_tr_b16 a[212:213], v11 offset:2048
    v_add_u32 v14, s44, v14
    v_mfma_f32_16x16x32_bf16 a[116:119], a[196:199], v[204:207], a[116:119]
    ds_read_b64_tr_b16 a[214:215], v11 offset:8192
    v_add_u32 v15, s44, v15
    v_mfma_f32_16x16x32_bf16 a[112:115], a[196:199], v[196:199], a[112:115]
    s_mov_b32 s39, s59
    v_exp_f32 v48, v140
    v_mfma_f32_16x16x32_bf16 a[96:99], a[192:195], v[196:199], a[96:99]
    s_waitcnt lgkmcnt(4)
    v_exp_f32 v49, v141
    v_mfma_f32_16x16x32_bf16 a[128:131], a[200:203], v[196:199], a[128:131]
    s_and_b32 s59, s3, 1
    ds_read_b64_tr_b16 a[192:193], v8 offset:12288
    v_cvt_pk_bf16_f32 v231, v54, v55
    v_mfma_f32_16x16x32_bf16 a[144:147], a[204:207], v[196:199], a[144:147]
    s_mul_i32 s59, s59, 20480
    ds_read_b64_tr_b16 a[194:195], v8 offset:18432
    v_add_f32 v24, v24, v55
    v_mfma_f32_16x16x32_bf16 a[148:151], a[204:207], v[204:207], a[148:151]
    s_lshl_b32 s36, s3, 10
    v_exp_f32 v50, v142
    v_mfma_f32_16x16x32_bf16 a[132:135], a[200:203], v[204:207], a[132:135]
    s_add_u32 s60, s51, 0
    v_exp_f32 v51, v143
    v_mfma_f32_16x16x32_bf16 a[136:139], a[200:203], v[212:215], a[136:139]
    s_and_b32 s60, s60, 3
    ds_read_b64_tr_b16 a[196:197], v9 offset:12288
    v_cvt_pk_bf16_f32 v236, v48, v49
    v_mfma_f32_16x16x32_bf16 a[152:155], a[204:207], v[212:215], a[152:155]
    s_mul_i32 s60, s60, 245760
    ds_read_b64_tr_b16 a[198:199], v9 offset:18432
    v_add_f32 v25, v48, v49
    v_mfma_f32_16x16x32_bf16 a[156:159], a[204:207], v[220:223], a[156:159]
    s_add_u32 s32, s60, s59
    v_exp_f32 v52, v172
    v_mfma_f32_16x16x32_bf16 a[140:143], a[200:203], v[220:223], a[140:143]
    s_waitcnt lgkmcnt(4)
    v_exp_f32 v53, v173
    v_mfma_f32_16x16x32_bf16 a[172:175], a[208:211], v[220:223], a[172:175]
    s_add_u32 s60, s51, 1
    ds_read_b64_tr_b16 a[200:201], v10 offset:12288
    v_add_f32 v25, v25, v50
    v_mfma_f32_16x16x32_bf16 a[188:191], a[212:215], v[220:223], a[188:191]
    s_and_b32 s60, s60, 3
    ds_read_b64_tr_b16 a[202:203], v10 offset:18432
    v_cvt_pk_bf16_f32 v237, v50, v51
    v_mfma_f32_16x16x32_bf16 a[184:187], a[212:215], v[212:215], a[184:187]
    s_mul_i32 s60, s60, 245760
    v_exp_f32 v54, v174
    v_mfma_f32_16x16x32_bf16 a[168:171], a[208:211], v[212:215], a[168:171]
    s_add_u32 s33, s60, s59
    v_exp_f32 v55, v175
    v_mfma_f32_16x16x32_bf16 a[164:167], a[208:211], v[204:207], a[164:167]
    s_add_u32 s60, s51, 2
    ds_read_b64_tr_b16 a[204:205], v11 offset:12288
    v_add_f32 v25, v25, v51
    v_mfma_f32_16x16x32_bf16 a[180:183], a[212:215], v[204:207], a[180:183]
    s_and_b32 s60, s60, 3
    ds_read_b64_tr_b16 a[206:207], v11 offset:18432
    v_add_f32 v25, v25, v52
    v_mfma_f32_16x16x32_bf16 a[176:179], a[212:215], v[196:199], a[176:179]
    s_mul_i32 s60, s60, 245760
    v_exp_f32 v48, v148
    v_mfma_f32_16x16x32_bf16 a[160:163], a[208:211], v[196:199], a[160:163]
    s_waitcnt lgkmcnt(4)
    v_exp_f32 v49, v149
    v_cvt_pk_bf16_f32 v238, v52, v53
    v_cvt_pk_bf16_f32 v239, v54, v55
    v_add_f32 v25, v25, v53
    v_add_f32 v25, v25, v54
    v_add_f32 v25, v25, v55
    v_cvt_pk_bf16_f32 v244, v48, v49
    v_exp_f32 v50, v150
    v_exp_f32 v51, v151
    s_add_u32 s34, s60, s59
    v_cvt_pk_bf16_f32 v245, v50, v51
    v_exp_f32 v52, v180
    v_exp_f32 v53, v181
    s_add_u32 s60, s51, 3
    v_cvt_pk_bf16_f32 v246, v52, v53
    v_exp_f32 v54, v182
    v_exp_f32 v55, v183
    s_and_b32 s60, s60, 3
    v_cvt_pk_bf16_f32 v247, v54, v55
    v_add_f32 v26, v48, v49
    v_add_f32 v26, v26, v50
    v_add_f32 v26, v26, v51
    v_add_f32 v26, v26, v52
    v_add_f32 v26, v26, v53
    v_add_f32 v26, v26, v54
    v_add_f32 v26, v26, v55
    v_max3_f32 v29, v24, v25, v26
    v_exp_f32 v48, v156
    v_exp_f32 v49, v157
    s_mul_i32 s60, s60, 245760
    v_cvt_pk_bf16_f32 v252, v48, v49
    v_exp_f32 v50, v158
    v_exp_f32 v51, v159
    s_add_u32 s35, s60, s59
    v_cvt_pk_bf16_f32 v253, v50, v51
    v_exp_f32 v52, v188
    v_exp_f32 v53, v189
    s_add_u32 s38, s33, 0
    v_cvt_pk_bf16_f32 v254, v52, v53
    v_exp_f32 v54, v190
    v_exp_f32 v55, v191
    s_add_u32 s57, s34, 0
    v_cvt_pk_bf16_f32 v255, v54, v55
    v_add_f32 v27, v48, v49
    v_add_f32 v27, v27, v50
    v_add_f32 v27, v27, v51
    v_add_f32 v27, v27, v52
    v_add_f32 v27, v27, v53
    v_add_f32 v27, v27, v54
    v_add_f32 v27, v27, v55
    v_max_f32 v29, v29, v27
    v_cmp_nle_f32 vcc, v29, v30
    s_cbranch_vccnz rare_e
rare_e_ret:
    v_mfma_f32_16x16x32_bf16 a[0:3], a[192:195], v[228:231], a[0:3]
    s_cmp_lt_u32 s3, 2
    s_cselect_b32 s38, s38, s57
    ds_read_b64_tr_b16 a[208:209], v8 offset:13312
    v_mfma_f32_16x16x32_bf16 a[16:19], a[196:199], v[228:231], a[16:19]
    s_add_u32 s76, s38, s63
    ds_read_b64_tr_b16 a[210:211], v8 offset:19456
    v_add_f32 v20, v20, v24
    v_mfma_f32_16x16x32_bf16 a[20:23], a[196:199], v[236:239], a[20:23]
    s_add_u32 m0, s49, 24576
    v_add_f32 v21, v21, v25
    v_add_f32 v22, v22, v26
    v_mfma_f32_16x16x32_bf16 a[4:7], a[192:195], v[236:239], a[4:7]
    buffer_load_dwordx4 v4, s[12:15], s38 offen offset:0 lds
    v_mfma_f32_16x16x32_bf16 a[8:11], a[192:195], v[244:247], a[8:11]
    s_add_u32 m0, s49, 25472
    ds_read_b64_tr_b16 a[212:213], v9 offset:13312
    v_add_f32 v23, v23, v27
    v_mfma_f32_16x16x32_bf16 a[24:27], a[196:199], v[244:247], a[24:27]
    ds_read_b64_tr_b16 a[214:215], v9 offset:19456
    v_mov_b32 v56, v20
    v_mfma_f32_16x16x32_bf16 a[28:31], a[196:199], v[252:255], a[28:31]
    buffer_load_dwordx4 v4, s[12:15], s38 offen offset:128 lds
    v_mfma_f32_16x16x32_bf16 a[12:15], a[192:195], v[252:255], a[12:15]
    s_waitcnt lgkmcnt(4)
    v_permlane16_swap_b32 v20, v56
    v_mfma_f32_16x16x32_bf16 a[44:47], a[200:203], v[252:255], a[44:47]
    s_add_u32 m0, s49, 26368
    ds_read_b64_tr_b16 a[192:193], v10 offset:13312
    v_add_f32 v20, v20, v56
    v_mfma_f32_16x16x32_bf16 a[60:63], a[204:207], v[252:255], a[60:63]
    ds_read_b64_tr_b16 a[194:195], v10 offset:19456
    v_mov_b32 v56, v20
    v_mfma_f32_16x16x32_bf16 a[56:59], a[204:207], v[244:247], a[56:59]
    buffer_load_dwordx4 v4, s[12:15], s76 offen offset:256 lds
    v_mfma_f32_16x16x32_bf16 a[40:43], a[200:203], v[244:247], a[40:43]
    s_add_u32 m0, s49, 27648
    v_permlane32_swap_b32 v20, v56
    v_mfma_f32_16x16x32_bf16 a[36:39], a[200:203], v[236:239], a[36:39]
    s_lshl_b32 s11, s54, 16
    ds_read_b64_tr_b16 a[196:197], v11 offset:13312
    v_add_f32 v20, v20, v56
    v_mfma_f32_16x16x32_bf16 a[52:55], a[204:207], v[236:239], a[52:55]
    s_and_b32 s72, s3, 1
    ds_read_b64_tr_b16 a[198:199], v11 offset:19456
    v_mov_b32 v57, v21
    v_mfma_f32_16x16x32_bf16 a[48:51], a[204:207], v[228:231], a[48:51]
    buffer_load_dwordx4 v5, s[12:15], s38 offen offset:0 lds
    v_mfma_f32_16x16x32_bf16 a[32:35], a[200:203], v[228:231], a[32:35]
    s_waitcnt lgkmcnt(4)
    v_rcp_f32 v20, v20
    v_mfma_f32_16x16x32_bf16 a[64:67], a[208:211], v[228:231], a[64:67]
    s_add_u32 m0, s49, 28544
    ds_read_b64_tr_b16 a[200:201], v8 offset:14336
    v_mov_b32 v58, v22
    v_mfma_f32_16x16x32_bf16 a[80:83], a[212:215], v[228:231], a[80:83]
    s_lshl_b32 s72, s72, 14
    ds_read_b64_tr_b16 a[202:203], v8 offset:20480
    v_mov_b32 v59, v23
    v_mfma_f32_16x16x32_bf16 a[84:87], a[212:215], v[236:239], a[84:87]
    s_or_b32 s11, s11, s72
    v_permlane16_swap_b32 v21, v57
    v_mfma_f32_16x16x32_bf16 a[68:71], a[208:211], v[236:239], a[68:71]
    buffer_load_dwordx4 v5, s[12:15], s38 offen offset:128 lds
    v_mfma_f32_16x16x32_bf16 a[72:75], a[208:211], v[244:247], a[72:75]
    s_add_u32 m0, s49, 29440
    ds_read_b64_tr_b16 a[204:205], v9 offset:14336
    v_add_f32 v21, v21, v57
    v_mfma_f32_16x16x32_bf16 a[88:91], a[212:215], v[244:247], a[88:91]
    s_lshr_b32 s73, s93, 8
    ds_read_b64_tr_b16 a[206:207], v9 offset:20480
    v_mov_b32 v57, v21
    v_mfma_f32_16x16x32_bf16 a[92:95], a[212:215], v[252:255], a[92:95]
pg_7:
    s_cbranch_execz pg_11
    s_add_u32 s8, s51, 1
    v_permlane32_swap_b32 v21, v57
    v_mfma_f32_16x16x32_bf16 a[76:79], a[208:211], v[252:255], a[76:79]
    s_waitcnt lgkmcnt(4)
    buffer_load_dwordx4 v5, s[12:15], s76 offen offset:256 lds
    v_mfma_f32_16x16x32_bf16 a[108:111], a[192:195], v[252:255], a[108:111]
    s_add_u32 s38, s35, 0
    ds_read_b64_tr_b16 a[208:209], v10 offset:14336
    v_add_f32 v21, v21, v57
    v_mfma_f32_16x16x32_bf16 a[124:127], a[196:199], v[252:255], a[124:127]
    s_add_u32 s57, s33, 40960
    ds_read_b64_tr_b16 a[210:211], v10 offset:20480
    v_add_u32 v8, 49152, v12
    v_mfma_f32_16x16x32_bf16 a[120:123], a[196:199], v[244:247], a[120:123]
    s_cmp_lt_u32 s3, 2
    s_cselect_b32 s38, s38, s57
    v_add_u32 v9, 49152, v13
    v_mfma_f32_16x16x32_bf16 a[104:107], a[192:195], v[244:247], a[104:107]
    s_add_u32 s76, s38, s63
    v_rcp_f32 v21, v21
    v_mfma_f32_16x16x32_bf16 a[100:103], a[192:195], v[236:239], a[100:103]
    s_add_u32 m0, s49, 73728
    ds_read_b64_tr_b16 a[212:213], v11 offset:14336
    v_add_u32 v10, 49152, v14
    v_mfma_f32_16x16x32_bf16 a[116:119], a[196:199], v[236:239], a[116:119]
    s_waitcnt vmcnt(29)
    ds_read_b64_tr_b16 a[214:215], v11 offset:20480
    v_accvgpr_read_b32 v64, a0
    v_mfma_f32_16x16x32_bf16 a[112:115], a[196:199], v[228:231], a[112:115]
    s_barrier
    v_mfma_f32_16x16x32_bf16 a[96:99], a[192:195], v[228:231], a[96:99]
    s_waitcnt lgkmcnt(4)
    buffer_load_dwordx4 v4, s[12:15], s38 offen offset:0 lds
    v_mfma_f32_16x16x32_bf16 a[128:131], a[200:203], v[228:231], a[128:131]
    s_add_u32 m0, s49, 74624
    ds_read_b64_tr_b16 a[192:193], v8 offset:0
    v_add_u32 v11, 49152, v15
    v_mfma_f32_16x16x32_bf16 a[144:147], a[204:207], v[228:231], a[144:147]
    s_and_b32 s8, s8, 3
    ds_read_b64_tr_b16 a[194:195], v8 offset:6144
    v_xor_b32 v18, s39, v8
    v_mfma_f32_16x16x32_bf16 a[148:151], a[204:207], v[236:239], a[148:151]
    buffer_load_dwordx4 v4, s[12:15], s38 offen offset:128 lds
    v_mfma_f32_16x16x32_bf16 a[132:135], a[200:203], v[236:239], a[132:135]
    s_add_u32 m0, s49, 75520
    v_permlane16_swap_b32 v22, v58
    v_mfma_f32_16x16x32_bf16 a[136:139], a[200:203], v[244:247], a[136:139]
    s_lshr_b32 s72, s73, s8
    ds_read_b64_tr_b16 a[196:197], v9 offset:0
    v_add_f32 v22, v22, v58
    v_mfma_f32_16x16x32_bf16 a[152:155], a[204:207], v[244:247], a[152:155]
    s_and_b32 s72, s72, 0x2000
    ds_read_b64_tr_b16 a[198:199], v9 offset:6144
    v_mov_b32 v58, v22
    v_mfma_f32_16x16x32_bf16 a[156:159], a[204:207], v[252:255], a[156:159]
    buffer_load_dwordx4 v4, s[12:15], s76 offen offset:256 lds
    v_mfma_f32_16x16x32_bf16 a[140:143], a[200:203], v[252:255], a[140:143]
    s_waitcnt lgkmcnt(4)
    v_permlane32_swap_b32 v22, v58
    v_mfma_f32_16x16x32_bf16 a[172:175], a[208:211], v[252:255], a[172:175]
    s_add_u32 m0, s49, 76800
    ds_read_b64_tr_b16 a[200:201], v10 offset:0
    v_add_f32 v22, v22, v58
    v_mfma_f32_16x16x32_bf16 a[188:191], a[212:215], v[252:255], a[188:191]
    s_mul_i32 s8, s8, 0x202000
    ds_read_b64_tr_b16 a[202:203], v10 offset:6144
    v_xor_b32 v19, s39, v9
    v_mfma_f32_16x16x32_bf16 a[184:187], a[212:215], v[244:247], a[184:187]
    buffer_load_dwordx4 v5, s[12:15], s38 offen offset:0 lds
    v_mfma_f32_16x16x32_bf16 a[168:171], a[208:211], v[244:247], a[168:171]
    s_add_u32 m0, s49, 77696
    v_rcp_f32 v22, v22
    v_mfma_f32_16x16x32_bf16 a[164:167], a[208:211], v[236:239], a[164:167]
    s_xor_b32 s8, s8, s72
    ds_read_b64_tr_b16 a[204:205], v11 offset:0
    v_accvgpr_read_b32 v65, a1
    v_mfma_f32_16x16x32_bf16 a[180:183], a[212:215], v[236:239], a[180:183]
    s_and_b32 s8, s8, 6299648
    ds_read_b64_tr_b16 a[206:207], v11 offset:6144
    v_accvgpr_read_b32 v66, a2
    v_accvgpr_read_b32 v24, a18
    v_mul_f32 v24, v20, v24
    v_accvgpr_read_b32 v25, a19
    v_mul_f32 v25, v20, v25
    v_mul_f32 v66, v20, v66
    v_accvgpr_read_b32 v67, a3
    v_mul_f32 v67, v20, v67
    v_mul_f32 v64, v20, v64
    v_mul_f32 v65, v20, v65
    v_cvt_pk_bf16_f32 v64, v64, v65
    v_cvt_pk_bf16_f32 v65, v66, v67
    v_accvgpr_read_b32 v66, a16
    v_mul_f32 v66, v20, v66
    v_accvgpr_read_b32 v67, a17
    v_mul_f32 v67, v20, v67
    v_cvt_pk_bf16_f32 v66, v66, v67
    v_cvt_pk_bf16_f32 v67, v24, v25
    v_accvgpr_read_b32 v26, a22
    v_mul_f32 v26, v21, v26
    v_accvgpr_read_b32 v27, a23
    v_mul_f32 v27, v21, v27
    v_accvgpr_read_b32 v74, a6
    v_mul_f32 v74, v21, v74
    v_accvgpr_read_b32 v75, a7
    v_mul_f32 v75, v21, v75
    v_accvgpr_read_b32 v72, a4
    v_mul_f32 v72, v21, v72
    v_accvgpr_read_b32 v73, a5
    v_mul_f32 v73, v21, v73
    v_cvt_pk_bf16_f32 v72, v72, v73
    v_cvt_pk_bf16_f32 v73, v74, v75
    v_accvgpr_read_b32 v74, a20
    v_mul_f32 v74, v21, v74
    v_accvgpr_read_b32 v75, a21
    v_mul_f32 v75, v21, v75
    v_cvt_pk_bf16_f32 v74, v74, v75
    v_cvt_pk_bf16_f32 v75, v26, v27
    v_accvgpr_read_b32 v30, a26
    v_mul_f32 v30, v22, v30
    v_accvgpr_read_b32 v31, a27
    v_mul_f32 v31, v22, v31
    v_accvgpr_read_b32 v82, a10
    v_mul_f32 v82, v22, v82
    v_accvgpr_read_b32 v83, a11
    v_mul_f32 v83, v22, v83
    v_accvgpr_read_b32 v80, a8
    v_mul_f32 v80, v22, v80
    v_accvgpr_read_b32 v81, a9
    v_mul_f32 v81, v22, v81
    v_cvt_pk_bf16_f32 v80, v80, v81
    v_cvt_pk_bf16_f32 v81, v82, v83
    v_accvgpr_read_b32 v82, a24
    v_mul_f32 v82, v22, v82
    v_accvgpr_read_b32 v83, a25
    v_mul_f32 v83, v22, v83
    v_cvt_pk_bf16_f32 v82, v82, v83
    v_cvt_pk_bf16_f32 v83, v30, v31
    v_permlane16_swap_b32 v23, v59
    s_xor_b32 s8, s8, s11
    v_add_f32 v23, v23, v59
    v_mov_b32 v59, v23
    s_add_u32 s9, s51, 2
    s_and_b32 s9, s9, 3
    v_permlane32_swap_b32 v23, v59
    s_lshr_b32 s72, s73, s9
    v_add_f32 v23, v23, v59
    v_rcp_f32 v23, v23
    v_accvgpr_read_b32 v24, a30
    v_mul_f32 v24, v23, v24
    v_accvgpr_read_b32 v25, a31
    v_mul_f32 v25, v23, v25
    v_accvgpr_read_b32 v90, a14
    v_mul_f32 v90, v23, v90
    v_accvgpr_read_b32 v91, a15
    v_mul_f32 v91, v23, v91
    v_accvgpr_read_b32 v88, a12
    v_mul_f32 v88, v23, v88
    v_accvgpr_read_b32 v89, a13
    v_mul_f32 v89, v23, v89
    v_cvt_pk_bf16_f32 v88, v88, v89
    v_cvt_pk_bf16_f32 v89, v90, v91
    v_accvgpr_read_b32 v90, a28
    v_mul_f32 v90, v23, v90
    v_accvgpr_read_b32 v91, a29
    v_mul_f32 v91, v23, v91
    v_cvt_pk_bf16_f32 v90, v90, v91
    v_cvt_pk_bf16_f32 v91, v24, v25
    v_mfma_f32_16x16x32_bf16 a[176:179], a[212:215], v[228:231], a[176:179]
    s_and_b32 s72, s72, 0x2000
    v_accvgpr_read_b32 v96, a32
    v_accvgpr_read_b32 v97, a33
    v_mfma_f32_16x16x32_bf16 a[160:163], a[208:211], v[228:231], a[160:163]
    s_waitcnt lgkmcnt(4)
    buffer_store_dwordx4 v[64:67], v28, s[20:23], s55 offen offset:0 sc1
    v_mfma_f32_16x16x32_bf16 a[224:227], a[192:195], v[64:67], 0
    s_mul_i32 s9, s9, 0x202000
    ds_read_b64_tr_b16 a[208:209], v8 offset:1024
    v_accvgpr_read_b32 v98, a34
    v_mfma_f32_16x16x32_bf16 a[240:243], a[196:199], v[64:67], 0
    s_xor_b32 s9, s9, s72
    ds_read_b64_tr_b16 a[210:211], v8 offset:7168
    v_accvgpr_read_b32 v99, a35
    v_mfma_f32_16x16x32_bf16 a[244:247], a[196:199], v[72:75], 0
    s_and_b32 s9, s9, 6299648
    v_mul_f32 v96, v20, v96
    v_mul_f32 v97, v20, v97
    v_mfma_f32_16x16x32_bf16 a[228:231], a[192:195], v[72:75], 0
    buffer_store_dwordx4 v[72:75], v28, s[20:23], s55 offen offset:1024 sc1
    v_mfma_f32_16x16x32_bf16 a[232:235], a[192:195], v[80:83], 0
    s_xor_b32 s9, s9, s11
    ds_read_b64_tr_b16 a[212:213], v9 offset:1024
    v_mul_f32 v98, v20, v98
    v_mfma_f32_16x16x32_bf16 a[248:251], a[196:199], v[80:83], 0
    s_add_u32 s10, s51, 3
    ds_read_b64_tr_b16 a[214:215], v9 offset:7168
    v_mul_f32 v99, v20, v99
    v_mfma_f32_16x16x32_bf16 a[252:255], a[196:199], v[88:91], 0
    s_and_b32 s10, s10, 3
    v_cvt_pk_bf16_f32 v96, v96, v97
    v_cvt_pk_bf16_f32 v97, v98, v99
    v_mfma_f32_16x16x32_bf16 a[236:239], a[192:195], v[88:91], 0
    s_waitcnt lgkmcnt(4)
    buffer_store_dwordx4 v[80:83], v28, s[20:23], s55 offen offset:2048 sc1
    buffer_store_dwordx4 v[88:91], v28, s[20:23], s55 offen offset:3072 sc1
    v_accvgpr_read_b32 v26, a50
    v_mul_f32 v26, v20, v26
    v_accvgpr_read_b32 v27, a51
    v_mul_f32 v27, v20, v27
    v_accvgpr_read_b32 v98, a48
    v_mul_f32 v98, v20, v98
    v_accvgpr_read_b32 v99, a49
    v_mul_f32 v99, v20, v99
    v_cvt_pk_bf16_f32 v98, v98, v99
    v_cvt_pk_bf16_f32 v99, v26, v27
    v_mfma_f32_16x16x32_bf16 v[92:95], a[200:203], v[88:91], 0
    s_add_u32 s55, s55, 4096
    ds_read_b64_tr_b16 a[192:193], v10 offset:1024
    v_accvgpr_read_b32 v104, a36
    v_mfma_f32_16x16x32_bf16 v[124:127], a[204:207], v[88:91], 0
    s_lshr_b32 s72, s73, s10
    ds_read_b64_tr_b16 a[194:195], v10 offset:7168
    v_accvgpr_read_b32 v105, a37
    v_mfma_f32_16x16x32_bf16 v[116:119], a[204:207], v[80:83], 0
    s_and_b32 s72, s72, 0x2000
    v_accvgpr_read_b32 v106, a38
    v_accvgpr_read_b32 v107, a39
    v_mfma_f32_16x16x32_bf16 v[84:87], a[200:203], v[80:83], 0
    s_mul_i32 s10, s10, 0x202000
    v_mul_f32 v104, v21, v104
    v_mul_f32 v105, v21, v105
    v_mfma_f32_16x16x32_bf16 v[76:79], a[200:203], v[72:75], 0
    s_xor_b32 s10, s10, s72
    ds_read_b64_tr_b16 a[196:197], v11 offset:1024
    v_mul_f32 v106, v21, v106
    v_mfma_f32_16x16x32_bf16 v[108:111], a[204:207], v[72:75], 0
    s_and_b32 s10, s10, 6299648
    ds_read_b64_tr_b16 a[198:199], v11 offset:7168
    v_mul_f32 v107, v21, v107
    v_mfma_f32_16x16x32_bf16 v[100:103], a[204:207], v[64:67], 0
    s_xor_b32 s10, s10, s11
    v_cvt_pk_bf16_f32 v104, v104, v105
    v_cvt_pk_bf16_f32 v105, v106, v107
    v_mfma_f32_16x16x32_bf16 v[68:71], a[200:203], v[64:67], 0
    s_waitcnt lgkmcnt(4)
    v_accvgpr_read_b32 v106, a52
    v_accvgpr_read_b32 v107, a53
    v_mfma_f32_16x16x32_bf16 v[132:135], a[208:211], v[64:67], 0
    s_lshl_b32 s72, 1, s51
    ds_read_b64_tr_b16 a[200:201], v18 offset:2048
    v_mov_b32 v16, s72
    v_mfma_f32_16x16x32_bf16 v[164:167], a[212:215], v[64:67], 0
    ds_read_b64_tr_b16 a[202:203], v18 offset:8192
    v_accvgpr_read_b32 v17, a223
    v_accvgpr_read_b32 v30, a54
    v_mul_f32 v30, v21, v30
    v_accvgpr_read_b32 v31, a55
    v_mul_f32 v31, v21, v31
    v_mul_f32 v106, v21, v106
    v_mul_f32 v107, v21, v107
    v_cvt_pk_bf16_f32 v106, v106, v107
    v_cvt_pk_bf16_f32 v107, v30, v31
    v_mfma_f32_16x16x32_bf16 v[172:175], a[212:215], v[72:75], 0
    buffer_load_dwordx4 v5, s[12:15], s38 offen offset:128 lds
    v_mfma_f32_16x16x32_bf16 v[140:143], a[208:211], v[72:75], 0
    s_add_u32 m0, s49, 78592
    v_accvgpr_read_b32 v112, a40
    v_accvgpr_read_b32 v113, a41
    v_mfma_f32_16x16x32_bf16 v[148:151], a[208:211], v[80:83], 0
    s_mov_b32 s72, 0
    ds_read_b64_tr_b16 a[204:205], v19 offset:2048
    v_accvgpr_read_b32 v114, a42
    v_mfma_f32_16x16x32_bf16 v[180:183], a[212:215], v[80:83], 0
    ds_read_b64_tr_b16 a[206:207], v19 offset:8192
    v_accvgpr_read_b32 v115, a43
    v_mfma_f32_16x16x32_bf16 v[188:191], a[212:215], v[88:91], 0
    buffer_load_dwordx4 v5, s[12:15], s76 offen offset:256 lds
    v_mfma_f32_16x16x32_bf16 v[156:159], a[208:211], v[88:91], 0
    s_waitcnt lgkmcnt(4)
    v_mul_f32 v112, v22, v112
    v_mul_f32 v113, v22, v113
    v_mfma_f32_16x16x32_bf16 v[220:223], a[192:195], v[88:91], 0
    s_add_u32 s38, s34, 40960
    ds_read_b64_tr_b16 a[208:209], v8 offset:12288
    v_mul_f32 v114, v22, v114
    v_mfma_f32_16x16x32_bf16 v[252:255], a[196:199], v[88:91], 0
    s_add_u32 s57, s35, 40960
    ds_read_b64_tr_b16 a[210:211], v8 offset:18432
    v_mul_f32 v115, v22, v115
    v_mfma_f32_16x16x32_bf16 v[244:247], a[196:199], v[80:83], 0
    buffer_store_dwordx4 v[96:99], v28, s[20:23], s55 offen offset:0 sc1
    v_mfma_f32_16x16x32_bf16 v[212:215], a[192:195], v[80:83], 0
    s_cmp_lt_u32 s3, 2
    s_cselect_b32 s38, s38, s57
    v_cvt_pk_bf16_f32 v112, v112, v113
    v_accvgpr_read_b32 v24, a58
    v_mul_f32 v24, v22, v24
    v_accvgpr_read_b32 v25, a59
    v_mul_f32 v25, v22, v25
    v_cvt_pk_bf16_f32 v113, v114, v115
    v_accvgpr_read_b32 v114, a56
    v_mul_f32 v114, v22, v114
    v_accvgpr_read_b32 v115, a57
    v_mul_f32 v115, v22, v115
    v_cvt_pk_bf16_f32 v114, v114, v115
    v_cvt_pk_bf16_f32 v115, v24, v25
    v_mfma_f32_16x16x32_bf16 v[204:207], a[192:195], v[72:75], 0
    s_add_u32 s76, s38, s63
    ds_read_b64_tr_b16 a[212:213], v9 offset:12288
    v_accvgpr_read_b32 v120, a44
    v_mfma_f32_16x16x32_bf16 v[236:239], a[196:199], v[72:75], 0
    s_add_u32 m0, s49, 98304
    ds_read_b64_tr_b16 a[214:215], v9 offset:18432
    v_accvgpr_read_b32 v121, a45
    v_mfma_f32_16x16x32_bf16 v[228:231], a[196:199], v[64:67], 0
    buffer_load_dwordx4 v4, s[12:15], s38 offen offset:0 lds
    v_mfma_f32_16x16x32_bf16 v[196:199], a[192:195], v[64:67], 0
    s_waitcnt lgkmcnt(4)
    v_accvgpr_read_b32 v122, a46
    v_accvgpr_read_b32 v123, a47
    v_mfma_f32_16x16x32_bf16 v[32:35], a[200:203], v[64:67], 0
    s_add_u32 m0, s49, 99200
    ds_read_b64_tr_b16 a[192:193], v10 offset:12288
    v_mul_f32 v120, v23, v120
    v_mfma_f32_16x16x32_bf16 v[48:51], a[204:207], v[64:67], 0
    ds_read_b64_tr_b16 a[194:195], v10 offset:18432
    v_mul_f32 v121, v23, v121
    v_mfma_f32_16x16x32_bf16 v[52:55], a[204:207], v[72:75], 0
    buffer_load_dwordx4 v4, s[12:15], s38 offen offset:128 lds
    v_mfma_f32_16x16x32_bf16 v[36:39], a[200:203], v[72:75], 0
    s_add_u32 m0, s49, 100096
    v_mul_f32 v122, v23, v122
    v_mul_f32 v123, v23, v123
    v_mfma_f32_16x16x32_bf16 v[40:43], a[200:203], v[80:83], 0
    ds_read_b64_tr_b16 a[196:197], v11 offset:12288
    v_cvt_pk_bf16_f32 v120, v120, v121
    v_mfma_f32_16x16x32_bf16 v[56:59], a[204:207], v[80:83], 0
    ds_read_b64_tr_b16 a[198:199], v11 offset:18432
    v_cvt_pk_bf16_f32 v121, v122, v123
    v_accvgpr_read_b32 v26, a62
    v_mul_f32 v26, v23, v26
    v_accvgpr_read_b32 v27, a63
    v_mul_f32 v27, v23, v27
    v_accvgpr_read_b32 v122, a60
    v_mul_f32 v122, v23, v122
    v_accvgpr_read_b32 v123, a61
    v_mul_f32 v123, v23, v123
    v_cvt_pk_bf16_f32 v122, v122, v123
    v_cvt_pk_bf16_f32 v123, v26, v27
    v_mfma_f32_16x16x32_bf16 v[60:63], a[204:207], v[88:91], 0
    buffer_load_dwordx4 v4, s[12:15], s76 offen offset:256 lds
    v_mfma_f32_16x16x32_bf16 v[44:47], a[200:203], v[88:91], 0
    s_waitcnt lgkmcnt(4)
    v_accvgpr_read_b32 v128, a64
    v_accvgpr_read_b32 v129, a65
    v_mfma_f32_16x16x32_bf16 a[236:239], a[208:211], v[120:123], a[236:239]
    s_add_u32 m0, s49, 101376
    ds_read_b64_tr_b16 a[200:201], v8 offset:13312
    v_accvgpr_read_b32 v130, a66
    v_mfma_f32_16x16x32_bf16 a[252:255], a[212:215], v[120:123], a[252:255]
    ds_read_b64_tr_b16 a[202:203], v8 offset:19456
    v_accvgpr_read_b32 v131, a67
    v_mfma_f32_16x16x32_bf16 a[248:251], a[212:215], v[112:115], a[248:251]
    buffer_load_dwordx4 v5, s[12:15], s38 offen offset:0 lds
    v_mfma_f32_16x16x32_bf16 a[232:235], a[208:211], v[112:115], a[232:235]
    s_add_u32 m0, s49, 102272
    v_mul_f32 v128, v20, v128
    v_mul_f32 v129, v20, v129
    v_mfma_f32_16x16x32_bf16 a[228:231], a[208:211], v[104:107], a[228:231]
    ds_read_b64_tr_b16 a[204:205], v9 offset:13312
    v_mul_f32 v130, v20, v130
    v_mfma_f32_16x16x32_bf16 a[244:247], a[212:215], v[104:107], a[244:247]
    ds_read_b64_tr_b16 a[206:207], v9 offset:19456
    v_mul_f32 v131, v20, v131
    v_mfma_f32_16x16x32_bf16 a[240:243], a[212:215], v[96:99], a[240:243]
    v_cvt_pk_bf16_f32 v128, v128, v129
    v_cvt_pk_bf16_f32 v129, v130, v131
    v_mfma_f32_16x16x32_bf16 a[224:227], a[208:211], v[96:99], a[224:227]
    s_waitcnt lgkmcnt(4)
    buffer_store_dwordx4 v[104:107], v28, s[20:23], s55 offen offset:1024 sc1
    v_accvgpr_read_b32 v30, a82
    v_mul_f32 v30, v20, v30
    v_accvgpr_read_b32 v31, a83
    v_mul_f32 v31, v20, v31
    v_accvgpr_read_b32 v130, a80
    v_mul_f32 v130, v20, v130
    v_accvgpr_read_b32 v131, a81
    v_mul_f32 v131, v20, v131
    v_cvt_pk_bf16_f32 v130, v130, v131
    v_cvt_pk_bf16_f32 v131, v30, v31
    v_mfma_f32_16x16x32_bf16 v[68:71], a[192:195], v[96:99], v[68:71]
    ds_read_b64_tr_b16 a[208:209], v10 offset:13312
    v_add_u32 v8, 0, v12
    v_mfma_f32_16x16x32_bf16 v[100:103], a[196:199], v[96:99], v[100:103]
    ds_read_b64_tr_b16 a[210:211], v10 offset:19456
    v_accvgpr_read_b32 v136, a68
    v_mfma_f32_16x16x32_bf16 v[108:111], a[196:199], v[104:107], v[108:111]
    v_accvgpr_read_b32 v137, a69
    v_accvgpr_read_b32 v138, a70
    v_mfma_f32_16x16x32_bf16 v[76:79], a[192:195], v[104:107], v[76:79]
    buffer_load_dwordx4 v5, s[12:15], s38 offen offset:128 lds
    v_mfma_f32_16x16x32_bf16 v[84:87], a[192:195], v[112:115], v[84:87]
    s_add_u32 m0, s49, 103168
    ds_read_b64_tr_b16 a[212:213], v11 offset:13312
    v_accvgpr_read_b32 v139, a71
    v_mfma_f32_16x16x32_bf16 v[116:119], a[196:199], v[112:115], v[116:119]
    ds_read_b64_tr_b16 a[214:215], v11 offset:19456
    v_mul_f32 v136, v21, v136
    v_mfma_f32_16x16x32_bf16 v[124:127], a[196:199], v[120:123], v[124:127]
    v_mul_f32 v137, v21, v137
    v_mul_f32 v138, v21, v138
    v_mfma_f32_16x16x32_bf16 v[92:95], a[192:195], v[120:123], v[92:95]
    s_waitcnt lgkmcnt(4)
    buffer_load_dwordx4 v5, s[12:15], s76 offen offset:256 lds
    v_mfma_f32_16x16x32_bf16 v[156:159], a[200:203], v[120:123], v[156:159]
    ds_read_b64_tr_b16 a[192:193], v18 offset:14336
    v_mul_f32 v139, v21, v139
    v_mfma_f32_16x16x32_bf16 v[188:191], a[204:207], v[120:123], v[188:191]
    ds_read_b64_tr_b16 a[194:195], v18 offset:20480
    v_cvt_pk_bf16_f32 v136, v136, v137
    v_accvgpr_read_b32 v24, a86
    v_mul_f32 v24, v21, v24
    v_accvgpr_read_b32 v25, a87
    v_mul_f32 v25, v21, v25
    v_cvt_pk_bf16_f32 v137, v138, v139
    v_accvgpr_read_b32 v138, a84
    v_mul_f32 v138, v21, v138
    v_accvgpr_read_b32 v139, a85
    v_mul_f32 v139, v21, v139
    v_cvt_pk_bf16_f32 v138, v138, v139
    v_cvt_pk_bf16_f32 v139, v24, v25
    v_mfma_f32_16x16x32_bf16 v[180:183], a[204:207], v[112:115], v[180:183]
    s_add_u32 s38, s33, 81920
    v_add_u32 v9, 0, v13
    v_add_u32 v10, 0, v14
    v_mfma_f32_16x16x32_bf16 v[148:151], a[200:203], v[112:115], v[148:151]
    s_add_u32 s57, s34, 81920
    v_accvgpr_read_b32 v144, a72
    v_accvgpr_read_b32 v145, a73
    v_mfma_f32_16x16x32_bf16 v[140:143], a[200:203], v[104:107], v[140:143]
    s_cmp_lt_u32 s3, 2
    s_cselect_b32 s38, s38, s57
    ds_read_b64_tr_b16 a[196:197], v19 offset:14336
    v_mfma_f32_16x16x32_bf16 v[172:175], a[204:207], v[104:107], v[172:175]
    s_waitcnt vmcnt(24)
    ds_read_b64_tr_b16 a[198:199], v19 offset:20480
    v_accvgpr_read_b32 v146, a74
    v_mfma_f32_16x16x32_bf16 v[164:167], a[204:207], v[96:99], v[164:167]
    s_barrier
    v_mfma_f32_16x16x32_bf16 v[132:135], a[200:203], v[96:99], v[132:135]
    s_waitcnt lgkmcnt(4)
    v_accvgpr_read_b32 v147, a75
    v_mul_f32 v144, v22, v144
    v_mfma_f32_16x16x32_bf16 v[196:199], a[208:211], v[96:99], v[196:199]
    s_add_u32 s76, s38, s63
    ds_read_b64_tr_b16 a[200:201], v8 offset:0
    v_mul_f32 v145, v22, v145
    v_mfma_f32_16x16x32_bf16 v[228:231], a[212:215], v[96:99], v[228:231]
    s_add_u32 m0, s49, 49152
    ds_read_b64_tr_b16 a[202:203], v8 offset:6144
    v_mul_f32 v146, v22, v146
    v_mfma_f32_16x16x32_bf16 v[236:239], a[212:215], v[104:107], v[236:239]
    buffer_store_dwordx4 v[112:115], v28, s[20:23], s55 offen offset:2048 sc1
    v_mfma_f32_16x16x32_bf16 v[204:207], a[208:211], v[104:107], v[204:207]
    s_waitcnt vmcnt(11)
    v_mul_f32 v147, v22, v147
    v_cvt_pk_bf16_f32 v144, v144, v145
    v_accvgpr_read_b32 v26, a90
    v_mul_f32 v26, v22, v26
    v_accvgpr_read_b32 v27, a91
    v_mul_f32 v27, v22, v27
    v_cvt_pk_bf16_f32 v145, v146, v147
    v_accvgpr_read_b32 v146, a88
    v_mul_f32 v146, v22, v146
    v_accvgpr_read_b32 v147, a89
    v_mul_f32 v147, v22, v147
    v_cvt_pk_bf16_f32 v146, v146, v147
    v_cvt_pk_bf16_f32 v147, v26, v27
    v_mfma_f32_16x16x32_bf16 v[212:215], a[208:211], v[112:115], v[212:215]
    ds_read_b64_tr_b16 a[204:205], v9 offset:0
    v_add_u32 v11, 0, v15
    v_mfma_f32_16x16x32_bf16 v[244:247], a[212:215], v[112:115], v[244:247]
    ds_read_b64_tr_b16 a[206:207], v9 offset:6144
    v_xor_b32 v18, s39, v8
    v_mfma_f32_16x16x32_bf16 v[252:255], a[212:215], v[120:123], v[252:255]
    buffer_atomic_or v16, v17, s[24:27], 0 offen
    v_mfma_f32_16x16x32_bf16 v[220:223], a[208:211], v[120:123], v[220:223]
    s_waitcnt lgkmcnt(4)
    buffer_load_dwordx4 v4, s[12:15], s38 offen offset:0 lds
    v_mfma_f32_16x16x32_bf16 v[44:47], a[192:195], v[120:123], v[44:47]
    s_add_u32 m0, s49, 50048
    ds_read_b64_tr_b16 a[208:209], v10 offset:0
    v_xor_b32 v19, s39, v9
    v_mfma_f32_16x16x32_bf16 v[60:63], a[196:199], v[120:123], v[60:63]
    ds_read_b64_tr_b16 a[210:211], v10 offset:6144
    v_accvgpr_read_b32 v152, a76
    v_mfma_f32_16x16x32_bf16 v[56:59], a[196:199], v[112:115], v[56:59]
    buffer_load_dwordx4 v4, s[12:15], s38 offen offset:128 lds
    v_mfma_f32_16x16x32_bf16 v[40:43], a[192:195], v[112:115], v[40:43]
    s_add_u32 m0, s49, 50944
    v_accvgpr_read_b32 v153, a77
    v_accvgpr_read_b32 v154, a78
    v_mfma_f32_16x16x32_bf16 v[36:39], a[192:195], v[104:107], v[36:39]
    ds_read_b64_tr_b16 a[212:213], v11 offset:0
    v_accvgpr_read_b32 v155, a79
    v_mfma_f32_16x16x32_bf16 v[52:55], a[196:199], v[104:107], v[52:55]
    ds_read_b64_tr_b16 a[214:215], v11 offset:6144
    v_mul_f32 v152, v23, v152
    v_accvgpr_read_b32 v30, a94
    v_mul_f32 v30, v23, v30
    v_accvgpr_read_b32 v31, a95
    v_mul_f32 v31, v23, v31
    v_mul_f32 v154, v23, v154
    v_mul_f32 v155, v23, v155
    v_mul_f32 v153, v23, v153
    v_cvt_pk_bf16_f32 v152, v152, v153
    v_cvt_pk_bf16_f32 v153, v154, v155
    v_accvgpr_read_b32 v154, a92
    v_mul_f32 v154, v23, v154
    v_accvgpr_read_b32 v155, a93
    v_mul_f32 v155, v23, v155
    v_cvt_pk_bf16_f32 v154, v154, v155
    v_cvt_pk_bf16_f32 v155, v30, v31
    v_mfma_f32_16x16x32_bf16 v[48:51], a[196:199], v[96:99], v[48:51]
    buffer_load_dwordx4 v4, s[12:15], s76 offen offset:256 lds
    v_mfma_f32_16x16x32_bf16 v[32:35], a[192:195], v[96:99], v[32:35]
    s_waitcnt lgkmcnt(4)
    v_accvgpr_read_b32 v160, a96
    v_accvgpr_read_b32 v161, a97
    v_mfma_f32_16x16x32_bf16 a[224:227], a[200:203], v[128:131], a[224:227]
    s_add_u32 m0, s49, 52224
    ds_read_b64_tr_b16 a[192:193], v8 offset:1024
    v_accvgpr_read_b32 v162, a98
    v_mfma_f32_16x16x32_bf16 a[240:243], a[204:207], v[128:131], a[240:243]
    ds_read_b64_tr_b16 a[194:195], v8 offset:7168
    v_accvgpr_read_b32 v163, a99
    v_mfma_f32_16x16x32_bf16 a[244:247], a[204:207], v[136:139], a[244:247]
    buffer_load_dwordx4 v5, s[12:15], s38 offen offset:0 lds
    v_mfma_f32_16x16x32_bf16 a[228:231], a[200:203], v[136:139], a[228:231]
    s_add_u32 m0, s49, 53120
    v_mul_f32 v160, v20, v160
    v_mul_f32 v161, v20, v161
    v_mfma_f32_16x16x32_bf16 a[232:235], a[200:203], v[144:147], a[232:235]
    ds_read_b64_tr_b16 a[196:197], v9 offset:1024
    v_mul_f32 v162, v20, v162
    v_mfma_f32_16x16x32_bf16 a[248:251], a[204:207], v[144:147], a[248:251]
    ds_read_b64_tr_b16 a[198:199], v9 offset:7168
    v_mul_f32 v163, v20, v163
    v_mfma_f32_16x16x32_bf16 a[252:255], a[204:207], v[152:155], a[252:255]
    v_cvt_pk_bf16_f32 v160, v160, v161
    v_cvt_pk_bf16_f32 v161, v162, v163
    v_mfma_f32_16x16x32_bf16 a[236:239], a[200:203], v[152:155], a[236:239]
    s_waitcnt lgkmcnt(4)
    buffer_load_dwordx4 v5, s[12:15], s38 offen offset:128 lds
    v_accvgpr_read_b32 v24, a114
    v_mul_f32 v24, v20, v24
    v_accvgpr_read_b32 v25, a115
    v_mul_f32 v25, v20, v25
    v_accvgpr_read_b32 v162, a112
    v_mul_f32 v162, v20, v162
    v_accvgpr_read_b32 v163, a113
    v_mul_f32 v163, v20, v163
    v_cvt_pk_bf16_f32 v162, v162, v163
    v_cvt_pk_bf16_f32 v163, v24, v25
    v_mfma_f32_16x16x32_bf16 v[92:95], a[208:211], v[152:155], v[92:95]
    s_add_u32 m0, s49, 54016
    ds_read_b64_tr_b16 a[200:201], v10 offset:1024
    v_accvgpr_read_b32 v168, a100
    v_mfma_f32_16x16x32_bf16 v[124:127], a[212:215], v[152:155], v[124:127]
    ds_read_b64_tr_b16 a[202:203], v10 offset:7168
    v_accvgpr_read_b32 v169, a101
    v_mfma_f32_16x16x32_bf16 v[116:119], a[212:215], v[144:147], v[116:119]
    v_accvgpr_read_b32 v170, a102
    v_accvgpr_read_b32 v171, a103
    v_mfma_f32_16x16x32_bf16 v[84:87], a[208:211], v[144:147], v[84:87]
    buffer_store_dwordx4 v[120:123], v28, s[20:23], s55 offen offset:3072 sc1
    v_mfma_f32_16x16x32_bf16 v[76:79], a[208:211], v[136:139], v[76:79]
    s_add_u32 s55, s55, 12288
    ds_read_b64_tr_b16 a[204:205], v11 offset:1024
    v_mul_f32 v168, v21, v168
    v_mfma_f32_16x16x32_bf16 v[108:111], a[212:215], v[136:139], v[108:111]
    ds_read_b64_tr_b16 a[206:207], v11 offset:7168
    v_mul_f32 v169, v21, v169
    v_mfma_f32_16x16x32_bf16 v[100:103], a[212:215], v[128:131], v[100:103]
    v_mul_f32 v170, v21, v170
    v_mul_f32 v171, v21, v171
    v_mfma_f32_16x16x32_bf16 v[68:71], a[208:211], v[128:131], v[68:71]
    s_waitcnt lgkmcnt(4)
    buffer_load_dwordx4 v5, s[12:15], s76 offen offset:256 lds
    v_mfma_f32_16x16x32_bf16 v[132:135], a[192:195], v[128:131], v[132:135]
    ds_read_b64_tr_b16 a[208:209], v18 offset:2048
    v_cvt_pk_bf16_f32 v168, v168, v169
    v_mfma_f32_16x16x32_bf16 v[164:167], a[196:199], v[128:131], v[164:167]
    ds_read_b64_tr_b16 a[210:211], v18 offset:8192
    v_cvt_pk_bf16_f32 v169, v170, v171
    v_accvgpr_read_b32 v26, a118
    v_mul_f32 v26, v21, v26
    v_accvgpr_read_b32 v27, a119
    v_mul_f32 v27, v21, v27
    v_accvgpr_read_b32 v170, a116
    v_mul_f32 v170, v21, v170
    v_accvgpr_read_b32 v171, a117
    v_mul_f32 v171, v21, v171
    v_cvt_pk_bf16_f32 v170, v170, v171
    v_cvt_pk_bf16_f32 v171, v26, v27
    v_mfma_f32_16x16x32_bf16 v[172:175], a[196:199], v[136:139], v[172:175]
pg_8:
    s_cbranch_execz pg_12
    v_accvgpr_read_b32 v176, a104
    v_accvgpr_read_b32 v177, a105
    v_mfma_f32_16x16x32_bf16 v[140:143], a[192:195], v[136:139], v[140:143]
    v_accvgpr_read_b32 v178, a106
    v_accvgpr_read_b32 v179, a107
    v_mfma_f32_16x16x32_bf16 v[148:151], a[192:195], v[144:147], v[148:151]
    ds_read_b64_tr_b16 a[212:213], v19 offset:2048
    v_mul_f32 v176, v22, v176
    v_mfma_f32_16x16x32_bf16 v[180:183], a[196:199], v[144:147], v[180:183]
    ds_read_b64_tr_b16 a[214:215], v19 offset:8192
    v_mul_f32 v177, v22, v177
    v_mfma_f32_16x16x32_bf16 v[188:191], a[196:199], v[152:155], v[188:191]
    buffer_store_dwordx4 v[128:131], v28, s[20:23], s55 offen offset:0 sc1
    v_mfma_f32_16x16x32_bf16 v[156:159], a[192:195], v[152:155], v[156:159]
    s_waitcnt lgkmcnt(4)
    v_mul_f32 v178, v22, v178
    v_mul_f32 v179, v22, v179
    v_mfma_f32_16x16x32_bf16 v[220:223], a[200:203], v[152:155], v[220:223]
    ds_read_b64_tr_b16 a[192:193], v8 offset:12288
    v_cvt_pk_bf16_f32 v176, v176, v177
    v_mfma_f32_16x16x32_bf16 v[252:255], a[204:207], v[152:155], v[252:255]
    ds_read_b64_tr_b16 a[194:195], v8 offset:18432
    v_cvt_pk_bf16_f32 v177, v178, v179
    v_mfma_f32_16x16x32_bf16 v[244:247], a[204:207], v[144:147], v[244:247]
    v_accvgpr_read_b32 v178, a120
    v_accvgpr_read_b32 v179, a121
    v_mfma_f32_16x16x32_bf16 v[212:215], a[200:203], v[144:147], v[212:215]
    v_accvgpr_read_b32 v30, a122
    v_accvgpr_read_b32 v31, a123
    v_mul_f32 v30, v22, v30
    v_mul_f32 v31, v22, v31
    v_mul_f32 v178, v22, v178
    v_mul_f32 v179, v22, v179
    v_cvt_pk_bf16_f32 v178, v178, v179
    v_cvt_pk_bf16_f32 v179, v30, v31
    v_mfma_f32_16x16x32_bf16 v[204:207], a[200:203], v[136:139], v[204:207]
    ds_read_b64_tr_b16 a[196:197], v9 offset:12288
    v_accvgpr_read_b32 v184, a108
    v_mfma_f32_16x16x32_bf16 v[236:239], a[204:207], v[136:139], v[236:239]
    ds_read_b64_tr_b16 a[198:199], v9 offset:18432
    v_accvgpr_read_b32 v185, a109
    v_mfma_f32_16x16x32_bf16 v[228:231], a[204:207], v[128:131], v[228:231]
    v_accvgpr_read_b32 v186, a110
    v_accvgpr_read_b32 v187, a111
    v_mfma_f32_16x16x32_bf16 v[196:199], a[200:203], v[128:131], v[196:199]
    s_waitcnt lgkmcnt(4)
    v_mul_f32 v184, v23, v184
    v_mul_f32 v185, v23, v185
    v_mfma_f32_16x16x32_bf16 v[32:35], a[208:211], v[128:131], v[32:35]
    ds_read_b64_tr_b16 a[200:201], v10 offset:12288
    v_mul_f32 v186, v23, v186
    v_mfma_f32_16x16x32_bf16 v[48:51], a[212:215], v[128:131], v[48:51]
    ds_read_b64_tr_b16 a[202:203], v10 offset:18432
    v_mul_f32 v187, v23, v187
    v_mfma_f32_16x16x32_bf16 v[52:55], a[212:215], v[136:139], v[52:55]
    v_cvt_pk_bf16_f32 v184, v184, v185
    v_cvt_pk_bf16_f32 v185, v186, v187
    v_mfma_f32_16x16x32_bf16 v[36:39], a[208:211], v[136:139], v[36:39]
    buffer_store_dwordx4 v[136:139], v28, s[20:23], s55 offen offset:1024 sc1
    v_mfma_f32_16x16x32_bf16 v[40:43], a[208:211], v[144:147], v[40:43]
    ds_read_b64_tr_b16 a[204:205], v11 offset:12288
    v_accvgpr_read_b32 v186, a124
    v_mfma_f32_16x16x32_bf16 v[56:59], a[212:215], v[144:147], v[56:59]
    ds_read_b64_tr_b16 a[206:207], v11 offset:18432
    v_accvgpr_read_b32 v187, a125
    v_accvgpr_read_b32 v24, a126
    v_mul_f32 v24, v23, v24
    v_accvgpr_read_b32 v25, a127
    v_mul_f32 v25, v23, v25
    v_mul_f32 v186, v23, v186
    v_mul_f32 v187, v23, v187
    v_cvt_pk_bf16_f32 v186, v186, v187
    v_cvt_pk_bf16_f32 v187, v24, v25
    v_mfma_f32_16x16x32_bf16 v[60:63], a[212:215], v[152:155], v[60:63]
    v_accvgpr_read_b32 v192, a128
    v_accvgpr_read_b32 v193, a129
    v_mfma_f32_16x16x32_bf16 v[44:47], a[208:211], v[152:155], v[44:47]
    s_waitcnt lgkmcnt(4)
    v_accvgpr_read_b32 v194, a130
    v_accvgpr_read_b32 v195, a131
    v_mfma_f32_16x16x32_bf16 a[236:239], a[192:195], v[184:187], a[236:239]
    ds_read_b64_tr_b16 a[208:209], v8 offset:13312
    v_mul_f32 v192, v20, v192
    v_mfma_f32_16x16x32_bf16 a[252:255], a[196:199], v[184:187], a[252:255]
    ds_read_b64_tr_b16 a[210:211], v8 offset:19456
    v_mul_f32 v193, v20, v193
    v_mfma_f32_16x16x32_bf16 a[248:251], a[196:199], v[176:179], a[248:251]
    v_mul_f32 v194, v20, v194
    v_mul_f32 v195, v20, v195
    v_mfma_f32_16x16x32_bf16 a[232:235], a[192:195], v[176:179], a[232:235]
    v_cvt_pk_bf16_f32 v192, v192, v193
    v_cvt_pk_bf16_f32 v193, v194, v195
    v_mfma_f32_16x16x32_bf16 a[228:231], a[192:195], v[168:171], a[228:231]
    ds_read_b64_tr_b16 a[212:213], v9 offset:13312
    v_accvgpr_read_b32 v194, a144
    v_mfma_f32_16x16x32_bf16 a[244:247], a[196:199], v[168:171], a[244:247]
    ds_read_b64_tr_b16 a[214:215], v9 offset:19456
    v_accvgpr_read_b32 v195, a145
    v_mfma_f32_16x16x32_bf16 a[240:243], a[196:199], v[160:163], a[240:243]
    v_accvgpr_read_b32 v26, a146
    v_accvgpr_read_b32 v27, a147
    v_mfma_f32_16x16x32_bf16 a[224:227], a[192:195], v[160:163], a[224:227]
    s_waitcnt lgkmcnt(4)
    v_mul_f32 v194, v20, v194
    v_mul_f32 v195, v20, v195
    v_mul_f32 v26, v20, v26
    v_mul_f32 v27, v20, v27
    v_cvt_pk_bf16_f32 v194, v194, v195
    v_cvt_pk_bf16_f32 v195, v26, v27
    v_mfma_f32_16x16x32_bf16 v[68:71], a[200:203], v[160:163], v[68:71]
    ds_read_b64_tr_b16 a[192:193], v10 offset:13312
    v_add_u32 v8, 122880, v12
    v_mfma_f32_16x16x32_bf16 v[100:103], a[204:207], v[160:163], v[100:103]
    ds_read_b64_tr_b16 a[194:195], v10 offset:19456
    v_accvgpr_read_b32 v200, a132
    v_mfma_f32_16x16x32_bf16 v[108:111], a[204:207], v[168:171], v[108:111]
    buffer_store_dwordx4 v[144:147], v28, s[20:23], s55 offen offset:2048 sc1
    v_mfma_f32_16x16x32_bf16 v[76:79], a[200:203], v[168:171], v[76:79]
    v_accvgpr_read_b32 v201, a133
    v_accvgpr_read_b32 v202, a134
    v_mfma_f32_16x16x32_bf16 v[84:87], a[200:203], v[176:179], v[84:87]
    ds_read_b64_tr_b16 a[196:197], v11 offset:13312
    v_accvgpr_read_b32 v203, a135
    v_mfma_f32_16x16x32_bf16 v[116:119], a[204:207], v[176:179], v[116:119]
    ds_read_b64_tr_b16 a[198:199], v11 offset:19456
    v_mul_f32 v200, v21, v200
    v_mfma_f32_16x16x32_bf16 v[124:127], a[204:207], v[184:187], v[124:127]
    v_mul_f32 v201, v21, v201
    v_mul_f32 v202, v21, v202
    v_mfma_f32_16x16x32_bf16 v[92:95], a[200:203], v[184:187], v[92:95]
    s_waitcnt lgkmcnt(4)
    v_mul_f32 v203, v21, v203
    v_cvt_pk_bf16_f32 v200, v200, v201
    v_mfma_f32_16x16x32_bf16 v[156:159], a[208:211], v[184:187], v[156:159]
    ds_read_b64_tr_b16 a[200:201], v18 offset:14336
    v_cvt_pk_bf16_f32 v201, v202, v203
    v_mfma_f32_16x16x32_bf16 v[188:191], a[212:215], v[184:187], v[188:191]
    ds_read_b64_tr_b16 a[202:203], v18 offset:20480
    v_accvgpr_read_b32 v202, a148
    v_accvgpr_read_b32 v30, a150
    v_mul_f32 v30, v21, v30
    v_accvgpr_read_b32 v31, a151
    v_mul_f32 v31, v21, v31
    v_mul_f32 v202, v21, v202
    v_accvgpr_read_b32 v203, a149
    v_mul_f32 v203, v21, v203
    v_cvt_pk_bf16_f32 v202, v202, v203
    v_cvt_pk_bf16_f32 v203, v30, v31
    v_mfma_f32_16x16x32_bf16 v[180:183], a[212:215], v[176:179], v[180:183]
    s_add_u32 s38, s35, 81920
    v_add_u32 v9, 122880, v13
    v_add_u32 v10, 122880, v14
    v_mfma_f32_16x16x32_bf16 v[148:151], a[208:211], v[176:179], v[148:151]
    s_add_u32 s57, s33, 122880
    v_accvgpr_read_b32 v208, a136
    v_accvgpr_read_b32 v209, a137
    v_mfma_f32_16x16x32_bf16 v[140:143], a[208:211], v[168:171], v[140:143]
    s_cmp_lt_u32 s3, 2
    s_cselect_b32 s38, s38, s57
    ds_read_b64_tr_b16 a[204:205], v19 offset:14336
    v_mfma_f32_16x16x32_bf16 v[172:175], a[212:215], v[168:171], v[172:175]
    s_waitcnt vmcnt(40)
    ds_read_b64_tr_b16 a[206:207], v19 offset:20480
    v_lshlrev_b32 v16, 4, v16
    v_mfma_f32_16x16x32_bf16 v[164:167], a[212:215], v[160:163], v[164:167]
    s_barrier
    v_mfma_f32_16x16x32_bf16 v[132:135], a[208:211], v[160:163], v[132:135]
    s_waitcnt lgkmcnt(4)
    v_accvgpr_read_b32 v210, a138
    v_accvgpr_read_b32 v211, a139
    v_mfma_f32_16x16x32_bf16 v[196:199], a[192:195], v[160:163], v[196:199]
    s_add_u32 s76, s38, s63
    ds_read_b64_tr_b16 a[208:209], v8 offset:0
    v_mul_f32 v208, v22, v208
    v_mfma_f32_16x16x32_bf16 v[228:231], a[196:199], v[160:163], v[228:231]
    s_add_u32 m0, s49, 0
    ds_read_b64_tr_b16 a[210:211], v8 offset:6144
    v_mul_f32 v209, v22, v209
    v_mfma_f32_16x16x32_bf16 v[236:239], a[196:199], v[168:171], v[236:239]
    buffer_store_dwordx4 v[152:155], v28, s[20:23], s55 offen offset:3072 sc1
    v_mfma_f32_16x16x32_bf16 v[204:207], a[192:195], v[168:171], v[204:207]
    s_add_u32 s55, s55, 4096
    v_mul_f32 v210, v22, v210
    v_mul_f32 v211, v22, v211
    v_accvgpr_read_b32 v24, a154
    v_mul_f32 v24, v22, v24
    v_accvgpr_read_b32 v25, a155
    v_mul_f32 v25, v22, v25
    v_cvt_pk_bf16_f32 v208, v208, v209
    v_cvt_pk_bf16_f32 v209, v210, v211
    v_accvgpr_read_b32 v210, a152
    v_mul_f32 v210, v22, v210
    v_accvgpr_read_b32 v211, a153
    v_mul_f32 v211, v22, v211
    v_cvt_pk_bf16_f32 v210, v210, v211
    v_cvt_pk_bf16_f32 v211, v24, v25
    v_mfma_f32_16x16x32_bf16 v[212:215], a[192:195], v[176:179], v[212:215]
    s_load_dword s72, s[86:87], s5 offset:4 glc
    ds_read_b64_tr_b16 a[212:213], v9 offset:0
    v_add_u32 v11, 122880, v15
    v_mfma_f32_16x16x32_bf16 v[244:247], a[196:199], v[176:179], v[244:247]
    s_waitcnt vmcnt(5)
    ds_read_b64_tr_b16 a[214:215], v9 offset:6144
    v_xor_b32 v18, s39, v8
    v_mfma_f32_16x16x32_bf16 v[252:255], a[196:199], v[184:187], v[252:255]
    buffer_atomic_or v16, v17, s[24:27], 0 offen
    v_mfma_f32_16x16x32_bf16 v[220:223], a[192:195], v[184:187], v[220:223]
    s_waitcnt lgkmcnt(4)
    buffer_load_dwordx4 v4, s[12:15], s38 offen offset:0 lds
    v_mfma_f32_16x16x32_bf16 v[44:47], a[200:203], v[184:187], v[44:47]
    s_add_u32 m0, s49, 896
    ds_read_b64_tr_b16 a[192:193], v10 offset:0
    v_xor_b32 v19, s39, v9
    v_mfma_f32_16x16x32_bf16 v[60:63], a[204:207], v[184:187], v[60:63]
    ds_read_b64_tr_b16 a[194:195], v10 offset:6144
    v_accvgpr_read_b32 v216, a140
    v_mfma_f32_16x16x32_bf16 v[56:59], a[204:207], v[176:179], v[56:59]
    buffer_load_dwordx4 v4, s[12:15], s38 offen offset:128 lds
    v_mfma_f32_16x16x32_bf16 v[40:43], a[200:203], v[176:179], v[40:43]
    s_add_u32 m0, s49, 1792
    v_accvgpr_read_b32 v217, a141
    v_accvgpr_read_b32 v218, a142
    v_mfma_f32_16x16x32_bf16 v[36:39], a[200:203], v[168:171], v[36:39]
    s_mov_b32 s28, s82
    ds_read_b64_tr_b16 a[196:197], v11 offset:0
    v_accvgpr_read_b32 v219, a143
    v_mfma_f32_16x16x32_bf16 v[52:55], a[204:207], v[168:171], v[52:55]
    s_and_b32 s29, s83, 0xffff
    ds_read_b64_tr_b16 a[198:199], v11 offset:6144
    v_mul_f32 v216, v23, v216
    v_accvgpr_read_b32 v26, a158
    v_mul_f32 v26, v23, v26
    v_accvgpr_read_b32 v27, a159
    v_mul_f32 v27, v23, v27
    v_mul_f32 v218, v23, v218
    v_mul_f32 v219, v23, v219
    v_mul_f32 v217, v23, v217
    v_cvt_pk_bf16_f32 v216, v216, v217
    v_cvt_pk_bf16_f32 v217, v218, v219
    v_accvgpr_read_b32 v218, a156
    v_mul_f32 v218, v23, v218
    v_accvgpr_read_b32 v219, a157
    v_mul_f32 v219, v23, v219
    v_cvt_pk_bf16_f32 v218, v218, v219
    v_cvt_pk_bf16_f32 v219, v26, v27
    v_mfma_f32_16x16x32_bf16 v[48:51], a[204:207], v[160:163], v[48:51]
    buffer_store_dwordx4 v[160:163], v28, s[20:23], s55 offen offset:0 sc1
    v_mfma_f32_16x16x32_bf16 v[32:35], a[200:203], v[160:163], v[32:35]
    s_waitcnt lgkmcnt(4)
    v_accvgpr_read_b32 v224, a160
    v_accvgpr_read_b32 v225, a161
    v_mfma_f32_16x16x32_bf16 a[224:227], a[208:211], v[192:195], a[224:227]
    s_mov_b32 s30, 1966080
    ds_read_b64_tr_b16 a[200:201], v8 offset:1024
    v_accvgpr_read_b32 v226, a162
    v_mfma_f32_16x16x32_bf16 a[240:243], a[212:215], v[192:195], a[240:243]
    s_mov_b32 s31, 0x00020000
    ds_read_b64_tr_b16 a[202:203], v8 offset:7168
    v_accvgpr_read_b32 v227, a163
    v_mfma_f32_16x16x32_bf16 a[244:247], a[212:215], v[200:203], a[244:247]
    buffer_load_dwordx4 v4, s[12:15], s76 offen offset:256 lds
    v_mfma_f32_16x16x32_bf16 a[228:231], a[208:211], v[200:203], a[228:231]
    s_add_u32 m0, s49, 3072
    v_mul_f32 v224, v20, v224
    v_mul_f32 v225, v20, v225
    v_mfma_f32_16x16x32_bf16 a[232:235], a[208:211], v[208:211], a[232:235]
    s_mul_i32 s44, s47, 10
    ds_read_b64_tr_b16 a[204:205], v9 offset:1024
    v_mul_f32 v226, v20, v226
    v_mfma_f32_16x16x32_bf16 a[248:251], a[212:215], v[208:211], a[248:251]
    s_sub_u32 s44, s58, s44
    ds_read_b64_tr_b16 a[206:207], v9 offset:7168
    v_mul_f32 v227, v20, v227
    v_mfma_f32_16x16x32_bf16 a[252:255], a[212:215], v[216:219], a[252:255]
    s_lshl_b32 s62, s44, 2
    v_cvt_pk_bf16_f32 v224, v224, v225
    v_cvt_pk_bf16_f32 v225, v226, v227
    v_mfma_f32_16x16x32_bf16 a[236:239], a[208:211], v[216:219], a[236:239]
    s_waitcnt lgkmcnt(4)
    buffer_load_dwordx4 v5, s[12:15], s38 offen offset:0 lds
    v_accvgpr_read_b32 v30, a178
    v_mul_f32 v30, v20, v30
    v_accvgpr_read_b32 v31, a179
    v_mul_f32 v31, v20, v31
    v_accvgpr_read_b32 v226, a176
    v_mul_f32 v226, v20, v226
    v_accvgpr_read_b32 v227, a177
    v_mul_f32 v227, v20, v227
    v_cvt_pk_bf16_f32 v226, v226, v227
    v_cvt_pk_bf16_f32 v227, v30, v31
    v_mfma_f32_16x16x32_bf16 v[92:95], a[192:195], v[216:219], v[92:95]
    s_add_u32 m0, s49, 3968
    ds_read_b64_tr_b16 a[208:209], v10 offset:1024
    v_accvgpr_read_b32 v232, a164
    v_mfma_f32_16x16x32_bf16 v[124:127], a[196:199], v[216:219], v[124:127]
    s_add_u32 s62, s62, s3
    ds_read_b64_tr_b16 a[210:211], v10 offset:7168
    v_accvgpr_read_b32 v233, a165
    v_mfma_f32_16x16x32_bf16 v[116:119], a[196:199], v[208:211], v[116:119]
    s_lshl_b32 s62, s62, 9
    v_accvgpr_read_b32 v234, a166
    v_accvgpr_read_b32 v235, a167
    v_mfma_f32_16x16x32_bf16 v[84:87], a[192:195], v[208:211], v[84:87]
    buffer_load_dwordx4 v5, s[12:15], s38 offen offset:128 lds
    v_mfma_f32_16x16x32_bf16 v[76:79], a[192:195], v[200:203], v[76:79]
    s_add_u32 m0, s49, 4864
    ds_read_b64_tr_b16 a[212:213], v11 offset:1024
    v_mul_f32 v232, v21, v232
    v_mfma_f32_16x16x32_bf16 v[108:111], a[196:199], v[200:203], v[108:111]
    s_add_u32 s62, s62, 3670016
    ds_read_b64_tr_b16 a[214:215], v11 offset:7168
    v_mul_f32 v233, v21, v233
    v_mfma_f32_16x16x32_bf16 v[100:103], a[196:199], v[192:195], v[100:103]
    s_cmp_lt_u32 s2, 240
    s_cselect_b32 s62, s62, 0x70000000
    v_mul_f32 v234, v21, v234
    v_mfma_f32_16x16x32_bf16 v[68:71], a[192:195], v[192:195], v[68:71]
    s_waitcnt lgkmcnt(4)
    buffer_store_dwordx4 v[168:171], v28, s[20:23], s55 offen offset:1024 sc1
    v_mfma_f32_16x16x32_bf16 v[132:135], a[200:203], v[192:195], v[132:135]
    s_lshl_b32 s59, s47, 6
    ds_read_b64_tr_b16 a[192:193], v18 offset:2048
    v_mul_f32 v235, v21, v235
    v_mfma_f32_16x16x32_bf16 v[164:167], a[204:207], v[192:195], v[164:167]
    s_lshr_b32 s56, s3, 1
    ds_read_b64_tr_b16 a[194:195], v18 offset:8192
    v_cvt_pk_bf16_f32 v232, v232, v233
    v_accvgpr_read_b32 v24, a182
    v_mul_f32 v24, v21, v24
    v_accvgpr_read_b32 v25, a183
    v_mul_f32 v25, v21, v25
    v_cvt_pk_bf16_f32 v233, v234, v235
    v_accvgpr_read_b32 v234, a180
    v_mul_f32 v234, v21, v234
    v_accvgpr_read_b32 v235, a181
    v_mul_f32 v235, v21, v235
    v_cvt_pk_bf16_f32 v234, v234, v235
    v_cvt_pk_bf16_f32 v235, v24, v25
    v_mfma_f32_16x16x32_bf16 v[172:175], a[204:207], v[200:203], v[172:175]
    s_lshl_b32 s56, s56, 5
    v_accvgpr_read_b32 v240, a168
    v_accvgpr_read_b32 v241, a169
    v_mfma_f32_16x16x32_bf16 v[140:143], a[200:203], v[200:203], v[140:143]
    s_add_u32 s59, s59, s56
    v_accvgpr_read_b32 v242, a170
    v_accvgpr_read_b32 v243, a171
    v_mfma_f32_16x16x32_bf16 v[148:151], a[200:203], v[208:211], v[148:151]
    s_and_b32 s56, s3, 1
    ds_read_b64_tr_b16 a[196:197], v19 offset:2048
    v_mul_f32 v240, v22, v240
    v_mfma_f32_16x16x32_bf16 v[180:183], a[204:207], v[208:211], v[180:183]
    s_lshl_b32 s56, s56, 2
    ds_read_b64_tr_b16 a[198:199], v19 offset:8192
    v_mul_f32 v241, v22, v241
    v_mfma_f32_16x16x32_bf16 v[188:191], a[204:207], v[216:219], v[188:191]
    s_bfe_u32 s88, s72, 262144
    s_cmp_lg_u32 s88, 15
    s_cbranch_scc1 spin_o0
spin_o0_ret:
    v_mul_f32 v242, v22, v242
    v_mfma_f32_16x16x32_bf16 v[156:159], a[200:203], v[216:219], v[156:159]
    s_waitcnt lgkmcnt(4)
    buffer_load_dwordx4 v5, s[12:15], s76 offen offset:256 lds
    v_mfma_f32_16x16x32_bf16 v[220:223], a[208:211], v[216:219], v[220:223]
    s_add_u32 s59, s59, s56
    ds_read_b64_tr_b16 a[200:201], v8 offset:12288
    v_mul_f32 v243, v22, v243
    v_mfma_f32_16x16x32_bf16 v[252:255], a[212:215], v[216:219], v[252:255]
    s_mul_i32 s59, s59, 1280
    ds_read_b64_tr_b16 a[202:203], v8 offset:18432
    v_cvt_pk_bf16_f32 v240, v240, v241
    v_mfma_f32_16x16x32_bf16 v[244:247], a[212:215], v[208:211], v[244:247]
    buffer_load_dwordx4 a[0:3], v28, s[20:23], s8 offen offset:0 sc1
    v_mfma_f32_16x16x32_bf16 v[212:215], a[208:211], v[208:211], v[212:215]
    s_lshl_b32 s44, s44, 7
    v_cvt_pk_bf16_f32 v241, v242, v243
    v_accvgpr_read_b32 v242, a184
    v_accvgpr_read_b32 v26, a186
    v_mul_f32 v26, v22, v26
    v_accvgpr_read_b32 v27, a187
    v_mul_f32 v27, v22, v27
    v_mul_f32 v242, v22, v242
    v_accvgpr_read_b32 v243, a185
    v_mul_f32 v243, v22, v243
    v_cvt_pk_bf16_f32 v242, v242, v243
    v_cvt_pk_bf16_f32 v243, v26, v27
    v_mfma_f32_16x16x32_bf16 v[204:207], a[208:211], v[200:203], v[204:207]
    s_add_u32 s59, s59, s44
    ds_read_b64_tr_b16 a[204:205], v9 offset:12288
    v_accvgpr_read_b32 v248, a172
    v_mfma_f32_16x16x32_bf16 v[236:239], a[212:215], v[200:203], v[236:239]
    s_lshl_b32 s44, s3, 11
    ds_read_b64_tr_b16 a[206:207], v9 offset:18432
    v_lshrrev_b32 v29, 5, v1
    v_mfma_f32_16x16x32_bf16 v[228:231], a[212:215], v[192:195], v[228:231]
    buffer_load_dwordx4 a[4:7], v28, s[20:23], s8 offen offset:1024 sc1
    v_mfma_f32_16x16x32_bf16 v[196:199], a[208:211], v[192:195], v[196:199]
    s_waitcnt lgkmcnt(4)
    v_lshlrev_b32 v29, 3, v29
    v_bfe_u32 v6, v1, 3, 2
    v_mfma_f32_16x16x32_bf16 v[32:35], a[192:195], v[192:195], v[32:35]
    ds_read_b64_tr_b16 a[208:209], v10 offset:12288
    v_add_u32 v6, v6, v29
    v_mfma_f32_16x16x32_bf16 v[48:51], a[196:199], v[192:195], v[48:51]
    ds_read_b64_tr_b16 a[210:211], v10 offset:18432
    v_mul_u32_u24 v6, 1280, v6
    v_mfma_f32_16x16x32_bf16 v[52:55], a[196:199], v[200:203], v[52:55]
    buffer_load_dwordx4 a[8:11], v28, s[20:23], s8 offen offset:2048 sc1
    v_mfma_f32_16x16x32_bf16 v[36:39], a[192:195], v[200:203], v[36:39]
    v_lshrrev_b32 v29, 4, v1
    v_lshlrev_b32 v29, 1, v29
    v_mfma_f32_16x16x32_bf16 v[40:43], a[192:195], v[208:211], v[40:43]
    ds_read_b64_tr_b16 a[212:213], v11 offset:12288
    v_and_b32 v7, 7, v1
    v_mfma_f32_16x16x32_bf16 v[56:59], a[196:199], v[208:211], v[56:59]
    ds_read_b64_tr_b16 a[214:215], v11 offset:18432
    v_xor_b32 v7, v7, v29
    buffer_store_dwordx4 v[176:179], v28, s[20:23], s55 offen offset:2048 sc1
    v_accvgpr_read_b32 v30, a190
    v_mul_f32 v30, v23, v30
    v_accvgpr_read_b32 v31, a191
    v_mul_f32 v31, v23, v31
    v_accvgpr_read_b32 v250, a174
    v_mul_f32 v250, v23, v250
    v_accvgpr_read_b32 v251, a175
    v_mul_f32 v251, v23, v251
    v_mul_f32 v248, v23, v248
    v_accvgpr_read_b32 v249, a173
    v_mul_f32 v249, v23, v249
    v_cvt_pk_bf16_f32 v248, v248, v249
    v_cvt_pk_bf16_f32 v249, v250, v251
    v_accvgpr_read_b32 v250, a188
    v_mul_f32 v250, v23, v250
    v_accvgpr_read_b32 v251, a189
    v_mul_f32 v251, v23, v251
    v_cvt_pk_bf16_f32 v250, v250, v251
    v_cvt_pk_bf16_f32 v251, v30, v31
    v_mfma_f32_16x16x32_bf16 v[60:63], a[196:199], v[216:219], v[60:63]
    v_lshlrev_b32 v16, 4, v16
    v_lshlrev_b32 v7, 4, v7
    v_mfma_f32_16x16x32_bf16 v[44:47], a[192:195], v[216:219], v[44:47]
    s_waitcnt lgkmcnt(4)
    v_add_u32 v6, v6, v7
    v_add_u32 v7, 20480, v6
    v_mfma_f32_16x16x32_bf16 a[236:239], a[200:203], v[248:251], a[236:239]
    s_waitcnt vmcnt(13)
    ds_read_b64_tr_b16 a[192:193], v8 offset:13312
    v_add_u32 v29, 147456, v28
    v_mfma_f32_16x16x32_bf16 a[252:255], a[204:207], v[248:251], a[252:255]
    ds_read_b64_tr_b16 a[194:195], v8 offset:19456
    v_mfma_f32_16x16x32_bf16 a[248:251], a[204:207], v[240:243], a[248:251]
    buffer_atomic_or v16, v17, s[24:27], 0 offen
    v_mfma_f32_16x16x32_bf16 a[232:235], a[200:203], v[240:243], a[232:235]
    buffer_load_dwordx4 a[12:15], v28, s[20:23], s8 offen offset:3072 sc1
    v_mfma_f32_16x16x32_bf16 a[228:231], a[200:203], v[232:235], a[228:231]
    s_add_u32 s8, s8, 4096
    ds_read_b64_tr_b16 a[196:197], v9 offset:13312
    v_add_u32 v8, 24576, v12
    v_mfma_f32_16x16x32_bf16 a[244:247], a[204:207], v[232:235], a[244:247]
    ds_read_b64_tr_b16 a[198:199], v9 offset:19456
    v_mfma_f32_16x16x32_bf16 a[240:243], a[204:207], v[224:227], a[240:243]
    v_add_u32 v9, 24576, v13
    v_mfma_f32_16x16x32_bf16 a[224:227], a[200:203], v[224:227], a[224:227]
    s_waitcnt lgkmcnt(4)
    buffer_store_dwordx4 v[184:187], v28, s[20:23], s55 offen offset:3072 sc1
    v_mfma_f32_16x16x32_bf16 v[68:71], a[208:211], v[224:227], v[68:71]
    s_add_u32 s55, s55, 12288
    ds_read_b64_tr_b16 a[200:201], v10 offset:13312
    s_mov_b32 s16, s64
    v_mfma_f32_16x16x32_bf16 v[100:103], a[212:215], v[224:227], v[100:103]
    s_and_b32 s17, s65, 0xffff
    ds_read_b64_tr_b16 a[202:203], v10 offset:19456
    s_mov_b32 s18, 2621440
    v_mfma_f32_16x16x32_bf16 v[108:111], a[212:215], v[232:235], v[108:111]
    s_mov_b32 s19, 0x00020000
    v_add_u32 v10, 24576, v14
    s_lshl_b32 s45, s52, 4
    v_mfma_f32_16x16x32_bf16 v[76:79], a[208:211], v[232:235], v[76:79]
    s_lshl_b32 s56, s53, 1
    s_add_u32 s45, s45, s56
    s_and_b32 s56, s3, 1
    v_mfma_f32_16x16x32_bf16 v[84:87], a[208:211], v[240:243], v[84:87]
    s_add_u32 s45, s45, s56
    ds_read_b64_tr_b16 a[204:205], v11 offset:13312
    s_lshl_b32 s56, s45, 4
    v_mfma_f32_16x16x32_bf16 v[116:119], a[212:215], v[240:243], v[116:119]
    ds_read_b64_tr_b16 a[206:207], v11 offset:19456
    v_and_b32 v20, 15, v1
    v_mfma_f32_16x16x32_bf16 v[124:127], a[212:215], v[248:251], v[124:127]
    buffer_load_dwordx4 a[16:19], v28, s[20:23], s9 offen offset:0 sc1
    v_mfma_f32_16x16x32_bf16 v[92:95], a[208:211], v[248:251], v[92:95]
    s_waitcnt lgkmcnt(4)
    v_add_u32 v20, s56, v20
    v_bfe_u32 v21, v1, 4, 1
    v_mfma_f32_16x16x32_bf16 v[156:159], a[192:195], v[248:251], v[156:159]
    ds_read_b64_tr_b16 a[208:209], v18 offset:14336
    v_bfe_u32 v22, v1, 5, 1
    v_mfma_f32_16x16x32_bf16 v[188:191], a[196:199], v[248:251], v[188:191]
    ds_read_b64_tr_b16 a[210:211], v18 offset:20480
    v_lshl_add_u32 v21, v21, 1, v22
    v_mfma_f32_16x16x32_bf16 v[180:183], a[196:199], v[240:243], v[180:183]
    buffer_store_dwordx4 v[192:195], v28, s[20:23], s55 offen offset:0 sc1
    v_mfma_f32_16x16x32_bf16 v[148:151], a[192:195], v[240:243], v[148:151]
    v_mul_u32_u24 v22, 1280, v20
    v_lshl_add_u32 v22, v21, 4, v22
    v_mfma_f32_16x16x32_bf16 v[140:143], a[192:195], v[232:235], v[140:143]
    ds_read_b64_tr_b16 a[212:213], v19 offset:14336
    v_lshlrev_b32 v23, 3, v20
    v_mfma_f32_16x16x32_bf16 v[172:175], a[196:199], v[232:235], v[172:175]
    s_waitcnt vmcnt(49)
    ds_read_b64_tr_b16 a[214:215], v19 offset:20480
    v_add_u32 v11, 24576, v15
    v_mfma_f32_16x16x32_bf16 v[164:167], a[196:199], v[224:227], v[164:167]
    s_barrier
    v_mfma_f32_16x16x32_bf16 v[132:135], a[192:195], v[224:227], v[132:135]
    s_waitcnt lgkmcnt(4)
    buffer_load_dwordx4 a[20:23], v28, s[20:23], s9 offen offset:1024 sc1
    v_mfma_f32_16x16x32_bf16 v[196:199], a[200:203], v[224:227], v[196:199]
    s_mul_i32 s56, s51, 5
    ds_read_b64_tr_b16 a[192:193], v8 offset:0
    v_xor_b32 v18, s39, v8
    v_mfma_f32_16x16x32_bf16 v[228:231], a[204:207], v[224:227], v[228:231]
    s_lshr_b32 s6, s3, 1
    ds_read_b64_tr_b16 a[194:195], v8 offset:6144
    v_xor_b32 v19, s39, v9
    v_mfma_f32_16x16x32_bf16 v[236:239], a[204:207], v[232:235], v[236:239]
    buffer_load_dwordx4 a[24:27], v28, s[20:23], s9 offen offset:2048 sc1
    v_mfma_f32_16x16x32_bf16 v[204:207], a[200:203], v[232:235], v[204:207]
    s_add_u32 s41, s56, s6
    s_add_u32 s42, s56, 2
    s_add_u32 s43, s56, 4
    v_mfma_f32_16x16x32_bf16 v[212:215], a[200:203], v[240:243], v[212:215]
    s_sub_u32 s43, s43, s6
    ds_read_b64_tr_b16 a[196:197], v9 offset:0
    s_lshr_b32 s48, s45, 2
    v_mfma_f32_16x16x32_bf16 v[244:247], a[204:207], v[240:243], v[244:247]
    s_lshr_b32 s56, s48, 1
    ds_read_b64_tr_b16 a[198:199], v9 offset:6144
    s_lshl_b32 s56, s56, 19
    v_mfma_f32_16x16x32_bf16 v[252:255], a[204:207], v[248:251], v[252:255]
    buffer_load_dwordx4 a[28:31], v28, s[20:23], s9 offen offset:3072 sc1
    v_mfma_f32_16x16x32_bf16 v[220:223], a[200:203], v[248:251], v[220:223]
    s_waitcnt lgkmcnt(4)
    s_add_u32 s9, s9, 4096
    s_and_b32 s40, s48, 1
    v_mfma_f32_16x16x32_bf16 v[44:47], a[208:211], v[248:251], v[44:47]
    s_lshl_b32 s40, s40, 12
    ds_read_b64_tr_b16 a[200:201], v10 offset:0
    s_or_b32 s56, s56, s40
    v_mfma_f32_16x16x32_bf16 v[60:63], a[212:215], v[248:251], v[60:63]
    s_lshl_b32 s40, s48, 10
    ds_read_b64_tr_b16 a[202:203], v10 offset:6144
    s_and_b32 s40, s40, 0x2000
    v_mfma_f32_16x16x32_bf16 v[56:59], a[212:215], v[240:243], v[56:59]
    buffer_store_dwordx4 v[200:203], v28, s[20:23], s55 offen offset:1024 sc1
    v_mfma_f32_16x16x32_bf16 v[40:43], a[208:211], v[240:243], v[40:43]
    s_or_b32 s56, s56, s40
    s_or_b32 s56, s56, 201326592
    s_and_b32 s45, s45, 3
    v_mfma_f32_16x16x32_bf16 v[36:39], a[208:211], v[232:235], v[36:39]
    s_lshl_b32 s45, s45, 10
    ds_read_b64_tr_b16 a[204:205], v11 offset:0
    s_add_u32 s45, s45, s56
    v_mfma_f32_16x16x32_bf16 v[52:55], a[212:215], v[232:235], v[52:55]
    s_waitcnt vmcnt(7)
    ds_read_b64_tr_b16 a[206:207], v11 offset:6144
    s_lshl_b32 s47, s41, 14
    v_mfma_f32_16x16x32_bf16 v[48:51], a[212:215], v[224:227], v[48:51]
    s_add_u32 s47, s47, s45
    s_sub_u32 s41, s41, s51
    s_lshl_b32 s48, s42, 14
    v_mfma_f32_16x16x32_bf16 v[32:35], a[208:211], v[224:227], v[32:35]
    s_waitcnt lgkmcnt(4)
    buffer_load_dwordx4 a[32:35], v28, s[20:23], s10 offen offset:0 sc1
    v_mfma_f32_16x16x32_bf16 a[224:227], a[192:195], a[0:3], a[224:227]
    s_load_dword s72, s[86:87], s5 offset:4 glc
    ds_read_b64_tr_b16 a[208:209], v8 offset:1024
    s_add_u32 s48, s48, s45
    v_mfma_f32_16x16x32_bf16 a[240:243], a[196:199], a[0:3], a[240:243]
    s_sub_u32 s42, s42, s51
    ds_read_b64_tr_b16 a[210:211], v8 offset:7168
    s_lshl_b32 s40, s43, 14
    v_mfma_f32_16x16x32_bf16 a[244:247], a[196:199], a[4:7], a[244:247]
    s_add_u32 s40, s40, s45
    ds_read_b128 v[64:67], v29 offset:0
    s_sub_u32 s43, s43, s51
    v_mfma_f32_16x16x32_bf16 a[228:231], a[192:195], a[4:7], a[228:231]
    s_add_u32 s56, s51, 16
    ds_read_b128 v[72:75], v29 offset:1024
    s_cmp_lt_u32 s3, 2
    s_cselect_b32 s43, s56, s43
    v_mfma_f32_16x16x32_bf16 a[232:235], a[192:195], a[8:11], a[232:235]
    s_lshl_b32 s41, s41, 6
    ds_read_b64_tr_b16 a[212:213], v9 offset:1024
    s_lshl_b32 s42, s42, 6
    v_mfma_f32_16x16x32_bf16 a[248:251], a[196:199], a[8:11], a[248:251]
    s_lshl_b32 s43, s43, 6
    ds_read_b64_tr_b16 a[214:215], v9 offset:7168
    v_add_u32 v23, 3211264, v23
    v_mfma_f32_16x16x32_bf16 a[252:255], a[196:199], a[12:15], a[252:255]
pg_9:
    s_cbranch_execz pg_13
    ds_read_b128 v[80:83], v29 offset:2048
    v_mfma_f32_16x16x32_bf16 a[236:239], a[192:195], a[12:15], a[236:239]
    s_waitcnt lgkmcnt(4)
    buffer_store_dwordx4 v[208:211], v28, s[20:23], s55 offen offset:2048 sc1
    v_mfma_f32_16x16x32_bf16 v[92:95], a[200:203], a[12:15], v[92:95]
    ds_read_b64_tr_b16 a[192:193], v10 offset:1024
    v_mfma_f32_16x16x32_bf16 v[124:127], a[204:207], a[12:15], v[124:127]
    ds_read_b64_tr_b16 a[194:195], v10 offset:7168
    v_mfma_f32_16x16x32_bf16 v[116:119], a[204:207], a[8:11], v[116:119]
    ds_read_b128 v[88:91], v29 offset:3072
    v_mfma_f32_16x16x32_bf16 v[84:87], a[200:203], a[8:11], v[84:87]
    ds_read_b128 v[96:99], v29 offset:4096
    v_mfma_f32_16x16x32_bf16 v[76:79], a[200:203], a[4:7], v[76:79]
    ds_read_b64_tr_b16 a[196:197], v11 offset:1024
    v_mfma_f32_16x16x32_bf16 v[108:111], a[204:207], a[4:7], v[108:111]
    ds_read_b64_tr_b16 a[198:199], v11 offset:7168
    v_mfma_f32_16x16x32_bf16 v[100:103], a[204:207], a[0:3], v[100:103]
    ds_read_b128 v[104:107], v29 offset:5120
    v_mfma_f32_16x16x32_bf16 v[68:71], a[200:203], a[0:3], v[68:71]
    s_waitcnt lgkmcnt(4)
    buffer_load_dwordx4 a[36:39], v28, s[20:23], s10 offen offset:1024 sc1
    v_mfma_f32_16x16x32_bf16 v[132:135], a[208:211], a[0:3], v[132:135]
    ds_read_b64_tr_b16 a[200:201], v18 offset:2048
    v_lshlrev_b32 v16, 4, v16
    v_mfma_f32_16x16x32_bf16 v[164:167], a[212:215], a[0:3], v[164:167]
    s_waitcnt vmcnt(9)
    ds_read_b64_tr_b16 a[202:203], v18 offset:8192
    v_mfma_f32_16x16x32_bf16 v[172:175], a[212:215], a[4:7], v[172:175]
    ds_read_b128 v[112:115], v29 offset:6144
    v_mfma_f32_16x16x32_bf16 v[140:143], a[208:211], a[4:7], v[140:143]
    ds_read_b128 v[120:123], v29 offset:7168
    v_mfma_f32_16x16x32_bf16 v[148:151], a[208:211], a[8:11], v[148:151]
    ds_read_b64_tr_b16 a[204:205], v19 offset:2048
    v_mfma_f32_16x16x32_bf16 v[180:183], a[212:215], a[8:11], v[180:183]
    ds_read_b64_tr_b16 a[206:207], v19 offset:8192
    v_mfma_f32_16x16x32_bf16 v[188:191], a[212:215], a[12:15], v[188:191]
    ds_read_b128 v[128:131], v29 offset:8192
    v_mfma_f32_16x16x32_bf16 v[156:159], a[208:211], a[12:15], v[156:159]
    s_waitcnt lgkmcnt(4)
    buffer_atomic_or v16, v17, s[24:27], 0 offen
    v_mfma_f32_16x16x32_bf16 v[220:223], a[192:195], a[12:15], v[220:223]
    ds_read_b64_tr_b16 a[208:209], v8 offset:12288
    v_mfma_f32_16x16x32_bf16 v[252:255], a[196:199], a[12:15], v[252:255]
    ds_read_b64_tr_b16 a[210:211], v8 offset:18432
    v_mfma_f32_16x16x32_bf16 v[244:247], a[196:199], a[8:11], v[244:247]
    ds_read_b128 v[136:139], v29 offset:9216
    v_mfma_f32_16x16x32_bf16 v[212:215], a[192:195], a[8:11], v[212:215]
    buffer_store_dwordx4 v[216:219], v28, s[20:23], s55 offen offset:3072 sc1
    v_mfma_f32_16x16x32_bf16 v[204:207], a[192:195], a[4:7], v[204:207]
    s_add_u32 s55, s55, 4096
    ds_read_b64_tr_b16 a[212:213], v9 offset:12288
    v_mfma_f32_16x16x32_bf16 v[236:239], a[196:199], a[4:7], v[236:239]
    ds_read_b64_tr_b16 a[214:215], v9 offset:18432
    v_mfma_f32_16x16x32_bf16 v[228:231], a[196:199], a[0:3], v[228:231]
    buffer_load_dwordx4 a[40:43], v28, s[20:23], s10 offen offset:2048 sc1
    v_mfma_f32_16x16x32_bf16 v[196:199], a[192:195], a[0:3], v[196:199]
    s_waitcnt lgkmcnt(4)
    v_mfma_f32_16x16x32_bf16 v[32:35], a[200:203], a[0:3], v[32:35]
    ds_read_b64_tr_b16 a[192:193], v10 offset:12288
    v_mfma_f32_16x16x32_bf16 v[48:51], a[204:207], a[0:3], v[48:51]
    ds_read_b64_tr_b16 a[194:195], v10 offset:18432
    v_mfma_f32_16x16x32_bf16 v[52:55], a[204:207], a[4:7], v[52:55]
    s_bfe_u32 s88, s72, 262148
    s_cmp_lg_u32 s88, 15
    s_cbranch_scc1 spin_o1
spin_o1_ret:
    v_mfma_f32_16x16x32_bf16 v[36:39], a[200:203], a[4:7], v[36:39]
    buffer_load_dwordx4 a[44:47], v28, s[20:23], s10 offen offset:3072 sc1
    v_mfma_f32_16x16x32_bf16 v[40:43], a[200:203], a[8:11], v[40:43]
    s_add_u32 s10, s10, 4096
    ds_read_b64_tr_b16 a[196:197], v11 offset:12288
    v_mfma_f32_16x16x32_bf16 v[56:59], a[204:207], a[8:11], v[56:59]
    s_waitcnt vmcnt(8)
    ds_read_b64_tr_b16 a[198:199], v11 offset:18432
    v_mfma_f32_16x16x32_bf16 v[60:63], a[204:207], a[12:15], v[60:63]
    buffer_load_dwordx4 a[48:51], v28, s[20:23], s8 offen offset:0 sc1
    v_mfma_f32_16x16x32_bf16 v[44:47], a[200:203], a[12:15], v[44:47]
    s_waitcnt lgkmcnt(4)
    v_mfma_f32_16x16x32_bf16 a[236:239], a[208:211], a[28:31], a[236:239]
    ds_read_b64_tr_b16 a[200:201], v8 offset:13312
    v_mfma_f32_16x16x32_bf16 a[252:255], a[212:215], a[28:31], a[252:255]
    ds_read_b64_tr_b16 a[202:203], v8 offset:19456
    v_mfma_f32_16x16x32_bf16 a[248:251], a[212:215], a[24:27], a[248:251]
    v_add_u32 v8, 73728, v12
    v_mfma_f32_16x16x32_bf16 a[232:235], a[208:211], a[24:27], a[232:235]
    buffer_load_dwordx4 a[52:55], v28, s[20:23], s8 offen offset:1024 sc1
    v_mfma_f32_16x16x32_bf16 a[228:231], a[208:211], a[20:23], a[228:231]
    ds_read_b64_tr_b16 a[204:205], v9 offset:13312
    v_add_f32 v64, v64, v72
    buffer_store_dwordx4 v[224:227], v28, s[20:23], s55 offen offset:0 sc1
    v_mfma_f32_16x16x32_bf16 a[244:247], a[212:215], a[20:23], a[244:247]
    ds_read_b64_tr_b16 a[206:207], v9 offset:19456
    v_add_f32 v65, v65, v73
    v_mfma_f32_16x16x32_bf16 a[240:243], a[212:215], a[16:19], a[240:243]
    v_add_f32 v66, v66, v74
    v_add_f32 v67, v67, v75
    v_mfma_f32_16x16x32_bf16 a[224:227], a[208:211], a[16:19], a[224:227]
    s_waitcnt lgkmcnt(4)
    v_add_f32 v64, v64, v80
    v_add_f32 v65, v65, v81
    v_mfma_f32_16x16x32_bf16 v[68:71], a[192:195], a[16:19], v[68:71]
    ds_read_b64_tr_b16 a[208:209], v10 offset:13312
    v_add_f32 v66, v66, v82
    v_mfma_f32_16x16x32_bf16 v[100:103], a[196:199], a[16:19], v[100:103]
    ds_read_b64_tr_b16 a[210:211], v10 offset:19456
    v_add_f32 v67, v67, v83
    v_mfma_f32_16x16x32_bf16 v[108:111], a[196:199], a[20:23], v[108:111]
    v_add_f32 v64, v64, v88
    v_add_f32 v65, v65, v89
    v_mfma_f32_16x16x32_bf16 v[76:79], a[192:195], a[20:23], v[76:79]
    buffer_load_dwordx4 a[56:59], v28, s[20:23], s8 offen offset:2048 sc1
    v_mfma_f32_16x16x32_bf16 v[84:87], a[192:195], a[24:27], v[84:87]
    ds_read_b64_tr_b16 a[212:213], v11 offset:13312
    v_add_f32 v66, v66, v90
    v_mfma_f32_16x16x32_bf16 v[116:119], a[196:199], a[24:27], v[116:119]
    ds_read_b64_tr_b16 a[214:215], v11 offset:19456
    v_add_f32 v67, v67, v91
    v_mfma_f32_16x16x32_bf16 v[124:127], a[196:199], a[28:31], v[124:127]
    v_add_f32 v64, v64, v96
    v_add_f32 v65, v65, v97
    v_mfma_f32_16x16x32_bf16 v[92:95], a[192:195], a[28:31], v[92:95]
    s_waitcnt lgkmcnt(4)
    v_add_f32 v66, v66, v98
    v_add_f32 v67, v67, v99
    v_mfma_f32_16x16x32_bf16 v[156:159], a[200:203], a[28:31], v[156:159]
    ds_read_b64_tr_b16 a[192:193], v18 offset:14336
    v_add_f32 v64, v64, v104
    v_mfma_f32_16x16x32_bf16 v[188:191], a[204:207], a[28:31], v[188:191]
    ds_read_b64_tr_b16 a[194:195], v18 offset:20480
    v_add_f32 v65, v65, v105
    v_mfma_f32_16x16x32_bf16 v[180:183], a[204:207], a[24:27], v[180:183]
    buffer_load_dwordx4 a[60:63], v28, s[20:23], s8 offen offset:3072 sc1
    v_mfma_f32_16x16x32_bf16 v[148:151], a[200:203], a[24:27], v[148:151]
    s_add_u32 s8, s8, 12288
    v_add_f32 v66, v66, v106
    v_add_f32 v67, v67, v107
    buffer_store_dwordx4 v[232:235], v28, s[20:23], s55 offen offset:1024 sc1
    v_mfma_f32_16x16x32_bf16 v[140:143], a[200:203], a[20:23], v[140:143]
    ds_read_b64_tr_b16 a[196:197], v19 offset:14336
    v_add_f32 v64, v64, v112
    v_mfma_f32_16x16x32_bf16 v[172:175], a[204:207], a[20:23], v[172:175]
    s_waitcnt vmcnt(56)
    ds_read_b64_tr_b16 a[198:199], v19 offset:20480
    v_add_f32 v65, v65, v113
    v_mfma_f32_16x16x32_bf16 v[164:167], a[204:207], a[16:19], v[164:167]
    s_barrier
    v_mfma_f32_16x16x32_bf16 v[132:135], a[200:203], a[16:19], v[132:135]
    s_waitcnt lgkmcnt(4)
    v_add_f32 v66, v66, v114
    v_add_f32 v67, v67, v115
    v_mfma_f32_16x16x32_bf16 v[196:199], a[208:211], a[16:19], v[196:199]
    ds_read_b64_tr_b16 a[200:201], v8 offset:0
    v_add_f32 v64, v64, v120
    v_mfma_f32_16x16x32_bf16 v[228:231], a[212:215], a[16:19], v[228:231]
    ds_read_b64_tr_b16 a[202:203], v8 offset:6144
    v_add_f32 v65, v65, v121
    v_mfma_f32_16x16x32_bf16 v[236:239], a[212:215], a[20:23], v[236:239]
    buffer_store_dwordx4 v[240:243], v28, s[20:23], s55 offen offset:2048 sc1
    v_mfma_f32_16x16x32_bf16 v[204:207], a[208:211], a[20:23], v[204:207]
    v_add_f32 v66, v66, v122
    v_add_f32 v67, v67, v123
    v_add_u32 v9, 73728, v13
    v_mfma_f32_16x16x32_bf16 v[212:215], a[208:211], a[24:27], v[212:215]
    ds_read_b64_tr_b16 a[204:205], v9 offset:0
    v_add_f32 v64, v64, v128
    v_mfma_f32_16x16x32_bf16 v[244:247], a[212:215], a[24:27], v[244:247]
    ds_read_b64_tr_b16 a[206:207], v9 offset:6144
    v_add_f32 v65, v65, v129
    v_mfma_f32_16x16x32_bf16 v[252:255], a[212:215], a[28:31], v[252:255]
    buffer_load_dwordx4 a[64:67], v28, s[20:23], s9 offen offset:0 sc1
    v_mfma_f32_16x16x32_bf16 v[220:223], a[208:211], a[28:31], v[220:223]
    s_waitcnt lgkmcnt(4)
    v_add_f32 v66, v66, v130
    v_add_f32 v67, v67, v131
    v_add_u32 v10, 73728, v14
    v_mfma_f32_16x16x32_bf16 v[44:47], a[192:195], a[28:31], v[44:47]
    s_load_dword s72, s[86:87], s5 offset:4 glc
    ds_read_b64_tr_b16 a[208:209], v10 offset:0
    v_add_f32 v64, v64, v136
    v_mfma_f32_16x16x32_bf16 v[60:63], a[196:199], a[28:31], v[60:63]
    ds_read_b64_tr_b16 a[210:211], v10 offset:6144
    v_add_f32 v65, v65, v137
    v_mfma_f32_16x16x32_bf16 v[56:59], a[196:199], a[24:27], v[56:59]
    buffer_load_dwordx4 a[68:71], v28, s[20:23], s9 offen offset:1024 sc1
    v_mfma_f32_16x16x32_bf16 v[40:43], a[192:195], a[24:27], v[40:43]
    v_lshlrev_b32 v16, 4, v16
    v_add_f32 v66, v66, v138
    v_add_u32 v11, 73728, v15
    v_mfma_f32_16x16x32_bf16 v[36:39], a[192:195], a[20:23], v[36:39]
    s_waitcnt vmcnt(11)
    ds_read_b64_tr_b16 a[212:213], v11 offset:0
    v_add_f32 v67, v67, v139
    v_mfma_f32_16x16x32_bf16 v[52:55], a[196:199], a[20:23], v[52:55]
    s_waitcnt vmcnt(9)
    ds_read_b64_tr_b16 a[214:215], v11 offset:6144
    v_cvt_pk_bf16_f32 v64, v64, v64
    v_mfma_f32_16x16x32_bf16 v[48:51], a[196:199], a[16:19], v[48:51]
    buffer_atomic_or v16, v17, s[24:27], 0 offen
    v_mfma_f32_16x16x32_bf16 v[32:35], a[192:195], a[16:19], v[32:35]
    s_waitcnt lgkmcnt(4)
    buffer_load_dwordx4 a[72:75], v28, s[20:23], s9 offen offset:2048 sc1
    v_mfma_f32_16x16x32_bf16 a[224:227], a[200:203], a[32:35], a[224:227]
    ds_read_b64_tr_b16 a[192:193], v8 offset:1024
    v_and_b32 v64, 0xffff0000, v64
    v_mfma_f32_16x16x32_bf16 a[240:243], a[204:207], a[32:35], a[240:243]
    ds_read_b64_tr_b16 a[194:195], v8 offset:7168
    v_cvt_pk_bf16_f32 v65, v65, v65
    v_mfma_f32_16x16x32_bf16 a[244:247], a[204:207], a[36:39], a[244:247]
    buffer_store_dwordx4 v[248:251], v28, s[20:23], s55 offen offset:3072 sc1
    v_mfma_f32_16x16x32_bf16 a[228:231], a[200:203], a[36:39], a[228:231]
    s_add_u32 s55, s55, 12288
    v_and_b32 v65, 0xffff0000, v65
    v_cvt_pk_bf16_f32 v66, v66, v66
    v_mfma_f32_16x16x32_bf16 a[232:235], a[200:203], a[40:43], a[232:235]
    ds_read_b64_tr_b16 a[196:197], v9 offset:1024
    v_and_b32 v66, 0xffff0000, v66
    v_mfma_f32_16x16x32_bf16 a[248:251], a[204:207], a[40:43], a[248:251]
    ds_read_b64_tr_b16 a[198:199], v9 offset:7168
    v_cvt_pk_bf16_f32 v67, v67, v67
    v_mfma_f32_16x16x32_bf16 a[252:255], a[204:207], a[44:47], a[252:255]
    v_and_b32 v67, 0xffff0000, v67
    v_mul_f32 v72, s92, v64
    v_mfma_f32_16x16x32_bf16 a[236:239], a[200:203], a[44:47], a[236:239]
    s_waitcnt lgkmcnt(4)
    buffer_load_dwordx4 a[76:79], v28, s[20:23], s9 offen offset:3072 sc1
    v_mfma_f32_16x16x32_bf16 v[92:95], a[208:211], a[44:47], v[92:95]
    s_add_u32 s9, s9, 12288
    ds_read_b64_tr_b16 a[200:201], v10 offset:1024
    v_xor_b32 v18, s39, v8
    v_mfma_f32_16x16x32_bf16 v[124:127], a[212:215], a[44:47], v[124:127]
    ds_read_b64_tr_b16 a[202:203], v10 offset:7168
    v_xor_b32 v19, s39, v9
    v_mfma_f32_16x16x32_bf16 v[116:119], a[212:215], a[40:43], v[116:119]
    v_exp_f32 v72, v72
    v_mfma_f32_16x16x32_bf16 v[84:87], a[208:211], a[40:43], v[84:87]
    buffer_load_dwordx4 a[80:83], v28, s[20:23], s10 offen offset:0 sc1
    v_mfma_f32_16x16x32_bf16 v[76:79], a[208:211], a[36:39], v[76:79]
    ds_read_b64_tr_b16 a[204:205], v11 offset:1024
    v_add_f32 v72, 1.0, v72
    v_mfma_f32_16x16x32_bf16 v[108:111], a[212:215], a[36:39], v[108:111]
    ds_read_b64_tr_b16 a[206:207], v11 offset:7168
    v_mfma_f32_16x16x32_bf16 v[100:103], a[212:215], a[32:35], v[100:103]
    v_rcp_f32 v72, v72
    v_mfma_f32_16x16x32_bf16 v[68:71], a[208:211], a[32:35], v[68:71]
    s_waitcnt lgkmcnt(4)
    buffer_load_dwordx4 a[84:87], v28, s[20:23], s10 offen offset:1024 sc1
    v_mfma_f32_16x16x32_bf16 v[132:135], a[192:195], a[32:35], v[132:135]
    ds_read_b64_tr_b16 a[208:209], v18 offset:2048
    v_mul_f32 v64, v64, v72
    v_mfma_f32_16x16x32_bf16 v[164:167], a[196:199], a[32:35], v[164:167]
    ds_read_b64_tr_b16 a[210:211], v18 offset:8192
    v_cvt_pk_bf16_f32 v64, v64, v64
    v_mfma_f32_16x16x32_bf16 v[172:175], a[196:199], a[36:39], v[172:175]
    v_and_b32 v64, 0xffff0000, v64
    v_mul_f32 v64, v64, v66
    v_mfma_f32_16x16x32_bf16 v[140:143], a[192:195], a[36:39], v[140:143]
    v_mul_f32 v73, s92, v65
    v_mfma_f32_16x16x32_bf16 v[148:151], a[192:195], a[40:43], v[148:151]
    ds_read_b64_tr_b16 a[212:213], v19 offset:2048
    v_mfma_f32_16x16x32_bf16 v[180:183], a[196:199], a[40:43], v[180:183]
    ds_read_b64_tr_b16 a[214:215], v19 offset:8192
    v_mfma_f32_16x16x32_bf16 v[188:191], a[196:199], a[44:47], v[188:191]
    buffer_load_dwordx4 a[88:91], v28, s[20:23], s10 offen offset:2048 sc1
    v_mfma_f32_16x16x32_bf16 v[156:159], a[192:195], a[44:47], v[156:159]
    s_waitcnt lgkmcnt(4)
    v_exp_f32 v73, v73
    v_mfma_f32_16x16x32_bf16 v[220:223], a[200:203], a[44:47], v[220:223]
    ds_read_b64_tr_b16 a[192:193], v8 offset:12288
    v_add_f32 v73, 1.0, v73
    v_mfma_f32_16x16x32_bf16 v[252:255], a[204:207], a[44:47], v[252:255]
    ds_read_b64_tr_b16 a[194:195], v8 offset:18432
    v_cmp_lt_u32 s[78:79], 31, v1
    v_mfma_f32_16x16x32_bf16 v[244:247], a[204:207], a[40:43], v[244:247]
    s_bfe_u32 s88, s72, 262152
    s_cmp_lg_u32 s88, 15
    s_cbranch_scc1 spin_o2
spin_o2_ret:
    v_mov_b32 v195, s70
    v_mfma_f32_16x16x32_bf16 v[212:215], a[200:203], a[40:43], v[212:215]
    buffer_load_dwordx4 a[92:95], v28, s[20:23], s10 offen offset:3072 sc1
    v_mfma_f32_16x16x32_bf16 v[204:207], a[200:203], a[36:39], v[204:207]
    s_add_u32 s10, s10, 12288
    ds_read_b64_tr_b16 a[196:197], v9 offset:12288
    v_mov_b32 v192, s71
    v_mfma_f32_16x16x32_bf16 v[236:239], a[204:207], a[36:39], v[236:239]
    ds_read_b64_tr_b16 a[198:199], v9 offset:18432
    v_cndmask_b32 v195, v195, v192, s[78:79]
    v_mfma_f32_16x16x32_bf16 v[228:231], a[204:207], a[32:35], v[228:231]
    buffer_load_dwordx4 a[96:99], v28, s[20:23], s8 offen offset:0 sc1
    v_mfma_f32_16x16x32_bf16 v[196:199], a[200:203], a[32:35], v[196:199]
    s_waitcnt lgkmcnt(4)
    v_rcp_f32 v73, v73
    v_mfma_f32_16x16x32_bf16 v[32:35], a[208:211], a[32:35], v[32:35]
    ds_read_b64_tr_b16 a[200:201], v10 offset:12288
    v_mul_f32 v65, v65, v73
    v_mfma_f32_16x16x32_bf16 v[48:51], a[212:215], a[32:35], v[48:51]
    ds_read_b64_tr_b16 a[202:203], v10 offset:18432
    v_cvt_pk_bf16_f32 v65, v65, v65
    v_mfma_f32_16x16x32_bf16 v[52:55], a[212:215], a[36:39], v[52:55]
    buffer_load_dwordx4 a[100:103], v28, s[20:23], s8 offen offset:1024 sc1
    v_mfma_f32_16x16x32_bf16 v[36:39], a[208:211], a[36:39], v[36:39]
    v_and_b32 v65, 0xffff0000, v65
    v_mul_f32 v65, v65, v67
    v_mfma_f32_16x16x32_bf16 v[40:43], a[208:211], a[40:43], v[40:43]
    ds_read_b64_tr_b16 a[204:205], v11 offset:12288
    v_cvt_pk_bf16_f32 v64, v64, v65
    v_mfma_f32_16x16x32_bf16 v[56:59], a[212:215], a[40:43], v[56:59]
    s_waitcnt vmcnt(14)
    ds_read_b64_tr_b16 a[206:207], v11 offset:18432
    v_bfe_u32 v194, v1, 3, 2
    v_mfma_f32_16x16x32_bf16 v[60:63], a[212:215], a[44:47], v[60:63]
    buffer_load_dwordx4 a[104:107], v28, s[20:23], s8 offen offset:2048 sc1
    v_mfma_f32_16x16x32_bf16 v[44:47], a[208:211], a[44:47], v[44:47]
    s_waitcnt lgkmcnt(4)
    v_mov_b32 v192, s41
    v_mov_b32 v193, s42
    v_mfma_f32_16x16x32_bf16 a[236:239], a[192:195], a[60:63], a[236:239]
    s_lshl_b32 s61, s3, 8
    ds_read_b64_tr_b16 a[208:209], v8 offset:13312
    v_cmp_eq_u32 s[78:79], 1, v194
    v_mfma_f32_16x16x32_bf16 a[252:255], a[196:199], a[60:63], a[252:255]
    s_add_u32 s61, s61, 157696
    ds_read_b64_tr_b16 a[210:211], v8 offset:19456
    v_lshlrev_b32 v80, 1, v1
    v_mfma_f32_16x16x32_bf16 a[248:251], a[196:199], a[56:59], a[248:251]
    v_add_u32 v80, s61, v80
    v_and_b32 v81, 1, v1
    v_mfma_f32_16x16x32_bf16 a[232:235], a[192:195], a[56:59], a[232:235]
    buffer_load_dwordx4 a[108:111], v28, s[20:23], s8 offen offset:3072 sc1
    v_mfma_f32_16x16x32_bf16 a[228:231], a[192:195], a[52:55], a[228:231]
    s_add_u32 s8, s8, 4096
    ds_read_b64_tr_b16 a[212:213], v9 offset:13312
    v_lshlrev_b32 v81, 7, v81
    v_mfma_f32_16x16x32_bf16 a[244:247], a[196:199], a[52:55], a[244:247]
    s_add_u32 m0, s44, 147456
    ds_read_b64_tr_b16 a[214:215], v9 offset:19456
    v_lshrrev_b32 v83, 4, v1
    v_mfma_f32_16x16x32_bf16 a[240:243], a[196:199], a[48:51], a[240:243]
    v_lshl_add_u32 v81, v83, 4, v81
    v_add_u32 v81, s61, v81
    v_mfma_f32_16x16x32_bf16 a[224:227], a[192:195], a[48:51], a[224:227]
    s_waitcnt lgkmcnt(4)
    buffer_load_dwordx4 v6, s[28:31], s59 offen lds
    v_mfma_f32_16x16x32_bf16 v[68:71], a[200:203], a[48:51], v[68:71]
    s_add_u32 m0, s44, 148480
    ds_read_b64_tr_b16 a[192:193], v10 offset:13312
    v_bfe_u32 v83, v1, 2, 3
    v_mfma_f32_16x16x32_bf16 v[100:103], a[204:207], a[48:51], v[100:103]
    ds_read_b64_tr_b16 a[194:195], v10 offset:19456
    v_lshlrev_b32 v82, 7, v83
    v_mfma_f32_16x16x32_bf16 v[108:111], a[204:207], a[52:55], v[108:111]
    v_lshrrev_b32 v83, 1, v83
    v_xor_b32 v83, s3, v83
    v_mfma_f32_16x16x32_bf16 v[76:79], a[200:203], a[52:55], v[76:79]
    buffer_load_dwordx4 v7, s[28:31], s59 offen lds
    v_mfma_f32_16x16x32_bf16 v[84:87], a[200:203], a[56:59], v[84:87]
    ds_read_b64_tr_b16 a[196:197], v11 offset:13312
    v_lshlrev_b32 v16, 4, v16
    v_mfma_f32_16x16x32_bf16 v[116:119], a[204:207], a[56:59], v[116:119]
    s_waitcnt vmcnt(11)
    ds_read_b64_tr_b16 a[198:199], v11 offset:19456
    v_lshl_add_u32 v82, v83, 5, v82
    v_mfma_f32_16x16x32_bf16 v[124:127], a[204:207], a[60:63], v[124:127]
    buffer_atomic_or v16, v17, s[24:27], 0 offen
    v_mfma_f32_16x16x32_bf16 v[92:95], a[200:203], a[60:63], v[92:95]
    s_waitcnt lgkmcnt(4)
    v_and_b32 v83, 3, v1
    v_lshl_add_u32 v82, v83, 3, v82
    v_mfma_f32_16x16x32_bf16 v[156:159], a[208:211], a[60:63], v[156:159]
    ds_read_b64_tr_b16 a[200:201], v18 offset:14336
    v_lshrrev_b32 v83, 5, v1
    v_mfma_f32_16x16x32_bf16 v[188:191], a[212:215], a[60:63], v[188:191]
    ds_read_b64_tr_b16 a[202:203], v18 offset:20480
    v_mul_u32_u24 v83, 1024, v83
    v_mfma_f32_16x16x32_bf16 v[180:183], a[212:215], a[56:59], v[180:183]
    buffer_load_dwordx4 a[112:115], v28, s[20:23], s9 offen offset:0 sc1
    v_mfma_f32_16x16x32_bf16 v[148:151], a[208:211], a[56:59], v[148:151]
    v_add_u32 v82, v82, v83
    v_add_u32 v82, 147456, v82
    v_mfma_f32_16x16x32_bf16 v[140:143], a[208:211], a[52:55], v[140:143]
    ds_read_b64_tr_b16 a[204:205], v19 offset:14336
    v_lshlrev_b32 v74, 2, v1
    v_mfma_f32_16x16x32_bf16 v[172:175], a[212:215], a[52:55], v[172:175]
    s_waitcnt vmcnt(63)
    ds_read_b64_tr_b16 a[206:207], v19 offset:20480
    v_cmp_gt_u32 vcc, 16, v1
    v_mfma_f32_16x16x32_bf16 v[164:167], a[212:215], a[48:51], v[164:167]
    s_barrier
    v_mfma_f32_16x16x32_bf16 v[132:135], a[208:211], a[48:51], v[132:135]
    s_waitcnt lgkmcnt(4)
    buffer_load_dwordx4 a[116:119], v28, s[20:23], s9 offen offset:1024 sc1
    v_add_u32 v8, 98304, v12
    v_mfma_f32_16x16x32_bf16 v[196:199], a[192:195], a[48:51], v[196:199]
    s_load_dword s72, s[86:87], s5 offset:4 glc
    ds_read_b64_tr_b16 a[208:209], v8 offset:0
    v_mov_b32 v83, 0x7ffffff0
    v_mfma_f32_16x16x32_bf16 v[228:231], a[196:199], a[48:51], v[228:231]
    ds_read_b64_tr_b16 a[210:211], v8 offset:6144
    v_cndmask_b32 v74, v83, v74, vcc
    v_mfma_f32_16x16x32_bf16 v[236:239], a[196:199], a[52:55], v[236:239]
    buffer_load_dwordx4 a[120:123], v28, s[20:23], s9 offen offset:2048 sc1
    v_mfma_f32_16x16x32_bf16 v[204:207], a[192:195], a[52:55], v[204:207]
    v_cndmask_b32 v192, v192, v193, s[78:79]
    v_mov_b32 v193, s43
    v_add_u32 v9, 98304, v13
    v_mfma_f32_16x16x32_bf16 v[212:215], a[192:195], a[56:59], v[212:215]
    ds_read_b64_tr_b16 a[212:213], v9 offset:0
    v_cmp_lt_u32 s[78:79], 1, v194
    v_mfma_f32_16x16x32_bf16 v[244:247], a[196:199], a[56:59], v[244:247]
    ds_read_b64_tr_b16 a[214:215], v9 offset:6144
    v_cndmask_b32 v192, v192, v193, s[78:79]
    v_mfma_f32_16x16x32_bf16 v[252:255], a[196:199], a[60:63], v[252:255]
    buffer_load_dwordx4 a[124:127], v28, s[20:23], s9 offen offset:3072 sc1
    v_mfma_f32_16x16x32_bf16 v[220:223], a[192:195], a[60:63], v[220:223]
    s_waitcnt lgkmcnt(4)
    v_and_b32 v193, 7, v1
    v_lshl_add_u32 v192, v193, 3, v192
    v_add_u32 v10, 98304, v14
    v_mfma_f32_16x16x32_bf16 v[44:47], a[200:203], a[60:63], v[44:47]
    s_add_u32 s9, s9, 4096
    ds_read_b64_tr_b16 a[192:193], v10 offset:0
    v_and_b32 v194, 0x7ff, v195
    v_mfma_f32_16x16x32_bf16 v[60:63], a[204:207], a[60:63], v[60:63]
    ds_read_b64_tr_b16 a[194:195], v10 offset:6144
    v_sub_u32 v194, 2047, v194
    v_mfma_f32_16x16x32_bf16 v[56:59], a[204:207], a[56:59], v[56:59]
    buffer_load_dwordx4 a[128:131], v28, s[20:23], s10 offen offset:0 sc1
    v_mfma_f32_16x16x32_bf16 v[40:43], a[200:203], a[56:59], v[40:43]
    v_mul_u32_u24 v193, 1280, v194
    v_add_u32 v193, v193, v192
    v_add_u32 v11, 98304, v15
    v_mfma_f32_16x16x32_bf16 v[36:39], a[200:203], a[52:55], v[36:39]
    ds_read_b64_tr_b16 a[196:197], v11 offset:0
    v_lshlrev_b32 v194, 3, v194
    v_mfma_f32_16x16x32_bf16 v[52:55], a[204:207], a[52:55], v[52:55]
    s_waitcnt vmcnt(16)
    ds_read_b64_tr_b16 a[198:199], v11 offset:6144
    v_add_u32 v194, 3211264, v194
    v_mfma_f32_16x16x32_bf16 v[48:51], a[204:207], a[48:51], v[48:51]
    v_xor_b32 v18, s39, v8
    v_xor_b32 v19, s39, v9
    v_mfma_f32_16x16x32_bf16 v[32:35], a[200:203], a[48:51], v[32:35]
    s_waitcnt lgkmcnt(4)
    buffer_load_dwordx4 a[132:135], v28, s[20:23], s10 offen offset:1024 sc1
    v_mfma_f32_16x16x32_bf16 a[224:227], a[208:211], a[64:67], a[224:227]
    ds_read_b64_tr_b16 a[200:201], v8 offset:1024
    v_mfma_f32_16x16x32_bf16 a[240:243], a[212:215], a[64:67], a[240:243]
    ds_read_b64_tr_b16 a[202:203], v8 offset:7168
    v_mfma_f32_16x16x32_bf16 a[244:247], a[212:215], a[68:71], a[244:247]
    v_mfma_f32_16x16x32_bf16 a[228:231], a[208:211], a[68:71], a[228:231]
    buffer_load_dwordx4 a[136:139], v28, s[20:23], s10 offen offset:2048 sc1
    v_mfma_f32_16x16x32_bf16 a[232:235], a[208:211], a[72:75], a[232:235]
    s_lshr_b32 s55, s54, 1
    ds_read_b64_tr_b16 a[204:205], v9 offset:1024
    v_mfma_f32_16x16x32_bf16 a[248:251], a[212:215], a[72:75], a[248:251]
    s_lshl_b32 s55, s55, 19
    ds_read_b64_tr_b16 a[206:207], v9 offset:7168
    v_mfma_f32_16x16x32_bf16 a[252:255], a[212:215], a[76:79], a[252:255]
    s_and_b32 s60, s54, 1
    s_lshl_b32 s60, s60, 12
    s_or_b32 s55, s55, s60
    v_mfma_f32_16x16x32_bf16 a[236:239], a[208:211], a[76:79], a[236:239]
    s_waitcnt lgkmcnt(4)
    buffer_load_dwordx4 a[140:143], v28, s[20:23], s10 offen offset:3072 sc1
    v_mfma_f32_16x16x32_bf16 v[92:95], a[192:195], a[76:79], v[92:95]
    s_add_u32 s10, s10, 4096
    ds_read_b64_tr_b16 a[208:209], v10 offset:1024
    s_lshl_b32 s60, s54, 10
    v_mfma_f32_16x16x32_bf16 v[124:127], a[196:199], a[76:79], v[124:127]
    s_and_b32 s60, s60, 0x2000
    ds_read_b64_tr_b16 a[210:211], v10 offset:7168
    s_or_b32 s55, s55, s60
    v_mfma_f32_16x16x32_bf16 v[116:119], a[196:199], a[72:75], v[116:119]
    s_or_b32 s55, s55, 201326592
    s_mul_i32 s60, s51, 81920
    s_add_u32 s55, s55, s60
    v_mfma_f32_16x16x32_bf16 v[84:87], a[192:195], a[72:75], v[84:87]
    s_mul_i32 s60, s53, 8389632
    s_xor_b32 s55, s55, s60
    s_add_u32 s60, s51, 8
    v_mfma_f32_16x16x32_bf16 v[76:79], a[192:195], a[68:71], v[76:79]
    s_lshr_b32 s60, s93, s60
    ds_read_b64_tr_b16 a[212:213], v11 offset:1024
    s_and_b32 s60, s60, 0x2000
    v_mfma_f32_16x16x32_bf16 v[108:111], a[196:199], a[68:71], v[108:111]
    s_xor_b32 s55, s55, s60
    ds_read_b64_tr_b16 a[214:215], v11 offset:7168
    v_mfma_f32_16x16x32_bf16 v[100:103], a[196:199], a[64:67], v[100:103]
    v_mfma_f32_16x16x32_bf16 v[68:71], a[192:195], a[64:67], v[68:71]
    s_waitcnt lgkmcnt(4)
    v_mfma_f32_16x16x32_bf16 v[132:135], a[200:203], a[64:67], v[132:135]
    ds_read_b64_tr_b16 a[192:193], v18 offset:2048
    v_mfma_f32_16x16x32_bf16 v[164:167], a[204:207], a[64:67], v[164:167]
    ds_read_b64_tr_b16 a[194:195], v18 offset:8192
    v_mfma_f32_16x16x32_bf16 v[172:175], a[204:207], a[68:71], v[172:175]
    s_bfe_u32 s88, s72, 262156
    s_cmp_lg_u32 s88, 15
    s_cbranch_scc1 spin_o3
spin_o3_ret:
    v_mfma_f32_16x16x32_bf16 v[140:143], a[200:203], a[68:71], v[140:143]
    v_mfma_f32_16x16x32_bf16 v[148:151], a[200:203], a[72:75], v[148:151]
    ds_read_b64_tr_b16 a[196:197], v19 offset:2048
    v_mfma_f32_16x16x32_bf16 v[180:183], a[204:207], a[72:75], v[180:183]
    ds_read_b64_tr_b16 a[198:199], v19 offset:8192
    v_mfma_f32_16x16x32_bf16 v[188:191], a[204:207], a[76:79], v[188:191]
    buffer_load_dwordx4 a[144:147], v28, s[20:23], s8 offen offset:0 sc1
    v_mfma_f32_16x16x32_bf16 v[156:159], a[200:203], a[76:79], v[156:159]
    s_waitcnt lgkmcnt(4)
    v_mfma_f32_16x16x32_bf16 v[220:223], a[208:211], a[76:79], v[220:223]
    ds_read_b64_tr_b16 a[200:201], v8 offset:12288
    v_mfma_f32_16x16x32_bf16 v[252:255], a[212:215], a[76:79], v[252:255]
    ds_read_b64_tr_b16 a[202:203], v8 offset:18432
    v_mfma_f32_16x16x32_bf16 v[244:247], a[212:215], a[72:75], v[244:247]
    buffer_load_dwordx2 v[24:25], v23, s[24:27], 0 offen sc1
    v_mfma_f32_16x16x32_bf16 v[212:215], a[208:211], a[72:75], v[212:215]
    buffer_load_dwordx4 a[148:151], v28, s[20:23], s8 offen offset:1024 sc1
    v_mfma_f32_16x16x32_bf16 v[204:207], a[208:211], a[68:71], v[204:207]
    ds_read_b64_tr_b16 a[204:205], v9 offset:12288
    v_mfma_f32_16x16x32_bf16 v[236:239], a[212:215], a[68:71], v[236:239]
    ds_read_b64_tr_b16 a[206:207], v9 offset:18432
    v_mfma_f32_16x16x32_bf16 v[228:231], a[212:215], a[64:67], v[228:231]
    buffer_load_dwordx2 v[200:201], v193, s[16:19], 0 offen
    v_mfma_f32_16x16x32_bf16 v[196:199], a[208:211], a[64:67], v[196:199]
    s_waitcnt lgkmcnt(4)
    buffer_load_dwordx4 a[152:155], v28, s[20:23], s8 offen offset:2048 sc1
    v_mfma_f32_16x16x32_bf16 v[32:35], a[192:195], a[64:67], v[32:35]
    ds_read_b64_tr_b16 a[208:209], v10 offset:12288
    v_mfma_f32_16x16x32_bf16 v[48:51], a[196:199], a[64:67], v[48:51]
    ds_read_b64_tr_b16 a[210:211], v10 offset:18432
    v_mfma_f32_16x16x32_bf16 v[52:55], a[196:199], a[68:71], v[52:55]
    buffer_load_dwordx2 v[202:203], v194, s[24:27], 0 offen sc1
    v_mfma_f32_16x16x32_bf16 v[36:39], a[192:195], a[68:71], v[36:39]
    buffer_load_dwordx4 a[156:159], v28, s[20:23], s8 offen offset:3072 sc1
    v_mfma_f32_16x16x32_bf16 v[40:43], a[192:195], a[72:75], v[40:43]
    s_add_u32 s8, s8, 12288
    ds_read_b64_tr_b16 a[212:213], v11 offset:12288
    v_mfma_f32_16x16x32_bf16 v[56:59], a[196:199], a[72:75], v[56:59]
    s_waitcnt vmcnt(22)
    ds_read_b64_tr_b16 a[214:215], v11 offset:18432
    v_mfma_f32_16x16x32_bf16 v[60:63], a[196:199], a[76:79], v[60:63]
    buffer_load_dwordx4 v[144:147], v22, s[16:19], s41 offen
    v_mfma_f32_16x16x32_bf16 v[44:47], a[192:195], a[76:79], v[44:47]
    s_waitcnt lgkmcnt(4)
    v_mfma_f32_16x16x32_bf16 a[236:239], a[200:203], a[92:95], a[236:239]
    ds_read_b64_tr_b16 a[192:193], v8 offset:13312
    v_mfma_f32_16x16x32_bf16 a[252:255], a[204:207], a[92:95], a[252:255]
    ds_read_b64_tr_b16 a[194:195], v8 offset:19456
    v_mfma_f32_16x16x32_bf16 a[248:251], a[204:207], a[88:91], a[248:251]
    v_add_u32 v8, 49152, v12
    v_mfma_f32_16x16x32_bf16 a[232:235], a[200:203], a[88:91], a[232:235]
    buffer_load_dwordx4 v[152:155], v22, s[16:19], s42 offen
    v_mfma_f32_16x16x32_bf16 a[228:231], a[200:203], a[84:87], a[228:231]
    ds_read_b64_tr_b16 a[196:197], v9 offset:13312
    v_lshrrev_b32 v136, 5, v192
    v_mfma_f32_16x16x32_bf16 a[244:247], a[204:207], a[84:87], a[244:247]
    ds_read_b64_tr_b16 a[198:199], v9 offset:19456
    v_lshlrev_b32 v136, 9, v136
    v_mfma_f32_16x16x32_bf16 a[240:243], a[204:207], a[80:83], a[240:243]
    v_and_b32 v192, 31, v192
    v_lshl_add_u32 v192, v192, 1, v136
    v_mfma_f32_16x16x32_bf16 a[224:227], a[200:203], a[80:83], a[224:227]
    s_waitcnt lgkmcnt(4)
    buffer_load_dwordx4 v[160:163], v22, s[16:19], s43 offen
    v_mfma_f32_16x16x32_bf16 v[68:71], a[208:211], a[80:83], v[68:71]
    ds_read_b64_tr_b16 a[200:201], v10 offset:13312
    v_lshrrev_b32 v193, 5, v1
    v_mfma_f32_16x16x32_bf16 v[100:103], a[212:215], a[80:83], v[100:103]
    ds_read_b64_tr_b16 a[202:203], v10 offset:19456
    v_lshl_add_u32 v192, v193, 8, v192
    v_mfma_f32_16x16x32_bf16 v[108:111], a[212:215], a[84:87], v[108:111]
    v_and_b32 v195, 0xffff0000, v195
    v_ashrrev_i32 v193, 31, v195
    v_mfma_f32_16x16x32_bf16 v[76:79], a[208:211], a[84:87], v[76:79]
    buffer_load_dwordx4 a[160:163], v28, s[20:23], s9 offen offset:0 sc1
    v_mfma_f32_16x16x32_bf16 v[84:87], a[208:211], a[88:91], v[84:87]
    ds_read_b64_tr_b16 a[204:205], v11 offset:13312
    v_not_b32 v193, v193
    v_mfma_f32_16x16x32_bf16 v[116:119], a[212:215], a[88:91], v[116:119]
    ds_read_b64_tr_b16 a[206:207], v11 offset:19456
    v_or_b32 v193, 0x80000000, v193
    v_mfma_f32_16x16x32_bf16 v[124:127], a[212:215], a[92:95], v[124:127]
    v_xor_b32 v195, v195, v193
    v_and_b32 v195, 0xffff0000, v195
    v_mfma_f32_16x16x32_bf16 v[92:95], a[208:211], a[92:95], v[92:95]
pg_10:
    s_cbranch_execz pg_ret2
    s_waitcnt lgkmcnt(4)
    v_mul_f32 v195, s92, v195
    v_add_u32 v9, 49152, v13
    v_mfma_f32_16x16x32_bf16 v[156:159], a[192:195], a[92:95], v[156:159]
    s_load_dword s72, s[86:87], s5 offset:4 glc
    ds_read_b64_tr_b16 a[208:209], v18 offset:14336
    v_add_u32 v10, 49152, v14
    v_mfma_f32_16x16x32_bf16 v[188:191], a[196:199], a[92:95], v[188:191]
    ds_read_b64_tr_b16 a[210:211], v18 offset:20480
    v_add_u32 v11, 49152, v15
    v_mfma_f32_16x16x32_bf16 v[180:183], a[196:199], a[88:91], v[180:183]
    buffer_load_dwordx4 a[164:167], v28, s[20:23], s9 offen offset:1024 sc1
    v_mfma_f32_16x16x32_bf16 v[148:151], a[192:195], a[88:91], v[148:151]
    v_exp_f32 v195, v195
    v_mfma_f32_16x16x32_bf16 v[140:143], a[192:195], a[84:87], v[140:143]
    ds_read_b64_tr_b16 a[212:213], v19 offset:14336
    v_add_f32 v195, 1.0, v195
    v_mfma_f32_16x16x32_bf16 v[172:175], a[196:199], a[84:87], v[172:175]
    s_waitcnt vmcnt(21)
    ds_read_b64_tr_b16 a[214:215], v19 offset:20480
    v_xor_b32 v18, s39, v8
    v_mfma_f32_16x16x32_bf16 v[164:167], a[196:199], a[80:83], v[164:167]
    s_barrier
    v_mfma_f32_16x16x32_bf16 v[132:135], a[192:195], a[80:83], v[132:135]
    s_waitcnt lgkmcnt(4)
    buffer_load_dwordx4 a[168:171], v28, s[20:23], s9 offen offset:2048 sc1
    v_mfma_f32_16x16x32_bf16 v[196:199], a[200:203], a[80:83], v[196:199]
    ds_read_b64_tr_b16 a[192:193], v8 offset:0
    v_xor_b32 v19, s39, v9
    v_mfma_f32_16x16x32_bf16 v[228:231], a[204:207], a[80:83], v[228:231]
    ds_read_b64_tr_b16 a[194:195], v8 offset:6144
    v_mfma_f32_16x16x32_bf16 v[236:239], a[204:207], a[84:87], v[236:239]
    buffer_load_dwordx4 a[172:175], v28, s[20:23], s9 offen offset:3072 sc1
    v_mfma_f32_16x16x32_bf16 v[204:207], a[200:203], a[84:87], v[204:207]
    s_add_u32 s9, s9, 12288
    v_rcp_f32 v195, v195
    v_mfma_f32_16x16x32_bf16 v[212:215], a[200:203], a[88:91], v[212:215]
    ds_read_b64_tr_b16 a[196:197], v9 offset:0
    v_cvt_pk_bf16_f32 v195, v195, v195
    v_mfma_f32_16x16x32_bf16 v[244:247], a[204:207], a[88:91], v[244:247]
    ds_read_b64_tr_b16 a[198:199], v9 offset:6144
    v_and_b32 v195, 0xffff0000, v195
    v_mfma_f32_16x16x32_bf16 v[252:255], a[204:207], a[92:95], v[252:255]
    ds_write_b16 v80, v64
    v_mfma_f32_16x16x32_bf16 v[220:223], a[200:203], a[92:95], v[220:223]
    s_waitcnt lgkmcnt(4)
    ds_write_b16_d16_hi v80, v64 offset:128
    v_mfma_f32_16x16x32_bf16 v[44:47], a[208:211], a[92:95], v[44:47]
    ds_read_b64_tr_b16 a[200:201], v10 offset:0
    v_mfma_f32_16x16x32_bf16 v[60:63], a[212:215], a[92:95], v[60:63]
    ds_read_b64_tr_b16 a[202:203], v10 offset:6144
    v_mfma_f32_16x16x32_bf16 v[56:59], a[212:215], a[88:91], v[56:59]
    ds_read_b128 v[88:91], v81
    v_mfma_f32_16x16x32_bf16 v[40:43], a[208:211], a[88:91], v[40:43]
    buffer_load_dwordx4 a[176:179], v28, s[20:23], s10 offen offset:0 sc1
    v_mfma_f32_16x16x32_bf16 v[36:39], a[208:211], a[84:87], v[36:39]
    ds_read_b64_tr_b16 a[204:205], v11 offset:0
    v_mfma_f32_16x16x32_bf16 v[52:55], a[212:215], a[84:87], v[52:55]
    s_waitcnt vmcnt(26)
    ds_read_b64_tr_b16 a[206:207], v11 offset:6144
    v_mfma_f32_16x16x32_bf16 v[48:51], a[212:215], a[80:83], v[48:51]
    ds_read_b128 v[96:99], v81 offset:64
    v_mfma_f32_16x16x32_bf16 v[32:35], a[208:211], a[80:83], v[32:35]
    s_waitcnt lgkmcnt(4)
    ds_read_b64_tr_b16 v[104:105], v82
    v_mfma_f32_16x16x32_bf16 a[224:227], a[192:195], a[96:99], a[224:227]
    ds_read_b64_tr_b16 a[208:209], v8 offset:1024
    v_mfma_f32_16x16x32_bf16 a[240:243], a[196:199], a[96:99], a[240:243]
    ds_read_b64_tr_b16 a[210:211], v8 offset:7168
    v_mfma_f32_16x16x32_bf16 a[244:247], a[196:199], a[100:103], a[244:247]
    ds_read_b64_tr_b16 v[106:107], v82 offset:2048
    v_mfma_f32_16x16x32_bf16 a[228:231], a[192:195], a[100:103], a[228:231]
    buffer_load_dwordx4 a[180:183], v28, s[20:23], s10 offen offset:1024 sc1
    v_mfma_f32_16x16x32_bf16 a[232:235], a[192:195], a[104:107], a[232:235]
    s_lshl1_add_u32 m0, s36, 81920
    ds_read_b64_tr_b16 a[212:213], v9 offset:1024
    s_add_u32 s38, s34, 122880
    v_mfma_f32_16x16x32_bf16 a[248:251], a[196:199], a[104:107], a[248:251]
    s_add_u32 s57, s35, 122880
    ds_read_b64_tr_b16 a[214:215], v9 offset:7168
    s_cmp_lt_u32 s3, 2
    s_cselect_b32 s38, s38, s57
    v_mfma_f32_16x16x32_bf16 a[252:255], a[196:199], a[108:111], a[252:255]
    ds_read_b64_tr_b16 v[112:113], v82 offset:4096
    v_mfma_f32_16x16x32_bf16 a[236:239], a[192:195], a[108:111], a[236:239]
    s_waitcnt lgkmcnt(4)
    ds_read_b64_tr_b16 v[114:115], v82 offset:6144
    v_mfma_f32_16x16x32_bf16 v[92:95], a[200:203], a[108:111], v[92:95]
    ds_read_b64_tr_b16 a[192:193], v10 offset:1024
    v_mfma_f32_16x16x32_bf16 v[124:127], a[204:207], a[108:111], v[124:127]
    ds_read_b64_tr_b16 a[194:195], v10 offset:7168
    v_mfma_f32_16x16x32_bf16 v[116:119], a[204:207], a[104:107], v[116:119]
    s_bfe_u32 s88, s72, 262160
    s_cmp_lg_u32 s88, 15
    s_cbranch_scc1 spin_o4
spin_o4_ret:
    v_mfma_f32_16x16x32_bf16 v[84:87], a[200:203], a[104:107], v[84:87]
    buffer_load_dwordx4 v4, s[12:15], s38 offen lds
    v_mfma_f32_16x16x32_bf16 v[76:79], a[200:203], a[100:103], v[76:79]
    s_lshl1_add_u32 m0, s36, 82944
    ds_read_b64_tr_b16 a[196:197], v11 offset:1024
    v_mfma_f32_16x16x32_bf16 v[108:111], a[204:207], a[100:103], v[108:111]
    ds_read_b64_tr_b16 a[198:199], v11 offset:7168
    v_mfma_f32_16x16x32_bf16 v[100:103], a[204:207], a[96:99], v[100:103]
    buffer_load_dwordx4 a[0:3], v28, s[20:23], s8 offen offset:0 sc1
    v_mfma_f32_16x16x32_bf16 v[68:71], a[200:203], a[96:99], v[68:71]
    s_waitcnt lgkmcnt(4)
    v_mfma_f32_16x16x32_bf16 v[132:135], a[208:211], a[96:99], v[132:135]
    ds_read_b64_tr_b16 a[200:201], v18 offset:2048
    v_mfma_f32_16x16x32_bf16 v[164:167], a[212:215], a[96:99], v[164:167]
    ds_read_b64_tr_b16 a[202:203], v18 offset:8192
    v_mfma_f32_16x16x32_bf16 v[172:175], a[212:215], a[100:103], v[172:175]
    buffer_load_dwordx4 a[4:7], v28, s[20:23], s8 offen offset:1024 sc1
    v_mfma_f32_16x16x32_bf16 v[140:143], a[208:211], a[100:103], v[140:143]
    v_mfma_f32_16x16x32_bf16 v[148:151], a[208:211], a[104:107], v[148:151]
    ds_read_b64_tr_b16 a[204:205], v19 offset:2048
    v_mfma_f32_16x16x32_bf16 v[180:183], a[212:215], a[104:107], v[180:183]
    ds_read_b64_tr_b16 a[206:207], v19 offset:8192
    v_mfma_f32_16x16x32_bf16 v[188:191], a[212:215], a[108:111], v[188:191]
    v_mfma_f32_16x16x32_bf16 v[120:123], v[88:91], v[104:107], 0
    v_mfma_f32_16x16x32_bf16 v[120:123], v[96:99], v[112:115], v[120:123]
    v_mfma_f32_16x16x32_bf16 v[156:159], a[208:211], a[108:111], v[156:159]
    s_waitcnt lgkmcnt(4)
    buffer_load_dwordx4 a[8:11], v28, s[20:23], s8 offen offset:2048 sc1
    v_mfma_f32_16x16x32_bf16 v[220:223], a[192:195], a[108:111], v[220:223]
    ds_read_b64_tr_b16 a[208:209], v8 offset:12288
    v_lshrrev_b32 v233, 5, v1
    v_mfma_f32_16x16x32_bf16 v[252:255], a[196:199], a[108:111], v[252:255]
    ds_read_b64_tr_b16 a[210:211], v8 offset:18432
    v_lshlrev_b32 v233, 11, v233
    v_mfma_f32_16x16x32_bf16 v[244:247], a[196:199], a[104:107], v[244:247]
    v_sub_u32 v233, 81920, v233
    v_mfma_f32_16x16x32_bf16 v[212:215], a[192:195], a[104:107], v[212:215]
    buffer_load_dwordx4 a[12:15], v28, s[20:23], s8 offen offset:3072 sc1
    v_mfma_f32_16x16x32_bf16 v[204:207], a[192:195], a[100:103], v[204:207]
    s_add_u32 s8, s8, 4096
    ds_read_b64_tr_b16 a[212:213], v9 offset:12288
    v_mfma_f32_16x16x32_bf16 v[236:239], a[196:199], a[100:103], v[236:239]
    ds_read_b64_tr_b16 a[214:215], v9 offset:18432
    v_mfma_f32_16x16x32_bf16 v[228:231], a[196:199], a[96:99], v[228:231]
    buffer_atomic_add_f32 v120, v74, s[24:27], s62 offen
    v_mfma_f32_16x16x32_bf16 v[196:199], a[192:195], a[96:99], v[196:199]
    s_waitcnt lgkmcnt(4)
    buffer_load_dwordx4 v5, s[12:15], s38 offen lds
    v_mfma_f32_16x16x32_bf16 v[32:35], a[200:203], a[96:99], v[32:35]
    s_lshl1_add_u32 m0, s36, 90112
    ds_read_b64_tr_b16 a[192:193], v10 offset:12288
    s_add_u32 s38, s33, 163840
    v_mfma_f32_16x16x32_bf16 v[48:51], a[204:207], a[96:99], v[48:51]
    s_add_u32 s57, s34, 163840
    ds_read_b64_tr_b16 a[194:195], v10 offset:18432
    s_cmp_lt_u32 s3, 2
    s_cselect_b32 s38, s38, s57
    v_mfma_f32_16x16x32_bf16 v[52:55], a[204:207], a[100:103], v[52:55]
    buffer_atomic_add_f32 v121, v74, s[24:27], s62 offen offset:256
    v_mfma_f32_16x16x32_bf16 v[36:39], a[200:203], a[100:103], v[36:39]
    buffer_load_dwordx4 v4, s[12:15], s38 offen lds
    v_mfma_f32_16x16x32_bf16 v[40:43], a[200:203], a[104:107], v[40:43]
    s_lshl1_add_u32 m0, s36, 91136
    ds_read_b64_tr_b16 a[196:197], v11 offset:12288
    v_mov_b32 v122, 1
    v_mfma_f32_16x16x32_bf16 v[56:59], a[204:207], a[104:107], v[56:59]
    s_waitcnt vmcnt(29)
    ds_read_b64_tr_b16 a[198:199], v11 offset:18432
    v_min_u32 v123, 1, v1
    v_mfma_f32_16x16x32_bf16 v[60:63], a[204:207], a[108:111], v[60:63]
    v_lshlrev_b32 v123, 30, v123
    v_mfma_f32_16x16x32_bf16 v[44:47], a[200:203], a[108:111], v[44:47]
    s_waitcnt lgkmcnt(4)
    v_mfma_f32_16x16x32_bf16 a[236:239], a[208:211], a[124:127], a[236:239]
    ds_read_b64_tr_b16 a[200:201], v8 offset:13312
    v_mfma_f32_16x16x32_bf16 a[252:255], a[212:215], a[124:127], a[252:255]
    ds_read_b64_tr_b16 a[202:203], v8 offset:19456
    v_mfma_f32_16x16x32_bf16 a[248:251], a[212:215], a[120:123], a[248:251]
    buffer_load_dwordx4 v5, s[12:15], s38 offen lds
    v_mfma_f32_16x16x32_bf16 a[232:235], a[208:211], a[120:123], a[232:235]
    s_lshl1_add_u32 m0, s36, 98304
    v_add_u32 v8, 0, v12
    s_add_u32 s38, s35, 163840
    v_mfma_f32_16x16x32_bf16 a[228:231], a[208:211], a[116:119], a[228:231]
    s_add_u32 s57, s33, 204800
    ds_read_b64_tr_b16 a[204:205], v9 offset:13312
    s_cmp_lt_u32 s3, 2
    s_cselect_b32 s38, s38, s57
    v_mfma_f32_16x16x32_bf16 a[244:247], a[212:215], a[116:119], a[244:247]
    ds_read_b64_tr_b16 a[206:207], v9 offset:19456
    v_mfma_f32_16x16x32_bf16 a[240:243], a[212:215], a[112:115], a[240:243]
    buffer_load_dwordx4 v4, s[12:15], s38 offen lds
    v_mfma_f32_16x16x32_bf16 a[224:227], a[208:211], a[112:115], a[224:227]
    s_waitcnt lgkmcnt(4)
    v_add_u32 v9, 0, v13
    s_lshl1_add_u32 m0, s36, 99328
    v_mfma_f32_16x16x32_bf16 v[68:71], a[192:195], a[112:115], v[68:71]
    s_load_dword s72, s[86:87], s5 offset:4 glc
    ds_read_b64_tr_b16 a[208:209], v10 offset:13312
    v_mfma_f32_16x16x32_bf16 v[100:103], a[196:199], a[112:115], v[100:103]
    ds_read_b64_tr_b16 a[210:211], v10 offset:19456
    v_mfma_f32_16x16x32_bf16 v[108:111], a[196:199], a[116:119], v[108:111]
    buffer_load_dwordx4 v5, s[12:15], s38 offen lds
    v_mfma_f32_16x16x32_bf16 v[76:79], a[192:195], a[116:119], v[76:79]
    s_waitcnt vmcnt(18)
    v_lshlrev_b32 v248, 16, v200
    v_and_b32 v249, 0xffff0000, v200
    v_mfma_f32_16x16x32_bf16 v[84:87], a[192:195], a[120:123], v[84:87]
    s_lshl1_add_u32 m0, s36, 106496
    ds_read_b64_tr_b16 a[212:213], v11 offset:13312
    v_sub_f32 v248, v248, v202
    v_mfma_f32_16x16x32_bf16 v[116:119], a[196:199], a[120:123], v[116:119]
    s_add_u32 s38, s34, 204800
    ds_read_b64_tr_b16 a[214:215], v11 offset:19456
    v_sub_f32 v249, v249, v202
    v_mfma_f32_16x16x32_bf16 v[124:127], a[196:199], a[124:127], v[124:127]
    buffer_load_dwordx4 a[184:187], v28, s[20:23], s10 offen offset:2048 sc1
    v_mfma_f32_16x16x32_bf16 v[92:95], a[192:195], a[124:127], v[92:95]
    s_waitcnt lgkmcnt(4)
    v_cvt_pk_bf16_f32 v193, v248, v249
    v_lshlrev_b32 v248, 16, v193
    v_mfma_f32_16x16x32_bf16 v[156:159], a[200:203], a[124:127], v[156:159]
    s_add_u32 s57, s35, 204800
    ds_read_b64_tr_b16 a[192:193], v18 offset:14336
    v_and_b32 v249, 0xffff0000, v193
    v_mfma_f32_16x16x32_bf16 v[188:191], a[204:207], a[124:127], v[188:191]
    s_cmp_lt_u32 s3, 2
    s_cselect_b32 s38, s38, s57
    ds_read_b64_tr_b16 a[194:195], v18 offset:20480
    v_mfma_f32_16x16x32_bf16 v[180:183], a[204:207], a[120:123], v[180:183]
    buffer_load_dwordx4 v4, s[12:15], s38 offen lds
    v_mfma_f32_16x16x32_bf16 v[148:151], a[200:203], a[120:123], v[148:151]
    v_mul_f32 v248, v248, v203
    v_mul_f32 v249, v249, v203
    v_mfma_f32_16x16x32_bf16 v[140:143], a[200:203], a[116:119], v[140:143]
    s_lshl1_add_u32 m0, s36, 107520
    ds_read_b64_tr_b16 a[196:197], v19 offset:14336
    v_cvt_pk_bf16_f32 v193, v248, v249
    v_mfma_f32_16x16x32_bf16 v[172:175], a[204:207], a[116:119], v[172:175]
    s_waitcnt vmcnt(63)
    ds_read_b64_tr_b16 a[198:199], v19 offset:20480
    v_lshlrev_b32 v248, 16, v193
    v_mfma_f32_16x16x32_bf16 v[164:167], a[204:207], a[112:115], v[164:167]
    s_barrier
    v_mfma_f32_16x16x32_bf16 v[132:135], a[200:203], a[112:115], v[132:135]
    s_waitcnt lgkmcnt(4)
    buffer_load_dwordx4 a[188:191], v28, s[20:23], s10 offen offset:3072 sc1
    v_mfma_f32_16x16x32_bf16 v[196:199], a[208:211], a[112:115], v[196:199]
    s_add_u32 s10, s10, 12288
    ds_read_b64_tr_b16 a[200:201], v8 offset:0
    v_and_b32 v249, 0xffff0000, v193
    v_mfma_f32_16x16x32_bf16 v[228:231], a[212:215], a[112:115], v[228:231]
    ds_read_b64_tr_b16 a[202:203], v8 offset:6144
    v_lshlrev_b32 v250, 16, v201
    v_mfma_f32_16x16x32_bf16 v[236:239], a[212:215], a[116:119], v[236:239]
    buffer_load_dwordx4 v5, s[12:15], s38 offen lds
    v_mfma_f32_16x16x32_bf16 v[204:207], a[208:211], a[116:119], v[204:207]
    v_and_b32 v251, 0xffff0000, v201
    v_sub_f32 v250, v250, v202
    v_mfma_f32_16x16x32_bf16 v[212:215], a[208:211], a[120:123], v[212:215]
    ds_read_b64_tr_b16 a[204:205], v9 offset:0
    v_sub_f32 v251, v251, v202
    v_mfma_f32_16x16x32_bf16 v[244:247], a[212:215], a[120:123], v[244:247]
    ds_read_b64_tr_b16 a[206:207], v9 offset:6144
    v_cvt_pk_bf16_f32 v193, v250, v251
    v_mfma_f32_16x16x32_bf16 v[252:255], a[212:215], a[124:127], v[252:255]
    v_lshlrev_b32 v250, 16, v193
    v_and_b32 v251, 0xffff0000, v193
    v_mfma_f32_16x16x32_bf16 v[220:223], a[208:211], a[124:127], v[220:223]
    s_waitcnt lgkmcnt(4)
    buffer_load_dwordx4 a[16:19], v28, s[20:23], s9 offen offset:0 sc1
    v_add_u32 v10, 0, v14
    v_mfma_f32_16x16x32_bf16 v[44:47], a[192:195], a[124:127], v[44:47]
    ds_read_b64_tr_b16 a[208:209], v10 offset:0
    v_mul_f32 v250, v250, v203
    v_mfma_f32_16x16x32_bf16 v[60:63], a[196:199], a[124:127], v[60:63]
    ds_read_b64_tr_b16 a[210:211], v10 offset:6144
    v_mul_f32 v251, v251, v203
    v_mfma_f32_16x16x32_bf16 v[56:59], a[196:199], a[120:123], v[56:59]
    v_cvt_pk_bf16_f32 v193, v250, v251
    v_lshlrev_b32 v250, 16, v193
    v_mfma_f32_16x16x32_bf16 v[40:43], a[192:195], a[120:123], v[40:43]
    buffer_load_dwordx4 a[20:23], v28, s[20:23], s9 offen offset:1024 sc1
    v_add_u32 v11, 0, v15
    v_mfma_f32_16x16x32_bf16 v[36:39], a[192:195], a[116:119], v[36:39]
    ds_read_b64_tr_b16 a[212:213], v11 offset:0
    v_and_b32 v251, 0xffff0000, v193
    v_mfma_f32_16x16x32_bf16 v[52:55], a[196:199], a[116:119], v[52:55]
    s_waitcnt vmcnt(34)
    ds_read_b64_tr_b16 a[214:215], v11 offset:6144
    v_mul_f32 v24, v24, -v25
    v_mfma_f32_16x16x32_bf16 v[48:51], a[196:199], a[112:115], v[48:51]
    v_lshlrev_b32 v26, 16, v144
    v_and_b32 v27, 0xffff0000, v144
    v_mfma_f32_16x16x32_bf16 v[32:35], a[192:195], a[112:115], v[32:35]
    s_waitcnt lgkmcnt(4)
    buffer_load_dwordx4 a[24:27], v28, s[20:23], s9 offen offset:2048 sc1
    v_mfma_f32_16x16x32_bf16 a[224:227], a[200:203], a[128:131], a[224:227]
    ds_read_b64_tr_b16 a[192:193], v8 offset:1024
    v_fma_f32 v26, v26, v25, v24
    v_mfma_f32_16x16x32_bf16 a[240:243], a[204:207], a[128:131], a[240:243]
    ds_read_b64_tr_b16 a[194:195], v8 offset:7168
    v_fma_f32 v27, v27, v25, v24
    v_mfma_f32_16x16x32_bf16 a[244:247], a[204:207], a[132:135], a[244:247]
    s_bfe_u32 s88, s72, 262164
    s_cmp_lg_u32 s88, 15
    s_cbranch_scc1 spin_o5
spin_o5_ret:
    v_mul_f32 v30, s92, v26
    v_mfma_f32_16x16x32_bf16 a[228:231], a[200:203], a[132:135], a[228:231]
    buffer_load_dwordx4 a[28:31], v28, s[20:23], s9 offen offset:3072 sc1
    v_mfma_f32_16x16x32_bf16 a[232:235], a[200:203], a[136:139], a[232:235]
    s_add_u32 s9, s9, 4096
    ds_read_b64_tr_b16 a[196:197], v9 offset:1024
    v_mul_f32 v31, s92, v27
    v_mfma_f32_16x16x32_bf16 a[248:251], a[204:207], a[136:139], a[248:251]
    ds_read_b64_tr_b16 a[198:199], v9 offset:7168
    v_xor_b32 v18, s39, v8
    v_mfma_f32_16x16x32_bf16 a[252:255], a[204:207], a[140:143], a[252:255]
    v_exp_f32 v30, v30
    v_mfma_f32_16x16x32_bf16 a[236:239], a[200:203], a[140:143], a[236:239]
    s_waitcnt lgkmcnt(4)
    v_exp_f32 v31, v31
    v_mfma_f32_16x16x32_bf16 v[92:95], a[208:211], a[140:143], v[92:95]
    ds_read_b64_tr_b16 a[200:201], v10 offset:1024
    v_add_f32 v30, 1.0, v30
    v_mfma_f32_16x16x32_bf16 v[124:127], a[212:215], a[140:143], v[124:127]
    ds_read_b64_tr_b16 a[202:203], v10 offset:7168
    v_add_f32 v31, 1.0, v31
    v_mfma_f32_16x16x32_bf16 v[116:119], a[212:215], a[136:139], v[116:119]
    buffer_load_dwordx4 a[48:51], v28, s[20:23], s8 offen offset:0 sc1
    v_mfma_f32_16x16x32_bf16 v[84:87], a[208:211], a[136:139], v[84:87]
    v_rcp_f32 v30, v30
    v_mfma_f32_16x16x32_bf16 v[76:79], a[208:211], a[132:135], v[76:79]
    ds_read_b64_tr_b16 a[204:205], v11 offset:1024
    v_xor_b32 v19, s39, v9
    v_mfma_f32_16x16x32_bf16 v[108:111], a[212:215], a[132:135], v[108:111]
    ds_read_b64_tr_b16 a[206:207], v11 offset:7168
    v_mfma_f32_16x16x32_bf16 v[100:103], a[212:215], a[128:131], v[100:103]
    buffer_load_dwordx4 a[52:55], v28, s[20:23], s8 offen offset:1024 sc1
    v_mfma_f32_16x16x32_bf16 v[68:71], a[208:211], a[128:131], v[68:71]
    s_waitcnt lgkmcnt(4)
    v_rcp_f32 v31, v31
    v_mfma_f32_16x16x32_bf16 v[132:135], a[192:195], a[128:131], v[132:135]
    ds_read_b64_tr_b16 a[208:209], v18 offset:2048
    v_mul_f32 v26, v26, v30
    v_mfma_f32_16x16x32_bf16 v[164:167], a[196:199], a[128:131], v[164:167]
    ds_read_b64_tr_b16 a[210:211], v18 offset:8192
    v_mul_f32 v27, v27, v31
    v_mfma_f32_16x16x32_bf16 v[172:175], a[196:199], a[132:135], v[172:175]
    buffer_load_dwordx4 a[56:59], v28, s[20:23], s8 offen offset:2048 sc1
    v_mfma_f32_16x16x32_bf16 v[140:143], a[192:195], a[132:135], v[140:143]
    v_cvt_pk_bf16_f32 v168, v26, v27
    v_lshlrev_b32 v26, 16, v145
    v_mfma_f32_16x16x32_bf16 v[148:151], a[192:195], a[136:139], v[148:151]
    ds_read_b64_tr_b16 a[212:213], v19 offset:2048
    v_and_b32 v27, 0xffff0000, v145
    v_mfma_f32_16x16x32_bf16 v[180:183], a[196:199], a[136:139], v[180:183]
    ds_read_b64_tr_b16 a[214:215], v19 offset:8192
    v_fma_f32 v26, v26, v25, v24
    v_mfma_f32_16x16x32_bf16 v[188:191], a[196:199], a[140:143], v[188:191]
    buffer_load_dwordx4 a[60:63], v28, s[20:23], s8 offen offset:3072 sc1
    v_mfma_f32_16x16x32_bf16 v[156:159], a[192:195], a[140:143], v[156:159]
    s_waitcnt lgkmcnt(4)
    v_fma_f32 v27, v27, v25, v24
    v_mul_f32 v30, s92, v26
    v_mfma_f32_16x16x32_bf16 v[220:223], a[200:203], a[140:143], v[220:223]
    s_add_u32 s8, s8, 12288
    ds_read_b64_tr_b16 a[192:193], v8 offset:12288
    v_mul_f32 v31, s92, v27
    v_mfma_f32_16x16x32_bf16 v[252:255], a[204:207], a[140:143], v[252:255]
    ds_read_b64_tr_b16 a[194:195], v8 offset:18432
    v_mfma_f32_16x16x32_bf16 v[244:247], a[204:207], a[136:139], v[244:247]
    buffer_load_dwordx4 a[32:35], v28, s[20:23], s10 offen offset:0 sc1
    v_mfma_f32_16x16x32_bf16 v[212:215], a[200:203], a[136:139], v[212:215]
    v_exp_f32 v30, v30
    v_mfma_f32_16x16x32_bf16 v[204:207], a[200:203], a[132:135], v[204:207]
    ds_read_b64_tr_b16 a[196:197], v9 offset:12288
    v_mfma_f32_16x16x32_bf16 v[236:239], a[204:207], a[132:135], v[236:239]
    ds_read_b64_tr_b16 a[198:199], v9 offset:18432
    v_mfma_f32_16x16x32_bf16 v[228:231], a[204:207], a[128:131], v[228:231]
    buffer_load_dwordx4 a[36:39], v28, s[20:23], s10 offen offset:1024 sc1
    v_mfma_f32_16x16x32_bf16 v[196:199], a[200:203], a[128:131], v[196:199]
    s_waitcnt lgkmcnt(4)
    v_exp_f32 v31, v31
    v_mfma_f32_16x16x32_bf16 v[32:35], a[208:211], a[128:131], v[32:35]
    s_waitcnt vmcnt(18)
    ds_read_b64_tr_b16 a[200:201], v10 offset:12288
    v_add_f32 v30, 1.0, v30
    v_mfma_f32_16x16x32_bf16 v[48:51], a[212:215], a[128:131], v[48:51]
    ds_read_b64_tr_b16 a[202:203], v10 offset:18432
    v_add_f32 v31, 1.0, v31
    v_mfma_f32_16x16x32_bf16 v[52:55], a[212:215], a[132:135], v[52:55]
    buffer_atomic_add v122, v123, s[24:27], s62 offen offset:128
    v_mfma_f32_16x16x32_bf16 v[36:39], a[208:211], a[132:135], v[36:39]
    buffer_load_dwordx4 a[40:43], v28, s[20:23], s10 offen offset:2048 sc1
    v_mfma_f32_16x16x32_bf16 v[40:43], a[208:211], a[136:139], v[40:43]
    ds_read_b64_tr_b16 a[204:205], v11 offset:12288
    v_mfma_f32_16x16x32_bf16 v[56:59], a[212:215], a[136:139], v[56:59]
    s_waitcnt vmcnt(37)
    ds_read_b64_tr_b16 a[206:207], v11 offset:18432
    v_mfma_f32_16x16x32_bf16 v[60:63], a[212:215], a[140:143], v[60:63]
    v_rcp_f32 v30, v30
    v_mfma_f32_16x16x32_bf16 v[44:47], a[208:211], a[140:143], v[44:47]
    s_waitcnt lgkmcnt(4)
    buffer_load_dwordx4 a[44:47], v28, s[20:23], s10 offen offset:3072 sc1
    v_mfma_f32_16x16x32_bf16 a[236:239], a[192:195], a[156:159], a[236:239]
    s_add_u32 s10, s10, 4096
    ds_read_b64_tr_b16 a[208:209], v8 offset:13312
    v_mfma_f32_16x16x32_bf16 a[252:255], a[196:199], a[156:159], a[252:255]
    ds_read_b64_tr_b16 a[210:211], v8 offset:19456
    v_mfma_f32_16x16x32_bf16 a[248:251], a[196:199], a[152:155], a[248:251]
    v_rcp_f32 v31, v31
    v_mfma_f32_16x16x32_bf16 a[232:235], a[192:195], a[152:155], a[232:235]
    buffer_load_dwordx4 a[64:67], v28, s[20:23], s9 offen offset:0 sc1
    v_mfma_f32_16x16x32_bf16 a[228:231], a[192:195], a[148:151], a[228:231]
    s_lshl_b32 s77, s3, 1
    s_add_u32 s77, s77, 0
    s_cmp_eq_u32 s77, s53
    s_cselect_b32 s77, 0x7ffffff0, 0
    ds_read_b64_tr_b16 a[212:213], v9 offset:13312
    v_mfma_f32_16x16x32_bf16 a[244:247], a[196:199], a[148:151], a[244:247]
    ds_read_b64_tr_b16 a[214:215], v9 offset:19456
    v_mul_f32 v26, v26, v30
    v_mfma_f32_16x16x32_bf16 a[240:243], a[196:199], a[144:147], a[240:243]
    v_mul_f32 v27, v27, v31
    v_cvt_pk_bf16_f32 v169, v26, v27
    v_mfma_f32_16x16x32_bf16 a[224:227], a[192:195], a[144:147], a[224:227]
    s_waitcnt lgkmcnt(4)
    buffer_load_dwordx4 a[68:71], v28, s[20:23], s9 offen offset:1024 sc1
    v_mfma_f32_16x16x32_bf16 v[68:71], a[200:203], a[144:147], v[68:71]
    ds_read_b64_tr_b16 a[192:193], v10 offset:13312
    v_lshlrev_b32 v26, 16, v146
    v_mfma_f32_16x16x32_bf16 v[100:103], a[204:207], a[144:147], v[100:103]
    ds_read_b64_tr_b16 a[194:195], v10 offset:19456
    v_and_b32 v27, 0xffff0000, v146
    v_mfma_f32_16x16x32_bf16 v[108:111], a[204:207], a[148:151], v[108:111]
    v_fma_f32 v26, v26, v25, v24
    v_fma_f32 v27, v27, v25, v24
    v_mfma_f32_16x16x32_bf16 v[76:79], a[200:203], a[148:151], v[76:79]
    buffer_load_dwordx4 a[72:75], v28, s[20:23], s9 offen offset:2048 sc1
    v_mfma_f32_16x16x32_bf16 v[84:87], a[200:203], a[152:155], v[84:87]
    s_lshl1_add_u32 m0, s36, 114688
    ds_read_b64_tr_b16 a[196:197], v11 offset:13312
    v_mul_f32 v30, s92, v26
    v_mfma_f32_16x16x32_bf16 v[116:119], a[204:207], a[152:155], v[116:119]
    s_add_u32 s38, s34, 123008
    ds_read_b64_tr_b16 a[198:199], v11 offset:19456
    v_mul_f32 v31, s92, v27
    v_mfma_f32_16x16x32_bf16 v[124:127], a[204:207], a[156:159], v[124:127]
    s_add_u32 s57, s35, 123008
    v_exp_f32 v30, v30
    v_mfma_f32_16x16x32_bf16 v[92:95], a[200:203], a[156:159], v[92:95]
    s_waitcnt lgkmcnt(4)
    v_exp_f32 v31, v31
    v_mfma_f32_16x16x32_bf16 v[156:159], a[208:211], a[156:159], v[156:159]
    s_cmp_lt_u32 s3, 2
    s_cselect_b32 s38, s38, s57
    ds_read_b64_tr_b16 a[200:201], v18 offset:14336
    v_mfma_f32_16x16x32_bf16 v[188:191], a[212:215], a[156:159], v[188:191]
    ds_read_b64_tr_b16 a[202:203], v18 offset:20480
    v_add_f32 v30, 1.0, v30
    v_mfma_f32_16x16x32_bf16 v[180:183], a[212:215], a[152:155], v[180:183]
    buffer_load_dwordx4 a[76:79], v28, s[20:23], s9 offen offset:3072 sc1
    v_mfma_f32_16x16x32_bf16 v[148:151], a[208:211], a[152:155], v[148:151]
    s_add_u32 s9, s9, 12288
    v_add_f32 v31, 1.0, v31
    v_add_u32 v8, v233, v12
    v_mfma_f32_16x16x32_bf16 v[140:143], a[208:211], a[148:151], v[140:143]
    ds_read_b64_tr_b16 a[204:205], v19 offset:14336
    v_or_b32 v6, s77, v28
    v_mfma_f32_16x16x32_bf16 v[172:175], a[212:215], a[148:151], v[172:175]
    s_waitcnt vmcnt(17)
    ds_read_b64_tr_b16 a[206:207], v19 offset:20480
    v_add_u32 v9, v233, v13
    v_mfma_f32_16x16x32_bf16 v[164:167], a[212:215], a[144:147], v[164:167]
    s_barrier
    v_mfma_f32_16x16x32_bf16 v[132:135], a[208:211], a[144:147], v[132:135]
    s_waitcnt lgkmcnt(4)
    buffer_load_dwordx4 a[80:83], v28, s[20:23], s10 offen offset:0 sc1
    v_mfma_f32_16x16x32_bf16 v[196:199], a[192:195], a[144:147], v[196:199]
    s_lshl_b32 s77, s3, 1
    s_add_u32 s77, s77, 1
    s_cmp_eq_u32 s77, s53
    s_cselect_b32 s77, 0x7ffffff0, 0
    ds_read_b64_tr_b16 a[208:209], v8 offset:0
    v_mfma_f32_16x16x32_bf16 v[228:231], a[196:199], a[144:147], v[228:231]
    ds_read_b64_tr_b16 a[210:211], v8 offset:2048
    v_lshrrev_b32 v2, 2, v1
    v_mfma_f32_16x16x32_bf16 v[236:239], a[196:199], a[148:151], v[236:239]
    buffer_load_dwordx4 a[84:87], v28, s[20:23], s10 offen offset:1024 sc1
    v_mfma_f32_16x16x32_bf16 v[204:207], a[192:195], a[148:151], v[204:207]
    v_lshlrev_b32 v18, 6, v2
    v_mul_u32_u24 v2, 1280, v2
    v_mfma_f32_16x16x32_bf16 v[212:215], a[192:195], a[152:155], v[212:215]
    ds_read_b64_tr_b16 a[212:213], v9 offset:0
    v_and_b32 v19, 3, v1
    v_mfma_f32_16x16x32_bf16 v[244:247], a[196:199], a[152:155], v[244:247]
    ds_read_b64_tr_b16 a[214:215], v9 offset:2048
    v_lshl_add_u32 v18, v19, 3, v18
    v_mfma_f32_16x16x32_bf16 v[252:255], a[196:199], a[156:159], v[252:255]
    buffer_load_dwordx4 a[88:91], v28, s[20:23], s10 offen offset:2048 sc1
    v_mfma_f32_16x16x32_bf16 v[220:223], a[192:195], a[156:159], v[220:223]
    s_waitcnt lgkmcnt(4)
    v_lshl_add_u32 v2, v19, 4, v2
    v_and_b32 v19, 16, v1
    v_mfma_f32_16x16x32_bf16 v[44:47], a[200:203], a[156:159], v[44:47]
    ds_read_b64_tr_b16 a[192:193], v8 offset:4096
    v_lshlrev_b32 v19, 1, v19
    v_mfma_f32_16x16x32_bf16 v[60:63], a[204:207], a[156:159], v[60:63]
    ds_read_b64_tr_b16 a[194:195], v8 offset:6144
    v_xor_b32 v2, v2, v19
    v_mfma_f32_16x16x32_bf16 v[56:59], a[204:207], a[152:155], v[56:59]
    buffer_load_dwordx4 a[92:95], v28, s[20:23], s10 offen offset:3072 sc1
    v_mfma_f32_16x16x32_bf16 v[40:43], a[200:203], a[152:155], v[40:43]
    s_add_u32 s10, s10, 12288
    v_or_b32 v18, v18, v19
    v_xor_b32 v19, 32, v18
    v_mfma_f32_16x16x32_bf16 v[36:39], a[200:203], a[148:151], v[36:39]
    ds_read_b64_tr_b16 a[196:197], v9 offset:4096
    v_add_u32 v2, s39, v2
    v_mfma_f32_16x16x32_bf16 v[52:55], a[204:207], a[148:151], v[52:55]
    s_waitcnt vmcnt(39)
    ds_read_b64_tr_b16 a[198:199], v9 offset:6144
    v_add_u32 v2, s63, v2
    v_mfma_f32_16x16x32_bf16 v[48:51], a[204:207], a[144:147], v[48:51]
    v_add_u32 v18, 147456, v18
    v_add_u32 v19, 147456, v19
    v_mfma_f32_16x16x32_bf16 v[32:35], a[200:203], a[144:147], v[32:35]
    s_waitcnt lgkmcnt(4)
    buffer_load_dwordx4 v4, s[12:15], s38 offen lds
    v_mfma_f32_16x16x32_bf16 a[224:227], a[208:211], a[160:163], a[224:227]
    s_lshl1_add_u32 m0, s36, 115712
    ds_read_b64_tr_b16 a[200:201], v8 offset:8192
    v_or_b32 v7, s77, v28
    v_mfma_f32_16x16x32_bf16 a[240:243], a[212:215], a[160:163], a[240:243]
    ds_read_b64_tr_b16 a[202:203], v8 offset:10240
    v_add_u32 v10, v233, v14
    v_mfma_f32_16x16x32_bf16 a[244:247], a[212:215], a[164:167], a[244:247]
    v_rcp_f32 v30, v30
    v_mfma_f32_16x16x32_bf16 a[228:231], a[208:211], a[164:167], a[228:231]
    buffer_load_dwordx4 v5, s[12:15], s38 offen lds
    v_mfma_f32_16x16x32_bf16 a[232:235], a[208:211], a[168:171], a[232:235]
    s_lshl1_add_u32 m0, s36, 122880
    ds_read_b64_tr_b16 a[204:205], v9 offset:8192
    v_add_u32 v11, v233, v15
    v_mfma_f32_16x16x32_bf16 a[248:251], a[212:215], a[168:171], a[248:251]
    s_waitcnt vmcnt(24)
    ds_read_b64_tr_b16 a[206:207], v9 offset:10240
    s_add_u32 s38, s33, 163968
    v_mfma_f32_16x16x32_bf16 a[252:255], a[212:215], a[172:175], a[252:255]
    s_add_u32 s57, s34, 163968
    v_rcp_f32 v31, v31
    v_mfma_f32_16x16x32_bf16 a[236:239], a[208:211], a[172:175], a[236:239]
    s_waitcnt lgkmcnt(4)
    v_mul_f32 v26, v26, v30
    v_mul_f32 v27, v27, v31
    v_mfma_f32_16x16x32_bf16 a[236:239], a[192:195], a[188:191], a[236:239]
    s_cmp_lt_u32 s3, 2
    s_cselect_b32 s38, s38, s57
    ds_read_b64_tr_b16 a[208:209], v8 offset:12288
    v_mfma_f32_16x16x32_bf16 a[252:255], a[196:199], a[188:191], a[252:255]
    s_and_b32 s56, s70, 0x7ff
    ds_read_b64_tr_b16 a[210:211], v8 offset:14336
    v_cvt_pk_bf16_f32 v170, v26, v27
    v_mfma_f32_16x16x32_bf16 a[248:251], a[196:199], a[184:187], a[248:251]
    buffer_load_dwordx4 v4, s[12:15], s38 offen lds
    v_mfma_f32_16x16x32_bf16 a[232:235], a[192:195], a[184:187], a[232:235]
    s_lshl1_add_u32 m0, s36, 123904
    v_lshlrev_b32 v26, 16, v147
    v_and_b32 v27, 0xffff0000, v147
    v_mfma_f32_16x16x32_bf16 a[228:231], a[192:195], a[180:183], a[228:231]
    s_sub_u32 s56, 2047, s56
    ds_read_b64_tr_b16 a[212:213], v9 offset:12288
    v_cmp_eq_u32 s[78:79], s56, v20
    v_mfma_f32_16x16x32_bf16 a[244:247], a[196:199], a[180:183], a[244:247]
    s_waitcnt vmcnt(35)
    ds_read_b64_tr_b16 a[214:215], v9 offset:14336
    v_fma_f32 v26, v26, v25, v24
    v_mfma_f32_16x16x32_bf16 a[240:243], a[196:199], a[176:179], a[240:243]
    buffer_load_dwordx4 v5, s[12:15], s38 offen lds
    v_mfma_f32_16x16x32_bf16 a[224:227], a[192:195], a[176:179], a[224:227]
    s_waitcnt lgkmcnt(4)
    v_fma_f32 v27, v27, v25, v24
    v_mul_f32 v30, s92, v26
    v_mfma_f32_16x16x32_bf16 a[224:227], a[200:203], a[0:3], a[224:227]
    s_lshl1_add_u32 m0, s36, 131072
    ds_read_b64_tr_b16 a[192:193], v8 offset:16384
    v_mul_f32 v31, s92, v27
    v_mfma_f32_16x16x32_bf16 a[240:243], a[204:207], a[0:3], a[240:243]
    s_add_u32 s38, s35, 163968
    ds_read_b64_tr_b16 a[194:195], v8 offset:18432
    s_add_u32 s57, s33, 204928
    v_mfma_f32_16x16x32_bf16 a[244:247], a[204:207], a[4:7], a[244:247]
    s_cmp_lt_u32 s3, 2
    s_cselect_b32 s38, s38, s57
    s_and_b32 s56, s71, 0x7ff
    v_mfma_f32_16x16x32_bf16 a[228:231], a[200:203], a[4:7], a[228:231]
pg_11:
    s_cbranch_execz pg_ret2
    buffer_load_dwordx4 v4, s[12:15], s38 offen lds
    v_mfma_f32_16x16x32_bf16 a[232:235], a[200:203], a[8:11], a[232:235]
    s_lshl1_add_u32 m0, s36, 132096
    ds_read_b64_tr_b16 a[196:197], v9 offset:16384
    s_sub_u32 s56, 2047, s56
    v_mfma_f32_16x16x32_bf16 a[248:251], a[204:207], a[8:11], a[248:251]
    s_waitcnt vmcnt(22)
    ds_read_b64_tr_b16 a[198:199], v9 offset:18432
    v_cmp_eq_u32 s[80:81], s56, v20
    v_mfma_f32_16x16x32_bf16 a[252:255], a[204:207], a[12:15], a[252:255]
    buffer_load_dwordx4 v5, s[12:15], s38 offen lds
    v_mfma_f32_16x16x32_bf16 a[236:239], a[200:203], a[12:15], a[236:239]
    s_waitcnt lgkmcnt(4)
    v_exp_f32 v30, v30
    v_mfma_f32_16x16x32_bf16 a[236:239], a[208:211], a[28:31], a[236:239]
    s_lshl1_add_u32 m0, s36, 139264
    ds_read_b64_tr_b16 a[200:201], v8 offset:20480
    s_add_u32 s38, s34, 204928
    v_mfma_f32_16x16x32_bf16 a[252:255], a[212:215], a[28:31], a[252:255]
    s_add_u32 s57, s35, 204928
    ds_read_b64_tr_b16 a[202:203], v8 offset:22528
    s_cmp_lt_u32 s3, 2
    s_cselect_b32 s38, s38, s57
    v_mfma_f32_16x16x32_bf16 a[248:251], a[212:215], a[24:27], a[248:251]
    buffer_load_dwordx4 v4, s[12:15], s38 offen lds
    v_mfma_f32_16x16x32_bf16 a[232:235], a[208:211], a[24:27], a[232:235]
    s_cmp_ge_u32 s3, 2
    s_cselect_b32 s68, 0, 0xff00
    s_lshl_b32 s69, 0x10101, s53
    s_or_b32 s68, s68, s69
    s_sub_u32 s48, s48, s47
    v_mfma_f32_16x16x32_bf16 a[228:231], a[208:211], a[20:23], a[228:231]
    s_lshl1_add_u32 m0, s36, 140288
    ds_read_b64_tr_b16 a[204:205], v9 offset:20480
    v_bfe_u32 v12, v1, 3, 2
    v_mfma_f32_16x16x32_bf16 a[244:247], a[212:215], a[20:23], a[244:247]
    s_waitcnt vmcnt(15)
    ds_read_b64_tr_b16 a[206:207], v9 offset:22528
    v_mul_u32_u24 v23, s48, v12
    v_mfma_f32_16x16x32_bf16 a[240:243], a[212:215], a[16:19], a[240:243]
    v_add_u32 v23, s47, v23
    v_and_b32 v12, 7, v1
    v_mfma_f32_16x16x32_bf16 a[224:227], a[208:211], a[16:19], a[224:227]
    s_waitcnt lgkmcnt(4)
    v_mul_u32_u24 v13, 8389632, v12
    v_xor_b32 v23, v23, v13
    v_mfma_f32_16x16x32_bf16 a[224:227], a[192:195], a[32:35], a[224:227]
    ds_read_b64_tr_b16 a[208:209], v8 offset:24576
    v_lshrrev_b32 v13, v12, s93
    v_mfma_f32_16x16x32_bf16 a[240:243], a[196:199], a[32:35], a[240:243]
    ds_read_b64_tr_b16 a[210:211], v8 offset:26624
    v_and_b32 v13, 0x2000, v13
    v_mfma_f32_16x16x32_bf16 a[244:247], a[196:199], a[36:39], a[244:247]
    buffer_load_dwordx4 v5, s[12:15], s38 offen lds
    v_mfma_f32_16x16x32_bf16 a[228:231], a[192:195], a[36:39], a[228:231]
    v_xor_b32 v23, v23, v13
    s_lshr_b32 s56, s2, 4
    v_mfma_f32_16x16x32_bf16 a[232:235], a[192:195], a[40:43], a[232:235]
    s_lshl_b32 s56, s56, 14
    ds_read_b64_tr_b16 a[212:213], v9 offset:24576
    s_and_b32 s46, s2, 8
    v_mfma_f32_16x16x32_bf16 a[248:251], a[196:199], a[40:43], a[248:251]
    s_waitcnt vmcnt(21)
    ds_read_b64_tr_b16 a[214:215], v9 offset:26624
    s_lshl_b32 s46, s46, 9
    v_mfma_f32_16x16x32_bf16 a[252:255], a[196:199], a[44:47], a[252:255]
    s_add_u32 s56, s56, s46
    v_exp_f32 v31, v31
    v_mfma_f32_16x16x32_bf16 a[236:239], a[192:195], a[44:47], a[236:239]
    s_waitcnt lgkmcnt(4)
    v_add_f32 v30, 1.0, v30
    v_add_f32 v31, 1.0, v31
    v_mfma_f32_16x16x32_bf16 a[236:239], a[200:203], a[60:63], a[236:239]
    s_add_u32 s56, s56, 4456448
    ds_read_b64_tr_b16 a[192:193], v8 offset:28672
    s_lshl_b32 s46, s3, 1
    v_mfma_f32_16x16x32_bf16 a[252:255], a[204:207], a[60:63], a[252:255]
    ds_read_b64_tr_b16 a[194:195], v8 offset:30720
    v_bfe_u32 v12, v1, 1, 1
    v_mfma_f32_16x16x32_bf16 a[248:251], a[204:207], a[56:59], a[248:251]
    v_add_u32 v12, s46, v12
    v_lshrrev_b32 v3, v12, s93
    v_mfma_f32_16x16x32_bf16 a[232:235], a[200:203], a[56:59], a[232:235]
    v_and_b32 v3, 0x2000, v3
    v_lshl_add_u32 v3, v12, 9, v3
    v_mfma_f32_16x16x32_bf16 a[228:231], a[200:203], a[52:55], a[228:231]
    ds_read_b64_tr_b16 a[196:197], v9 offset:28672
    v_add_u32 v3, s56, v3
    v_mfma_f32_16x16x32_bf16 a[244:247], a[204:207], a[52:55], a[244:247]
    s_waitcnt vmcnt(12)
    ds_read_b64_tr_b16 a[198:199], v9 offset:30720
    v_and_b32 v12, 1, v1
    v_mfma_f32_16x16x32_bf16 a[240:243], a[204:207], a[48:51], a[240:243]
    v_lshl_add_u32 v3, v12, 7, v3
    v_lshrrev_b32 v12, 2, v1
    v_mfma_f32_16x16x32_bf16 a[224:227], a[200:203], a[48:51], a[224:227]
    s_waitcnt lgkmcnt(4)
    v_min_u32 v12, 1, v12
    v_lshl_or_b32 v3, v12, 30, v3
    v_mfma_f32_16x16x32_bf16 a[224:227], a[208:211], a[64:67], a[224:227]
    s_lshl_b32 s56, 1, s53
    ds_read_b64_tr_b16 a[200:201], v10 offset:0
    v_mov_b32 v128, s56
    v_mfma_f32_16x16x32_bf16 a[240:243], a[212:215], a[64:67], a[240:243]
    ds_read_b64_tr_b16 a[202:203], v10 offset:2048
    v_lshlrev_b32 v129, 8, v128
    v_mfma_f32_16x16x32_bf16 a[244:247], a[212:215], a[68:71], a[244:247]
    v_lshlrev_b32 v130, 16, v128
    v_or_b32 v131, v129, v130
    v_mfma_f32_16x16x32_bf16 a[228:231], a[208:211], a[68:71], a[228:231]
    s_mov_b32 s67, 0
    v_rcp_f32 v30, v30
    v_mfma_f32_16x16x32_bf16 a[232:235], a[208:211], a[72:75], a[232:235]
    s_lshl_b32 s37, s3, 2
    ds_read_b64_tr_b16 a[204:205], v11 offset:0
    s_lshr_b32 s37, 0x7410, s37
    v_mfma_f32_16x16x32_bf16 a[248:251], a[212:215], a[72:75], a[248:251]
    s_waitcnt vmcnt(8)
    ds_read_b64_tr_b16 a[206:207], v11 offset:2048
    s_and_b32 s37, s37, 7
    v_mfma_f32_16x16x32_bf16 a[252:255], a[212:215], a[76:79], a[252:255]
    s_lshl_b32 s37, s37, 13
    v_rcp_f32 v31, v31
    v_mfma_f32_16x16x32_bf16 a[236:239], a[208:211], a[76:79], a[236:239]
    s_waitcnt lgkmcnt(4)
    v_mul_f32 v26, v26, v30
    v_mul_f32 v27, v27, v31
    v_mfma_f32_16x16x32_bf16 a[236:239], a[192:195], a[92:95], a[236:239]
    s_lshl_b32 s56, s3, 9
    ds_read_b64_tr_b16 a[208:209], v10 offset:4096
    v_cvt_pk_bf16_f32 v171, v26, v27
    v_mfma_f32_16x16x32_bf16 a[252:255], a[196:199], a[92:95], a[252:255]
    s_add_u32 s56, s56, 159744
    ds_read_b64_tr_b16 a[210:211], v10 offset:6144
    v_lshlrev_b32 v138, 3, v1
    v_mfma_f32_16x16x32_bf16 a[248:251], a[196:199], a[88:91], a[248:251]
    v_add_u32 v138, s56, v138
    v_mov_b32 v139, 256
    v_mfma_f32_16x16x32_bf16 a[232:235], a[192:195], a[88:91], a[232:235]
    v_cndmask_b32 v139, 0, v139, s[80:81]
    v_lshl_add_u32 v139, v21, 4, v139
    v_mfma_f32_16x16x32_bf16 a[228:231], a[192:195], a[84:87], a[228:231]
    ds_read_b64_tr_b16 a[212:213], v11 offset:4096
    v_add_u32 v139, s56, v139
    v_mfma_f32_16x16x32_bf16 a[244:247], a[196:199], a[84:87], a[244:247]
    s_mov_b32 s59, 3670016
    ds_read_b64_tr_b16 a[214:215], v11 offset:6144
    v_lshlrev_b32 v26, 16, v152
    v_mfma_f32_16x16x32_bf16 a[240:243], a[196:199], a[80:83], a[240:243]
    s_or_b64 s[88:89], s[78:79], s[80:81]
    s_cselect_b32 s59, s59, 0x70000000
    v_and_b32 v27, 0xffff0000, v152
    v_mfma_f32_16x16x32_bf16 a[224:227], a[192:195], a[80:83], a[224:227]
    s_waitcnt lgkmcnt(4)
    v_fma_f32 v26, v26, v25, v24
    v_fma_f32 v27, v27, v25, v24
    v_mfma_f32_16x16x32_bf16 v[68:71], a[200:203], a[160:163], v[68:71]
    ds_read_b64_tr_b16 a[192:193], v10 offset:8192
    v_mul_f32 v30, s92, v26
    v_mfma_f32_16x16x32_bf16 v[100:103], a[204:207], a[160:163], v[100:103]
    ds_read_b64_tr_b16 a[194:195], v10 offset:10240
    v_mul_f32 v31, s92, v27
    v_mfma_f32_16x16x32_bf16 v[108:111], a[204:207], a[164:167], v[108:111]
    v_exp_f32 v30, v30
    v_mfma_f32_16x16x32_bf16 v[76:79], a[200:203], a[164:167], v[76:79]
    v_exp_f32 v31, v31
    v_mfma_f32_16x16x32_bf16 v[84:87], a[200:203], a[168:171], v[84:87]
    ds_read_b64_tr_b16 a[196:197], v11 offset:8192
    v_add_f32 v30, 1.0, v30
    v_mfma_f32_16x16x32_bf16 v[116:119], a[204:207], a[168:171], v[116:119]
    ds_read_b64_tr_b16 a[198:199], v11 offset:10240
    v_add_f32 v31, 1.0, v31
    v_mfma_f32_16x16x32_bf16 v[124:127], a[204:207], a[172:175], v[124:127]
    v_accvgpr_read_b32 v64, a224
    v_accvgpr_read_b32 v65, a225
    v_mfma_f32_16x16x32_bf16 v[92:95], a[200:203], a[172:175], v[92:95]
    s_waitcnt lgkmcnt(4)
    v_accvgpr_read_b32 v66, a226
    v_accvgpr_read_b32 v67, a227
    v_mfma_f32_16x16x32_bf16 v[92:95], a[208:211], a[188:191], v[92:95]
    ds_read_b64_tr_b16 a[200:201], v10 offset:12288
    v_accvgpr_read_b32 v72, a240
    v_mfma_f32_16x16x32_bf16 v[124:127], a[212:215], a[188:191], v[124:127]
    ds_read_b64_tr_b16 a[202:203], v10 offset:14336
    v_accvgpr_read_b32 v73, a241
    v_mfma_f32_16x16x32_bf16 v[116:119], a[212:215], a[184:187], v[116:119]
    v_accvgpr_read_b32 v74, a242
    v_accvgpr_read_b32 v75, a243
    v_mfma_f32_16x16x32_bf16 v[84:87], a[208:211], a[184:187], v[84:87]
    v_cvt_pk_bf16_f32 v64, v64, v65
    v_cvt_pk_bf16_f32 v65, v66, v67
    v_mfma_f32_16x16x32_bf16 v[76:79], a[208:211], a[180:183], v[76:79]
    ds_read_b64_tr_b16 a[204:205], v11 offset:12288
    v_cvt_pk_bf16_f32 v66, v72, v73
    v_mfma_f32_16x16x32_bf16 v[108:111], a[212:215], a[180:183], v[108:111]
    ds_read_b64_tr_b16 a[206:207], v11 offset:14336
    v_cvt_pk_bf16_f32 v67, v74, v75
    v_mfma_f32_16x16x32_bf16 v[100:103], a[212:215], a[176:179], v[100:103]
    buffer_store_dwordx4 v[64:67], v6, s[24:27], s55 offen sc1
    v_mfma_f32_16x16x32_bf16 v[68:71], a[208:211], a[176:179], v[68:71]
    s_waitcnt lgkmcnt(4)
    v_accvgpr_read_b32 v80, a228
    v_accvgpr_read_b32 v81, a229
    v_mfma_f32_16x16x32_bf16 v[68:71], a[192:195], a[0:3], v[68:71]
    s_xor_b32 s55, s55, 1024
    ds_read_b64_tr_b16 a[208:209], v10 offset:16384
    v_accvgpr_read_b32 v82, a230
    v_mfma_f32_16x16x32_bf16 v[100:103], a[196:199], a[0:3], v[100:103]
    ds_read_b64_tr_b16 a[210:211], v10 offset:18432
    v_accvgpr_read_b32 v83, a231
    v_mfma_f32_16x16x32_bf16 v[108:111], a[196:199], a[4:7], v[108:111]
    v_accvgpr_read_b32 v88, a244
    v_accvgpr_read_b32 v89, a245
    v_mfma_f32_16x16x32_bf16 v[76:79], a[192:195], a[4:7], v[76:79]
    v_accvgpr_read_b32 v90, a246
    v_accvgpr_read_b32 v91, a247
    v_mfma_f32_16x16x32_bf16 v[84:87], a[192:195], a[8:11], v[84:87]
    ds_read_b64_tr_b16 a[212:213], v11 offset:16384
    v_cvt_pk_bf16_f32 v80, v80, v81
    v_mfma_f32_16x16x32_bf16 v[116:119], a[196:199], a[8:11], v[116:119]
    ds_read_b64_tr_b16 a[214:215], v11 offset:18432
    v_cvt_pk_bf16_f32 v81, v82, v83
    v_mfma_f32_16x16x32_bf16 v[124:127], a[196:199], a[12:15], v[124:127]
    v_cvt_pk_bf16_f32 v82, v88, v89
    v_cvt_pk_bf16_f32 v83, v90, v91
    v_mfma_f32_16x16x32_bf16 v[92:95], a[192:195], a[12:15], v[92:95]
    s_waitcnt lgkmcnt(4)
    buffer_store_dwordx4 v[80:83], v6, s[24:27], s55 offen sc1
    v_mfma_f32_16x16x32_bf16 v[92:95], a[200:203], a[28:31], v[92:95]
    s_xor_b32 s55, s55, 3072
    ds_read_b64_tr_b16 a[192:193], v10 offset:20480
    v_accvgpr_read_b32 v96, a232
    v_mfma_f32_16x16x32_bf16 v[124:127], a[204:207], a[28:31], v[124:127]
    ds_read_b64_tr_b16 a[194:195], v10 offset:22528
    v_accvgpr_read_b32 v97, a233
    v_mfma_f32_16x16x32_bf16 v[116:119], a[204:207], a[24:27], v[116:119]
    v_accvgpr_read_b32 v98, a234
    v_accvgpr_read_b32 v99, a235
    v_mfma_f32_16x16x32_bf16 v[84:87], a[200:203], a[24:27], v[84:87]
    v_accvgpr_read_b32 v104, a248
    v_accvgpr_read_b32 v105, a249
    v_mfma_f32_16x16x32_bf16 v[76:79], a[200:203], a[20:23], v[76:79]
    ds_read_b64_tr_b16 a[196:197], v11 offset:20480
    v_accvgpr_read_b32 v106, a250
    v_mfma_f32_16x16x32_bf16 v[108:111], a[204:207], a[20:23], v[108:111]
    ds_read_b64_tr_b16 a[198:199], v11 offset:22528
    v_accvgpr_read_b32 v107, a251
    v_mfma_f32_16x16x32_bf16 v[100:103], a[204:207], a[16:19], v[100:103]
    v_cvt_pk_bf16_f32 v96, v96, v97
    v_cvt_pk_bf16_f32 v97, v98, v99
    v_mfma_f32_16x16x32_bf16 v[68:71], a[200:203], a[16:19], v[68:71]
    s_waitcnt lgkmcnt(4)
    v_cvt_pk_bf16_f32 v98, v104, v105
    v_cvt_pk_bf16_f32 v99, v106, v107
    v_mfma_f32_16x16x32_bf16 v[68:71], a[208:211], a[32:35], v[68:71]
    ds_read_b64_tr_b16 a[200:201], v10 offset:24576
    v_accvgpr_read_b32 v112, a236
    v_mfma_f32_16x16x32_bf16 v[100:103], a[212:215], a[32:35], v[100:103]
    ds_read_b64_tr_b16 a[202:203], v10 offset:26624
    v_accvgpr_read_b32 v113, a237
    v_mfma_f32_16x16x32_bf16 v[108:111], a[212:215], a[36:39], v[108:111]
    buffer_store_dwordx4 v[96:99], v7, s[24:27], s55 offen sc1
    v_mfma_f32_16x16x32_bf16 v[76:79], a[208:211], a[36:39], v[76:79]
    s_xor_b32 s55, s55, 1024
    v_accvgpr_read_b32 v114, a238
    v_accvgpr_read_b32 v115, a239
    v_mfma_f32_16x16x32_bf16 v[84:87], a[208:211], a[40:43], v[84:87]
    s_add_u32 m0, s36, 147456
    ds_read_b64_tr_b16 a[204:205], v11 offset:24576
    v_accvgpr_read_b32 v120, a252
    v_mfma_f32_16x16x32_bf16 v[116:119], a[212:215], a[40:43], v[116:119]
    s_add_u32 s38, s34, 123136
    ds_read_b64_tr_b16 a[206:207], v11 offset:26624
    v_accvgpr_read_b32 v121, a253
    v_mfma_f32_16x16x32_bf16 v[124:127], a[212:215], a[44:47], v[124:127]
    s_add_u32 s57, s35, 123136
    v_accvgpr_read_b32 v122, a254
    v_accvgpr_read_b32 v123, a255
    v_mfma_f32_16x16x32_bf16 v[92:95], a[208:211], a[44:47], v[92:95]
    s_waitcnt lgkmcnt(4)
    v_cvt_pk_bf16_f32 v112, v112, v113
    v_cvt_pk_bf16_f32 v113, v114, v115
    v_mfma_f32_16x16x32_bf16 v[92:95], a[192:195], a[60:63], v[92:95]
    s_cmp_lt_u32 s3, 2
    s_cselect_b32 s38, s38, s57
    ds_read_b64_tr_b16 a[208:209], v10 offset:28672
    v_mfma_f32_16x16x32_bf16 v[124:127], a[196:199], a[60:63], v[124:127]
    ds_read_b64_tr_b16 a[210:211], v10 offset:30720
    v_cvt_pk_bf16_f32 v114, v120, v121
    v_mfma_f32_16x16x32_bf16 v[116:119], a[196:199], a[56:59], v[116:119]
    buffer_load_dwordx4 v2, s[12:15], s38 offen lds
    v_mfma_f32_16x16x32_bf16 v[84:87], a[192:195], a[56:59], v[84:87]
    s_add_u32 m0, s36, 151552
    v_cvt_pk_bf16_f32 v115, v122, v123
    v_add_u32 v4, s37, v28
    v_mfma_f32_16x16x32_bf16 v[76:79], a[192:195], a[52:55], v[76:79]
    s_add_u32 s38, s33, 164096
    ds_read_b64_tr_b16 a[212:213], v11 offset:28672
    v_and_b32 v14, 15, v1
    v_mfma_f32_16x16x32_bf16 v[108:111], a[196:199], a[52:55], v[108:111]
    s_waitcnt vmcnt(4)
    ds_read_b64_tr_b16 a[214:215], v11 offset:30720
    v_lshl_add_u32 v14, s3, 4, v14
    v_mfma_f32_16x16x32_bf16 v[100:103], a[196:199], a[48:51], v[100:103]
    s_barrier
    v_mfma_f32_16x16x32_bf16 v[68:71], a[192:195], a[48:51], v[68:71]
    s_waitcnt lgkmcnt(4)
    buffer_store_dwordx4 v[112:115], v7, s[24:27], s55 offen sc1
    v_mfma_f32_16x16x32_bf16 v[68:71], a[200:203], a[64:67], v[68:71]
    s_add_u32 s57, s34, 164096
    ds_read_b64_tr_b16 a[192:193], v8 offset:32768
    v_lshlrev_b32 v14, 6, v14
    v_mfma_f32_16x16x32_bf16 v[100:103], a[204:207], a[64:67], v[100:103]
    s_cmp_lt_u32 s3, 2
    s_cselect_b32 s38, s38, s57
    ds_read_b64_tr_b16 a[194:195], v8 offset:34816
    v_mfma_f32_16x16x32_bf16 v[108:111], a[204:207], a[68:71], v[108:111]
    s_getpc_b64 s[8:9]
ct5:
    s_add_u32 s8, s8, post_code-ct5
    s_addc_u32 s9, s9, 0
    global_load_dword a216, v14, s[8:9]
    v_mfma_f32_16x16x32_bf16 v[76:79], a[200:203], a[68:71], v[76:79]
    buffer_load_dwordx4 v2, s[12:15], s38 offen lds
    v_mfma_f32_16x16x32_bf16 v[84:87], a[200:203], a[72:75], v[84:87]
    s_add_u32 m0, s36, 155648
    ds_read_b64_tr_b16 a[196:197], v9 offset:32768
    s_add_u32 s38, s35, 164096
    v_mfma_f32_16x16x32_bf16 v[116:119], a[204:207], a[72:75], v[116:119]
    s_add_u32 s57, s33, 205056
    ds_read_b64_tr_b16 a[198:199], v9 offset:34816
    s_cmp_lt_u32 s3, 2
    s_cselect_b32 s38, s38, s57
    v_mfma_f32_16x16x32_bf16 v[124:127], a[204:207], a[76:79], v[124:127]
    buffer_load_dwordx4 v2, s[12:15], s38 offen lds
    v_mfma_f32_16x16x32_bf16 v[92:95], a[200:203], a[76:79], v[92:95]
    s_waitcnt lgkmcnt(4)
    v_rcp_f32 v30, v30
    v_mfma_f32_16x16x32_bf16 v[92:95], a[208:211], a[92:95], v[92:95]
    s_add_u32 m0, s36, 159744
    ds_read_b64_tr_b16 a[200:201], v8 offset:36864
    s_add_u32 s38, s34, 205056
    v_mfma_f32_16x16x32_bf16 v[124:127], a[212:215], a[92:95], v[124:127]
    s_add_u32 s57, s35, 205056
    ds_read_b64_tr_b16 a[202:203], v8 offset:38912
    s_cmp_lt_u32 s3, 2
    s_cselect_b32 s38, s38, s57
    v_mfma_f32_16x16x32_bf16 v[116:119], a[212:215], a[88:91], v[116:119]
    buffer_load_dwordx4 v2, s[12:15], s38 offen lds
    v_mfma_f32_16x16x32_bf16 v[84:87], a[208:211], a[88:91], v[84:87]
    s_xor_b32 s55, s55, 3072
    v_rcp_f32 v31, v31
    v_mfma_f32_16x16x32_bf16 v[76:79], a[208:211], a[84:87], v[76:79]
    s_add_u32 s55, s55, 16384
    ds_read_b64_tr_b16 a[204:205], v9 offset:36864
    v_mul_f32 v26, v26, v30
    v_mfma_f32_16x16x32_bf16 v[108:111], a[212:215], a[84:87], v[108:111]
    ds_read_b64_tr_b16 a[206:207], v9 offset:38912
    v_mul_f32 v27, v27, v31
    v_mfma_f32_16x16x32_bf16 v[100:103], a[212:215], a[80:83], v[100:103]
    v_cvt_pk_bf16_f32 v176, v26, v27
    v_lshlrev_b32 v26, 16, v153
    v_mfma_f32_16x16x32_bf16 v[68:71], a[208:211], a[80:83], v[68:71]
    s_waitcnt lgkmcnt(4)
    v_and_b32 v27, 0xffff0000, v153
    v_fma_f32 v26, v26, v25, v24
    v_mfma_f32_16x16x32_bf16 v[132:135], a[192:195], a[160:163], v[132:135]
    ds_read_b64_tr_b16 a[208:209], v8 offset:40960
    v_fma_f32 v27, v27, v25, v24
    v_mfma_f32_16x16x32_bf16 v[164:167], a[196:199], a[160:163], v[164:167]
    ds_read_b64_tr_b16 a[210:211], v8 offset:43008
    v_mul_f32 v30, s92, v26
    v_mfma_f32_16x16x32_bf16 v[172:175], a[196:199], a[164:167], v[172:175]
    v_mul_f32 v31, s92, v27
    v_mfma_f32_16x16x32_bf16 v[140:143], a[192:195], a[164:167], v[140:143]
    v_exp_f32 v30, v30
    v_mfma_f32_16x16x32_bf16 v[148:151], a[192:195], a[168:171], v[148:151]
    ds_read_b64_tr_b16 a[212:213], v9 offset:40960
    v_mfma_f32_16x16x32_bf16 v[180:183], a[196:199], a[168:171], v[180:183]
    ds_read_b64_tr_b16 a[214:215], v9 offset:43008
    v_mfma_f32_16x16x32_bf16 v[188:191], a[196:199], a[172:175], v[188:191]
    v_cvt_pk_bf16_f32 v68, v68, v69
    v_cvt_pk_bf16_f32 v69, v70, v71
    v_mfma_f32_16x16x32_bf16 v[156:159], a[192:195], a[172:175], v[156:159]
    s_waitcnt lgkmcnt(4)
    v_cvt_pk_bf16_f32 v70, v100, v101
    v_cvt_pk_bf16_f32 v71, v102, v103
    v_mfma_f32_16x16x32_bf16 v[156:159], a[200:203], a[188:191], v[156:159]
    ds_read_b64_tr_b16 a[192:193], v8 offset:45056
    v_cvt_pk_bf16_f32 v76, v76, v77
    v_mfma_f32_16x16x32_bf16 v[188:191], a[204:207], a[188:191], v[188:191]
    ds_read_b64_tr_b16 a[194:195], v8 offset:47104
    v_cvt_pk_bf16_f32 v77, v78, v79
    v_mfma_f32_16x16x32_bf16 v[180:183], a[204:207], a[184:187], v[180:183]
    buffer_store_dwordx4 v[68:71], v6, s[24:27], s55 offen sc1
    v_mfma_f32_16x16x32_bf16 v[148:151], a[200:203], a[184:187], v[148:151]
    s_xor_b32 s55, s55, 1024
    v_cvt_pk_bf16_f32 v78, v108, v109
    v_cvt_pk_bf16_f32 v79, v110, v111
    v_mfma_f32_16x16x32_bf16 v[140:143], a[200:203], a[180:183], v[140:143]
    ds_read_b64_tr_b16 a[196:197], v9 offset:45056
    v_cvt_pk_bf16_f32 v84, v84, v85
    v_mfma_f32_16x16x32_bf16 v[172:175], a[204:207], a[180:183], v[172:175]
    ds_read_b64_tr_b16 a[198:199], v9 offset:47104
    v_cvt_pk_bf16_f32 v85, v86, v87
    v_mfma_f32_16x16x32_bf16 v[164:167], a[204:207], a[176:179], v[164:167]
    v_cvt_pk_bf16_f32 v86, v116, v117
    v_cvt_pk_bf16_f32 v87, v118, v119
    v_mfma_f32_16x16x32_bf16 v[132:135], a[200:203], a[176:179], v[132:135]
    s_waitcnt lgkmcnt(4)
    v_cvt_pk_bf16_f32 v92, v92, v93
    v_cvt_pk_bf16_f32 v93, v94, v95
    v_mfma_f32_16x16x32_bf16 v[132:135], a[208:211], a[0:3], v[132:135]
    ds_read_b64_tr_b16 a[200:201], v8 offset:49152
    v_cvt_pk_bf16_f32 v94, v124, v125
    v_mfma_f32_16x16x32_bf16 v[164:167], a[212:215], a[0:3], v[164:167]
    ds_read_b64_tr_b16 a[202:203], v8 offset:51200
    v_cvt_pk_bf16_f32 v95, v126, v127
    v_mfma_f32_16x16x32_bf16 v[172:175], a[212:215], a[4:7], v[172:175]
    buffer_store_dwordx4 v[76:79], v6, s[24:27], s55 offen sc1
    v_mfma_f32_16x16x32_bf16 v[140:143], a[208:211], a[4:7], v[140:143]
    s_xor_b32 s55, s55, 3072
    v_exp_f32 v31, v31
    v_mfma_f32_16x16x32_bf16 v[148:151], a[208:211], a[8:11], v[148:151]
    ds_read_b64_tr_b16 a[204:205], v9 offset:49152
    v_add_f32 v30, 1.0, v30
    v_mfma_f32_16x16x32_bf16 v[180:183], a[212:215], a[8:11], v[180:183]
    ds_read_b64_tr_b16 a[206:207], v9 offset:51200
    v_add_f32 v31, 1.0, v31
    v_mfma_f32_16x16x32_bf16 v[188:191], a[212:215], a[12:15], v[188:191]
    v_rcp_f32 v30, v30
    v_mfma_f32_16x16x32_bf16 v[156:159], a[208:211], a[12:15], v[156:159]
    s_waitcnt lgkmcnt(4)
    v_rcp_f32 v31, v31
    v_mfma_f32_16x16x32_bf16 v[156:159], a[192:195], a[28:31], v[156:159]
    ds_read_b64_tr_b16 a[208:209], v8 offset:53248
    v_mul_f32 v26, v26, v30
    v_mfma_f32_16x16x32_bf16 v[188:191], a[196:199], a[28:31], v[188:191]
    ds_read_b64_tr_b16 a[210:211], v8 offset:55296
    v_mul_f32 v27, v27, v31
    v_mfma_f32_16x16x32_bf16 v[180:183], a[196:199], a[24:27], v[180:183]
    v_cvt_pk_bf16_f32 v177, v26, v27
    v_lshlrev_b32 v26, 16, v154
    v_mfma_f32_16x16x32_bf16 v[148:151], a[192:195], a[24:27], v[148:151]
    v_and_b32 v27, 0xffff0000, v154
    v_fma_f32 v26, v26, v25, v24
    v_mfma_f32_16x16x32_bf16 v[140:143], a[192:195], a[20:23], v[140:143]
    ds_read_b64_tr_b16 a[212:213], v9 offset:53248
    v_fma_f32 v27, v27, v25, v24
    v_mfma_f32_16x16x32_bf16 v[172:175], a[196:199], a[20:23], v[172:175]
    ds_read_b64_tr_b16 a[214:215], v9 offset:55296
    v_mul_f32 v30, s92, v26
    v_mfma_f32_16x16x32_bf16 v[164:167], a[196:199], a[16:19], v[164:167]
    buffer_store_dwordx4 v[84:87], v7, s[24:27], s55 offen sc1
    v_mfma_f32_16x16x32_bf16 v[132:135], a[192:195], a[16:19], v[132:135]
    s_waitcnt lgkmcnt(4)
    v_mul_f32 v31, s92, v27
    s_xor_b32 s55, s55, 1024
    v_mfma_f32_16x16x32_bf16 v[132:135], a[200:203], a[32:35], v[132:135]
    ds_read_b64_tr_b16 a[192:193], v8 offset:57344
    v_mfma_f32_16x16x32_bf16 v[164:167], a[204:207], a[32:35], v[164:167]
    ds_read_b64_tr_b16 a[194:195], v8 offset:59392
    v_mfma_f32_16x16x32_bf16 v[172:175], a[204:207], a[36:39], v[172:175]
    v_exp_f32 v30, v30
    v_mfma_f32_16x16x32_bf16 v[140:143], a[200:203], a[36:39], v[140:143]
    v_exp_f32 v31, v31
    v_mfma_f32_16x16x32_bf16 v[148:151], a[200:203], a[40:43], v[148:151]
    ds_read_b64_tr_b16 a[196:197], v9 offset:57344
    v_add_f32 v30, 1.0, v30
    v_mfma_f32_16x16x32_bf16 v[180:183], a[204:207], a[40:43], v[180:183]
    ds_read_b64_tr_b16 a[198:199], v9 offset:59392
    v_add_f32 v31, 1.0, v31
    v_mfma_f32_16x16x32_bf16 v[188:191], a[204:207], a[44:47], v[188:191]
    v_rcp_f32 v30, v30
    v_mfma_f32_16x16x32_bf16 v[156:159], a[200:203], a[44:47], v[156:159]
    s_waitcnt lgkmcnt(4)
    v_rcp_f32 v31, v31
    v_mfma_f32_16x16x32_bf16 v[156:159], a[208:211], a[60:63], v[156:159]
    ds_read_b64_tr_b16 a[200:201], v8 offset:61440
    v_mul_f32 v26, v26, v30
    v_mfma_f32_16x16x32_bf16 v[188:191], a[212:215], a[60:63], v[188:191]
    ds_read_b64_tr_b16 a[202:203], v8 offset:63488
    v_mul_f32 v27, v27, v31
    v_mfma_f32_16x16x32_bf16 v[180:183], a[212:215], a[56:59], v[180:183]
    buffer_load_dword v137, v136, s[24:27], s59 offen offset:128 sc1
    v_mfma_f32_16x16x32_bf16 v[148:151], a[208:211], a[56:59], v[148:151]
    buffer_store_dwordx4 v[92:95], v7, s[24:27], s55 offen sc1
    v_mfma_f32_16x16x32_bf16 v[140:143], a[208:211], a[52:55], v[140:143]
    s_xor_b32 s55, s55, 3072
    ds_read_b64_tr_b16 a[204:205], v9 offset:61440
    v_cvt_pk_bf16_f32 v178, v26, v27
    v_mfma_f32_16x16x32_bf16 v[172:175], a[212:215], a[52:55], v[172:175]
    s_add_u32 s55, s55, 16384
    ds_read_b64_tr_b16 a[206:207], v9 offset:63488
    v_lshlrev_b32 v26, 16, v155
    v_mfma_f32_16x16x32_bf16 v[164:167], a[212:215], a[48:51], v[164:167]
    v_and_b32 v27, 0xffff0000, v155
    v_fma_f32 v26, v26, v25, v24
    v_mfma_f32_16x16x32_bf16 v[132:135], a[208:211], a[48:51], v[132:135]
    s_waitcnt lgkmcnt(4)
    v_fma_f32 v27, v27, v25, v24
    v_mul_f32 v30, s92, v26
    v_mfma_f32_16x16x32_bf16 v[132:135], a[192:195], a[64:67], v[132:135]
    ds_read_b64_tr_b16 a[208:209], v10 offset:32768
    v_mul_f32 v31, s92, v27
    v_mfma_f32_16x16x32_bf16 v[164:167], a[196:199], a[64:67], v[164:167]
    ds_read_b64_tr_b16 a[210:211], v10 offset:34816
    v_bfe_u32 v224, v1, 3, 1
    v_mfma_f32_16x16x32_bf16 v[172:175], a[196:199], a[68:71], v[172:175]
    s_load_dword s67, s[86:87], s5 glc
    v_exp_f32 v30, v30
    v_mfma_f32_16x16x32_bf16 v[140:143], a[192:195], a[68:71], v[140:143]
    v_exp_f32 v31, v31
    v_mfma_f32_16x16x32_bf16 v[148:151], a[192:195], a[72:75], v[148:151]
    ds_read_b64_tr_b16 a[212:213], v11 offset:32768
    v_add_f32 v30, 1.0, v30
    v_mfma_f32_16x16x32_bf16 v[180:183], a[196:199], a[72:75], v[180:183]
    ds_read_b64_tr_b16 a[214:215], v11 offset:34816
    v_add_f32 v31, 1.0, v31
    v_mfma_f32_16x16x32_bf16 v[188:191], a[196:199], a[76:79], v[188:191]
    v_rcp_f32 v30, v30
    v_mfma_f32_16x16x32_bf16 v[156:159], a[192:195], a[76:79], v[156:159]
    s_waitcnt lgkmcnt(4)
    v_rcp_f32 v31, v31
    v_mfma_f32_16x16x32_bf16 v[156:159], a[200:203], a[92:95], v[156:159]
    ds_read_b64_tr_b16 a[192:193], v10 offset:36864
    v_mul_f32 v26, v26, v30
    v_mfma_f32_16x16x32_bf16 v[188:191], a[204:207], a[92:95], v[188:191]
    ds_read_b64_tr_b16 a[194:195], v10 offset:38912
    v_mul_f32 v27, v27, v31
    v_mfma_f32_16x16x32_bf16 v[180:183], a[204:207], a[88:91], v[180:183]
    v_cvt_pk_bf16_f32 v179, v26, v27
    v_lshlrev_b32 v26, 16, v160
    v_mfma_f32_16x16x32_bf16 v[148:151], a[200:203], a[88:91], v[148:151]
    v_and_b32 v27, 0xffff0000, v160
    v_fma_f32 v26, v26, v25, v24
    v_mfma_f32_16x16x32_bf16 v[140:143], a[200:203], a[84:87], v[140:143]
    ds_read_b64_tr_b16 a[196:197], v11 offset:36864
    v_fma_f32 v27, v27, v25, v24
    v_mfma_f32_16x16x32_bf16 v[172:175], a[204:207], a[84:87], v[172:175]
    ds_read_b64_tr_b16 a[198:199], v11 offset:38912
    v_mul_f32 v30, s92, v26
    v_mfma_f32_16x16x32_bf16 v[164:167], a[204:207], a[80:83], v[164:167]
    s_waitcnt vmcnt(9)
    v_mul_f32 v31, s92, v27
    v_lshlrev_b32 v224, 1, v224
    v_mfma_f32_16x16x32_bf16 v[132:135], a[200:203], a[80:83], v[132:135]
    s_waitcnt lgkmcnt(4)
    v_exp_f32 v30, v30
    v_mfma_f32_16x16x32_bf16 v[196:199], a[208:211], a[160:163], v[196:199]
    ds_read_b64_tr_b16 a[200:201], v10 offset:40960
    v_lshrrev_b32 v225, 4, v1
    v_mfma_f32_16x16x32_bf16 v[228:231], a[212:215], a[160:163], v[228:231]
    ds_read_b64_tr_b16 a[202:203], v10 offset:43008
    v_sub_u32 v224, v225, v224
    v_mfma_f32_16x16x32_bf16 v[236:239], a[212:215], a[164:167], v[236:239]
    buffer_atomic_or v128, v3, s[24:27], 0 offen offset:0
    v_mfma_f32_16x16x32_bf16 v[204:207], a[208:211], a[164:167], v[204:207]
    v_exp_f32 v31, v31
    v_mfma_f32_16x16x32_bf16 v[212:215], a[208:211], a[168:171], v[212:215]
    ds_read_b64_tr_b16 a[204:205], v11 offset:40960
    v_add_f32 v30, 1.0, v30
    v_mfma_f32_16x16x32_bf16 v[244:247], a[212:215], a[168:171], v[244:247]
    ds_read_b64_tr_b16 a[206:207], v11 offset:43008
    v_add_f32 v31, 1.0, v31
    v_mfma_f32_16x16x32_bf16 v[252:255], a[212:215], a[172:175], v[252:255]
    v_cvt_pk_bf16_f32 v132, v132, v133
    v_cvt_pk_bf16_f32 v133, v134, v135
    v_mfma_f32_16x16x32_bf16 v[220:223], a[208:211], a[172:175], v[220:223]
    s_waitcnt lgkmcnt(4)
    v_cvt_pk_bf16_f32 v134, v164, v165
    v_cvt_pk_bf16_f32 v135, v166, v167
    v_mfma_f32_16x16x32_bf16 v[220:223], a[192:195], a[188:191], v[220:223]
    ds_read_b64_tr_b16 a[208:209], v10 offset:45056
    v_cvt_pk_bf16_f32 v140, v140, v141
    v_mfma_f32_16x16x32_bf16 v[252:255], a[196:199], a[188:191], v[252:255]
    ds_read_b64_tr_b16 a[210:211], v10 offset:47104
    v_cvt_pk_bf16_f32 v141, v142, v143
    v_mfma_f32_16x16x32_bf16 v[244:247], a[196:199], a[184:187], v[244:247]
pg_12:
    s_cbranch_execz pg_ret2
    buffer_store_dwordx4 v[132:135], v6, s[24:27], s55 offen sc1
    v_mfma_f32_16x16x32_bf16 v[212:215], a[192:195], a[184:187], v[212:215]
    s_xor_b32 s55, s55, 1024
    v_cvt_pk_bf16_f32 v142, v172, v173
    v_cvt_pk_bf16_f32 v143, v174, v175
    v_mfma_f32_16x16x32_bf16 v[204:207], a[192:195], a[180:183], v[204:207]
    ds_read_b64_tr_b16 a[212:213], v11 offset:45056
    v_cvt_pk_bf16_f32 v148, v148, v149
    v_mfma_f32_16x16x32_bf16 v[236:239], a[196:199], a[180:183], v[236:239]
    ds_read_b64_tr_b16 a[214:215], v11 offset:47104
    v_cvt_pk_bf16_f32 v149, v150, v151
    v_mfma_f32_16x16x32_bf16 v[228:231], a[196:199], a[176:179], v[228:231]
    v_cvt_pk_bf16_f32 v150, v180, v181
    v_cvt_pk_bf16_f32 v151, v182, v183
    v_mfma_f32_16x16x32_bf16 v[196:199], a[192:195], a[176:179], v[196:199]
    s_waitcnt lgkmcnt(4)
    v_cvt_pk_bf16_f32 v156, v156, v157
    v_cvt_pk_bf16_f32 v157, v158, v159
    v_mfma_f32_16x16x32_bf16 v[196:199], a[200:203], a[0:3], v[196:199]
    ds_read_b64_tr_b16 a[192:193], v10 offset:49152
    v_cvt_pk_bf16_f32 v158, v188, v189
    v_mfma_f32_16x16x32_bf16 v[228:231], a[204:207], a[0:3], v[228:231]
    ds_read_b64_tr_b16 a[194:195], v10 offset:51200
    v_cvt_pk_bf16_f32 v159, v190, v191
    v_mfma_f32_16x16x32_bf16 v[236:239], a[204:207], a[4:7], v[236:239]
    buffer_store_dwordx4 v[140:143], v6, s[24:27], s55 offen sc1
    v_mfma_f32_16x16x32_bf16 v[204:207], a[200:203], a[4:7], v[204:207]
    s_xor_b32 s55, s55, 3072
    v_rcp_f32 v30, v30
    v_mfma_f32_16x16x32_bf16 v[212:215], a[200:203], a[8:11], v[212:215]
    ds_read_b64_tr_b16 a[196:197], v11 offset:49152
    v_and_b32 v225, 1, v1
    v_mfma_f32_16x16x32_bf16 v[244:247], a[204:207], a[8:11], v[244:247]
    ds_read_b64_tr_b16 a[198:199], v11 offset:51200
    v_lshlrev_b32 v225, 4, v225
    v_mfma_f32_16x16x32_bf16 v[252:255], a[204:207], a[12:15], v[252:255]
    s_andn2_b32 s69, s67, s68
    s_and_b32 s69, s69, 255
    s_or_b32 s68, s68, s69
    v_mfma_f32_16x16x32_bf16 v[220:223], a[200:203], a[12:15], v[220:223]
    s_waitcnt lgkmcnt(4)
    v_readlane_b32 s56, v23, 0
    v_mov_b32 v226, 0x3f80
    v_mfma_f32_16x16x32_bf16 v[220:223], a[208:211], a[28:31], v[220:223]
    s_add_u32 m0, s37, 0
    ds_read_b64_tr_b16 a[200:201], v10 offset:53248
    v_lshlrev_b32 v225, v225, v226
    v_mfma_f32_16x16x32_bf16 v[252:255], a[212:215], a[28:31], v[252:255]
    s_bitcmp1_b32 s69, 0
    s_cselect_b32 s56, s56, 0x70000000
    s_cselect_b32 m0, m0, 0x30000
    ds_read_b64_tr_b16 a[202:203], v10 offset:55296
    v_mfma_f32_16x16x32_bf16 v[244:247], a[212:215], a[24:27], v[244:247]
    buffer_load_dwordx4 v28, s[24:27], s56 offen sc1 lds
    v_mfma_f32_16x16x32_bf16 v[212:215], a[208:211], a[24:27], v[212:215]
    v_readlane_b32 s56, v23, 1
    v_bfe_u32 v226, v1, 1, 2
    v_mfma_f32_16x16x32_bf16 v[204:207], a[208:211], a[20:23], v[204:207]
    s_waitcnt vmcnt(5)
    ds_read_b64_tr_b16 a[204:205], v11 offset:53248
    v_cmp_ne_u32 s[78:79], 24, v137
    v_mfma_f32_16x16x32_bf16 v[236:239], a[212:215], a[20:23], v[236:239]
    s_cmp_eq_u64 s[78:79], 0
    s_cselect_b32 s44, s59, 0x70000000
    ds_read_b64_tr_b16 a[206:207], v11 offset:55296
    v_mfma_f32_16x16x32_bf16 v[228:231], a[212:215], a[16:19], v[228:231]
    buffer_load_dwordx4 v[240:243], v192, s[24:27], s44 offen sc1
    v_mfma_f32_16x16x32_bf16 v[196:199], a[208:211], a[16:19], v[196:199]
    s_waitcnt lgkmcnt(4)
    v_rcp_f32 v31, v31
    v_mfma_f32_16x16x32_bf16 v[196:199], a[192:195], a[32:35], v[196:199]
    s_add_u32 m0, s37, 1024
    ds_read_b64_tr_b16 a[208:209], v10 offset:57344
    v_mul_f32 v26, v26, v30
    v_mfma_f32_16x16x32_bf16 v[228:231], a[196:199], a[32:35], v[228:231]
    s_bitcmp1_b32 s69, 1
    s_cselect_b32 s56, s56, 0x70000000
    s_cselect_b32 m0, m0, 0x30000
    ds_read_b64_tr_b16 a[210:211], v10 offset:59392
    v_mfma_f32_16x16x32_bf16 v[236:239], a[196:199], a[36:39], v[236:239]
    buffer_load_dwordx4 v28, s[24:27], s56 offen sc1 lds
    v_mfma_f32_16x16x32_bf16 v[204:207], a[192:195], a[36:39], v[204:207]
    v_readlane_b32 s56, v23, 2
    v_mul_f32 v27, v27, v31
    v_mfma_f32_16x16x32_bf16 v[212:215], a[192:195], a[40:43], v[212:215]
    s_add_u32 m0, s37, 2048
    ds_read_b64_tr_b16 a[212:213], v11 offset:57344
    v_cvt_pk_bf16_f32 v184, v26, v27
    v_mfma_f32_16x16x32_bf16 v[244:247], a[196:199], a[40:43], v[244:247]
    s_bitcmp1_b32 s69, 2
    s_cselect_b32 s56, s56, 0x70000000
    s_cselect_b32 m0, m0, 0x30000
    ds_read_b64_tr_b16 a[214:215], v11 offset:59392
    v_mfma_f32_16x16x32_bf16 v[252:255], a[196:199], a[44:47], v[252:255]
    buffer_load_dwordx4 v28, s[24:27], s56 offen sc1 lds
    v_mfma_f32_16x16x32_bf16 v[220:223], a[192:195], a[44:47], v[220:223]
    s_waitcnt lgkmcnt(4)
    v_readlane_b32 s56, v23, 3
    v_lshlrev_b32 v26, 16, v161
    v_mfma_f32_16x16x32_bf16 v[220:223], a[200:203], a[60:63], v[220:223]
    s_add_u32 m0, s37, 3072
    ds_read_b64_tr_b16 a[192:193], v10 offset:61440
    v_and_b32 v27, 0xffff0000, v161
    v_mfma_f32_16x16x32_bf16 v[252:255], a[204:207], a[60:63], v[252:255]
    s_bitcmp1_b32 s69, 3
    s_cselect_b32 s56, s56, 0x70000000
    s_cselect_b32 m0, m0, 0x30000
    ds_read_b64_tr_b16 a[194:195], v10 offset:63488
    v_mfma_f32_16x16x32_bf16 v[244:247], a[204:207], a[56:59], v[244:247]
    buffer_store_dwordx4 v[148:151], v7, s[24:27], s55 offen sc1
    v_mfma_f32_16x16x32_bf16 v[212:215], a[200:203], a[56:59], v[212:215]
    s_xor_b32 s55, s55, 1024
    v_fma_f32 v26, v26, v25, v24
    v_fma_f32 v27, v27, v25, v24
    v_mfma_f32_16x16x32_bf16 v[204:207], a[200:203], a[52:55], v[204:207]
    ds_read_b64_tr_b16 a[196:197], v11 offset:61440
    v_mul_f32 v30, s92, v26
    v_mfma_f32_16x16x32_bf16 v[236:239], a[204:207], a[52:55], v[236:239]
    s_waitcnt vmcnt(13)
    ds_read_b64_tr_b16 a[198:199], v11 offset:63488
    v_mul_f32 v31, s92, v27
    v_mfma_f32_16x16x32_bf16 v[228:231], a[204:207], a[48:51], v[228:231]
    s_barrier
    v_mfma_f32_16x16x32_bf16 v[196:199], a[200:203], a[48:51], v[196:199]
    s_waitcnt lgkmcnt(4)
    buffer_load_dwordx4 v28, s[24:27], s56 offen sc1 lds
    v_mfma_f32_16x16x32_bf16 v[196:199], a[208:211], a[64:67], v[196:199]
    ds_read_b64_tr_b16 a[200:201], v18 offset:0
    v_readlane_b32 s56, v23, 4
    v_mfma_f32_16x16x32_bf16 v[228:231], a[212:215], a[64:67], v[228:231]
    s_add_u32 m0, s37, 4096
    ds_read_b64_tr_b16 a[202:203], v18 offset:1024
    v_lshl_add_u32 v226, v224, 2, v226
    v_mfma_f32_16x16x32_bf16 v[236:239], a[212:215], a[68:71], v[236:239]
    buffer_store_dwordx4 v[156:159], v7, s[24:27], s55 offen sc1
    v_mfma_f32_16x16x32_bf16 v[204:207], a[208:211], a[68:71], v[204:207]
    s_bitcmp1_b32 s69, 4
    s_cselect_b32 s56, s56, 0x70000000
    s_cselect_b32 m0, m0, 0x30000
    v_mfma_f32_16x16x32_bf16 v[212:215], a[208:211], a[72:75], v[212:215]
    s_xor_b32 s55, s55, 3072
    ds_read_b64_tr_b16 a[204:205], v19 offset:0
    v_cmp_eq_u32 s[10:11], 0, v226
    v_mfma_f32_16x16x32_bf16 v[244:247], a[212:215], a[72:75], v[244:247]
    s_add_u32 s55, s55, 16384
    ds_read_b64_tr_b16 a[206:207], v19 offset:1024
    v_cndmask_b32 v208, 0, v225, s[10:11]
    v_mfma_f32_16x16x32_bf16 v[252:255], a[212:215], a[76:79], v[252:255]
    v_exp_f32 v30, v30
    v_mfma_f32_16x16x32_bf16 v[220:223], a[208:211], a[76:79], v[220:223]
    s_waitcnt lgkmcnt(4)
    buffer_load_dwordx4 v28, s[24:27], s56 offen sc1 lds
    v_mfma_f32_16x16x32_bf16 v[220:223], a[192:195], a[92:95], v[220:223]
    ds_read_b64_tr_b16 a[208:209], v18 offset:2048
    v_readlane_b32 s56, v23, 5
    v_mfma_f32_16x16x32_bf16 v[252:255], a[196:199], a[92:95], v[252:255]
    s_add_u32 m0, s37, 5120
    ds_read_b64_tr_b16 a[210:211], v18 offset:3072
    v_cmp_eq_u32 s[10:11], 1, v226
    v_mfma_f32_16x16x32_bf16 v[244:247], a[196:199], a[88:91], v[244:247]
    s_bitcmp1_b32 s69, 5
    s_cselect_b32 s56, s56, 0x70000000
    s_cselect_b32 m0, m0, 0x30000
    v_mfma_f32_16x16x32_bf16 v[212:215], a[192:195], a[88:91], v[212:215]
    buffer_load_dwordx4 v28, s[24:27], s56 offen sc1 lds
    v_mfma_f32_16x16x32_bf16 v[204:207], a[192:195], a[84:87], v[204:207]
    ds_read_b64_tr_b16 a[212:213], v19 offset:2048
    v_readlane_b32 s56, v23, 6
    v_mfma_f32_16x16x32_bf16 v[236:239], a[196:199], a[84:87], v[236:239]
    s_add_u32 m0, s37, 6144
    ds_read_b64_tr_b16 a[214:215], v19 offset:3072
    v_cndmask_b32 v209, 0, v225, s[10:11]
    v_mfma_f32_16x16x32_bf16 v[228:231], a[196:199], a[80:83], v[228:231]
    s_waitcnt vmcnt(12)
    v_exp_f32 v31, v31
    v_mfma_f32_16x16x32_bf16 v[196:199], a[192:195], a[80:83], v[196:199]
    s_waitcnt lgkmcnt(4)
    v_add_f32 v30, 1.0, v30
    v_add_f32 v31, 1.0, v31
    v_mfma_f32_16x16x32_bf16 v[32:35], a[200:203], a[160:163], v[32:35]
    s_bitcmp1_b32 s69, 6
    s_cselect_b32 s56, s56, 0x70000000
    s_cselect_b32 m0, m0, 0x30000
    ds_read_b64_tr_b16 a[192:193], v18 offset:4096
    v_mfma_f32_16x16x32_bf16 v[48:51], a[204:207], a[160:163], v[48:51]
    ds_read_b64_tr_b16 a[194:195], v18 offset:5120
    v_cmp_eq_u32 s[10:11], 2, v226
    v_mfma_f32_16x16x32_bf16 v[52:55], a[204:207], a[164:167], v[52:55]
    buffer_atomic_or v128, v3, s[24:27], 0 offen offset:256
    v_mfma_f32_16x16x32_bf16 v[36:39], a[200:203], a[164:167], v[36:39]
    buffer_load_dwordx4 v28, s[24:27], s56 offen sc1 lds
    v_mfma_f32_16x16x32_bf16 v[40:43], a[200:203], a[168:171], v[40:43]
    ds_read_b64_tr_b16 a[196:197], v19 offset:4096
    v_readlane_b32 s56, v23, 7
    v_mfma_f32_16x16x32_bf16 v[56:59], a[204:207], a[168:171], v[56:59]
    s_add_u32 m0, s37, 7168
    ds_read_b64_tr_b16 a[198:199], v19 offset:5120
    v_cndmask_b32 v210, 0, v225, s[10:11]
    v_mfma_f32_16x16x32_bf16 v[60:63], a[204:207], a[172:175], v[60:63]
    s_bitcmp1_b32 s69, 7
    s_cselect_b32 s56, s56, 0x70000000
    s_cselect_b32 m0, m0, 0x30000
    v_mfma_f32_16x16x32_bf16 v[44:47], a[200:203], a[172:175], v[44:47]
    s_waitcnt lgkmcnt(4)
    buffer_load_dwordx4 v28, s[24:27], s56 offen sc1 lds
    v_mfma_f32_16x16x32_bf16 v[44:47], a[208:211], a[188:191], v[44:47]
    ds_read_b64_tr_b16 a[200:201], v18 offset:6144
    v_cvt_pk_bf16_f32 v196, v196, v197
    v_mfma_f32_16x16x32_bf16 v[60:63], a[212:215], a[188:191], v[60:63]
    ds_read_b64_tr_b16 a[202:203], v18 offset:7168
    v_cvt_pk_bf16_f32 v197, v198, v199
    v_mfma_f32_16x16x32_bf16 v[56:59], a[212:215], a[184:187], v[56:59]
    v_cvt_pk_bf16_f32 v198, v228, v229
    v_cvt_pk_bf16_f32 v199, v230, v231
    v_mfma_f32_16x16x32_bf16 v[40:43], a[208:211], a[184:187], v[40:43]
    buffer_store_dwordx4 v[196:199], v6, s[24:27], s55 offen sc1
    v_mfma_f32_16x16x32_bf16 v[36:39], a[208:211], a[180:183], v[36:39]
    s_xor_b32 s55, s55, 1024
    ds_read_b64_tr_b16 a[204:205], v19 offset:6144
    v_cvt_pk_bf16_f32 v204, v204, v205
    v_mfma_f32_16x16x32_bf16 v[52:55], a[212:215], a[180:183], v[52:55]
    ds_read_b64_tr_b16 a[206:207], v19 offset:7168
    v_cvt_pk_bf16_f32 v205, v206, v207
    v_mfma_f32_16x16x32_bf16 v[48:51], a[212:215], a[176:179], v[48:51]
    v_cvt_pk_bf16_f32 v206, v236, v237
    v_cvt_pk_bf16_f32 v207, v238, v239
    v_mfma_f32_16x16x32_bf16 v[32:35], a[208:211], a[176:179], v[32:35]
    s_waitcnt lgkmcnt(4)
    v_cvt_pk_bf16_f32 v212, v212, v213
    v_cvt_pk_bf16_f32 v213, v214, v215
    v_mfma_f32_16x16x32_bf16 v[32:35], a[192:195], a[0:3], v[32:35]
    ds_read_b64_tr_b16 a[208:209], v18 offset:8192
    v_cvt_pk_bf16_f32 v214, v244, v245
    v_mfma_f32_16x16x32_bf16 v[48:51], a[196:199], a[0:3], v[48:51]
    ds_read_b64_tr_b16 a[210:211], v18 offset:9216
    v_cvt_pk_bf16_f32 v215, v246, v247
    v_mfma_f32_16x16x32_bf16 v[52:55], a[196:199], a[4:7], v[52:55]
    buffer_store_dwordx4 v[204:207], v6, s[24:27], s55 offen sc1
    v_mfma_f32_16x16x32_bf16 v[36:39], a[192:195], a[4:7], v[36:39]
    s_xor_b32 s55, s55, 3072
    v_cvt_pk_bf16_f32 v220, v220, v221
    v_cvt_pk_bf16_f32 v221, v222, v223
    v_mfma_f32_16x16x32_bf16 v[40:43], a[192:195], a[8:11], v[40:43]
    ds_read_b64_tr_b16 a[212:213], v19 offset:8192
    v_cvt_pk_bf16_f32 v222, v252, v253
    v_mfma_f32_16x16x32_bf16 v[56:59], a[196:199], a[8:11], v[56:59]
    ds_read_b64_tr_b16 a[214:215], v19 offset:9216
    v_cvt_pk_bf16_f32 v223, v254, v255
    v_mfma_f32_16x16x32_bf16 v[60:63], a[196:199], a[12:15], v[60:63]
    v_rcp_f32 v30, v30
    v_mfma_f32_16x16x32_bf16 v[44:47], a[192:195], a[12:15], v[44:47]
    s_waitcnt lgkmcnt(4)
    v_rcp_f32 v31, v31
    v_mfma_f32_16x16x32_bf16 v[44:47], a[200:203], a[28:31], v[44:47]
    ds_read_b64_tr_b16 a[192:193], v18 offset:10240
    v_mul_f32 v26, v26, v30
    v_mfma_f32_16x16x32_bf16 v[60:63], a[204:207], a[28:31], v[60:63]
    ds_read_b64_tr_b16 a[194:195], v18 offset:11264
    v_mul_f32 v27, v27, v31
    v_mfma_f32_16x16x32_bf16 v[56:59], a[204:207], a[24:27], v[56:59]
    v_cvt_pk_bf16_f32 v185, v26, v27
    v_lshlrev_b32 v26, 16, v162
    v_mfma_f32_16x16x32_bf16 v[40:43], a[200:203], a[24:27], v[40:43]
    v_and_b32 v27, 0xffff0000, v162
    v_fma_f32 v26, v26, v25, v24
    v_mfma_f32_16x16x32_bf16 v[36:39], a[200:203], a[20:23], v[36:39]
    ds_read_b64_tr_b16 a[196:197], v19 offset:10240
    v_fma_f32 v27, v27, v25, v24
    v_mfma_f32_16x16x32_bf16 v[52:55], a[204:207], a[20:23], v[52:55]
    ds_read_b64_tr_b16 a[198:199], v19 offset:11264
    v_mul_f32 v30, s92, v26
    v_mfma_f32_16x16x32_bf16 v[48:51], a[204:207], a[16:19], v[48:51]
    buffer_store_dwordx4 v[212:215], v7, s[24:27], s55 offen sc1
    v_mfma_f32_16x16x32_bf16 v[32:35], a[200:203], a[16:19], v[32:35]
    s_waitcnt lgkmcnt(4)
    v_mul_f32 v31, s92, v27
    v_cmp_eq_u32 s[10:11], 3, v226
    v_mfma_f32_16x16x32_bf16 v[32:35], a[208:211], a[32:35], v[32:35]
    s_xor_b32 s55, s55, 1024
    ds_read_b64_tr_b16 a[200:201], v18 offset:12288
    v_cndmask_b32 v211, 0, v225, s[10:11]
    v_mfma_f32_16x16x32_bf16 v[48:51], a[212:215], a[32:35], v[48:51]
    ds_read_b64_tr_b16 a[202:203], v18 offset:13312
    v_cmp_eq_u32 s[10:11], 4, v226
    v_mfma_f32_16x16x32_bf16 v[52:55], a[212:215], a[36:39], v[52:55]
    v_exp_f32 v30, v30
    v_mfma_f32_16x16x32_bf16 v[36:39], a[208:211], a[36:39], v[36:39]
    v_exp_f32 v31, v31
    v_mfma_f32_16x16x32_bf16 v[40:43], a[208:211], a[40:43], v[40:43]
    ds_read_b64_tr_b16 a[204:205], v19 offset:12288
    v_add_f32 v30, 1.0, v30
    v_mfma_f32_16x16x32_bf16 v[56:59], a[212:215], a[40:43], v[56:59]
    ds_read_b64_tr_b16 a[206:207], v19 offset:13312
    v_add_f32 v31, 1.0, v31
    v_mfma_f32_16x16x32_bf16 v[60:63], a[212:215], a[44:47], v[60:63]
    s_waitcnt vmcnt(8)
    v_rcp_f32 v30, v30
    v_mfma_f32_16x16x32_bf16 v[44:47], a[208:211], a[44:47], v[44:47]
    s_waitcnt lgkmcnt(4)
    v_rcp_f32 v31, v31
    v_mfma_f32_16x16x32_bf16 v[44:47], a[192:195], a[60:63], v[44:47]
    ds_read_b64_tr_b16 a[208:209], v18 offset:14336
    v_mul_f32 v26, v26, v30
    v_mfma_f32_16x16x32_bf16 v[60:63], a[196:199], a[60:63], v[60:63]
    ds_read_b64_tr_b16 a[210:211], v18 offset:15360
    v_mul_f32 v27, v27, v31
    v_mfma_f32_16x16x32_bf16 v[56:59], a[196:199], a[56:59], v[56:59]
    buffer_atomic_or v129, v3, s[24:27], 0 offen offset:256
    v_mfma_f32_16x16x32_bf16 v[40:43], a[192:195], a[56:59], v[40:43]
    buffer_store_dwordx4 v[220:223], v7, s[24:27], s55 offen sc1
    v_mfma_f32_16x16x32_bf16 v[36:39], a[192:195], a[52:55], v[36:39]
    s_xor_b32 s55, s55, 3072
    ds_read_b64_tr_b16 a[212:213], v19 offset:14336
    v_cvt_pk_bf16_f32 v186, v26, v27
    v_mfma_f32_16x16x32_bf16 v[52:55], a[196:199], a[52:55], v[52:55]
    s_add_u32 s55, s55, 16384
    ds_read_b64_tr_b16 a[214:215], v19 offset:15360
    v_lshlrev_b32 v26, 16, v163
    v_mfma_f32_16x16x32_bf16 v[48:51], a[196:199], a[48:51], v[48:51]
    v_and_b32 v27, 0xffff0000, v163
    v_fma_f32 v26, v26, v25, v24
    v_mfma_f32_16x16x32_bf16 v[32:35], a[192:195], a[48:51], v[32:35]
    s_waitcnt lgkmcnt(4)
    v_fma_f32 v27, v27, v25, v24
    v_mul_f32 v30, s92, v26
    v_mfma_f32_16x16x32_bf16 v[32:35], a[200:203], a[64:67], v[32:35]
    s_load_dword s67, s[86:87], s5 glc
    v_mul_f32 v31, s92, v27
    v_cndmask_b32 v216, 0, v225, s[10:11]
    v_mfma_f32_16x16x32_bf16 v[48:51], a[204:207], a[64:67], v[48:51]
    v_exp_f32 v30, v30
    v_mfma_f32_16x16x32_bf16 v[52:55], a[204:207], a[68:71], v[52:55]
    v_exp_f32 v31, v31
    v_mfma_f32_16x16x32_bf16 v[36:39], a[200:203], a[68:71], v[36:39]
    v_add_f32 v30, 1.0, v30
    v_add_f32 v31, 1.0, v31
    v_mfma_f32_16x16x32_bf16 v[40:43], a[200:203], a[72:75], v[40:43]
    v_rcp_f32 v30, v30
    v_mfma_f32_16x16x32_bf16 v[56:59], a[204:207], a[72:75], v[56:59]
    v_rcp_f32 v31, v31
    v_mfma_f32_16x16x32_bf16 v[60:63], a[204:207], a[76:79], v[60:63]
    v_mul_f32 v26, v26, v30
    v_mul_f32 v27, v27, v31
    v_mfma_f32_16x16x32_bf16 v[44:47], a[200:203], a[76:79], v[44:47]
    s_waitcnt lgkmcnt(0)
    v_cvt_pk_bf16_f32 v187, v26, v27
    v_cmp_eq_u32 s[10:11], 5, v226
    v_mfma_f32_16x16x32_bf16 v[44:47], a[208:211], a[92:95], v[44:47]
    v_mfma_f32_16x16x32_bf16 v[60:63], a[212:215], a[92:95], v[60:63]
    v_cndmask_b32 v217, 0, v225, s[10:11]
    v_cmp_eq_u32 s[10:11], 6, v226
    v_mfma_f32_16x16x32_bf16 v[56:59], a[212:215], a[88:91], v[56:59]
    v_mfma_f32_16x16x32_bf16 v[40:43], a[208:211], a[88:91], v[40:43]
    v_cndmask_b32 v218, 0, v225, s[10:11]
    v_cmp_eq_u32 s[10:11], 7, v226
    v_mfma_f32_16x16x32_bf16 v[36:39], a[208:211], a[84:87], v[36:39]
    v_mfma_f32_16x16x32_bf16 v[52:55], a[212:215], a[84:87], v[52:55]
    v_cndmask_b32 v219, 0, v225, s[10:11]
    s_mov_b32 s32, s84
    v_mfma_f32_16x16x32_bf16 v[48:51], a[212:215], a[80:83], v[48:51]
    s_and_b32 s33, s85, 0xffff
    s_mov_b32 s34, 2621440
    s_mov_b32 s35, 0x00020000
    v_mfma_f32_16x16x32_bf16 v[32:35], a[208:211], a[80:83], v[32:35]
    s_nop 7
    v_cvt_pk_bf16_f32 v32, v32, v33
    v_cvt_pk_bf16_f32 v33, v34, v35
    v_cvt_pk_bf16_f32 v34, v48, v49
    v_cvt_pk_bf16_f32 v35, v50, v51
    buffer_store_dwordx4 v[32:35], v6, s[24:27], s55 offen sc1
    s_xor_b32 s55, s55, 1024
    v_cvt_pk_bf16_f32 v36, v36, v37
    v_cvt_pk_bf16_f32 v37, v38, v39
    v_cvt_pk_bf16_f32 v38, v52, v53
    v_cvt_pk_bf16_f32 v39, v54, v55
    buffer_store_dwordx4 v[36:39], v6, s[24:27], s55 offen sc1
    s_xor_b32 s55, s55, 3072
    v_cvt_pk_bf16_f32 v40, v40, v41
    v_cvt_pk_bf16_f32 v41, v42, v43
    v_cvt_pk_bf16_f32 v42, v56, v57
    v_cvt_pk_bf16_f32 v43, v58, v59
    buffer_store_dwordx4 v[40:43], v7, s[24:27], s55 offen sc1
    s_xor_b32 s55, s55, 1024
    v_cvt_pk_bf16_f32 v44, v44, v45
    v_cvt_pk_bf16_f32 v45, v46, v47
    v_cvt_pk_bf16_f32 v46, v60, v61
    v_cvt_pk_bf16_f32 v47, v62, v63
    buffer_store_dwordx4 v[44:47], v7, s[24:27], s55 offen sc1
    s_xor_b32 s55, s55, 3072
    s_add_u32 s55, s55, 16384
post_code:
    s_cmp_ge_u32 s3, 2
    s_cselect_b32 s60, 0, 0xff00
    s_mov_b32 s9, 1
    s_mov_b32 s55, s68
    s_waitcnt vmcnt(4) lgkmcnt(0)
    buffer_atomic_or v130, v3, s[24:27], 0 offen offset:256
    s_andn2_b32 s69, s67, s68
    s_load_dword s67, s[86:87], s5 glc
    s_or_b32 s68, s68, s69
    s_and_b32 s8, s69, 0xff00ff
    s_andn2_b32 s69, s69, s8
    s_cmp_lg_u32 s8, 0
    s_cbranch_scc0 e0_issued
e0_iss:
    s_ff1_i32_b32 s56, s8
    v_readlane_b32 s57, v23, s56
    s_lshl_b32 s39, s56, 10
    s_add_u32 m0, s37, s39
    s_bitset0_b32 s8, s56
    s_add_u32 s9, s9, 1
    s_cmp_lg_u32 s8, 0
    buffer_load_dwordx4 v28, s[24:27], s57 offen sc1 lds
    s_cbranch_scc1 e0_iss
e0_issued:
w4:
    s_getreg_b32 s56, hwreg(HW_REG_IB_STS)
    s_bfe_u32 s57, s56, 0x20016
    s_and_b32 s56, s56, 15
    s_lshl4_add_u32 s56, s57, s56
    s_cmp_gt_u32 s56, s9
    s_cbranch_scc1 w4
    buffer_atomic_or v130, v3, s[24:27], 0 offen offset:0
    s_lshr_b32 s56, s53, 1
    s_cmp_eq_u32 s56, s3
    s_cbranch_scc0 own_share_ret
    s_lshl_b32 s56, s53, 10
    v_add_u32 v8, s56, v28
    v_add_u32 v11, 57344, v8
    v_add_u32 v10, 32768, v8
    v_add_u32 v9, 8192, v8
    v_add_u32 v8, 0, v8
    s_bitcmp1_b32 s53, 0
    s_cbranch_scc1 own_odd
    ds_write_b128 v8, v[32:35] offset:16384
    ds_write_b128 v9, v[36:39] offset:16384
    ds_write_b128 v10, v[196:199] offset:16384
    ds_write_b128 v11, v[204:207] offset:16384
    ds_write_b128 v10, v[132:135] offset:8192
    ds_write_b128 v11, v[140:143] offset:8192
    ds_write_b128 v10, v[68:71] offset:0
    ds_write_b128 v11, v[76:79] offset:0
    ds_write_b128 v8, v[64:67] offset:0
    ds_write_b128 v9, v[80:83] offset:0
    s_branch own_share_ret
own_odd:
    ds_write_b128 v8, v[40:43] offset:16384
    ds_write_b128 v9, v[44:47] offset:16384
    ds_write_b128 v10, v[212:215] offset:16384
    ds_write_b128 v11, v[220:223] offset:16384
    ds_write_b128 v10, v[148:151] offset:8192
    ds_write_b128 v11, v[156:159] offset:8192
    ds_write_b128 v10, v[84:87] offset:0
    ds_write_b128 v11, v[92:95] offset:0
    ds_write_b128 v8, v[96:99] offset:0
    ds_write_b128 v9, v[112:115] offset:0
own_share_ret:
    s_cmp_lg_u32 s69, 0
    s_cbranch_scc0 e1_issued
e1_iss:
    s_ff1_i32_b32 s56, s69
    v_readlane_b32 s57, v23, s56
    s_lshl_b32 s39, s56, 10
    s_add_u32 m0, s37, s39
    s_bitset0_b32 s69, s56
    s_add_u32 s9, s9, 1
    s_cmp_lg_u32 s69, 0
    buffer_load_dwordx4 v28, s[24:27], s57 offen sc1 lds
    s_cbranch_scc1 e1_iss
e1_issued:
    s_waitcnt lgkmcnt(0)
    s_barrier
    s_cmp_lg_u64 s[88:89], 0
    s_cbranch_scc1 routed
routed_ret:
ev_loop:
    s_waitcnt lgkmcnt(0)
    s_getreg_b32 s56, hwreg(HW_REG_IB_STS)
    s_and_b32 s56, s56, 0xc0000f
    s_cselect_b32 s55, s55, s68
    s_andn2_b32 s69, s67, s68
    s_or_b32 s68, s68, s69
    s_cmp_eq_u32 s68, 0xffffff
    s_cbranch_scc1 ev_nopoll
    s_load_dword s67, s[86:87], s5 glc
ev_nopoll:
    s_cmp_lg_u32 s69, 0
    s_cbranch_scc0 ev_issued
ev_iss:
    s_ff1_i32_b32 s56, s69
    v_readlane_b32 s57, v23, s56
    s_lshl_b32 s39, s56, 10
    s_add_u32 m0, s37, s39
    s_bitset0_b32 s69, s56
    s_add_u32 s9, s9, 1
    s_cmp_lg_u32 s69, 0
    buffer_load_dwordx4 v28, s[24:27], s57 offen sc1 lds
    s_cbranch_scc1 ev_iss
ev_issued:
ev_sel:
    s_andn2_b32 s8, s55, s60
    s_bfe_u32 s56, s8, 524288
    s_cmp_eq_u32 s56, 0xff
    s_cbranch_scc0 ev_r0
    s_or_b32 s60, s60, 255
    s_mov_b32 s38, s41
    ds_read_b128 v[132:135], v4 offset:0
    ds_read_b128 v[140:143], v4 offset:1024
    ds_read_b128 v[148:151], v4 offset:2048
    ds_read_b128 v[156:159], v4 offset:3072
    ds_read_b128 v[164:167], v4 offset:4096
    ds_read_b128 v[172:175], v4 offset:5120
    ds_read_b128 v[180:183], v4 offset:6144
    ds_read_b128 v[188:191], v4 offset:7168
    v_lshlrev_b32 v84, 16, v168
    v_and_b32 v85, 0xffff0000, v168
    v_lshlrev_b32 v100, 16, v144
    v_and_b32 v101, 0xffff0000, v144
    v_lshlrev_b32 v86, 16, v169
    v_and_b32 v87, 0xffff0000, v169
    v_lshlrev_b32 v102, 16, v145
    v_and_b32 v103, 0xffff0000, v145
    v_lshlrev_b32 v92, 16, v170
    v_and_b32 v93, 0xffff0000, v170
    v_lshlrev_b32 v108, 16, v146
    v_and_b32 v109, 0xffff0000, v146
    v_lshlrev_b32 v94, 16, v171
    v_and_b32 v95, 0xffff0000, v171
    v_lshlrev_b32 v110, 16, v147
    v_and_b32 v111, 0xffff0000, v147
    s_branch ev_go
ev_r0:
    s_bfe_u32 s56, s8, 524296
    s_cmp_eq_u32 s56, 0xff
    s_cbranch_scc0 ev_r1
    s_or_b32 s60, s60, 65280
    s_mov_b32 s38, s42
    ds_read_b128 v[132:135], v4 offset:8192
    ds_read_b128 v[140:143], v4 offset:9216
    ds_read_b128 v[148:151], v4 offset:10240
    ds_read_b128 v[156:159], v4 offset:11264
    ds_read_b128 v[164:167], v4 offset:12288
    ds_read_b128 v[172:175], v4 offset:13312
    ds_read_b128 v[180:183], v4 offset:14336
    ds_read_b128 v[188:191], v4 offset:15360
    v_lshlrev_b32 v84, 16, v176
    v_and_b32 v85, 0xffff0000, v176
    v_lshlrev_b32 v100, 16, v152
    v_and_b32 v101, 0xffff0000, v152
    v_lshlrev_b32 v86, 16, v177
    v_and_b32 v87, 0xffff0000, v177
    v_lshlrev_b32 v102, 16, v153
    v_and_b32 v103, 0xffff0000, v153
    v_lshlrev_b32 v92, 16, v178
    v_and_b32 v93, 0xffff0000, v178
    v_lshlrev_b32 v108, 16, v154
    v_and_b32 v109, 0xffff0000, v154
    v_lshlrev_b32 v94, 16, v179
    v_and_b32 v95, 0xffff0000, v179
    v_lshlrev_b32 v110, 16, v155
    v_and_b32 v111, 0xffff0000, v155
    s_branch ev_go
ev_r1:
    s_bfe_u32 s56, s8, 524304
    s_cmp_eq_u32 s56, 0xff
    s_cbranch_scc0 ev_r2
    s_or_b32 s60, s60, 16711680
    s_mov_b32 s38, s43
    ds_read_b128 v[132:135], v4 offset:16384
    ds_read_b128 v[140:143], v4 offset:17408
    ds_read_b128 v[148:151], v4 offset:18432
    ds_read_b128 v[156:159], v4 offset:19456
    ds_read_b128 v[164:167], v4 offset:20480
    ds_read_b128 v[172:175], v4 offset:21504
    ds_read_b128 v[180:183], v4 offset:22528
    ds_read_b128 v[188:191], v4 offset:23552
    v_lshlrev_b32 v84, 16, v184
    v_and_b32 v85, 0xffff0000, v184
    v_lshlrev_b32 v100, 16, v160
    v_and_b32 v101, 0xffff0000, v160
    v_lshlrev_b32 v86, 16, v185
    v_and_b32 v87, 0xffff0000, v185
    v_lshlrev_b32 v102, 16, v161
    v_and_b32 v103, 0xffff0000, v161
    v_lshlrev_b32 v92, 16, v186
    v_and_b32 v93, 0xffff0000, v186
    v_lshlrev_b32 v108, 16, v162
    v_and_b32 v109, 0xffff0000, v162
    v_lshlrev_b32 v94, 16, v187
    v_and_b32 v95, 0xffff0000, v187
    v_lshlrev_b32 v110, 16, v163
    v_and_b32 v111, 0xffff0000, v163
    s_branch ev_go
ev_r2:
    s_cmp_eq_u32 s68, 0xffffff
    s_cbranch_scc0 ev_more
    s_waitcnt vmcnt(0)
    s_mov_b32 s55, s68
    s_branch ev_sel
ev_more:
    s_add_u32 s101, s101, 1
    s_cmp_gt_u32 s101, 0x2000000
    s_cbranch_scc0 ev_loop
    s_branch ev_done
ev_go:
    s_waitcnt lgkmcnt(7)
    v_mfma_f32_16x16x32_bf16 v[68:71], v[208:211], v[132:135], 0
    v_mfma_f32_16x16x32_bf16 v[76:79], v[216:219], v[132:135], 0
    s_waitcnt lgkmcnt(6)
    v_mfma_f32_16x16x32_bf16 v[68:71], v[208:211], v[140:143], v[68:71]
    v_mfma_f32_16x16x32_bf16 v[76:79], v[216:219], v[140:143], v[76:79]
    s_waitcnt lgkmcnt(5)
    v_mfma_f32_16x16x32_bf16 v[68:71], v[208:211], v[148:151], v[68:71]
    v_mfma_f32_16x16x32_bf16 v[76:79], v[216:219], v[148:151], v[76:79]
    s_waitcnt lgkmcnt(4)
    v_mfma_f32_16x16x32_bf16 v[68:71], v[208:211], v[156:159], v[68:71]
pg_13:
    s_cbranch_execz pg_ret2
    v_mfma_f32_16x16x32_bf16 v[76:79], v[216:219], v[156:159], v[76:79]
    s_waitcnt lgkmcnt(3)
    v_mfma_f32_16x16x32_bf16 v[68:71], v[208:211], v[164:167], v[68:71]
    v_mfma_f32_16x16x32_bf16 v[76:79], v[216:219], v[164:167], v[76:79]
    s_waitcnt lgkmcnt(2)
    v_mfma_f32_16x16x32_bf16 v[68:71], v[208:211], v[172:175], v[68:71]
    v_mfma_f32_16x16x32_bf16 v[76:79], v[216:219], v[172:175], v[76:79]
    s_waitcnt lgkmcnt(1)
    v_mfma_f32_16x16x32_bf16 v[68:71], v[208:211], v[180:183], v[68:71]
    v_mfma_f32_16x16x32_bf16 v[76:79], v[216:219], v[180:183], v[76:79]
    s_waitcnt lgkmcnt(0)
    v_mfma_f32_16x16x32_bf16 v[68:71], v[208:211], v[188:191], v[68:71]
    v_mfma_f32_16x16x32_bf16 v[76:79], v[216:219], v[188:191], v[76:79]
    s_nop 6
    v_pk_fma_f32 v[68:69], v[68:69], v[84:85], v[100:101]
    v_pk_fma_f32 v[70:71], v[70:71], v[86:87], v[102:103]
    v_pk_fma_f32 v[76:77], v[76:77], v[92:93], v[108:109]
    v_pk_fma_f32 v[78:79], v[78:79], v[94:95], v[110:111]
    v_cvt_pk_bf16_f32 v124, v68, v69
    v_cvt_pk_bf16_f32 v125, v70, v71
    v_cvt_pk_bf16_f32 v126, v76, v77
    v_cvt_pk_bf16_f32 v127, v78, v79
    buffer_store_dwordx4 v[124:127], v22, s[32:35], s38 offen sc1
    s_cmp_lg_u32 s60, 0xffffff
    s_cbranch_scc1 ev_sel
ev_done:
    s_or_b32 s56, s2, s3
    s_cbranch_scc1 main_fin
    v_mov_b32 v8, s7
    v_mov_b32 v9, 3203072
    s_mov_b64 exec, 1
    buffer_store_dword v8, v9, s[24:27], 0 offen
main_fin:
main_end:
    s_endpgm
spin_o0:
    s_load_dword s72, s[86:87], s5 offset:4 glc
    s_add_u32 s101, s101, 1
    s_cmp_gt_u32 s101, 0x2000000
    s_waitcnt lgkmcnt(0)
    s_cbranch_scc1 spin_o0_ret
    s_bfe_u32 s88, s72, 262144
    s_cmp_lg_u32 s88, 15
    s_cbranch_scc1 spin_o0
    s_branch spin_o0_ret
spin_o1:
    s_load_dword s72, s[86:87], s5 offset:4 glc
    s_add_u32 s101, s101, 1
    s_cmp_gt_u32 s101, 0x2000000
    s_waitcnt lgkmcnt(0)
    s_cbranch_scc1 spin_o1_ret
    s_bfe_u32 s88, s72, 262148
    s_cmp_lg_u32 s88, 15
    s_cbranch_scc1 spin_o1
    s_branch spin_o1_ret
spin_o2:
    s_load_dword s72, s[86:87], s5 offset:4 glc
    s_add_u32 s101, s101, 1
    s_cmp_gt_u32 s101, 0x2000000
    s_waitcnt lgkmcnt(0)
    s_cbranch_scc1 spin_o2_ret
    s_bfe_u32 s88, s72, 262152
    s_cmp_lg_u32 s88, 15
    s_cbranch_scc1 spin_o2
    s_branch spin_o2_ret
spin_o3:
    s_load_dword s72, s[86:87], s5 offset:4 glc
    s_add_u32 s101, s101, 1
    s_cmp_gt_u32 s101, 0x2000000
    s_waitcnt lgkmcnt(0)
    s_cbranch_scc1 spin_o3_ret
    s_bfe_u32 s88, s72, 262156
    s_cmp_lg_u32 s88, 15
    s_cbranch_scc1 spin_o3
    s_branch spin_o3_ret
spin_o4:
    s_load_dword s72, s[86:87], s5 offset:4 glc
    s_add_u32 s101, s101, 1
    s_cmp_gt_u32 s101, 0x2000000
    s_waitcnt lgkmcnt(0)
    s_cbranch_scc1 spin_o4_ret
    s_bfe_u32 s88, s72, 262160
    s_cmp_lg_u32 s88, 15
    s_cbranch_scc1 spin_o4
    s_branch spin_o4_ret
spin_o5:
    s_load_dword s72, s[86:87], s5 offset:4 glc
    s_add_u32 s101, s101, 1
    s_cmp_gt_u32 s101, 0x2000000
    s_waitcnt lgkmcnt(0)
    s_cbranch_scc1 spin_o5_ret
    s_bfe_u32 s88, s72, 262164
    s_cmp_lg_u32 s88, 15
    s_cbranch_scc1 spin_o5
    s_branch spin_o5_ret
routed:
    s_cmp_eq_u32 s44, s59
    s_cbranch_scc0 spin_y
spin_y_ret:
    v_cvt_pk_bf16_f32 v200, v240, v241
    v_cvt_pk_bf16_f32 v201, v242, v243
    v_lshlrev_b32 v240, 16, v200
    v_and_b32 v241, 0xffff0000, v200
    v_lshlrev_b32 v242, 16, v201
    v_and_b32 v243, 0xffff0000, v201
    v_mul_f32 v240, v240, v195
    v_mul_f32 v241, v241, v195
    v_mul_f32 v242, v242, v195
    v_mul_f32 v243, v243, v195
    v_cvt_pk_bf16_f32 v200, v240, v241
    v_cvt_pk_bf16_f32 v201, v242, v243
    v_lshlrev_b32 v240, 16, v200
    v_and_b32 v241, 0xffff0000, v200
    v_lshlrev_b32 v242, 16, v201
    v_and_b32 v243, 0xffff0000, v201
    v_add_f32 v240, v240, v248
    v_add_f32 v241, v241, v249
    v_add_f32 v242, v242, v250
    v_add_f32 v243, v243, v251
    v_cvt_pk_bf16_f32 v200, v240, v241
    v_cvt_pk_bf16_f32 v201, v242, v243
    v_lshlrev_b32 v240, 16, v200
    v_and_b32 v241, 0xffff0000, v200
    v_lshlrev_b32 v242, 16, v201
    v_and_b32 v243, 0xffff0000, v201
    v_mul_f32 v200, s92, v240
    v_mul_f32 v201, s92, v241
    v_mul_f32 v202, s92, v242
    v_mul_f32 v203, s92, v243
    v_exp_f32 v200, v200
    v_exp_f32 v201, v201
    v_exp_f32 v202, v202
    v_exp_f32 v203, v203
    v_add_f32 v200, 1.0, v200
    v_add_f32 v201, 1.0, v201
    v_add_f32 v202, 1.0, v202
    v_add_f32 v203, 1.0, v203
    v_rcp_f32 v200, v200
    v_rcp_f32 v201, v201
    v_rcp_f32 v202, v202
    v_rcp_f32 v203, v203
    v_mul_f32 v240, v240, v200
    v_mul_f32 v241, v241, v201
    v_mul_f32 v242, v242, v202
    v_mul_f32 v243, v243, v203
    v_cvt_pk_bf16_f32 v240, v240, v241
    v_cvt_pk_bf16_f32 v241, v242, v243
    ds_write_b64 v138, v[240:241]
    s_mov_b64 exec, s[88:89]
    ds_read_b128 v[168:171], v139 offset:0
    ds_read_b128 v[176:179], v139 offset:64
    ds_read_b128 v[184:187], v139 offset:128
    s_waitcnt lgkmcnt(0)
    s_mov_b64 exec, -1
    s_branch routed_ret
spin_y:
    s_add_u32 s101, s101, 1
    s_cmp_gt_u32 s101, 0x2000000
    s_cbranch_scc1 spin_y_x
    buffer_load_dword v137, v136, s[24:27], s59 offen offset:128 sc1
    s_waitcnt vmcnt(0)
    v_cmp_ne_u32 vcc, 24, v137
    s_cbranch_vccnz spin_y
spin_y_x:
    buffer_load_dwordx4 v[240:243], v192, s[24:27], s59 offen sc1
    s_waitcnt vmcnt(0)
    s_branch spin_y_ret
spin_rec:
    s_add_u32 s101, s101, 1
    s_cmp_gt_u32 s101, 0x2000000
    s_cbranch_scc1 spin_rec_x
    buffer_load_dwordx4 v[32:35], v17, s[24:27], s47 offen offset:0 sc1
    buffer_load_dwordx4 v[36:39], v17, s[24:27], s47 offen offset:1024 sc1
    buffer_load_dwordx4 v[40:43], v17, s[24:27], s47 offen offset:2048 sc1
    buffer_load_dwordx4 v[44:47], v17, s[24:27], s47 offen offset:3072 sc1
    s_waitcnt vmcnt(0)
    v_xor_b32 v34, s7, v34
    v_xor_b32 v38, s7, v38
    v_xor_b32 v42, s7, v42
    v_xor_b32 v46, s7, v46
    v_or3_b32 v34, v34, v38, v42
    v_or_b32 v34, v34, v46
    v_cmp_ne_u32 vcc, 0, v34
    s_cbranch_vccnz spin_rec
spin_rec_x:
    s_branch spin_rec_ret
spin_gu:
    s_add_u32 s101, s101, 1
    s_cmp_gt_u32 s101, 0x2000000
    s_cbranch_scc1 spin_gu_x
    buffer_load_dword v61, v60, s[24:27], s37 offen sc1
    s_waitcnt vmcnt(0)
    v_cmp_ne_u32 vcc, s7, v61
    s_cbranch_vccnz spin_gu
spin_gu_x:
    s_branch spin_gu_ret
rare_p:
    s_nop 7
    s_nop 7
    v_max3_f32 v56, v68, v69, v70
    v_max3_f32 v56, v56, v71, v100
    v_max3_f32 v56, v56, v101, v102
    v_max3_f32 v56, v56, v103, 0
    v_mov_b32 v58, v56
    s_nop 1
    v_permlane16_swap_b32 v56, v58
    s_nop 1
    v_max_f32 v56, v56, v58
    v_mov_b32 v58, v56
    s_nop 1
    v_permlane32_swap_b32 v56, v58
    s_nop 1
    v_max_f32 v56, v56, v58
    v_exp_f32 v57, -v56
    v_sub_f32 v32, v32, v56
    v_sub_f32 v33, v33, v56
    v_sub_f32 v34, v34, v56
    v_sub_f32 v35, v35, v56
    v_mul_f32 v20, v20, v57
    v_sub_f32 v68, v68, v56
    v_sub_f32 v69, v69, v56
    v_sub_f32 v70, v70, v56
    v_sub_f32 v71, v71, v56
    v_sub_f32 v100, v100, v56
    v_sub_f32 v101, v101, v56
    v_sub_f32 v102, v102, v56
    v_sub_f32 v103, v103, v56
    v_sub_f32 v132, v132, v56
    v_sub_f32 v133, v133, v56
    v_sub_f32 v134, v134, v56
    v_sub_f32 v135, v135, v56
    v_sub_f32 v164, v164, v56
    v_sub_f32 v165, v165, v56
    v_sub_f32 v166, v166, v56
    v_sub_f32 v167, v167, v56
    v_accvgpr_read_b32 v48, a0
    v_accvgpr_read_b32 v49, a1
    v_accvgpr_read_b32 v50, a2
    v_accvgpr_read_b32 v51, a3
    v_mul_f32 v48, v48, v57
    v_mul_f32 v49, v49, v57
    v_mul_f32 v50, v50, v57
    v_mul_f32 v51, v51, v57
    v_accvgpr_write_b32 a0, v48
    v_accvgpr_write_b32 a1, v49
    v_accvgpr_write_b32 a2, v50
    v_accvgpr_write_b32 a3, v51
    v_accvgpr_read_b32 v48, a16
    v_accvgpr_read_b32 v49, a17
    v_accvgpr_read_b32 v50, a18
    v_accvgpr_read_b32 v51, a19
    v_mul_f32 v48, v48, v57
    v_mul_f32 v49, v49, v57
    v_mul_f32 v50, v50, v57
    v_mul_f32 v51, v51, v57
    v_accvgpr_write_b32 a16, v48
    v_accvgpr_write_b32 a17, v49
    v_accvgpr_write_b32 a18, v50
    v_accvgpr_write_b32 a19, v51
    v_accvgpr_read_b32 v48, a32
    v_accvgpr_read_b32 v49, a33
    v_accvgpr_read_b32 v50, a34
    v_accvgpr_read_b32 v51, a35
    v_mul_f32 v48, v48, v57
    v_mul_f32 v49, v49, v57
    v_mul_f32 v50, v50, v57
    v_mul_f32 v51, v51, v57
    v_accvgpr_write_b32 a32, v48
    v_accvgpr_write_b32 a33, v49
    v_accvgpr_write_b32 a34, v50
    v_accvgpr_write_b32 a35, v51
    v_accvgpr_read_b32 v48, a48
    v_accvgpr_read_b32 v49, a49
    v_accvgpr_read_b32 v50, a50
    v_accvgpr_read_b32 v51, a51
    v_mul_f32 v48, v48, v57
    v_mul_f32 v49, v49, v57
    v_mul_f32 v50, v50, v57
    v_mul_f32 v51, v51, v57
    v_accvgpr_write_b32 a48, v48
    v_accvgpr_write_b32 a49, v49
    v_accvgpr_write_b32 a50, v50
    v_accvgpr_write_b32 a51, v51
    v_accvgpr_read_b32 v48, a64
    v_accvgpr_read_b32 v49, a65
    v_accvgpr_read_b32 v50, a66
    v_accvgpr_read_b32 v51, a67
    v_mul_f32 v48, v48, v57
    v_mul_f32 v49, v49, v57
    v_mul_f32 v50, v50, v57
    v_mul_f32 v51, v51, v57
    v_accvgpr_write_b32 a64, v48
    v_accvgpr_write_b32 a65, v49
    v_accvgpr_write_b32 a66, v50
    v_accvgpr_write_b32 a67, v51
    v_accvgpr_read_b32 v48, a80
    v_accvgpr_read_b32 v49, a81
    v_accvgpr_read_b32 v50, a82
    v_accvgpr_read_b32 v51, a83
    v_mul_f32 v48, v48, v57
    v_mul_f32 v49, v49, v57
    v_mul_f32 v50, v50, v57
    v_mul_f32 v51, v51, v57
    v_accvgpr_write_b32 a80, v48
    v_accvgpr_write_b32 a81, v49
    v_accvgpr_write_b32 a82, v50
    v_accvgpr_write_b32 a83, v51
    v_accvgpr_read_b32 v48, a96
    v_accvgpr_read_b32 v49, a97
    v_accvgpr_read_b32 v50, a98
    v_accvgpr_read_b32 v51, a99
    v_mul_f32 v48, v48, v57
    v_mul_f32 v49, v49, v57
    v_mul_f32 v50, v50, v57
    v_mul_f32 v51, v51, v57
    v_accvgpr_write_b32 a96, v48
    v_accvgpr_write_b32 a97, v49
    v_accvgpr_write_b32 a98, v50
    v_accvgpr_write_b32 a99, v51
    v_accvgpr_read_b32 v48, a112
    v_accvgpr_read_b32 v49, a113
    v_accvgpr_read_b32 v50, a114
    v_accvgpr_read_b32 v51, a115
    v_mul_f32 v48, v48, v57
    v_mul_f32 v49, v49, v57
    v_mul_f32 v50, v50, v57
    v_mul_f32 v51, v51, v57
    v_accvgpr_write_b32 a112, v48
    v_accvgpr_write_b32 a113, v49
    v_accvgpr_write_b32 a114, v50
    v_accvgpr_write_b32 a115, v51
    v_accvgpr_read_b32 v48, a128
    v_accvgpr_read_b32 v49, a129
    v_accvgpr_read_b32 v50, a130
    v_accvgpr_read_b32 v51, a131
    v_mul_f32 v48, v48, v57
    v_mul_f32 v49, v49, v57
    v_mul_f32 v50, v50, v57
    v_mul_f32 v51, v51, v57
    v_accvgpr_write_b32 a128, v48
    v_accvgpr_write_b32 a129, v49
    v_accvgpr_write_b32 a130, v50
    v_accvgpr_write_b32 a131, v51
    v_accvgpr_read_b32 v48, a144
    v_accvgpr_read_b32 v49, a145
    v_accvgpr_read_b32 v50, a146
    v_accvgpr_read_b32 v51, a147
    v_mul_f32 v48, v48, v57
    v_mul_f32 v49, v49, v57
    v_mul_f32 v50, v50, v57
    v_mul_f32 v51, v51, v57
    v_accvgpr_write_b32 a144, v48
    v_accvgpr_write_b32 a145, v49
    v_accvgpr_write_b32 a146, v50
    v_accvgpr_write_b32 a147, v51
    v_accvgpr_read_b32 v48, a160
    v_accvgpr_read_b32 v49, a161
    v_accvgpr_read_b32 v50, a162
    v_accvgpr_read_b32 v51, a163
    v_mul_f32 v48, v48, v57
    v_mul_f32 v49, v49, v57
    v_mul_f32 v50, v50, v57
    v_mul_f32 v51, v51, v57
    v_accvgpr_write_b32 a160, v48
    v_accvgpr_write_b32 a161, v49
    v_accvgpr_write_b32 a162, v50
    v_accvgpr_write_b32 a163, v51
    v_accvgpr_read_b32 v48, a176
    v_accvgpr_read_b32 v49, a177
    v_accvgpr_read_b32 v50, a178
    v_accvgpr_read_b32 v51, a179
    v_mul_f32 v48, v48, v57
    v_mul_f32 v49, v49, v57
    v_mul_f32 v50, v50, v57
    v_mul_f32 v51, v51, v57
    v_accvgpr_write_b32 a176, v48
    v_accvgpr_write_b32 a177, v49
    v_accvgpr_write_b32 a178, v50
    v_accvgpr_write_b32 a179, v51
    v_exp_f32 v48, v68
    v_exp_f32 v49, v69
    v_exp_f32 v50, v70
    v_exp_f32 v51, v71
    v_exp_f32 v52, v100
    v_exp_f32 v53, v101
    v_exp_f32 v54, v102
    v_exp_f32 v55, v103
    s_nop 0
    v_cvt_pk_bf16_f32 v196, v48, v49
    v_cvt_pk_bf16_f32 v197, v50, v51
    v_cvt_pk_bf16_f32 v198, v52, v53
    v_cvt_pk_bf16_f32 v199, v54, v55
    v_add_f32 v24, v48, v49
    v_add_f32 v24, v24, v50
    v_add_f32 v24, v24, v51
    v_add_f32 v24, v24, v52
    v_add_f32 v24, v24, v53
    v_add_f32 v24, v24, v54
    v_add_f32 v24, v24, v55
    v_max3_f32 v56, v76, v77, v78
    v_max3_f32 v56, v56, v79, v108
    v_max3_f32 v56, v56, v109, v110
    v_max3_f32 v56, v56, v111, 0
    v_mov_b32 v58, v56
    s_nop 1
    v_permlane16_swap_b32 v56, v58
    s_nop 1
    v_max_f32 v56, v56, v58
    v_mov_b32 v58, v56
    s_nop 1
    v_permlane32_swap_b32 v56, v58
    s_nop 1
    v_max_f32 v56, v56, v58
    v_exp_f32 v57, -v56
    v_sub_f32 v36, v36, v56
    v_sub_f32 v37, v37, v56
    v_sub_f32 v38, v38, v56
    v_sub_f32 v39, v39, v56
    v_mul_f32 v21, v21, v57
    v_sub_f32 v76, v76, v56
    v_sub_f32 v77, v77, v56
    v_sub_f32 v78, v78, v56
    v_sub_f32 v79, v79, v56
    v_sub_f32 v108, v108, v56
    v_sub_f32 v109, v109, v56
    v_sub_f32 v110, v110, v56
    v_sub_f32 v111, v111, v56
    v_sub_f32 v140, v140, v56
    v_sub_f32 v141, v141, v56
    v_sub_f32 v142, v142, v56
    v_sub_f32 v143, v143, v56
    v_sub_f32 v172, v172, v56
    v_sub_f32 v173, v173, v56
    v_sub_f32 v174, v174, v56
    v_sub_f32 v175, v175, v56
    v_accvgpr_read_b32 v48, a4
    v_accvgpr_read_b32 v49, a5
    v_accvgpr_read_b32 v50, a6
    v_accvgpr_read_b32 v51, a7
    v_mul_f32 v48, v48, v57
    v_mul_f32 v49, v49, v57
    v_mul_f32 v50, v50, v57
    v_mul_f32 v51, v51, v57
    v_accvgpr_write_b32 a4, v48
    v_accvgpr_write_b32 a5, v49
    v_accvgpr_write_b32 a6, v50
    v_accvgpr_write_b32 a7, v51
    v_accvgpr_read_b32 v48, a20
    v_accvgpr_read_b32 v49, a21
    v_accvgpr_read_b32 v50, a22
    v_accvgpr_read_b32 v51, a23
    v_mul_f32 v48, v48, v57
    v_mul_f32 v49, v49, v57
    v_mul_f32 v50, v50, v57
    v_mul_f32 v51, v51, v57
    v_accvgpr_write_b32 a20, v48
    v_accvgpr_write_b32 a21, v49
    v_accvgpr_write_b32 a22, v50
    v_accvgpr_write_b32 a23, v51
    v_accvgpr_read_b32 v48, a36
    v_accvgpr_read_b32 v49, a37
    v_accvgpr_read_b32 v50, a38
    v_accvgpr_read_b32 v51, a39
    v_mul_f32 v48, v48, v57
    v_mul_f32 v49, v49, v57
    v_mul_f32 v50, v50, v57
    v_mul_f32 v51, v51, v57
    v_accvgpr_write_b32 a36, v48
    v_accvgpr_write_b32 a37, v49
    v_accvgpr_write_b32 a38, v50
    v_accvgpr_write_b32 a39, v51
    v_accvgpr_read_b32 v48, a52
    v_accvgpr_read_b32 v49, a53
    v_accvgpr_read_b32 v50, a54
    v_accvgpr_read_b32 v51, a55
    v_mul_f32 v48, v48, v57
    v_mul_f32 v49, v49, v57
    v_mul_f32 v50, v50, v57
    v_mul_f32 v51, v51, v57
    v_accvgpr_write_b32 a52, v48
    v_accvgpr_write_b32 a53, v49
    v_accvgpr_write_b32 a54, v50
    v_accvgpr_write_b32 a55, v51
    v_accvgpr_read_b32 v48, a68
    v_accvgpr_read_b32 v49, a69
    v_accvgpr_read_b32 v50, a70
    v_accvgpr_read_b32 v51, a71
    v_mul_f32 v48, v48, v57
    v_mul_f32 v49, v49, v57
    v_mul_f32 v50, v50, v57
    v_mul_f32 v51, v51, v57
    v_accvgpr_write_b32 a68, v48
    v_accvgpr_write_b32 a69, v49
    v_accvgpr_write_b32 a70, v50
    v_accvgpr_write_b32 a71, v51
    v_accvgpr_read_b32 v48, a84
    v_accvgpr_read_b32 v49, a85
    v_accvgpr_read_b32 v50, a86
    v_accvgpr_read_b32 v51, a87
    v_mul_f32 v48, v48, v57
    v_mul_f32 v49, v49, v57
    v_mul_f32 v50, v50, v57
    v_mul_f32 v51, v51, v57
    v_accvgpr_write_b32 a84, v48
    v_accvgpr_write_b32 a85, v49
    v_accvgpr_write_b32 a86, v50
    v_accvgpr_write_b32 a87, v51
    v_accvgpr_read_b32 v48, a100
    v_accvgpr_read_b32 v49, a101
    v_accvgpr_read_b32 v50, a102
    v_accvgpr_read_b32 v51, a103
    v_mul_f32 v48, v48, v57
    v_mul_f32 v49, v49, v57
    v_mul_f32 v50, v50, v57
    v_mul_f32 v51, v51, v57
    v_accvgpr_write_b32 a100, v48
    v_accvgpr_write_b32 a101, v49
    v_accvgpr_write_b32 a102, v50
    v_accvgpr_write_b32 a103, v51
    v_accvgpr_read_b32 v48, a116
    v_accvgpr_read_b32 v49, a117
    v_accvgpr_read_b32 v50, a118
    v_accvgpr_read_b32 v51, a119
    v_mul_f32 v48, v48, v57
    v_mul_f32 v49, v49, v57
    v_mul_f32 v50, v50, v57
    v_mul_f32 v51, v51, v57
    v_accvgpr_write_b32 a116, v48
    v_accvgpr_write_b32 a117, v49
    v_accvgpr_write_b32 a118, v50
    v_accvgpr_write_b32 a119, v51
    v_accvgpr_read_b32 v48, a132
    v_accvgpr_read_b32 v49, a133
    v_accvgpr_read_b32 v50, a134
    v_accvgpr_read_b32 v51, a135
    v_mul_f32 v48, v48, v57
    v_mul_f32 v49, v49, v57
    v_mul_f32 v50, v50, v57
    v_mul_f32 v51, v51, v57
    v_accvgpr_write_b32 a132, v48
    v_accvgpr_write_b32 a133, v49
    v_accvgpr_write_b32 a134, v50
    v_accvgpr_write_b32 a135, v51
    v_accvgpr_read_b32 v48, a148
    v_accvgpr_read_b32 v49, a149
    v_accvgpr_read_b32 v50, a150
    v_accvgpr_read_b32 v51, a151
    v_mul_f32 v48, v48, v57
    v_mul_f32 v49, v49, v57
    v_mul_f32 v50, v50, v57
    v_mul_f32 v51, v51, v57
    v_accvgpr_write_b32 a148, v48
    v_accvgpr_write_b32 a149, v49
    v_accvgpr_write_b32 a150, v50
    v_accvgpr_write_b32 a151, v51
    v_accvgpr_read_b32 v48, a164
    v_accvgpr_read_b32 v49, a165
    v_accvgpr_read_b32 v50, a166
    v_accvgpr_read_b32 v51, a167
    v_mul_f32 v48, v48, v57
    v_mul_f32 v49, v49, v57
    v_mul_f32 v50, v50, v57
    v_mul_f32 v51, v51, v57
    v_accvgpr_write_b32 a164, v48
    v_accvgpr_write_b32 a165, v49
    v_accvgpr_write_b32 a166, v50
    v_accvgpr_write_b32 a167, v51
    v_accvgpr_read_b32 v48, a180
    v_accvgpr_read_b32 v49, a181
    v_accvgpr_read_b32 v50, a182
    v_accvgpr_read_b32 v51, a183
    v_mul_f32 v48, v48, v57
    v_mul_f32 v49, v49, v57
    v_mul_f32 v50, v50, v57
    v_mul_f32 v51, v51, v57
    v_accvgpr_write_b32 a180, v48
    v_accvgpr_write_b32 a181, v49
    v_accvgpr_write_b32 a182, v50
    v_accvgpr_write_b32 a183, v51
    v_exp_f32 v48, v76
    v_exp_f32 v49, v77
    v_exp_f32 v50, v78
    v_exp_f32 v51, v79
    v_exp_f32 v52, v108
    v_exp_f32 v53, v109
    v_exp_f32 v54, v110
    v_exp_f32 v55, v111
    s_nop 0
    v_cvt_pk_bf16_f32 v204, v48, v49
    v_cvt_pk_bf16_f32 v205, v50, v51
    v_cvt_pk_bf16_f32 v206, v52, v53
    v_cvt_pk_bf16_f32 v207, v54, v55
    v_add_f32 v25, v48, v49
    v_add_f32 v25, v25, v50
    v_add_f32 v25, v25, v51
    v_add_f32 v25, v25, v52
    v_add_f32 v25, v25, v53
    v_add_f32 v25, v25, v54
    v_add_f32 v25, v25, v55
    v_max3_f32 v56, v84, v85, v86
    v_max3_f32 v56, v56, v87, v116
    v_max3_f32 v56, v56, v117, v118
    v_max3_f32 v56, v56, v119, 0
    v_mov_b32 v58, v56
    s_nop 1
    v_permlane16_swap_b32 v56, v58
    s_nop 1
    v_max_f32 v56, v56, v58
    v_mov_b32 v58, v56
    s_nop 1
    v_permlane32_swap_b32 v56, v58
    s_nop 1
    v_max_f32 v56, v56, v58
    v_exp_f32 v57, -v56
    v_sub_f32 v40, v40, v56
    v_sub_f32 v41, v41, v56
    v_sub_f32 v42, v42, v56
    v_sub_f32 v43, v43, v56
    v_mul_f32 v22, v22, v57
    v_sub_f32 v84, v84, v56
    v_sub_f32 v85, v85, v56
    v_sub_f32 v86, v86, v56
    v_sub_f32 v87, v87, v56
    v_sub_f32 v116, v116, v56
    v_sub_f32 v117, v117, v56
    v_sub_f32 v118, v118, v56
    v_sub_f32 v119, v119, v56
    v_sub_f32 v148, v148, v56
    v_sub_f32 v149, v149, v56
    v_sub_f32 v150, v150, v56
    v_sub_f32 v151, v151, v56
    v_sub_f32 v180, v180, v56
    v_sub_f32 v181, v181, v56
    v_sub_f32 v182, v182, v56
    v_sub_f32 v183, v183, v56
    v_accvgpr_read_b32 v48, a8
    v_accvgpr_read_b32 v49, a9
    v_accvgpr_read_b32 v50, a10
    v_accvgpr_read_b32 v51, a11
    v_mul_f32 v48, v48, v57
    v_mul_f32 v49, v49, v57
    v_mul_f32 v50, v50, v57
    v_mul_f32 v51, v51, v57
    v_accvgpr_write_b32 a8, v48
    v_accvgpr_write_b32 a9, v49
    v_accvgpr_write_b32 a10, v50
    v_accvgpr_write_b32 a11, v51
    v_accvgpr_read_b32 v48, a24
    v_accvgpr_read_b32 v49, a25
    v_accvgpr_read_b32 v50, a26
    v_accvgpr_read_b32 v51, a27
    v_mul_f32 v48, v48, v57
    v_mul_f32 v49, v49, v57
    v_mul_f32 v50, v50, v57
    v_mul_f32 v51, v51, v57
    v_accvgpr_write_b32 a24, v48
    v_accvgpr_write_b32 a25, v49
    v_accvgpr_write_b32 a26, v50
    v_accvgpr_write_b32 a27, v51
    v_accvgpr_read_b32 v48, a40
    v_accvgpr_read_b32 v49, a41
    v_accvgpr_read_b32 v50, a42
    v_accvgpr_read_b32 v51, a43
    v_mul_f32 v48, v48, v57
    v_mul_f32 v49, v49, v57
    v_mul_f32 v50, v50, v57
    v_mul_f32 v51, v51, v57
    v_accvgpr_write_b32 a40, v48
    v_accvgpr_write_b32 a41, v49
    v_accvgpr_write_b32 a42, v50
    v_accvgpr_write_b32 a43, v51
    v_accvgpr_read_b32 v48, a56
    v_accvgpr_read_b32 v49, a57
    v_accvgpr_read_b32 v50, a58
    v_accvgpr_read_b32 v51, a59
    v_mul_f32 v48, v48, v57
    v_mul_f32 v49, v49, v57
    v_mul_f32 v50, v50, v57
    v_mul_f32 v51, v51, v57
    v_accvgpr_write_b32 a56, v48
    v_accvgpr_write_b32 a57, v49
    v_accvgpr_write_b32 a58, v50
    v_accvgpr_write_b32 a59, v51
    v_accvgpr_read_b32 v48, a72
    v_accvgpr_read_b32 v49, a73
    v_accvgpr_read_b32 v50, a74
    v_accvgpr_read_b32 v51, a75
    v_mul_f32 v48, v48, v57
    v_mul_f32 v49, v49, v57
    v_mul_f32 v50, v50, v57
    v_mul_f32 v51, v51, v57
    v_accvgpr_write_b32 a72, v48
    v_accvgpr_write_b32 a73, v49
    v_accvgpr_write_b32 a74, v50
    v_accvgpr_write_b32 a75, v51
    v_accvgpr_read_b32 v48, a88
    v_accvgpr_read_b32 v49, a89
    v_accvgpr_read_b32 v50, a90
    v_accvgpr_read_b32 v51, a91
    v_mul_f32 v48, v48, v57
    v_mul_f32 v49, v49, v57
    v_mul_f32 v50, v50, v57
    v_mul_f32 v51, v51, v57
    v_accvgpr_write_b32 a88, v48
    v_accvgpr_write_b32 a89, v49
    v_accvgpr_write_b32 a90, v50
    v_accvgpr_write_b32 a91, v51
    v_accvgpr_read_b32 v48, a104
    v_accvgpr_read_b32 v49, a105
    v_accvgpr_read_b32 v50, a106
    v_accvgpr_read_b32 v51, a107
    v_mul_f32 v48, v48, v57
    v_mul_f32 v49, v49, v57
    v_mul_f32 v50, v50, v57
    v_mul_f32 v51, v51, v57
    v_accvgpr_write_b32 a104, v48
    v_accvgpr_write_b32 a105, v49
    v_accvgpr_write_b32 a106, v50
    v_accvgpr_write_b32 a107, v51
    v_accvgpr_read_b32 v48, a120
    v_accvgpr_read_b32 v49, a121
    v_accvgpr_read_b32 v50, a122
    v_accvgpr_read_b32 v51, a123
    v_mul_f32 v48, v48, v57
    v_mul_f32 v49, v49, v57
    v_mul_f32 v50, v50, v57
    v_mul_f32 v51, v51, v57
    v_accvgpr_write_b32 a120, v48
    v_accvgpr_write_b32 a121, v49
    v_accvgpr_write_b32 a122, v50
    v_accvgpr_write_b32 a123, v51
    v_accvgpr_read_b32 v48, a136
    v_accvgpr_read_b32 v49, a137
    v_accvgpr_read_b32 v50, a138
    v_accvgpr_read_b32 v51, a139
    v_mul_f32 v48, v48, v57
    v_mul_f32 v49, v49, v57
    v_mul_f32 v50, v50, v57
    v_mul_f32 v51, v51, v57
    v_accvgpr_write_b32 a136, v48
    v_accvgpr_write_b32 a137, v49
    v_accvgpr_write_b32 a138, v50
    v_accvgpr_write_b32 a139, v51
    v_accvgpr_read_b32 v48, a152
    v_accvgpr_read_b32 v49, a153
    v_accvgpr_read_b32 v50, a154
    v_accvgpr_read_b32 v51, a155
    v_mul_f32 v48, v48, v57
    v_mul_f32 v49, v49, v57
    v_mul_f32 v50, v50, v57
    v_mul_f32 v51, v51, v57
    v_accvgpr_write_b32 a152, v48
    v_accvgpr_write_b32 a153, v49
    v_accvgpr_write_b32 a154, v50
    v_accvgpr_write_b32 a155, v51
    v_accvgpr_read_b32 v48, a168
    v_accvgpr_read_b32 v49, a169
    v_accvgpr_read_b32 v50, a170
    v_accvgpr_read_b32 v51, a171
    v_mul_f32 v48, v48, v57
    v_mul_f32 v49, v49, v57
    v_mul_f32 v50, v50, v57
    v_mul_f32 v51, v51, v57
    v_accvgpr_write_b32 a168, v48
    v_accvgpr_write_b32 a169, v49
    v_accvgpr_write_b32 a170, v50
    v_accvgpr_write_b32 a171, v51
    v_accvgpr_read_b32 v48, a184
    v_accvgpr_read_b32 v49, a185
    v_accvgpr_read_b32 v50, a186
    v_accvgpr_read_b32 v51, a187
    v_mul_f32 v48, v48, v57
    v_mul_f32 v49, v49, v57
    v_mul_f32 v50, v50, v57
    v_mul_f32 v51, v51, v57
    v_accvgpr_write_b32 a184, v48
    v_accvgpr_write_b32 a185, v49
    v_accvgpr_write_b32 a186, v50
    v_accvgpr_write_b32 a187, v51
    v_exp_f32 v48, v84
    v_exp_f32 v49, v85
    v_exp_f32 v50, v86
    v_exp_f32 v51, v87
    v_exp_f32 v52, v116
    v_exp_f32 v53, v117
    v_exp_f32 v54, v118
    v_exp_f32 v55, v119
    s_nop 0
    v_cvt_pk_bf16_f32 v212, v48, v49
    v_cvt_pk_bf16_f32 v213, v50, v51
    v_cvt_pk_bf16_f32 v214, v52, v53
    v_cvt_pk_bf16_f32 v215, v54, v55
    v_add_f32 v26, v48, v49
    v_add_f32 v26, v26, v50
    v_add_f32 v26, v26, v51
    v_add_f32 v26, v26, v52
    v_add_f32 v26, v26, v53
    v_add_f32 v26, v26, v54
    v_add_f32 v26, v26, v55
    v_max3_f32 v56, v92, v93, v94
    v_max3_f32 v56, v56, v95, v124
    v_max3_f32 v56, v56, v125, v126
    v_max3_f32 v56, v56, v127, 0
    v_mov_b32 v58, v56
    s_nop 1
    v_permlane16_swap_b32 v56, v58
    s_nop 1
    v_max_f32 v56, v56, v58
    v_mov_b32 v58, v56
    s_nop 1
    v_permlane32_swap_b32 v56, v58
    s_nop 1
    v_max_f32 v56, v56, v58
    v_exp_f32 v57, -v56
    v_sub_f32 v44, v44, v56
    v_sub_f32 v45, v45, v56
    v_sub_f32 v46, v46, v56
    v_sub_f32 v47, v47, v56
    v_mul_f32 v23, v23, v57
    v_sub_f32 v92, v92, v56
    v_sub_f32 v93, v93, v56
    v_sub_f32 v94, v94, v56
    v_sub_f32 v95, v95, v56
    v_sub_f32 v124, v124, v56
    v_sub_f32 v125, v125, v56
    v_sub_f32 v126, v126, v56
    v_sub_f32 v127, v127, v56
    v_sub_f32 v156, v156, v56
    v_sub_f32 v157, v157, v56
    v_sub_f32 v158, v158, v56
    v_sub_f32 v159, v159, v56
    v_sub_f32 v188, v188, v56
    v_sub_f32 v189, v189, v56
    v_sub_f32 v190, v190, v56
    v_sub_f32 v191, v191, v56
    v_accvgpr_read_b32 v48, a12
    v_accvgpr_read_b32 v49, a13
    v_accvgpr_read_b32 v50, a14
    v_accvgpr_read_b32 v51, a15
    v_mul_f32 v48, v48, v57
    v_mul_f32 v49, v49, v57
    v_mul_f32 v50, v50, v57
    v_mul_f32 v51, v51, v57
    v_accvgpr_write_b32 a12, v48
    v_accvgpr_write_b32 a13, v49
    v_accvgpr_write_b32 a14, v50
    v_accvgpr_write_b32 a15, v51
    v_accvgpr_read_b32 v48, a28
    v_accvgpr_read_b32 v49, a29
    v_accvgpr_read_b32 v50, a30
    v_accvgpr_read_b32 v51, a31
    v_mul_f32 v48, v48, v57
    v_mul_f32 v49, v49, v57
    v_mul_f32 v50, v50, v57
    v_mul_f32 v51, v51, v57
    v_accvgpr_write_b32 a28, v48
    v_accvgpr_write_b32 a29, v49
    v_accvgpr_write_b32 a30, v50
    v_accvgpr_write_b32 a31, v51
    v_accvgpr_read_b32 v48, a44
    v_accvgpr_read_b32 v49, a45
    v_accvgpr_read_b32 v50, a46
    v_accvgpr_read_b32 v51, a47
    v_mul_f32 v48, v48, v57
    v_mul_f32 v49, v49, v57
    v_mul_f32 v50, v50, v57
    v_mul_f32 v51, v51, v57
    v_accvgpr_write_b32 a44, v48
    v_accvgpr_write_b32 a45, v49
    v_accvgpr_write_b32 a46, v50
    v_accvgpr_write_b32 a47, v51
    v_accvgpr_read_b32 v48, a60
    v_accvgpr_read_b32 v49, a61
    v_accvgpr_read_b32 v50, a62
    v_accvgpr_read_b32 v51, a63
    v_mul_f32 v48, v48, v57
    v_mul_f32 v49, v49, v57
    v_mul_f32 v50, v50, v57
    v_mul_f32 v51, v51, v57
    v_accvgpr_write_b32 a60, v48
    v_accvgpr_write_b32 a61, v49
    v_accvgpr_write_b32 a62, v50
    v_accvgpr_write_b32 a63, v51
    v_accvgpr_read_b32 v48, a76
    v_accvgpr_read_b32 v49, a77
    v_accvgpr_read_b32 v50, a78
    v_accvgpr_read_b32 v51, a79
    v_mul_f32 v48, v48, v57
    v_mul_f32 v49, v49, v57
    v_mul_f32 v50, v50, v57
    v_mul_f32 v51, v51, v57
    v_accvgpr_write_b32 a76, v48
    v_accvgpr_write_b32 a77, v49
    v_accvgpr_write_b32 a78, v50
    v_accvgpr_write_b32 a79, v51
    v_accvgpr_read_b32 v48, a92
    v_accvgpr_read_b32 v49, a93
    v_accvgpr_read_b32 v50, a94
    v_accvgpr_read_b32 v51, a95
    v_mul_f32 v48, v48, v57
    v_mul_f32 v49, v49, v57
    v_mul_f32 v50, v50, v57
    v_mul_f32 v51, v51, v57
    v_accvgpr_write_b32 a92, v48
    v_accvgpr_write_b32 a93, v49
    v_accvgpr_write_b32 a94, v50
    v_accvgpr_write_b32 a95, v51
    v_accvgpr_read_b32 v48, a108
    v_accvgpr_read_b32 v49, a109
    v_accvgpr_read_b32 v50, a110
    v_accvgpr_read_b32 v51, a111
    v_mul_f32 v48, v48, v57
    v_mul_f32 v49, v49, v57
    v_mul_f32 v50, v50, v57
    v_mul_f32 v51, v51, v57
    v_accvgpr_write_b32 a108, v48
    v_accvgpr_write_b32 a109, v49
    v_accvgpr_write_b32 a110, v50
    v_accvgpr_write_b32 a111, v51
    v_accvgpr_read_b32 v48, a124
    v_accvgpr_read_b32 v49, a125
    v_accvgpr_read_b32 v50, a126
    v_accvgpr_read_b32 v51, a127
    v_mul_f32 v48, v48, v57
    v_mul_f32 v49, v49, v57
    v_mul_f32 v50, v50, v57
    v_mul_f32 v51, v51, v57
    v_accvgpr_write_b32 a124, v48
    v_accvgpr_write_b32 a125, v49
    v_accvgpr_write_b32 a126, v50
    v_accvgpr_write_b32 a127, v51
    v_accvgpr_read_b32 v48, a140
    v_accvgpr_read_b32 v49, a141
    v_accvgpr_read_b32 v50, a142
    v_accvgpr_read_b32 v51, a143
    v_mul_f32 v48, v48, v57
    v_mul_f32 v49, v49, v57
    v_mul_f32 v50, v50, v57
    v_mul_f32 v51, v51, v57
    v_accvgpr_write_b32 a140, v48
    v_accvgpr_write_b32 a141, v49
    v_accvgpr_write_b32 a142, v50
    v_accvgpr_write_b32 a143, v51
    v_accvgpr_read_b32 v48, a156
    v_accvgpr_read_b32 v49, a157
    v_accvgpr_read_b32 v50, a158
    v_accvgpr_read_b32 v51, a159
    v_mul_f32 v48, v48, v57
    v_mul_f32 v49, v49, v57
    v_mul_f32 v50, v50, v57
    v_mul_f32 v51, v51, v57
    v_accvgpr_write_b32 a156, v48
    v_accvgpr_write_b32 a157, v49
    v_accvgpr_write_b32 a158, v50
    v_accvgpr_write_b32 a159, v51
    v_accvgpr_read_b32 v48, a172
    v_accvgpr_read_b32 v49, a173
    v_accvgpr_read_b32 v50, a174
    v_accvgpr_read_b32 v51, a175
    v_mul_f32 v48, v48, v57
    v_mul_f32 v49, v49, v57
    v_mul_f32 v50, v50, v57
    v_mul_f32 v51, v51, v57
    v_accvgpr_write_b32 a172, v48
    v_accvgpr_write_b32 a173, v49
    v_accvgpr_write_b32 a174, v50
    v_accvgpr_write_b32 a175, v51
    v_accvgpr_read_b32 v48, a188
    v_accvgpr_read_b32 v49, a189
    v_accvgpr_read_b32 v50, a190
    v_accvgpr_read_b32 v51, a191
    v_mul_f32 v48, v48, v57
    v_mul_f32 v49, v49, v57
    v_mul_f32 v50, v50, v57
    v_mul_f32 v51, v51, v57
    v_accvgpr_write_b32 a188, v48
    v_accvgpr_write_b32 a189, v49
    v_accvgpr_write_b32 a190, v50
    v_accvgpr_write_b32 a191, v51
    v_exp_f32 v48, v92
    v_exp_f32 v49, v93
    v_exp_f32 v50, v94
    v_exp_f32 v51, v95
    v_exp_f32 v52, v124
    v_exp_f32 v53, v125
    v_exp_f32 v54, v126
    v_exp_f32 v55, v127
    s_nop 0
    v_cvt_pk_bf16_f32 v220, v48, v49
    v_cvt_pk_bf16_f32 v221, v50, v51
    v_cvt_pk_bf16_f32 v222, v52, v53
    v_cvt_pk_bf16_f32 v223, v54, v55
    v_add_f32 v27, v48, v49
    v_add_f32 v27, v27, v50
    v_add_f32 v27, v27, v51
    v_add_f32 v27, v27, v52
    v_add_f32 v27, v27, v53
    v_add_f32 v27, v27, v54
    v_add_f32 v27, v27, v55
    s_nop 1
    s_branch rare_p_ret
rare_a:
    s_nop 7
    s_nop 7
    v_max3_f32 v56, v132, v133, v134
    v_max3_f32 v56, v56, v135, v164
    v_max3_f32 v56, v56, v165, v166
    v_max3_f32 v56, v56, v167, 0
    v_mov_b32 v58, v56
    s_nop 1
    v_permlane16_swap_b32 v56, v58
    s_nop 1
    v_max_f32 v56, v56, v58
    v_mov_b32 v58, v56
    s_nop 1
    v_permlane32_swap_b32 v56, v58
    s_nop 1
    v_max_f32 v56, v56, v58
    v_exp_f32 v57, -v56
    v_sub_f32 v32, v32, v56
    v_sub_f32 v33, v33, v56
    v_sub_f32 v34, v34, v56
    v_sub_f32 v35, v35, v56
    v_mul_f32 v20, v20, v57
    v_sub_f32 v132, v132, v56
    v_sub_f32 v133, v133, v56
    v_sub_f32 v134, v134, v56
    v_sub_f32 v135, v135, v56
    v_sub_f32 v164, v164, v56
    v_sub_f32 v165, v165, v56
    v_sub_f32 v166, v166, v56
    v_sub_f32 v167, v167, v56
    v_sub_f32 v68, v68, v56
    v_sub_f32 v69, v69, v56
    v_sub_f32 v70, v70, v56
    v_sub_f32 v71, v71, v56
    v_sub_f32 v100, v100, v56
    v_sub_f32 v101, v101, v56
    v_sub_f32 v102, v102, v56
    v_sub_f32 v103, v103, v56
    v_accvgpr_read_b32 v48, a0
    v_accvgpr_read_b32 v49, a1
    v_accvgpr_read_b32 v50, a2
    v_accvgpr_read_b32 v51, a3
    v_mul_f32 v48, v48, v57
    v_mul_f32 v49, v49, v57
    v_mul_f32 v50, v50, v57
    v_mul_f32 v51, v51, v57
    v_accvgpr_write_b32 a0, v48
    v_accvgpr_write_b32 a1, v49
    v_accvgpr_write_b32 a2, v50
    v_accvgpr_write_b32 a3, v51
    v_accvgpr_read_b32 v48, a16
    v_accvgpr_read_b32 v49, a17
    v_accvgpr_read_b32 v50, a18
    v_accvgpr_read_b32 v51, a19
    v_mul_f32 v48, v48, v57
    v_mul_f32 v49, v49, v57
    v_mul_f32 v50, v50, v57
    v_mul_f32 v51, v51, v57
    v_accvgpr_write_b32 a16, v48
    v_accvgpr_write_b32 a17, v49
    v_accvgpr_write_b32 a18, v50
    v_accvgpr_write_b32 a19, v51
    v_accvgpr_read_b32 v48, a32
    v_accvgpr_read_b32 v49, a33
    v_accvgpr_read_b32 v50, a34
    v_accvgpr_read_b32 v51, a35
    v_mul_f32 v48, v48, v57
    v_mul_f32 v49, v49, v57
    v_mul_f32 v50, v50, v57
    v_mul_f32 v51, v51, v57
    v_accvgpr_write_b32 a32, v48
    v_accvgpr_write_b32 a33, v49
    v_accvgpr_write_b32 a34, v50
    v_accvgpr_write_b32 a35, v51
    v_accvgpr_read_b32 v48, a48
    v_accvgpr_read_b32 v49, a49
    v_accvgpr_read_b32 v50, a50
    v_accvgpr_read_b32 v51, a51
    v_mul_f32 v48, v48, v57
    v_mul_f32 v49, v49, v57
    v_mul_f32 v50, v50, v57
    v_mul_f32 v51, v51, v57
    v_accvgpr_write_b32 a48, v48
    v_accvgpr_write_b32 a49, v49
    v_accvgpr_write_b32 a50, v50
    v_accvgpr_write_b32 a51, v51
    v_accvgpr_read_b32 v48, a64
    v_accvgpr_read_b32 v49, a65
    v_accvgpr_read_b32 v50, a66
    v_accvgpr_read_b32 v51, a67
    v_mul_f32 v48, v48, v57
    v_mul_f32 v49, v49, v57
    v_mul_f32 v50, v50, v57
    v_mul_f32 v51, v51, v57
    v_accvgpr_write_b32 a64, v48
    v_accvgpr_write_b32 a65, v49
    v_accvgpr_write_b32 a66, v50
    v_accvgpr_write_b32 a67, v51
    v_accvgpr_read_b32 v48, a80
    v_accvgpr_read_b32 v49, a81
    v_accvgpr_read_b32 v50, a82
    v_accvgpr_read_b32 v51, a83
    v_mul_f32 v48, v48, v57
    v_mul_f32 v49, v49, v57
    v_mul_f32 v50, v50, v57
    v_mul_f32 v51, v51, v57
    v_accvgpr_write_b32 a80, v48
    v_accvgpr_write_b32 a81, v49
    v_accvgpr_write_b32 a82, v50
    v_accvgpr_write_b32 a83, v51
    v_accvgpr_read_b32 v48, a96
    v_accvgpr_read_b32 v49, a97
    v_accvgpr_read_b32 v50, a98
    v_accvgpr_read_b32 v51, a99
    v_mul_f32 v48, v48, v57
    v_mul_f32 v49, v49, v57
    v_mul_f32 v50, v50, v57
    v_mul_f32 v51, v51, v57
    v_accvgpr_write_b32 a96, v48
    v_accvgpr_write_b32 a97, v49
    v_accvgpr_write_b32 a98, v50
    v_accvgpr_write_b32 a99, v51
    v_accvgpr_read_b32 v48, a112
    v_accvgpr_read_b32 v49, a113
    v_accvgpr_read_b32 v50, a114
    v_accvgpr_read_b32 v51, a115
    v_mul_f32 v48, v48, v57
    v_mul_f32 v49, v49, v57
    v_mul_f32 v50, v50, v57
    v_mul_f32 v51, v51, v57
    v_accvgpr_write_b32 a112, v48
    v_accvgpr_write_b32 a113, v49
    v_accvgpr_write_b32 a114, v50
    v_accvgpr_write_b32 a115, v51
    v_accvgpr_read_b32 v48, a128
    v_accvgpr_read_b32 v49, a129
    v_accvgpr_read_b32 v50, a130
    v_accvgpr_read_b32 v51, a131
    v_mul_f32 v48, v48, v57
    v_mul_f32 v49, v49, v57
    v_mul_f32 v50, v50, v57
    v_mul_f32 v51, v51, v57
    v_accvgpr_write_b32 a128, v48
    v_accvgpr_write_b32 a129, v49
    v_accvgpr_write_b32 a130, v50
    v_accvgpr_write_b32 a131, v51
    v_accvgpr_read_b32 v48, a144
    v_accvgpr_read_b32 v49, a145
    v_accvgpr_read_b32 v50, a146
    v_accvgpr_read_b32 v51, a147
    v_mul_f32 v48, v48, v57
    v_mul_f32 v49, v49, v57
    v_mul_f32 v50, v50, v57
    v_mul_f32 v51, v51, v57
    v_accvgpr_write_b32 a144, v48
    v_accvgpr_write_b32 a145, v49
    v_accvgpr_write_b32 a146, v50
    v_accvgpr_write_b32 a147, v51
    v_accvgpr_read_b32 v48, a160
    v_accvgpr_read_b32 v49, a161
    v_accvgpr_read_b32 v50, a162
    v_accvgpr_read_b32 v51, a163
    v_mul_f32 v48, v48, v57
    v_mul_f32 v49, v49, v57
    v_mul_f32 v50, v50, v57
    v_mul_f32 v51, v51, v57
    v_accvgpr_write_b32 a160, v48
    v_accvgpr_write_b32 a161, v49
    v_accvgpr_write_b32 a162, v50
    v_accvgpr_write_b32 a163, v51
    v_accvgpr_read_b32 v48, a176
    v_accvgpr_read_b32 v49, a177
    v_accvgpr_read_b32 v50, a178
    v_accvgpr_read_b32 v51, a179
    v_mul_f32 v48, v48, v57
    v_mul_f32 v49, v49, v57
    v_mul_f32 v50, v50, v57
    v_mul_f32 v51, v51, v57
    v_accvgpr_write_b32 a176, v48
    v_accvgpr_write_b32 a177, v49
    v_accvgpr_write_b32 a178, v50
    v_accvgpr_write_b32 a179, v51
    v_exp_f32 v48, v132
    v_exp_f32 v49, v133
    v_exp_f32 v50, v134
    v_exp_f32 v51, v135
    v_exp_f32 v52, v164
    v_exp_f32 v53, v165
    v_exp_f32 v54, v166
    v_exp_f32 v55, v167
    s_nop 0
    v_cvt_pk_bf16_f32 v228, v48, v49
    v_cvt_pk_bf16_f32 v229, v50, v51
    v_cvt_pk_bf16_f32 v230, v52, v53
    v_cvt_pk_bf16_f32 v231, v54, v55
    v_add_f32 v24, v48, v49
    v_add_f32 v24, v24, v50
    v_add_f32 v24, v24, v51
    v_add_f32 v24, v24, v52
    v_add_f32 v24, v24, v53
    v_add_f32 v24, v24, v54
    v_add_f32 v24, v24, v55
    v_max3_f32 v56, v140, v141, v142
    v_max3_f32 v56, v56, v143, v172
    v_max3_f32 v56, v56, v173, v174
    v_max3_f32 v56, v56, v175, 0
    v_mov_b32 v58, v56
    s_nop 1
    v_permlane16_swap_b32 v56, v58
    s_nop 1
    v_max_f32 v56, v56, v58
    v_mov_b32 v58, v56
    s_nop 1
    v_permlane32_swap_b32 v56, v58
    s_nop 1
    v_max_f32 v56, v56, v58
    v_exp_f32 v57, -v56
    v_sub_f32 v36, v36, v56
    v_sub_f32 v37, v37, v56
    v_sub_f32 v38, v38, v56
    v_sub_f32 v39, v39, v56
    v_mul_f32 v21, v21, v57
    v_sub_f32 v140, v140, v56
    v_sub_f32 v141, v141, v56
    v_sub_f32 v142, v142, v56
    v_sub_f32 v143, v143, v56
    v_sub_f32 v172, v172, v56
    v_sub_f32 v173, v173, v56
    v_sub_f32 v174, v174, v56
    v_sub_f32 v175, v175, v56
    v_sub_f32 v76, v76, v56
    v_sub_f32 v77, v77, v56
    v_sub_f32 v78, v78, v56
    v_sub_f32 v79, v79, v56
    v_sub_f32 v108, v108, v56
    v_sub_f32 v109, v109, v56
    v_sub_f32 v110, v110, v56
    v_sub_f32 v111, v111, v56
    v_accvgpr_read_b32 v48, a4
    v_accvgpr_read_b32 v49, a5
    v_accvgpr_read_b32 v50, a6
    v_accvgpr_read_b32 v51, a7
    v_mul_f32 v48, v48, v57
    v_mul_f32 v49, v49, v57
    v_mul_f32 v50, v50, v57
    v_mul_f32 v51, v51, v57
    v_accvgpr_write_b32 a4, v48
    v_accvgpr_write_b32 a5, v49
    v_accvgpr_write_b32 a6, v50
    v_accvgpr_write_b32 a7, v51
    v_accvgpr_read_b32 v48, a20
    v_accvgpr_read_b32 v49, a21
    v_accvgpr_read_b32 v50, a22
    v_accvgpr_read_b32 v51, a23
    v_mul_f32 v48, v48, v57
    v_mul_f32 v49, v49, v57
    v_mul_f32 v50, v50, v57
    v_mul_f32 v51, v51, v57
    v_accvgpr_write_b32 a20, v48
    v_accvgpr_write_b32 a21, v49
    v_accvgpr_write_b32 a22, v50
    v_accvgpr_write_b32 a23, v51
    v_accvgpr_read_b32 v48, a36
    v_accvgpr_read_b32 v49, a37
    v_accvgpr_read_b32 v50, a38
    v_accvgpr_read_b32 v51, a39
    v_mul_f32 v48, v48, v57
    v_mul_f32 v49, v49, v57
    v_mul_f32 v50, v50, v57
    v_mul_f32 v51, v51, v57
    v_accvgpr_write_b32 a36, v48
    v_accvgpr_write_b32 a37, v49
    v_accvgpr_write_b32 a38, v50
    v_accvgpr_write_b32 a39, v51
    v_accvgpr_read_b32 v48, a52
    v_accvgpr_read_b32 v49, a53
    v_accvgpr_read_b32 v50, a54
    v_accvgpr_read_b32 v51, a55
    v_mul_f32 v48, v48, v57
    v_mul_f32 v49, v49, v57
    v_mul_f32 v50, v50, v57
    v_mul_f32 v51, v51, v57
    v_accvgpr_write_b32 a52, v48
    v_accvgpr_write_b32 a53, v49
    v_accvgpr_write_b32 a54, v50
    v_accvgpr_write_b32 a55, v51
    v_accvgpr_read_b32 v48, a68
    v_accvgpr_read_b32 v49, a69
    v_accvgpr_read_b32 v50, a70
    v_accvgpr_read_b32 v51, a71
    v_mul_f32 v48, v48, v57
    v_mul_f32 v49, v49, v57
    v_mul_f32 v50, v50, v57
    v_mul_f32 v51, v51, v57
    v_accvgpr_write_b32 a68, v48
    v_accvgpr_write_b32 a69, v49
    v_accvgpr_write_b32 a70, v50
    v_accvgpr_write_b32 a71, v51
    v_accvgpr_read_b32 v48, a84
    v_accvgpr_read_b32 v49, a85
    v_accvgpr_read_b32 v50, a86
    v_accvgpr_read_b32 v51, a87
    v_mul_f32 v48, v48, v57
    v_mul_f32 v49, v49, v57
    v_mul_f32 v50, v50, v57
    v_mul_f32 v51, v51, v57
    v_accvgpr_write_b32 a84, v48
    v_accvgpr_write_b32 a85, v49
    v_accvgpr_write_b32 a86, v50
    v_accvgpr_write_b32 a87, v51
    v_accvgpr_read_b32 v48, a100
    v_accvgpr_read_b32 v49, a101
    v_accvgpr_read_b32 v50, a102
    v_accvgpr_read_b32 v51, a103
    v_mul_f32 v48, v48, v57
    v_mul_f32 v49, v49, v57
    v_mul_f32 v50, v50, v57
    v_mul_f32 v51, v51, v57
    v_accvgpr_write_b32 a100, v48
    v_accvgpr_write_b32 a101, v49
    v_accvgpr_write_b32 a102, v50
    v_accvgpr_write_b32 a103, v51
    v_accvgpr_read_b32 v48, a116
    v_accvgpr_read_b32 v49, a117
    v_accvgpr_read_b32 v50, a118
    v_accvgpr_read_b32 v51, a119
    v_mul_f32 v48, v48, v57
    v_mul_f32 v49, v49, v57
    v_mul_f32 v50, v50, v57
    v_mul_f32 v51, v51, v57
    v_accvgpr_write_b32 a116, v48
    v_accvgpr_write_b32 a117, v49
    v_accvgpr_write_b32 a118, v50
    v_accvgpr_write_b32 a119, v51
    v_accvgpr_read_b32 v48, a132
    v_accvgpr_read_b32 v49, a133
    v_accvgpr_read_b32 v50, a134
    v_accvgpr_read_b32 v51, a135
    v_mul_f32 v48, v48, v57
    v_mul_f32 v49, v49, v57
    v_mul_f32 v50, v50, v57
    v_mul_f32 v51, v51, v57
    v_accvgpr_write_b32 a132, v48
    v_accvgpr_write_b32 a133, v49
    v_accvgpr_write_b32 a134, v50
    v_accvgpr_write_b32 a135, v51
    v_accvgpr_read_b32 v48, a148
    v_accvgpr_read_b32 v49, a149
    v_accvgpr_read_b32 v50, a150
    v_accvgpr_read_b32 v51, a151
    v_mul_f32 v48, v48, v57
    v_mul_f32 v49, v49, v57
    v_mul_f32 v50, v50, v57
    v_mul_f32 v51, v51, v57
    v_accvgpr_write_b32 a148, v48
    v_accvgpr_write_b32 a149, v49
    v_accvgpr_write_b32 a150, v50
    v_accvgpr_write_b32 a151, v51
    v_accvgpr_read_b32 v48, a164
    v_accvgpr_read_b32 v49, a165
    v_accvgpr_read_b32 v50, a166
    v_accvgpr_read_b32 v51, a167
    v_mul_f32 v48, v48, v57
    v_mul_f32 v49, v49, v57
    v_mul_f32 v50, v50, v57
    v_mul_f32 v51, v51, v57
    v_accvgpr_write_b32 a164, v48
    v_accvgpr_write_b32 a165, v49
    v_accvgpr_write_b32 a166, v50
    v_accvgpr_write_b32 a167, v51
    v_accvgpr_read_b32 v48, a180
    v_accvgpr_read_b32 v49, a181
    v_accvgpr_read_b32 v50, a182
    v_accvgpr_read_b32 v51, a183
    v_mul_f32 v48, v48, v57
    v_mul_f32 v49, v49, v57
    v_mul_f32 v50, v50, v57
    v_mul_f32 v51, v51, v57
    v_accvgpr_write_b32 a180, v48
    v_accvgpr_write_b32 a181, v49
    v_accvgpr_write_b32 a182, v50
    v_accvgpr_write_b32 a183, v51
    v_exp_f32 v48, v140
    v_exp_f32 v49, v141
    v_exp_f32 v50, v142
    v_exp_f32 v51, v143
    v_exp_f32 v52, v172
    v_exp_f32 v53, v173
    v_exp_f32 v54, v174
    v_exp_f32 v55, v175
    s_nop 0
    v_cvt_pk_bf16_f32 v236, v48, v49
    v_cvt_pk_bf16_f32 v237, v50, v51
    v_cvt_pk_bf16_f32 v238, v52, v53
    v_cvt_pk_bf16_f32 v239, v54, v55
    v_add_f32 v25, v48, v49
    v_add_f32 v25, v25, v50
    v_add_f32 v25, v25, v51
    v_add_f32 v25, v25, v52
    v_add_f32 v25, v25, v53
    v_add_f32 v25, v25, v54
    v_add_f32 v25, v25, v55
    v_max3_f32 v56, v148, v149, v150
    v_max3_f32 v56, v56, v151, v180
    v_max3_f32 v56, v56, v181, v182
    v_max3_f32 v56, v56, v183, 0
    v_mov_b32 v58, v56
    s_nop 1
    v_permlane16_swap_b32 v56, v58
    s_nop 1
    v_max_f32 v56, v56, v58
    v_mov_b32 v58, v56
    s_nop 1
    v_permlane32_swap_b32 v56, v58
    s_nop 1
    v_max_f32 v56, v56, v58
    v_exp_f32 v57, -v56
    v_sub_f32 v40, v40, v56
    v_sub_f32 v41, v41, v56
    v_sub_f32 v42, v42, v56
    v_sub_f32 v43, v43, v56
    v_mul_f32 v22, v22, v57
    v_sub_f32 v148, v148, v56
    v_sub_f32 v149, v149, v56
    v_sub_f32 v150, v150, v56
    v_sub_f32 v151, v151, v56
    v_sub_f32 v180, v180, v56
    v_sub_f32 v181, v181, v56
    v_sub_f32 v182, v182, v56
    v_sub_f32 v183, v183, v56
    v_sub_f32 v84, v84, v56
    v_sub_f32 v85, v85, v56
    v_sub_f32 v86, v86, v56
    v_sub_f32 v87, v87, v56
    v_sub_f32 v116, v116, v56
    v_sub_f32 v117, v117, v56
    v_sub_f32 v118, v118, v56
    v_sub_f32 v119, v119, v56
    v_accvgpr_read_b32 v48, a8
    v_accvgpr_read_b32 v49, a9
    v_accvgpr_read_b32 v50, a10
    v_accvgpr_read_b32 v51, a11
    v_mul_f32 v48, v48, v57
    v_mul_f32 v49, v49, v57
    v_mul_f32 v50, v50, v57
    v_mul_f32 v51, v51, v57
    v_accvgpr_write_b32 a8, v48
    v_accvgpr_write_b32 a9, v49
    v_accvgpr_write_b32 a10, v50
    v_accvgpr_write_b32 a11, v51
    v_accvgpr_read_b32 v48, a24
    v_accvgpr_read_b32 v49, a25
    v_accvgpr_read_b32 v50, a26
    v_accvgpr_read_b32 v51, a27
    v_mul_f32 v48, v48, v57
    v_mul_f32 v49, v49, v57
    v_mul_f32 v50, v50, v57
    v_mul_f32 v51, v51, v57
    v_accvgpr_write_b32 a24, v48
    v_accvgpr_write_b32 a25, v49
    v_accvgpr_write_b32 a26, v50
    v_accvgpr_write_b32 a27, v51
    v_accvgpr_read_b32 v48, a40
    v_accvgpr_read_b32 v49, a41
    v_accvgpr_read_b32 v50, a42
    v_accvgpr_read_b32 v51, a43
    v_mul_f32 v48, v48, v57
    v_mul_f32 v49, v49, v57
    v_mul_f32 v50, v50, v57
    v_mul_f32 v51, v51, v57
    v_accvgpr_write_b32 a40, v48
    v_accvgpr_write_b32 a41, v49
    v_accvgpr_write_b32 a42, v50
    v_accvgpr_write_b32 a43, v51
    v_accvgpr_read_b32 v48, a56
    v_accvgpr_read_b32 v49, a57
    v_accvgpr_read_b32 v50, a58
    v_accvgpr_read_b32 v51, a59
    v_mul_f32 v48, v48, v57
    v_mul_f32 v49, v49, v57
    v_mul_f32 v50, v50, v57
    v_mul_f32 v51, v51, v57
    v_accvgpr_write_b32 a56, v48
    v_accvgpr_write_b32 a57, v49
    v_accvgpr_write_b32 a58, v50
    v_accvgpr_write_b32 a59, v51
    v_accvgpr_read_b32 v48, a72
    v_accvgpr_read_b32 v49, a73
    v_accvgpr_read_b32 v50, a74
    v_accvgpr_read_b32 v51, a75
    v_mul_f32 v48, v48, v57
    v_mul_f32 v49, v49, v57
    v_mul_f32 v50, v50, v57
    v_mul_f32 v51, v51, v57
    v_accvgpr_write_b32 a72, v48
    v_accvgpr_write_b32 a73, v49
    v_accvgpr_write_b32 a74, v50
    v_accvgpr_write_b32 a75, v51
    v_accvgpr_read_b32 v48, a88
    v_accvgpr_read_b32 v49, a89
    v_accvgpr_read_b32 v50, a90
    v_accvgpr_read_b32 v51, a91
    v_mul_f32 v48, v48, v57
    v_mul_f32 v49, v49, v57
    v_mul_f32 v50, v50, v57
    v_mul_f32 v51, v51, v57
    v_accvgpr_write_b32 a88, v48
    v_accvgpr_write_b32 a89, v49
    v_accvgpr_write_b32 a90, v50
    v_accvgpr_write_b32 a91, v51
    v_accvgpr_read_b32 v48, a104
    v_accvgpr_read_b32 v49, a105
    v_accvgpr_read_b32 v50, a106
    v_accvgpr_read_b32 v51, a107
    v_mul_f32 v48, v48, v57
    v_mul_f32 v49, v49, v57
    v_mul_f32 v50, v50, v57
    v_mul_f32 v51, v51, v57
    v_accvgpr_write_b32 a104, v48
    v_accvgpr_write_b32 a105, v49
    v_accvgpr_write_b32 a106, v50
    v_accvgpr_write_b32 a107, v51
    v_accvgpr_read_b32 v48, a120
    v_accvgpr_read_b32 v49, a121
    v_accvgpr_read_b32 v50, a122
    v_accvgpr_read_b32 v51, a123
    v_mul_f32 v48, v48, v57
    v_mul_f32 v49, v49, v57
    v_mul_f32 v50, v50, v57
    v_mul_f32 v51, v51, v57
    v_accvgpr_write_b32 a120, v48
    v_accvgpr_write_b32 a121, v49
    v_accvgpr_write_b32 a122, v50
    v_accvgpr_write_b32 a123, v51
    v_accvgpr_read_b32 v48, a136
    v_accvgpr_read_b32 v49, a137
    v_accvgpr_read_b32 v50, a138
    v_accvgpr_read_b32 v51, a139
    v_mul_f32 v48, v48, v57
    v_mul_f32 v49, v49, v57
    v_mul_f32 v50, v50, v57
    v_mul_f32 v51, v51, v57
    v_accvgpr_write_b32 a136, v48
    v_accvgpr_write_b32 a137, v49
    v_accvgpr_write_b32 a138, v50
    v_accvgpr_write_b32 a139, v51
    v_accvgpr_read_b32 v48, a152
    v_accvgpr_read_b32 v49, a153
    v_accvgpr_read_b32 v50, a154
    v_accvgpr_read_b32 v51, a155
    v_mul_f32 v48, v48, v57
    v_mul_f32 v49, v49, v57
    v_mul_f32 v50, v50, v57
    v_mul_f32 v51, v51, v57
    v_accvgpr_write_b32 a152, v48
    v_accvgpr_write_b32 a153, v49
    v_accvgpr_write_b32 a154, v50
    v_accvgpr_write_b32 a155, v51
    v_accvgpr_read_b32 v48, a168
    v_accvgpr_read_b32 v49, a169
    v_accvgpr_read_b32 v50, a170
    v_accvgpr_read_b32 v51, a171
    v_mul_f32 v48, v48, v57
    v_mul_f32 v49, v49, v57
    v_mul_f32 v50, v50, v57
    v_mul_f32 v51, v51, v57
    v_accvgpr_write_b32 a168, v48
    v_accvgpr_write_b32 a169, v49
    v_accvgpr_write_b32 a170, v50
    v_accvgpr_write_b32 a171, v51
    v_accvgpr_read_b32 v48, a184
    v_accvgpr_read_b32 v49, a185
    v_accvgpr_read_b32 v50, a186
    v_accvgpr_read_b32 v51, a187
    v_mul_f32 v48, v48, v57
    v_mul_f32 v49, v49, v57
    v_mul_f32 v50, v50, v57
    v_mul_f32 v51, v51, v57
    v_accvgpr_write_b32 a184, v48
    v_accvgpr_write_b32 a185, v49
    v_accvgpr_write_b32 a186, v50
    v_accvgpr_write_b32 a187, v51
    v_exp_f32 v48, v148
    v_exp_f32 v49, v149
    v_exp_f32 v50, v150
    v_exp_f32 v51, v151
    v_exp_f32 v52, v180
    v_exp_f32 v53, v181
    v_exp_f32 v54, v182
    v_exp_f32 v55, v183
    s_nop 0
    v_cvt_pk_bf16_f32 v244, v48, v49
    v_cvt_pk_bf16_f32 v245, v50, v51
    v_cvt_pk_bf16_f32 v246, v52, v53
    v_cvt_pk_bf16_f32 v247, v54, v55
    v_add_f32 v26, v48, v49
    v_add_f32 v26, v26, v50
    v_add_f32 v26, v26, v51
    v_add_f32 v26, v26, v52
    v_add_f32 v26, v26, v53
    v_add_f32 v26, v26, v54
    v_add_f32 v26, v26, v55
    v_max3_f32 v56, v156, v157, v158
    v_max3_f32 v56, v56, v159, v188
    v_max3_f32 v56, v56, v189, v190
    v_max3_f32 v56, v56, v191, 0
    v_mov_b32 v58, v56
    s_nop 1
    v_permlane16_swap_b32 v56, v58
    s_nop 1
    v_max_f32 v56, v56, v58
    v_mov_b32 v58, v56
    s_nop 1
    v_permlane32_swap_b32 v56, v58
    s_nop 1
    v_max_f32 v56, v56, v58
    v_exp_f32 v57, -v56
    v_sub_f32 v44, v44, v56
    v_sub_f32 v45, v45, v56
    v_sub_f32 v46, v46, v56
    v_sub_f32 v47, v47, v56
    v_mul_f32 v23, v23, v57
    v_sub_f32 v156, v156, v56
    v_sub_f32 v157, v157, v56
    v_sub_f32 v158, v158, v56
    v_sub_f32 v159, v159, v56
    v_sub_f32 v188, v188, v56
    v_sub_f32 v189, v189, v56
    v_sub_f32 v190, v190, v56
    v_sub_f32 v191, v191, v56
    v_sub_f32 v92, v92, v56
    v_sub_f32 v93, v93, v56
    v_sub_f32 v94, v94, v56
    v_sub_f32 v95, v95, v56
    v_sub_f32 v124, v124, v56
    v_sub_f32 v125, v125, v56
    v_sub_f32 v126, v126, v56
    v_sub_f32 v127, v127, v56
    v_accvgpr_read_b32 v48, a12
    v_accvgpr_read_b32 v49, a13
    v_accvgpr_read_b32 v50, a14
    v_accvgpr_read_b32 v51, a15
    v_mul_f32 v48, v48, v57
    v_mul_f32 v49, v49, v57
    v_mul_f32 v50, v50, v57
    v_mul_f32 v51, v51, v57
    v_accvgpr_write_b32 a12, v48
    v_accvgpr_write_b32 a13, v49
    v_accvgpr_write_b32 a14, v50
    v_accvgpr_write_b32 a15, v51
    v_accvgpr_read_b32 v48, a28
    v_accvgpr_read_b32 v49, a29
    v_accvgpr_read_b32 v50, a30
    v_accvgpr_read_b32 v51, a31
    v_mul_f32 v48, v48, v57
    v_mul_f32 v49, v49, v57
    v_mul_f32 v50, v50, v57
    v_mul_f32 v51, v51, v57
    v_accvgpr_write_b32 a28, v48
    v_accvgpr_write_b32 a29, v49
    v_accvgpr_write_b32 a30, v50
    v_accvgpr_write_b32 a31, v51
    v_accvgpr_read_b32 v48, a44
    v_accvgpr_read_b32 v49, a45
    v_accvgpr_read_b32 v50, a46
    v_accvgpr_read_b32 v51, a47
    v_mul_f32 v48, v48, v57
    v_mul_f32 v49, v49, v57
    v_mul_f32 v50, v50, v57
    v_mul_f32 v51, v51, v57
    v_accvgpr_write_b32 a44, v48
    v_accvgpr_write_b32 a45, v49
    v_accvgpr_write_b32 a46, v50
    v_accvgpr_write_b32 a47, v51
    v_accvgpr_read_b32 v48, a60
    v_accvgpr_read_b32 v49, a61
    v_accvgpr_read_b32 v50, a62
    v_accvgpr_read_b32 v51, a63
    v_mul_f32 v48, v48, v57
    v_mul_f32 v49, v49, v57
    v_mul_f32 v50, v50, v57
    v_mul_f32 v51, v51, v57
    v_accvgpr_write_b32 a60, v48
    v_accvgpr_write_b32 a61, v49
    v_accvgpr_write_b32 a62, v50
    v_accvgpr_write_b32 a63, v51
    v_accvgpr_read_b32 v48, a76
    v_accvgpr_read_b32 v49, a77
    v_accvgpr_read_b32 v50, a78
    v_accvgpr_read_b32 v51, a79
    v_mul_f32 v48, v48, v57
    v_mul_f32 v49, v49, v57
    v_mul_f32 v50, v50, v57
    v_mul_f32 v51, v51, v57
    v_accvgpr_write_b32 a76, v48
    v_accvgpr_write_b32 a77, v49
    v_accvgpr_write_b32 a78, v50
    v_accvgpr_write_b32 a79, v51
    v_accvgpr_read_b32 v48, a92
    v_accvgpr_read_b32 v49, a93
    v_accvgpr_read_b32 v50, a94
    v_accvgpr_read_b32 v51, a95
    v_mul_f32 v48, v48, v57
    v_mul_f32 v49, v49, v57
    v_mul_f32 v50, v50, v57
    v_mul_f32 v51, v51, v57
    v_accvgpr_write_b32 a92, v48
    v_accvgpr_write_b32 a93, v49
    v_accvgpr_write_b32 a94, v50
    v_accvgpr_write_b32 a95, v51
    v_accvgpr_read_b32 v48, a108
    v_accvgpr_read_b32 v49, a109
    v_accvgpr_read_b32 v50, a110
    v_accvgpr_read_b32 v51, a111
    v_mul_f32 v48, v48, v57
    v_mul_f32 v49, v49, v57
    v_mul_f32 v50, v50, v57
    v_mul_f32 v51, v51, v57
    v_accvgpr_write_b32 a108, v48
    v_accvgpr_write_b32 a109, v49
    v_accvgpr_write_b32 a110, v50
    v_accvgpr_write_b32 a111, v51
    v_accvgpr_read_b32 v48, a124
    v_accvgpr_read_b32 v49, a125
    v_accvgpr_read_b32 v50, a126
    v_accvgpr_read_b32 v51, a127
    v_mul_f32 v48, v48, v57
    v_mul_f32 v49, v49, v57
    v_mul_f32 v50, v50, v57
    v_mul_f32 v51, v51, v57
    v_accvgpr_write_b32 a124, v48
    v_accvgpr_write_b32 a125, v49
    v_accvgpr_write_b32 a126, v50
    v_accvgpr_write_b32 a127, v51
    v_accvgpr_read_b32 v48, a140
    v_accvgpr_read_b32 v49, a141
    v_accvgpr_read_b32 v50, a142
    v_accvgpr_read_b32 v51, a143
    v_mul_f32 v48, v48, v57
    v_mul_f32 v49, v49, v57
    v_mul_f32 v50, v50, v57
    v_mul_f32 v51, v51, v57
    v_accvgpr_write_b32 a140, v48
    v_accvgpr_write_b32 a141, v49
    v_accvgpr_write_b32 a142, v50
    v_accvgpr_write_b32 a143, v51
    v_accvgpr_read_b32 v48, a156
    v_accvgpr_read_b32 v49, a157
    v_accvgpr_read_b32 v50, a158
    v_accvgpr_read_b32 v51, a159
    v_mul_f32 v48, v48, v57
    v_mul_f32 v49, v49, v57
    v_mul_f32 v50, v50, v57
    v_mul_f32 v51, v51, v57
    v_accvgpr_write_b32 a156, v48
    v_accvgpr_write_b32 a157, v49
    v_accvgpr_write_b32 a158, v50
    v_accvgpr_write_b32 a159, v51
    v_accvgpr_read_b32 v48, a172
    v_accvgpr_read_b32 v49, a173
    v_accvgpr_read_b32 v50, a174
    v_accvgpr_read_b32 v51, a175
    v_mul_f32 v48, v48, v57
    v_mul_f32 v49, v49, v57
    v_mul_f32 v50, v50, v57
    v_mul_f32 v51, v51, v57
    v_accvgpr_write_b32 a172, v48
    v_accvgpr_write_b32 a173, v49
    v_accvgpr_write_b32 a174, v50
    v_accvgpr_write_b32 a175, v51
    v_accvgpr_read_b32 v48, a188
    v_accvgpr_read_b32 v49, a189
    v_accvgpr_read_b32 v50, a190
    v_accvgpr_read_b32 v51, a191
    v_mul_f32 v48, v48, v57
    v_mul_f32 v49, v49, v57
    v_mul_f32 v50, v50, v57
    v_mul_f32 v51, v51, v57
    v_accvgpr_write_b32 a188, v48
    v_accvgpr_write_b32 a189, v49
    v_accvgpr_write_b32 a190, v50
    v_accvgpr_write_b32 a191, v51
    v_exp_f32 v48, v156
    v_exp_f32 v49, v157
    v_exp_f32 v50, v158
    v_exp_f32 v51, v159
    v_exp_f32 v52, v188
    v_exp_f32 v53, v189
    v_exp_f32 v54, v190
    v_exp_f32 v55, v191
    s_nop 0
    v_cvt_pk_bf16_f32 v252, v48, v49
    v_cvt_pk_bf16_f32 v253, v50, v51
    v_cvt_pk_bf16_f32 v254, v52, v53
    v_cvt_pk_bf16_f32 v255, v54, v55
    v_add_f32 v27, v48, v49
    v_add_f32 v27, v27, v50
    v_add_f32 v27, v27, v51
    v_add_f32 v27, v27, v52
    v_add_f32 v27, v27, v53
    v_add_f32 v27, v27, v54
    v_add_f32 v27, v27, v55
    s_nop 1
    s_branch rare_a_ret
rare_b:
    s_nop 7
    s_nop 7
    v_max3_f32 v56, v68, v69, v70
    v_max3_f32 v56, v56, v71, v100
    v_max3_f32 v56, v56, v101, v102
    v_max3_f32 v56, v56, v103, 0
    v_mov_b32 v58, v56
    s_nop 1
    v_permlane16_swap_b32 v56, v58
    s_nop 1
    v_max_f32 v56, v56, v58
    v_mov_b32 v58, v56
    s_nop 1
    v_permlane32_swap_b32 v56, v58
    s_nop 1
    v_max_f32 v56, v56, v58
    v_exp_f32 v57, -v56
    v_sub_f32 v32, v32, v56
    v_sub_f32 v33, v33, v56
    v_sub_f32 v34, v34, v56
    v_sub_f32 v35, v35, v56
    v_mul_f32 v20, v20, v57
    v_sub_f32 v68, v68, v56
    v_sub_f32 v69, v69, v56
    v_sub_f32 v70, v70, v56
    v_sub_f32 v71, v71, v56
    v_sub_f32 v100, v100, v56
    v_sub_f32 v101, v101, v56
    v_sub_f32 v102, v102, v56
    v_sub_f32 v103, v103, v56
    v_sub_f32 v132, v132, v56
    v_sub_f32 v133, v133, v56
    v_sub_f32 v134, v134, v56
    v_sub_f32 v135, v135, v56
    v_sub_f32 v164, v164, v56
    v_sub_f32 v165, v165, v56
    v_sub_f32 v166, v166, v56
    v_sub_f32 v167, v167, v56
    v_accvgpr_read_b32 v48, a0
    v_accvgpr_read_b32 v49, a1
    v_accvgpr_read_b32 v50, a2
    v_accvgpr_read_b32 v51, a3
    v_mul_f32 v48, v48, v57
    v_mul_f32 v49, v49, v57
    v_mul_f32 v50, v50, v57
    v_mul_f32 v51, v51, v57
    v_accvgpr_write_b32 a0, v48
    v_accvgpr_write_b32 a1, v49
    v_accvgpr_write_b32 a2, v50
    v_accvgpr_write_b32 a3, v51
    v_accvgpr_read_b32 v48, a16
    v_accvgpr_read_b32 v49, a17
    v_accvgpr_read_b32 v50, a18
    v_accvgpr_read_b32 v51, a19
    v_mul_f32 v48, v48, v57
    v_mul_f32 v49, v49, v57
    v_mul_f32 v50, v50, v57
    v_mul_f32 v51, v51, v57
    v_accvgpr_write_b32 a16, v48
    v_accvgpr_write_b32 a17, v49
    v_accvgpr_write_b32 a18, v50
    v_accvgpr_write_b32 a19, v51
    v_accvgpr_read_b32 v48, a32
    v_accvgpr_read_b32 v49, a33
    v_accvgpr_read_b32 v50, a34
    v_accvgpr_read_b32 v51, a35
    v_mul_f32 v48, v48, v57
    v_mul_f32 v49, v49, v57
    v_mul_f32 v50, v50, v57
    v_mul_f32 v51, v51, v57
    v_accvgpr_write_b32 a32, v48
    v_accvgpr_write_b32 a33, v49
    v_accvgpr_write_b32 a34, v50
    v_accvgpr_write_b32 a35, v51
    v_accvgpr_read_b32 v48, a48
    v_accvgpr_read_b32 v49, a49
    v_accvgpr_read_b32 v50, a50
    v_accvgpr_read_b32 v51, a51
    v_mul_f32 v48, v48, v57
    v_mul_f32 v49, v49, v57
    v_mul_f32 v50, v50, v57
    v_mul_f32 v51, v51, v57
    v_accvgpr_write_b32 a48, v48
    v_accvgpr_write_b32 a49, v49
    v_accvgpr_write_b32 a50, v50
    v_accvgpr_write_b32 a51, v51
    v_accvgpr_read_b32 v48, a64
    v_accvgpr_read_b32 v49, a65
    v_accvgpr_read_b32 v50, a66
    v_accvgpr_read_b32 v51, a67
    v_mul_f32 v48, v48, v57
    v_mul_f32 v49, v49, v57
    v_mul_f32 v50, v50, v57
    v_mul_f32 v51, v51, v57
    v_accvgpr_write_b32 a64, v48
    v_accvgpr_write_b32 a65, v49
    v_accvgpr_write_b32 a66, v50
    v_accvgpr_write_b32 a67, v51
    v_accvgpr_read_b32 v48, a80
    v_accvgpr_read_b32 v49, a81
    v_accvgpr_read_b32 v50, a82
    v_accvgpr_read_b32 v51, a83
    v_mul_f32 v48, v48, v57
    v_mul_f32 v49, v49, v57
    v_mul_f32 v50, v50, v57
    v_mul_f32 v51, v51, v57
    v_accvgpr_write_b32 a80, v48
    v_accvgpr_write_b32 a81, v49
    v_accvgpr_write_b32 a82, v50
    v_accvgpr_write_b32 a83, v51
    v_accvgpr_read_b32 v48, a96
    v_accvgpr_read_b32 v49, a97
    v_accvgpr_read_b32 v50, a98
    v_accvgpr_read_b32 v51, a99
    v_mul_f32 v48, v48, v57
    v_mul_f32 v49, v49, v57
    v_mul_f32 v50, v50, v57
    v_mul_f32 v51, v51, v57
    v_accvgpr_write_b32 a96, v48
    v_accvgpr_write_b32 a97, v49
    v_accvgpr_write_b32 a98, v50
    v_accvgpr_write_b32 a99, v51
    v_accvgpr_read_b32 v48, a112
    v_accvgpr_read_b32 v49, a113
    v_accvgpr_read_b32 v50, a114
    v_accvgpr_read_b32 v51, a115
    v_mul_f32 v48, v48, v57
    v_mul_f32 v49, v49, v57
    v_mul_f32 v50, v50, v57
    v_mul_f32 v51, v51, v57
    v_accvgpr_write_b32 a112, v48
    v_accvgpr_write_b32 a113, v49
    v_accvgpr_write_b32 a114, v50
    v_accvgpr_write_b32 a115, v51
    v_accvgpr_read_b32 v48, a128
    v_accvgpr_read_b32 v49, a129
    v_accvgpr_read_b32 v50, a130
    v_accvgpr_read_b32 v51, a131
    v_mul_f32 v48, v48, v57
    v_mul_f32 v49, v49, v57
    v_mul_f32 v50, v50, v57
    v_mul_f32 v51, v51, v57
    v_accvgpr_write_b32 a128, v48
    v_accvgpr_write_b32 a129, v49
    v_accvgpr_write_b32 a130, v50
    v_accvgpr_write_b32 a131, v51
    v_accvgpr_read_b32 v48, a144
    v_accvgpr_read_b32 v49, a145
    v_accvgpr_read_b32 v50, a146
    v_accvgpr_read_b32 v51, a147
    v_mul_f32 v48, v48, v57
    v_mul_f32 v49, v49, v57
    v_mul_f32 v50, v50, v57
    v_mul_f32 v51, v51, v57
    v_accvgpr_write_b32 a144, v48
    v_accvgpr_write_b32 a145, v49
    v_accvgpr_write_b32 a146, v50
    v_accvgpr_write_b32 a147, v51
    v_accvgpr_read_b32 v48, a160
    v_accvgpr_read_b32 v49, a161
    v_accvgpr_read_b32 v50, a162
    v_accvgpr_read_b32 v51, a163
    v_mul_f32 v48, v48, v57
    v_mul_f32 v49, v49, v57
    v_mul_f32 v50, v50, v57
    v_mul_f32 v51, v51, v57
    v_accvgpr_write_b32 a160, v48
    v_accvgpr_write_b32 a161, v49
    v_accvgpr_write_b32 a162, v50
    v_accvgpr_write_b32 a163, v51
    v_accvgpr_read_b32 v48, a176
    v_accvgpr_read_b32 v49, a177
    v_accvgpr_read_b32 v50, a178
    v_accvgpr_read_b32 v51, a179
    v_mul_f32 v48, v48, v57
    v_mul_f32 v49, v49, v57
    v_mul_f32 v50, v50, v57
    v_mul_f32 v51, v51, v57
    v_accvgpr_write_b32 a176, v48
    v_accvgpr_write_b32 a177, v49
    v_accvgpr_write_b32 a178, v50
    v_accvgpr_write_b32 a179, v51
    v_exp_f32 v48, v68
    v_exp_f32 v49, v69
    v_exp_f32 v50, v70
    v_exp_f32 v51, v71
    v_exp_f32 v52, v100
    v_exp_f32 v53, v101
    v_exp_f32 v54, v102
    v_exp_f32 v55, v103
    s_nop 0
    v_cvt_pk_bf16_f32 v196, v48, v49
    v_cvt_pk_bf16_f32 v197, v50, v51
    v_cvt_pk_bf16_f32 v198, v52, v53
    v_cvt_pk_bf16_f32 v199, v54, v55
    v_add_f32 v24, v48, v49
    v_add_f32 v24, v24, v50
    v_add_f32 v24, v24, v51
    v_add_f32 v24, v24, v52
    v_add_f32 v24, v24, v53
    v_add_f32 v24, v24, v54
    v_add_f32 v24, v24, v55
    v_max3_f32 v56, v76, v77, v78
    v_max3_f32 v56, v56, v79, v108
    v_max3_f32 v56, v56, v109, v110
    v_max3_f32 v56, v56, v111, 0
    v_mov_b32 v58, v56
    s_nop 1
    v_permlane16_swap_b32 v56, v58
    s_nop 1
    v_max_f32 v56, v56, v58
    v_mov_b32 v58, v56
    s_nop 1
    v_permlane32_swap_b32 v56, v58
    s_nop 1
    v_max_f32 v56, v56, v58
    v_exp_f32 v57, -v56
    v_sub_f32 v36, v36, v56
    v_sub_f32 v37, v37, v56
    v_sub_f32 v38, v38, v56
    v_sub_f32 v39, v39, v56
    v_mul_f32 v21, v21, v57
    v_sub_f32 v76, v76, v56
    v_sub_f32 v77, v77, v56
    v_sub_f32 v78, v78, v56
    v_sub_f32 v79, v79, v56
    v_sub_f32 v108, v108, v56
    v_sub_f32 v109, v109, v56
    v_sub_f32 v110, v110, v56
    v_sub_f32 v111, v111, v56
    v_sub_f32 v140, v140, v56
    v_sub_f32 v141, v141, v56
    v_sub_f32 v142, v142, v56
    v_sub_f32 v143, v143, v56
    v_sub_f32 v172, v172, v56
    v_sub_f32 v173, v173, v56
    v_sub_f32 v174, v174, v56
    v_sub_f32 v175, v175, v56
    v_accvgpr_read_b32 v48, a4
    v_accvgpr_read_b32 v49, a5
    v_accvgpr_read_b32 v50, a6
    v_accvgpr_read_b32 v51, a7
    v_mul_f32 v48, v48, v57
    v_mul_f32 v49, v49, v57
    v_mul_f32 v50, v50, v57
    v_mul_f32 v51, v51, v57
    v_accvgpr_write_b32 a4, v48
    v_accvgpr_write_b32 a5, v49
    v_accvgpr_write_b32 a6, v50
    v_accvgpr_write_b32 a7, v51
    v_accvgpr_read_b32 v48, a20
    v_accvgpr_read_b32 v49, a21
    v_accvgpr_read_b32 v50, a22
    v_accvgpr_read_b32 v51, a23
    v_mul_f32 v48, v48, v57
    v_mul_f32 v49, v49, v57
    v_mul_f32 v50, v50, v57
    v_mul_f32 v51, v51, v57
    v_accvgpr_write_b32 a20, v48
    v_accvgpr_write_b32 a21, v49
    v_accvgpr_write_b32 a22, v50
    v_accvgpr_write_b32 a23, v51
    v_accvgpr_read_b32 v48, a36
    v_accvgpr_read_b32 v49, a37
    v_accvgpr_read_b32 v50, a38
    v_accvgpr_read_b32 v51, a39
    v_mul_f32 v48, v48, v57
    v_mul_f32 v49, v49, v57
    v_mul_f32 v50, v50, v57
    v_mul_f32 v51, v51, v57
    v_accvgpr_write_b32 a36, v48
    v_accvgpr_write_b32 a37, v49
    v_accvgpr_write_b32 a38, v50
    v_accvgpr_write_b32 a39, v51
    v_accvgpr_read_b32 v48, a52
    v_accvgpr_read_b32 v49, a53
    v_accvgpr_read_b32 v50, a54
    v_accvgpr_read_b32 v51, a55
    v_mul_f32 v48, v48, v57
    v_mul_f32 v49, v49, v57
    v_mul_f32 v50, v50, v57
    v_mul_f32 v51, v51, v57
    v_accvgpr_write_b32 a52, v48
    v_accvgpr_write_b32 a53, v49
    v_accvgpr_write_b32 a54, v50
    v_accvgpr_write_b32 a55, v51
    v_accvgpr_read_b32 v48, a68
    v_accvgpr_read_b32 v49, a69
    v_accvgpr_read_b32 v50, a70
    v_accvgpr_read_b32 v51, a71
    v_mul_f32 v48, v48, v57
    v_mul_f32 v49, v49, v57
    v_mul_f32 v50, v50, v57
    v_mul_f32 v51, v51, v57
    v_accvgpr_write_b32 a68, v48
    v_accvgpr_write_b32 a69, v49
    v_accvgpr_write_b32 a70, v50
    v_accvgpr_write_b32 a71, v51
    v_accvgpr_read_b32 v48, a84
    v_accvgpr_read_b32 v49, a85
    v_accvgpr_read_b32 v50, a86
    v_accvgpr_read_b32 v51, a87
    v_mul_f32 v48, v48, v57
    v_mul_f32 v49, v49, v57
    v_mul_f32 v50, v50, v57
    v_mul_f32 v51, v51, v57
    v_accvgpr_write_b32 a84, v48
    v_accvgpr_write_b32 a85, v49
    v_accvgpr_write_b32 a86, v50
    v_accvgpr_write_b32 a87, v51
    v_accvgpr_read_b32 v48, a100
    v_accvgpr_read_b32 v49, a101
    v_accvgpr_read_b32 v50, a102
    v_accvgpr_read_b32 v51, a103
    v_mul_f32 v48, v48, v57
    v_mul_f32 v49, v49, v57
    v_mul_f32 v50, v50, v57
    v_mul_f32 v51, v51, v57
    v_accvgpr_write_b32 a100, v48
    v_accvgpr_write_b32 a101, v49
    v_accvgpr_write_b32 a102, v50
    v_accvgpr_write_b32 a103, v51
    v_accvgpr_read_b32 v48, a116
    v_accvgpr_read_b32 v49, a117
    v_accvgpr_read_b32 v50, a118
    v_accvgpr_read_b32 v51, a119
    v_mul_f32 v48, v48, v57
    v_mul_f32 v49, v49, v57
    v_mul_f32 v50, v50, v57
    v_mul_f32 v51, v51, v57
    v_accvgpr_write_b32 a116, v48
    v_accvgpr_write_b32 a117, v49
    v_accvgpr_write_b32 a118, v50
    v_accvgpr_write_b32 a119, v51
    v_accvgpr_read_b32 v48, a132
    v_accvgpr_read_b32 v49, a133
    v_accvgpr_read_b32 v50, a134
    v_accvgpr_read_b32 v51, a135
    v_mul_f32 v48, v48, v57
    v_mul_f32 v49, v49, v57
    v_mul_f32 v50, v50, v57
    v_mul_f32 v51, v51, v57
    v_accvgpr_write_b32 a132, v48
    v_accvgpr_write_b32 a133, v49
    v_accvgpr_write_b32 a134, v50
    v_accvgpr_write_b32 a135, v51
    v_accvgpr_read_b32 v48, a148
    v_accvgpr_read_b32 v49, a149
    v_accvgpr_read_b32 v50, a150
    v_accvgpr_read_b32 v51, a151
    v_mul_f32 v48, v48, v57
    v_mul_f32 v49, v49, v57
    v_mul_f32 v50, v50, v57
    v_mul_f32 v51, v51, v57
    v_accvgpr_write_b32 a148, v48
    v_accvgpr_write_b32 a149, v49
    v_accvgpr_write_b32 a150, v50
    v_accvgpr_write_b32 a151, v51
    v_accvgpr_read_b32 v48, a164
    v_accvgpr_read_b32 v49, a165
    v_accvgpr_read_b32 v50, a166
    v_accvgpr_read_b32 v51, a167
    v_mul_f32 v48, v48, v57
    v_mul_f32 v49, v49, v57
    v_mul_f32 v50, v50, v57
    v_mul_f32 v51, v51, v57
    v_accvgpr_write_b32 a164, v48
    v_accvgpr_write_b32 a165, v49
    v_accvgpr_write_b32 a166, v50
    v_accvgpr_write_b32 a167, v51
    v_accvgpr_read_b32 v48, a180
    v_accvgpr_read_b32 v49, a181
    v_accvgpr_read_b32 v50, a182
    v_accvgpr_read_b32 v51, a183
    v_mul_f32 v48, v48, v57
    v_mul_f32 v49, v49, v57
    v_mul_f32 v50, v50, v57
    v_mul_f32 v51, v51, v57
    v_accvgpr_write_b32 a180, v48
    v_accvgpr_write_b32 a181, v49
    v_accvgpr_write_b32 a182, v50
    v_accvgpr_write_b32 a183, v51
    v_exp_f32 v48, v76
    v_exp_f32 v49, v77
    v_exp_f32 v50, v78
    v_exp_f32 v51, v79
    v_exp_f32 v52, v108
    v_exp_f32 v53, v109
    v_exp_f32 v54, v110
    v_exp_f32 v55, v111
    s_nop 0
    v_cvt_pk_bf16_f32 v204, v48, v49
    v_cvt_pk_bf16_f32 v205, v50, v51
    v_cvt_pk_bf16_f32 v206, v52, v53
    v_cvt_pk_bf16_f32 v207, v54, v55
    v_add_f32 v25, v48, v49
    v_add_f32 v25, v25, v50
    v_add_f32 v25, v25, v51
    v_add_f32 v25, v25, v52
    v_add_f32 v25, v25, v53
    v_add_f32 v25, v25, v54
    v_add_f32 v25, v25, v55
    v_max3_f32 v56, v84, v85, v86
    v_max3_f32 v56, v56, v87, v116
    v_max3_f32 v56, v56, v117, v118
    v_max3_f32 v56, v56, v119, 0
    v_mov_b32 v58, v56
    s_nop 1
    v_permlane16_swap_b32 v56, v58
    s_nop 1
    v_max_f32 v56, v56, v58
    v_mov_b32 v58, v56
    s_nop 1
    v_permlane32_swap_b32 v56, v58
    s_nop 1
    v_max_f32 v56, v56, v58
    v_exp_f32 v57, -v56
    v_sub_f32 v40, v40, v56
    v_sub_f32 v41, v41, v56
    v_sub_f32 v42, v42, v56
    v_sub_f32 v43, v43, v56
    v_mul_f32 v22, v22, v57
    v_sub_f32 v84, v84, v56
    v_sub_f32 v85, v85, v56
    v_sub_f32 v86, v86, v56
    v_sub_f32 v87, v87, v56
    v_sub_f32 v116, v116, v56
    v_sub_f32 v117, v117, v56
    v_sub_f32 v118, v118, v56
    v_sub_f32 v119, v119, v56
    v_sub_f32 v148, v148, v56
    v_sub_f32 v149, v149, v56
    v_sub_f32 v150, v150, v56
    v_sub_f32 v151, v151, v56
    v_sub_f32 v180, v180, v56
    v_sub_f32 v181, v181, v56
    v_sub_f32 v182, v182, v56
    v_sub_f32 v183, v183, v56
    v_accvgpr_read_b32 v48, a8
    v_accvgpr_read_b32 v49, a9
    v_accvgpr_read_b32 v50, a10
    v_accvgpr_read_b32 v51, a11
    v_mul_f32 v48, v48, v57
    v_mul_f32 v49, v49, v57
    v_mul_f32 v50, v50, v57
    v_mul_f32 v51, v51, v57
    v_accvgpr_write_b32 a8, v48
    v_accvgpr_write_b32 a9, v49
    v_accvgpr_write_b32 a10, v50
    v_accvgpr_write_b32 a11, v51
    v_accvgpr_read_b32 v48, a24
    v_accvgpr_read_b32 v49, a25
    v_accvgpr_read_b32 v50, a26
    v_accvgpr_read_b32 v51, a27
    v_mul_f32 v48, v48, v57
    v_mul_f32 v49, v49, v57
    v_mul_f32 v50, v50, v57
    v_mul_f32 v51, v51, v57
    v_accvgpr_write_b32 a24, v48
    v_accvgpr_write_b32 a25, v49
    v_accvgpr_write_b32 a26, v50
    v_accvgpr_write_b32 a27, v51
    v_accvgpr_read_b32 v48, a40
    v_accvgpr_read_b32 v49, a41
    v_accvgpr_read_b32 v50, a42
    v_accvgpr_read_b32 v51, a43
    v_mul_f32 v48, v48, v57
    v_mul_f32 v49, v49, v57
    v_mul_f32 v50, v50, v57
    v_mul_f32 v51, v51, v57
    v_accvgpr_write_b32 a40, v48
    v_accvgpr_write_b32 a41, v49
    v_accvgpr_write_b32 a42, v50
    v_accvgpr_write_b32 a43, v51
    v_accvgpr_read_b32 v48, a56
    v_accvgpr_read_b32 v49, a57
    v_accvgpr_read_b32 v50, a58
    v_accvgpr_read_b32 v51, a59
    v_mul_f32 v48, v48, v57
    v_mul_f32 v49, v49, v57
    v_mul_f32 v50, v50, v57
    v_mul_f32 v51, v51, v57
    v_accvgpr_write_b32 a56, v48
    v_accvgpr_write_b32 a57, v49
    v_accvgpr_write_b32 a58, v50
    v_accvgpr_write_b32 a59, v51
    v_accvgpr_read_b32 v48, a72
    v_accvgpr_read_b32 v49, a73
    v_accvgpr_read_b32 v50, a74
    v_accvgpr_read_b32 v51, a75
    v_mul_f32 v48, v48, v57
    v_mul_f32 v49, v49, v57
    v_mul_f32 v50, v50, v57
    v_mul_f32 v51, v51, v57
    v_accvgpr_write_b32 a72, v48
    v_accvgpr_write_b32 a73, v49
    v_accvgpr_write_b32 a74, v50
    v_accvgpr_write_b32 a75, v51
    v_accvgpr_read_b32 v48, a88
    v_accvgpr_read_b32 v49, a89
    v_accvgpr_read_b32 v50, a90
    v_accvgpr_read_b32 v51, a91
    v_mul_f32 v48, v48, v57
    v_mul_f32 v49, v49, v57
    v_mul_f32 v50, v50, v57
    v_mul_f32 v51, v51, v57
    v_accvgpr_write_b32 a88, v48
    v_accvgpr_write_b32 a89, v49
    v_accvgpr_write_b32 a90, v50
    v_accvgpr_write_b32 a91, v51
    v_accvgpr_read_b32 v48, a104
    v_accvgpr_read_b32 v49, a105
    v_accvgpr_read_b32 v50, a106
    v_accvgpr_read_b32 v51, a107
    v_mul_f32 v48, v48, v57
    v_mul_f32 v49, v49, v57
    v_mul_f32 v50, v50, v57
    v_mul_f32 v51, v51, v57
    v_accvgpr_write_b32 a104, v48
    v_accvgpr_write_b32 a105, v49
    v_accvgpr_write_b32 a106, v50
    v_accvgpr_write_b32 a107, v51
    v_accvgpr_read_b32 v48, a120
    v_accvgpr_read_b32 v49, a121
    v_accvgpr_read_b32 v50, a122
    v_accvgpr_read_b32 v51, a123
    v_mul_f32 v48, v48, v57
    v_mul_f32 v49, v49, v57
    v_mul_f32 v50, v50, v57
    v_mul_f32 v51, v51, v57
    v_accvgpr_write_b32 a120, v48
    v_accvgpr_write_b32 a121, v49
    v_accvgpr_write_b32 a122, v50
    v_accvgpr_write_b32 a123, v51
    v_accvgpr_read_b32 v48, a136
    v_accvgpr_read_b32 v49, a137
    v_accvgpr_read_b32 v50, a138
    v_accvgpr_read_b32 v51, a139
    v_mul_f32 v48, v48, v57
    v_mul_f32 v49, v49, v57
    v_mul_f32 v50, v50, v57
    v_mul_f32 v51, v51, v57
    v_accvgpr_write_b32 a136, v48
    v_accvgpr_write_b32 a137, v49
    v_accvgpr_write_b32 a138, v50
    v_accvgpr_write_b32 a139, v51
    v_accvgpr_read_b32 v48, a152
    v_accvgpr_read_b32 v49, a153
    v_accvgpr_read_b32 v50, a154
    v_accvgpr_read_b32 v51, a155
    v_mul_f32 v48, v48, v57
    v_mul_f32 v49, v49, v57
    v_mul_f32 v50, v50, v57
    v_mul_f32 v51, v51, v57
    v_accvgpr_write_b32 a152, v48
    v_accvgpr_write_b32 a153, v49
    v_accvgpr_write_b32 a154, v50
    v_accvgpr_write_b32 a155, v51
    v_accvgpr_read_b32 v48, a168
    v_accvgpr_read_b32 v49, a169
    v_accvgpr_read_b32 v50, a170
    v_accvgpr_read_b32 v51, a171
    v_mul_f32 v48, v48, v57
    v_mul_f32 v49, v49, v57
    v_mul_f32 v50, v50, v57
    v_mul_f32 v51, v51, v57
    v_accvgpr_write_b32 a168, v48
    v_accvgpr_write_b32 a169, v49
    v_accvgpr_write_b32 a170, v50
    v_accvgpr_write_b32 a171, v51
    v_accvgpr_read_b32 v48, a184
    v_accvgpr_read_b32 v49, a185
    v_accvgpr_read_b32 v50, a186
    v_accvgpr_read_b32 v51, a187
    v_mul_f32 v48, v48, v57
    v_mul_f32 v49, v49, v57
    v_mul_f32 v50, v50, v57
    v_mul_f32 v51, v51, v57
    v_accvgpr_write_b32 a184, v48
    v_accvgpr_write_b32 a185, v49
    v_accvgpr_write_b32 a186, v50
    v_accvgpr_write_b32 a187, v51
    v_exp_f32 v48, v84
    v_exp_f32 v49, v85
    v_exp_f32 v50, v86
    v_exp_f32 v51, v87
    v_exp_f32 v52, v116
    v_exp_f32 v53, v117
    v_exp_f32 v54, v118
    v_exp_f32 v55, v119
    s_nop 0
    v_cvt_pk_bf16_f32 v212, v48, v49
    v_cvt_pk_bf16_f32 v213, v50, v51
    v_cvt_pk_bf16_f32 v214, v52, v53
    v_cvt_pk_bf16_f32 v215, v54, v55
    v_add_f32 v26, v48, v49
    v_add_f32 v26, v26, v50
    v_add_f32 v26, v26, v51
    v_add_f32 v26, v26, v52
    v_add_f32 v26, v26, v53
    v_add_f32 v26, v26, v54
    v_add_f32 v26, v26, v55
    v_max3_f32 v56, v92, v93, v94
    v_max3_f32 v56, v56, v95, v124
    v_max3_f32 v56, v56, v125, v126
    v_max3_f32 v56, v56, v127, 0
    v_mov_b32 v58, v56
    s_nop 1
    v_permlane16_swap_b32 v56, v58
    s_nop 1
    v_max_f32 v56, v56, v58
    v_mov_b32 v58, v56
    s_nop 1
    v_permlane32_swap_b32 v56, v58
    s_nop 1
    v_max_f32 v56, v56, v58
    v_exp_f32 v57, -v56
    v_sub_f32 v44, v44, v56
    v_sub_f32 v45, v45, v56
    v_sub_f32 v46, v46, v56
    v_sub_f32 v47, v47, v56
    v_mul_f32 v23, v23, v57
    v_sub_f32 v92, v92, v56
    v_sub_f32 v93, v93, v56
    v_sub_f32 v94, v94, v56
    v_sub_f32 v95, v95, v56
    v_sub_f32 v124, v124, v56
    v_sub_f32 v125, v125, v56
    v_sub_f32 v126, v126, v56
    v_sub_f32 v127, v127, v56
    v_sub_f32 v156, v156, v56
    v_sub_f32 v157, v157, v56
    v_sub_f32 v158, v158, v56
    v_sub_f32 v159, v159, v56
    v_sub_f32 v188, v188, v56
    v_sub_f32 v189, v189, v56
    v_sub_f32 v190, v190, v56
    v_sub_f32 v191, v191, v56
    v_accvgpr_read_b32 v48, a12
    v_accvgpr_read_b32 v49, a13
    v_accvgpr_read_b32 v50, a14
    v_accvgpr_read_b32 v51, a15
    v_mul_f32 v48, v48, v57
    v_mul_f32 v49, v49, v57
    v_mul_f32 v50, v50, v57
    v_mul_f32 v51, v51, v57
    v_accvgpr_write_b32 a12, v48
    v_accvgpr_write_b32 a13, v49
    v_accvgpr_write_b32 a14, v50
    v_accvgpr_write_b32 a15, v51
    v_accvgpr_read_b32 v48, a28
    v_accvgpr_read_b32 v49, a29
    v_accvgpr_read_b32 v50, a30
    v_accvgpr_read_b32 v51, a31
    v_mul_f32 v48, v48, v57
    v_mul_f32 v49, v49, v57
    v_mul_f32 v50, v50, v57
    v_mul_f32 v51, v51, v57
    v_accvgpr_write_b32 a28, v48
    v_accvgpr_write_b32 a29, v49
    v_accvgpr_write_b32 a30, v50
    v_accvgpr_write_b32 a31, v51
    v_accvgpr_read_b32 v48, a44
    v_accvgpr_read_b32 v49, a45
    v_accvgpr_read_b32 v50, a46
    v_accvgpr_read_b32 v51, a47
    v_mul_f32 v48, v48, v57
    v_mul_f32 v49, v49, v57
    v_mul_f32 v50, v50, v57
    v_mul_f32 v51, v51, v57
    v_accvgpr_write_b32 a44, v48
    v_accvgpr_write_b32 a45, v49
    v_accvgpr_write_b32 a46, v50
    v_accvgpr_write_b32 a47, v51
    v_accvgpr_read_b32 v48, a60
    v_accvgpr_read_b32 v49, a61
    v_accvgpr_read_b32 v50, a62
    v_accvgpr_read_b32 v51, a63
    v_mul_f32 v48, v48, v57
    v_mul_f32 v49, v49, v57
    v_mul_f32 v50, v50, v57
    v_mul_f32 v51, v51, v57
    v_accvgpr_write_b32 a60, v48
    v_accvgpr_write_b32 a61, v49
    v_accvgpr_write_b32 a62, v50
    v_accvgpr_write_b32 a63, v51
    v_accvgpr_read_b32 v48, a76
    v_accvgpr_read_b32 v49, a77
    v_accvgpr_read_b32 v50, a78
    v_accvgpr_read_b32 v51, a79
    v_mul_f32 v48, v48, v57
    v_mul_f32 v49, v49, v57
    v_mul_f32 v50, v50, v57
    v_mul_f32 v51, v51, v57
    v_accvgpr_write_b32 a76, v48
    v_accvgpr_write_b32 a77, v49
    v_accvgpr_write_b32 a78, v50
    v_accvgpr_write_b32 a79, v51
    v_accvgpr_read_b32 v48, a92
    v_accvgpr_read_b32 v49, a93
    v_accvgpr_read_b32 v50, a94
    v_accvgpr_read_b32 v51, a95
    v_mul_f32 v48, v48, v57
    v_mul_f32 v49, v49, v57
    v_mul_f32 v50, v50, v57
    v_mul_f32 v51, v51, v57
    v_accvgpr_write_b32 a92, v48
    v_accvgpr_write_b32 a93, v49
    v_accvgpr_write_b32 a94, v50
    v_accvgpr_write_b32 a95, v51
    v_accvgpr_read_b32 v48, a108
    v_accvgpr_read_b32 v49, a109
    v_accvgpr_read_b32 v50, a110
    v_accvgpr_read_b32 v51, a111
    v_mul_f32 v48, v48, v57
    v_mul_f32 v49, v49, v57
    v_mul_f32 v50, v50, v57
    v_mul_f32 v51, v51, v57
    v_accvgpr_write_b32 a108, v48
    v_accvgpr_write_b32 a109, v49
    v_accvgpr_write_b32 a110, v50
    v_accvgpr_write_b32 a111, v51
    v_accvgpr_read_b32 v48, a124
    v_accvgpr_read_b32 v49, a125
    v_accvgpr_read_b32 v50, a126
    v_accvgpr_read_b32 v51, a127
    v_mul_f32 v48, v48, v57
    v_mul_f32 v49, v49, v57
    v_mul_f32 v50, v50, v57
    v_mul_f32 v51, v51, v57
    v_accvgpr_write_b32 a124, v48
    v_accvgpr_write_b32 a125, v49
    v_accvgpr_write_b32 a126, v50
    v_accvgpr_write_b32 a127, v51
    v_accvgpr_read_b32 v48, a140
    v_accvgpr_read_b32 v49, a141
    v_accvgpr_read_b32 v50, a142
    v_accvgpr_read_b32 v51, a143
    v_mul_f32 v48, v48, v57
    v_mul_f32 v49, v49, v57
    v_mul_f32 v50, v50, v57
    v_mul_f32 v51, v51, v57
    v_accvgpr_write_b32 a140, v48
    v_accvgpr_write_b32 a141, v49
    v_accvgpr_write_b32 a142, v50
    v_accvgpr_write_b32 a143, v51
    v_accvgpr_read_b32 v48, a156
    v_accvgpr_read_b32 v49, a157
    v_accvgpr_read_b32 v50, a158
    v_accvgpr_read_b32 v51, a159
    v_mul_f32 v48, v48, v57
    v_mul_f32 v49, v49, v57
    v_mul_f32 v50, v50, v57
    v_mul_f32 v51, v51, v57
    v_accvgpr_write_b32 a156, v48
    v_accvgpr_write_b32 a157, v49
    v_accvgpr_write_b32 a158, v50
    v_accvgpr_write_b32 a159, v51
    v_accvgpr_read_b32 v48, a172
    v_accvgpr_read_b32 v49, a173
    v_accvgpr_read_b32 v50, a174
    v_accvgpr_read_b32 v51, a175
    v_mul_f32 v48, v48, v57
    v_mul_f32 v49, v49, v57
    v_mul_f32 v50, v50, v57
    v_mul_f32 v51, v51, v57
    v_accvgpr_write_b32 a172, v48
    v_accvgpr_write_b32 a173, v49
    v_accvgpr_write_b32 a174, v50
    v_accvgpr_write_b32 a175, v51
    v_accvgpr_read_b32 v48, a188
    v_accvgpr_read_b32 v49, a189
    v_accvgpr_read_b32 v50, a190
    v_accvgpr_read_b32 v51, a191
    v_mul_f32 v48, v48, v57
    v_mul_f32 v49, v49, v57
    v_mul_f32 v50, v50, v57
    v_mul_f32 v51, v51, v57
    v_accvgpr_write_b32 a188, v48
    v_accvgpr_write_b32 a189, v49
    v_accvgpr_write_b32 a190, v50
    v_accvgpr_write_b32 a191, v51
    v_exp_f32 v48, v92
    v_exp_f32 v49, v93
    v_exp_f32 v50, v94
    v_exp_f32 v51, v95
    v_exp_f32 v52, v124
    v_exp_f32 v53, v125
    v_exp_f32 v54, v126
    v_exp_f32 v55, v127
    s_nop 0
    v_cvt_pk_bf16_f32 v220, v48, v49
    v_cvt_pk_bf16_f32 v221, v50, v51
    v_cvt_pk_bf16_f32 v222, v52, v53
    v_cvt_pk_bf16_f32 v223, v54, v55
    v_add_f32 v27, v48, v49
    v_add_f32 v27, v27, v50
    v_add_f32 v27, v27, v51
    v_add_f32 v27, v27, v52
    v_add_f32 v27, v27, v53
    v_add_f32 v27, v27, v54
    v_add_f32 v27, v27, v55
    s_nop 1
    s_branch rare_b_ret
rare_e:
    s_nop 7
    s_nop 7
    v_max3_f32 v56, v132, v133, v134
    v_max3_f32 v56, v56, v135, v164
    v_max3_f32 v56, v56, v165, v166
    v_max3_f32 v56, v56, v167, 0
    v_mov_b32 v58, v56
    s_nop 1
    v_permlane16_swap_b32 v56, v58
    s_nop 1
    v_max_f32 v56, v56, v58
    v_mov_b32 v58, v56
    s_nop 1
    v_permlane32_swap_b32 v56, v58
    s_nop 1
    v_max_f32 v56, v56, v58
    v_exp_f32 v57, -v56
    v_sub_f32 v32, v32, v56
    v_sub_f32 v33, v33, v56
    v_sub_f32 v34, v34, v56
    v_sub_f32 v35, v35, v56
    v_mul_f32 v20, v20, v57
    v_sub_f32 v132, v132, v56
    v_sub_f32 v133, v133, v56
    v_sub_f32 v134, v134, v56
    v_sub_f32 v135, v135, v56
    v_sub_f32 v164, v164, v56
    v_sub_f32 v165, v165, v56
    v_sub_f32 v166, v166, v56
    v_sub_f32 v167, v167, v56
    v_accvgpr_read_b32 v48, a0
    v_accvgpr_read_b32 v49, a1
    v_accvgpr_read_b32 v50, a2
    v_accvgpr_read_b32 v51, a3
    v_mul_f32 v48, v48, v57
    v_mul_f32 v49, v49, v57
    v_mul_f32 v50, v50, v57
    v_mul_f32 v51, v51, v57
    v_accvgpr_write_b32 a0, v48
    v_accvgpr_write_b32 a1, v49
    v_accvgpr_write_b32 a2, v50
    v_accvgpr_write_b32 a3, v51
    v_accvgpr_read_b32 v48, a16
    v_accvgpr_read_b32 v49, a17
    v_accvgpr_read_b32 v50, a18
    v_accvgpr_read_b32 v51, a19
    v_mul_f32 v48, v48, v57
    v_mul_f32 v49, v49, v57
    v_mul_f32 v50, v50, v57
    v_mul_f32 v51, v51, v57
    v_accvgpr_write_b32 a16, v48
    v_accvgpr_write_b32 a17, v49
    v_accvgpr_write_b32 a18, v50
    v_accvgpr_write_b32 a19, v51
    v_accvgpr_read_b32 v48, a32
    v_accvgpr_read_b32 v49, a33
    v_accvgpr_read_b32 v50, a34
    v_accvgpr_read_b32 v51, a35
    v_mul_f32 v48, v48, v57
    v_mul_f32 v49, v49, v57
    v_mul_f32 v50, v50, v57
    v_mul_f32 v51, v51, v57
    v_accvgpr_write_b32 a32, v48
    v_accvgpr_write_b32 a33, v49
    v_accvgpr_write_b32 a34, v50
    v_accvgpr_write_b32 a35, v51
    v_accvgpr_read_b32 v48, a48
    v_accvgpr_read_b32 v49, a49
    v_accvgpr_read_b32 v50, a50
    v_accvgpr_read_b32 v51, a51
    v_mul_f32 v48, v48, v57
    v_mul_f32 v49, v49, v57
    v_mul_f32 v50, v50, v57
    v_mul_f32 v51, v51, v57
    v_accvgpr_write_b32 a48, v48
    v_accvgpr_write_b32 a49, v49
    v_accvgpr_write_b32 a50, v50
    v_accvgpr_write_b32 a51, v51
    v_accvgpr_read_b32 v48, a64
    v_accvgpr_read_b32 v49, a65
    v_accvgpr_read_b32 v50, a66
    v_accvgpr_read_b32 v51, a67
    v_mul_f32 v48, v48, v57
    v_mul_f32 v49, v49, v57
    v_mul_f32 v50, v50, v57
    v_mul_f32 v51, v51, v57
    v_accvgpr_write_b32 a64, v48
    v_accvgpr_write_b32 a65, v49
    v_accvgpr_write_b32 a66, v50
    v_accvgpr_write_b32 a67, v51
    v_accvgpr_read_b32 v48, a80
    v_accvgpr_read_b32 v49, a81
    v_accvgpr_read_b32 v50, a82
    v_accvgpr_read_b32 v51, a83
    v_mul_f32 v48, v48, v57
    v_mul_f32 v49, v49, v57
    v_mul_f32 v50, v50, v57
    v_mul_f32 v51, v51, v57
    v_accvgpr_write_b32 a80, v48
    v_accvgpr_write_b32 a81, v49
    v_accvgpr_write_b32 a82, v50
    v_accvgpr_write_b32 a83, v51
    v_accvgpr_read_b32 v48, a96
    v_accvgpr_read_b32 v49, a97
    v_accvgpr_read_b32 v50, a98
    v_accvgpr_read_b32 v51, a99
    v_mul_f32 v48, v48, v57
    v_mul_f32 v49, v49, v57
    v_mul_f32 v50, v50, v57
    v_mul_f32 v51, v51, v57
    v_accvgpr_write_b32 a96, v48
    v_accvgpr_write_b32 a97, v49
    v_accvgpr_write_b32 a98, v50
    v_accvgpr_write_b32 a99, v51
    v_accvgpr_read_b32 v48, a112
    v_accvgpr_read_b32 v49, a113
    v_accvgpr_read_b32 v50, a114
    v_accvgpr_read_b32 v51, a115
    v_mul_f32 v48, v48, v57
    v_mul_f32 v49, v49, v57
    v_mul_f32 v50, v50, v57
    v_mul_f32 v51, v51, v57
    v_accvgpr_write_b32 a112, v48
    v_accvgpr_write_b32 a113, v49
    v_accvgpr_write_b32 a114, v50
    v_accvgpr_write_b32 a115, v51
    v_accvgpr_read_b32 v48, a128
    v_accvgpr_read_b32 v49, a129
    v_accvgpr_read_b32 v50, a130
    v_accvgpr_read_b32 v51, a131
    v_mul_f32 v48, v48, v57
    v_mul_f32 v49, v49, v57
    v_mul_f32 v50, v50, v57
    v_mul_f32 v51, v51, v57
    v_accvgpr_write_b32 a128, v48
    v_accvgpr_write_b32 a129, v49
    v_accvgpr_write_b32 a130, v50
    v_accvgpr_write_b32 a131, v51
    v_accvgpr_read_b32 v48, a144
    v_accvgpr_read_b32 v49, a145
    v_accvgpr_read_b32 v50, a146
    v_accvgpr_read_b32 v51, a147
    v_mul_f32 v48, v48, v57
    v_mul_f32 v49, v49, v57
    v_mul_f32 v50, v50, v57
    v_mul_f32 v51, v51, v57
    v_accvgpr_write_b32 a144, v48
    v_accvgpr_write_b32 a145, v49
    v_accvgpr_write_b32 a146, v50
    v_accvgpr_write_b32 a147, v51
    v_accvgpr_read_b32 v48, a160
    v_accvgpr_read_b32 v49, a161
    v_accvgpr_read_b32 v50, a162
    v_accvgpr_read_b32 v51, a163
    v_mul_f32 v48, v48, v57
    v_mul_f32 v49, v49, v57
    v_mul_f32 v50, v50, v57
    v_mul_f32 v51, v51, v57
    v_accvgpr_write_b32 a160, v48
    v_accvgpr_write_b32 a161, v49
    v_accvgpr_write_b32 a162, v50
    v_accvgpr_write_b32 a163, v51
    v_accvgpr_read_b32 v48, a176
    v_accvgpr_read_b32 v49, a177
    v_accvgpr_read_b32 v50, a178
    v_accvgpr_read_b32 v51, a179
    v_mul_f32 v48, v48, v57
    v_mul_f32 v49, v49, v57
    v_mul_f32 v50, v50, v57
    v_mul_f32 v51, v51, v57
    v_accvgpr_write_b32 a176, v48
    v_accvgpr_write_b32 a177, v49
    v_accvgpr_write_b32 a178, v50
    v_accvgpr_write_b32 a179, v51
    v_exp_f32 v48, v132
    v_exp_f32 v49, v133
    v_exp_f32 v50, v134
    v_exp_f32 v51, v135
    v_exp_f32 v52, v164
    v_exp_f32 v53, v165
    v_exp_f32 v54, v166
    v_exp_f32 v55, v167
    s_nop 0
    v_cvt_pk_bf16_f32 v228, v48, v49
    v_cvt_pk_bf16_f32 v229, v50, v51
    v_cvt_pk_bf16_f32 v230, v52, v53
    v_cvt_pk_bf16_f32 v231, v54, v55
    v_add_f32 v24, v48, v49
    v_add_f32 v24, v24, v50
    v_add_f32 v24, v24, v51
    v_add_f32 v24, v24, v52
    v_add_f32 v24, v24, v53
    v_add_f32 v24, v24, v54
    v_add_f32 v24, v24, v55
    v_max3_f32 v56, v140, v141, v142
    v_max3_f32 v56, v56, v143, v172
    v_max3_f32 v56, v56, v173, v174
    v_max3_f32 v56, v56, v175, 0
    v_mov_b32 v58, v56
    s_nop 1
    v_permlane16_swap_b32 v56, v58
    s_nop 1
    v_max_f32 v56, v56, v58
    v_mov_b32 v58, v56
    s_nop 1
    v_permlane32_swap_b32 v56, v58
    s_nop 1
    v_max_f32 v56, v56, v58
    v_exp_f32 v57, -v56
    v_sub_f32 v36, v36, v56
    v_sub_f32 v37, v37, v56
    v_sub_f32 v38, v38, v56
    v_sub_f32 v39, v39, v56
    v_mul_f32 v21, v21, v57
    v_sub_f32 v140, v140, v56
    v_sub_f32 v141, v141, v56
    v_sub_f32 v142, v142, v56
    v_sub_f32 v143, v143, v56
    v_sub_f32 v172, v172, v56
    v_sub_f32 v173, v173, v56
    v_sub_f32 v174, v174, v56
    v_sub_f32 v175, v175, v56
    v_accvgpr_read_b32 v48, a4
    v_accvgpr_read_b32 v49, a5
    v_accvgpr_read_b32 v50, a6
    v_accvgpr_read_b32 v51, a7
    v_mul_f32 v48, v48, v57
    v_mul_f32 v49, v49, v57
    v_mul_f32 v50, v50, v57
    v_mul_f32 v51, v51, v57
    v_accvgpr_write_b32 a4, v48
    v_accvgpr_write_b32 a5, v49
    v_accvgpr_write_b32 a6, v50
    v_accvgpr_write_b32 a7, v51
    v_accvgpr_read_b32 v48, a20
    v_accvgpr_read_b32 v49, a21
    v_accvgpr_read_b32 v50, a22
    v_accvgpr_read_b32 v51, a23
    v_mul_f32 v48, v48, v57
    v_mul_f32 v49, v49, v57
    v_mul_f32 v50, v50, v57
    v_mul_f32 v51, v51, v57
    v_accvgpr_write_b32 a20, v48
    v_accvgpr_write_b32 a21, v49
    v_accvgpr_write_b32 a22, v50
    v_accvgpr_write_b32 a23, v51
    v_accvgpr_read_b32 v48, a36
    v_accvgpr_read_b32 v49, a37
    v_accvgpr_read_b32 v50, a38
    v_accvgpr_read_b32 v51, a39
    v_mul_f32 v48, v48, v57
    v_mul_f32 v49, v49, v57
    v_mul_f32 v50, v50, v57
    v_mul_f32 v51, v51, v57
    v_accvgpr_write_b32 a36, v48
    v_accvgpr_write_b32 a37, v49
    v_accvgpr_write_b32 a38, v50
    v_accvgpr_write_b32 a39, v51
    v_accvgpr_read_b32 v48, a52
    v_accvgpr_read_b32 v49, a53
    v_accvgpr_read_b32 v50, a54
    v_accvgpr_read_b32 v51, a55
    v_mul_f32 v48, v48, v57
    v_mul_f32 v49, v49, v57
    v_mul_f32 v50, v50, v57
    v_mul_f32 v51, v51, v57
    v_accvgpr_write_b32 a52, v48
    v_accvgpr_write_b32 a53, v49
    v_accvgpr_write_b32 a54, v50
    v_accvgpr_write_b32 a55, v51
    v_accvgpr_read_b32 v48, a68
    v_accvgpr_read_b32 v49, a69
    v_accvgpr_read_b32 v50, a70
    v_accvgpr_read_b32 v51, a71
    v_mul_f32 v48, v48, v57
    v_mul_f32 v49, v49, v57
    v_mul_f32 v50, v50, v57
    v_mul_f32 v51, v51, v57
    v_accvgpr_write_b32 a68, v48
    v_accvgpr_write_b32 a69, v49
    v_accvgpr_write_b32 a70, v50
    v_accvgpr_write_b32 a71, v51
    v_accvgpr_read_b32 v48, a84
    v_accvgpr_read_b32 v49, a85
    v_accvgpr_read_b32 v50, a86
    v_accvgpr_read_b32 v51, a87
    v_mul_f32 v48, v48, v57
    v_mul_f32 v49, v49, v57
    v_mul_f32 v50, v50, v57
    v_mul_f32 v51, v51, v57
    v_accvgpr_write_b32 a84, v48
    v_accvgpr_write_b32 a85, v49
    v_accvgpr_write_b32 a86, v50
    v_accvgpr_write_b32 a87, v51
    v_accvgpr_read_b32 v48, a100
    v_accvgpr_read_b32 v49, a101
    v_accvgpr_read_b32 v50, a102
    v_accvgpr_read_b32 v51, a103
    v_mul_f32 v48, v48, v57
    v_mul_f32 v49, v49, v57
    v_mul_f32 v50, v50, v57
    v_mul_f32 v51, v51, v57
    v_accvgpr_write_b32 a100, v48
    v_accvgpr_write_b32 a101, v49
    v_accvgpr_write_b32 a102, v50
    v_accvgpr_write_b32 a103, v51
    v_accvgpr_read_b32 v48, a116
    v_accvgpr_read_b32 v49, a117
    v_accvgpr_read_b32 v50, a118
    v_accvgpr_read_b32 v51, a119
    v_mul_f32 v48, v48, v57
    v_mul_f32 v49, v49, v57
    v_mul_f32 v50, v50, v57
    v_mul_f32 v51, v51, v57
    v_accvgpr_write_b32 a116, v48
    v_accvgpr_write_b32 a117, v49
    v_accvgpr_write_b32 a118, v50
    v_accvgpr_write_b32 a119, v51
    v_accvgpr_read_b32 v48, a132
    v_accvgpr_read_b32 v49, a133
    v_accvgpr_read_b32 v50, a134
    v_accvgpr_read_b32 v51, a135
    v_mul_f32 v48, v48, v57
    v_mul_f32 v49, v49, v57
    v_mul_f32 v50, v50, v57
    v_mul_f32 v51, v51, v57
    v_accvgpr_write_b32 a132, v48
    v_accvgpr_write_b32 a133, v49
    v_accvgpr_write_b32 a134, v50
    v_accvgpr_write_b32 a135, v51
    v_accvgpr_read_b32 v48, a148
    v_accvgpr_read_b32 v49, a149
    v_accvgpr_read_b32 v50, a150
    v_accvgpr_read_b32 v51, a151
    v_mul_f32 v48, v48, v57
    v_mul_f32 v49, v49, v57
    v_mul_f32 v50, v50, v57
    v_mul_f32 v51, v51, v57
    v_accvgpr_write_b32 a148, v48
    v_accvgpr_write_b32 a149, v49
    v_accvgpr_write_b32 a150, v50
    v_accvgpr_write_b32 a151, v51
    v_accvgpr_read_b32 v48, a164
    v_accvgpr_read_b32 v49, a165
    v_accvgpr_read_b32 v50, a166
    v_accvgpr_read_b32 v51, a167
    v_mul_f32 v48, v48, v57
    v_mul_f32 v49, v49, v57
    v_mul_f32 v50, v50, v57
    v_mul_f32 v51, v51, v57
    v_accvgpr_write_b32 a164, v48
    v_accvgpr_write_b32 a165, v49
    v_accvgpr_write_b32 a166, v50
    v_accvgpr_write_b32 a167, v51
    v_accvgpr_read_b32 v48, a180
    v_accvgpr_read_b32 v49, a181
    v_accvgpr_read_b32 v50, a182
    v_accvgpr_read_b32 v51, a183
    v_mul_f32 v48, v48, v57
    v_mul_f32 v49, v49, v57
    v_mul_f32 v50, v50, v57
    v_mul_f32 v51, v51, v57
    v_accvgpr_write_b32 a180, v48
    v_accvgpr_write_b32 a181, v49
    v_accvgpr_write_b32 a182, v50
    v_accvgpr_write_b32 a183, v51
    v_exp_f32 v48, v140
    v_exp_f32 v49, v141
    v_exp_f32 v50, v142
    v_exp_f32 v51, v143
    v_exp_f32 v52, v172
    v_exp_f32 v53, v173
    v_exp_f32 v54, v174
    v_exp_f32 v55, v175
    s_nop 0
    v_cvt_pk_bf16_f32 v236, v48, v49
    v_cvt_pk_bf16_f32 v237, v50, v51
    v_cvt_pk_bf16_f32 v238, v52, v53
    v_cvt_pk_bf16_f32 v239, v54, v55
    v_add_f32 v25, v48, v49
    v_add_f32 v25, v25, v50
    v_add_f32 v25, v25, v51
    v_add_f32 v25, v25, v52
    v_add_f32 v25, v25, v53
    v_add_f32 v25, v25, v54
    v_add_f32 v25, v25, v55
    v_max3_f32 v56, v148, v149, v150
    v_max3_f32 v56, v56, v151, v180
    v_max3_f32 v56, v56, v181, v182
    v_max3_f32 v56, v56, v183, 0
    v_mov_b32 v58, v56
    s_nop 1
    v_permlane16_swap_b32 v56, v58
    s_nop 1
    v_max_f32 v56, v56, v58
    v_mov_b32 v58, v56
    s_nop 1
    v_permlane32_swap_b32 v56, v58
    s_nop 1
    v_max_f32 v56, v56, v58
    v_exp_f32 v57, -v56
    v_sub_f32 v40, v40, v56
    v_sub_f32 v41, v41, v56
    v_sub_f32 v42, v42, v56
    v_sub_f32 v43, v43, v56
    v_mul_f32 v22, v22, v57
    v_sub_f32 v148, v148, v56
    v_sub_f32 v149, v149, v56
    v_sub_f32 v150, v150, v56
    v_sub_f32 v151, v151, v56
    v_sub_f32 v180, v180, v56
    v_sub_f32 v181, v181, v56
    v_sub_f32 v182, v182, v56
    v_sub_f32 v183, v183, v56
    v_accvgpr_read_b32 v48, a8
    v_accvgpr_read_b32 v49, a9
    v_accvgpr_read_b32 v50, a10
    v_accvgpr_read_b32 v51, a11
    v_mul_f32 v48, v48, v57
    v_mul_f32 v49, v49, v57
    v_mul_f32 v50, v50, v57
    v_mul_f32 v51, v51, v57
    v_accvgpr_write_b32 a8, v48
    v_accvgpr_write_b32 a9, v49
    v_accvgpr_write_b32 a10, v50
    v_accvgpr_write_b32 a11, v51
    v_accvgpr_read_b32 v48, a24
    v_accvgpr_read_b32 v49, a25
    v_accvgpr_read_b32 v50, a26
    v_accvgpr_read_b32 v51, a27
    v_mul_f32 v48, v48, v57
    v_mul_f32 v49, v49, v57
    v_mul_f32 v50, v50, v57
    v_mul_f32 v51, v51, v57
    v_accvgpr_write_b32 a24, v48
    v_accvgpr_write_b32 a25, v49
    v_accvgpr_write_b32 a26, v50
    v_accvgpr_write_b32 a27, v51
    v_accvgpr_read_b32 v48, a40
    v_accvgpr_read_b32 v49, a41
    v_accvgpr_read_b32 v50, a42
    v_accvgpr_read_b32 v51, a43
    v_mul_f32 v48, v48, v57
    v_mul_f32 v49, v49, v57
    v_mul_f32 v50, v50, v57
    v_mul_f32 v51, v51, v57
    v_accvgpr_write_b32 a40, v48
    v_accvgpr_write_b32 a41, v49
    v_accvgpr_write_b32 a42, v50
    v_accvgpr_write_b32 a43, v51
    v_accvgpr_read_b32 v48, a56
    v_accvgpr_read_b32 v49, a57
    v_accvgpr_read_b32 v50, a58
    v_accvgpr_read_b32 v51, a59
    v_mul_f32 v48, v48, v57
    v_mul_f32 v49, v49, v57
    v_mul_f32 v50, v50, v57
    v_mul_f32 v51, v51, v57
    v_accvgpr_write_b32 a56, v48
    v_accvgpr_write_b32 a57, v49
    v_accvgpr_write_b32 a58, v50
    v_accvgpr_write_b32 a59, v51
    v_accvgpr_read_b32 v48, a72
    v_accvgpr_read_b32 v49, a73
    v_accvgpr_read_b32 v50, a74
    v_accvgpr_read_b32 v51, a75
    v_mul_f32 v48, v48, v57
    v_mul_f32 v49, v49, v57
    v_mul_f32 v50, v50, v57
    v_mul_f32 v51, v51, v57
    v_accvgpr_write_b32 a72, v48
    v_accvgpr_write_b32 a73, v49
    v_accvgpr_write_b32 a74, v50
    v_accvgpr_write_b32 a75, v51
    v_accvgpr_read_b32 v48, a88
    v_accvgpr_read_b32 v49, a89
    v_accvgpr_read_b32 v50, a90
    v_accvgpr_read_b32 v51, a91
    v_mul_f32 v48, v48, v57
    v_mul_f32 v49, v49, v57
    v_mul_f32 v50, v50, v57
    v_mul_f32 v51, v51, v57
    v_accvgpr_write_b32 a88, v48
    v_accvgpr_write_b32 a89, v49
    v_accvgpr_write_b32 a90, v50
    v_accvgpr_write_b32 a91, v51
    v_accvgpr_read_b32 v48, a104
    v_accvgpr_read_b32 v49, a105
    v_accvgpr_read_b32 v50, a106
    v_accvgpr_read_b32 v51, a107
    v_mul_f32 v48, v48, v57
    v_mul_f32 v49, v49, v57
    v_mul_f32 v50, v50, v57
    v_mul_f32 v51, v51, v57
    v_accvgpr_write_b32 a104, v48
    v_accvgpr_write_b32 a105, v49
    v_accvgpr_write_b32 a106, v50
    v_accvgpr_write_b32 a107, v51
    v_accvgpr_read_b32 v48, a120
    v_accvgpr_read_b32 v49, a121
    v_accvgpr_read_b32 v50, a122
    v_accvgpr_read_b32 v51, a123
    v_mul_f32 v48, v48, v57
    v_mul_f32 v49, v49, v57
    v_mul_f32 v50, v50, v57
    v_mul_f32 v51, v51, v57
    v_accvgpr_write_b32 a120, v48
    v_accvgpr_write_b32 a121, v49
    v_accvgpr_write_b32 a122, v50
    v_accvgpr_write_b32 a123, v51
    v_accvgpr_read_b32 v48, a136
    v_accvgpr_read_b32 v49, a137
    v_accvgpr_read_b32 v50, a138
    v_accvgpr_read_b32 v51, a139
    v_mul_f32 v48, v48, v57
    v_mul_f32 v49, v49, v57
    v_mul_f32 v50, v50, v57
    v_mul_f32 v51, v51, v57
    v_accvgpr_write_b32 a136, v48
    v_accvgpr_write_b32 a137, v49
    v_accvgpr_write_b32 a138, v50
    v_accvgpr_write_b32 a139, v51
    v_accvgpr_read_b32 v48, a152
    v_accvgpr_read_b32 v49, a153
    v_accvgpr_read_b32 v50, a154
    v_accvgpr_read_b32 v51, a155
    v_mul_f32 v48, v48, v57
    v_mul_f32 v49, v49, v57
    v_mul_f32 v50, v50, v57
    v_mul_f32 v51, v51, v57
    v_accvgpr_write_b32 a152, v48
    v_accvgpr_write_b32 a153, v49
    v_accvgpr_write_b32 a154, v50
    v_accvgpr_write_b32 a155, v51
    v_accvgpr_read_b32 v48, a168
    v_accvgpr_read_b32 v49, a169
    v_accvgpr_read_b32 v50, a170
    v_accvgpr_read_b32 v51, a171
    v_mul_f32 v48, v48, v57
    v_mul_f32 v49, v49, v57
    v_mul_f32 v50, v50, v57
    v_mul_f32 v51, v51, v57
    v_accvgpr_write_b32 a168, v48
    v_accvgpr_write_b32 a169, v49
    v_accvgpr_write_b32 a170, v50
    v_accvgpr_write_b32 a171, v51
    v_accvgpr_read_b32 v48, a184
    v_accvgpr_read_b32 v49, a185
    v_accvgpr_read_b32 v50, a186
    v_accvgpr_read_b32 v51, a187
    v_mul_f32 v48, v48, v57
    v_mul_f32 v49, v49, v57
    v_mul_f32 v50, v50, v57
    v_mul_f32 v51, v51, v57
    v_accvgpr_write_b32 a184, v48
    v_accvgpr_write_b32 a185, v49
    v_accvgpr_write_b32 a186, v50
    v_accvgpr_write_b32 a187, v51
    v_exp_f32 v48, v148
    v_exp_f32 v49, v149
    v_exp_f32 v50, v150
    v_exp_f32 v51, v151
    v_exp_f32 v52, v180
    v_exp_f32 v53, v181
    v_exp_f32 v54, v182
    v_exp_f32 v55, v183
    s_nop 0
    v_cvt_pk_bf16_f32 v244, v48, v49
    v_cvt_pk_bf16_f32 v245, v50, v51
    v_cvt_pk_bf16_f32 v246, v52, v53
    v_cvt_pk_bf16_f32 v247, v54, v55
    v_add_f32 v26, v48, v49
    v_add_f32 v26, v26, v50
    v_add_f32 v26, v26, v51
    v_add_f32 v26, v26, v52
    v_add_f32 v26, v26, v53
    v_add_f32 v26, v26, v54
    v_add_f32 v26, v26, v55
    v_max3_f32 v56, v156, v157, v158
    v_max3_f32 v56, v56, v159, v188
    v_max3_f32 v56, v56, v189, v190
    v_max3_f32 v56, v56, v191, 0
    v_mov_b32 v58, v56
    s_nop 1
    v_permlane16_swap_b32 v56, v58
    s_nop 1
    v_max_f32 v56, v56, v58
    v_mov_b32 v58, v56
    s_nop 1
    v_permlane32_swap_b32 v56, v58
    s_nop 1
    v_max_f32 v56, v56, v58
    v_exp_f32 v57, -v56
    v_sub_f32 v44, v44, v56
    v_sub_f32 v45, v45, v56
    v_sub_f32 v46, v46, v56
    v_sub_f32 v47, v47, v56
    v_mul_f32 v23, v23, v57
    v_sub_f32 v156, v156, v56
    v_sub_f32 v157, v157, v56
    v_sub_f32 v158, v158, v56
    v_sub_f32 v159, v159, v56
    v_sub_f32 v188, v188, v56
    v_sub_f32 v189, v189, v56
    v_sub_f32 v190, v190, v56
    v_sub_f32 v191, v191, v56
    v_accvgpr_read_b32 v48, a12
    v_accvgpr_read_b32 v49, a13
    v_accvgpr_read_b32 v50, a14
    v_accvgpr_read_b32 v51, a15
    v_mul_f32 v48, v48, v57
    v_mul_f32 v49, v49, v57
    v_mul_f32 v50, v50, v57
    v_mul_f32 v51, v51, v57
    v_accvgpr_write_b32 a12, v48
    v_accvgpr_write_b32 a13, v49
    v_accvgpr_write_b32 a14, v50
    v_accvgpr_write_b32 a15, v51
    v_accvgpr_read_b32 v48, a28
    v_accvgpr_read_b32 v49, a29
    v_accvgpr_read_b32 v50, a30
    v_accvgpr_read_b32 v51, a31
    v_mul_f32 v48, v48, v57
    v_mul_f32 v49, v49, v57
    v_mul_f32 v50, v50, v57
    v_mul_f32 v51, v51, v57
    v_accvgpr_write_b32 a28, v48
    v_accvgpr_write_b32 a29, v49
    v_accvgpr_write_b32 a30, v50
    v_accvgpr_write_b32 a31, v51
    v_accvgpr_read_b32 v48, a44
    v_accvgpr_read_b32 v49, a45
    v_accvgpr_read_b32 v50, a46
    v_accvgpr_read_b32 v51, a47
    v_mul_f32 v48, v48, v57
    v_mul_f32 v49, v49, v57
    v_mul_f32 v50, v50, v57
    v_mul_f32 v51, v51, v57
    v_accvgpr_write_b32 a44, v48
    v_accvgpr_write_b32 a45, v49
    v_accvgpr_write_b32 a46, v50
    v_accvgpr_write_b32 a47, v51
    v_accvgpr_read_b32 v48, a60
    v_accvgpr_read_b32 v49, a61
    v_accvgpr_read_b32 v50, a62
    v_accvgpr_read_b32 v51, a63
    v_mul_f32 v48, v48, v57
    v_mul_f32 v49, v49, v57
    v_mul_f32 v50, v50, v57
    v_mul_f32 v51, v51, v57
    v_accvgpr_write_b32 a60, v48
    v_accvgpr_write_b32 a61, v49
    v_accvgpr_write_b32 a62, v50
    v_accvgpr_write_b32 a63, v51
    v_accvgpr_read_b32 v48, a76
    v_accvgpr_read_b32 v49, a77
    v_accvgpr_read_b32 v50, a78
    v_accvgpr_read_b32 v51, a79
    v_mul_f32 v48, v48, v57
    v_mul_f32 v49, v49, v57
    v_mul_f32 v50, v50, v57
    v_mul_f32 v51, v51, v57
    v_accvgpr_write_b32 a76, v48
    v_accvgpr_write_b32 a77, v49
    v_accvgpr_write_b32 a78, v50
    v_accvgpr_write_b32 a79, v51
    v_accvgpr_read_b32 v48, a92
    v_accvgpr_read_b32 v49, a93
    v_accvgpr_read_b32 v50, a94
    v_accvgpr_read_b32 v51, a95
    v_mul_f32 v48, v48, v57
    v_mul_f32 v49, v49, v57
    v_mul_f32 v50, v50, v57
    v_mul_f32 v51, v51, v57
    v_accvgpr_write_b32 a92, v48
    v_accvgpr_write_b32 a93, v49
    v_accvgpr_write_b32 a94, v50
    v_accvgpr_write_b32 a95, v51
    v_accvgpr_read_b32 v48, a108
    v_accvgpr_read_b32 v49, a109
    v_accvgpr_read_b32 v50, a110
    v_accvgpr_read_b32 v51, a111
    v_mul_f32 v48, v48, v57
    v_mul_f32 v49, v49, v57
    v_mul_f32 v50, v50, v57
    v_mul_f32 v51, v51, v57
    v_accvgpr_write_b32 a108, v48
    v_accvgpr_write_b32 a109, v49
    v_accvgpr_write_b32 a110, v50
    v_accvgpr_write_b32 a111, v51
    v_accvgpr_read_b32 v48, a124
    v_accvgpr_read_b32 v49, a125
    v_accvgpr_read_b32 v50, a126
    v_accvgpr_read_b32 v51, a127
    v_mul_f32 v48, v48, v57
    v_mul_f32 v49, v49, v57
    v_mul_f32 v50, v50, v57
    v_mul_f32 v51, v51, v57
    v_accvgpr_write_b32 a124, v48
    v_accvgpr_write_b32 a125, v49
    v_accvgpr_write_b32 a126, v50
    v_accvgpr_write_b32 a127, v51
    v_accvgpr_read_b32 v48, a140
    v_accvgpr_read_b32 v49, a141
    v_accvgpr_read_b32 v50, a142
    v_accvgpr_read_b32 v51, a143
    v_mul_f32 v48, v48, v57
    v_mul_f32 v49, v49, v57
    v_mul_f32 v50, v50, v57
    v_mul_f32 v51, v51, v57
    v_accvgpr_write_b32 a140, v48
    v_accvgpr_write_b32 a141, v49
    v_accvgpr_write_b32 a142, v50
    v_accvgpr_write_b32 a143, v51
    v_accvgpr_read_b32 v48, a156
    v_accvgpr_read_b32 v49, a157
    v_accvgpr_read_b32 v50, a158
    v_accvgpr_read_b32 v51, a159
    v_mul_f32 v48, v48, v57
    v_mul_f32 v49, v49, v57
    v_mul_f32 v50, v50, v57
    v_mul_f32 v51, v51, v57
    v_accvgpr_write_b32 a156, v48
    v_accvgpr_write_b32 a157, v49
    v_accvgpr_write_b32 a158, v50
    v_accvgpr_write_b32 a159, v51
    v_accvgpr_read_b32 v48, a172
    v_accvgpr_read_b32 v49, a173
    v_accvgpr_read_b32 v50, a174
    v_accvgpr_read_b32 v51, a175
    v_mul_f32 v48, v48, v57
    v_mul_f32 v49, v49, v57
    v_mul_f32 v50, v50, v57
    v_mul_f32 v51, v51, v57
    v_accvgpr_write_b32 a172, v48
    v_accvgpr_write_b32 a173, v49
    v_accvgpr_write_b32 a174, v50
    v_accvgpr_write_b32 a175, v51
    v_accvgpr_read_b32 v48, a188
    v_accvgpr_read_b32 v49, a189
    v_accvgpr_read_b32 v50, a190
    v_accvgpr_read_b32 v51, a191
    v_mul_f32 v48, v48, v57
    v_mul_f32 v49, v49, v57
    v_mul_f32 v50, v50, v57
    v_mul_f32 v51, v51, v57
    v_accvgpr_write_b32 a188, v48
    v_accvgpr_write_b32 a189, v49
    v_accvgpr_write_b32 a190, v50
    v_accvgpr_write_b32 a191, v51
    v_exp_f32 v48, v156
    v_exp_f32 v49, v157
    v_exp_f32 v50, v158
    v_exp_f32 v51, v159
    v_exp_f32 v52, v188
    v_exp_f32 v53, v189
    v_exp_f32 v54, v190
    v_exp_f32 v55, v191
    s_nop 0
    v_cvt_pk_bf16_f32 v252, v48, v49
    v_cvt_pk_bf16_f32 v253, v50, v51
    v_cvt_pk_bf16_f32 v254, v52, v53
    v_cvt_pk_bf16_f32 v255, v54, v55
    v_add_f32 v27, v48, v49
    v_add_f32 v27, v27, v50
    v_add_f32 v27, v27, v51
    v_add_f32 v27, v27, v52
    v_add_f32 v27, v27, v53
    v_add_f32 v27, v27, v54
    v_add_f32 v27, v27, v55
    s_nop 1
    s_branch rare_e_ret
.section .rodata,"a"
.p2align 6
.amdhsa_kernel recurrent_scan__sliding_block_cached__moe_arch_mod__prompt_kernel
  .amdhsa_next_free_vgpr 512
  .amdhsa_next_free_sgpr 102
  .amdhsa_accum_offset 256
  .amdhsa_group_segment_fixed_size 0
  .amdhsa_kernarg_size 104
  .amdhsa_user_sgpr_count 2
  .amdhsa_user_sgpr_kernarg_segment_ptr 1
  .amdhsa_system_sgpr_workgroup_id_x 1
  .amdhsa_float_denorm_mode_32 3
.end_amdhsa_kernel
```

```asm
; @launch grid=(256,1,1) block=(256,1,1) lds=163840
.amdgcn_target "amdgcn-amd-amdhsa--gfx950"
.text
.globl recurrent_scan__sliding_block_cached__moe_arch_mod__prompt_kernel
.p2align 8
.type recurrent_scan__sliding_block_cached__moe_arch_mod__prompt_kernel,@function
recurrent_scan__sliding_block_cached__moe_arch_mod__prompt_kernel:
    s_cmp_ge_u32 s2, 256
    s_cbranch_scc1 main_end
    s_load_dwordx16 s[64:79], s[0:1], 0
    s_load_dwordx4 s[80:83], s[0:1], 64
    s_load_dwordx2 s[84:85], s[0:1], 80
    s_load_dwordx2 s[86:87], s[0:1], 96
    s_bfe_u32 s30, s2, 0x20003
    s_lshl_b32 s30, s30, 3
    s_lshr_b32 s30, 0x18183060, s30
    s_and_b32 s30, s30, 0xff
    s_load_dwordx2 s[28:29], s[0:1], s30
    s_bfe_u32 s30, s2, 0x10003
    s_bfe_u32 s31, s2, 0x10005
    s_lshl1_add_u32 s30, s30, s31
    s_lshl_b32 s30, s30, 21
    s_bitcmp1_b32 s2, 3
    s_cselect_b32 s31, 0, 0x300000
    s_bitcmp1_b32 s2, 4
    s_cselect_b32 s30, s30, s31
    s_lshr_b32 s56, s2, 3
    s_lshl_b32 s56, s56, 11
    v_lshrrev_b32 v17, 4, v0
    v_lshlrev_b32 v17, 7, v17
    v_add_u32 v17, s56, v17
    s_getpc_b64 s[88:89]
    global_load_dword a220, v17, s[88:89]
    v_lshrrev_b32 v17, 6, v0
    v_lshlrev_b32 v17, 12, v17
    v_and_b32 v1, 63, v0
    v_lshl_add_u32 v17, v1, 4, v17
    v_and_b32 v1, 63, v0
    v_lshrrev_b32 v29, 6, v0
    v_mov_b32 v16, v0
    v_readfirstlane_b32 s3, v29
    s_and_b32 s53, s2, 7
    s_lshr_b32 s52, s2, 5
    s_bfe_u32 s51, s2, 0x20003
    s_lshl_b32 s50, s53, 2
    s_add_u32 s50, s50, s51
    s_lshl_b32 s60, s2, 3
    s_lshl_b32 s56, s3, 1
    s_add_u32 s60, s60, s56
    v_bfe_u32 v240, v1, 2, 1
    v_add_u32 v240, s60, v240
    v_lshrrev_b32 v241, 3, v1
    v_lshlrev_b32 v241, 6, v241
    v_and_b32 v29, 3, v1
    v_lshl_add_u32 v241, v29, 4, v241
    v_mul_u32_u24 v242, 1280, v240
    v_add_u32 v242, v242, v241
    v_lshrrev_b32 v29, 4, v1
    v_lshlrev_b32 v29, 1, v29
    v_and_b32 v7, 7, v1
    v_xor_b32 v7, v7, v29
    v_lshlrev_b32 v7, 4, v7
    v_lshrrev_b32 v29, 5, v1
    v_lshlrev_b32 v29, 3, v29
    v_bfe_u32 v5, v1, 3, 2
    v_add_u32 v5, v5, v29
    v_mul_u32_u24 v2, 12288, v5
    v_add_u32 v2, v2, v7
    v_add_u32 v3, 196608, v2
    s_lshl_b32 s54, s52, 2
    s_add_u32 s54, s54, s3
    s_mul_i32 s49, s3, 6144
    s_lshr_b32 s59, s3, 1
    s_lshl_b32 s59, s59, 5
    s_and_b32 s56, s3, 1
    s_lshl_b32 s56, s56, 2
    s_add_u32 s59, s59, s56
    s_mul_i32 s36, s59, 12288
    s_mov_b32 s37, 786432
    s_add_u32 s45, s51, s52
    s_and_b32 s45, s45, 3
    s_lshl_b32 s45, s45, 2
    s_lshr_b32 s45, 0x5050, s45
    s_and_b32 s45, s45, 15
    s_mul_i32 s56, s45, 786432
    s_add_u32 s36, s36, s56
    s_lshl_b32 s45, s45, 13
    s_lshr_b32 s56, s2, 3
    s_lshl_b32 s56, s56, 8
    v_add_u32 v22, s56, v16
    s_mov_b32 s56, 357913942
    v_mul_hi_u32 v23, s56, v22
    v_mul_u32_u24 v24, 12, v23
    v_sub_u32 v24, v22, v24
    v_mul_u32_u24 v23, 12288, v23
    v_lshl_add_u32 v23, v24, 7, v23
    s_mul_i32 s40, s51, 384
    s_sub_u32 s40, 1572864, s40
    v_lshlrev_b32 v24, 7, v1
    s_mul_i32 s47, s50, 786432
    s_add_u32 s47, s47, 589824
    s_lshl_b32 s48, s52, 13
    s_mul_i32 s56, s50, 384
    s_sub_u32 s57, 7864320, s56
    s_waitcnt lgkmcnt(0)
k_in:
    s_load_dword s4, s[28:29], s30 offset:1024
    s_mov_b32 s12, s64
    s_and_b32 s13, s65, 0xffff
    s_mov_b32 s14, 2621440
    s_mov_b32 s15, 0x00020000
    s_mov_b32 s16, s76
    s_and_b32 s17, s77, 0xffff
    s_mov_b32 s18, 1280
    s_mov_b32 s19, 0x00020000
    buffer_load_dwordx4 v[64:67], v242, s[12:15], 0 offen
    buffer_load_dwordx4 v[68:71], v242, s[12:15], 0 offen offset:512
    buffer_load_dwordx4 v[72:75], v242, s[12:15], 0 offen offset:1024
    v_mov_b32 v25, 3203072
    global_load_dword v26, v25, s[86:87] sc1
    s_lshr_b32 s44, s2, 3
    s_lshl_b32 s44, s44, 7
    s_add_u32 s44, s44, 4784128
    s_load_dword s92, s[86:87], s44 glc
    s_lshr_b32 s58, s2, 4
    s_lshl_b32 s58, s58, 14
    s_and_b32 s44, s2, 15
    s_lshl_b32 s44, s44, 2
    s_add_u32 s44, s44, s3
    s_lshl_b32 s44, s44, 7
    s_add_u32 s58, s58, s44
    s_add_u32 s58, s58, 4456448
    v_and_b32 v27, 31, v1
    v_lshlrev_b32 v27, 2, v27
    v_lshrrev_b32 v25, 5, v1
    v_lshl_add_u32 v27, v25, 13, v27
    v_add_u32 v27, s58, v27
    v_mov_b32 v25, 0
    global_store_dword v27, v25, s[86:87] sc1
    buffer_load_dwordx4 v[76:79], v241, s[16:19], 0 offen offset:0
    buffer_load_dwordx4 v[80:83], v241, s[16:19], 0 offen offset:512
    buffer_load_dwordx4 v[84:87], v241, s[16:19], 0 offen offset:1024
    s_add_u32 s8, s70, s56
    s_addc_u32 s9, s71, 0
    s_and_b32 s9, s9, 0xffff
    s_mov_b32 s10, s57
    s_mov_b32 s11, 0x00020000
    s_add_u32 m0, s49, 49152
    s_nop 0
    buffer_load_dwordx4 v2, s[8:11], s36 offen offset:0 lds
    s_add_u32 m0, s49, 50048
    s_nop 0
    buffer_load_dwordx4 v2, s[8:11], s36 offen offset:128 lds
    s_add_u32 m0, s49, 50944
    s_nop 0
    buffer_load_dwordx4 v2, s[8:11], s36 offen offset:256 lds
    s_add_u32 m0, s49, 52224
    s_nop 0
    buffer_load_dwordx4 v3, s[8:11], s36 offen offset:0 lds
    s_add_u32 m0, s49, 53120
    s_nop 0
    buffer_load_dwordx4 v3, s[8:11], s36 offen offset:128 lds
    s_add_u32 m0, s49, 54016
    s_nop 0
    buffer_load_dwordx4 v3, s[8:11], s36 offen offset:256 lds
    s_add_u32 s36, s36, s37
    s_sub_u32 s55, s36, 7864320
    s_min_u32 s36, s36, s55
    s_mov_b32 s24, s86
    s_and_b32 s25, s87, 0xffff
    s_mov_b32 s26, 268435456
    s_mov_b32 s27, 0x00020000
    s_lshl_b32 s56, s2, 2
    s_add_u32 s56, s56, s3
    s_cmp_lt_u32 s56, 20
    s_cselect_b32 s57, 0, 0x70000000
    s_add_u32 s57, s57, 3670016
    s_lshl_b32 s56, s56, 10
    s_add_u32 s56, s56, s57
    v_mov_b32 v160, 0
    v_mov_b32 v161, 0
    v_mov_b32 v162, 0
    v_mov_b32 v163, 0
    v_lshlrev_b32 v164, 4, v1
    buffer_store_dwordx4 v[160:163], v164, s[24:27], s56 offen sc1
    v_lshrrev_b32 v243, 6, v240
    v_mul_u32_u24 v243, 81920, v243
    v_bfe_u32 v29, v240, 4, 2
    v_lshl_add_u32 v243, v29, 10, v243
    v_and_b32 v29, 15, v240
    v_lshl_add_u32 v243, v29, 6, v243
    v_lshrrev_b32 v29, 3, v1
    v_lshl_add_u32 v243, v29, 12, v243
    v_and_b32 v29, 3, v1
    v_lshl_add_u32 v243, v29, 4, v243
    s_mov_b32 s38, 0x3acccccd
    s_mov_b32 s39, 0x3727c5ac
    s_mov_b32 s41, 0
    s_mov_b32 s42, 32768
    s_mov_b32 s43, 65536
    v_bfe_u32 v29, v1, 2, 3
    v_lshlrev_b32 v12, 7, v29
    v_lshrrev_b32 v29, 1, v29
    v_xor_b32 v29, 0, v29
    v_lshl_add_u32 v12, v29, 5, v12
    v_and_b32 v29, 3, v1
    v_lshl_add_u32 v12, v29, 3, v12
    v_lshrrev_b32 v29, 5, v1
    v_mul_u32_u24 v29, 3072, v29
    v_add_u32 v12, v12, v29
    v_xor_b32 v13, 32, v12
    v_xor_b32 v14, 64, v12
    v_xor_b32 v15, 96, v12
    v_add_u32 v8, 49152, v12
    v_add_u32 v9, 49152, v13
    v_add_u32 v10, 49152, v14
    v_add_u32 v11, 49152, v15
    v_and_b32 v28, 15, v1
    v_lshlrev_b32 v28, 6, v28
    v_lshrrev_b32 v29, 4, v1
    v_lshl_add_u32 v28, v29, 4, v28
    s_mul_i32 s56, s54, 81920
    s_add_u32 s56, s56, 0
    s_add_u32 s20, s86, s56
    s_addc_u32 s21, s87, 0
    s_and_b32 s21, s21, 0xffff
    s_mov_b32 s22, 81920
    s_mov_b32 s23, 0x00020000
    s_lshl_b32 s46, s54, 7
    s_add_u32 s46, s46, 4784128
    s_mov_b32 s101, 0
    s_bitcmp1_b32 s53, 1
    s_cselect_b32 s56, 0x4000, 0
    s_add_u32 s46, s46, s56
    s_and_b32 s56, s53, 1
    s_lshl_b32 s56, s56, 12
    s_add_u32 s46, s46, s56
    s_load_dword s47, s[86:87], s46 glc
    s_load_dword s48, s[86:87], s46 offset:0x2000 glc
    s_lshr_b32 s6, s2, 3
    s_lshl_b32 s6, s6, 7
    s_lshl_b32 s56, s53, 2
    s_add_u32 s6, s6, s56
    s_add_u32 s6, s6, 4784128
    s_cmp_eq_u32 s3, 0
    s_cselect_b32 s6, s6, 0x70000000
    v_lshlrev_b32 v20, 12, v1
    s_mov_b64 exec, 0
    s_cmp_eq_u32 s3, 0
    s_cbranch_scc1 pg_0
    s_cmp_eq_u32 s3, 1
    s_cbranch_scc1 pg_1
    s_cmp_eq_u32 s3, 2
    s_cbranch_scc1 pg_2
    s_cmp_eq_u32 s3, 3
    s_cbranch_scc1 pg_3
pg_ret:
    s_mov_b64 exec, -1
    s_waitcnt vmcnt(12)
x_in:
    v_lshlrev_b32 v96, 16, v64
    v_and_b32 v97, 0xffff0000, v64
    v_lshlrev_b32 v98, 16, v65
    v_and_b32 v99, 0xffff0000, v65
    v_lshlrev_b32 v100, 16, v66
    v_and_b32 v101, 0xffff0000, v66
    v_lshlrev_b32 v102, 16, v67
    v_and_b32 v103, 0xffff0000, v67
    v_lshlrev_b32 v104, 16, v68
    v_and_b32 v105, 0xffff0000, v68
    v_lshlrev_b32 v106, 16, v69
    v_and_b32 v107, 0xffff0000, v69
    v_lshlrev_b32 v108, 16, v70
    v_and_b32 v109, 0xffff0000, v70
    v_lshlrev_b32 v110, 16, v71
    v_and_b32 v111, 0xffff0000, v71
    v_lshlrev_b32 v112, 16, v72
    v_and_b32 v113, 0xffff0000, v72
    v_lshlrev_b32 v114, 16, v73
    v_and_b32 v115, 0xffff0000, v73
    v_lshlrev_b32 v116, 16, v74
    v_and_b32 v117, 0xffff0000, v74
    v_lshlrev_b32 v118, 16, v75
    v_and_b32 v119, 0xffff0000, v75
    v_pk_add_f32 v[120:121], v[96:97], v[98:99]
    v_pk_add_f32 v[122:123], v[100:101], v[102:103]
    v_pk_add_f32 v[120:121], v[120:121], v[104:105]
    v_pk_add_f32 v[122:123], v[122:123], v[106:107]
    v_pk_add_f32 v[120:121], v[120:121], v[108:109]
    v_pk_add_f32 v[122:123], v[122:123], v[110:111]
    s_mov_b32 exec_hi, 0
    v_pk_add_f32 v[120:121], v[120:121], v[112:113]
    v_pk_add_f32 v[122:123], v[122:123], v[114:115]
    v_pk_add_f32 v[120:121], v[120:121], v[116:117]
    v_pk_add_f32 v[122:123], v[122:123], v[118:119]
    s_mov_b64 exec, -1
    v_pk_add_f32 v[120:121], v[120:121], v[122:123]
    v_add_f32 v120, v120, v121
    s_nop 1
    v_add_f32_dpp v120, v120, v120 quad_perm:[1,0,3,2] row_mask:0xf bank_mask:0xf
    s_nop 1
    v_add_f32_dpp v120, v120, v120 quad_perm:[2,3,0,1] row_mask:0xf bank_mask:0xf
    s_nop 1
    v_add_f32_dpp v120, v120, v120 row_ror:8 row_mask:0xf bank_mask:0xf
    v_mov_b32 v124, v120
    s_nop 1
    v_permlane16_swap_b32 v120, v124
    s_nop 1
    v_add_f32 v120, v120, v124
    v_mov_b32 v124, v120
    s_nop 1
    v_permlane32_swap_b32 v120, v124
    s_nop 1
    v_add_f32 v120, v120, v124
    v_mul_f32 v126, s38, v120
    v_mul_f32 v128, s38, -v120
    v_mul_f32 v129, s38, -v120
    v_pk_add_f32 v[132:133], v[96:97], v[128:129]
    v_pk_mul_f32 v[120:121], v[132:133], v[132:133]
    v_pk_add_f32 v[134:135], v[98:99], v[128:129]
    v_pk_mul_f32 v[122:123], v[134:135], v[134:135]
    v_pk_add_f32 v[136:137], v[100:101], v[128:129]
    v_pk_fma_f32 v[120:121], v[136:137], v[136:137], v[120:121]
    v_pk_add_f32 v[138:139], v[102:103], v[128:129]
    v_pk_fma_f32 v[122:123], v[138:139], v[138:139], v[122:123]
    v_pk_add_f32 v[132:133], v[104:105], v[128:129]
    v_pk_fma_f32 v[120:121], v[132:133], v[132:133], v[120:121]
    v_pk_add_f32 v[134:135], v[106:107], v[128:129]
    v_pk_fma_f32 v[122:123], v[134:135], v[134:135], v[122:123]
    v_pk_add_f32 v[136:137], v[108:109], v[128:129]
    v_pk_fma_f32 v[120:121], v[136:137], v[136:137], v[120:121]
    v_pk_add_f32 v[138:139], v[110:111], v[128:129]
    v_pk_fma_f32 v[122:123], v[138:139], v[138:139], v[122:123]
    s_mov_b32 exec_hi, 0
    v_pk_add_f32 v[132:133], v[112:113], v[128:129]
    v_pk_fma_f32 v[120:121], v[132:133], v[132:133], v[120:121]
    v_pk_add_f32 v[134:135], v[114:115], v[128:129]
    v_pk_fma_f32 v[122:123], v[134:135], v[134:135], v[122:123]
    v_pk_add_f32 v[136:137], v[116:117], v[128:129]
    v_pk_fma_f32 v[120:121], v[136:137], v[136:137], v[120:121]
    v_pk_add_f32 v[138:139], v[118:119], v[128:129]
    v_pk_fma_f32 v[122:123], v[138:139], v[138:139], v[122:123]
    s_mov_b64 exec, -1
    v_pk_add_f32 v[120:121], v[120:121], v[122:123]
    v_add_f32 v120, v120, v121
    s_nop 1
    v_add_f32_dpp v120, v120, v120 quad_perm:[1,0,3,2] row_mask:0xf bank_mask:0xf
    s_nop 1
    v_add_f32_dpp v120, v120, v120 quad_perm:[2,3,0,1] row_mask:0xf bank_mask:0xf
    s_nop 1
    v_add_f32_dpp v120, v120, v120 row_ror:8 row_mask:0xf bank_mask:0xf
    v_mov_b32 v124, v120
    s_nop 1
    v_permlane16_swap_b32 v120, v124
    s_nop 1
    v_add_f32 v120, v120, v124
    v_mov_b32 v124, v120
    s_nop 1
    v_permlane32_swap_b32 v120, v124
    s_nop 1
    v_add_f32 v120, v120, v124
    v_mul_f32 v130, s38, v120
    v_cvt_pk_bf16_f32 v126, v126, v126
    v_and_b32 v126, 0xffff0000, v126
    v_cvt_pk_bf16_f32 v130, v130, v130
    v_and_b32 v130, 0xffff0000, v130
    v_add_f32 v130, s39, v130
    v_cvt_pk_bf16_f32 v130, v130, v130
    v_and_b32 v130, 0xffff0000, v130
    v_sqrt_f32 v130, v130
    v_sub_f32 v128, 0, v126
    v_cvt_pk_bf16_f32 v130, v130, v130
    v_and_b32 v130, 0xffff0000, v130
    v_rcp_f32 v127, v130
    v_sub_f32 v129, 0, v126
    v_mul_f32 v120, 0x3dd53b95, v127
    v_mul_f32 v121, 0x3dd53b95, v127
    v_mov_b32 v130, v127
    v_mov_b32 v131, v127
    v_pk_add_f32 v[96:97], v[96:97], v[128:129]
    v_pk_mul_f32 v[132:133], v[96:97], v[120:121]
    v_cvt_pk_bf16_f32 v144, v132, v133
    v_pk_add_f32 v[98:99], v[98:99], v[128:129]
    v_pk_mul_f32 v[134:135], v[98:99], v[120:121]
    v_cvt_pk_bf16_f32 v145, v134, v135
    v_pk_add_f32 v[100:101], v[100:101], v[128:129]
    v_pk_mul_f32 v[136:137], v[100:101], v[120:121]
    v_cvt_pk_bf16_f32 v146, v136, v137
    v_pk_add_f32 v[102:103], v[102:103], v[128:129]
    v_pk_mul_f32 v[138:139], v[102:103], v[120:121]
    v_cvt_pk_bf16_f32 v147, v138, v139
    buffer_store_dwordx4 v[144:147], v243, s[24:27], s41 offen sc1
    v_pk_add_f32 v[104:105], v[104:105], v[128:129]
    v_pk_mul_f32 v[132:133], v[104:105], v[120:121]
    v_cvt_pk_bf16_f32 v148, v132, v133
    v_pk_add_f32 v[106:107], v[106:107], v[128:129]
    v_pk_mul_f32 v[134:135], v[106:107], v[120:121]
    v_cvt_pk_bf16_f32 v149, v134, v135
    v_pk_add_f32 v[108:109], v[108:109], v[128:129]
    v_pk_mul_f32 v[136:137], v[108:109], v[120:121]
    v_cvt_pk_bf16_f32 v150, v136, v137
    v_pk_add_f32 v[110:111], v[110:111], v[128:129]
    v_pk_mul_f32 v[138:139], v[110:111], v[120:121]
    v_cvt_pk_bf16_f32 v151, v138, v139
    buffer_store_dwordx4 v[148:151], v243, s[24:27], s42 offen sc1
    v_pk_add_f32 v[112:113], v[112:113], v[128:129]
    v_pk_mul_f32 v[132:133], v[112:113], v[120:121]
    v_cvt_pk_bf16_f32 v152, v132, v133
    v_pk_add_f32 v[114:115], v[114:115], v[128:129]
    v_pk_mul_f32 v[134:135], v[114:115], v[120:121]
    v_cvt_pk_bf16_f32 v153, v134, v135
    v_pk_add_f32 v[116:117], v[116:117], v[128:129]
    v_pk_mul_f32 v[136:137], v[116:117], v[120:121]
    v_cvt_pk_bf16_f32 v154, v136, v137
    v_pk_add_f32 v[118:119], v[118:119], v[128:129]
    v_pk_mul_f32 v[138:139], v[118:119], v[120:121]
    v_cvt_pk_bf16_f32 v155, v138, v139
    s_mov_b32 exec_hi, 0
    buffer_store_dwordx4 v[152:155], v243, s[24:27], s43 offen sc1
    s_mov_b64 exec, -1
    s_branch pg_start
    .p2align 12
pg_0:
    s_cbranch_execz pg_ret
pg_start:
    s_waitcnt vmcnt(10)
    v_readfirstlane_b32 s7, v26
    v_cvt_pk_bf16_f32 v64, v96, v97
    v_lshlrev_b32 v96, 16, v64
    v_and_b32 v97, 0xffff0000, v64
    v_pk_mul_f32 v[96:97], v[96:97], v[130:131]
    v_cvt_pk_bf16_f32 v64, v96, v97
    v_lshlrev_b32 v96, 16, v64
    v_and_b32 v97, 0xffff0000, v64
    v_lshlrev_b32 v132, 16, v76
    v_and_b32 v133, 0xffff0000, v76
    v_pk_mul_f32 v[120:121], v[96:97], v[132:133]
    s_add_u32 m0, s49, 73728
    s_nop 0
    buffer_load_dwordx4 v2, s[8:11], s36 offen offset:0 lds
    s_add_u32 m0, s49, 74624
    s_nop 0
    buffer_load_dwordx4 v2, s[8:11], s36 offen offset:128 lds
    v_cvt_pk_bf16_f32 v65, v98, v99
    v_lshlrev_b32 v98, 16, v65
    v_and_b32 v99, 0xffff0000, v65
    v_pk_mul_f32 v[98:99], v[98:99], v[130:131]
    v_cvt_pk_bf16_f32 v65, v98, v99
    v_lshlrev_b32 v98, 16, v65
    v_and_b32 v99, 0xffff0000, v65
    v_lshlrev_b32 v134, 16, v77
    v_and_b32 v135, 0xffff0000, v77
    v_pk_mul_f32 v[122:123], v[98:99], v[134:135]
    s_add_u32 m0, s49, 75520
    s_nop 0
    buffer_load_dwordx4 v2, s[8:11], s36 offen offset:256 lds
    s_add_u32 m0, s49, 76800
    s_nop 0
    buffer_load_dwordx4 v3, s[8:11], s36 offen offset:0 lds
    v_cvt_pk_bf16_f32 v66, v100, v101
    v_lshlrev_b32 v100, 16, v66
    v_and_b32 v101, 0xffff0000, v66
    v_pk_mul_f32 v[100:101], v[100:101], v[130:131]
    v_cvt_pk_bf16_f32 v66, v100, v101
    v_lshlrev_b32 v100, 16, v66
    v_and_b32 v101, 0xffff0000, v66
    v_lshlrev_b32 v136, 16, v78
    v_and_b32 v137, 0xffff0000, v78
    v_pk_fma_f32 v[120:121], v[100:101], v[136:137], v[120:121]
    s_add_u32 m0, s49, 77696
    s_nop 0
    buffer_load_dwordx4 v3, s[8:11], s36 offen offset:128 lds
    s_add_u32 m0, s49, 78592
    s_nop 0
    buffer_load_dwordx4 v3, s[8:11], s36 offen offset:256 lds
    s_add_u32 s36, s36, s37
    s_sub_u32 s55, s36, 7864320
    s_min_u32 s36, s36, s55
    s_waitcnt vmcnt(6) lgkmcnt(0)
    s_lshr_b32 s7, s7, 4
    s_mul_i32 s7, s7, 0x2c9277b5
    s_add_u32 s7, s7, 0x6c564b05
    s_lshl_b32 s7, s7, 4
    s_barrier
    v_mov_b32 v21, s7
    s_mov_b64 exec, 255
    buffer_store_dword v21, v20, s[24:27], s6 offen sc1
    s_mov_b64 exec, 0x11
    v_lshlrev_b32 v29, 3, v240
    s_mov_b32 s56, 3211264
    buffer_store_dwordx2 v[126:127], v29, s[24:27], s56 offen sc1
    s_mov_b64 exec, -1
    v_cvt_pk_bf16_f32 v67, v102, v103
    v_lshlrev_b32 v102, 16, v67
    v_and_b32 v103, 0xffff0000, v67
    v_pk_mul_f32 v[102:103], v[102:103], v[130:131]
    v_cvt_pk_bf16_f32 v67, v102, v103
    v_lshlrev_b32 v102, 16, v67
    v_and_b32 v103, 0xffff0000, v67
    v_lshlrev_b32 v138, 16, v79
    v_and_b32 v139, 0xffff0000, v79
    v_pk_fma_f32 v[122:123], v[102:103], v[138:139], v[122:123]
    s_add_u32 m0, s49, 98304
    s_nop 0
    buffer_load_dwordx4 v2, s[8:11], s36 offen offset:0 lds
    s_add_u32 m0, s49, 99200
    s_nop 0
    buffer_load_dwordx4 v2, s[8:11], s36 offen offset:128 lds
    v_cvt_pk_bf16_f32 v68, v104, v105
    v_lshlrev_b32 v104, 16, v68
    v_and_b32 v105, 0xffff0000, v68
    v_pk_mul_f32 v[104:105], v[104:105], v[130:131]
    v_cvt_pk_bf16_f32 v68, v104, v105
    v_lshlrev_b32 v104, 16, v68
    v_and_b32 v105, 0xffff0000, v68
    v_lshlrev_b32 v132, 16, v80
    v_and_b32 v133, 0xffff0000, v80
    v_pk_fma_f32 v[120:121], v[104:105], v[132:133], v[120:121]
    s_add_u32 m0, s49, 100096
    s_nop 0
    buffer_load_dwordx4 v2, s[8:11], s36 offen offset:256 lds
    s_add_u32 m0, s49, 101376
    s_nop 0
    buffer_load_dwordx4 v3, s[8:11], s36 offen offset:0 lds
    s_waitcnt lgkmcnt(0)
    s_mov_b32 s63, -1
    s_load_dword s4, s[86:87], s58 offset:0x2000 glc
    s_load_dword s63, s[86:87], s58 glc
    s_waitcnt lgkmcnt(1)
    v_cvt_pk_bf16_f32 v69, v106, v107
    v_lshlrev_b32 v106, 16, v69
    v_and_b32 v107, 0xffff0000, v69
    v_pk_mul_f32 v[106:107], v[106:107], v[130:131]
    v_cvt_pk_bf16_f32 v69, v106, v107
    v_lshlrev_b32 v106, 16, v69
    v_and_b32 v107, 0xffff0000, v69
    v_lshlrev_b32 v134, 16, v81
    v_and_b32 v135, 0xffff0000, v81
    v_pk_fma_f32 v[122:123], v[106:107], v[134:135], v[122:123]
    s_and_b32 s93, s63, 0x2000
    s_add_u32 s46, s46, s93
    s_getreg_b32 s61, hwreg(HW_REG_XCC_ID, 2, 1)
    s_mul_i32 s61, s61, 0x6000
    s_lshl_b32 s93, s93, 1
    s_xor_b32 s93, s93, s61
    s_add_u32 m0, s49, 102272
    s_nop 0
    buffer_load_dwordx4 v3, s[8:11], s36 offen offset:128 lds
    s_add_u32 m0, s49, 103168
    s_nop 0
    buffer_load_dwordx4 v3, s[8:11], s36 offen offset:256 lds
    s_add_u32 s36, s36, s37
    s_sub_u32 s55, s36, 7864320
    s_min_u32 s36, s36, s55
    s_mov_b64 exec, -1
    s_add_u32 m0, s49, 122880
    s_nop 0
    buffer_load_dwordx4 v2, s[8:11], s36 offen offset:0 lds
    s_add_u32 m0, s49, 123776
    s_nop 0
    buffer_load_dwordx4 v2, s[8:11], s36 offen offset:128 lds
    s_add_u32 m0, s49, 124672
    s_nop 0
    buffer_load_dwordx4 v2, s[8:11], s36 offen offset:256 lds
    s_add_u32 m0, s49, 125952
    s_nop 0
    buffer_load_dwordx4 v3, s[8:11], s36 offen offset:0 lds
    s_add_u32 m0, s49, 126848
    s_nop 0
    buffer_load_dwordx4 v3, s[8:11], s36 offen offset:128 lds
    s_add_u32 m0, s49, 127744
    s_nop 0
    buffer_load_dwordx4 v3, s[8:11], s36 offen offset:256 lds
    s_add_u32 s36, s36, s37
    s_sub_u32 s55, s36, 7864320
    s_min_u32 s36, s36, s55
    s_mov_b64 exec, 0
    s_cmp_eq_u32 s3, 0
    s_cbranch_scc1 pg_4
    s_cmp_eq_u32 s3, 1
    s_cbranch_scc1 pg_5
    s_cmp_eq_u32 s3, 2
    s_cbranch_scc1 pg_6
    s_cmp_eq_u32 s3, 3
    s_cbranch_scc1 pg_7
pg_ret2:
    s_mov_b64 exec, -1
    ds_read_b64_tr_b16 a[192:193], v8 offset:0
    ds_read_b64_tr_b16 a[194:195], v8 offset:6144
    ds_read_b64_tr_b16 a[196:197], v9 offset:0
    ds_read_b64_tr_b16 a[198:199], v9 offset:6144
    ds_read_b64_tr_b16 a[200:201], v10 offset:0
    ds_read_b64_tr_b16 a[202:203], v10 offset:6144
    ds_read_b64_tr_b16 a[204:205], v11 offset:0
    ds_read_b64_tr_b16 a[206:207], v11 offset:6144
spin_ln:
    s_load_dwordx8 s[28:35], s[86:87], s46 glc
    s_add_u32 s101, s101, 1
    s_cmp_gt_u32 s101, 0x2000000
    s_cselect_b32 s57, 0, -1
    s_waitcnt lgkmcnt(0)
    s_xor_b32 s56, s28, s7
    s_xor_b32 s29, s29, s7
    s_or_b32 s56, s56, s29
    s_xor_b32 s30, s30, s7
    s_or_b32 s56, s56, s30
    s_xor_b32 s31, s31, s7
    s_or_b32 s56, s56, s31
    s_xor_b32 s32, s32, s7
    s_or_b32 s56, s56, s32
    s_xor_b32 s33, s33, s7
    s_or_b32 s56, s56, s33
    s_xor_b32 s34, s34, s7
    s_or_b32 s56, s56, s34
    s_xor_b32 s35, s35, s7
    s_or_b32 s56, s56, s35
    s_and_b32 s56, s56, s57
    s_cbranch_scc1 spin_ln
z_skip:
    s_add_u32 s46, s45, 0
    s_sub_u32 s5, s46, 81920
    s_min_u32 s46, s46, s5
    buffer_load_dwordx4 a[0:3], v28, s[20:23], s46 offen offset:0 sc1
    buffer_load_dwordx4 a[4:7], v28, s[20:23], s46 offen offset:1024 sc1
    buffer_load_dwordx4 a[8:11], v28, s[20:23], s46 offen offset:2048 sc1
    buffer_load_dwordx4 a[12:15], v28, s[20:23], s46 offen offset:3072 sc1
    s_add_u32 s46, s45, 4096
    s_sub_u32 s5, s46, 81920
    s_min_u32 s46, s46, s5
    buffer_load_dwordx4 a[16:19], v28, s[20:23], s46 offen offset:0 sc1
    buffer_load_dwordx4 a[20:23], v28, s[20:23], s46 offen offset:1024 sc1
    buffer_load_dwordx4 a[24:27], v28, s[20:23], s46 offen offset:2048 sc1
    buffer_load_dwordx4 a[28:31], v28, s[20:23], s46 offen offset:3072 sc1
    v_cvt_pk_bf16_f32 v70, v108, v109
    v_lshlrev_b32 v108, 16, v70
    v_and_b32 v109, 0xffff0000, v70
    v_pk_mul_f32 v[108:109], v[108:109], v[130:131]
    v_cvt_pk_bf16_f32 v70, v108, v109
    v_lshlrev_b32 v108, 16, v70
    v_and_b32 v109, 0xffff0000, v70
    v_lshlrev_b32 v136, 16, v82
    v_and_b32 v137, 0xffff0000, v82
    v_pk_fma_f32 v[120:121], v[108:109], v[136:137], v[120:121]
    v_cvt_pk_bf16_f32 v71, v110, v111
    v_lshlrev_b32 v110, 16, v71
    v_and_b32 v111, 0xffff0000, v71
    v_pk_mul_f32 v[110:111], v[110:111], v[130:131]
    v_cvt_pk_bf16_f32 v71, v110, v111
    v_lshlrev_b32 v110, 16, v71
    v_and_b32 v111, 0xffff0000, v71
    v_lshlrev_b32 v138, 16, v83
    v_and_b32 v139, 0xffff0000, v83
    v_pk_fma_f32 v[122:123], v[110:111], v[138:139], v[122:123]
    s_mov_b32 exec_hi, 0
    v_cvt_pk_bf16_f32 v72, v112, v113
    v_lshlrev_b32 v112, 16, v72
    v_and_b32 v113, 0xffff0000, v72
    v_pk_mul_f32 v[112:113], v[112:113], v[130:131]
    v_cvt_pk_bf16_f32 v72, v112, v113
    v_lshlrev_b32 v112, 16, v72
    v_and_b32 v113, 0xffff0000, v72
    v_lshlrev_b32 v132, 16, v84
    v_and_b32 v133, 0xffff0000, v84
    v_pk_fma_f32 v[120:121], v[112:113], v[132:133], v[120:121]
    v_cvt_pk_bf16_f32 v73, v114, v115
    v_lshlrev_b32 v114, 16, v73
    v_and_b32 v115, 0xffff0000, v73
    v_pk_mul_f32 v[114:115], v[114:115], v[130:131]
    v_cvt_pk_bf16_f32 v73, v114, v115
    v_lshlrev_b32 v114, 16, v73
    v_and_b32 v115, 0xffff0000, v73
    v_lshlrev_b32 v134, 16, v85
    v_and_b32 v135, 0xffff0000, v85
    v_pk_fma_f32 v[122:123], v[114:115], v[134:135], v[122:123]
    v_cvt_pk_bf16_f32 v74, v116, v117
    v_lshlrev_b32 v116, 16, v74
    v_and_b32 v117, 0xffff0000, v74
    v_pk_mul_f32 v[116:117], v[116:117], v[130:131]
    v_cvt_pk_bf16_f32 v74, v116, v117
    v_lshlrev_b32 v116, 16, v74
    v_and_b32 v117, 0xffff0000, v74
    v_lshlrev_b32 v136, 16, v86
    v_and_b32 v137, 0xffff0000, v86
    v_pk_fma_f32 v[120:121], v[116:117], v[136:137], v[120:121]
    v_cvt_pk_bf16_f32 v75, v118, v119
    v_lshlrev_b32 v118, 16, v75
    v_and_b32 v119, 0xffff0000, v75
    v_pk_mul_f32 v[118:119], v[118:119], v[130:131]
    v_cvt_pk_bf16_f32 v75, v118, v119
    v_lshlrev_b32 v118, 16, v75
    v_and_b32 v119, 0xffff0000, v75
    v_lshlrev_b32 v138, 16, v87
    v_and_b32 v139, 0xffff0000, v87
    v_pk_fma_f32 v[122:123], v[118:119], v[138:139], v[122:123]
    s_mov_b64 exec, -1
    v_pk_add_f32 v[120:121], v[120:121], v[122:123]
    v_add_f32 v120, v120, v121
    s_nop 1
    v_add_f32_dpp v120, v120, v120 quad_perm:[1,0,3,2] row_mask:0xf bank_mask:0xf
    s_nop 1
    v_add_f32_dpp v120, v120, v120 quad_perm:[2,3,0,1] row_mask:0xf bank_mask:0xf
    s_nop 1
    v_add_f32_dpp v120, v120, v120 row_ror:8 row_mask:0xf bank_mask:0xf
    v_mov_b32 v124, v120
    s_nop 1
    v_permlane16_swap_b32 v120, v124
    s_nop 1
    v_add_f32 v120, v120, v124
    v_mov_b32 v124, v120
    s_nop 1
    v_permlane32_swap_b32 v120, v124
    s_nop 1
    v_add_f32 v120, v120, v124
    v_cvt_pk_bf16_f32 v120, v120, v120
    v_and_b32 v120, 0xffff0000, v120
    v_ashrrev_i32 v122, 31, v120
    v_or_b32 v122, 0x80000000, v122
    v_xor_b32 v120, v120, v122
    v_and_b32 v120, 0xffff0000, v120
    v_sub_u32 v122, 2047, v240
    v_or_b32 v120, v120, v122
    s_nop 1
    v_mov_b32_dpp v121, v120 row_ror:4 row_mask:0xf bank_mask:0xf
    v_mov_b32 v122, s7
    v_mov_b32 v123, s93
    s_lshl_b32 s56, s2, 2
    s_add_u32 s56, s56, s3
    s_lshl_b32 s56, s56, 4
    s_add_u32 s56, s56, 3162112
    v_mov_b32 v29, 0
    s_mov_b64 s[74:75], s[66:67]
    s_mul_i32 s57, s50, 786432
    s_add_u32 s57, s57, 688128
    s_cmp_eq_u32 s3, 1
    s_cselect_b64 s[74:75], s[68:69], s[74:75]
    s_cmp_eq_u32 s3, 2
    s_cselect_b64 s[74:75], s[78:79], s[74:75]
    s_cselect_b32 s57, 0, s57
    s_cmp_eq_u32 s3, 3
    s_cselect_b64 s[74:75], s[80:81], s[74:75]
    s_cselect_b32 s57, 0, s57
    s_load_dword s76, s[74:75], s57
    s_mov_b64 s[74:75], s[72:73]
    s_mul_i32 s57, s50, 245760
    s_cmp_eq_u32 s3, 1
    s_cselect_b64 s[74:75], s[82:83], s[74:75]
    s_cselect_b32 s57, 0, s57
    s_mul_i32 s77, s2, 10240
    s_cmp_eq_u32 s3, 2
    s_cselect_b64 s[74:75], s[84:85], s[74:75]
    s_cselect_b32 s57, s77, s57
    s_lshr_b32 s77, s2, 3
    s_lshl_b32 s77, s77, 22
    s_add_u32 s77, s77, 67563520
    s_cmp_eq_u32 s3, 3
    s_cselect_b64 s[74:75], s[86:87], s[74:75]
    s_cselect_b32 s57, s77, s57
    s_load_dword s76, s[74:75], s57
    s_waitcnt vmcnt(4)
    s_mov_b64 exec, 1
    s_waitcnt vmcnt(20)
    buffer_store_dwordx4 v[120:123], v29, s[24:27], s56 offen sc1
    s_mov_b64 exec, -1
head_code:
    v_mfma_f32_16x16x32_bf16 v[64:67], a[192:195], a[0:3], 0
    s_add_u32 s46, s45, 8192
    ds_read_b64_tr_b16 a[208:209], v8 offset:1024
    s_sub_u32 s77, s46, 81920
    v_mfma_f32_16x16x32_bf16 v[68:71], a[196:199], a[0:3], 0
    s_min_u32 s46, s46, s77
    ds_read_b64_tr_b16 a[210:211], v8 offset:7168
    v_mfma_f32_16x16x32_bf16 v[76:79], a[196:199], a[4:7], 0
    buffer_load_dwordx4 a[32:35], v28, s[20:23], s46 offen offset:0 sc1
    v_mfma_f32_16x16x32_bf16 v[72:75], a[192:195], a[4:7], 0
    v_mfma_f32_16x16x32_bf16 v[80:83], a[192:195], a[8:11], 0
    ds_read_b64_tr_b16 a[212:213], v9 offset:1024
    v_mfma_f32_16x16x32_bf16 v[84:87], a[196:199], a[8:11], 0
    ds_read_b64_tr_b16 a[214:215], v9 offset:7168
    v_mfma_f32_16x16x32_bf16 v[92:95], a[196:199], a[12:15], 0
    v_mfma_f32_16x16x32_bf16 v[88:91], a[192:195], a[12:15], 0
    s_waitcnt lgkmcnt(4)
    v_mfma_f32_16x16x32_bf16 v[120:123], a[200:203], a[12:15], 0
    ds_read_b64_tr_b16 a[192:193], v10 offset:1024
    v_mul_u32_u24 v56, 3072, v5
    v_mfma_f32_16x16x32_bf16 v[124:127], a[204:207], a[12:15], 0
    ds_read_b64_tr_b16 a[194:195], v10 offset:7168
    v_add_u32 v56, v56, v7
    v_mfma_f32_16x16x32_bf16 v[116:119], a[204:207], a[8:11], 0
    buffer_load_dwordx4 a[36:39], v28, s[20:23], s46 offen offset:1024 sc1
    v_mfma_f32_16x16x32_bf16 v[112:115], a[200:203], a[8:11], 0
    v_add_u32 v57, 49152, v56
    v_lshrrev_b32 v29, 3, v1
    v_mfma_f32_16x16x32_bf16 v[104:107], a[200:203], a[4:7], 0
    ds_read_b64_tr_b16 a[196:197], v11 offset:1024
    v_mul_u32_u24 v62, 1280, v29
    v_mfma_f32_16x16x32_bf16 v[108:111], a[204:207], a[4:7], 0
    ds_read_b64_tr_b16 a[198:199], v11 offset:7168
    v_add_u32 v62, v62, v7
    v_mfma_f32_16x16x32_bf16 v[100:103], a[204:207], a[0:3], 0
    v_add_u32 v63, 10240, v62
    v_mul_u32_u24 v31, 384, v29
    v_mfma_f32_16x16x32_bf16 v[96:99], a[200:203], a[0:3], 0
    s_waitcnt lgkmcnt(4)
    v_add_u32 v6, v31, v7
    v_add_u32 v7, 3072, v6
    v_mfma_f32_16x16x32_bf16 v[128:131], a[208:211], a[0:3], 0
    ds_read_b64_tr_b16 a[200:201], v8 offset:2048
    v_bfe_u32 v29, v1, 4, 1
    v_mfma_f32_16x16x32_bf16 v[132:135], a[212:215], a[0:3], 0
    ds_read_b64_tr_b16 a[202:203], v8 offset:8192
    v_bfe_u32 v30, v1, 5, 1
    v_mfma_f32_16x16x32_bf16 v[140:143], a[212:215], a[4:7], 0
    buffer_load_dwordx4 a[40:43], v28, s[20:23], s46 offen offset:2048 sc1
    v_mfma_f32_16x16x32_bf16 v[136:139], a[208:211], a[4:7], 0
    v_lshl_add_u32 v29, v29, 1, v30
    v_and_b32 v30, 7, v1
    v_mfma_f32_16x16x32_bf16 v[144:147], a[208:211], a[8:11], 0
    ds_read_b64_tr_b16 a[204:205], v9 offset:2048
    v_xor_b32 v30, v30, v29
    v_mfma_f32_16x16x32_bf16 v[148:151], a[212:215], a[8:11], 0
    ds_read_b64_tr_b16 a[206:207], v9 offset:8192
    v_lshl_add_u32 v4, v30, 4, v31
    v_mfma_f32_16x16x32_bf16 v[156:159], a[212:215], a[12:15], 0
    buffer_load_dwordx4 a[44:47], v28, s[20:23], s46 offen offset:3072 sc1
    v_mfma_f32_16x16x32_bf16 v[152:155], a[208:211], a[12:15], 0
    s_waitcnt lgkmcnt(4)
    v_xor_b32 v30, 4, v30
    v_lshl_add_u32 v5, v30, 4, v31
    v_mfma_f32_16x16x32_bf16 v[184:187], a[192:195], a[12:15], 0
    s_add_u32 s46, s45, 12288
    ds_read_b64_tr_b16 a[208:209], v10 offset:2048
    v_add_u32 v5, 3072, v5
    v_mfma_f32_16x16x32_bf16 v[188:191], a[196:199], a[12:15], 0
    s_sub_u32 s77, s46, 81920
    ds_read_b64_tr_b16 a[210:211], v10 offset:8192
    v_bfe_u32 v30, v1, 1, 1
    v_mfma_f32_16x16x32_bf16 v[180:183], a[196:199], a[8:11], 0
    s_min_u32 s46, s46, s77
    v_bfe_u32 v31, v1, 2, 1
    v_lshl_add_u32 v30, v30, 1, v31
    v_mfma_f32_16x16x32_bf16 v[176:179], a[192:195], a[8:11], 0
    v_bfe_u32 v31, v1, 3, 1
    v_lshl_add_u32 v30, v31, 2, v30
    v_mfma_f32_16x16x32_bf16 v[168:171], a[192:195], a[4:7], 0
    ds_read_b64_tr_b16 a[212:213], v11 offset:2048
    v_xor_b32 v30, v30, v29
    v_mfma_f32_16x16x32_bf16 v[172:175], a[196:199], a[4:7], 0
    ds_read_b64_tr_b16 a[214:215], v11 offset:8192
    v_lshlrev_b32 v30, 4, v30
    v_mfma_f32_16x16x32_bf16 v[164:167], a[196:199], a[0:3], 0
    buffer_load_dwordx4 a[48:51], v28, s[20:23], s46 offen offset:0 sc1
    v_mfma_f32_16x16x32_bf16 v[160:163], a[192:195], a[0:3], 0
    s_waitcnt lgkmcnt(4)
    v_mul_u32_u24 v31, 3072, v31
    v_and_b32 v29, 7, v1
    v_mfma_f32_16x16x32_bf16 v[192:195], a[200:203], a[0:3], 0
    ds_read_b64_tr_b16 a[192:193], v8 offset:12288
    v_lshl_add_u32 v31, v29, 7, v31
    v_mfma_f32_16x16x32_bf16 v[196:199], a[204:207], a[0:3], 0
    ds_read_b64_tr_b16 a[194:195], v8 offset:18432
    v_subrev_u32 v31, s49, v31
    v_mfma_f32_16x16x32_bf16 v[204:207], a[204:207], a[4:7], 0
    buffer_load_dwordx4 a[52:55], v28, s[20:23], s46 offen offset:1024 sc1
    v_mfma_f32_16x16x32_bf16 v[200:203], a[200:203], a[4:7], 0
    v_add_u32 v18, v31, v30
    v_xor_b32 v30, 64, v30
    v_mfma_f32_16x16x32_bf16 v[208:211], a[200:203], a[8:11], 0
    ds_read_b64_tr_b16 a[196:197], v9 offset:12288
    v_add_u32 v19, v31, v30
    v_mfma_f32_16x16x32_bf16 v[212:215], a[204:207], a[8:11], 0
    s_mul_i32 s56, s50, 786432
    ds_read_b64_tr_b16 a[198:199], v9 offset:18432
    s_add_u32 s56, s56, 589824
    v_mfma_f32_16x16x32_bf16 v[220:223], a[204:207], a[12:15], 0
    s_add_u32 s12, s66, s56
    s_addc_u32 s13, s67, 0
    s_and_b32 s13, s13, 0xffff
    v_mfma_f32_16x16x32_bf16 v[216:219], a[200:203], a[12:15], 0
    s_waitcnt lgkmcnt(4)
    s_mov_b32 s14, 196608
    s_mov_b32 s15, 0x00020000
    v_mfma_f32_16x16x32_bf16 v[248:251], a[208:211], a[12:15], 0
    s_add_u32 s16, s68, s56
    s_addc_u32 s17, s69, 0
    ds_read_b64_tr_b16 a[200:201], v10 offset:12288
    v_mfma_f32_16x16x32_bf16 v[252:255], a[212:215], a[12:15], 0
    s_and_b32 s17, s17, 0xffff
    ds_read_b64_tr_b16 a[202:203], v10 offset:18432
    s_mov_b32 s18, 196608
    v_mfma_f32_16x16x32_bf16 v[244:247], a[212:215], a[8:11], 0
    buffer_load_dwordx4 a[56:59], v28, s[20:23], s46 offen offset:2048 sc1
    v_mfma_f32_16x16x32_bf16 v[240:243], a[208:211], a[8:11], 0
    s_mov_b32 s19, 0x00020000
    s_mov_b32 s28, s78
    s_and_b32 s29, s79, 0xffff
    v_mfma_f32_16x16x32_bf16 v[232:235], a[208:211], a[4:7], 0
    s_mov_b32 s30, 1966080
    ds_read_b64_tr_b16 a[204:205], v11 offset:12288
    s_mov_b32 s31, 0x00020000
    v_mfma_f32_16x16x32_bf16 v[236:239], a[212:215], a[4:7], 0
    s_waitcnt vmcnt(8)
    ds_read_b64_tr_b16 a[206:207], v11 offset:18432
    s_mov_b32 s32, s80
    v_mfma_f32_16x16x32_bf16 v[228:231], a[212:215], a[0:3], 0
    s_and_b32 s33, s81, 0xffff
    s_mov_b32 s34, 1966080
    s_mov_b32 s35, 0x00020000
    v_mfma_f32_16x16x32_bf16 v[224:227], a[208:211], a[0:3], 0
    s_waitcnt lgkmcnt(4)
    s_mov_b32 s5, s58
    s_min_u32 s58, s2, 239
    v_mfma_f32_16x16x32_bf16 v[64:67], a[192:195], a[16:19], v[64:67]
    s_mul_hi_u32 s56, s58, 178956971
    ds_read_b64_tr_b16 a[208:209], v8 offset:13312
    s_mul_i32 s57, s56, 24
    v_mfma_f32_16x16x32_bf16 v[68:71], a[196:199], a[16:19], v[68:71]
    s_sub_u32 s57, s58, s57
    ds_read_b64_tr_b16 a[210:211], v8 offset:19456
    s_lshl_b32 s60, s56, 6
    v_mfma_f32_16x16x32_bf16 v[76:79], a[196:199], a[20:23], v[76:79]
    buffer_load_dwordx4 a[60:63], v28, s[20:23], s46 offen offset:3072 sc1
    v_mfma_f32_16x16x32_bf16 v[72:75], a[192:195], a[20:23], v[72:75]
    s_add_u32 s46, s45, 16384
    s_sub_u32 s77, s46, 81920
    s_min_u32 s46, s46, s77
    v_mfma_f32_16x16x32_bf16 v[80:83], a[192:195], a[24:27], v[80:83]
    s_add_u32 s60, s60, s59
    ds_read_b64_tr_b16 a[212:213], v9 offset:13312
    s_mul_i32 s60, s60, 3072
    v_mfma_f32_16x16x32_bf16 v[84:87], a[196:199], a[24:27], v[84:87]
    s_lshl_b32 s44, s57, 7
    ds_read_b64_tr_b16 a[214:215], v9 offset:19456
    s_add_u32 s60, s60, s44
    v_mfma_f32_16x16x32_bf16 v[92:95], a[196:199], a[28:31], v[92:95]
    buffer_load_dwordx4 a[64:67], v28, s[20:23], s46 offen offset:0 sc1
    v_mfma_f32_16x16x32_bf16 v[88:91], a[192:195], a[28:31], v[88:91]
    s_waitcnt lgkmcnt(4)
    s_lshl_b32 s61, s56, 7
    s_mul_i32 s62, s56, 1536
    v_mfma_f32_16x16x32_bf16 v[120:123], a[200:203], a[28:31], v[120:123]
    s_lshl_b32 s44, s57, 6
    ds_read_b64_tr_b16 a[192:193], v10 offset:13312
    s_add_u32 s62, s62, s44
    v_mfma_f32_16x16x32_bf16 v[124:127], a[204:207], a[28:31], v[124:127]
    s_lshl_b32 s44, s3, 4
    ds_read_b64_tr_b16 a[194:195], v10 offset:19456
    s_add_u32 s62, s62, s44
    v_mfma_f32_16x16x32_bf16 v[116:119], a[204:207], a[24:27], v[116:119]
    s_lshl_b32 s62, s62, 4
    s_add_u32 s62, s62, 3276800
    s_lshl_b32 s4, s2, 8
    v_mfma_f32_16x16x32_bf16 v[112:115], a[200:203], a[24:27], v[112:115]
    s_lshl_b32 s44, s3, 2
    s_add_u32 s4, s4, s44
    s_add_u32 s4, s4, 4718592
    v_mfma_f32_16x16x32_bf16 v[104:107], a[200:203], a[20:23], v[104:107]
    s_mov_b32 s92, 0xbfb8aa3b
    ds_read_b64_tr_b16 a[196:197], v11 offset:13312
    s_lshl_b32 s44, s3, 12
    v_mfma_f32_16x16x32_bf16 v[108:111], a[204:207], a[20:23], v[108:111]
    s_mov_b32 s38, s49
    ds_read_b64_tr_b16 a[198:199], v11 offset:19456
    s_mov_b32 s40, s49
    v_mfma_f32_16x16x32_bf16 v[100:103], a[204:207], a[16:19], v[100:103]
    buffer_load_dwordx4 a[68:71], v28, s[20:23], s46 offen offset:1024 sc1
    v_mfma_f32_16x16x32_bf16 v[96:99], a[200:203], a[16:19], v[96:99]
    s_waitcnt lgkmcnt(4)
    s_mov_b32 s39, 24576
    s_mov_b32 s47, 3162112
    v_mfma_f32_16x16x32_bf16 v[128:131], a[208:211], a[16:19], v[128:131]
    s_mov_b32 s88, 0xaaaaaaaa
    ds_read_b64_tr_b16 a[200:201], v8 offset:14336
    s_mov_b32 s89, 0xaaaaaaaa
    v_mfma_f32_16x16x32_bf16 v[132:135], a[212:215], a[16:19], v[132:135]
    ds_read_b64_tr_b16 a[202:203], v8 offset:20480
    v_mfma_f32_16x16x32_bf16 v[140:143], a[212:215], a[20:23], v[140:143]
    v_add_u32 v8, 73728, v12
    v_mfma_f32_16x16x32_bf16 v[136:139], a[208:211], a[20:23], v[136:139]
    buffer_load_dwordx4 a[72:75], v28, s[20:23], s46 offen offset:2048 sc1
    v_mfma_f32_16x16x32_bf16 v[144:147], a[208:211], a[24:27], v[144:147]
    ds_read_b64_tr_b16 a[204:205], v9 offset:14336
    v_mfma_f32_16x16x32_bf16 v[148:151], a[212:215], a[24:27], v[148:151]
    ds_read_b64_tr_b16 a[206:207], v9 offset:20480
    v_mfma_f32_16x16x32_bf16 v[156:159], a[212:215], a[28:31], v[156:159]
    v_add_u32 v9, 73728, v13
    v_mfma_f32_16x16x32_bf16 v[152:155], a[208:211], a[28:31], v[152:155]
    s_waitcnt lgkmcnt(4)
    v_mfma_f32_16x16x32_bf16 v[184:187], a[192:195], a[28:31], v[184:187]
    ds_read_b64_tr_b16 a[208:209], v10 offset:14336
    v_mfma_f32_16x16x32_bf16 v[188:191], a[196:199], a[28:31], v[188:191]
    ds_read_b64_tr_b16 a[210:211], v10 offset:20480
    v_mfma_f32_16x16x32_bf16 v[180:183], a[196:199], a[24:27], v[180:183]
    buffer_load_dwordx4 a[76:79], v28, s[20:23], s46 offen offset:3072 sc1
    v_mfma_f32_16x16x32_bf16 v[176:179], a[192:195], a[24:27], v[176:179]
    v_add_u32 v10, 73728, v14
    v_mfma_f32_16x16x32_bf16 v[168:171], a[192:195], a[20:23], v[168:171]
    s_add_u32 s46, s45, 20480
    ds_read_b64_tr_b16 a[212:213], v11 offset:14336
    s_sub_u32 s77, s46, 81920
    v_mfma_f32_16x16x32_bf16 v[172:175], a[196:199], a[20:23], v[172:175]
    s_waitcnt vmcnt(35)
    ds_read_b64_tr_b16 a[214:215], v11 offset:20480
    s_min_u32 s46, s46, s77
    v_mfma_f32_16x16x32_bf16 v[164:167], a[196:199], a[16:19], v[164:167]
    s_barrier
    v_mfma_f32_16x16x32_bf16 v[160:163], a[192:195], a[16:19], v[160:163]
    s_waitcnt lgkmcnt(4)
    v_add_u32 v11, 73728, v15
    v_mfma_f32_16x16x32_bf16 v[192:195], a[200:203], a[16:19], v[192:195]
    ds_read_b64_tr_b16 a[192:193], v8 offset:0
    v_mfma_f32_16x16x32_bf16 v[196:199], a[204:207], a[16:19], v[196:199]
    ds_read_b64_tr_b16 a[194:195], v8 offset:6144
    v_mfma_f32_16x16x32_bf16 v[204:207], a[204:207], a[20:23], v[204:207]
    buffer_load_dwordx4 a[80:83], v28, s[20:23], s46 offen offset:0 sc1
    v_mfma_f32_16x16x32_bf16 v[200:203], a[200:203], a[20:23], v[200:203]
    v_mfma_f32_16x16x32_bf16 v[208:211], a[200:203], a[24:27], v[208:211]
    ds_read_b64_tr_b16 a[196:197], v8 offset:12288
    v_mfma_f32_16x16x32_bf16 v[212:215], a[204:207], a[24:27], v[212:215]
    ds_read_b64_tr_b16 a[198:199], v8 offset:18432
    v_mfma_f32_16x16x32_bf16 v[220:223], a[204:207], a[28:31], v[220:223]
    buffer_load_dwordx4 a[84:87], v28, s[20:23], s46 offen offset:1024 sc1
    v_mfma_f32_16x16x32_bf16 v[216:219], a[200:203], a[28:31], v[216:219]
    s_waitcnt lgkmcnt(4)
    v_mfma_f32_16x16x32_bf16 v[248:251], a[208:211], a[28:31], v[248:251]
    ds_read_b64_tr_b16 a[200:201], v9 offset:0
    v_mfma_f32_16x16x32_bf16 v[252:255], a[212:215], a[28:31], v[252:255]
    ds_read_b64_tr_b16 a[202:203], v9 offset:6144
    v_mfma_f32_16x16x32_bf16 v[244:247], a[212:215], a[24:27], v[244:247]
    v_mfma_f32_16x16x32_bf16 v[240:243], a[208:211], a[24:27], v[240:243]
    v_mfma_f32_16x16x32_bf16 v[232:235], a[208:211], a[20:23], v[232:235]
    ds_read_b64_tr_b16 a[204:205], v9 offset:12288
    v_mfma_f32_16x16x32_bf16 v[236:239], a[212:215], a[20:23], v[236:239]
    s_waitcnt vmcnt(10)
    s_waitcnt vmcnt(6)
    ds_read_b64_tr_b16 a[206:207], v9 offset:18432
    v_mfma_f32_16x16x32_bf16 v[228:231], a[212:215], a[16:19], v[228:231]
    buffer_load_dwordx4 a[88:91], v28, s[20:23], s46 offen offset:2048 sc1
    v_mfma_f32_16x16x32_bf16 v[224:227], a[208:211], a[16:19], v[224:227]
    s_waitcnt lgkmcnt(4)
    v_mfma_f32_16x16x32_bf16 v[64:67], a[192:195], a[32:35], v[64:67]
    ds_read_b64_tr_b16 a[208:209], v10 offset:0
    v_mfma_f32_16x16x32_bf16 v[64:67], a[196:199], a[48:51], v[64:67]
    ds_read_b64_tr_b16 a[210:211], v10 offset:6144
    v_mfma_f32_16x16x32_bf16 v[72:75], a[196:199], a[52:55], v[72:75]
    v_mfma_f32_16x16x32_bf16 v[72:75], a[192:195], a[36:39], v[72:75]
    buffer_load_dwordx4 a[92:95], v28, s[20:23], s46 offen offset:3072 sc1
    v_mfma_f32_16x16x32_bf16 v[80:83], a[192:195], a[40:43], v[80:83]
    ds_read_b64_tr_b16 a[212:213], v10 offset:12288
    v_mfma_f32_16x16x32_bf16 v[80:83], a[196:199], a[56:59], v[80:83]
    ds_read_b64_tr_b16 a[214:215], v10 offset:18432
    v_mfma_f32_16x16x32_bf16 v[88:91], a[196:199], a[60:63], v[88:91]
    s_add_u32 s46, s45, 24576
    s_sub_u32 s77, s46, 81920
    s_min_u32 s46, s46, s77
    v_mfma_f32_16x16x32_bf16 v[88:91], a[192:195], a[44:47], v[88:91]
pg_1:
    s_cbranch_execz pg_ret
    s_waitcnt lgkmcnt(4)
    v_mfma_f32_16x16x32_bf16 v[92:95], a[200:203], a[44:47], v[92:95]
    ds_read_b64_tr_b16 a[192:193], v11 offset:0
    v_mfma_f32_16x16x32_bf16 v[92:95], a[204:207], a[60:63], v[92:95]
    ds_read_b64_tr_b16 a[194:195], v11 offset:6144
    v_mfma_f32_16x16x32_bf16 v[84:87], a[204:207], a[56:59], v[84:87]
    buffer_load_dwordx4 a[96:99], v28, s[20:23], s46 offen offset:0 sc1
    v_mfma_f32_16x16x32_bf16 v[84:87], a[200:203], a[40:43], v[84:87]
    v_mfma_f32_16x16x32_bf16 v[76:79], a[200:203], a[36:39], v[76:79]
    ds_read_b64_tr_b16 a[196:197], v11 offset:12288
    v_mfma_f32_16x16x32_bf16 v[76:79], a[204:207], a[52:55], v[76:79]
    ds_read_b64_tr_b16 a[198:199], v11 offset:18432
    v_mfma_f32_16x16x32_bf16 v[68:71], a[204:207], a[48:51], v[68:71]
    v_mfma_f32_16x16x32_bf16 v[68:71], a[200:203], a[32:35], v[68:71]
    s_waitcnt lgkmcnt(4)
    v_mfma_f32_16x16x32_bf16 v[96:99], a[208:211], a[32:35], v[96:99]
    ds_read_b64_tr_b16 a[200:201], v8 offset:1024
    v_mfma_f32_16x16x32_bf16 v[96:99], a[212:215], a[48:51], v[96:99]
    ds_read_b64_tr_b16 a[202:203], v8 offset:7168
    v_mfma_f32_16x16x32_bf16 v[104:107], a[212:215], a[52:55], v[104:107]
    buffer_load_dwordx4 a[100:103], v28, s[20:23], s46 offen offset:1024 sc1
    v_mfma_f32_16x16x32_bf16 v[104:107], a[208:211], a[36:39], v[104:107]
    v_mfma_f32_16x16x32_bf16 v[112:115], a[208:211], a[40:43], v[112:115]
    ds_read_b64_tr_b16 a[204:205], v8 offset:13312
    v_mfma_f32_16x16x32_bf16 v[112:115], a[212:215], a[56:59], v[112:115]
    ds_read_b64_tr_b16 a[206:207], v8 offset:19456
    v_mfma_f32_16x16x32_bf16 v[120:123], a[212:215], a[60:63], v[120:123]
    v_mfma_f32_16x16x32_bf16 v[120:123], a[208:211], a[44:47], v[120:123]
    s_waitcnt lgkmcnt(4)
    v_mfma_f32_16x16x32_bf16 v[124:127], a[192:195], a[44:47], v[124:127]
    ds_read_b64_tr_b16 a[208:209], v9 offset:1024
    v_mfma_f32_16x16x32_bf16 v[124:127], a[196:199], a[60:63], v[124:127]
    ds_read_b64_tr_b16 a[210:211], v9 offset:7168
    v_mfma_f32_16x16x32_bf16 v[116:119], a[196:199], a[56:59], v[116:119]
    buffer_load_dwordx4 a[104:107], v28, s[20:23], s46 offen offset:2048 sc1
    v_mfma_f32_16x16x32_bf16 v[116:119], a[192:195], a[40:43], v[116:119]
    v_mfma_f32_16x16x32_bf16 v[108:111], a[192:195], a[36:39], v[108:111]
    ds_read_b64_tr_b16 a[212:213], v9 offset:13312
    v_mfma_f32_16x16x32_bf16 v[108:111], a[196:199], a[52:55], v[108:111]
    ds_read_b64_tr_b16 a[214:215], v9 offset:19456
    v_mfma_f32_16x16x32_bf16 v[100:103], a[196:199], a[48:51], v[100:103]
    buffer_load_dwordx4 a[108:111], v28, s[20:23], s46 offen offset:3072 sc1
    v_mfma_f32_16x16x32_bf16 v[100:103], a[192:195], a[32:35], v[100:103]
    s_waitcnt lgkmcnt(4)
    v_mfma_f32_16x16x32_bf16 v[128:131], a[200:203], a[32:35], v[128:131]
    ds_read_b64_tr_b16 a[192:193], v10 offset:1024
    v_mfma_f32_16x16x32_bf16 v[128:131], a[204:207], a[48:51], v[128:131]
    ds_read_b64_tr_b16 a[194:195], v10 offset:7168
    v_mfma_f32_16x16x32_bf16 v[136:139], a[204:207], a[52:55], v[136:139]
    v_mfma_f32_16x16x32_bf16 v[136:139], a[200:203], a[36:39], v[136:139]
    s_add_u32 m0, s49, 0
    v_mfma_f32_16x16x32_bf16 v[144:147], a[200:203], a[40:43], v[144:147]
    ds_read_b64_tr_b16 a[196:197], v10 offset:13312
    v_mfma_f32_16x16x32_bf16 v[144:147], a[204:207], a[56:59], v[144:147]
    ds_read_b64_tr_b16 a[198:199], v10 offset:19456
    v_mfma_f32_16x16x32_bf16 v[152:155], a[204:207], a[60:63], v[152:155]
    buffer_load_dwordx4 v2, s[8:11], s36 offen offset:0 lds
    v_mfma_f32_16x16x32_bf16 v[152:155], a[200:203], a[44:47], v[152:155]
    s_waitcnt lgkmcnt(4)
    v_mfma_f32_16x16x32_bf16 v[156:159], a[208:211], a[44:47], v[156:159]
    ds_read_b64_tr_b16 a[200:201], v11 offset:1024
    v_mfma_f32_16x16x32_bf16 v[156:159], a[212:215], a[60:63], v[156:159]
    s_add_u32 m0, s49, 896
    ds_read_b64_tr_b16 a[202:203], v11 offset:7168
    v_mfma_f32_16x16x32_bf16 v[148:151], a[212:215], a[56:59], v[148:151]
    buffer_load_dwordx4 v2, s[8:11], s36 offen offset:128 lds
    v_mfma_f32_16x16x32_bf16 v[148:151], a[208:211], a[40:43], v[148:151]
    v_mfma_f32_16x16x32_bf16 v[140:143], a[208:211], a[36:39], v[140:143]
    ds_read_b64_tr_b16 a[204:205], v11 offset:13312
    v_mfma_f32_16x16x32_bf16 v[140:143], a[212:215], a[52:55], v[140:143]
    ds_read_b64_tr_b16 a[206:207], v11 offset:19456
    v_mfma_f32_16x16x32_bf16 v[132:135], a[212:215], a[48:51], v[132:135]
    v_mfma_f32_16x16x32_bf16 v[132:135], a[208:211], a[32:35], v[132:135]
    s_waitcnt lgkmcnt(4)
    v_mfma_f32_16x16x32_bf16 v[160:163], a[192:195], a[32:35], v[160:163]
    s_add_u32 m0, s49, 1792
    ds_read_b64_tr_b16 a[208:209], v8 offset:2048
    v_mfma_f32_16x16x32_bf16 v[160:163], a[196:199], a[48:51], v[160:163]
    ds_read_b64_tr_b16 a[210:211], v8 offset:8192
    v_mfma_f32_16x16x32_bf16 v[168:171], a[196:199], a[52:55], v[168:171]
    buffer_load_dwordx4 v2, s[8:11], s36 offen offset:256 lds
    v_mfma_f32_16x16x32_bf16 v[168:171], a[192:195], a[36:39], v[168:171]
    v_mfma_f32_16x16x32_bf16 v[176:179], a[192:195], a[40:43], v[176:179]
    ds_read_b64_tr_b16 a[212:213], v8 offset:14336
    v_mfma_f32_16x16x32_bf16 v[176:179], a[196:199], a[56:59], v[176:179]
    ds_read_b64_tr_b16 a[214:215], v8 offset:20480
    v_mfma_f32_16x16x32_bf16 v[184:187], a[196:199], a[60:63], v[184:187]
    s_add_u32 m0, s49, 3072
    v_add_u32 v8, 98304, v12
    v_mfma_f32_16x16x32_bf16 v[184:187], a[192:195], a[44:47], v[184:187]
    s_waitcnt lgkmcnt(4)
    v_mfma_f32_16x16x32_bf16 v[188:191], a[200:203], a[44:47], v[188:191]
    ds_read_b64_tr_b16 a[192:193], v9 offset:2048
    v_mfma_f32_16x16x32_bf16 v[188:191], a[204:207], a[60:63], v[188:191]
    ds_read_b64_tr_b16 a[194:195], v9 offset:8192
    v_mfma_f32_16x16x32_bf16 v[180:183], a[204:207], a[56:59], v[180:183]
    buffer_load_dwordx4 v3, s[8:11], s36 offen offset:0 lds
    v_mfma_f32_16x16x32_bf16 v[180:183], a[200:203], a[40:43], v[180:183]
    v_mfma_f32_16x16x32_bf16 v[172:175], a[200:203], a[36:39], v[172:175]
    ds_read_b64_tr_b16 a[196:197], v9 offset:14336
    v_mfma_f32_16x16x32_bf16 v[172:175], a[204:207], a[52:55], v[172:175]
    s_add_u32 m0, s49, 3968
    ds_read_b64_tr_b16 a[198:199], v9 offset:20480
    v_mfma_f32_16x16x32_bf16 v[164:167], a[204:207], a[48:51], v[164:167]
    buffer_load_dwordx4 v3, s[8:11], s36 offen offset:128 lds
    v_mfma_f32_16x16x32_bf16 v[164:167], a[200:203], a[32:35], v[164:167]
    s_waitcnt lgkmcnt(4)
    v_add_u32 v9, 98304, v13
    v_mfma_f32_16x16x32_bf16 v[192:195], a[208:211], a[32:35], v[192:195]
    ds_read_b64_tr_b16 a[200:201], v10 offset:2048
    v_mfma_f32_16x16x32_bf16 v[192:195], a[212:215], a[48:51], v[192:195]
    ds_read_b64_tr_b16 a[202:203], v10 offset:8192
    v_mfma_f32_16x16x32_bf16 v[200:203], a[212:215], a[52:55], v[200:203]
    v_mfma_f32_16x16x32_bf16 v[200:203], a[208:211], a[36:39], v[200:203]
    s_add_u32 m0, s49, 4864
    v_mfma_f32_16x16x32_bf16 v[208:211], a[208:211], a[40:43], v[208:211]
    ds_read_b64_tr_b16 a[204:205], v10 offset:14336
    v_mfma_f32_16x16x32_bf16 v[208:211], a[212:215], a[56:59], v[208:211]
    ds_read_b64_tr_b16 a[206:207], v10 offset:20480
    v_mfma_f32_16x16x32_bf16 v[216:219], a[212:215], a[60:63], v[216:219]
    buffer_load_dwordx4 v3, s[8:11], s36 offen offset:256 lds
    v_mfma_f32_16x16x32_bf16 v[216:219], a[208:211], a[44:47], v[216:219]
    s_waitcnt lgkmcnt(4)
    v_add_u32 v10, 98304, v14
    s_add_u32 s36, s36, s37
    v_mfma_f32_16x16x32_bf16 v[220:223], a[192:195], a[44:47], v[220:223]
    s_sub_u32 s55, s36, 7864320
    ds_read_b64_tr_b16 a[208:209], v11 offset:2048
    s_min_u32 s36, s36, s55
    v_mfma_f32_16x16x32_bf16 v[220:223], a[196:199], a[60:63], v[220:223]
    s_add_u32 s46, s45, 28672
    ds_read_b64_tr_b16 a[210:211], v11 offset:8192
    s_sub_u32 s77, s46, 81920
    v_mfma_f32_16x16x32_bf16 v[212:215], a[196:199], a[56:59], v[212:215]
    s_min_u32 s46, s46, s77
    v_mfma_f32_16x16x32_bf16 v[212:215], a[192:195], a[40:43], v[212:215]
    buffer_load_dwordx4 a[112:115], v28, s[20:23], s46 offen offset:0 sc1
    v_mfma_f32_16x16x32_bf16 v[204:207], a[192:195], a[36:39], v[204:207]
    ds_read_b64_tr_b16 a[212:213], v11 offset:14336
    v_mfma_f32_16x16x32_bf16 v[204:207], a[196:199], a[52:55], v[204:207]
    s_waitcnt vmcnt(42)
    ds_read_b64_tr_b16 a[214:215], v11 offset:20480
    v_mfma_f32_16x16x32_bf16 v[196:199], a[196:199], a[48:51], v[196:199]
    s_barrier
    v_mfma_f32_16x16x32_bf16 v[196:199], a[192:195], a[32:35], v[196:199]
    s_waitcnt lgkmcnt(4)
    v_add_u32 v11, 98304, v15
    v_mfma_f32_16x16x32_bf16 v[224:227], a[200:203], a[32:35], v[224:227]
    ds_read_b64_tr_b16 a[192:193], v8 offset:0
    v_mfma_f32_16x16x32_bf16 v[224:227], a[204:207], a[48:51], v[224:227]
    ds_read_b64_tr_b16 a[194:195], v8 offset:6144
    v_mfma_f32_16x16x32_bf16 v[232:235], a[204:207], a[52:55], v[232:235]
    buffer_load_dwordx4 a[116:119], v28, s[20:23], s46 offen offset:1024 sc1
    v_mfma_f32_16x16x32_bf16 v[232:235], a[200:203], a[36:39], v[232:235]
    v_mfma_f32_16x16x32_bf16 v[240:243], a[200:203], a[40:43], v[240:243]
    ds_read_b64_tr_b16 a[196:197], v8 offset:12288
    v_mov_b32 v23, 0
    v_mfma_f32_16x16x32_bf16 v[240:243], a[204:207], a[56:59], v[240:243]
    ds_read_b64_tr_b16 a[198:199], v8 offset:18432
    v_mfma_f32_16x16x32_bf16 v[248:251], a[204:207], a[60:63], v[248:251]
    buffer_load_dword a218, v23, s[24:27], s4 offen offset:128 sc1
    v_mfma_f32_16x16x32_bf16 v[248:251], a[200:203], a[44:47], v[248:251]
    s_waitcnt lgkmcnt(4)
    v_mfma_f32_16x16x32_bf16 v[252:255], a[208:211], a[44:47], v[252:255]
    ds_read_b64_tr_b16 a[200:201], v9 offset:0
    v_mfma_f32_16x16x32_bf16 v[252:255], a[212:215], a[60:63], v[252:255]
    ds_read_b64_tr_b16 a[202:203], v9 offset:6144
    v_mfma_f32_16x16x32_bf16 v[244:247], a[212:215], a[56:59], v[244:247]
    buffer_load_dwordx4 a[120:123], v28, s[20:23], s46 offen offset:2048 sc1
    v_mfma_f32_16x16x32_bf16 v[244:247], a[208:211], a[40:43], v[244:247]
    v_mfma_f32_16x16x32_bf16 v[236:239], a[208:211], a[36:39], v[236:239]
    ds_read_b64_tr_b16 a[204:205], v9 offset:12288
    v_mfma_f32_16x16x32_bf16 v[236:239], a[212:215], a[52:55], v[236:239]
    s_waitcnt vmcnt(18)
    s_waitcnt vmcnt(14)
    ds_read_b64_tr_b16 a[206:207], v9 offset:18432
    v_mfma_f32_16x16x32_bf16 v[228:231], a[212:215], a[48:51], v[228:231]
    buffer_load_dwordx4 a[124:127], v28, s[20:23], s46 offen offset:3072 sc1
    v_mfma_f32_16x16x32_bf16 v[228:231], a[208:211], a[32:35], v[228:231]
    s_waitcnt lgkmcnt(4)
    v_mfma_f32_16x16x32_bf16 v[64:67], a[192:195], a[64:67], v[64:67]
    ds_read_b64_tr_b16 a[208:209], v10 offset:0
    v_mfma_f32_16x16x32_bf16 v[64:67], a[196:199], a[80:83], v[64:67]
    s_add_u32 s46, s45, 32768
    ds_read_b64_tr_b16 a[210:211], v10 offset:6144
    s_sub_u32 s77, s46, 81920
    v_mfma_f32_16x16x32_bf16 v[72:75], a[196:199], a[84:87], v[72:75]
    s_min_u32 s46, s46, s77
    v_mfma_f32_16x16x32_bf16 v[72:75], a[192:195], a[68:71], v[72:75]
    v_mfma_f32_16x16x32_bf16 v[80:83], a[192:195], a[72:75], v[80:83]
    ds_read_b64_tr_b16 a[212:213], v10 offset:12288
    v_mfma_f32_16x16x32_bf16 v[80:83], a[196:199], a[88:91], v[80:83]
    ds_read_b64_tr_b16 a[214:215], v10 offset:18432
    v_mfma_f32_16x16x32_bf16 v[88:91], a[196:199], a[92:95], v[88:91]
    buffer_load_dwordx4 a[128:131], v28, s[20:23], s46 offen offset:0 sc1
    v_mfma_f32_16x16x32_bf16 v[88:91], a[192:195], a[76:79], v[88:91]
    s_waitcnt lgkmcnt(4)
    v_mfma_f32_16x16x32_bf16 v[92:95], a[200:203], a[76:79], v[92:95]
    ds_read_b64_tr_b16 a[192:193], v11 offset:0
    v_mfma_f32_16x16x32_bf16 v[92:95], a[204:207], a[92:95], v[92:95]
    ds_read_b64_tr_b16 a[194:195], v11 offset:6144
    v_mfma_f32_16x16x32_bf16 v[84:87], a[204:207], a[88:91], v[84:87]
    v_mfma_f32_16x16x32_bf16 v[84:87], a[200:203], a[72:75], v[84:87]
    buffer_load_dwordx4 a[132:135], v28, s[20:23], s46 offen offset:1024 sc1
    v_mfma_f32_16x16x32_bf16 v[76:79], a[200:203], a[68:71], v[76:79]
    ds_read_b64_tr_b16 a[196:197], v11 offset:12288
    v_mfma_f32_16x16x32_bf16 v[76:79], a[204:207], a[84:87], v[76:79]
    ds_read_b64_tr_b16 a[198:199], v11 offset:18432
    v_mfma_f32_16x16x32_bf16 v[68:71], a[204:207], a[80:83], v[68:71]
    v_mfma_f32_16x16x32_bf16 v[68:71], a[200:203], a[64:67], v[68:71]
    s_waitcnt lgkmcnt(4)
    v_mfma_f32_16x16x32_bf16 v[96:99], a[208:211], a[64:67], v[96:99]
    ds_read_b64_tr_b16 a[200:201], v8 offset:1024
    v_mfma_f32_16x16x32_bf16 v[96:99], a[212:215], a[80:83], v[96:99]
    ds_read_b64_tr_b16 a[202:203], v8 offset:7168
    v_mfma_f32_16x16x32_bf16 v[104:107], a[212:215], a[84:87], v[104:107]
    buffer_load_dwordx4 a[136:139], v28, s[20:23], s46 offen offset:2048 sc1
    v_mfma_f32_16x16x32_bf16 v[104:107], a[208:211], a[68:71], v[104:107]
    v_mfma_f32_16x16x32_bf16 v[112:115], a[208:211], a[72:75], v[112:115]
    ds_read_b64_tr_b16 a[204:205], v8 offset:13312
    v_mfma_f32_16x16x32_bf16 v[112:115], a[212:215], a[88:91], v[112:115]
    ds_read_b64_tr_b16 a[206:207], v8 offset:19456
    v_mfma_f32_16x16x32_bf16 v[120:123], a[212:215], a[92:95], v[120:123]
    v_mfma_f32_16x16x32_bf16 v[120:123], a[208:211], a[76:79], v[120:123]
    s_waitcnt lgkmcnt(4)
    v_mfma_f32_16x16x32_bf16 v[124:127], a[192:195], a[76:79], v[124:127]
    ds_read_b64_tr_b16 a[208:209], v9 offset:1024
    v_mfma_f32_16x16x32_bf16 v[124:127], a[196:199], a[92:95], v[124:127]
    ds_read_b64_tr_b16 a[210:211], v9 offset:7168
    v_mfma_f32_16x16x32_bf16 v[116:119], a[196:199], a[88:91], v[116:119]
    buffer_load_dwordx4 a[140:143], v28, s[20:23], s46 offen offset:3072 sc1
    v_mfma_f32_16x16x32_bf16 v[116:119], a[192:195], a[72:75], v[116:119]
    v_mfma_f32_16x16x32_bf16 v[108:111], a[192:195], a[68:71], v[108:111]
    ds_read_b64_tr_b16 a[212:213], v9 offset:13312
    v_mfma_f32_16x16x32_bf16 v[108:111], a[196:199], a[84:87], v[108:111]
    ds_read_b64_tr_b16 a[214:215], v9 offset:19456
    v_mfma_f32_16x16x32_bf16 v[100:103], a[196:199], a[80:83], v[100:103]
    s_add_u32 m0, s49, 24576
    v_mfma_f32_16x16x32_bf16 v[100:103], a[192:195], a[64:67], v[100:103]
    s_waitcnt lgkmcnt(4)
    v_mfma_f32_16x16x32_bf16 v[128:131], a[200:203], a[64:67], v[128:131]
    ds_read_b64_tr_b16 a[192:193], v10 offset:1024
    v_mfma_f32_16x16x32_bf16 v[128:131], a[204:207], a[80:83], v[128:131]
    ds_read_b64_tr_b16 a[194:195], v10 offset:7168
    v_mfma_f32_16x16x32_bf16 v[136:139], a[204:207], a[84:87], v[136:139]
    buffer_load_dwordx4 v2, s[8:11], s36 offen offset:0 lds
    v_mfma_f32_16x16x32_bf16 v[136:139], a[200:203], a[68:71], v[136:139]
    v_mfma_f32_16x16x32_bf16 v[144:147], a[200:203], a[72:75], v[144:147]
    s_add_u32 m0, s49, 25472
    ds_read_b64_tr_b16 a[196:197], v10 offset:13312
    v_mfma_f32_16x16x32_bf16 v[144:147], a[204:207], a[88:91], v[144:147]
    ds_read_b64_tr_b16 a[198:199], v10 offset:19456
    v_mfma_f32_16x16x32_bf16 v[152:155], a[204:207], a[92:95], v[152:155]
    buffer_load_dwordx4 v2, s[8:11], s36 offen offset:128 lds
    v_mfma_f32_16x16x32_bf16 v[152:155], a[200:203], a[76:79], v[152:155]
    s_waitcnt lgkmcnt(4)
    v_mfma_f32_16x16x32_bf16 v[156:159], a[208:211], a[76:79], v[156:159]
    ds_read_b64_tr_b16 a[200:201], v11 offset:1024
    v_mfma_f32_16x16x32_bf16 v[156:159], a[212:215], a[92:95], v[156:159]
    ds_read_b64_tr_b16 a[202:203], v11 offset:7168
    v_mfma_f32_16x16x32_bf16 v[148:151], a[212:215], a[88:91], v[148:151]
    buffer_load_dwordx4 v[32:35], v17, s[24:27], s47 offen offset:0 sc1
    v_mfma_f32_16x16x32_bf16 v[148:151], a[208:211], a[72:75], v[148:151]
    s_add_u32 m0, s49, 26368
    v_mfma_f32_16x16x32_bf16 v[140:143], a[208:211], a[68:71], v[140:143]
    ds_read_b64_tr_b16 a[204:205], v11 offset:13312
    v_mfma_f32_16x16x32_bf16 v[140:143], a[212:215], a[84:87], v[140:143]
    ds_read_b64_tr_b16 a[206:207], v11 offset:19456
    v_mfma_f32_16x16x32_bf16 v[132:135], a[212:215], a[80:83], v[132:135]
    buffer_load_dwordx4 v2, s[8:11], s36 offen offset:256 lds
    v_mfma_f32_16x16x32_bf16 v[132:135], a[208:211], a[64:67], v[132:135]
    s_waitcnt lgkmcnt(4)
    v_mfma_f32_16x16x32_bf16 v[160:163], a[192:195], a[64:67], v[160:163]
    ds_read_b64_tr_b16 a[208:209], v8 offset:2048
    v_mfma_f32_16x16x32_bf16 v[160:163], a[196:199], a[80:83], v[160:163]
    s_add_u32 m0, s49, 27648
    ds_read_b64_tr_b16 a[210:211], v8 offset:8192
    v_mfma_f32_16x16x32_bf16 v[168:171], a[196:199], a[84:87], v[168:171]
    buffer_load_dwordx4 v3, s[8:11], s36 offen offset:0 lds
    v_mfma_f32_16x16x32_bf16 v[168:171], a[192:195], a[68:71], v[168:171]
    v_mfma_f32_16x16x32_bf16 v[176:179], a[192:195], a[72:75], v[176:179]
    ds_read_b64_tr_b16 a[212:213], v8 offset:14336
    v_mfma_f32_16x16x32_bf16 v[176:179], a[196:199], a[88:91], v[176:179]
    ds_read_b64_tr_b16 a[214:215], v8 offset:20480
    v_mfma_f32_16x16x32_bf16 v[184:187], a[196:199], a[92:95], v[184:187]
    buffer_load_dwordx4 v[36:39], v17, s[24:27], s47 offen offset:1024 sc1
    v_mfma_f32_16x16x32_bf16 v[184:187], a[192:195], a[76:79], v[184:187]
    s_waitcnt lgkmcnt(4)
    v_add_u32 v8, 122880, v12
    v_mfma_f32_16x16x32_bf16 v[188:191], a[200:203], a[76:79], v[188:191]
    s_add_u32 m0, s49, 28544
    ds_read_b64_tr_b16 a[192:193], v9 offset:2048
    v_mfma_f32_16x16x32_bf16 v[188:191], a[204:207], a[92:95], v[188:191]
    ds_read_b64_tr_b16 a[194:195], v9 offset:8192
    v_mfma_f32_16x16x32_bf16 v[180:183], a[204:207], a[88:91], v[180:183]
    buffer_load_dwordx4 v3, s[8:11], s36 offen offset:128 lds
    v_mfma_f32_16x16x32_bf16 v[180:183], a[200:203], a[72:75], v[180:183]
    v_mfma_f32_16x16x32_bf16 v[172:175], a[200:203], a[68:71], v[172:175]
    ds_read_b64_tr_b16 a[196:197], v9 offset:14336
    v_mfma_f32_16x16x32_bf16 v[172:175], a[204:207], a[84:87], v[172:175]
    ds_read_b64_tr_b16 a[198:199], v9 offset:20480
    v_mfma_f32_16x16x32_bf16 v[164:167], a[204:207], a[80:83], v[164:167]
    s_add_u32 m0, s49, 29440
    v_add_u32 v9, 122880, v13
    v_mfma_f32_16x16x32_bf16 v[164:167], a[200:203], a[64:67], v[164:167]
    s_waitcnt lgkmcnt(4)
    v_mfma_f32_16x16x32_bf16 v[192:195], a[208:211], a[64:67], v[192:195]
    ds_read_b64_tr_b16 a[200:201], v10 offset:2048
    v_mfma_f32_16x16x32_bf16 v[192:195], a[212:215], a[80:83], v[192:195]
    ds_read_b64_tr_b16 a[202:203], v10 offset:8192
    v_mfma_f32_16x16x32_bf16 v[200:203], a[212:215], a[84:87], v[200:203]
    buffer_load_dwordx4 v3, s[8:11], s36 offen offset:256 lds
    v_mfma_f32_16x16x32_bf16 v[200:203], a[208:211], a[68:71], v[200:203]
    buffer_load_dwordx4 v[40:43], v17, s[24:27], s47 offen offset:2048 sc1
    v_mfma_f32_16x16x32_bf16 v[208:211], a[208:211], a[72:75], v[208:211]
    s_add_u32 s36, s36, s37
    ds_read_b64_tr_b16 a[204:205], v10 offset:14336
    s_sub_u32 s55, s36, 7864320
    v_mfma_f32_16x16x32_bf16 v[208:211], a[212:215], a[88:91], v[208:211]
    s_min_u32 s36, s36, s55
    ds_read_b64_tr_b16 a[206:207], v10 offset:20480
    s_add_u32 s46, s45, 36864
    v_mfma_f32_16x16x32_bf16 v[216:219], a[212:215], a[92:95], v[216:219]
    s_sub_u32 s77, s46, 81920
    v_add_u32 v10, 122880, v14
    s_min_u32 s46, s46, s77
    v_mfma_f32_16x16x32_bf16 v[216:219], a[208:211], a[76:79], v[216:219]
    s_waitcnt lgkmcnt(4)
    v_mfma_f32_16x16x32_bf16 v[220:223], a[192:195], a[76:79], v[220:223]
    ds_read_b64_tr_b16 a[208:209], v11 offset:2048
    v_mfma_f32_16x16x32_bf16 v[220:223], a[196:199], a[92:95], v[220:223]
    ds_read_b64_tr_b16 a[210:211], v11 offset:8192
    v_mfma_f32_16x16x32_bf16 v[212:215], a[196:199], a[88:91], v[212:215]
    buffer_load_dwordx4 a[144:147], v28, s[20:23], s46 offen offset:0 sc1
    v_mfma_f32_16x16x32_bf16 v[212:215], a[192:195], a[72:75], v[212:215]
    v_mfma_f32_16x16x32_bf16 v[204:207], a[192:195], a[68:71], v[204:207]
    ds_read_b64_tr_b16 a[212:213], v11 offset:14336
    v_mfma_f32_16x16x32_bf16 v[204:207], a[196:199], a[84:87], v[204:207]
    s_waitcnt vmcnt(54)
    ds_read_b64_tr_b16 a[214:215], v11 offset:20480
    v_mfma_f32_16x16x32_bf16 v[196:199], a[196:199], a[80:83], v[196:199]
    s_barrier
    v_mfma_f32_16x16x32_bf16 v[196:199], a[192:195], a[64:67], v[196:199]
    s_waitcnt lgkmcnt(4)
    buffer_load_dwordx4 a[148:151], v28, s[20:23], s46 offen offset:1024 sc1
    v_mfma_f32_16x16x32_bf16 v[224:227], a[200:203], a[64:67], v[224:227]
    ds_read_b64_tr_b16 a[192:193], v8 offset:0
    v_add_u32 v11, 122880, v15
    v_mfma_f32_16x16x32_bf16 v[224:227], a[204:207], a[80:83], v[224:227]
    ds_read_b64_tr_b16 a[194:195], v8 offset:6144
    v_mfma_f32_16x16x32_bf16 v[232:235], a[204:207], a[84:87], v[232:235]
    buffer_load_dwordx4 v[44:47], v17, s[24:27], s47 offen offset:3072 sc1
    v_mfma_f32_16x16x32_bf16 v[232:235], a[200:203], a[68:71], v[232:235]
    buffer_load_dwordx4 a[152:155], v28, s[20:23], s46 offen offset:2048 sc1
    v_mfma_f32_16x16x32_bf16 v[240:243], a[200:203], a[72:75], v[240:243]
    ds_read_b64_tr_b16 a[196:197], v8 offset:12288
    v_mfma_f32_16x16x32_bf16 v[240:243], a[204:207], a[88:91], v[240:243]
    ds_read_b64_tr_b16 a[198:199], v8 offset:18432
    v_mfma_f32_16x16x32_bf16 v[248:251], a[204:207], a[92:95], v[248:251]
    v_mfma_f32_16x16x32_bf16 v[248:251], a[200:203], a[76:79], v[248:251]
    s_waitcnt lgkmcnt(4)
    v_mfma_f32_16x16x32_bf16 v[252:255], a[208:211], a[76:79], v[252:255]
    ds_read_b64_tr_b16 a[200:201], v9 offset:0
    v_mfma_f32_16x16x32_bf16 v[252:255], a[212:215], a[92:95], v[252:255]
    ds_read_b64_tr_b16 a[202:203], v9 offset:6144
    v_mfma_f32_16x16x32_bf16 v[244:247], a[212:215], a[88:91], v[244:247]
    buffer_load_dwordx4 a[156:159], v28, s[20:23], s46 offen offset:3072 sc1
    v_mfma_f32_16x16x32_bf16 v[244:247], a[208:211], a[72:75], v[244:247]
    v_mfma_f32_16x16x32_bf16 v[236:239], a[208:211], a[68:71], v[236:239]
    s_add_u32 s46, s45, 40960
    ds_read_b64_tr_b16 a[204:205], v9 offset:12288
    s_sub_u32 s77, s46, 81920
    v_mfma_f32_16x16x32_bf16 v[236:239], a[212:215], a[84:87], v[236:239]
    s_waitcnt vmcnt(29)
    s_waitcnt vmcnt(18)
    ds_read_b64_tr_b16 a[206:207], v9 offset:18432
    v_mfma_f32_16x16x32_bf16 v[228:231], a[212:215], a[80:83], v[228:231]
    s_min_u32 s46, s46, s77
    v_mfma_f32_16x16x32_bf16 v[228:231], a[208:211], a[64:67], v[228:231]
    s_waitcnt lgkmcnt(4)
    v_mfma_f32_16x16x32_bf16 v[64:67], a[192:195], a[96:99], v[64:67]
    ds_read_b64_tr_b16 a[208:209], v10 offset:0
    v_mfma_f32_16x16x32_bf16 v[64:67], a[196:199], a[112:115], v[64:67]
    ds_read_b64_tr_b16 a[210:211], v10 offset:6144
    v_mfma_f32_16x16x32_bf16 v[72:75], a[196:199], a[116:119], v[72:75]
    buffer_load_dwordx4 a[160:163], v28, s[20:23], s46 offen offset:0 sc1
    v_mfma_f32_16x16x32_bf16 v[72:75], a[192:195], a[100:103], v[72:75]
    v_mfma_f32_16x16x32_bf16 v[80:83], a[192:195], a[104:107], v[80:83]
    ds_read_b64_tr_b16 a[212:213], v10 offset:12288
    v_mfma_f32_16x16x32_bf16 v[80:83], a[196:199], a[120:123], v[80:83]
    ds_read_b64_tr_b16 a[214:215], v10 offset:18432
    v_mfma_f32_16x16x32_bf16 v[88:91], a[196:199], a[124:127], v[88:91]
    buffer_load_dwordx4 a[164:167], v28, s[20:23], s46 offen offset:1024 sc1
    v_mfma_f32_16x16x32_bf16 v[88:91], a[192:195], a[108:111], v[88:91]
    s_waitcnt lgkmcnt(4)
    v_mfma_f32_16x16x32_bf16 v[92:95], a[200:203], a[108:111], v[92:95]
    ds_read_b64_tr_b16 a[192:193], v11 offset:0
    v_mfma_f32_16x16x32_bf16 v[92:95], a[204:207], a[124:127], v[92:95]
    ds_read_b64_tr_b16 a[194:195], v11 offset:6144
    v_mfma_f32_16x16x32_bf16 v[84:87], a[204:207], a[120:123], v[84:87]
    v_mfma_f32_16x16x32_bf16 v[84:87], a[200:203], a[104:107], v[84:87]
    v_mfma_f32_16x16x32_bf16 v[76:79], a[200:203], a[100:103], v[76:79]
    ds_read_b64_tr_b16 a[196:197], v11 offset:12288
    v_mfma_f32_16x16x32_bf16 v[76:79], a[204:207], a[116:119], v[76:79]
    ds_read_b64_tr_b16 a[198:199], v11 offset:18432
    v_mfma_f32_16x16x32_bf16 v[68:71], a[204:207], a[112:115], v[68:71]
    buffer_load_dwordx4 a[168:171], v28, s[20:23], s46 offen offset:2048 sc1
    v_mfma_f32_16x16x32_bf16 v[68:71], a[200:203], a[96:99], v[68:71]
    s_waitcnt lgkmcnt(4)
    v_mfma_f32_16x16x32_bf16 v[96:99], a[208:211], a[96:99], v[96:99]
    ds_read_b64_tr_b16 a[200:201], v8 offset:1024
    v_mfma_f32_16x16x32_bf16 v[96:99], a[212:215], a[112:115], v[96:99]
    ds_read_b64_tr_b16 a[202:203], v8 offset:7168
    v_mfma_f32_16x16x32_bf16 v[104:107], a[212:215], a[116:119], v[104:107]
    v_mfma_f32_16x16x32_bf16 v[104:107], a[208:211], a[100:103], v[104:107]
    buffer_load_dwordx4 a[172:175], v28, s[20:23], s46 offen offset:3072 sc1
    v_mfma_f32_16x16x32_bf16 v[112:115], a[208:211], a[104:107], v[112:115]
    ds_read_b64_tr_b16 a[204:205], v8 offset:13312
    v_mfma_f32_16x16x32_bf16 v[112:115], a[212:215], a[120:123], v[112:115]
    ds_read_b64_tr_b16 a[206:207], v8 offset:19456
    v_mfma_f32_16x16x32_bf16 v[120:123], a[212:215], a[124:127], v[120:123]
    v_mfma_f32_16x16x32_bf16 v[120:123], a[208:211], a[108:111], v[120:123]
    s_waitcnt lgkmcnt(4)
    v_mfma_f32_16x16x32_bf16 v[124:127], a[192:195], a[108:111], v[124:127]
    ds_read_b64_tr_b16 a[208:209], v9 offset:1024
    v_mfma_f32_16x16x32_bf16 v[124:127], a[196:199], a[124:127], v[124:127]
    s_add_u32 m0, s49, 49152
    ds_read_b64_tr_b16 a[210:211], v9 offset:7168
    v_mfma_f32_16x16x32_bf16 v[116:119], a[196:199], a[120:123], v[116:119]
    buffer_load_dwordx4 v2, s[8:11], s36 offen offset:0 lds
    v_mfma_f32_16x16x32_bf16 v[116:119], a[192:195], a[104:107], v[116:119]
    v_mfma_f32_16x16x32_bf16 v[108:111], a[192:195], a[100:103], v[108:111]
    ds_read_b64_tr_b16 a[212:213], v9 offset:13312
    v_mfma_f32_16x16x32_bf16 v[108:111], a[196:199], a[116:119], v[108:111]
    ds_read_b64_tr_b16 a[214:215], v9 offset:19456
    v_mfma_f32_16x16x32_bf16 v[100:103], a[196:199], a[112:115], v[100:103]
    v_mfma_f32_16x16x32_bf16 v[100:103], a[192:195], a[96:99], v[100:103]
    s_waitcnt lgkmcnt(4)
    s_add_u32 m0, s49, 50048
    v_mfma_f32_16x16x32_bf16 v[128:131], a[200:203], a[96:99], v[128:131]
    ds_read_b64_tr_b16 a[192:193], v10 offset:1024
    v_mfma_f32_16x16x32_bf16 v[128:131], a[204:207], a[112:115], v[128:131]
    ds_read_b64_tr_b16 a[194:195], v10 offset:7168
    v_mfma_f32_16x16x32_bf16 v[136:139], a[204:207], a[116:119], v[136:139]
    buffer_load_dwordx4 v2, s[8:11], s36 offen offset:128 lds
    v_mfma_f32_16x16x32_bf16 v[136:139], a[200:203], a[100:103], v[136:139]
    v_mfma_f32_16x16x32_bf16 v[144:147], a[200:203], a[104:107], v[144:147]
    ds_read_b64_tr_b16 a[196:197], v10 offset:13312
    v_mfma_f32_16x16x32_bf16 v[144:147], a[204:207], a[120:123], v[144:147]
    ds_read_b64_tr_b16 a[198:199], v10 offset:19456
    v_mfma_f32_16x16x32_bf16 v[152:155], a[204:207], a[124:127], v[152:155]
    s_add_u32 m0, s49, 50944
    v_mfma_f32_16x16x32_bf16 v[152:155], a[200:203], a[108:111], v[152:155]
    s_waitcnt lgkmcnt(4)
    v_mfma_f32_16x16x32_bf16 v[156:159], a[208:211], a[108:111], v[156:159]
    ds_read_b64_tr_b16 a[200:201], v11 offset:1024
    v_mfma_f32_16x16x32_bf16 v[156:159], a[212:215], a[124:127], v[156:159]
    ds_read_b64_tr_b16 a[202:203], v11 offset:7168
    v_mfma_f32_16x16x32_bf16 v[148:151], a[212:215], a[120:123], v[148:151]
    buffer_load_dwordx4 v2, s[8:11], s36 offen offset:256 lds
    v_mfma_f32_16x16x32_bf16 v[148:151], a[208:211], a[104:107], v[148:151]
    v_mfma_f32_16x16x32_bf16 v[140:143], a[208:211], a[100:103], v[140:143]
    s_add_u32 m0, s49, 52224
    ds_read_b64_tr_b16 a[204:205], v11 offset:13312
    v_mfma_f32_16x16x32_bf16 v[140:143], a[212:215], a[116:119], v[140:143]
    ds_read_b64_tr_b16 a[206:207], v11 offset:19456
    v_mfma_f32_16x16x32_bf16 v[132:135], a[212:215], a[112:115], v[132:135]
    buffer_load_dwordx4 v3, s[8:11], s36 offen offset:0 lds
    v_mfma_f32_16x16x32_bf16 v[132:135], a[208:211], a[96:99], v[132:135]
    s_waitcnt lgkmcnt(4)
    v_mfma_f32_16x16x32_bf16 v[160:163], a[192:195], a[96:99], v[160:163]
    ds_read_b64_tr_b16 a[208:209], v8 offset:2048
    v_mfma_f32_16x16x32_bf16 v[160:163], a[196:199], a[112:115], v[160:163]
    ds_read_b64_tr_b16 a[210:211], v8 offset:8192
    v_mfma_f32_16x16x32_bf16 v[168:171], a[196:199], a[116:119], v[168:171]
    v_mfma_f32_16x16x32_bf16 v[168:171], a[192:195], a[100:103], v[168:171]
    s_add_u32 m0, s49, 53120
    v_mfma_f32_16x16x32_bf16 v[176:179], a[192:195], a[104:107], v[176:179]
    ds_read_b64_tr_b16 a[212:213], v8 offset:14336
    v_mfma_f32_16x16x32_bf16 v[176:179], a[196:199], a[120:123], v[176:179]
    ds_read_b64_tr_b16 a[214:215], v8 offset:20480
    v_mfma_f32_16x16x32_bf16 v[184:187], a[196:199], a[124:127], v[184:187]
    buffer_load_dwordx4 v3, s[8:11], s36 offen offset:128 lds
    v_mfma_f32_16x16x32_bf16 v[184:187], a[192:195], a[108:111], v[184:187]
    s_waitcnt lgkmcnt(4)
    v_add_u32 v8, 0, v12
    v_mfma_f32_16x16x32_bf16 v[188:191], a[200:203], a[108:111], v[188:191]
    ds_read_b64_tr_b16 a[192:193], v9 offset:2048
    v_mfma_f32_16x16x32_bf16 v[188:191], a[204:207], a[124:127], v[188:191]
    s_add_u32 m0, s49, 54016
    ds_read_b64_tr_b16 a[194:195], v9 offset:8192
    v_mfma_f32_16x16x32_bf16 v[180:183], a[204:207], a[120:123], v[180:183]
    buffer_load_dwordx4 v3, s[8:11], s36 offen offset:256 lds
    v_mfma_f32_16x16x32_bf16 v[180:183], a[200:203], a[104:107], v[180:183]
    s_add_u32 s36, s36, s37
    s_sub_u32 s55, s36, 7864320
    s_min_u32 s36, s36, s55
    v_mfma_f32_16x16x32_bf16 v[172:175], a[200:203], a[100:103], v[172:175]
    ds_read_b64_tr_b16 a[196:197], v9 offset:14336
    v_mfma_f32_16x16x32_bf16 v[172:175], a[204:207], a[116:119], v[172:175]
    s_add_u32 s46, s45, 45056
    ds_read_b64_tr_b16 a[198:199], v9 offset:20480
    s_sub_u32 s77, s46, 81920
    v_mfma_f32_16x16x32_bf16 v[164:167], a[204:207], a[112:115], v[164:167]
    s_min_u32 s46, s46, s77
    v_add_u32 v9, 0, v13
    v_mfma_f32_16x16x32_bf16 v[164:167], a[200:203], a[96:99], v[164:167]
    s_waitcnt lgkmcnt(4)
    v_mfma_f32_16x16x32_bf16 v[192:195], a[208:211], a[96:99], v[192:195]
    ds_read_b64_tr_b16 a[200:201], v10 offset:2048
    v_mfma_f32_16x16x32_bf16 v[192:195], a[212:215], a[112:115], v[192:195]
    ds_read_b64_tr_b16 a[202:203], v10 offset:8192
    v_mfma_f32_16x16x32_bf16 v[200:203], a[212:215], a[116:119], v[200:203]
    buffer_load_dwordx4 a[176:179], v28, s[20:23], s46 offen offset:0 sc1
    v_mfma_f32_16x16x32_bf16 v[200:203], a[208:211], a[100:103], v[200:203]
    v_mfma_f32_16x16x32_bf16 v[208:211], a[208:211], a[104:107], v[208:211]
    ds_read_b64_tr_b16 a[204:205], v10 offset:14336
    v_mfma_f32_16x16x32_bf16 v[208:211], a[212:215], a[120:123], v[208:211]
    ds_read_b64_tr_b16 a[206:207], v10 offset:20480
    v_mfma_f32_16x16x32_bf16 v[216:219], a[212:215], a[124:127], v[216:219]
    v_add_u32 v10, 0, v14
    v_mfma_f32_16x16x32_bf16 v[216:219], a[208:211], a[108:111], v[216:219]
    s_waitcnt lgkmcnt(4)
    v_mfma_f32_16x16x32_bf16 v[220:223], a[192:195], a[108:111], v[220:223]
    s_waitcnt vmcnt(13)
    ds_read_b64_tr_b16 a[208:209], v11 offset:2048
    v_xor_b32 v34, s7, v34
    v_mfma_f32_16x16x32_bf16 v[220:223], a[196:199], a[124:127], v[220:223]
    ds_read_b64_tr_b16 a[210:211], v11 offset:8192
    v_xor_b32 v38, s7, v38
    v_mfma_f32_16x16x32_bf16 v[212:215], a[196:199], a[120:123], v[212:215]
    buffer_load_dwordx4 a[180:183], v28, s[20:23], s46 offen offset:1024 sc1
    v_mfma_f32_16x16x32_bf16 v[212:215], a[192:195], a[104:107], v[212:215]
    v_xor_b32 v42, s7, v42
    v_xor_b32 v46, s7, v46
    v_mfma_f32_16x16x32_bf16 v[204:207], a[192:195], a[100:103], v[204:207]
    ds_read_b64_tr_b16 a[212:213], v11 offset:14336
    v_or3_b32 v34, v34, v38, v42
    v_mfma_f32_16x16x32_bf16 v[204:207], a[196:199], a[116:119], v[204:207]
    s_waitcnt vmcnt(35)
    ds_read_b64_tr_b16 a[214:215], v11 offset:20480
    v_or_b32 v34, v34, v46
    v_mfma_f32_16x16x32_bf16 v[196:199], a[196:199], a[112:115], v[196:199]
pg_2:
    s_cbranch_execz pg_ret
    s_barrier
    v_mfma_f32_16x16x32_bf16 v[196:199], a[192:195], a[96:99], v[196:199]
    s_waitcnt lgkmcnt(4)
    v_cmp_ne_u32 vcc, 0, v34
    v_add_u32 v11, 0, v15
    v_mfma_f32_16x16x32_bf16 v[224:227], a[200:203], a[96:99], v[224:227]
    ds_read_b64_tr_b16 a[192:193], v8 offset:0
    v_mfma_f32_16x16x32_bf16 v[224:227], a[204:207], a[112:115], v[224:227]
    ds_read_b64_tr_b16 a[194:195], v8 offset:6144
    v_mfma_f32_16x16x32_bf16 v[232:235], a[204:207], a[116:119], v[232:235]
    s_cbranch_vccnz spin_rec
spin_rec_ret:
    v_max_u32 v20, v32, v33
    v_mfma_f32_16x16x32_bf16 v[232:235], a[200:203], a[100:103], v[232:235]
    buffer_load_dwordx4 a[184:187], v28, s[20:23], s46 offen offset:2048 sc1
    v_mfma_f32_16x16x32_bf16 v[240:243], a[200:203], a[104:107], v[240:243]
    ds_read_b64_tr_b16 a[196:197], v8 offset:12288
    v_min_u32 v21, v32, v33
    v_mfma_f32_16x16x32_bf16 v[240:243], a[204:207], a[120:123], v[240:243]
    ds_read_b64_tr_b16 a[198:199], v8 offset:18432
    v_med3_u32 v21, v20, v21, v36
    v_mfma_f32_16x16x32_bf16 v[248:251], a[204:207], a[124:127], v[248:251]
    buffer_load_dwordx4 a[188:191], v28, s[20:23], s46 offen offset:3072 sc1
    v_mfma_f32_16x16x32_bf16 v[248:251], a[200:203], a[108:111], v[248:251]
    s_waitcnt lgkmcnt(4)
    v_max_u32 v20, v20, v36
    v_med3_u32 v21, v20, v21, v37
    v_mfma_f32_16x16x32_bf16 v[252:255], a[208:211], a[108:111], v[252:255]
    s_add_u32 s46, s45, 49152
    ds_read_b64_tr_b16 a[200:201], v9 offset:0
    v_max_u32 v20, v20, v37
    v_mfma_f32_16x16x32_bf16 v[252:255], a[212:215], a[124:127], v[252:255]
    s_sub_u32 s77, s46, 81920
    ds_read_b64_tr_b16 a[202:203], v9 offset:6144
    v_med3_u32 v21, v20, v21, v40
    v_mfma_f32_16x16x32_bf16 v[244:247], a[212:215], a[120:123], v[244:247]
    s_min_u32 s46, s46, s77
    v_max_u32 v20, v20, v40
    v_med3_u32 v21, v20, v21, v41
    v_mfma_f32_16x16x32_bf16 v[244:247], a[208:211], a[104:107], v[244:247]
    buffer_load_dwordx4 a[0:3], v28, s[20:23], s46 offen offset:0 sc1
    v_mfma_f32_16x16x32_bf16 v[236:239], a[208:211], a[100:103], v[236:239]
    ds_read_b64_tr_b16 a[204:205], v9 offset:12288
    v_max_u32 v20, v20, v41
    v_mfma_f32_16x16x32_bf16 v[236:239], a[212:215], a[116:119], v[236:239]
    s_waitcnt vmcnt(29)
    s_waitcnt vmcnt(15)
    ds_read_b64_tr_b16 a[206:207], v9 offset:18432
    v_mfma_f32_16x16x32_bf16 v[228:231], a[212:215], a[112:115], v[228:231]
    v_med3_u32 v21, v20, v21, v44
    v_max_u32 v20, v20, v44
    v_mfma_f32_16x16x32_bf16 v[228:231], a[208:211], a[96:99], v[228:231]
    s_waitcnt lgkmcnt(4)
    v_med3_u32 v21, v20, v21, v45
    v_max_u32 v20, v20, v45
    v_mfma_f32_16x16x32_bf16 v[64:67], a[192:195], a[128:131], v[64:67]
    ds_read_b64_tr_b16 a[208:209], v10 offset:0
    v_mov_b32_dpp v22, v20 row_ror:8 row_mask:0xf bank_mask:0xf
    v_mfma_f32_16x16x32_bf16 v[64:67], a[196:199], a[144:147], v[64:67]
    ds_read_b64_tr_b16 a[210:211], v10 offset:6144
    v_mov_b32_dpp v23, v21 row_ror:8 row_mask:0xf bank_mask:0xf
    v_mfma_f32_16x16x32_bf16 v[72:75], a[196:199], a[148:151], v[72:75]
    buffer_load_dwordx4 a[4:7], v28, s[20:23], s46 offen offset:1024 sc1
    v_mfma_f32_16x16x32_bf16 v[72:75], a[192:195], a[132:135], v[72:75]
    v_min_u32 v24, v20, v22
    v_max_u32 v20, v20, v22
    v_mfma_f32_16x16x32_bf16 v[80:83], a[192:195], a[136:139], v[80:83]
    ds_read_b64_tr_b16 a[212:213], v10 offset:12288
    v_max3_u32 v21, v24, v21, v23
    v_mfma_f32_16x16x32_bf16 v[80:83], a[196:199], a[152:155], v[80:83]
    ds_read_b64_tr_b16 a[214:215], v10 offset:18432
    v_mov_b32_dpp v22, v20 row_ror:4 row_mask:0xf bank_mask:0xf
    v_mfma_f32_16x16x32_bf16 v[88:91], a[196:199], a[156:159], v[88:91]
    v_mov_b32_dpp v23, v21 row_ror:4 row_mask:0xf bank_mask:0xf
    v_min_u32 v24, v20, v22
    v_mfma_f32_16x16x32_bf16 v[88:91], a[192:195], a[140:143], v[88:91]
    s_waitcnt lgkmcnt(4)
    v_max_u32 v20, v20, v22
    v_max3_u32 v21, v24, v21, v23
    v_mfma_f32_16x16x32_bf16 v[92:95], a[200:203], a[140:143], v[92:95]
    ds_read_b64_tr_b16 a[192:193], v11 offset:0
    v_mov_b32_dpp v22, v20 row_ror:2 row_mask:0xf bank_mask:0xf
    v_mfma_f32_16x16x32_bf16 v[92:95], a[204:207], a[156:159], v[92:95]
    ds_read_b64_tr_b16 a[194:195], v11 offset:6144
    v_mov_b32_dpp v23, v21 row_ror:2 row_mask:0xf bank_mask:0xf
    v_mfma_f32_16x16x32_bf16 v[84:87], a[204:207], a[152:155], v[84:87]
    buffer_load_dwordx4 a[8:11], v28, s[20:23], s46 offen offset:2048 sc1
    v_mfma_f32_16x16x32_bf16 v[84:87], a[200:203], a[136:139], v[84:87]
    v_min_u32 v24, v20, v22
    v_max_u32 v20, v20, v22
    v_mfma_f32_16x16x32_bf16 v[76:79], a[200:203], a[132:135], v[76:79]
    ds_read_b64_tr_b16 a[196:197], v11 offset:12288
    v_max3_u32 v21, v24, v21, v23
    v_mfma_f32_16x16x32_bf16 v[76:79], a[204:207], a[148:151], v[76:79]
    ds_read_b64_tr_b16 a[198:199], v11 offset:18432
    v_mov_b32_dpp v22, v20 row_ror:1 row_mask:0xf bank_mask:0xf
    v_mfma_f32_16x16x32_bf16 v[68:71], a[204:207], a[144:147], v[68:71]
    buffer_load_dwordx4 a[12:15], v28, s[20:23], s46 offen offset:3072 sc1
    v_mfma_f32_16x16x32_bf16 v[68:71], a[200:203], a[128:131], v[68:71]
    s_waitcnt lgkmcnt(4)
    v_mov_b32_dpp v23, v21 row_ror:1 row_mask:0xf bank_mask:0xf
    v_min_u32 v24, v20, v22
    v_mfma_f32_16x16x32_bf16 v[96:99], a[208:211], a[128:131], v[96:99]
    s_andn2_b32 s88, s2, 7
    ds_read_b64_tr_b16 a[200:201], v8 offset:1024
    v_max_u32 v20, v20, v22
    v_mfma_f32_16x16x32_bf16 v[96:99], a[212:215], a[144:147], v[96:99]
    s_lshl_b32 s88, s88, 2
    ds_read_b64_tr_b16 a[202:203], v8 offset:7168
    v_max3_u32 v21, v24, v21, v23
    v_mfma_f32_16x16x32_bf16 v[104:107], a[212:215], a[148:151], v[104:107]
    s_lshr_b32 s89, s53, 1
    v_mov_b32 v22, v20
    v_mov_b32 v23, v21
    v_mfma_f32_16x16x32_bf16 v[104:107], a[208:211], a[132:135], v[104:107]
    s_add_u32 s88, s88, s89
    v_permlane16_swap_b32 v20, v22
    v_mfma_f32_16x16x32_bf16 v[112:115], a[208:211], a[136:139], v[112:115]
    s_add_u32 m0, s49, 73728
    ds_read_b64_tr_b16 a[204:205], v8 offset:13312
    v_lshl_add_u32 v60, v1, 2, s88
    v_mfma_f32_16x16x32_bf16 v[112:115], a[212:215], a[152:155], v[112:115]
    s_andn2_b32 s88, s2, 0x18
    ds_read_b64_tr_b16 a[206:207], v8 offset:19456
    v_accvgpr_write_b32 a96, 0
    v_mfma_f32_16x16x32_bf16 v[120:123], a[212:215], a[156:159], v[120:123]
    buffer_load_dwordx4 v2, s[8:11], s36 offen offset:0 lds
    v_mfma_f32_16x16x32_bf16 v[120:123], a[208:211], a[140:143], v[120:123]
    s_waitcnt lgkmcnt(4)
    v_permlane16_swap_b32 v21, v23
    v_mfma_f32_16x16x32_bf16 v[124:127], a[192:195], a[140:143], v[124:127]
    s_lshl_b32 s88, s88, 2
    ds_read_b64_tr_b16 a[208:209], v9 offset:1024
    v_min_u32 v24, v20, v22
    v_mfma_f32_16x16x32_bf16 v[124:127], a[196:199], a[156:159], v[124:127]
    s_add_u32 s88, s88, s3
    ds_read_b64_tr_b16 a[210:211], v9 offset:7168
    v_max_u32 v20, v20, v22
    v_mfma_f32_16x16x32_bf16 v[116:119], a[196:199], a[152:155], v[116:119]
    s_add_u32 m0, s49, 74624
    v_max3_u32 v21, v24, v21, v23
    v_mov_b32 v22, v20
    v_mfma_f32_16x16x32_bf16 v[116:119], a[192:195], a[136:139], v[116:119]
    buffer_load_dwordx4 v2, s[8:11], s36 offen offset:128 lds
    v_mfma_f32_16x16x32_bf16 v[108:111], a[192:195], a[132:135], v[108:111]
    ds_read_b64_tr_b16 a[212:213], v9 offset:13312
    v_mov_b32 v23, v21
    v_mfma_f32_16x16x32_bf16 v[108:111], a[196:199], a[148:151], v[108:111]
    ds_read_b64_tr_b16 a[214:215], v9 offset:19456
    v_and_b32 v61, 3, v1
    v_mfma_f32_16x16x32_bf16 v[100:103], a[196:199], a[144:147], v[100:103]
    v_permlane32_swap_b32 v20, v22
    v_mfma_f32_16x16x32_bf16 v[100:103], a[192:195], a[128:131], v[100:103]
    s_waitcnt lgkmcnt(4)
    v_permlane32_swap_b32 v21, v23
    v_mfma_f32_16x16x32_bf16 v[128:131], a[200:203], a[128:131], v[128:131]
    ds_read_b64_tr_b16 a[192:193], v10 offset:1024
    v_min_u32 v24, v20, v22
    v_mfma_f32_16x16x32_bf16 v[128:131], a[204:207], a[144:147], v[128:131]
    s_add_u32 m0, s49, 75520
    ds_read_b64_tr_b16 a[194:195], v10 offset:7168
    v_max_u32 v20, v20, v22
    v_mfma_f32_16x16x32_bf16 v[136:139], a[204:207], a[148:151], v[136:139]
    buffer_load_dwordx4 v2, s[8:11], s36 offen offset:256 lds
    v_mfma_f32_16x16x32_bf16 v[136:139], a[200:203], a[132:135], v[136:139]
    v_max3_u32 v21, v24, v21, v23
    v_lshl_add_u32 v61, v61, 5, s88
    v_mfma_f32_16x16x32_bf16 v[144:147], a[200:203], a[136:139], v[144:147]
    s_lshl_b32 s56, s3, 3
    ds_read_b64_tr_b16 a[196:197], v10 offset:13312
    v_cmp_gt_u32 s[88:89], 8, v1
    v_mfma_f32_16x16x32_bf16 v[144:147], a[204:207], a[152:155], v[144:147]
    s_add_u32 s56, s56, 147456
    ds_read_b64_tr_b16 a[198:199], v10 offset:19456
    v_mov_b32 v22, s56
    v_mfma_f32_16x16x32_bf16 v[152:155], a[204:207], a[156:159], v[152:155]
    v_mov_b32 v23, 147456
    v_cndmask_b32 v60, v61, v60, s[88:89]
    v_mfma_f32_16x16x32_bf16 v[152:155], a[200:203], a[140:143], v[152:155]
    s_waitcnt lgkmcnt(4)
    v_lshlrev_b32 v61, 2, v1
    v_cmp_gt_u32 s[88:89], 12, v1
    v_mfma_f32_16x16x32_bf16 v[156:159], a[208:211], a[140:143], v[156:159]
    s_add_u32 m0, s49, 76800
    ds_read_b64_tr_b16 a[200:201], v11 offset:1024
    v_cndmask_b32 v60, v61, v60, s[88:89]
    v_mfma_f32_16x16x32_bf16 v[156:159], a[212:215], a[156:159], v[156:159]
    ds_read_b64_tr_b16 a[202:203], v11 offset:7168
    v_lshlrev_b32 v60, 4, v60
    v_mfma_f32_16x16x32_bf16 v[148:151], a[212:215], a[152:155], v[148:151]
    buffer_load_dwordx4 v3, s[8:11], s36 offen offset:0 lds
    v_mfma_f32_16x16x32_bf16 v[148:151], a[208:211], a[136:139], v[148:151]
    v_accvgpr_write_b32 a97, 0
    v_accvgpr_write_b32 a98, 0
    v_mfma_f32_16x16x32_bf16 v[140:143], a[208:211], a[132:135], v[140:143]
    ds_read_b64_tr_b16 a[204:205], v11 offset:13312
    v_accvgpr_write_b32 a99, 0
    v_mfma_f32_16x16x32_bf16 v[140:143], a[212:215], a[148:151], v[140:143]
    ds_read_b64_tr_b16 a[206:207], v11 offset:19456
    v_accvgpr_write_b32 a100, 0
    v_mfma_f32_16x16x32_bf16 v[132:135], a[212:215], a[144:147], v[132:135]
    s_add_u32 m0, s49, 77696
    v_accvgpr_write_b32 a101, 0
    v_accvgpr_write_b32 a102, 0
    v_mfma_f32_16x16x32_bf16 v[132:135], a[208:211], a[128:131], v[132:135]
    s_waitcnt lgkmcnt(4)
    v_accvgpr_write_b32 a103, 0
    v_accvgpr_write_b32 a104, 0
    v_mfma_f32_16x16x32_bf16 v[160:163], a[192:195], a[128:131], v[160:163]
    ds_read_b64_tr_b16 a[208:209], v8 offset:2048
    v_accvgpr_write_b32 a105, 0
    v_mfma_f32_16x16x32_bf16 v[160:163], a[196:199], a[144:147], v[160:163]
    ds_read_b64_tr_b16 a[210:211], v8 offset:8192
    v_accvgpr_write_b32 a106, 0
    v_mfma_f32_16x16x32_bf16 v[168:171], a[196:199], a[148:151], v[168:171]
    buffer_load_dwordx4 v3, s[8:11], s36 offen offset:128 lds
    v_mfma_f32_16x16x32_bf16 v[168:171], a[192:195], a[132:135], v[168:171]
    v_accvgpr_write_b32 a107, 0
    v_accvgpr_write_b32 a108, 0
    v_mfma_f32_16x16x32_bf16 v[176:179], a[192:195], a[136:139], v[176:179]
    s_add_u32 m0, s49, 78592
    ds_read_b64_tr_b16 a[212:213], v8 offset:14336
    v_accvgpr_write_b32 a109, 0
    v_mfma_f32_16x16x32_bf16 v[176:179], a[196:199], a[152:155], v[176:179]
    ds_read_b64_tr_b16 a[214:215], v8 offset:20480
    v_accvgpr_write_b32 a110, 0
    v_mfma_f32_16x16x32_bf16 v[184:187], a[196:199], a[156:159], v[184:187]
    buffer_load_dwordx4 v3, s[8:11], s36 offen offset:256 lds
    v_mfma_f32_16x16x32_bf16 v[184:187], a[192:195], a[140:143], v[184:187]
    s_waitcnt lgkmcnt(4)
    v_accvgpr_write_b32 a111, 0
    v_accvgpr_write_b32 a112, 0
    v_mfma_f32_16x16x32_bf16 v[188:191], a[200:203], a[140:143], v[188:191]
    s_add_u32 s36, s36, s37
    ds_read_b64_tr_b16 a[192:193], v9 offset:2048
    v_accvgpr_write_b32 a113, 0
    v_mfma_f32_16x16x32_bf16 v[188:191], a[204:207], a[156:159], v[188:191]
    s_sub_u32 s55, s36, 7864320
    ds_read_b64_tr_b16 a[194:195], v9 offset:8192
    v_accvgpr_write_b32 a114, 0
    v_mfma_f32_16x16x32_bf16 v[180:183], a[204:207], a[152:155], v[180:183]
    s_min_u32 s36, s36, s55
    ds_write_b64 v22, v[20:21]
    v_accvgpr_write_b32 a115, 0
    v_mfma_f32_16x16x32_bf16 v[180:183], a[200:203], a[136:139], v[180:183]
    s_add_u32 s46, s45, 53248
    v_accvgpr_write_b32 a116, 0
    v_accvgpr_write_b32 a117, 0
    v_mfma_f32_16x16x32_bf16 v[172:175], a[200:203], a[132:135], v[172:175]
    s_sub_u32 s77, s46, 81920
    ds_read_b64_tr_b16 a[196:197], v9 offset:14336
    v_accvgpr_write_b32 a118, 0
    v_mfma_f32_16x16x32_bf16 v[172:175], a[204:207], a[148:151], v[172:175]
    s_min_u32 s46, s46, s77
    ds_read_b64_tr_b16 a[198:199], v9 offset:20480
    v_accvgpr_write_b32 a119, 0
    v_mfma_f32_16x16x32_bf16 v[164:167], a[204:207], a[144:147], v[164:167]
    buffer_load_dwordx4 a[16:19], v28, s[20:23], s46 offen offset:0 sc1
    v_mfma_f32_16x16x32_bf16 v[164:167], a[200:203], a[128:131], v[164:167]
    s_waitcnt lgkmcnt(4)
    v_accvgpr_write_b32 a120, 0
    v_accvgpr_write_b32 a121, 0
    v_mfma_f32_16x16x32_bf16 v[192:195], a[208:211], a[128:131], v[192:195]
    ds_read_b64_tr_b16 a[200:201], v10 offset:2048
    v_accvgpr_write_b32 a122, 0
    v_mfma_f32_16x16x32_bf16 v[192:195], a[212:215], a[144:147], v[192:195]
    ds_read_b64_tr_b16 a[202:203], v10 offset:8192
    v_accvgpr_write_b32 a123, 0
    v_mfma_f32_16x16x32_bf16 v[200:203], a[212:215], a[148:151], v[200:203]
    buffer_load_dwordx4 a[20:23], v28, s[20:23], s46 offen offset:1024 sc1
    v_mfma_f32_16x16x32_bf16 v[200:203], a[208:211], a[132:135], v[200:203]
    v_accvgpr_write_b32 a124, 0
    v_accvgpr_write_b32 a125, 0
    v_mfma_f32_16x16x32_bf16 v[208:211], a[208:211], a[136:139], v[208:211]
    ds_read_b64_tr_b16 a[204:205], v10 offset:14336
    v_accvgpr_write_b32 a126, 0
    v_mfma_f32_16x16x32_bf16 v[208:211], a[212:215], a[152:155], v[208:211]
    ds_read_b64_tr_b16 a[206:207], v10 offset:20480
    v_accvgpr_write_b32 a127, 0
    v_mfma_f32_16x16x32_bf16 v[216:219], a[212:215], a[156:159], v[216:219]
    v_add_u32 v8, 24576, v12
    v_add_u32 v9, 24576, v13
    v_mfma_f32_16x16x32_bf16 v[216:219], a[208:211], a[140:143], v[216:219]
    s_waitcnt lgkmcnt(4)
    v_add_u32 v10, 24576, v14
    v_mfma_f32_16x16x32_bf16 v[220:223], a[192:195], a[140:143], v[220:223]
    ds_read_b64_tr_b16 a[208:209], v11 offset:2048
    v_mfma_f32_16x16x32_bf16 v[220:223], a[196:199], a[156:159], v[220:223]
    ds_read_b64_tr_b16 a[210:211], v11 offset:8192
    v_mfma_f32_16x16x32_bf16 v[212:215], a[196:199], a[152:155], v[212:215]
    buffer_load_dwordx4 a[24:27], v28, s[20:23], s46 offen offset:2048 sc1
    v_mfma_f32_16x16x32_bf16 v[212:215], a[192:195], a[136:139], v[212:215]
    v_mfma_f32_16x16x32_bf16 v[204:207], a[192:195], a[132:135], v[204:207]
    ds_read_b64_tr_b16 a[212:213], v11 offset:14336
    v_mfma_f32_16x16x32_bf16 v[204:207], a[196:199], a[148:151], v[204:207]
    s_waitcnt vmcnt(33)
    ds_read_b64_tr_b16 a[214:215], v11 offset:20480
    v_mfma_f32_16x16x32_bf16 v[196:199], a[196:199], a[144:147], v[196:199]
    s_barrier
    v_mfma_f32_16x16x32_bf16 v[196:199], a[192:195], a[128:131], v[196:199]
    s_waitcnt lgkmcnt(4)
    v_add_u32 v11, 24576, v15
    v_mfma_f32_16x16x32_bf16 v[224:227], a[200:203], a[128:131], v[224:227]
    ds_read_b64_tr_b16 a[192:193], v8 offset:0
    v_mfma_f32_16x16x32_bf16 v[224:227], a[204:207], a[144:147], v[224:227]
    ds_read_b64_tr_b16 a[194:195], v8 offset:6144
    v_mfma_f32_16x16x32_bf16 v[232:235], a[204:207], a[148:151], v[232:235]
    ds_read_b128 v[32:35], v23
    v_mfma_f32_16x16x32_bf16 v[232:235], a[200:203], a[132:135], v[232:235]
    ds_read_b128 v[36:39], v23 offset:16
    v_mfma_f32_16x16x32_bf16 v[240:243], a[200:203], a[136:139], v[240:243]
    ds_read_b64_tr_b16 a[196:197], v8 offset:12288
    v_mfma_f32_16x16x32_bf16 v[240:243], a[204:207], a[152:155], v[240:243]
    ds_read_b64_tr_b16 a[198:199], v8 offset:18432
    v_mfma_f32_16x16x32_bf16 v[248:251], a[204:207], a[156:159], v[248:251]
    buffer_load_dwordx4 a[28:31], v28, s[20:23], s46 offen offset:3072 sc1
    v_mfma_f32_16x16x32_bf16 v[248:251], a[200:203], a[140:143], v[248:251]
    s_waitcnt lgkmcnt(4)
    s_add_u32 s46, s45, 57344
    s_sub_u32 s77, s46, 81920
    v_mfma_f32_16x16x32_bf16 v[252:255], a[208:211], a[140:143], v[252:255]
    s_min_u32 s46, s46, s77
    ds_read_b64_tr_b16 a[200:201], v9 offset:0
    v_mfma_f32_16x16x32_bf16 v[252:255], a[212:215], a[156:159], v[252:255]
    ds_read_b64_tr_b16 a[202:203], v9 offset:6144
    v_mfma_f32_16x16x32_bf16 v[244:247], a[212:215], a[152:155], v[244:247]
    buffer_load_dwordx4 a[32:35], v28, s[20:23], s46 offen offset:0 sc1
    v_mfma_f32_16x16x32_bf16 v[244:247], a[208:211], a[136:139], v[244:247]
    v_mfma_f32_16x16x32_bf16 v[236:239], a[208:211], a[132:135], v[236:239]
    ds_read_b64_tr_b16 a[204:205], v9 offset:12288
    v_mfma_f32_16x16x32_bf16 v[236:239], a[212:215], a[148:151], v[236:239]
    s_waitcnt vmcnt(25)
    s_waitcnt vmcnt(15)
    ds_read_b64_tr_b16 a[206:207], v9 offset:18432
    v_mfma_f32_16x16x32_bf16 v[228:231], a[212:215], a[144:147], v[228:231]
    buffer_load_dwordx4 a[36:39], v28, s[20:23], s46 offen offset:1024 sc1
    v_mfma_f32_16x16x32_bf16 v[228:231], a[208:211], a[128:131], v[228:231]
    s_waitcnt lgkmcnt(4)
    v_mfma_f32_16x16x32_bf16 v[64:67], a[192:195], a[160:163], v[64:67]
    ds_read_b64_tr_b16 a[208:209], v10 offset:0
    v_mfma_f32_16x16x32_bf16 v[64:67], a[196:199], a[176:179], v[64:67]
    ds_read_b64_tr_b16 a[210:211], v10 offset:6144
    v_accvgpr_write_b32 a128, 0
    v_mfma_f32_16x16x32_bf16 v[72:75], a[196:199], a[180:183], v[72:75]
    v_accvgpr_write_b32 a129, 0
    v_mfma_f32_16x16x32_bf16 v[72:75], a[192:195], a[164:167], v[72:75]
    buffer_load_dwordx4 a[40:43], v28, s[20:23], s46 offen offset:2048 sc1
    v_mfma_f32_16x16x32_bf16 v[80:83], a[192:195], a[168:171], v[80:83]
    ds_read_b64_tr_b16 a[212:213], v10 offset:12288
    v_max_u32 v20, v32, v33
    v_mfma_f32_16x16x32_bf16 v[80:83], a[196:199], a[184:187], v[80:83]
    ds_read_b64_tr_b16 a[214:215], v10 offset:18432
    v_min_u32 v21, v32, v33
    v_mfma_f32_16x16x32_bf16 v[88:91], a[196:199], a[188:191], v[88:91]
    v_med3_u32 v21, v20, v21, v34
    v_max_u32 v20, v20, v34
    v_mfma_f32_16x16x32_bf16 v[88:91], a[192:195], a[172:175], v[88:91]
    s_waitcnt lgkmcnt(4)
    v_med3_u32 v21, v20, v21, v35
    v_max_u32 v20, v20, v35
    v_mfma_f32_16x16x32_bf16 v[92:95], a[200:203], a[172:175], v[92:95]
    ds_read_b64_tr_b16 a[192:193], v11 offset:0
    v_med3_u32 v21, v20, v21, v36
    v_mfma_f32_16x16x32_bf16 v[92:95], a[204:207], a[188:191], v[92:95]
    ds_read_b64_tr_b16 a[194:195], v11 offset:6144
    v_max_u32 v20, v20, v36
    v_mfma_f32_16x16x32_bf16 v[84:87], a[204:207], a[184:187], v[84:87]
    buffer_load_dwordx4 a[44:47], v28, s[20:23], s46 offen offset:3072 sc1
    v_mfma_f32_16x16x32_bf16 v[84:87], a[200:203], a[168:171], v[84:87]
    v_med3_u32 v21, v20, v21, v37
    v_max_u32 v20, v20, v37
    v_mfma_f32_16x16x32_bf16 v[76:79], a[200:203], a[164:167], v[76:79]
    ds_read_b64_tr_b16 a[196:197], v11 offset:12288
    v_med3_u32 v21, v20, v21, v38
    v_mfma_f32_16x16x32_bf16 v[76:79], a[204:207], a[180:183], v[76:79]
    ds_read_b64_tr_b16 a[198:199], v11 offset:18432
    v_max_u32 v20, v20, v38
    v_mfma_f32_16x16x32_bf16 v[68:71], a[204:207], a[176:179], v[68:71]
    v_med3_u32 v21, v20, v21, v39
    v_max_u32 v20, v20, v39
    v_mfma_f32_16x16x32_bf16 v[68:71], a[200:203], a[160:163], v[68:71]
    s_waitcnt lgkmcnt(4)
    v_and_b32 v22, 1, v1
    v_cmp_eq_u32 vcc, 1, v22
    v_mfma_f32_16x16x32_bf16 v[96:99], a[208:211], a[160:163], v[96:99]
    s_add_u32 m0, s49, 98304
    ds_read_b64_tr_b16 a[200:201], v8 offset:1024
    v_readfirstlane_b32 s70, v20
    v_mfma_f32_16x16x32_bf16 v[96:99], a[212:215], a[176:179], v[96:99]
    ds_read_b64_tr_b16 a[202:203], v8 offset:7168
    v_readfirstlane_b32 s71, v21
    v_mfma_f32_16x16x32_bf16 v[104:107], a[212:215], a[180:183], v[104:107]
    buffer_load_dwordx4 v2, s[8:11], s36 offen offset:0 lds
    v_mfma_f32_16x16x32_bf16 v[104:107], a[208:211], a[164:167], v[104:107]
    v_cndmask_b32 v22, v20, v21, vcc
    v_and_b32 v22, 0x7ff, v22
    v_mfma_f32_16x16x32_bf16 v[112:115], a[208:211], a[168:171], v[112:115]
    ds_read_b64_tr_b16 a[204:205], v8 offset:13312
    v_sub_u32 v22, 2047, v22
    v_mfma_f32_16x16x32_bf16 v[112:115], a[212:215], a[184:187], v[112:115]
    s_add_u32 m0, s49, 99200
    ds_read_b64_tr_b16 a[206:207], v8 offset:19456
    v_mul_u32_u24 v23, 1280, v22
    v_mfma_f32_16x16x32_bf16 v[120:123], a[212:215], a[188:191], v[120:123]
    buffer_load_dwordx4 v2, s[8:11], s36 offen offset:128 lds
    v_mfma_f32_16x16x32_bf16 v[120:123], a[208:211], a[172:175], v[120:123]
    s_waitcnt lgkmcnt(4)
    v_lshrrev_b32 v24, 4, v1
    v_lshl_add_u32 v23, v24, 4, v23
    v_mfma_f32_16x16x32_bf16 v[124:127], a[192:195], a[172:175], v[124:127]
    ds_read_b64_tr_b16 a[208:209], v9 offset:1024
    v_add_u32 v23, s61, v23
    v_mfma_f32_16x16x32_bf16 v[124:127], a[196:199], a[188:191], v[124:127]
    ds_read_b64_tr_b16 a[210:211], v9 offset:7168
    v_lshlrev_b32 v24, 3, v22
    v_mfma_f32_16x16x32_bf16 v[116:119], a[196:199], a[184:187], v[116:119]
    s_mov_b32 s56, 3211264
    v_accvgpr_write_b32 a130, 0
    v_accvgpr_write_b32 a131, 0
    v_mfma_f32_16x16x32_bf16 v[116:119], a[192:195], a[168:171], v[116:119]
    v_accvgpr_write_b32 a132, 0
    v_accvgpr_write_b32 a133, 0
    v_mfma_f32_16x16x32_bf16 v[108:111], a[192:195], a[164:167], v[108:111]
    s_add_u32 m0, s49, 100096
    ds_read_b64_tr_b16 a[212:213], v9 offset:13312
    v_accvgpr_write_b32 a134, 0
    v_mfma_f32_16x16x32_bf16 v[108:111], a[196:199], a[180:183], v[108:111]
    ds_read_b64_tr_b16 a[214:215], v9 offset:19456
    v_accvgpr_write_b32 a135, 0
    v_mfma_f32_16x16x32_bf16 v[100:103], a[196:199], a[176:179], v[100:103]
    buffer_load_dwordx4 v2, s[8:11], s36 offen offset:256 lds
    v_mfma_f32_16x16x32_bf16 v[100:103], a[192:195], a[160:163], v[100:103]
    s_waitcnt lgkmcnt(4)
    v_accvgpr_write_b32 a136, 0
    v_accvgpr_write_b32 a137, 0
    v_mfma_f32_16x16x32_bf16 v[128:131], a[200:203], a[160:163], v[128:131]
    ds_read_b64_tr_b16 a[192:193], v10 offset:1024
    v_accvgpr_write_b32 a138, 0
    v_mfma_f32_16x16x32_bf16 v[128:131], a[204:207], a[176:179], v[128:131]
    ds_read_b64_tr_b16 a[194:195], v10 offset:7168
    v_accvgpr_write_b32 a139, 0
    v_mfma_f32_16x16x32_bf16 v[136:139], a[204:207], a[180:183], v[136:139]
    s_add_u32 m0, s49, 101376
    v_accvgpr_write_b32 a140, 0
    v_accvgpr_write_b32 a141, 0
    v_mfma_f32_16x16x32_bf16 v[136:139], a[200:203], a[164:167], v[136:139]
    buffer_load_dwordx4 v3, s[8:11], s36 offen offset:0 lds
    v_mfma_f32_16x16x32_bf16 v[144:147], a[200:203], a[168:171], v[144:147]
    ds_read_b64_tr_b16 a[196:197], v10 offset:13312
    v_accvgpr_write_b32 a142, 0
    v_mfma_f32_16x16x32_bf16 v[144:147], a[204:207], a[184:187], v[144:147]
    ds_read_b64_tr_b16 a[198:199], v10 offset:19456
    v_accvgpr_write_b32 a143, 0
    v_mfma_f32_16x16x32_bf16 v[152:155], a[204:207], a[188:191], v[152:155]
    v_accvgpr_write_b32 a144, 0
    v_accvgpr_write_b32 a145, 0
    v_mfma_f32_16x16x32_bf16 v[152:155], a[200:203], a[172:175], v[152:155]
    s_waitcnt lgkmcnt(4)
    v_accvgpr_write_b32 a146, 0
    v_accvgpr_write_b32 a147, 0
    v_mfma_f32_16x16x32_bf16 v[156:159], a[208:211], a[172:175], v[156:159]
    ds_read_b64_tr_b16 a[200:201], v11 offset:1024
    v_accvgpr_write_b32 a148, 0
    v_mfma_f32_16x16x32_bf16 v[156:159], a[212:215], a[188:191], v[156:159]
    s_add_u32 m0, s49, 102272
    ds_read_b64_tr_b16 a[202:203], v11 offset:7168
    v_accvgpr_write_b32 a149, 0
    v_mfma_f32_16x16x32_bf16 v[148:151], a[212:215], a[184:187], v[148:151]
    buffer_load_dwordx4 v3, s[8:11], s36 offen offset:128 lds
    v_mfma_f32_16x16x32_bf16 v[148:151], a[208:211], a[168:171], v[148:151]
    v_accvgpr_write_b32 a150, 0
    v_accvgpr_write_b32 a151, 0
    v_mfma_f32_16x16x32_bf16 v[140:143], a[208:211], a[164:167], v[140:143]
    ds_read_b64_tr_b16 a[204:205], v11 offset:13312
    v_accvgpr_write_b32 a152, 0
    v_mfma_f32_16x16x32_bf16 v[140:143], a[212:215], a[180:183], v[140:143]
    ds_read_b64_tr_b16 a[206:207], v11 offset:19456
    v_accvgpr_write_b32 a153, 0
    v_mfma_f32_16x16x32_bf16 v[132:135], a[212:215], a[176:179], v[132:135]
    v_accvgpr_write_b32 a154, 0
    v_accvgpr_write_b32 a155, 0
    v_mfma_f32_16x16x32_bf16 v[132:135], a[208:211], a[160:163], v[132:135]
    s_waitcnt lgkmcnt(4)
    v_accvgpr_write_b32 a156, 0
    v_accvgpr_write_b32 a157, 0
    v_mfma_f32_16x16x32_bf16 v[160:163], a[192:195], a[160:163], v[160:163]
    s_add_u32 m0, s49, 103168
    ds_read_b64_tr_b16 a[208:209], v8 offset:2048
    v_accvgpr_write_b32 a158, 0
    v_mfma_f32_16x16x32_bf16 v[160:163], a[196:199], a[176:179], v[160:163]
    ds_read_b64_tr_b16 a[210:211], v8 offset:8192
    v_accvgpr_write_b32 a159, 0
    v_mfma_f32_16x16x32_bf16 v[168:171], a[196:199], a[180:183], v[168:171]
    buffer_load_dwordx4 v3, s[8:11], s36 offen offset:256 lds
    v_mfma_f32_16x16x32_bf16 v[168:171], a[192:195], a[164:167], v[168:171]
    s_add_u32 s36, s36, s37
    s_sub_u32 s55, s36, 7864320
    s_min_u32 s36, s36, s55
    v_mfma_f32_16x16x32_bf16 v[176:179], a[192:195], a[168:171], v[176:179]
    s_add_u32 s46, s45, 61440
    ds_read_b64_tr_b16 a[212:213], v8 offset:14336
    s_sub_u32 s77, s46, 81920
    v_mfma_f32_16x16x32_bf16 v[176:179], a[196:199], a[184:187], v[176:179]
    s_min_u32 s46, s46, s77
    ds_read_b64_tr_b16 a[214:215], v8 offset:20480
    v_mfma_f32_16x16x32_bf16 v[184:187], a[196:199], a[188:191], v[184:187]
    v_add_u32 v8, 49152, v12
    v_mfma_f32_16x16x32_bf16 v[184:187], a[192:195], a[172:175], v[184:187]
    s_waitcnt lgkmcnt(4)
    v_mfma_f32_16x16x32_bf16 v[188:191], a[200:203], a[172:175], v[188:191]
    ds_read_b64_tr_b16 a[192:193], v9 offset:2048
    v_mfma_f32_16x16x32_bf16 v[188:191], a[204:207], a[188:191], v[188:191]
    ds_read_b64_tr_b16 a[194:195], v9 offset:8192
    v_mfma_f32_16x16x32_bf16 v[180:183], a[204:207], a[184:187], v[180:183]
    buffer_load_dwordx4 a[48:51], v28, s[20:23], s46 offen offset:0 sc1
    v_mfma_f32_16x16x32_bf16 v[180:183], a[200:203], a[168:171], v[180:183]
    v_mfma_f32_16x16x32_bf16 v[172:175], a[200:203], a[164:167], v[172:175]
    ds_read_b64_tr_b16 a[196:197], v9 offset:14336
    v_mfma_f32_16x16x32_bf16 v[172:175], a[204:207], a[180:183], v[172:175]
    ds_read_b64_tr_b16 a[198:199], v9 offset:20480
    v_mfma_f32_16x16x32_bf16 v[164:167], a[204:207], a[176:179], v[164:167]
    buffer_load_dwordx4 a[52:55], v28, s[20:23], s46 offen offset:1024 sc1
    v_mfma_f32_16x16x32_bf16 v[164:167], a[200:203], a[160:163], v[164:167]
    s_waitcnt lgkmcnt(4)
    v_add_u32 v9, 49152, v13
    v_mfma_f32_16x16x32_bf16 v[192:195], a[208:211], a[160:163], v[192:195]
    ds_read_b64_tr_b16 a[200:201], v10 offset:2048
    v_mfma_f32_16x16x32_bf16 v[192:195], a[212:215], a[176:179], v[192:195]
    ds_read_b64_tr_b16 a[202:203], v10 offset:8192
    v_mfma_f32_16x16x32_bf16 v[200:203], a[212:215], a[180:183], v[200:203]
    v_mfma_f32_16x16x32_bf16 v[200:203], a[208:211], a[164:167], v[200:203]
    v_mfma_f32_16x16x32_bf16 v[208:211], a[208:211], a[168:171], v[208:211]
    ds_read_b64_tr_b16 a[204:205], v10 offset:14336
    v_mfma_f32_16x16x32_bf16 v[208:211], a[212:215], a[184:187], v[208:211]
    ds_read_b64_tr_b16 a[206:207], v10 offset:20480
    v_mfma_f32_16x16x32_bf16 v[216:219], a[212:215], a[188:191], v[216:219]
    buffer_load_dwordx4 a[56:59], v28, s[20:23], s46 offen offset:2048 sc1
    v_mfma_f32_16x16x32_bf16 v[216:219], a[208:211], a[172:175], v[216:219]
    s_waitcnt lgkmcnt(4)
    v_add_u32 v10, 49152, v14
    v_mfma_f32_16x16x32_bf16 v[220:223], a[192:195], a[172:175], v[220:223]
    ds_read_b64_tr_b16 a[208:209], v11 offset:2048
    v_mfma_f32_16x16x32_bf16 v[220:223], a[196:199], a[188:191], v[220:223]
    ds_read_b64_tr_b16 a[210:211], v11 offset:8192
    v_mfma_f32_16x16x32_bf16 v[212:215], a[196:199], a[184:187], v[212:215]
    buffer_load_dwordx4 a[60:63], v28, s[20:23], s46 offen offset:3072 sc1
    v_mfma_f32_16x16x32_bf16 v[212:215], a[192:195], a[168:171], v[212:215]
    v_mfma_f32_16x16x32_bf16 v[204:207], a[192:195], a[164:167], v[204:207]
    ds_read_b64_tr_b16 a[212:213], v11 offset:14336
    v_mfma_f32_16x16x32_bf16 v[204:207], a[196:199], a[180:183], v[204:207]
    s_waitcnt vmcnt(32)
    ds_read_b64_tr_b16 a[214:215], v11 offset:20480
    v_mfma_f32_16x16x32_bf16 v[196:199], a[196:199], a[176:179], v[196:199]
    s_barrier
    v_mfma_f32_16x16x32_bf16 v[196:199], a[192:195], a[160:163], v[196:199]
    s_waitcnt lgkmcnt(4)
    global_load_dwordx4 v[48:51], v23, s[64:65]
    v_mfma_f32_16x16x32_bf16 v[224:227], a[200:203], a[160:163], v[224:227]
    ds_read_b64_tr_b16 a[192:193], v8 offset:0
    v_add_u32 v11, 49152, v15
    v_mfma_f32_16x16x32_bf16 v[224:227], a[204:207], a[176:179], v[224:227]
    s_add_u32 m0, s44, 147456
    ds_read_b64_tr_b16 a[194:195], v8 offset:6144
    v_mfma_f32_16x16x32_bf16 v[232:235], a[204:207], a[180:183], v[232:235]
pg_3:
    s_cbranch_execz pg_ret
    global_load_dwordx4 v[52:55], v23, s[64:65] offset:64
    v_mfma_f32_16x16x32_bf16 v[232:235], a[200:203], a[164:167], v[232:235]
    buffer_load_dwordx2 v[40:41], v24, s[24:27], s56 offen sc1
    v_mfma_f32_16x16x32_bf16 v[240:243], a[200:203], a[168:171], v[240:243]
    ds_read_b64_tr_b16 a[196:197], v8 offset:12288
    v_bfe_u32 v26, v1, 2, 3
    v_mfma_f32_16x16x32_bf16 v[240:243], a[204:207], a[184:187], v[240:243]
    ds_read_b64_tr_b16 a[198:199], v8 offset:18432
    v_lshlrev_b32 v25, 7, v26
    v_mfma_f32_16x16x32_bf16 v[248:251], a[204:207], a[188:191], v[248:251]
    buffer_load_dword v61, v60, s[24:27], s47 offen offset:12 sc1
    v_mfma_f32_16x16x32_bf16 v[248:251], a[200:203], a[172:175], v[248:251]
    s_waitcnt lgkmcnt(4)
    buffer_load_dwordx4 v56, s[28:31], s60 offen lds
    v_mfma_f32_16x16x32_bf16 v[252:255], a[208:211], a[172:175], v[252:255]
    s_add_u32 m0, s44, 148480
    ds_read_b64_tr_b16 a[200:201], v9 offset:0
    v_lshrrev_b32 v26, 1, v26
    v_mfma_f32_16x16x32_bf16 v[252:255], a[212:215], a[188:191], v[252:255]
    ds_read_b64_tr_b16 a[202:203], v9 offset:6144
    v_xor_b32 v26, s3, v26
    v_mfma_f32_16x16x32_bf16 v[244:247], a[212:215], a[184:187], v[244:247]
    buffer_load_dwordx4 v56, s[32:35], s60 offen lds
    v_mfma_f32_16x16x32_bf16 v[244:247], a[208:211], a[168:171], v[244:247]
    s_add_u32 m0, s44, 149504
    v_lshl_add_u32 v25, v26, 5, v25
    v_and_b32 v26, 3, v1
    v_mfma_f32_16x16x32_bf16 v[236:239], a[208:211], a[164:167], v[236:239]
    ds_read_b64_tr_b16 a[204:205], v9 offset:12288
    v_lshl_add_u32 v25, v26, 3, v25
    v_mfma_f32_16x16x32_bf16 v[236:239], a[212:215], a[180:183], v[236:239]
    s_waitcnt vmcnt(30)
    s_waitcnt vmcnt(20)
    ds_read_b64_tr_b16 a[206:207], v9 offset:18432
    v_mfma_f32_16x16x32_bf16 v[228:231], a[212:215], a[176:179], v[228:231]
    buffer_load_dwordx4 v57, s[28:31], s60 offen lds
    v_mfma_f32_16x16x32_bf16 v[228:231], a[208:211], a[160:163], v[228:231]
    s_waitcnt lgkmcnt(4)
    v_lshrrev_b32 v26, 5, v1
    v_mul_u32_u24 v26, 2048, v26
    v_mfma_f32_16x16x32_bf16 v[64:67], a[192:195], a[0:3], v[64:67]
    s_add_u32 m0, s44, 150528
    ds_read_b64_tr_b16 a[208:209], v10 offset:0
    v_add_u32 v25, v25, v26
    v_mfma_f32_16x16x32_bf16 v[64:67], a[196:199], a[16:19], v[64:67]
    ds_read_b64_tr_b16 a[210:211], v10 offset:6144
    v_add_u32 v25, 147456, v25
    v_mfma_f32_16x16x32_bf16 v[72:75], a[196:199], a[20:23], v[72:75]
    buffer_load_dwordx4 v57, s[32:35], s60 offen lds
    v_mfma_f32_16x16x32_bf16 v[72:75], a[192:195], a[4:7], v[72:75]
    v_lshlrev_b32 v26, 4, v1
    v_cmp_gt_u32 vcc, 16, v1
    v_mfma_f32_16x16x32_bf16 v[80:83], a[192:195], a[8:11], v[80:83]
    ds_read_b64_tr_b16 a[212:213], v10 offset:12288
    v_mov_b32 v27, 0x7ffffff0
    v_mfma_f32_16x16x32_bf16 v[80:83], a[196:199], a[24:27], v[80:83]
    ds_read_b64_tr_b16 a[214:215], v10 offset:18432
    v_cndmask_b32 v26, v27, v26, vcc
    v_mfma_f32_16x16x32_bf16 v[88:91], a[196:199], a[28:31], v[88:91]
    v_accvgpr_write_b32 a160, 0
    v_mfma_f32_16x16x32_bf16 v[88:91], a[192:195], a[12:15], v[88:91]
    s_waitcnt lgkmcnt(4)
    v_accvgpr_write_b32 a161, 0
    v_mfma_f32_16x16x32_bf16 v[92:95], a[200:203], a[12:15], v[92:95]
    s_add_u32 s46, s45, 65536
    ds_read_b64_tr_b16 a[192:193], v11 offset:0
    v_accvgpr_write_b32 a162, 0
    v_mfma_f32_16x16x32_bf16 v[92:95], a[204:207], a[28:31], v[92:95]
    s_sub_u32 s77, s46, 81920
    ds_read_b64_tr_b16 a[194:195], v11 offset:6144
    v_accvgpr_write_b32 a163, 0
    v_mfma_f32_16x16x32_bf16 v[84:87], a[204:207], a[24:27], v[84:87]
    s_min_u32 s46, s46, s77
    v_accvgpr_write_b32 a164, 0
    v_mfma_f32_16x16x32_bf16 v[84:87], a[200:203], a[8:11], v[84:87]
    buffer_load_dwordx4 a[64:67], v28, s[20:23], s46 offen offset:0 sc1
    v_mfma_f32_16x16x32_bf16 v[76:79], a[200:203], a[4:7], v[76:79]
    ds_read_b64_tr_b16 a[196:197], v11 offset:12288
    v_accvgpr_write_b32 a165, 0
    v_mfma_f32_16x16x32_bf16 v[76:79], a[204:207], a[20:23], v[76:79]
    ds_read_b64_tr_b16 a[198:199], v11 offset:18432
    v_accvgpr_write_b32 a166, 0
    v_mfma_f32_16x16x32_bf16 v[68:71], a[204:207], a[16:19], v[68:71]
    v_accvgpr_write_b32 a167, 0
    v_mfma_f32_16x16x32_bf16 v[68:71], a[200:203], a[0:3], v[68:71]
    s_waitcnt lgkmcnt(4)
    v_accvgpr_write_b32 a168, 0
    v_mfma_f32_16x16x32_bf16 v[96:99], a[208:211], a[0:3], v[96:99]
    ds_read_b64_tr_b16 a[200:201], v8 offset:1024
    v_accvgpr_write_b32 a169, 0
    v_mfma_f32_16x16x32_bf16 v[96:99], a[212:215], a[16:19], v[96:99]
    ds_read_b64_tr_b16 a[202:203], v8 offset:7168
    v_accvgpr_write_b32 a170, 0
    v_mfma_f32_16x16x32_bf16 v[104:107], a[212:215], a[20:23], v[104:107]
    buffer_load_dwordx4 a[68:71], v28, s[20:23], s46 offen offset:1024 sc1
    v_mfma_f32_16x16x32_bf16 v[104:107], a[208:211], a[4:7], v[104:107]
    v_accvgpr_write_b32 a171, 0
    v_accvgpr_write_b32 a172, 0
    v_mfma_f32_16x16x32_bf16 v[112:115], a[208:211], a[8:11], v[112:115]
    ds_read_b64_tr_b16 a[204:205], v8 offset:13312
    v_accvgpr_write_b32 a173, 0
    v_mfma_f32_16x16x32_bf16 v[112:115], a[212:215], a[24:27], v[112:115]
    ds_read_b64_tr_b16 a[206:207], v8 offset:19456
    v_accvgpr_write_b32 a174, 0
    v_mfma_f32_16x16x32_bf16 v[120:123], a[212:215], a[28:31], v[120:123]
    v_accvgpr_write_b32 a175, 0
    v_accvgpr_write_b32 a176, 0
    v_mfma_f32_16x16x32_bf16 v[120:123], a[208:211], a[12:15], v[120:123]
    s_waitcnt lgkmcnt(4)
    v_accvgpr_write_b32 a177, 0
    v_accvgpr_write_b32 a178, 0
    v_mfma_f32_16x16x32_bf16 v[124:127], a[192:195], a[12:15], v[124:127]
    ds_read_b64_tr_b16 a[208:209], v9 offset:1024
    v_accvgpr_write_b32 a179, 0
    v_mfma_f32_16x16x32_bf16 v[124:127], a[196:199], a[28:31], v[124:127]
    ds_read_b64_tr_b16 a[210:211], v9 offset:7168
    v_accvgpr_write_b32 a180, 0
    v_mfma_f32_16x16x32_bf16 v[116:119], a[196:199], a[24:27], v[116:119]
    buffer_load_dwordx4 a[72:75], v28, s[20:23], s46 offen offset:2048 sc1
    v_mfma_f32_16x16x32_bf16 v[116:119], a[192:195], a[8:11], v[116:119]
    v_accvgpr_write_b32 a181, 0
    v_accvgpr_write_b32 a182, 0
    v_mfma_f32_16x16x32_bf16 v[108:111], a[192:195], a[4:7], v[108:111]
    ds_read_b64_tr_b16 a[212:213], v9 offset:13312
    v_accvgpr_write_b32 a183, 0
    v_mfma_f32_16x16x32_bf16 v[108:111], a[196:199], a[20:23], v[108:111]
    ds_read_b64_tr_b16 a[214:215], v9 offset:19456
    v_accvgpr_write_b32 a184, 0
    v_mfma_f32_16x16x32_bf16 v[100:103], a[196:199], a[16:19], v[100:103]
    buffer_load_dwordx4 a[76:79], v28, s[20:23], s46 offen offset:3072 sc1
    v_mfma_f32_16x16x32_bf16 v[100:103], a[192:195], a[0:3], v[100:103]
    s_waitcnt lgkmcnt(4)
    v_accvgpr_write_b32 a185, 0
    v_accvgpr_write_b32 a186, 0
    v_mfma_f32_16x16x32_bf16 v[128:131], a[200:203], a[0:3], v[128:131]
    ds_read_b64_tr_b16 a[192:193], v10 offset:1024
    v_accvgpr_write_b32 a187, 0
    v_mfma_f32_16x16x32_bf16 v[128:131], a[204:207], a[16:19], v[128:131]
    ds_read_b64_tr_b16 a[194:195], v10 offset:7168
    v_accvgpr_write_b32 a188, 0
    v_mfma_f32_16x16x32_bf16 v[136:139], a[204:207], a[20:23], v[136:139]
    v_accvgpr_write_b32 a189, 0
    v_accvgpr_write_b32 a190, 0
    v_mfma_f32_16x16x32_bf16 v[136:139], a[200:203], a[4:7], v[136:139]
    v_accvgpr_write_b32 a191, 0
    v_mfma_f32_16x16x32_bf16 v[144:147], a[200:203], a[8:11], v[144:147]
    s_add_u32 m0, s49, 122880
    ds_read_b64_tr_b16 a[196:197], v10 offset:13312
    v_mfma_f32_16x16x32_bf16 v[144:147], a[204:207], a[24:27], v[144:147]
    ds_read_b64_tr_b16 a[198:199], v10 offset:19456
    v_mfma_f32_16x16x32_bf16 v[152:155], a[204:207], a[28:31], v[152:155]
    buffer_load_dwordx4 v2, s[8:11], s36 offen offset:0 lds
    v_mfma_f32_16x16x32_bf16 v[152:155], a[200:203], a[12:15], v[152:155]
    s_waitcnt lgkmcnt(4)
    v_mfma_f32_16x16x32_bf16 v[156:159], a[208:211], a[12:15], v[156:159]
    ds_read_b64_tr_b16 a[200:201], v11 offset:1024
    v_mfma_f32_16x16x32_bf16 v[156:159], a[212:215], a[28:31], v[156:159]
    ds_read_b64_tr_b16 a[202:203], v11 offset:7168
    v_mfma_f32_16x16x32_bf16 v[148:151], a[212:215], a[24:27], v[148:151]
    s_add_u32 m0, s49, 123776
    v_mfma_f32_16x16x32_bf16 v[148:151], a[208:211], a[8:11], v[148:151]
    buffer_load_dwordx4 v2, s[8:11], s36 offen offset:128 lds
    v_mfma_f32_16x16x32_bf16 v[140:143], a[208:211], a[4:7], v[140:143]
    ds_read_b64_tr_b16 a[204:205], v11 offset:13312
    v_mfma_f32_16x16x32_bf16 v[140:143], a[212:215], a[20:23], v[140:143]
    ds_read_b64_tr_b16 a[206:207], v11 offset:19456
    v_mfma_f32_16x16x32_bf16 v[132:135], a[212:215], a[16:19], v[132:135]
    v_mfma_f32_16x16x32_bf16 v[132:135], a[208:211], a[0:3], v[132:135]
    s_waitcnt lgkmcnt(4)
    v_mfma_f32_16x16x32_bf16 v[160:163], a[192:195], a[0:3], v[160:163]
    ds_read_b64_tr_b16 a[208:209], v8 offset:2048
    v_mfma_f32_16x16x32_bf16 v[160:163], a[196:199], a[16:19], v[160:163]
    s_add_u32 m0, s49, 124672
    ds_read_b64_tr_b16 a[210:211], v8 offset:8192
    v_mfma_f32_16x16x32_bf16 v[168:171], a[196:199], a[20:23], v[168:171]
    buffer_load_dwordx4 v2, s[8:11], s36 offen offset:256 lds
    v_mfma_f32_16x16x32_bf16 v[168:171], a[192:195], a[4:7], v[168:171]
    v_mfma_f32_16x16x32_bf16 v[176:179], a[192:195], a[8:11], v[176:179]
    ds_read_b64_tr_b16 a[212:213], v8 offset:14336
    v_mfma_f32_16x16x32_bf16 v[176:179], a[196:199], a[24:27], v[176:179]
    ds_read_b64_tr_b16 a[214:215], v8 offset:20480
    v_mfma_f32_16x16x32_bf16 v[184:187], a[196:199], a[28:31], v[184:187]
    v_add_u32 v8, 73728, v12
    v_mfma_f32_16x16x32_bf16 v[184:187], a[192:195], a[12:15], v[184:187]
    s_waitcnt lgkmcnt(4)
    s_add_u32 m0, s49, 125952
    v_mfma_f32_16x16x32_bf16 v[188:191], a[200:203], a[12:15], v[188:191]
    ds_read_b64_tr_b16 a[192:193], v9 offset:2048
    v_mfma_f32_16x16x32_bf16 v[188:191], a[204:207], a[28:31], v[188:191]
    ds_read_b64_tr_b16 a[194:195], v9 offset:8192
    v_mfma_f32_16x16x32_bf16 v[180:183], a[204:207], a[24:27], v[180:183]
    buffer_load_dwordx4 v3, s[8:11], s36 offen offset:0 lds
    v_mfma_f32_16x16x32_bf16 v[180:183], a[200:203], a[8:11], v[180:183]
    v_mfma_f32_16x16x32_bf16 v[172:175], a[200:203], a[4:7], v[172:175]
    ds_read_b64_tr_b16 a[196:197], v9 offset:14336
    v_mfma_f32_16x16x32_bf16 v[172:175], a[204:207], a[20:23], v[172:175]
    ds_read_b64_tr_b16 a[198:199], v9 offset:20480
    v_mfma_f32_16x16x32_bf16 v[164:167], a[204:207], a[16:19], v[164:167]
    s_add_u32 m0, s49, 126848
    v_add_u32 v9, 73728, v13
    v_mfma_f32_16x16x32_bf16 v[164:167], a[200:203], a[0:3], v[164:167]
    s_waitcnt lgkmcnt(4)
    v_mfma_f32_16x16x32_bf16 v[192:195], a[208:211], a[0:3], v[192:195]
    ds_read_b64_tr_b16 a[200:201], v10 offset:2048
    v_mfma_f32_16x16x32_bf16 v[192:195], a[212:215], a[16:19], v[192:195]
    ds_read_b64_tr_b16 a[202:203], v10 offset:8192
    v_mfma_f32_16x16x32_bf16 v[200:203], a[212:215], a[20:23], v[200:203]
    buffer_load_dwordx4 v3, s[8:11], s36 offen offset:128 lds
    v_mfma_f32_16x16x32_bf16 v[200:203], a[208:211], a[4:7], v[200:203]
    v_mfma_f32_16x16x32_bf16 v[208:211], a[208:211], a[8:11], v[208:211]
    s_add_u32 m0, s49, 127744
    ds_read_b64_tr_b16 a[204:205], v10 offset:14336
    v_mfma_f32_16x16x32_bf16 v[208:211], a[212:215], a[24:27], v[208:211]
    ds_read_b64_tr_b16 a[206:207], v10 offset:20480
    v_mfma_f32_16x16x32_bf16 v[216:219], a[212:215], a[28:31], v[216:219]
    buffer_load_dwordx4 v3, s[8:11], s36 offen offset:256 lds
    v_mfma_f32_16x16x32_bf16 v[216:219], a[208:211], a[12:15], v[216:219]
    s_waitcnt lgkmcnt(4)
    v_add_u32 v10, 73728, v14
    s_add_u32 s36, s36, s37
    v_mfma_f32_16x16x32_bf16 v[220:223], a[192:195], a[12:15], v[220:223]
    s_sub_u32 s55, s36, 7864320
    ds_read_b64_tr_b16 a[208:209], v11 offset:2048
    s_min_u32 s36, s36, s55
    v_mfma_f32_16x16x32_bf16 v[220:223], a[196:199], a[28:31], v[220:223]
    s_add_u32 s46, s45, 69632
    ds_read_b64_tr_b16 a[210:211], v11 offset:8192
    s_sub_u32 s77, s46, 81920
    v_mfma_f32_16x16x32_bf16 v[212:215], a[196:199], a[24:27], v[212:215]
    s_min_u32 s46, s46, s77
    v_mfma_f32_16x16x32_bf16 v[212:215], a[192:195], a[8:11], v[212:215]
    v_mfma_f32_16x16x32_bf16 v[204:207], a[192:195], a[4:7], v[204:207]
    ds_read_b64_tr_b16 a[212:213], v11 offset:14336
    v_mfma_f32_16x16x32_bf16 v[204:207], a[196:199], a[20:23], v[204:207]
    s_waitcnt vmcnt(36)
    ds_read_b64_tr_b16 a[214:215], v11 offset:20480
    v_mfma_f32_16x16x32_bf16 v[196:199], a[196:199], a[16:19], v[196:199]
    s_barrier
    v_mfma_f32_16x16x32_bf16 v[196:199], a[192:195], a[0:3], v[196:199]
    s_waitcnt lgkmcnt(4)
    buffer_load_dwordx4 a[80:83], v28, s[20:23], s46 offen offset:0 sc1
    v_mfma_f32_16x16x32_bf16 v[224:227], a[200:203], a[0:3], v[224:227]
    ds_read_b64_tr_b16 a[192:193], v8 offset:0
    v_add_u32 v11, 73728, v15
    v_mfma_f32_16x16x32_bf16 v[224:227], a[204:207], a[16:19], v[224:227]
    ds_read_b64_tr_b16 a[194:195], v8 offset:6144
    v_mfma_f32_16x16x32_bf16 v[232:235], a[204:207], a[20:23], v[232:235]
    buffer_load_dwordx4 a[84:87], v28, s[20:23], s46 offen offset:1024 sc1
    v_mfma_f32_16x16x32_bf16 v[232:235], a[200:203], a[4:7], v[232:235]
    v_mfma_f32_16x16x32_bf16 v[240:243], a[200:203], a[8:11], v[240:243]
    ds_read_b64_tr_b16 a[196:197], v8 offset:12288
    v_mfma_f32_16x16x32_bf16 v[240:243], a[204:207], a[24:27], v[240:243]
    ds_read_b64_tr_b16 a[198:199], v8 offset:18432
    v_mfma_f32_16x16x32_bf16 v[248:251], a[204:207], a[28:31], v[248:251]
    v_mfma_f32_16x16x32_bf16 v[248:251], a[200:203], a[12:15], v[248:251]
    s_waitcnt lgkmcnt(4)
    v_mfma_f32_16x16x32_bf16 v[252:255], a[208:211], a[12:15], v[252:255]
    ds_read_b64_tr_b16 a[200:201], v9 offset:0
    v_mfma_f32_16x16x32_bf16 v[252:255], a[212:215], a[28:31], v[252:255]
    ds_read_b64_tr_b16 a[202:203], v9 offset:6144
    v_mfma_f32_16x16x32_bf16 v[244:247], a[212:215], a[24:27], v[244:247]
    buffer_load_dwordx4 a[88:91], v28, s[20:23], s46 offen offset:2048 sc1
    v_mfma_f32_16x16x32_bf16 v[244:247], a[208:211], a[8:11], v[244:247]
    v_mfma_f32_16x16x32_bf16 v[236:239], a[208:211], a[4:7], v[236:239]
    ds_read_b64_tr_b16 a[204:205], v9 offset:12288
    v_mfma_f32_16x16x32_bf16 v[236:239], a[212:215], a[20:23], v[236:239]
    s_waitcnt vmcnt(31)
    s_waitcnt vmcnt(21)
    ds_read_b64_tr_b16 a[206:207], v9 offset:18432
    v_mfma_f32_16x16x32_bf16 v[228:231], a[212:215], a[16:19], v[228:231]
    v_mfma_f32_16x16x32_bf16 v[228:231], a[208:211], a[0:3], v[228:231]
    s_waitcnt lgkmcnt(4)
    v_mfma_f32_16x16x32_bf16 v[64:67], a[192:195], a[32:35], v[64:67]
    ds_read_b64_tr_b16 a[208:209], v10 offset:0
    v_mfma_f32_16x16x32_bf16 v[64:67], a[196:199], a[48:51], v[64:67]
    ds_read_b64_tr_b16 a[210:211], v10 offset:6144
    v_accvgpr_write_b32 a0, 0
    v_mfma_f32_16x16x32_bf16 v[72:75], a[196:199], a[52:55], v[72:75]
    buffer_load_dwordx4 a[92:95], v28, s[20:23], s46 offen offset:3072 sc1
    v_mfma_f32_16x16x32_bf16 v[72:75], a[192:195], a[36:39], v[72:75]
    s_add_u32 s46, s45, 73728
    v_accvgpr_write_b32 a1, 0
    v_mfma_f32_16x16x32_bf16 v[80:83], a[192:195], a[40:43], v[80:83]
    s_sub_u32 s77, s46, 81920
    ds_read_b64_tr_b16 a[212:213], v10 offset:12288
    v_accvgpr_write_b32 a2, 0
    v_mfma_f32_16x16x32_bf16 v[80:83], a[196:199], a[56:59], v[80:83]
    s_min_u32 s46, s46, s77
    ds_read_b64_tr_b16 a[214:215], v10 offset:18432
    v_accvgpr_write_b32 a3, 0
    v_mfma_f32_16x16x32_bf16 v[88:91], a[196:199], a[60:63], v[88:91]
    buffer_load_dwordx4 a[224:227], v28, s[20:23], s46 offen offset:0 sc1
    v_mfma_f32_16x16x32_bf16 v[88:91], a[192:195], a[44:47], v[88:91]
    s_waitcnt lgkmcnt(4)
    v_accvgpr_write_b32 a4, 0
    v_mfma_f32_16x16x32_bf16 v[92:95], a[200:203], a[44:47], v[92:95]
    s_waitcnt vmcnt(20)
    ds_read_b64_tr_b16 a[192:193], v11 offset:0
    v_lshlrev_b32 v42, 16, v48
    v_mfma_f32_16x16x32_bf16 v[92:95], a[204:207], a[60:63], v[92:95]
    ds_read_b64_tr_b16 a[194:195], v11 offset:6144
    v_and_b32 v43, 0xffff0000, v48
    v_mfma_f32_16x16x32_bf16 v[84:87], a[204:207], a[56:59], v[84:87]
    v_sub_f32 v42, v42, v40
    v_sub_f32 v43, v43, v40
    v_mfma_f32_16x16x32_bf16 v[84:87], a[200:203], a[40:43], v[84:87]
    v_cvt_pk_bf16_f32 v44, v42, v43
    v_lshlrev_b32 v42, 16, v44
    v_mfma_f32_16x16x32_bf16 v[76:79], a[200:203], a[36:39], v[76:79]
    ds_read_b64_tr_b16 a[196:197], v11 offset:12288
    v_and_b32 v43, 0xffff0000, v44
    v_mfma_f32_16x16x32_bf16 v[76:79], a[204:207], a[52:55], v[76:79]
    ds_read_b64_tr_b16 a[198:199], v11 offset:18432
    v_mul_f32 v42, v42, v41
    v_mfma_f32_16x16x32_bf16 v[68:71], a[204:207], a[48:51], v[68:71]
    buffer_load_dwordx4 a[228:231], v28, s[20:23], s46 offen offset:1024 sc1
    v_mfma_f32_16x16x32_bf16 v[68:71], a[200:203], a[32:35], v[68:71]
    s_waitcnt lgkmcnt(4)
    v_mul_f32 v43, v43, v41
    v_cvt_pk_bf16_f32 v48, v42, v43
    v_mfma_f32_16x16x32_bf16 v[96:99], a[208:211], a[32:35], v[96:99]
    ds_read_b64_tr_b16 a[200:201], v8 offset:1024
    v_lshlrev_b32 v42, 16, v49
    v_mfma_f32_16x16x32_bf16 v[96:99], a[212:215], a[48:51], v[96:99]
    ds_read_b64_tr_b16 a[202:203], v8 offset:7168
    v_and_b32 v43, 0xffff0000, v49
    v_mfma_f32_16x16x32_bf16 v[104:107], a[212:215], a[52:55], v[104:107]
    s_waitcnt vmcnt(20)
    v_sub_f32 v42, v42, v40
    v_sub_f32 v43, v43, v40
    v_mfma_f32_16x16x32_bf16 v[104:107], a[208:211], a[36:39], v[104:107]
    buffer_load_dwordx4 a[232:235], v28, s[20:23], s46 offen offset:2048 sc1
    v_mfma_f32_16x16x32_bf16 v[112:115], a[208:211], a[40:43], v[112:115]
    ds_read_b64_tr_b16 a[204:205], v8 offset:13312
    v_cvt_pk_bf16_f32 v44, v42, v43
    v_mfma_f32_16x16x32_bf16 v[112:115], a[212:215], a[56:59], v[112:115]
    ds_read_b64_tr_b16 a[206:207], v8 offset:19456
    v_lshlrev_b32 v42, 16, v44
    v_mfma_f32_16x16x32_bf16 v[120:123], a[212:215], a[60:63], v[120:123]
    v_and_b32 v43, 0xffff0000, v44
    v_mul_f32 v42, v42, v41
    v_mfma_f32_16x16x32_bf16 v[120:123], a[208:211], a[44:47], v[120:123]
    s_waitcnt lgkmcnt(4)
    v_mul_f32 v43, v43, v41
    v_cvt_pk_bf16_f32 v49, v42, v43
    v_mfma_f32_16x16x32_bf16 v[124:127], a[192:195], a[44:47], v[124:127]
    ds_read_b64_tr_b16 a[208:209], v9 offset:1024
    v_lshlrev_b32 v42, 16, v50
    v_mfma_f32_16x16x32_bf16 v[124:127], a[196:199], a[60:63], v[124:127]
    ds_read_b64_tr_b16 a[210:211], v9 offset:7168
    v_and_b32 v43, 0xffff0000, v50
    v_mfma_f32_16x16x32_bf16 v[116:119], a[196:199], a[56:59], v[116:119]
    buffer_load_dwordx4 a[236:239], v28, s[20:23], s46 offen offset:3072 sc1
    v_mfma_f32_16x16x32_bf16 v[116:119], a[192:195], a[40:43], v[116:119]
    v_sub_f32 v42, v42, v40
    v_sub_f32 v43, v43, v40
    v_mfma_f32_16x16x32_bf16 v[108:111], a[192:195], a[36:39], v[108:111]
    s_add_u32 s46, s45, 77824
    ds_read_b64_tr_b16 a[212:213], v9 offset:13312
    v_cvt_pk_bf16_f32 v44, v42, v43
    v_mfma_f32_16x16x32_bf16 v[108:111], a[196:199], a[52:55], v[108:111]
    s_sub_u32 s77, s46, 81920
    ds_read_b64_tr_b16 a[214:215], v9 offset:19456
    v_lshlrev_b32 v42, 16, v44
    v_mfma_f32_16x16x32_bf16 v[100:103], a[196:199], a[48:51], v[100:103]
    s_min_u32 s46, s46, s77
    v_and_b32 v43, 0xffff0000, v44
    v_mul_f32 v42, v42, v41
    v_mfma_f32_16x16x32_bf16 v[100:103], a[192:195], a[32:35], v[100:103]
    s_waitcnt lgkmcnt(4)
    v_mul_f32 v43, v43, v41
    v_cvt_pk_bf16_f32 v50, v42, v43
    v_mfma_f32_16x16x32_bf16 v[128:131], a[200:203], a[32:35], v[128:131]
    ds_read_b64_tr_b16 a[192:193], v10 offset:1024
    v_lshlrev_b32 v42, 16, v51
    v_mfma_f32_16x16x32_bf16 v[128:131], a[204:207], a[48:51], v[128:131]
    ds_read_b64_tr_b16 a[194:195], v10 offset:7168
    v_and_b32 v43, 0xffff0000, v51
    v_mfma_f32_16x16x32_bf16 v[136:139], a[204:207], a[52:55], v[136:139]
    buffer_load_dwordx4 a[240:243], v28, s[20:23], s46 offen offset:0 sc1
    v_mfma_f32_16x16x32_bf16 v[136:139], a[200:203], a[36:39], v[136:139]
    v_sub_f32 v42, v42, v40
    v_sub_f32 v43, v43, v40
    v_mfma_f32_16x16x32_bf16 v[144:147], a[200:203], a[40:43], v[144:147]
    ds_read_b64_tr_b16 a[196:197], v10 offset:13312
    v_cvt_pk_bf16_f32 v44, v42, v43
    v_mfma_f32_16x16x32_bf16 v[144:147], a[204:207], a[56:59], v[144:147]
    ds_read_b64_tr_b16 a[198:199], v10 offset:19456
    v_lshlrev_b32 v42, 16, v44
    v_mfma_f32_16x16x32_bf16 v[152:155], a[204:207], a[60:63], v[152:155]
    buffer_load_dwordx4 a[244:247], v28, s[20:23], s46 offen offset:1024 sc1
    v_mfma_f32_16x16x32_bf16 v[152:155], a[200:203], a[44:47], v[152:155]
    s_waitcnt lgkmcnt(4)
    v_and_b32 v43, 0xffff0000, v44
    v_mul_f32 v42, v42, v41
    v_mfma_f32_16x16x32_bf16 v[156:159], a[208:211], a[44:47], v[156:159]
    ds_read_b64_tr_b16 a[200:201], v11 offset:1024
    v_mul_f32 v43, v43, v41
    v_mfma_f32_16x16x32_bf16 v[156:159], a[212:215], a[60:63], v[156:159]
    ds_read_b64_tr_b16 a[202:203], v11 offset:7168
    v_cvt_pk_bf16_f32 v51, v42, v43
    v_mfma_f32_16x16x32_bf16 v[148:151], a[212:215], a[56:59], v[148:151]
    v_lshlrev_b32 v42, 16, v52
    v_and_b32 v43, 0xffff0000, v52
    v_mfma_f32_16x16x32_bf16 v[148:151], a[208:211], a[40:43], v[148:151]
    v_sub_f32 v42, v42, v40
    v_sub_f32 v43, v43, v40
    v_mfma_f32_16x16x32_bf16 v[140:143], a[208:211], a[36:39], v[140:143]
    ds_read_b64_tr_b16 a[204:205], v11 offset:13312
    v_cvt_pk_bf16_f32 v44, v42, v43
    v_mfma_f32_16x16x32_bf16 v[140:143], a[212:215], a[52:55], v[140:143]
    ds_read_b64_tr_b16 a[206:207], v11 offset:19456
    v_lshlrev_b32 v42, 16, v44
    v_mfma_f32_16x16x32_bf16 v[132:135], a[212:215], a[48:51], v[132:135]
    buffer_load_dwordx4 a[248:251], v28, s[20:23], s46 offen offset:2048 sc1
    v_mfma_f32_16x16x32_bf16 v[132:135], a[208:211], a[32:35], v[132:135]
    s_waitcnt lgkmcnt(4)
    v_and_b32 v43, 0xffff0000, v44
    v_mul_f32 v42, v42, v41
    v_mfma_f32_16x16x32_bf16 v[160:163], a[192:195], a[32:35], v[160:163]
    ds_read_b64_tr_b16 a[208:209], v8 offset:2048
    v_mul_f32 v43, v43, v41
    v_mfma_f32_16x16x32_bf16 v[160:163], a[196:199], a[48:51], v[160:163]
    ds_read_b64_tr_b16 a[210:211], v8 offset:8192
    v_cvt_pk_bf16_f32 v52, v42, v43
    v_mfma_f32_16x16x32_bf16 v[168:171], a[196:199], a[52:55], v[168:171]
    v_lshlrev_b32 v42, 16, v53
    v_and_b32 v43, 0xffff0000, v53
    v_mfma_f32_16x16x32_bf16 v[168:171], a[192:195], a[36:39], v[168:171]
    buffer_load_dwordx4 a[252:255], v28, s[20:23], s46 offen offset:3072 sc1
    v_mfma_f32_16x16x32_bf16 v[176:179], a[192:195], a[40:43], v[176:179]
    ds_read_b64_tr_b16 a[212:213], v8 offset:14336
    v_sub_f32 v42, v42, v40
    v_mfma_f32_16x16x32_bf16 v[176:179], a[196:199], a[56:59], v[176:179]
    ds_read_b64_tr_b16 a[214:215], v8 offset:20480
    v_sub_f32 v43, v43, v40
    v_mfma_f32_16x16x32_bf16 v[184:187], a[196:199], a[60:63], v[184:187]
    v_cvt_pk_bf16_f32 v44, v42, v43
    v_lshlrev_b32 v42, 16, v44
    v_mfma_f32_16x16x32_bf16 v[184:187], a[192:195], a[44:47], v[184:187]
    s_waitcnt lgkmcnt(4)
    v_and_b32 v43, 0xffff0000, v44
    v_mul_f32 v42, v42, v41
    v_mfma_f32_16x16x32_bf16 v[188:191], a[200:203], a[44:47], v[188:191]
    ds_read_b64_tr_b16 a[192:193], v9 offset:2048
    v_mul_f32 v43, v43, v41
    v_mfma_f32_16x16x32_bf16 v[188:191], a[204:207], a[60:63], v[188:191]
    s_add_u32 m0, s49, 0
    ds_read_b64_tr_b16 a[194:195], v9 offset:8192
    v_cvt_pk_bf16_f32 v53, v42, v43
    v_mfma_f32_16x16x32_bf16 v[180:183], a[204:207], a[56:59], v[180:183]
    buffer_load_dwordx4 v4, s[12:15], s38 offen offset:0 lds
    v_mfma_f32_16x16x32_bf16 v[180:183], a[200:203], a[40:43], v[180:183]
    v_lshlrev_b32 v42, 16, v54
    v_and_b32 v43, 0xffff0000, v54
    v_mfma_f32_16x16x32_bf16 v[172:175], a[200:203], a[36:39], v[172:175]
    ds_read_b64_tr_b16 a[196:197], v9 offset:14336
    v_sub_f32 v42, v42, v40
    v_mfma_f32_16x16x32_bf16 v[172:175], a[204:207], a[52:55], v[172:175]
    ds_read_b64_tr_b16 a[198:199], v9 offset:20480
    v_sub_f32 v43, v43, v40
    v_mfma_f32_16x16x32_bf16 v[164:167], a[204:207], a[48:51], v[164:167]
    v_cvt_pk_bf16_f32 v44, v42, v43
    v_lshlrev_b32 v42, 16, v44
    v_mfma_f32_16x16x32_bf16 v[164:167], a[200:203], a[32:35], v[164:167]
    s_waitcnt lgkmcnt(4)
    v_and_b32 v43, 0xffff0000, v44
    v_mul_f32 v42, v42, v41
    v_mfma_f32_16x16x32_bf16 v[192:195], a[208:211], a[32:35], v[192:195]
    s_add_u32 m0, s49, 896
    ds_read_b64_tr_b16 a[200:201], v10 offset:2048
    v_mul_f32 v43, v43, v41
    v_mfma_f32_16x16x32_bf16 v[192:195], a[212:215], a[48:51], v[192:195]
    ds_read_b64_tr_b16 a[202:203], v10 offset:8192
    v_cvt_pk_bf16_f32 v54, v42, v43
    v_mfma_f32_16x16x32_bf16 v[200:203], a[212:215], a[52:55], v[200:203]
    buffer_load_dwordx4 v4, s[12:15], s38 offen offset:128 lds
    v_mfma_f32_16x16x32_bf16 v[200:203], a[208:211], a[36:39], v[200:203]
    v_lshlrev_b32 v42, 16, v55
    v_and_b32 v43, 0xffff0000, v55
    v_mfma_f32_16x16x32_bf16 v[208:211], a[208:211], a[40:43], v[208:211]
    ds_read_b64_tr_b16 a[204:205], v10 offset:14336
    v_sub_f32 v42, v42, v40
    v_mfma_f32_16x16x32_bf16 v[208:211], a[212:215], a[56:59], v[208:211]
    ds_read_b64_tr_b16 a[206:207], v10 offset:20480
    v_sub_f32 v43, v43, v40
    v_mfma_f32_16x16x32_bf16 v[216:219], a[212:215], a[60:63], v[216:219]
    s_add_u32 m0, s49, 1792
    v_cvt_pk_bf16_f32 v44, v42, v43
    v_lshlrev_b32 v42, 16, v44
    v_mfma_f32_16x16x32_bf16 v[216:219], a[208:211], a[44:47], v[216:219]
    s_waitcnt lgkmcnt(4)
    v_and_b32 v43, 0xffff0000, v44
    v_mul_f32 v42, v42, v41
    v_mfma_f32_16x16x32_bf16 v[220:223], a[192:195], a[44:47], v[220:223]
    ds_read_b64_tr_b16 a[208:209], v11 offset:2048
    v_mul_f32 v43, v43, v41
    v_mfma_f32_16x16x32_bf16 v[220:223], a[196:199], a[60:63], v[220:223]
    ds_read_b64_tr_b16 a[210:211], v11 offset:8192
    v_cvt_pk_bf16_f32 v55, v42, v43
    v_mfma_f32_16x16x32_bf16 v[212:215], a[196:199], a[56:59], v[212:215]
    buffer_load_dwordx4 v4, s[12:15], s38 offen offset:256 lds
    v_mfma_f32_16x16x32_bf16 v[212:215], a[192:195], a[40:43], v[212:215]
    v_lshrrev_b32 v60, 14, v61
    v_and_b32 v61, 0x2000, v61
    v_mfma_f32_16x16x32_bf16 v[204:207], a[192:195], a[36:39], v[204:207]
    s_add_u32 m0, s49, 3072
    ds_read_b64_tr_b16 a[212:213], v11 offset:14336
    v_cmp_ne_u32 s[88:89], 0, v60
    v_mfma_f32_16x16x32_bf16 v[204:207], a[196:199], a[52:55], v[204:207]
    s_waitcnt vmcnt(25)
    ds_read_b64_tr_b16 a[214:215], v11 offset:20480
    v_accvgpr_write_b32 a5, 0
    v_mfma_f32_16x16x32_bf16 v[196:199], a[196:199], a[48:51], v[196:199]
    s_barrier
    v_mfma_f32_16x16x32_bf16 v[196:199], a[192:195], a[32:35], v[196:199]
    s_waitcnt lgkmcnt(4)
    buffer_load_dwordx4 v5, s[12:15], s38 offen offset:0 lds
    v_add_u32 v8, 98304, v12
    v_mfma_f32_16x16x32_bf16 v[224:227], a[200:203], a[32:35], v[224:227]
    s_lshr_b64 s[88:89], s[88:89], 12
    ds_read_b64_tr_b16 a[192:193], v8 offset:0
    v_accvgpr_write_b32 a6, 0
    v_mfma_f32_16x16x32_bf16 v[224:227], a[204:207], a[48:51], v[224:227]
    s_bcnt1_i32_b64 s93, s[88:89]
    ds_read_b64_tr_b16 a[194:195], v8 offset:6144
    v_cmp_ne_u32 s[88:89], 0, v61
    v_mfma_f32_16x16x32_bf16 v[232:235], a[204:207], a[52:55], v[232:235]
    s_cmp_gt_u32 s93, 26
    s_cselect_b32 s93, -1, 0
    v_accvgpr_write_b32 a7, 0
    v_mfma_f32_16x16x32_bf16 v[232:235], a[200:203], a[36:39], v[232:235]
    s_add_u32 m0, s49, 3968
    v_accvgpr_write_b32 a8, 0
    v_accvgpr_write_b32 a9, 0
    v_mfma_f32_16x16x32_bf16 v[240:243], a[200:203], a[40:43], v[240:243]
    s_xor_b32 s88, s88, s93
    ds_read_b64_tr_b16 a[196:197], v8 offset:12288
    v_accvgpr_write_b32 a10, 0
    v_mfma_f32_16x16x32_bf16 v[240:243], a[204:207], a[56:59], v[240:243]
    s_and_b32 s88, s88, 0xfff
    ds_read_b64_tr_b16 a[198:199], v8 offset:18432
    v_accvgpr_write_b32 a11, 0
    v_mfma_f32_16x16x32_bf16 v[248:251], a[204:207], a[60:63], v[248:251]
    buffer_load_dwordx4 v5, s[12:15], s38 offen offset:128 lds
    v_mfma_f32_16x16x32_bf16 v[248:251], a[200:203], a[44:47], v[248:251]
    s_waitcnt lgkmcnt(4)
    v_accvgpr_write_b32 a12, 0
    v_accvgpr_write_b32 a13, 0
    v_add_u32 v9, 98304, v13
    v_mfma_f32_16x16x32_bf16 v[252:255], a[208:211], a[44:47], v[252:255]
    s_lshl_b32 s93, s88, 13
    ds_read_b64_tr_b16 a[200:201], v9 offset:0
    v_accvgpr_write_b32 a14, 0
    v_mfma_f32_16x16x32_bf16 v[252:255], a[212:215], a[60:63], v[252:255]
    s_add_u32 m0, s49, 4864
    ds_read_b64_tr_b16 a[202:203], v9 offset:6144
    v_accvgpr_write_b32 a15, 0
    v_mfma_f32_16x16x32_bf16 v[244:247], a[212:215], a[56:59], v[244:247]
    buffer_load_dwordx4 v5, s[12:15], s38 offen offset:256 lds
    v_mfma_f32_16x16x32_bf16 v[244:247], a[208:211], a[40:43], v[244:247]
pg_4:
    s_cbranch_execz pg_8
    s_add_u32 s38, s38, 24576
    v_accvgpr_write_b32 a16, 0
    v_accvgpr_write_b32 a17, 0
    v_mfma_f32_16x16x32_bf16 v[236:239], a[208:211], a[36:39], v[236:239]
    s_add_u32 s88, s51, 8
    ds_read_b64_tr_b16 a[204:205], v9 offset:12288
    v_accvgpr_write_b32 a18, 0
    v_mfma_f32_16x16x32_bf16 v[236:239], a[212:215], a[52:55], v[236:239]
    s_waitcnt vmcnt(24)
    s_waitcnt vmcnt(14)
    ds_read_b64_tr_b16 a[206:207], v9 offset:18432
    v_mfma_f32_16x16x32_bf16 v[228:231], a[212:215], a[48:51], v[228:231]
    s_lshr_b32 s88, s93, s88
    v_accvgpr_write_b32 a19, 0
    v_accvgpr_write_b32 a20, 0
    v_mfma_f32_16x16x32_bf16 v[228:231], a[208:211], a[32:35], v[228:231]
    s_waitcnt lgkmcnt(4)
    v_accvgpr_write_b32 a21, 0
    v_accvgpr_write_b32 a22, 0
    v_add_u32 v10, 98304, v14
    v_mfma_f32_16x16x32_bf16 v[64:67], a[192:195], a[64:67], v[64:67]
    s_add_u32 m0, s49, 24576
    ds_read_b64_tr_b16 a[208:209], v10 offset:0
    v_accvgpr_write_b32 a23, 0
    v_mfma_f32_16x16x32_bf16 v[64:67], a[196:199], a[80:83], v[64:67]
    s_and_b32 s88, s88, 0x2000
    ds_read_b64_tr_b16 a[210:211], v10 offset:6144
    v_accvgpr_write_b32 a24, 0
    v_mfma_f32_16x16x32_bf16 v[72:75], a[196:199], a[84:87], v[72:75]
    s_add_u32 s5, s5, s88
    ds_read_b64_tr_b16 v[32:33], v25 offset:0
    v_accvgpr_write_b32 a25, 0
    v_mfma_f32_16x16x32_bf16 v[72:75], a[192:195], a[68:71], v[72:75]
    s_lshl_b32 s88, s52, 15
    ds_read_b64_tr_b16 v[34:35], v25 offset:4096
    v_accvgpr_write_b32 a26, 0
    v_mfma_f32_16x16x32_bf16 v[80:83], a[192:195], a[72:75], v[80:83]
    s_lshl_b32 s89, s53, 9
    ds_read_b64_tr_b16 a[212:213], v10 offset:12288
    v_accvgpr_write_b32 a27, 0
    v_mfma_f32_16x16x32_bf16 v[80:83], a[196:199], a[88:91], v[80:83]
    s_add_u32 s88, s88, s89
    ds_read_b64_tr_b16 a[214:215], v10 offset:18432
    v_accvgpr_write_b32 a28, 0
    v_mfma_f32_16x16x32_bf16 v[88:91], a[196:199], a[92:95], v[88:91]
    s_lshl_b32 s89, s3, 7
    ds_read_b64_tr_b16 v[36:37], v25 offset:1024
    v_accvgpr_write_b32 a29, 0
    v_mfma_f32_16x16x32_bf16 v[88:91], a[192:195], a[76:79], v[88:91]
    s_waitcnt lgkmcnt(4)
    buffer_load_dwordx4 v4, s[12:15], s38 offen offset:0 lds
    v_add_u32 v11, 98304, v15
    v_mfma_f32_16x16x32_bf16 v[92:95], a[200:203], a[76:79], v[92:95]
    s_add_u32 m0, s49, 25472
    ds_read_b64_tr_b16 a[192:193], v11 offset:0
    v_accvgpr_write_b32 a30, 0
    v_mfma_f32_16x16x32_bf16 v[92:95], a[204:207], a[92:95], v[92:95]
    s_add_u32 s88, s88, s89
    ds_read_b64_tr_b16 a[194:195], v11 offset:6144
    v_accvgpr_write_b32 a31, 0
    v_mfma_f32_16x16x32_bf16 v[84:87], a[204:207], a[88:91], v[84:87]
    s_add_u32 s88, s88, 4456452
    ds_read_b64_tr_b16 v[38:39], v25 offset:5120
    v_accvgpr_write_b32 a32, 0
    v_mfma_f32_16x16x32_bf16 v[84:87], a[200:203], a[72:75], v[84:87]
    s_lshr_b32 s89, s93, 8
    ds_read_b64_tr_b16 v[40:41], v25 offset:8192
    v_lshrrev_b32 v60, v1, s89
    v_mfma_f32_16x16x32_bf16 v[76:79], a[200:203], a[68:71], v[76:79]
    ds_read_b64_tr_b16 a[196:197], v11 offset:12288
    v_and_b32 v60, 0x2000, v60
    v_mfma_f32_16x16x32_bf16 v[76:79], a[204:207], a[84:87], v[76:79]
    ds_read_b64_tr_b16 a[198:199], v11 offset:18432
    v_add_u32 v60, s88, v60
    v_mfma_f32_16x16x32_bf16 v[68:71], a[204:207], a[80:83], v[68:71]
    ds_read_b64_tr_b16 v[42:43], v25 offset:12288
    v_bfe_u32 v61, v1, 1, 1
    v_mfma_f32_16x16x32_bf16 v[68:71], a[200:203], a[64:67], v[68:71]
    s_waitcnt lgkmcnt(4)
    buffer_load_dwordx4 v4, s[12:15], s38 offen offset:128 lds
    v_mfma_f32_16x16x32_bf16 v[96:99], a[208:211], a[64:67], v[96:99]
    s_add_u32 m0, s49, 26368
    ds_read_b64_tr_b16 a[200:201], v8 offset:1024
    v_lshl_add_u32 v60, v61, 14, v60
    v_mfma_f32_16x16x32_bf16 v[96:99], a[212:215], a[80:83], v[96:99]
    ds_read_b64_tr_b16 a[202:203], v8 offset:7168
    v_and_b32 v61, 1, v1
    v_mfma_f32_16x16x32_bf16 v[104:107], a[212:215], a[84:87], v[104:107]
    ds_read_b64_tr_b16 v[44:45], v25 offset:9216
    v_lshl_add_u32 v60, v61, 12, v60
    v_mfma_f32_16x16x32_bf16 v[104:107], a[208:211], a[68:71], v[104:107]
    ds_read_b64_tr_b16 v[46:47], v25 offset:13312
    v_lshrrev_b32 v61, 2, v1
    v_mfma_f32_16x16x32_bf16 v[112:115], a[208:211], a[72:75], v[112:115]
    ds_read_b64_tr_b16 a[204:205], v8 offset:13312
    v_min_u32 v61, 1, v61
    v_mfma_f32_16x16x32_bf16 v[112:115], a[212:215], a[88:91], v[112:115]
    ds_read_b64_tr_b16 a[206:207], v8 offset:19456
    v_lshl_or_b32 v60, v61, 30, v60
    v_mfma_f32_16x16x32_bf16 v[120:123], a[212:215], a[92:95], v[120:123]
    buffer_load_dwordx4 v4, s[12:15], s38 offen offset:256 lds
    v_accvgpr_write_b32 a223, v60
    v_mfma_f32_16x16x32_bf16 v[120:123], a[208:211], a[76:79], v[120:123]
    s_waitcnt lgkmcnt(4)
    v_accvgpr_write_b32 a33, 0
    v_accvgpr_write_b32 a34, 0
    v_mfma_f32_16x16x32_bf16 v[124:127], a[192:195], a[76:79], v[124:127]
    s_add_u32 m0, s49, 27648
    ds_read_b64_tr_b16 a[208:209], v9 offset:1024
    v_accvgpr_write_b32 a35, 0
    v_mfma_f32_16x16x32_bf16 v[124:127], a[196:199], a[92:95], v[124:127]
    s_mul_hi_u32 s47, s58, 429496730
    ds_read_b64_tr_b16 a[210:211], v9 offset:7168
    v_accvgpr_write_b32 a36, 0
    v_mfma_f32_16x16x32_bf16 v[116:119], a[196:199], a[88:91], v[116:119]
    buffer_load_dwordx4 v5, s[12:15], s38 offen offset:0 lds
    v_mfma_f32_16x16x32_bf16 v[116:119], a[192:195], a[72:75], v[116:119]
    s_add_u32 m0, s49, 28544
    v_accvgpr_write_b32 a37, 0
    v_accvgpr_write_b32 a38, 0
    v_mfma_f32_16x16x32_bf16 v[108:111], a[192:195], a[68:71], v[108:111]
    s_lshl_b32 s37, s47, 8
    ds_read_b64_tr_b16 a[212:213], v9 offset:13312
    v_accvgpr_write_b32 a39, 0
    v_mfma_f32_16x16x32_bf16 v[108:111], a[196:199], a[84:87], v[108:111]
    s_add_u32 s37, s37, 4718736
    ds_read_b64_tr_b16 a[214:215], v9 offset:19456
    v_accvgpr_write_b32 a40, 0
    v_mfma_f32_16x16x32_bf16 v[100:103], a[196:199], a[80:83], v[100:103]
    buffer_load_dwordx4 v5, s[12:15], s38 offen offset:128 lds
    v_mfma_f32_16x16x32_bf16 v[100:103], a[192:195], a[64:67], v[100:103]
    s_waitcnt lgkmcnt(4)
    v_accvgpr_write_b32 a41, 0
    v_accvgpr_write_b32 a42, 0
    v_mfma_f32_16x16x32_bf16 v[128:131], a[200:203], a[64:67], v[128:131]
    s_add_u32 m0, s49, 29440
    ds_read_b64_tr_b16 a[192:193], v10 offset:1024
    v_accvgpr_write_b32 a43, 0
    v_mfma_f32_16x16x32_bf16 v[128:131], a[204:207], a[80:83], v[128:131]
    s_mov_b32 s32, s82
    ds_read_b64_tr_b16 a[194:195], v10 offset:7168
    v_accvgpr_write_b32 a44, 0
    v_mfma_f32_16x16x32_bf16 v[136:139], a[204:207], a[84:87], v[136:139]
    v_mfma_f32_16x16x32_bf16 v[20:23], v[48:51], v[32:35], 0
    v_mfma_f32_16x16x32_bf16 v[58:61], v[48:51], v[36:39], 0
    v_mfma_f32_16x16x32_bf16 v[20:23], v[52:55], v[40:43], v[20:23]
    v_mfma_f32_16x16x32_bf16 v[58:61], v[52:55], v[44:47], v[58:61]
    v_mfma_f32_16x16x32_bf16 v[136:139], a[200:203], a[68:71], v[136:139]
    buffer_load_dwordx4 v5, s[12:15], s38 offen offset:256 lds
    v_mfma_f32_16x16x32_bf16 v[144:147], a[200:203], a[72:75], v[144:147]
    s_add_u32 s38, s38, 24576
    ds_read_b64_tr_b16 a[196:197], v10 offset:13312
    v_accvgpr_write_b32 a45, 0
    v_mfma_f32_16x16x32_bf16 v[144:147], a[204:207], a[88:91], v[144:147]
    s_and_b32 s33, s83, 0xffff
    ds_read_b64_tr_b16 a[198:199], v10 offset:19456
    v_accvgpr_write_b32 a46, 0
    v_mfma_f32_16x16x32_bf16 v[152:155], a[204:207], a[92:95], v[152:155]
    s_mov_b32 s34, 1966080
    v_accvgpr_write_b32 a47, 0
    v_accvgpr_write_b32 a48, 0
    v_mfma_f32_16x16x32_bf16 v[152:155], a[200:203], a[76:79], v[152:155]
    s_waitcnt lgkmcnt(4)
    v_accvgpr_write_b32 a49, 0
    v_accvgpr_write_b32 a50, 0
    v_mfma_f32_16x16x32_bf16 v[156:159], a[208:211], a[76:79], v[156:159]
    s_add_u32 m0, s49, 73728
    ds_read_b64_tr_b16 a[200:201], v11 offset:1024
    v_accvgpr_write_b32 a51, 0
    v_mfma_f32_16x16x32_bf16 v[156:159], a[212:215], a[92:95], v[156:159]
    s_mov_b32 s35, 0x00020000
    ds_read_b64_tr_b16 a[202:203], v11 offset:7168
    v_accvgpr_write_b32 a52, 0
    v_mfma_f32_16x16x32_bf16 v[148:151], a[212:215], a[88:91], v[148:151]
    buffer_load_dwordx4 v6, s[16:19], s40 offen offset:0 lds
    v_mfma_f32_16x16x32_bf16 v[148:151], a[208:211], a[72:75], v[148:151]
    s_mul_i32 s60, s47, 80640
    v_accvgpr_write_b32 a53, 0
    v_accvgpr_write_b32 a54, 0
    v_mfma_f32_16x16x32_bf16 v[140:143], a[208:211], a[68:71], v[140:143]
    s_lshl_b32 s56, s58, 7
    ds_read_b64_tr_b16 a[204:205], v11 offset:13312
    v_accvgpr_write_b32 a55, 0
    v_mfma_f32_16x16x32_bf16 v[140:143], a[212:215], a[84:87], v[140:143]
    s_add_u32 m0, s49, 74624
    ds_read_b64_tr_b16 a[206:207], v11 offset:19456
    v_accvgpr_write_b32 a56, 0
    v_mfma_f32_16x16x32_bf16 v[132:135], a[212:215], a[80:83], v[132:135]
    buffer_load_dwordx4 v6, s[16:19], s40 offen offset:128 lds
    v_mfma_f32_16x16x32_bf16 v[132:135], a[208:211], a[64:67], v[132:135]
    s_waitcnt lgkmcnt(4)
    v_accvgpr_write_b32 a57, 0
    v_accvgpr_write_b32 a58, 0
    v_mfma_f32_16x16x32_bf16 v[160:163], a[192:195], a[64:67], v[160:163]
    s_add_u32 s60, s60, s56
    ds_read_b64_tr_b16 a[208:209], v8 offset:2048
    v_accvgpr_write_b32 a59, 0
    v_mfma_f32_16x16x32_bf16 v[160:163], a[196:199], a[80:83], v[160:163]
    s_mul_i32 s56, s53, 983040
    ds_read_b64_tr_b16 a[210:211], v8 offset:8192
    v_accvgpr_write_b32 a60, 0
    v_mfma_f32_16x16x32_bf16 v[168:171], a[196:199], a[84:87], v[168:171]
    s_add_u32 s28, s72, s56
    s_addc_u32 s29, s73, 0
    v_accvgpr_write_b32 a61, 0
    v_mfma_f32_16x16x32_bf16 v[168:171], a[192:195], a[68:71], v[168:171]
    s_and_b32 s29, s29, 0xffff
    v_accvgpr_write_b32 a62, 0
    v_accvgpr_write_b32 a63, 0
    v_mfma_f32_16x16x32_bf16 v[176:179], a[192:195], a[72:75], v[176:179]
    s_add_u32 m0, s49, 75520
    ds_read_b64_tr_b16 a[212:213], v8 offset:14336
    v_mov_b32 v22, v58
    v_mfma_f32_16x16x32_bf16 v[176:179], a[196:199], a[88:91], v[176:179]
    s_mov_b32 s30, 983040
    ds_read_b64_tr_b16 a[214:215], v8 offset:20480
    v_mov_b32 v23, v59
    v_mfma_f32_16x16x32_bf16 v[184:187], a[196:199], a[92:95], v[184:187]
    buffer_store_dwordx4 v[20:23], v26, s[24:27], s62 offen sc1
    v_mfma_f32_16x16x32_bf16 v[184:187], a[192:195], a[76:79], v[184:187]
    s_waitcnt lgkmcnt(4)
    buffer_load_dwordx4 v6, s[16:19], s40 offen offset:256 lds
    v_mfma_f32_16x16x32_bf16 v[188:191], a[200:203], a[76:79], v[188:191]
    s_mov_b32 s31, 0x00020000
    ds_read_b64_tr_b16 a[192:193], v9 offset:2048
    v_add_u32 v8, 122880, v12
    v_mfma_f32_16x16x32_bf16 v[188:191], a[204:207], a[92:95], v[188:191]
    s_lshr_b32 s48, s2, 3
    ds_read_b64_tr_b16 a[194:195], v9 offset:8192
    s_lshl_b32 s48, s48, 2
    v_mfma_f32_16x16x32_bf16 v[180:183], a[204:207], a[88:91], v[180:183]
    s_add_u32 m0, s49, 76800
    s_add_u32 s48, s48, s3
    s_mul_i32 s6, s48, 7680
    v_mfma_f32_16x16x32_bf16 v[180:183], a[200:203], a[72:75], v[180:183]
    buffer_load_dwordx4 v7, s[16:19], s40 offen offset:0 lds
    v_mfma_f32_16x16x32_bf16 v[172:175], a[200:203], a[68:71], v[172:175]
    ds_read_b64_tr_b16 a[196:197], v9 offset:14336
    v_lshlrev_b32 v16, 7, v16
    v_mfma_f32_16x16x32_bf16 v[172:175], a[204:207], a[84:87], v[172:175]
    s_lshl_b32 s57, s51, 8
    ds_read_b64_tr_b16 a[198:199], v9 offset:20480
    s_add_u32 s56, s56, s57
    v_mfma_f32_16x16x32_bf16 v[164:167], a[204:207], a[80:83], v[164:167]
    s_lshr_b32 s63, s51, 1
    v_add_u32 v9, 122880, v13
    s_lshl_b32 s63, s63, 7
    v_mfma_f32_16x16x32_bf16 v[164:167], a[200:203], a[64:67], v[164:167]
    s_waitcnt lgkmcnt(4)
    s_add_u32 s63, s63, 768
    s_sub_u32 s63, s63, s57
    v_mfma_f32_16x16x32_bf16 v[192:195], a[208:211], a[64:67], v[192:195]
    s_mov_b32 s66, 0
    ds_read_b64_tr_b16 a[200:201], v10 offset:2048
    s_sub_u32 s57, 7864320, s56
    v_mfma_f32_16x16x32_bf16 v[192:195], a[212:215], a[80:83], v[192:195]
    s_add_u32 m0, s49, 77696
    ds_read_b64_tr_b16 a[202:203], v10 offset:8192
    s_add_u32 s8, s72, s56
    s_addc_u32 s9, s73, 0
    v_mfma_f32_16x16x32_bf16 v[200:203], a[212:215], a[84:87], v[200:203]
    buffer_load_dwordx4 v7, s[16:19], s40 offen offset:128 lds
    v_mfma_f32_16x16x32_bf16 v[200:203], a[208:211], a[68:71], v[200:203]
    s_and_b32 s9, s9, 0xffff
    s_mov_b32 s10, s57
    s_mov_b32 s11, 0x00020000
    v_mfma_f32_16x16x32_bf16 v[208:211], a[208:211], a[72:75], v[208:211]
    s_mul_i32 s36, s51, 245760
    ds_read_b64_tr_b16 a[204:205], v10 offset:14336
    s_mul_i32 s56, s3, 20480
    v_mfma_f32_16x16x32_bf16 v[208:211], a[212:215], a[88:91], v[208:211]
    s_add_u32 s36, s36, s56
    ds_read_b64_tr_b16 a[206:207], v10 offset:20480
    s_lshl_b32 s59, s53, 23
    v_mfma_f32_16x16x32_bf16 v[216:219], a[212:215], a[92:95], v[216:219]
    s_add_u32 s59, s59, 67108864
    v_add_u32 v10, 122880, v14
    s_add_u32 s20, s86, s59
    s_addc_u32 s21, s87, 0
    v_mfma_f32_16x16x32_bf16 v[216:219], a[208:211], a[76:79], v[216:219]
    s_waitcnt lgkmcnt(4)
    s_add_u32 m0, s49, 78592
    s_and_b32 s21, s21, 0xffff
    v_mfma_f32_16x16x32_bf16 v[220:223], a[192:195], a[76:79], v[220:223]
    s_mov_b32 s22, 8388608
    ds_read_b64_tr_b16 a[208:209], v11 offset:2048
    s_mov_b32 s23, 0x00020000
    v_mfma_f32_16x16x32_bf16 v[220:223], a[196:199], a[92:95], v[220:223]
    s_add_u32 s55, s51, 8
    ds_read_b64_tr_b16 a[210:211], v11 offset:8192
    s_lshr_b32 s55, s93, s55
    v_mfma_f32_16x16x32_bf16 v[212:215], a[196:199], a[88:91], v[212:215]
    buffer_load_dwordx4 v7, s[16:19], s40 offen offset:256 lds
    v_mfma_f32_16x16x32_bf16 v[212:215], a[192:195], a[72:75], v[212:215]
    s_add_u32 s40, s40, 24576
    s_and_b32 s55, s55, 0x2000
    s_lshl_b32 s59, s54, 16
    v_mfma_f32_16x16x32_bf16 v[204:207], a[192:195], a[68:71], v[204:207]
    s_or_b32 s55, s55, s59
    ds_read_b64_tr_b16 a[212:213], v11 offset:14336
    s_and_b32 s59, s3, 1
    v_mfma_f32_16x16x32_bf16 v[204:207], a[196:199], a[84:87], v[204:207]
    s_waitcnt vmcnt(31)
    ds_read_b64_tr_b16 a[214:215], v11 offset:20480
    s_lshl_b32 s59, s59, 14
    v_mfma_f32_16x16x32_bf16 v[196:199], a[196:199], a[80:83], v[196:199]
    s_barrier
    v_mfma_f32_16x16x32_bf16 v[196:199], a[192:195], a[64:67], v[196:199]
    s_waitcnt lgkmcnt(4)
    v_add_u32 v11, 122880, v15
    s_or_b32 s55, s55, s59
    v_mfma_f32_16x16x32_bf16 v[224:227], a[200:203], a[64:67], v[224:227]
    s_mul_i32 s59, s51, 0x202000
    ds_read_b64_tr_b16 a[192:193], v8 offset:0
    s_and_b32 s59, s59, 6299648
    v_mfma_f32_16x16x32_bf16 v[224:227], a[204:207], a[80:83], v[224:227]
    s_xor_b32 s55, s55, s59
    ds_read_b64_tr_b16 a[194:195], v8 offset:6144
    v_lshlrev_b32 v2, 7, v1
    v_mfma_f32_16x16x32_bf16 v[232:235], a[204:207], a[84:87], v[232:235]
    v_and_b32 v3, 3, v1
    v_lshlrev_b32 v3, 11, v3
    v_mfma_f32_16x16x32_bf16 v[232:235], a[200:203], a[68:71], v[232:235]
    v_lshlrev_b32 v28, 4, v1
    v_mov_b32 v31, v16
    v_mfma_f32_16x16x32_bf16 v[240:243], a[200:203], a[72:75], v[240:243]
    s_mov_b32 s41, s49
    ds_read_b64_tr_b16 a[196:197], v8 offset:12288
    s_add_u32 s42, s49, 24576
    v_mfma_f32_16x16x32_bf16 v[240:243], a[204:207], a[88:91], v[240:243]
    s_add_u32 s43, s49, 49152
    ds_read_b64_tr_b16 a[198:199], v8 offset:18432
    s_mov_b32 s45, 6
    v_mfma_f32_16x16x32_bf16 v[248:251], a[204:207], a[92:95], v[248:251]
    s_sub_u32 s56, 73728, s49
    v_add_u32 v16, s49, v18
    v_add_u32 v17, s49, v19
    v_mfma_f32_16x16x32_bf16 v[248:251], a[200:203], a[76:79], v[248:251]
    s_waitcnt lgkmcnt(4)
    v_mfma_f32_16x16x32_bf16 v[252:255], a[208:211], a[76:79], v[252:255]
    ds_read_b64_tr_b16 a[200:201], v9 offset:0
    v_mfma_f32_16x16x32_bf16 v[252:255], a[212:215], a[92:95], v[252:255]
    ds_read_b64_tr_b16 a[202:203], v9 offset:6144
    v_mfma_f32_16x16x32_bf16 v[244:247], a[212:215], a[88:91], v[244:247]
    v_mfma_f32_16x16x32_bf16 v[244:247], a[208:211], a[72:75], v[244:247]
    v_mfma_f32_16x16x32_bf16 v[236:239], a[208:211], a[68:71], v[236:239]
    ds_read_b64_tr_b16 a[204:205], v9 offset:12288
    v_mfma_f32_16x16x32_bf16 v[236:239], a[212:215], a[84:87], v[236:239]
    s_waitcnt vmcnt(23)
    s_waitcnt vmcnt(19)
    ds_read_b64_tr_b16 a[206:207], v9 offset:18432
    v_mfma_f32_16x16x32_bf16 v[228:231], a[212:215], a[80:83], v[228:231]
    v_mfma_f32_16x16x32_bf16 v[228:231], a[208:211], a[64:67], v[228:231]
    s_waitcnt lgkmcnt(4)
    v_mfma_f32_16x16x32_bf16 v[64:67], a[192:195], a[224:227], v[64:67]
    ds_read_b64_tr_b16 a[208:209], v10 offset:0
    v_add_u32 v12, s56, v12
    v_mfma_f32_16x16x32_bf16 v[64:67], a[196:199], a[240:243], v[64:67]
    ds_read_b64_tr_b16 a[210:211], v10 offset:6144
    v_add_u32 v13, s56, v13
    v_mfma_f32_16x16x32_bf16 v[72:75], a[196:199], a[244:247], v[72:75]
    v_add_u32 v14, s56, v14
    v_add_u32 v15, s56, v15
    v_mfma_f32_16x16x32_bf16 v[72:75], a[192:195], a[228:231], v[72:75]
    v_mov_b32 v30, 0x47800000
    v_mov_b32 v20, 0
    v_mfma_f32_16x16x32_bf16 v[80:83], a[192:195], a[232:235], v[80:83]
    ds_read_b64_tr_b16 a[212:213], v10 offset:12288
    v_mov_b32 v21, 0
    v_mfma_f32_16x16x32_bf16 v[80:83], a[196:199], a[248:251], v[80:83]
    ds_read_b64_tr_b16 a[214:215], v10 offset:18432
    v_mov_b32 v22, 0
    v_mfma_f32_16x16x32_bf16 v[88:91], a[196:199], a[252:255], v[88:91]
    v_mov_b32 v23, 0
    v_mfma_f32_16x16x32_bf16 v[88:91], a[192:195], a[236:239], v[88:91]
    s_waitcnt lgkmcnt(4)
    v_accvgpr_write_b32 a64, 0
    v_mfma_f32_16x16x32_bf16 v[92:95], a[200:203], a[236:239], v[92:95]
    ds_read_b64_tr_b16 a[192:193], v11 offset:0
    v_accvgpr_write_b32 a65, 0
    v_mfma_f32_16x16x32_bf16 v[92:95], a[204:207], a[252:255], v[92:95]
    ds_read_b64_tr_b16 a[194:195], v11 offset:6144
    v_accvgpr_write_b32 a66, 0
    v_mfma_f32_16x16x32_bf16 v[84:87], a[204:207], a[248:251], v[84:87]
    s_getpc_b64 s[74:75]
ct3:
    s_add_u32 s74, s74, at_switch-ct3
    s_addc_u32 s75, s75, 0
    global_load_dword a222, v2, s[74:75]
    v_mfma_f32_16x16x32_bf16 v[84:87], a[200:203], a[232:235], v[84:87]
    v_min_u32 v2, 15, v1
    v_mfma_f32_16x16x32_bf16 v[76:79], a[200:203], a[228:231], v[76:79]
    s_lshl_b32 s59, s3, 4
    ds_read_b64_tr_b16 a[196:197], v11 offset:12288
    v_add_u32 v2, s59, v2
    v_mfma_f32_16x16x32_bf16 v[76:79], a[204:207], a[244:247], v[76:79]
    ds_read_b64_tr_b16 a[198:199], v11 offset:18432
    v_mul_u32_u24 v2, 1280, v2
    v_mfma_f32_16x16x32_bf16 v[68:71], a[204:207], a[240:243], v[68:71]
    buffer_load_dword a217, v2, s[32:35], s60 offen
    v_mfma_f32_16x16x32_bf16 v[68:71], a[200:203], a[224:227], v[68:71]
    s_waitcnt lgkmcnt(4)
    v_and_b32 v2, 1, v1
    v_lshlrev_b32 v2, 7, v2
    v_mfma_f32_16x16x32_bf16 v[96:99], a[208:211], a[224:227], v[96:99]
    s_lshl_b32 s59, s48, 8
    ds_read_b64_tr_b16 a[200:201], v8 offset:1024
    v_add_u32 v2, s59, v2
    v_mfma_f32_16x16x32_bf16 v[96:99], a[212:215], a[240:243], v[96:99]
    ds_read_b64_tr_b16 a[202:203], v8 offset:7168
    v_accvgpr_write_b32 a67, 0
    v_mfma_f32_16x16x32_bf16 v[104:107], a[212:215], a[244:247], v[104:107]
    v_accvgpr_write_b32 a68, 0
    v_accvgpr_write_b32 a69, 0
    v_mfma_f32_16x16x32_bf16 v[104:107], a[208:211], a[228:231], v[104:107]
    v_accvgpr_write_b32 a70, 0
    v_accvgpr_write_b32 a71, 0
    v_mfma_f32_16x16x32_bf16 v[112:115], a[208:211], a[232:235], v[112:115]
    ds_read_b64_tr_b16 a[204:205], v8 offset:13312
    v_accvgpr_write_b32 a72, 0
    v_mfma_f32_16x16x32_bf16 v[112:115], a[212:215], a[248:251], v[112:115]
    ds_read_b64_tr_b16 a[206:207], v8 offset:19456
    v_accvgpr_write_b32 a73, 0
    v_mfma_f32_16x16x32_bf16 v[120:123], a[212:215], a[252:255], v[120:123]
    s_getpc_b64 s[74:75]
ct4:
    s_add_u32 s74, s74, tail_code-ct4
    s_addc_u32 s75, s75, 0
    global_load_dword a218, v2, s[74:75]
    v_mfma_f32_16x16x32_bf16 v[120:123], a[208:211], a[236:239], v[120:123]
    s_waitcnt lgkmcnt(4)
    v_accvgpr_write_b32 a74, 0
    v_accvgpr_write_b32 a75, 0
    v_mfma_f32_16x16x32_bf16 v[124:127], a[192:195], a[236:239], v[124:127]
    ds_read_b64_tr_b16 a[208:209], v9 offset:1024
    v_accvgpr_write_b32 a76, 0
    v_mfma_f32_16x16x32_bf16 v[124:127], a[196:199], a[252:255], v[124:127]
    ds_read_b64_tr_b16 a[210:211], v9 offset:7168
    v_accvgpr_write_b32 a77, 0
    v_mfma_f32_16x16x32_bf16 v[116:119], a[196:199], a[248:251], v[116:119]
    v_accvgpr_write_b32 a78, 0
    v_accvgpr_write_b32 a79, 0
    v_mfma_f32_16x16x32_bf16 v[116:119], a[192:195], a[232:235], v[116:119]
    v_accvgpr_write_b32 a80, 0
    v_accvgpr_write_b32 a81, 0
    v_mfma_f32_16x16x32_bf16 v[108:111], a[192:195], a[228:231], v[108:111]
    ds_read_b64_tr_b16 a[212:213], v9 offset:13312
    v_accvgpr_write_b32 a82, 0
    v_mfma_f32_16x16x32_bf16 v[108:111], a[196:199], a[244:247], v[108:111]
    ds_read_b64_tr_b16 a[214:215], v9 offset:19456
    v_accvgpr_write_b32 a83, 0
    v_mfma_f32_16x16x32_bf16 v[100:103], a[196:199], a[240:243], v[100:103]
    v_accvgpr_write_b32 a84, 0
    v_accvgpr_write_b32 a85, 0
    v_mfma_f32_16x16x32_bf16 v[100:103], a[192:195], a[224:227], v[100:103]
    s_waitcnt lgkmcnt(4)
    v_accvgpr_write_b32 a86, 0
    v_accvgpr_write_b32 a87, 0
    v_mfma_f32_16x16x32_bf16 v[128:131], a[200:203], a[224:227], v[128:131]
    ds_read_b64_tr_b16 a[192:193], v10 offset:1024
    v_accvgpr_write_b32 a88, 0
    v_mfma_f32_16x16x32_bf16 v[128:131], a[204:207], a[240:243], v[128:131]
    ds_read_b64_tr_b16 a[194:195], v10 offset:7168
    v_accvgpr_write_b32 a89, 0
    v_mfma_f32_16x16x32_bf16 v[136:139], a[204:207], a[244:247], v[136:139]
    v_accvgpr_write_b32 a90, 0
    v_accvgpr_write_b32 a91, 0
    v_mfma_f32_16x16x32_bf16 v[136:139], a[200:203], a[228:231], v[136:139]
    v_accvgpr_write_b32 a92, 0
    v_accvgpr_write_b32 a93, 0
    v_mfma_f32_16x16x32_bf16 v[144:147], a[200:203], a[232:235], v[144:147]
    ds_read_b64_tr_b16 a[196:197], v10 offset:13312
    v_accvgpr_write_b32 a94, 0
    v_mfma_f32_16x16x32_bf16 v[144:147], a[204:207], a[248:251], v[144:147]
    ds_read_b64_tr_b16 a[198:199], v10 offset:19456
    v_accvgpr_write_b32 a95, 0
    v_mfma_f32_16x16x32_bf16 v[152:155], a[204:207], a[252:255], v[152:155]
    v_and_b32 v31, 3, v1
    v_lshlrev_b32 v31, 7, v31
    v_mfma_f32_16x16x32_bf16 v[152:155], a[200:203], a[236:239], v[152:155]
    s_waitcnt lgkmcnt(4)
    v_cvt_pk_bf16_f32 v64, v64, v65
    v_cvt_pk_bf16_f32 v65, v66, v67
    v_mfma_f32_16x16x32_bf16 v[156:159], a[208:211], a[236:239], v[156:159]
    s_lshl_b32 s59, s48, 9
    ds_read_b64_tr_b16 a[200:201], v11 offset:1024
    v_cvt_pk_bf16_f32 v66, v68, v69
    v_mfma_f32_16x16x32_bf16 v[156:159], a[212:215], a[252:255], v[156:159]
    s_and_b32 s59, s59, 0x7fff
    ds_read_b64_tr_b16 a[202:203], v11 offset:7168
    v_add_u32 v31, s59, v31
    v_mfma_f32_16x16x32_bf16 v[148:151], a[212:215], a[248:251], v[148:151]
    v_permlane16_swap_b32 v64, v66
    v_mfma_f32_16x16x32_bf16 v[148:151], a[208:211], a[232:235], v[148:151]
    v_min_u32 v2, 11, v1
    v_lshlrev_b32 v2, 7, v2
    v_mfma_f32_16x16x32_bf16 v[140:143], a[208:211], a[228:231], v[140:143]
    ds_read_b64_tr_b16 a[204:205], v11 offset:13312
    v_cvt_pk_bf16_f32 v67, v70, v71
    v_mfma_f32_16x16x32_bf16 v[140:143], a[212:215], a[244:247], v[140:143]
    ds_read_b64_tr_b16 a[206:207], v11 offset:19456
    v_cvt_pk_bf16_f32 v72, v72, v73
    v_mfma_f32_16x16x32_bf16 v[132:135], a[212:215], a[240:243], v[132:135]
    v_permlane16_swap_b32 v65, v67
    v_mfma_f32_16x16x32_bf16 v[132:135], a[208:211], a[224:227], v[132:135]
    s_waitcnt lgkmcnt(4)
    v_cvt_pk_bf16_f32 v73, v74, v75
    v_cvt_pk_bf16_f32 v74, v76, v77
    v_mfma_f32_16x16x32_bf16 v[160:163], a[192:195], a[224:227], v[160:163]
    ds_read_b64_tr_b16 a[208:209], v8 offset:2048
    v_cvt_pk_bf16_f32 v75, v78, v79
    v_mfma_f32_16x16x32_bf16 v[160:163], a[196:199], a[240:243], v[160:163]
    ds_read_b64_tr_b16 a[210:211], v8 offset:8192
    v_cvt_pk_bf16_f32 v80, v80, v81
    v_mfma_f32_16x16x32_bf16 v[168:171], a[196:199], a[244:247], v[168:171]
    v_permlane16_swap_b32 v72, v74
    v_mfma_f32_16x16x32_bf16 v[168:171], a[192:195], a[228:231], v[168:171]
    v_permlane16_swap_b32 v73, v75
    v_mfma_f32_16x16x32_bf16 v[176:179], a[192:195], a[232:235], v[176:179]
    ds_read_b64_tr_b16 a[212:213], v8 offset:14336
    v_cvt_pk_bf16_f32 v81, v82, v83
    v_mfma_f32_16x16x32_bf16 v[176:179], a[196:199], a[248:251], v[176:179]
    ds_read_b64_tr_b16 a[214:215], v8 offset:20480
    v_cvt_pk_bf16_f32 v82, v84, v85
    v_mfma_f32_16x16x32_bf16 v[184:187], a[196:199], a[252:255], v[184:187]
    v_cvt_pk_bf16_f32 v83, v86, v87
    v_cvt_pk_bf16_f32 v88, v88, v89
    v_mfma_f32_16x16x32_bf16 v[184:187], a[192:195], a[236:239], v[184:187]
    s_waitcnt lgkmcnt(4)
    v_permlane16_swap_b32 v80, v82
    v_mfma_f32_16x16x32_bf16 v[188:191], a[200:203], a[236:239], v[188:191]
    ds_read_b64_tr_b16 a[192:193], v9 offset:2048
    v_cvt_pk_bf16_f32 v89, v90, v91
    v_mfma_f32_16x16x32_bf16 v[188:191], a[204:207], a[252:255], v[188:191]
    ds_read_b64_tr_b16 a[194:195], v9 offset:8192
    v_cvt_pk_bf16_f32 v90, v92, v93
    v_mfma_f32_16x16x32_bf16 v[180:183], a[204:207], a[248:251], v[180:183]
    v_permlane16_swap_b32 v81, v83
    v_mfma_f32_16x16x32_bf16 v[180:183], a[200:203], a[232:235], v[180:183]
    v_permlane16_swap_b32 v88, v90
    v_mfma_f32_16x16x32_bf16 v[172:175], a[200:203], a[228:231], v[172:175]
    ds_read_b64_tr_b16 a[196:197], v9 offset:14336
    v_cvt_pk_bf16_f32 v91, v94, v95
    v_mfma_f32_16x16x32_bf16 v[172:175], a[204:207], a[244:247], v[172:175]
    ds_read_b64_tr_b16 a[198:199], v9 offset:20480
    v_cvt_pk_bf16_f32 v96, v96, v97
    v_mfma_f32_16x16x32_bf16 v[164:167], a[204:207], a[240:243], v[164:167]
    v_permlane16_swap_b32 v89, v91
    v_mfma_f32_16x16x32_bf16 v[164:167], a[200:203], a[224:227], v[164:167]
    s_waitcnt lgkmcnt(4)
    v_cvt_pk_bf16_f32 v97, v98, v99
    v_cvt_pk_bf16_f32 v98, v100, v101
    v_mfma_f32_16x16x32_bf16 v[192:195], a[208:211], a[224:227], v[192:195]
    ds_read_b64_tr_b16 a[200:201], v10 offset:2048
    v_cvt_pk_bf16_f32 v99, v102, v103
    v_mfma_f32_16x16x32_bf16 v[192:195], a[212:215], a[240:243], v[192:195]
    ds_read_b64_tr_b16 a[202:203], v10 offset:8192
    v_cvt_pk_bf16_f32 v104, v104, v105
    v_mfma_f32_16x16x32_bf16 v[200:203], a[212:215], a[244:247], v[200:203]
    v_permlane16_swap_b32 v96, v98
    v_mfma_f32_16x16x32_bf16 v[200:203], a[208:211], a[228:231], v[200:203]
    v_permlane16_swap_b32 v97, v99
    v_mfma_f32_16x16x32_bf16 v[208:211], a[208:211], a[232:235], v[208:211]
    ds_read_b64_tr_b16 a[204:205], v10 offset:14336
    v_cvt_pk_bf16_f32 v105, v106, v107
    v_mfma_f32_16x16x32_bf16 v[208:211], a[212:215], a[248:251], v[208:211]
    ds_read_b64_tr_b16 a[206:207], v10 offset:20480
    v_cvt_pk_bf16_f32 v106, v108, v109
    v_mfma_f32_16x16x32_bf16 v[216:219], a[212:215], a[252:255], v[216:219]
    v_cvt_pk_bf16_f32 v107, v110, v111
    v_cvt_pk_bf16_f32 v112, v112, v113
    v_mfma_f32_16x16x32_bf16 v[216:219], a[208:211], a[236:239], v[216:219]
pg_5:
    s_cbranch_execz pg_9
    s_waitcnt lgkmcnt(4)
    v_permlane16_swap_b32 v104, v106
    v_mfma_f32_16x16x32_bf16 v[220:223], a[192:195], a[236:239], v[220:223]
    ds_read_b64_tr_b16 a[208:209], v11 offset:2048
    v_cvt_pk_bf16_f32 v113, v114, v115
    v_mfma_f32_16x16x32_bf16 v[220:223], a[196:199], a[252:255], v[220:223]
    ds_read_b64_tr_b16 a[210:211], v11 offset:8192
    v_cvt_pk_bf16_f32 v114, v116, v117
    v_mfma_f32_16x16x32_bf16 v[212:215], a[196:199], a[248:251], v[212:215]
    v_permlane16_swap_b32 v105, v107
    v_mfma_f32_16x16x32_bf16 v[212:215], a[192:195], a[232:235], v[212:215]
    v_permlane16_swap_b32 v112, v114
    v_mfma_f32_16x16x32_bf16 v[204:207], a[192:195], a[228:231], v[204:207]
    ds_read_b64_tr_b16 a[212:213], v11 offset:14336
    v_cvt_pk_bf16_f32 v115, v118, v119
    v_mfma_f32_16x16x32_bf16 v[204:207], a[196:199], a[244:247], v[204:207]
    s_waitcnt vmcnt(16)
    ds_read_b64_tr_b16 a[214:215], v11 offset:20480
    v_cvt_pk_bf16_f32 v120, v120, v121
    v_mfma_f32_16x16x32_bf16 v[196:199], a[196:199], a[240:243], v[196:199]
    s_barrier
    v_mfma_f32_16x16x32_bf16 v[196:199], a[192:195], a[224:227], v[196:199]
    s_waitcnt lgkmcnt(4)
    v_permlane16_swap_b32 v113, v115
    v_mfma_f32_16x16x32_bf16 v[224:227], a[200:203], a[224:227], v[224:227]
    s_add_u32 m0, s49, 49152
    ds_read_b128 a[192:195], v16 offset:0
    v_cvt_pk_bf16_f32 v121, v122, v123
    v_mfma_f32_16x16x32_bf16 v[224:227], a[204:207], a[240:243], v[224:227]
    buffer_load_dwordx4 v4, s[12:15], s38 offen offset:0 lds
    v_mfma_f32_16x16x32_bf16 v[232:235], a[204:207], a[244:247], v[232:235]
    v_cvt_pk_bf16_f32 v122, v124, v125
    v_cvt_pk_bf16_f32 v123, v126, v127
    v_mfma_f32_16x16x32_bf16 v[232:235], a[200:203], a[228:231], v[232:235]
    v_permlane16_swap_b32 v120, v122
    v_mfma_f32_16x16x32_bf16 v[240:243], a[200:203], a[232:235], v[240:243]
    ds_read_b128 a[196:199], v17 offset:0
    v_cvt_pk_bf16_f32 v128, v128, v129
    v_mfma_f32_16x16x32_bf16 v[240:243], a[204:207], a[248:251], v[240:243]
    s_add_u32 m0, s49, 50048
    v_permlane16_swap_b32 v121, v123
    v_mfma_f32_16x16x32_bf16 v[248:251], a[204:207], a[252:255], v[248:251]
    buffer_load_dwordx4 v4, s[12:15], s38 offen offset:128 lds
    v_mfma_f32_16x16x32_bf16 v[248:251], a[200:203], a[236:239], v[248:251]
    s_waitcnt lgkmcnt(2)
    v_cvt_pk_bf16_f32 v129, v130, v131
    v_cvt_pk_bf16_f32 v130, v132, v133
    v_mfma_f32_16x16x32_bf16 v[252:255], a[208:211], a[236:239], v[252:255]
    ds_read_b128 a[200:203], v16 offset:1024
    v_cvt_pk_bf16_f32 v131, v134, v135
    v_mfma_f32_16x16x32_bf16 v[252:255], a[212:215], a[252:255], v[252:255]
    v_permlane16_swap_b32 v128, v130
    v_mfma_f32_16x16x32_bf16 v[244:247], a[212:215], a[248:251], v[244:247]
    v_permlane16_swap_b32 v129, v131
    v_mfma_f32_16x16x32_bf16 v[244:247], a[208:211], a[232:235], v[244:247]
    v_cvt_pk_bf16_f32 v136, v136, v137
    v_cvt_pk_bf16_f32 v137, v138, v139
    v_mfma_f32_16x16x32_bf16 v[236:239], a[208:211], a[228:231], v[236:239]
    s_add_u32 m0, s49, 50944
    ds_read_b128 a[204:207], v17 offset:1024
    v_cvt_pk_bf16_f32 v138, v140, v141
    v_mfma_f32_16x16x32_bf16 v[236:239], a[212:215], a[244:247], v[236:239]
    buffer_load_dwordx4 v4, s[12:15], s38 offen offset:256 lds
    v_mfma_f32_16x16x32_bf16 v[228:231], a[212:215], a[240:243], v[228:231]
    v_permlane16_swap_b32 v136, v138
    v_mfma_f32_16x16x32_bf16 v[228:231], a[208:211], a[224:227], v[228:231]
    s_waitcnt lgkmcnt(2)
    v_cvt_pk_bf16_f32 v139, v142, v143
    v_cvt_pk_bf16_f32 v144, v144, v145
    v_mfma_f32_16x16x32_bf16 v[68:71], a[192:195], v[64:67], 0
    ds_read_b128 a[208:211], v16 offset:2048
    v_cvt_pk_bf16_f32 v145, v146, v147
    v_mfma_f32_16x16x32_bf16 v[68:71], a[196:199], v[96:99], v[68:71]
    v_permlane16_swap_b32 v137, v139
    v_mfma_f32_16x16x32_bf16 v[76:79], a[196:199], v[104:107], 0
    s_add_u32 m0, s49, 52224
    v_cvt_pk_bf16_f32 v146, v148, v149
    v_cvt_pk_bf16_f32 v147, v150, v151
    v_mfma_f32_16x16x32_bf16 v[76:79], a[192:195], v[72:75], v[76:79]
    buffer_load_dwordx4 v5, s[12:15], s38 offen offset:0 lds
    v_mfma_f32_16x16x32_bf16 v[84:87], a[192:195], v[80:83], 0
    ds_read_b128 a[212:215], v17 offset:2048
    v_cvt_pk_bf16_f32 v152, v152, v153
    v_mfma_f32_16x16x32_bf16 v[84:87], a[196:199], v[112:115], v[84:87]
    v_permlane16_swap_b32 v144, v146
    v_permlane16_swap_b32 v145, v147
    v_cvt_pk_bf16_f32 v153, v154, v155
    v_cvt_pk_bf16_f32 v154, v156, v157
    v_cvt_pk_bf16_f32 v155, v158, v159
    v_mov_b32 v26, s7
    v_permlane16_swap_b32 v152, v154
    v_permlane16_swap_b32 v153, v155
    v_cvt_pk_bf16_f32 v160, v160, v161
    v_cvt_pk_bf16_f32 v161, v162, v163
    v_cvt_pk_bf16_f32 v162, v164, v165
    v_min_u32 v27, 1, v1
    v_lshlrev_b32 v27, 30, v27
    v_permlane16_swap_b32 v160, v162
    v_cvt_pk_bf16_f32 v163, v166, v167
    s_waitcnt vmcnt(11)
    v_cvt_pk_bf16_f32 v168, v168, v169
    v_permlane16_swap_b32 v161, v163
    v_cvt_pk_bf16_f32 v169, v170, v171
    v_cvt_pk_bf16_f32 v170, v172, v173
    v_cvt_pk_bf16_f32 v171, v174, v175
    v_cvt_pk_bf16_f32 v176, v176, v177
    v_permlane16_swap_b32 v168, v170
    v_permlane16_swap_b32 v169, v171
    v_cvt_pk_bf16_f32 v177, v178, v179
    v_cvt_pk_bf16_f32 v178, v180, v181
    v_cvt_pk_bf16_f32 v179, v182, v183
    v_cvt_pk_bf16_f32 v184, v184, v185
    v_permlane16_swap_b32 v176, v178
    v_permlane16_swap_b32 v177, v179
    v_cvt_pk_bf16_f32 v185, v186, v187
    v_cvt_pk_bf16_f32 v186, v188, v189
    v_cvt_pk_bf16_f32 v187, v190, v191
    v_cvt_pk_bf16_f32 v192, v192, v193
    v_permlane16_swap_b32 v184, v186
    v_permlane16_swap_b32 v185, v187
    v_mfma_f32_16x16x32_bf16 v[92:95], a[196:199], v[120:123], 0
    buffer_store_dword v26, v27, s[24:27], s4 offen offset:144 sc1
    v_mfma_f32_16x16x32_bf16 v[92:95], a[192:195], v[88:91], v[92:95]
    s_waitcnt lgkmcnt(2)
    v_cvt_pk_bf16_f32 v193, v194, v195
    v_cvt_pk_bf16_f32 v194, v196, v197
    v_mfma_f32_16x16x32_bf16 v[92:95], a[200:203], v[152:155], v[92:95]
    ds_read_b128 a[192:195], v16 offset:6144
    v_cvt_pk_bf16_f32 v195, v198, v199
    v_mfma_f32_16x16x32_bf16 v[92:95], a[204:207], v[184:187], v[92:95]
    s_add_u32 m0, s49, 53120
    v_permlane16_swap_b32 v192, v194
    v_mfma_f32_16x16x32_bf16 v[84:87], a[204:207], v[176:179], v[84:87]
    buffer_load_dwordx4 v5, s[12:15], s38 offen offset:128 lds
    v_mfma_f32_16x16x32_bf16 v[84:87], a[200:203], v[144:147], v[84:87]
    v_permlane16_swap_b32 v193, v195
    v_mfma_f32_16x16x32_bf16 v[76:79], a[200:203], v[136:139], v[76:79]
    ds_read_b128 a[196:199], v17 offset:6144
    v_cvt_pk_bf16_f32 v200, v200, v201
    v_mfma_f32_16x16x32_bf16 v[76:79], a[204:207], v[168:171], v[76:79]
    v_cvt_pk_bf16_f32 v201, v202, v203
    v_cvt_pk_bf16_f32 v202, v204, v205
    v_cvt_pk_bf16_f32 v203, v206, v207
    v_cvt_pk_bf16_f32 v208, v208, v209
    v_permlane16_swap_b32 v200, v202
    v_permlane16_swap_b32 v201, v203
    v_cvt_pk_bf16_f32 v209, v210, v211
    v_cvt_pk_bf16_f32 v210, v212, v213
    v_cvt_pk_bf16_f32 v211, v214, v215
    v_cvt_pk_bf16_f32 v216, v216, v217
    v_permlane16_swap_b32 v208, v210
    v_permlane16_swap_b32 v209, v211
    v_cvt_pk_bf16_f32 v217, v218, v219
    v_cvt_pk_bf16_f32 v218, v220, v221
    v_cvt_pk_bf16_f32 v219, v222, v223
    v_cvt_pk_bf16_f32 v224, v224, v225
    v_permlane16_swap_b32 v216, v218
    v_permlane16_swap_b32 v217, v219
    v_cvt_pk_bf16_f32 v225, v226, v227
    v_cvt_pk_bf16_f32 v226, v228, v229
    v_cvt_pk_bf16_f32 v227, v230, v231
    v_cvt_pk_bf16_f32 v232, v232, v233
    v_permlane16_swap_b32 v224, v226
    v_permlane16_swap_b32 v225, v227
    v_cvt_pk_bf16_f32 v233, v234, v235
    v_cvt_pk_bf16_f32 v234, v236, v237
    v_cvt_pk_bf16_f32 v235, v238, v239
    v_cvt_pk_bf16_f32 v240, v240, v241
    v_permlane16_swap_b32 v232, v234
    v_permlane16_swap_b32 v233, v235
    v_cvt_pk_bf16_f32 v241, v242, v243
    v_cvt_pk_bf16_f32 v242, v244, v245
    v_cvt_pk_bf16_f32 v243, v246, v247
    v_cvt_pk_bf16_f32 v248, v248, v249
    v_permlane16_swap_b32 v240, v242
    v_permlane16_swap_b32 v241, v243
    v_cvt_pk_bf16_f32 v249, v250, v251
    v_cvt_pk_bf16_f32 v250, v252, v253
    v_cvt_pk_bf16_f32 v251, v254, v255
    s_nop 0
    v_permlane16_swap_b32 v248, v250
    v_permlane16_swap_b32 v249, v251
    v_mfma_f32_16x16x32_bf16 v[68:71], a[204:207], v[160:163], v[68:71]
    v_mfma_f32_16x16x32_bf16 v[68:71], a[200:203], v[128:131], v[68:71]
    s_waitcnt lgkmcnt(2)
    s_add_u32 m0, s49, 54016
    v_mfma_f32_16x16x32_bf16 v[68:71], a[208:211], v[192:195], v[68:71]
    ds_read_b128 a[200:203], v16 offset:7168
    v_mfma_f32_16x16x32_bf16 v[68:71], a[212:215], v[224:227], v[68:71]
    buffer_load_dwordx4 v5, s[12:15], s38 offen offset:256 lds
    v_mfma_f32_16x16x32_bf16 v[76:79], a[212:215], v[232:235], v[76:79]
    s_add_u32 s38, s38, 24576
    v_mfma_f32_16x16x32_bf16 v[76:79], a[208:211], v[200:203], v[76:79]
    v_mfma_f32_16x16x32_bf16 v[84:87], a[208:211], v[208:211], v[84:87]
    ds_read_b128 a[204:207], v17 offset:7168
    v_mfma_f32_16x16x32_bf16 v[84:87], a[212:215], v[240:243], v[84:87]
    v_mfma_f32_16x16x32_bf16 v[92:95], a[212:215], v[248:251], v[92:95]
    v_mfma_f32_16x16x32_bf16 v[92:95], a[208:211], v[216:219], v[92:95]
    s_waitcnt lgkmcnt(2)
    v_mfma_f32_16x16x32_bf16 v[124:127], a[192:195], v[88:91], 0
    ds_read_b128 a[208:211], v16 offset:8192
    v_mfma_f32_16x16x32_bf16 v[124:127], a[196:199], v[120:123], v[124:127]
    v_mfma_f32_16x16x32_bf16 v[116:119], a[196:199], v[112:115], 0
    v_mfma_f32_16x16x32_bf16 v[116:119], a[192:195], v[80:83], v[116:119]
    v_mfma_f32_16x16x32_bf16 v[108:111], a[192:195], v[72:75], 0
    ds_read_b128 a[212:215], v17 offset:8192
    v_mfma_f32_16x16x32_bf16 v[108:111], a[196:199], v[104:107], v[108:111]
    s_add_u32 m0, s49, 98304
    v_max3_f32 v56, v68, v69, v70
    v_max_f32 v56, v56, v71
    v_mfma_f32_16x16x32_bf16 v[100:103], a[196:199], v[96:99], 0
    buffer_load_dwordx4 v6, s[16:19], s40 offen offset:0 lds
    v_mfma_f32_16x16x32_bf16 v[100:103], a[192:195], v[64:67], v[100:103]
    s_waitcnt lgkmcnt(2)
    v_mov_b32 v48, v56
    v_max3_f32 v57, v76, v77, v78
    v_mfma_f32_16x16x32_bf16 v[100:103], a[200:203], v[128:131], v[100:103]
    ds_read_b128 a[192:195], v16 offset:12288
    v_max_f32 v57, v57, v79
    v_mfma_f32_16x16x32_bf16 v[100:103], a[204:207], v[160:163], v[100:103]
    v_permlane16_swap_b32 v56, v48
    v_mfma_f32_16x16x32_bf16 v[108:111], a[204:207], v[168:171], v[108:111]
    v_max_f32 v56, v56, v48
    v_mov_b32 v48, v56
    v_mfma_f32_16x16x32_bf16 v[108:111], a[200:203], v[136:139], v[108:111]
    s_add_u32 m0, s49, 99200
    v_permlane32_swap_b32 v56, v48
    v_mfma_f32_16x16x32_bf16 v[116:119], a[200:203], v[144:147], v[116:119]
    ds_read_b128 a[196:199], v17 offset:12288
    v_max_f32 v56, v56, v48
    v_mfma_f32_16x16x32_bf16 v[116:119], a[204:207], v[176:179], v[116:119]
    buffer_load_dwordx4 v6, s[16:19], s40 offen offset:128 lds
    v_mfma_f32_16x16x32_bf16 v[124:127], a[204:207], v[184:187], v[124:127]
    v_sub_f32 v32, 0, v56
    v_sub_f32 v33, 0, v56
    v_mfma_f32_16x16x32_bf16 v[124:127], a[200:203], v[152:155], v[124:127]
    s_waitcnt lgkmcnt(2)
    v_sub_f32 v34, 0, v56
    v_sub_f32 v35, 0, v56
    v_mfma_f32_16x16x32_bf16 v[124:127], a[208:211], v[216:219], v[124:127]
    ds_read_b128 a[200:203], v16 offset:13312
    v_mov_b32 v49, v57
    v_mfma_f32_16x16x32_bf16 v[124:127], a[212:215], v[248:251], v[124:127]
    v_max3_f32 v58, v84, v85, v86
    v_max_f32 v58, v58, v87
    v_mfma_f32_16x16x32_bf16 v[116:119], a[212:215], v[240:243], v[116:119]
    s_add_u32 m0, s49, 100096
    v_permlane16_swap_b32 v57, v49
    v_mfma_f32_16x16x32_bf16 v[116:119], a[208:211], v[208:211], v[116:119]
    buffer_load_dwordx4 v6, s[16:19], s40 offen offset:256 lds
    v_mfma_f32_16x16x32_bf16 v[108:111], a[208:211], v[200:203], v[108:111]
    ds_read_b128 a[204:207], v17 offset:13312
    v_max_f32 v57, v57, v49
    v_mfma_f32_16x16x32_bf16 v[108:111], a[212:215], v[232:235], v[108:111]
    v_mov_b32 v49, v57
    v_mov_b32 v50, v58
    v_max3_f32 v59, v92, v93, v94
    v_permlane32_swap_b32 v57, v49
    v_permlane16_swap_b32 v58, v50
    v_max_f32 v57, v57, v49
    v_sub_f32 v36, 0, v57
    v_sub_f32 v37, 0, v57
    v_sub_f32 v38, 0, v57
    v_sub_f32 v39, 0, v57
    v_max_f32 v58, v58, v50
    v_mov_b32 v50, v58
    v_max_f32 v59, v59, v95
    v_mov_b32 v51, v59
    v_permlane32_swap_b32 v58, v50
    s_nop 0
    v_max_f32 v58, v58, v50
    v_sub_f32 v40, 0, v58
    v_sub_f32 v41, 0, v58
    v_sub_f32 v42, 0, v58
    v_sub_f32 v43, 0, v58
    v_permlane16_swap_b32 v59, v51
    s_nop 0
    v_max_f32 v59, v59, v51
    v_mov_b32 v51, v59
    s_nop 0
    s_nop 0
    v_permlane32_swap_b32 v59, v51
    s_nop 0
    v_max_f32 v59, v59, v51
    v_sub_f32 v44, 0, v59
    v_sub_f32 v45, 0, v59
    v_sub_f32 v46, 0, v59
    v_sub_f32 v47, 0, v59
    v_mfma_f32_16x16x32_bf16 v[100:103], a[212:215], v[224:227], v[100:103]
    v_sub_f32 v68, v68, v56
    v_sub_f32 v69, v69, v56
    v_mfma_f32_16x16x32_bf16 v[100:103], a[208:211], v[192:195], v[100:103]
    s_waitcnt lgkmcnt(2)
    v_exp_f32 v48, v68
    v_mfma_f32_16x16x32_bf16 v[132:135], a[192:195], v[64:67], v[32:35]
    s_add_u32 m0, s49, 101376
    ds_read_b128 a[208:211], v16 offset:14336
    v_sub_f32 v70, v70, v56
    v_mfma_f32_16x16x32_bf16 v[132:135], a[196:199], v[96:99], v[132:135]
    buffer_load_dwordx4 v7, s[16:19], s40 offen offset:0 lds
    v_mfma_f32_16x16x32_bf16 v[140:143], a[196:199], v[104:107], v[36:39]
    v_exp_f32 v49, v69
    v_mfma_f32_16x16x32_bf16 v[140:143], a[192:195], v[72:75], v[140:143]
    v_exp_f32 v50, v70
    v_mfma_f32_16x16x32_bf16 v[148:151], a[192:195], v[80:83], v[40:43]
    ds_read_b128 a[212:215], v17 offset:14336
    v_sub_f32 v71, v71, v56
    v_mfma_f32_16x16x32_bf16 v[148:151], a[196:199], v[112:115], v[148:151]
    v_exp_f32 v51, v71
    v_mfma_f32_16x16x32_bf16 v[156:159], a[196:199], v[120:123], v[44:47]
    v_sub_f32 v100, v100, v56
    v_cvt_pk_bf16_f32 v196, v48, v49
    v_mfma_f32_16x16x32_bf16 v[156:159], a[192:195], v[88:91], v[156:159]
    s_waitcnt lgkmcnt(2)
    v_exp_f32 v52, v100
    v_mfma_f32_16x16x32_bf16 v[156:159], a[200:203], v[152:155], v[156:159]
    s_add_u32 m0, s49, 102272
    ds_read_b128 a[192:195], v16 offset:18432
    v_add_f32 v24, v48, v49
    v_mfma_f32_16x16x32_bf16 v[156:159], a[204:207], v[184:187], v[156:159]
    buffer_load_dwordx4 v7, s[16:19], s40 offen offset:128 lds
    v_mfma_f32_16x16x32_bf16 v[148:151], a[204:207], v[176:179], v[148:151]
    v_sub_f32 v101, v101, v56
    v_sub_f32 v102, v102, v56
    v_mfma_f32_16x16x32_bf16 v[148:151], a[200:203], v[144:147], v[148:151]
    v_exp_f32 v53, v101
    v_mfma_f32_16x16x32_bf16 v[140:143], a[200:203], v[136:139], v[140:143]
    ds_read_b128 a[196:199], v17 offset:18432
    v_add_f32 v24, v24, v50
    v_mfma_f32_16x16x32_bf16 v[140:143], a[204:207], v[168:171], v[140:143]
    s_add_u32 m0, s49, 103168
    v_exp_f32 v54, v102
    v_mfma_f32_16x16x32_bf16 v[132:135], a[204:207], v[160:163], v[132:135]
    buffer_load_dwordx4 v7, s[16:19], s40 offen offset:256 lds
    v_mfma_f32_16x16x32_bf16 v[132:135], a[200:203], v[128:131], v[132:135]
    s_waitcnt lgkmcnt(2)
    v_sub_f32 v103, v103, v56
    v_cvt_pk_bf16_f32 v197, v50, v51
    v_mfma_f32_16x16x32_bf16 v[132:135], a[208:211], v[192:195], v[132:135]
    s_add_u32 s40, s40, 24576
    ds_read_b128 a[200:203], v16 offset:19456
    v_add_f32 v24, v24, v51
    v_mfma_f32_16x16x32_bf16 v[132:135], a[212:215], v[224:227], v[132:135]
    v_exp_f32 v55, v103
    v_mfma_f32_16x16x32_bf16 v[140:143], a[212:215], v[232:235], v[140:143]
    v_sub_f32 v76, v76, v57
    v_sub_f32 v77, v77, v57
    v_mfma_f32_16x16x32_bf16 v[140:143], a[208:211], v[200:203], v[140:143]
    v_exp_f32 v48, v76
    v_mfma_f32_16x16x32_bf16 v[148:151], a[208:211], v[208:211], v[148:151]
    ds_read_b128 a[204:207], v17 offset:19456
    v_add_f32 v24, v24, v52
    v_mfma_f32_16x16x32_bf16 v[148:151], a[212:215], v[240:243], v[148:151]
    v_exp_f32 v49, v77
    v_mfma_f32_16x16x32_bf16 v[156:159], a[212:215], v[248:251], v[156:159]
    v_sub_f32 v78, v78, v57
    v_cvt_pk_bf16_f32 v198, v52, v53
    v_mfma_f32_16x16x32_bf16 v[156:159], a[208:211], v[216:219], v[156:159]
    s_waitcnt lgkmcnt(2)
    v_exp_f32 v50, v78
    v_mfma_f32_16x16x32_bf16 v[188:191], a[192:195], v[88:91], v[44:47]
    ds_read_b128 a[208:211], v16 offset:20480
    v_add_f32 v24, v24, v53
    v_mfma_f32_16x16x32_bf16 v[188:191], a[196:199], v[120:123], v[188:191]
    v_sub_f32 v79, v79, v57
    v_sub_f32 v108, v108, v57
    v_mfma_f32_16x16x32_bf16 v[180:183], a[196:199], v[112:115], v[40:43]
    v_exp_f32 v51, v79
    v_mfma_f32_16x16x32_bf16 v[180:183], a[192:195], v[80:83], v[180:183]
    v_add_f32 v24, v24, v54
    v_sub_f32 v109, v109, v57
    v_mfma_f32_16x16x32_bf16 v[172:175], a[192:195], v[72:75], v[36:39]
    ds_read_b128 a[212:215], v17 offset:20480
    v_cvt_pk_bf16_f32 v199, v54, v55
    v_mfma_f32_16x16x32_bf16 v[172:175], a[196:199], v[104:107], v[172:175]
    s_waitcnt vmcnt(16)
    v_exp_f32 v52, v108
    v_mfma_f32_16x16x32_bf16 v[164:167], a[196:199], v[96:99], v[32:35]
    s_barrier
    v_mfma_f32_16x16x32_bf16 v[164:167], a[192:195], v[64:67], v[164:167]
    s_waitcnt lgkmcnt(2)
    v_add_f32 v24, v24, v55
    v_sub_f32 v110, v110, v57
    v_add_u32 v16, s42, v18
    v_mfma_f32_16x16x32_bf16 v[164:167], a[200:203], v[128:131], v[164:167]
    ds_read_b128 a[224:227], v16 offset:0
    v_sub_f32 v111, v111, v57
    v_mfma_f32_16x16x32_bf16 v[164:167], a[204:207], v[160:163], v[164:167]
    v_exp_f32 v53, v109
    v_add_u32 v17, s42, v19
    v_mfma_f32_16x16x32_bf16 v[172:175], a[204:207], v[168:171], v[172:175]
    ds_read_b128 a[228:231], v17 offset:0
    v_sub_f32 v84, v84, v58
    v_mfma_f32_16x16x32_bf16 v[172:175], a[200:203], v[136:139], v[172:175]
    v_exp_f32 v54, v110
    v_mfma_f32_16x16x32_bf16 v[180:183], a[200:203], v[144:147], v[180:183]
    ds_read_b128 a[232:235], v16 offset:1024
    v_cvt_pk_bf16_f32 v204, v48, v49
    v_mfma_f32_16x16x32_bf16 v[180:183], a[204:207], v[176:179], v[180:183]
    v_exp_f32 v55, v111
    v_mfma_f32_16x16x32_bf16 v[188:191], a[204:207], v[184:187], v[188:191]
    ds_read_b128 a[236:239], v17 offset:1024
    v_add_f32 v25, v48, v49
    v_mfma_f32_16x16x32_bf16 v[188:191], a[200:203], v[152:155], v[188:191]
    s_waitcnt lgkmcnt(4)
    v_sub_f32 v85, v85, v58
    v_sub_f32 v86, v86, v58
    v_mfma_f32_16x16x32_bf16 v[188:191], a[208:211], v[216:219], v[188:191]
    ds_read_b128 a[240:243], v16 offset:2048
    v_add_f32 v25, v25, v50
    v_mfma_f32_16x16x32_bf16 v[188:191], a[212:215], v[248:251], v[188:191]
    v_exp_f32 v48, v84
    v_mfma_f32_16x16x32_bf16 v[180:183], a[212:215], v[240:243], v[180:183]
    ds_read_b128 a[244:247], v17 offset:2048
    v_sub_f32 v87, v87, v58
    v_mfma_f32_16x16x32_bf16 v[180:183], a[208:211], v[208:211], v[180:183]
    v_cvt_pk_bf16_f32 v205, v50, v51
    v_add_f32 v25, v25, v51
    v_mfma_f32_16x16x32_bf16 v[172:175], a[208:211], v[200:203], v[172:175]
    v_sub_f32 v116, v116, v58
    v_sub_f32 v117, v117, v58
    v_mfma_f32_16x16x32_bf16 v[172:175], a[212:215], v[232:235], v[172:175]
    v_exp_f32 v49, v85
    v_mfma_f32_16x16x32_bf16 v[164:167], a[212:215], v[224:227], v[164:167]
    v_exp_f32 v50, v86
    v_mfma_f32_16x16x32_bf16 v[164:167], a[208:211], v[192:195], v[164:167]
    v_add_f32 v25, v25, v52
    v_cvt_pk_bf16_f32 v206, v52, v53
    v_cvt_pk_bf16_f32 v207, v54, v55
    v_add_f32 v25, v25, v53
    v_add_f32 v25, v25, v54
    v_add_f32 v25, v25, v55
    v_cvt_pk_bf16_f32 v212, v48, v49
    v_exp_f32 v51, v87
    v_sub_f32 v118, v118, v58
    v_cvt_pk_bf16_f32 v213, v50, v51
    v_exp_f32 v52, v116
    v_exp_f32 v53, v117
    v_sub_f32 v119, v119, v58
    v_cvt_pk_bf16_f32 v214, v52, v53
    v_exp_f32 v54, v118
    v_exp_f32 v55, v119
    v_sub_f32 v92, v92, v59
    v_cvt_pk_bf16_f32 v215, v54, v55
    v_add_f32 v26, v48, v49
    v_add_f32 v26, v26, v50
    v_add_f32 v26, v26, v51
    v_add_f32 v26, v26, v52
    v_add_f32 v26, v26, v53
    v_add_f32 v26, v26, v54
    v_add_f32 v26, v26, v55
    v_max3_f32 v29, v24, v25, v26
    v_exp_f32 v48, v92
    v_sub_f32 v93, v93, v59
    v_exp_f32 v49, v93
    v_sub_f32 v94, v94, v59
    v_cvt_pk_bf16_f32 v220, v48, v49
    v_exp_f32 v50, v94
    v_sub_f32 v95, v95, v59
    v_exp_f32 v51, v95
    v_sub_f32 v124, v124, v59
    v_cvt_pk_bf16_f32 v221, v50, v51
    v_exp_f32 v52, v124
    v_sub_f32 v125, v125, v59
    v_exp_f32 v53, v125
    v_sub_f32 v126, v126, v59
    v_cvt_pk_bf16_f32 v222, v52, v53
    v_exp_f32 v54, v126
    v_sub_f32 v127, v127, v59
    v_exp_f32 v55, v127
    v_add_f32 v27, v48, v49
    v_cvt_pk_bf16_f32 v223, v54, v55
    v_add_f32 v27, v27, v50
    v_add_f32 v27, v27, v51
    v_add_f32 v27, v27, v52
    v_add_f32 v27, v27, v53
    v_add_f32 v27, v27, v54
    v_add_f32 v27, v27, v55
    v_max_f32 v29, v29, v27
    v_cmp_nle_f32 vcc, v29, v30
    s_cbranch_vccnz rare_p
rare_p_ret:
    s_waitcnt lgkmcnt(0)
    s_mov_b64 s[88:89], s[12:13]
    s_mov_b32 s57, s38
    v_mov_b32 v58, v4
    v_mov_b32 v59, v5
at_switch:
    s_cmp_eq_u32 s45, 0
    s_cbranch_scc1 at_sw2
    s_mov_b32 s76, s63
    s_mov_b32 s12, s8
    s_mov_b32 s13, s9
    s_mov_b32 s14, s10
    s_mov_b32 s38, s36
    s_mov_b32 s39, 81920
    v_mov_b32 v4, v62
    v_mov_b32 v5, v63
    v_lshrrev_b32 v60, 2, v1
    v_min_u32 v60, 9, v60
    v_mul_u32_u24 v60, 6144, v60
    v_lshrrev_b32 v57, 9, v3
    v_add_u32 v60, v60, v57
    v_and_b32 v57, 15, v1
    v_lshl_add_u32 v57, s3, 4, v57
    v_mul_u32_u24 v57, 1280, v57
    s_getpc_b64 s[74:75]
ct1:
    s_add_u32 s74, s74, tail_code-ct1
    s_addc_u32 s75, s75, 0
    s_cmp_eq_u32 s45, 1
    s_cbranch_scc0 at_dry
    global_load_dword a219, v31, s[74:75]
    buffer_load_dword a217, v57, s[32:35], s60 offen
    buffer_load_dword v61, v60, s[24:27], s37 offen sc1
    s_branch at_switch_ret
at_sw2:
    s_mov_b32 s16, s8
    s_mov_b32 s17, s9
    s_mov_b32 s18, s10
    s_add_u32 s40, s38, s39
    s_mov_b32 s66, s63
    v_mov_b32 v6, v62
    v_mov_b32 v7, v63
    s_branch at_switch_ret
at_dry:
    s_mov_b32 s76, 0
    s_mov_b64 s[12:13], s[88:89]
    s_mov_b32 s14, 196608
    s_mov_b32 s38, s57
    s_mov_b32 s39, 24576
    v_mov_b32 v4, v58
    v_mov_b32 v5, v59
    .p2align 6
at_loop:
    v_mfma_f32_16x16x32_bf16 v[68:71], a[224:227], v[64:67], v[32:35]
    ds_read_b128 a[192:195], v16 offset:6144
    v_add_f32 v20, v20, v24
    v_mfma_f32_16x16x32_bf16 v[68:71], a[228:231], v[96:99], v[68:71]
    s_cmp_le_u32 s45, 1
    s_cbranch_scc1 at_switch
at_switch_ret:
    v_add_f32 v21, v21, v25
    v_mfma_f32_16x16x32_bf16 v[68:71], a[232:235], v[128:131], v[68:71]
    s_add_u32 s77, s38, s76
    v_add_f32 v22, v22, v26
    v_add_f32 v23, v23, v27
    v_mfma_f32_16x16x32_bf16 v[68:71], a[236:239], v[160:163], v[68:71]
    ds_read_b128 a[196:199], v17 offset:6144
    v_add_u32 v8, s41, v12
    v_mfma_f32_16x16x32_bf16 v[68:71], a[240:243], v[192:195], v[68:71]
    v_exp_f32 v48, v132
    v_mfma_f32_16x16x32_bf16 v[68:71], a[244:247], v[224:227], v[68:71]
    s_add_u32 m0, s41, 0
    v_exp_f32 v49, v133
    v_mfma_f32_16x16x32_bf16 v[76:79], a[244:247], v[232:235], v[36:39]
    ds_read_b128 a[200:203], v16 offset:7168
    v_cvt_pk_bf16_f32 v228, v48, v49
    v_mfma_f32_16x16x32_bf16 v[76:79], a[240:243], v[200:203], v[76:79]
    buffer_load_dwordx4 v4, s[12:15], s38 offen offset:0 lds
    v_mfma_f32_16x16x32_bf16 v[76:79], a[236:239], v[168:171], v[76:79]
    v_exp_f32 v50, v134
    v_mfma_f32_16x16x32_bf16 v[76:79], a[232:235], v[136:139], v[76:79]
    ds_read_b128 a[204:207], v17 offset:7168
    v_add_f32 v24, v48, v49
    v_mfma_f32_16x16x32_bf16 v[76:79], a[228:231], v[104:107], v[76:79]
    v_exp_f32 v51, v135
    v_mfma_f32_16x16x32_bf16 v[76:79], a[224:227], v[72:75], v[76:79]
    v_exp_f32 v52, v164
    v_mfma_f32_16x16x32_bf16 v[84:87], a[224:227], v[80:83], v[40:43]
    ds_read_b128 a[208:211], v16 offset:8192
    v_add_u32 v9, s41, v13
    v_mfma_f32_16x16x32_bf16 v[84:87], a[228:231], v[112:115], v[84:87]
    v_exp_f32 v53, v165
    v_mfma_f32_16x16x32_bf16 v[84:87], a[232:235], v[144:147], v[84:87]
    v_exp_f32 v54, v166
    v_mfma_f32_16x16x32_bf16 v[84:87], a[236:239], v[176:179], v[84:87]
    ds_read_b128 a[212:215], v17 offset:8192
    v_add_f32 v24, v24, v50
    v_mfma_f32_16x16x32_bf16 v[84:87], a[240:243], v[208:211], v[84:87]
    v_exp_f32 v55, v167
    v_mfma_f32_16x16x32_bf16 v[84:87], a[244:247], v[240:243], v[84:87]
    s_add_u32 m0, s41, 896
    v_add_u32 v10, s41, v14
    v_cvt_pk_bf16_f32 v229, v50, v51
    v_mfma_f32_16x16x32_bf16 v[92:95], a[244:247], v[248:251], v[44:47]
    buffer_load_dwordx4 v4, s[12:15], s38 offen offset:128 lds
    v_mfma_f32_16x16x32_bf16 v[92:95], a[240:243], v[216:219], v[92:95]
    v_add_f32 v24, v24, v51
    v_add_u32 v11, s41, v15
    v_mfma_f32_16x16x32_bf16 v[92:95], a[236:239], v[184:187], v[92:95]
    v_exp_f32 v48, v140
    v_mfma_f32_16x16x32_bf16 v[92:95], a[232:235], v[152:155], v[92:95]
    v_add_f32 v24, v24, v52
    v_cvt_pk_bf16_f32 v230, v52, v53
    v_mfma_f32_16x16x32_bf16 v[92:95], a[228:231], v[120:123], v[92:95]
    v_exp_f32 v49, v141
    v_mfma_f32_16x16x32_bf16 v[92:95], a[224:227], v[88:91], v[92:95]
    s_waitcnt lgkmcnt(0)
    v_add_f32 v24, v24, v53
    v_add_f32 v24, v24, v54
    v_mfma_f32_16x16x32_bf16 v[124:127], a[192:195], v[88:91], v[44:47]
    ds_read_b64_tr_b16 a[224:225], v8 offset:0
    v_cvt_pk_bf16_f32 v231, v54, v55
    v_mfma_f32_16x16x32_bf16 v[124:127], a[196:199], v[120:123], v[124:127]
    ds_read_b64_tr_b16 a[226:227], v8 offset:6144
    v_add_f32 v24, v24, v55
    v_mfma_f32_16x16x32_bf16 v[124:127], a[200:203], v[152:155], v[124:127]
    v_exp_f32 v50, v142
    v_mfma_f32_16x16x32_bf16 v[124:127], a[204:207], v[184:187], v[124:127]
    ds_read_b64_tr_b16 a[228:229], v9 offset:0
    v_cvt_pk_bf16_f32 v236, v48, v49
    v_mfma_f32_16x16x32_bf16 v[124:127], a[208:211], v[216:219], v[124:127]
    ds_read_b64_tr_b16 a[230:231], v9 offset:6144
    v_add_f32 v25, v48, v49
    v_mfma_f32_16x16x32_bf16 v[124:127], a[212:215], v[248:251], v[124:127]
    v_exp_f32 v51, v143
    v_mfma_f32_16x16x32_bf16 v[116:119], a[212:215], v[240:243], v[40:43]
    ds_read_b64_tr_b16 a[232:233], v10 offset:0
    v_add_f32 v25, v25, v50
    v_mfma_f32_16x16x32_bf16 v[116:119], a[208:211], v[208:211], v[116:119]
    s_add_u32 m0, s41, 1792
    ds_read_b64_tr_b16 a[234:235], v10 offset:6144
    v_cvt_pk_bf16_f32 v237, v50, v51
    v_mfma_f32_16x16x32_bf16 v[116:119], a[204:207], v[176:179], v[116:119]
    buffer_load_dwordx4 v4, s[12:15], s77 offen offset:256 lds
    v_mfma_f32_16x16x32_bf16 v[116:119], a[200:203], v[144:147], v[116:119]
    ds_read_b64_tr_b16 a[236:237], v11 offset:0
    v_add_f32 v25, v25, v51
    v_mfma_f32_16x16x32_bf16 v[116:119], a[196:199], v[112:115], v[116:119]
    ds_read_b64_tr_b16 a[238:239], v11 offset:6144
    v_mfma_f32_16x16x32_bf16 v[116:119], a[192:195], v[80:83], v[116:119]
    v_exp_f32 v52, v172
    v_mfma_f32_16x16x32_bf16 v[108:111], a[192:195], v[72:75], v[36:39]
    ds_read_b64_tr_b16 a[240:241], v8 offset:1024
    v_add_f32 v25, v25, v52
    v_mfma_f32_16x16x32_bf16 v[108:111], a[196:199], v[104:107], v[108:111]
    ds_read_b64_tr_b16 a[242:243], v8 offset:7168
    v_mfma_f32_16x16x32_bf16 v[108:111], a[200:203], v[136:139], v[108:111]
    v_exp_f32 v53, v173
    v_mfma_f32_16x16x32_bf16 v[108:111], a[204:207], v[168:171], v[108:111]
    ds_read_b64_tr_b16 a[244:245], v9 offset:1024
    v_cvt_pk_bf16_f32 v238, v52, v53
    v_mfma_f32_16x16x32_bf16 v[108:111], a[208:211], v[200:203], v[108:111]
    ds_read_b64_tr_b16 a[246:247], v9 offset:7168
    v_add_f32 v25, v25, v53
    v_mfma_f32_16x16x32_bf16 v[108:111], a[212:215], v[232:235], v[108:111]
    v_exp_f32 v54, v174
    v_mfma_f32_16x16x32_bf16 v[100:103], a[212:215], v[224:227], v[32:35]
    v_exp_f32 v55, v175
    v_mfma_f32_16x16x32_bf16 v[100:103], a[208:211], v[192:195], v[100:103]
    v_exp_f32 v48, v148
    v_mfma_f32_16x16x32_bf16 v[100:103], a[204:207], v[160:163], v[100:103]
    v_exp_f32 v49, v149
    v_mfma_f32_16x16x32_bf16 v[100:103], a[200:203], v[128:131], v[100:103]
    s_add_u32 m0, s41, 3072
    v_exp_f32 v50, v150
    v_mfma_f32_16x16x32_bf16 v[100:103], a[196:199], v[96:99], v[100:103]
    buffer_load_dwordx4 v5, s[12:15], s38 offen offset:0 lds
    v_mfma_f32_16x16x32_bf16 v[100:103], a[192:195], v[64:67], v[100:103]
    s_waitcnt lgkmcnt(0)
    v_add_f32 v25, v25, v54
    v_cvt_pk_bf16_f32 v239, v54, v55
    v_mfma_f32_16x16x32_bf16 a[0:3], a[224:227], v[196:199], a[0:3]
    ds_read_b64_tr_b16 a[192:193], v10 offset:1024
    v_add_f32 v25, v25, v55
    v_mfma_f32_16x16x32_bf16 a[16:19], a[228:231], v[196:199], a[16:19]
    ds_read_b64_tr_b16 a[194:195], v10 offset:7168
    v_cvt_pk_bf16_f32 v244, v48, v49
    v_mfma_f32_16x16x32_bf16 a[32:35], a[232:235], v[196:199], a[32:35]
pg_6:
    s_cbranch_execz pg_10
    v_exp_f32 v51, v151
    v_mfma_f32_16x16x32_bf16 a[48:51], a[236:239], v[196:199], a[48:51]
    ds_read_b64_tr_b16 a[196:197], v11 offset:1024
    v_add_f32 v26, v48, v49
    v_mfma_f32_16x16x32_bf16 a[64:67], a[240:243], v[196:199], a[64:67]
    ds_read_b64_tr_b16 a[198:199], v11 offset:7168
    v_add_f32 v26, v26, v50
    v_mfma_f32_16x16x32_bf16 a[80:83], a[244:247], v[196:199], a[80:83]
    v_exp_f32 v52, v180
    v_mfma_f32_16x16x32_bf16 a[84:87], a[244:247], v[204:207], a[84:87]
    ds_read_b64_tr_b16 a[200:201], v8 offset:2048
    v_cvt_pk_bf16_f32 v245, v50, v51
    v_mfma_f32_16x16x32_bf16 a[68:71], a[240:243], v[204:207], a[68:71]
    ds_read_b64_tr_b16 a[202:203], v8 offset:8192
    v_add_f32 v26, v26, v51
    v_mfma_f32_16x16x32_bf16 a[52:55], a[236:239], v[204:207], a[52:55]
    v_exp_f32 v53, v181
    v_mfma_f32_16x16x32_bf16 a[36:39], a[232:235], v[204:207], a[36:39]
    ds_read_b64_tr_b16 a[204:205], v9 offset:2048
    v_add_f32 v26, v26, v52
    v_mfma_f32_16x16x32_bf16 a[20:23], a[228:231], v[204:207], a[20:23]
    ds_read_b64_tr_b16 a[206:207], v9 offset:8192
    v_cvt_pk_bf16_f32 v246, v52, v53
    v_mfma_f32_16x16x32_bf16 a[4:7], a[224:227], v[204:207], a[4:7]
    s_add_u32 m0, s41, 3968
    v_exp_f32 v54, v182
    v_mfma_f32_16x16x32_bf16 a[8:11], a[224:227], v[212:215], a[8:11]
    ds_read_b64_tr_b16 a[208:209], v10 offset:2048
    v_add_f32 v26, v26, v53
    v_mfma_f32_16x16x32_bf16 a[24:27], a[228:231], v[212:215], a[24:27]
    ds_read_b64_tr_b16 a[210:211], v10 offset:8192
    v_add_f32 v26, v26, v54
    v_mfma_f32_16x16x32_bf16 a[40:43], a[232:235], v[212:215], a[40:43]
    buffer_load_dwordx4 v5, s[12:15], s38 offen offset:128 lds
    v_mfma_f32_16x16x32_bf16 a[56:59], a[236:239], v[212:215], a[56:59]
    ds_read_b64_tr_b16 a[212:213], v11 offset:2048
    v_mfma_f32_16x16x32_bf16 a[72:75], a[240:243], v[212:215], a[72:75]
    ds_read_b64_tr_b16 a[214:215], v11 offset:8192
    v_mfma_f32_16x16x32_bf16 a[88:91], a[244:247], v[212:215], a[88:91]
    v_exp_f32 v55, v183
    v_mfma_f32_16x16x32_bf16 a[92:95], a[244:247], v[220:223], a[92:95]
    v_exp_f32 v48, v156
    v_mfma_f32_16x16x32_bf16 a[76:79], a[240:243], v[220:223], a[76:79]
    v_exp_f32 v49, v157
    v_mfma_f32_16x16x32_bf16 a[60:63], a[236:239], v[220:223], a[60:63]
    v_exp_f32 v50, v158
    v_mfma_f32_16x16x32_bf16 a[44:47], a[232:235], v[220:223], a[44:47]
    v_exp_f32 v51, v159
    v_mfma_f32_16x16x32_bf16 a[28:31], a[228:231], v[220:223], a[28:31]
    v_cvt_pk_bf16_f32 v247, v54, v55
    v_add_f32 v26, v26, v55
    v_mfma_f32_16x16x32_bf16 a[12:15], a[224:227], v[220:223], a[12:15]
    s_waitcnt lgkmcnt(0)
    v_exp_f32 v52, v188
    v_mfma_f32_16x16x32_bf16 a[108:111], a[192:195], v[220:223], a[108:111]
    ds_read_b128 a[224:227], v16 offset:12288
    v_cvt_pk_bf16_f32 v252, v48, v49
    v_mfma_f32_16x16x32_bf16 a[124:127], a[196:199], v[220:223], a[124:127]
    s_add_u32 m0, s41, 4864
    v_exp_f32 v53, v189
    v_mfma_f32_16x16x32_bf16 a[140:143], a[200:203], v[220:223], a[140:143]
    buffer_load_dwordx4 v5, s[12:15], s77 offen offset:256 lds
    v_mfma_f32_16x16x32_bf16 a[156:159], a[204:207], v[220:223], a[156:159]
    ds_read_b128 a[228:231], v17 offset:12288
    v_add_f32 v27, v48, v49
    v_mfma_f32_16x16x32_bf16 a[172:175], a[208:211], v[220:223], a[172:175]
    s_add_u32 s38, s38, s39
    v_exp_f32 v54, v190
    v_mfma_f32_16x16x32_bf16 a[188:191], a[212:215], v[220:223], a[188:191]
    s_add_u32 s77, s40, s66
    v_add_f32 v27, v27, v50
    v_cvt_pk_bf16_f32 v253, v50, v51
    v_mfma_f32_16x16x32_bf16 a[184:187], a[212:215], v[212:215], a[184:187]
    ds_read_b128 a[232:235], v16 offset:13312
    v_add_f32 v27, v27, v51
    v_mfma_f32_16x16x32_bf16 a[168:171], a[208:211], v[212:215], a[168:171]
    v_exp_f32 v55, v191
    v_mfma_f32_16x16x32_bf16 a[152:155], a[204:207], v[212:215], a[152:155]
    v_add_f32 v27, v27, v52
    v_mfma_f32_16x16x32_bf16 a[136:139], a[200:203], v[212:215], a[136:139]
    ds_read_b128 a[236:239], v17 offset:13312
    v_cvt_pk_bf16_f32 v254, v52, v53
    v_mfma_f32_16x16x32_bf16 a[120:123], a[196:199], v[212:215], a[120:123]
    v_add_f32 v27, v27, v53
    v_mfma_f32_16x16x32_bf16 a[104:107], a[192:195], v[212:215], a[104:107]
    v_add_f32 v27, v27, v54
    v_mfma_f32_16x16x32_bf16 a[100:103], a[192:195], v[204:207], a[100:103]
    ds_read_b128 a[240:243], v16 offset:14336
    v_cvt_pk_bf16_f32 v255, v54, v55
    v_mfma_f32_16x16x32_bf16 a[116:119], a[196:199], v[204:207], a[116:119]
    v_add_f32 v27, v27, v55
    v_mfma_f32_16x16x32_bf16 a[132:135], a[200:203], v[204:207], a[132:135]
    v_max3_f32 v29, v24, v25, v26
    v_mfma_f32_16x16x32_bf16 a[148:151], a[204:207], v[204:207], a[148:151]
    s_add_u32 m0, s43, 73728
    ds_read_b128 a[244:247], v17 offset:14336
    v_max_f32 v29, v29, v27
    v_mfma_f32_16x16x32_bf16 a[164:167], a[208:211], v[204:207], a[164:167]
    buffer_load_dwordx4 v6, s[16:19], s40 offen offset:0 lds
    v_mfma_f32_16x16x32_bf16 a[180:183], a[212:215], v[204:207], a[180:183]
    v_cmp_nle_f32 vcc, v29, v30
    v_mfma_f32_16x16x32_bf16 a[176:179], a[212:215], v[196:199], a[176:179]
    v_mfma_f32_16x16x32_bf16 a[160:163], a[208:211], v[196:199], a[160:163]
    v_mfma_f32_16x16x32_bf16 a[144:147], a[204:207], v[196:199], a[144:147]
    v_mfma_f32_16x16x32_bf16 a[128:131], a[200:203], v[196:199], a[128:131]
    v_mfma_f32_16x16x32_bf16 a[112:115], a[196:199], v[196:199], a[112:115]
    v_mfma_f32_16x16x32_bf16 a[96:99], a[192:195], v[196:199], a[96:99]
    s_waitcnt lgkmcnt(0)
    s_cbranch_vccnz rare_a
rare_a_ret:
    v_mfma_f32_16x16x32_bf16 v[132:135], a[224:227], v[64:67], v[32:35]
    ds_read_b128 a[192:195], v16 offset:18432
    v_add_f32 v20, v20, v24
    v_mfma_f32_16x16x32_bf16 v[132:135], a[228:231], v[96:99], v[132:135]
    v_add_f32 v21, v21, v25
    v_add_f32 v22, v22, v26
    v_mfma_f32_16x16x32_bf16 v[132:135], a[232:235], v[128:131], v[132:135]
    v_add_f32 v23, v23, v27
    v_mfma_f32_16x16x32_bf16 v[132:135], a[236:239], v[160:163], v[132:135]
    ds_read_b128 a[196:199], v17 offset:18432
    v_mfma_f32_16x16x32_bf16 v[132:135], a[240:243], v[192:195], v[132:135]
    v_exp_f32 v48, v68
    v_mfma_f32_16x16x32_bf16 v[132:135], a[244:247], v[224:227], v[132:135]
    s_add_u32 m0, s43, 74624
    v_exp_f32 v49, v69
    v_mfma_f32_16x16x32_bf16 v[140:143], a[244:247], v[232:235], v[36:39]
    ds_read_b128 a[200:203], v16 offset:19456
    v_cvt_pk_bf16_f32 v196, v48, v49
    v_mfma_f32_16x16x32_bf16 v[140:143], a[240:243], v[200:203], v[140:143]
    buffer_load_dwordx4 v6, s[16:19], s40 offen offset:128 lds
    v_mfma_f32_16x16x32_bf16 v[140:143], a[236:239], v[168:171], v[140:143]
    v_exp_f32 v50, v70
    v_mfma_f32_16x16x32_bf16 v[140:143], a[232:235], v[136:139], v[140:143]
    ds_read_b128 a[204:207], v17 offset:19456
    v_add_f32 v24, v48, v49
    v_mfma_f32_16x16x32_bf16 v[140:143], a[228:231], v[104:107], v[140:143]
    v_exp_f32 v51, v71
    v_mfma_f32_16x16x32_bf16 v[140:143], a[224:227], v[72:75], v[140:143]
    v_exp_f32 v52, v100
    v_mfma_f32_16x16x32_bf16 v[148:151], a[224:227], v[80:83], v[40:43]
    ds_read_b128 a[208:211], v16 offset:20480
    v_add_f32 v24, v24, v50
    v_mfma_f32_16x16x32_bf16 v[148:151], a[228:231], v[112:115], v[148:151]
    v_exp_f32 v53, v101
    v_mfma_f32_16x16x32_bf16 v[148:151], a[232:235], v[144:147], v[148:151]
    v_exp_f32 v54, v102
    v_mfma_f32_16x16x32_bf16 v[148:151], a[236:239], v[176:179], v[148:151]
    ds_read_b128 a[212:215], v17 offset:20480
    v_cvt_pk_bf16_f32 v197, v50, v51
    v_mfma_f32_16x16x32_bf16 v[148:151], a[240:243], v[208:211], v[148:151]
    v_exp_f32 v55, v103
    v_mfma_f32_16x16x32_bf16 v[148:151], a[244:247], v[240:243], v[148:151]
    v_add_f32 v24, v24, v51
    v_add_f32 v24, v24, v52
    v_mfma_f32_16x16x32_bf16 v[156:159], a[244:247], v[248:251], v[44:47]
    v_exp_f32 v48, v76
    v_mfma_f32_16x16x32_bf16 v[156:159], a[240:243], v[216:219], v[156:159]
    s_add_u32 m0, s43, 75520
    v_exp_f32 v49, v77
    v_mfma_f32_16x16x32_bf16 v[156:159], a[236:239], v[184:187], v[156:159]
    buffer_load_dwordx4 v6, s[16:19], s77 offen offset:256 lds
    v_mfma_f32_16x16x32_bf16 v[156:159], a[232:235], v[152:155], v[156:159]
    v_cvt_pk_bf16_f32 v198, v52, v53
    v_add_f32 v24, v24, v53
    v_mfma_f32_16x16x32_bf16 v[156:159], a[228:231], v[120:123], v[156:159]
    v_exp_f32 v50, v78
    v_mfma_f32_16x16x32_bf16 v[156:159], a[224:227], v[88:91], v[156:159]
    s_waitcnt lgkmcnt(0)
    v_add_f32 v24, v24, v54
    v_cvt_pk_bf16_f32 v199, v54, v55
    v_mfma_f32_16x16x32_bf16 v[188:191], a[192:195], v[88:91], v[44:47]
    ds_read_b64_tr_b16 a[224:225], v8 offset:12288
    v_add_f32 v24, v24, v55
    v_mfma_f32_16x16x32_bf16 v[188:191], a[196:199], v[120:123], v[188:191]
    ds_read_b64_tr_b16 a[226:227], v8 offset:18432
    v_cvt_pk_bf16_f32 v204, v48, v49
    v_mfma_f32_16x16x32_bf16 v[188:191], a[200:203], v[152:155], v[188:191]
    v_exp_f32 v51, v79
    v_mfma_f32_16x16x32_bf16 v[188:191], a[204:207], v[184:187], v[188:191]
    ds_read_b64_tr_b16 a[228:229], v9 offset:12288
    v_add_f32 v25, v48, v49
    v_mfma_f32_16x16x32_bf16 v[188:191], a[208:211], v[216:219], v[188:191]
    ds_read_b64_tr_b16 a[230:231], v9 offset:18432
    v_add_f32 v25, v25, v50
    v_mfma_f32_16x16x32_bf16 v[188:191], a[212:215], v[248:251], v[188:191]
    v_exp_f32 v52, v108
    v_mfma_f32_16x16x32_bf16 v[180:183], a[212:215], v[240:243], v[40:43]
    ds_read_b64_tr_b16 a[232:233], v10 offset:12288
    v_cvt_pk_bf16_f32 v205, v50, v51
    v_mfma_f32_16x16x32_bf16 v[180:183], a[208:211], v[208:211], v[180:183]
    ds_read_b64_tr_b16 a[234:235], v10 offset:18432
    v_add_f32 v25, v25, v51
    v_mfma_f32_16x16x32_bf16 v[180:183], a[204:207], v[176:179], v[180:183]
    v_exp_f32 v53, v109
    v_mfma_f32_16x16x32_bf16 v[180:183], a[200:203], v[144:147], v[180:183]
    s_add_u32 m0, s43, 76800
    ds_read_b64_tr_b16 a[236:237], v11 offset:12288
    v_add_f32 v25, v25, v52
    v_mfma_f32_16x16x32_bf16 v[180:183], a[196:199], v[112:115], v[180:183]
    ds_read_b64_tr_b16 a[238:239], v11 offset:18432
    v_cvt_pk_bf16_f32 v206, v52, v53
    v_mfma_f32_16x16x32_bf16 v[180:183], a[192:195], v[80:83], v[180:183]
    buffer_load_dwordx4 v7, s[16:19], s40 offen offset:0 lds
    v_mfma_f32_16x16x32_bf16 v[172:175], a[192:195], v[72:75], v[36:39]
    ds_read_b64_tr_b16 a[240:241], v8 offset:13312
    v_add_f32 v25, v25, v53
    v_mfma_f32_16x16x32_bf16 v[172:175], a[196:199], v[104:107], v[172:175]
    ds_read_b64_tr_b16 a[242:243], v8 offset:19456
    v_add_u32 v16, s43, v18
    v_mfma_f32_16x16x32_bf16 v[172:175], a[200:203], v[136:139], v[172:175]
    v_exp_f32 v54, v110
    v_mfma_f32_16x16x32_bf16 v[172:175], a[204:207], v[168:171], v[172:175]
    ds_read_b64_tr_b16 a[244:245], v9 offset:13312
    v_add_f32 v25, v25, v54
    v_mfma_f32_16x16x32_bf16 v[172:175], a[208:211], v[200:203], v[172:175]
    ds_read_b64_tr_b16 a[246:247], v9 offset:19456
    v_add_u32 v17, s43, v19
    v_mfma_f32_16x16x32_bf16 v[172:175], a[212:215], v[232:235], v[172:175]
    v_exp_f32 v55, v111
    v_mfma_f32_16x16x32_bf16 v[164:167], a[212:215], v[224:227], v[32:35]
    v_exp_f32 v48, v84
    v_mfma_f32_16x16x32_bf16 v[164:167], a[208:211], v[192:195], v[164:167]
    v_exp_f32 v49, v85
    v_mfma_f32_16x16x32_bf16 v[164:167], a[204:207], v[160:163], v[164:167]
    v_exp_f32 v50, v86
    v_mfma_f32_16x16x32_bf16 v[164:167], a[200:203], v[128:131], v[164:167]
    v_exp_f32 v51, v87
    v_mfma_f32_16x16x32_bf16 v[164:167], a[196:199], v[96:99], v[164:167]
    v_cvt_pk_bf16_f32 v207, v54, v55
    v_add_f32 v25, v25, v55
    v_mfma_f32_16x16x32_bf16 v[164:167], a[192:195], v[64:67], v[164:167]
    s_waitcnt lgkmcnt(0)
    v_exp_f32 v52, v116
    v_mfma_f32_16x16x32_bf16 a[0:3], a[224:227], v[228:231], a[0:3]
    s_add_u32 m0, s43, 77696
    ds_read_b64_tr_b16 a[192:193], v10 offset:13312
    v_cvt_pk_bf16_f32 v212, v48, v49
    v_mfma_f32_16x16x32_bf16 a[16:19], a[228:231], v[228:231], a[16:19]
    ds_read_b64_tr_b16 a[194:195], v10 offset:19456
    v_add_f32 v26, v48, v49
    v_mfma_f32_16x16x32_bf16 a[32:35], a[232:235], v[228:231], a[32:35]
    buffer_load_dwordx4 v7, s[16:19], s40 offen offset:128 lds
    v_mfma_f32_16x16x32_bf16 a[48:51], a[236:239], v[228:231], a[48:51]
    ds_read_b64_tr_b16 a[196:197], v11 offset:13312
    v_add_f32 v26, v26, v50
    v_mfma_f32_16x16x32_bf16 a[64:67], a[240:243], v[228:231], a[64:67]
    ds_read_b64_tr_b16 a[198:199], v11 offset:19456
    v_cvt_pk_bf16_f32 v213, v50, v51
    v_mfma_f32_16x16x32_bf16 a[80:83], a[244:247], v[228:231], a[80:83]
    v_exp_f32 v53, v117
    v_mfma_f32_16x16x32_bf16 a[84:87], a[244:247], v[236:239], a[84:87]
    ds_read_b64_tr_b16 a[200:201], v8 offset:14336
    v_add_f32 v26, v26, v51
    v_mfma_f32_16x16x32_bf16 a[68:71], a[240:243], v[236:239], a[68:71]
    ds_read_b64_tr_b16 a[202:203], v8 offset:20480
    v_add_f32 v26, v26, v52
    v_mfma_f32_16x16x32_bf16 a[52:55], a[236:239], v[236:239], a[52:55]
    v_exp_f32 v54, v118
    v_mfma_f32_16x16x32_bf16 a[36:39], a[232:235], v[236:239], a[36:39]
    ds_read_b64_tr_b16 a[204:205], v9 offset:14336
    v_cvt_pk_bf16_f32 v214, v52, v53
    v_mfma_f32_16x16x32_bf16 a[20:23], a[228:231], v[236:239], a[20:23]
    ds_read_b64_tr_b16 a[206:207], v9 offset:20480
    v_add_f32 v26, v26, v53
    v_mfma_f32_16x16x32_bf16 a[4:7], a[224:227], v[236:239], a[4:7]
    v_exp_f32 v55, v119
    v_mfma_f32_16x16x32_bf16 a[8:11], a[224:227], v[244:247], a[8:11]
    ds_read_b64_tr_b16 a[208:209], v10 offset:14336
    v_add_f32 v26, v26, v54
    v_mfma_f32_16x16x32_bf16 a[24:27], a[228:231], v[244:247], a[24:27]
    s_add_u32 m0, s43, 78592
    ds_read_b64_tr_b16 a[210:211], v10 offset:20480
    v_cvt_pk_bf16_f32 v215, v54, v55
    v_mfma_f32_16x16x32_bf16 a[40:43], a[232:235], v[244:247], a[40:43]
    buffer_load_dwordx4 v7, s[16:19], s77 offen offset:256 lds
    v_mfma_f32_16x16x32_bf16 a[56:59], a[236:239], v[244:247], a[56:59]
    ds_read_b64_tr_b16 a[212:213], v11 offset:14336
    v_add_f32 v26, v26, v55
    v_mfma_f32_16x16x32_bf16 a[72:75], a[240:243], v[244:247], a[72:75]
    s_add_u32 s40, s40, 24576
    ds_read_b64_tr_b16 a[214:215], v11 offset:20480
    v_max3_f32 v29, v24, v25, v26
    v_mfma_f32_16x16x32_bf16 a[88:91], a[244:247], v[244:247], a[88:91]
    v_exp_f32 v48, v92
    v_mfma_f32_16x16x32_bf16 a[92:95], a[244:247], v[252:255], a[92:95]
    v_exp_f32 v49, v93
    v_mfma_f32_16x16x32_bf16 a[76:79], a[240:243], v[252:255], a[76:79]
    v_exp_f32 v50, v94
    v_mfma_f32_16x16x32_bf16 a[60:63], a[236:239], v[252:255], a[60:63]
    v_exp_f32 v51, v95
    v_mfma_f32_16x16x32_bf16 a[44:47], a[232:235], v[252:255], a[44:47]
    s_waitcnt vmcnt(12)
    v_exp_f32 v52, v124
    v_mfma_f32_16x16x32_bf16 a[28:31], a[228:231], v[252:255], a[28:31]
    s_barrier
    v_mfma_f32_16x16x32_bf16 a[12:15], a[224:227], v[252:255], a[12:15]
    s_waitcnt lgkmcnt(0)
    v_exp_f32 v53, v125
    v_mfma_f32_16x16x32_bf16 a[108:111], a[192:195], v[252:255], a[108:111]
    ds_read_b128 a[224:227], v16 offset:0
    v_cvt_pk_bf16_f32 v220, v48, v49
    v_mfma_f32_16x16x32_bf16 a[124:127], a[196:199], v[252:255], a[124:127]
    v_add_f32 v27, v48, v49
    v_mfma_f32_16x16x32_bf16 a[140:143], a[200:203], v[252:255], a[140:143]
    v_exp_f32 v54, v126
    v_mfma_f32_16x16x32_bf16 a[156:159], a[204:207], v[252:255], a[156:159]
    ds_read_b128 a[228:231], v17 offset:0
    v_add_f32 v27, v27, v50
    v_mfma_f32_16x16x32_bf16 a[172:175], a[208:211], v[252:255], a[172:175]
    v_exp_f32 v55, v127
    v_mfma_f32_16x16x32_bf16 a[188:191], a[212:215], v[252:255], a[188:191]
    v_cvt_pk_bf16_f32 v221, v50, v51
    v_add_f32 v27, v27, v51
    v_mfma_f32_16x16x32_bf16 a[184:187], a[212:215], v[244:247], a[184:187]
    ds_read_b128 a[232:235], v16 offset:1024
    v_add_f32 v27, v27, v52
    v_mfma_f32_16x16x32_bf16 a[168:171], a[208:211], v[244:247], a[168:171]
    v_cvt_pk_bf16_f32 v222, v52, v53
    v_mfma_f32_16x16x32_bf16 a[152:155], a[204:207], v[244:247], a[152:155]
    v_add_f32 v27, v27, v53
    v_mfma_f32_16x16x32_bf16 a[136:139], a[200:203], v[244:247], a[136:139]
    ds_read_b128 a[236:239], v17 offset:1024
    v_add_f32 v27, v27, v54
    v_mfma_f32_16x16x32_bf16 a[120:123], a[196:199], v[244:247], a[120:123]
    buffer_load_dword a216, v2, s[28:31], s6 offen
    v_mfma_f32_16x16x32_bf16 a[104:107], a[192:195], v[244:247], a[104:107]
    s_add_u32 s6, s6, 1536
    v_cvt_pk_bf16_f32 v223, v54, v55
    v_mfma_f32_16x16x32_bf16 a[100:103], a[192:195], v[236:239], a[100:103]
    s_mov_b32 s44, s41
    ds_read_b128 a[240:243], v16 offset:2048
    v_add_f32 v27, v27, v55
    v_mfma_f32_16x16x32_bf16 a[116:119], a[196:199], v[236:239], a[116:119]
    s_mov_b32 s41, s42
    v_max_f32 v29, v29, v27
    v_mfma_f32_16x16x32_bf16 a[132:135], a[200:203], v[236:239], a[132:135]
    s_mov_b32 s42, s43
    v_cmp_nle_f32 vcc, v29, v30
    s_mov_b32 s43, s44
    v_mfma_f32_16x16x32_bf16 a[148:151], a[204:207], v[236:239], a[148:151]
    s_sub_u32 s45, s45, 1
    ds_read_b128 a[244:247], v17 offset:2048
    v_mfma_f32_16x16x32_bf16 a[164:167], a[208:211], v[236:239], a[164:167]
    v_mfma_f32_16x16x32_bf16 a[180:183], a[212:215], v[236:239], a[180:183]
    v_mfma_f32_16x16x32_bf16 a[176:179], a[212:215], v[228:231], a[176:179]
    v_mfma_f32_16x16x32_bf16 a[160:163], a[208:211], v[228:231], a[160:163]
    v_mfma_f32_16x16x32_bf16 a[144:147], a[204:207], v[228:231], a[144:147]
    v_mfma_f32_16x16x32_bf16 a[128:131], a[200:203], v[228:231], a[128:131]
    v_mfma_f32_16x16x32_bf16 a[112:115], a[196:199], v[228:231], a[112:115]
    s_waitcnt lgkmcnt(0)
    v_mfma_f32_16x16x32_bf16 a[96:99], a[192:195], v[228:231], a[96:99]
    s_cbranch_vccnz rare_b
rare_b_ret:
    s_cbranch_scc0 at_loop
tail_code:
    v_add_u32 v8, s41, v12
    v_add_u32 v9, s41, v13
    v_add_u32 v10, s41, v14
    v_add_u32 v11, s41, v15
    s_waitcnt lgkmcnt(0)
    ds_read_b64_tr_b16 a[192:193], v8 offset:0
    ds_read_b64_tr_b16 a[194:195], v8 offset:6144
    ds_read_b64_tr_b16 a[196:197], v9 offset:0
    ds_read_b64_tr_b16 a[198:199], v9 offset:6144
    ds_read_b64_tr_b16 a[200:201], v10 offset:0
    ds_read_b64_tr_b16 a[202:203], v10 offset:6144
    ds_read_b64_tr_b16 a[204:205], v11 offset:0
    ds_read_b64_tr_b16 a[206:207], v11 offset:6144
    s_waitcnt lgkmcnt(4)
    v_mfma_f32_16x16x32_bf16 a[0:3], a[192:195], v[196:199], a[0:3]
    s_waitcnt vmcnt(26)
    ds_read_b64_tr_b16 a[208:209], v8 offset:1024
    v_cmp_ne_u32 vcc, s7, v61
    v_mfma_f32_16x16x32_bf16 a[16:19], a[196:199], v[196:199], a[16:19]
    s_and_b32 s59, s51, 1
    ds_read_b64_tr_b16 a[210:211], v8 offset:7168
    v_add_f32 v20, v20, v24
    v_mfma_f32_16x16x32_bf16 a[20:23], a[196:199], v[204:207], a[20:23]
    s_cbranch_vccnz spin_gu
spin_gu_ret:
    v_add_f32 v21, v21, v25
    v_mfma_f32_16x16x32_bf16 a[4:7], a[192:195], v[204:207], a[4:7]
    s_lshl_b32 s61, s47, 10
    v_add_f32 v22, v22, v26
    v_add_f32 v23, v23, v27
    v_mfma_f32_16x16x32_bf16 a[8:11], a[192:195], v[212:215], a[8:11]
    s_add_u32 s61, s61, 3276800
    ds_read_b64_tr_b16 a[212:213], v9 offset:1024
    s_add_u32 s56, s3, 0
    v_mfma_f32_16x16x32_bf16 a[24:27], a[196:199], v[212:215], a[24:27]
    s_min_u32 s56, s56, 9
    ds_read_b64_tr_b16 a[214:215], v9 offset:7168
    s_mul_i32 s57, s56, 24576
    v_mfma_f32_16x16x32_bf16 a[28:31], a[196:199], v[220:223], a[28:31]
    s_add_u32 s57, s57, s61
    v_exp_f32 v48, v132
    v_mfma_f32_16x16x32_bf16 a[12:15], a[192:195], v[220:223], a[12:15]
    s_waitcnt lgkmcnt(4)
    v_exp_f32 v49, v133
    v_mfma_f32_16x16x32_bf16 a[44:47], a[200:203], v[220:223], a[44:47]
    s_lshl_b32 s56, s56, 10
    ds_read_b64_tr_b16 a[192:193], v10 offset:1024
    v_cvt_pk_bf16_f32 v228, v48, v49
    v_mfma_f32_16x16x32_bf16 a[60:63], a[204:207], v[220:223], a[60:63]
    s_add_u32 m0, s56, 147456
    ds_read_b64_tr_b16 a[194:195], v10 offset:7168
    v_add_f32 v24, v48, v49
    v_mfma_f32_16x16x32_bf16 a[56:59], a[204:207], v[212:215], a[56:59]
    buffer_load_dwordx4 v28, s[24:27], s57 offen sc1 lds
    v_mfma_f32_16x16x32_bf16 a[40:43], a[200:203], v[212:215], a[40:43]
    s_add_u32 s56, s3, 4
    v_exp_f32 v50, v134
    v_mfma_f32_16x16x32_bf16 a[36:39], a[200:203], v[204:207], a[36:39]
    s_min_u32 s56, s56, 9
    ds_read_b64_tr_b16 a[196:197], v11 offset:1024
    v_add_f32 v24, v24, v50
    v_mfma_f32_16x16x32_bf16 a[52:55], a[204:207], v[204:207], a[52:55]
    s_mul_i32 s57, s56, 24576
    ds_read_b64_tr_b16 a[198:199], v11 offset:7168
    s_add_u32 s57, s57, s61
    v_mfma_f32_16x16x32_bf16 a[48:51], a[204:207], v[196:199], a[48:51]
    s_lshl_b32 s56, s56, 10
    v_exp_f32 v51, v135
    v_mfma_f32_16x16x32_bf16 a[32:35], a[200:203], v[196:199], a[32:35]
    s_waitcnt lgkmcnt(4)
    v_exp_f32 v52, v164
    v_mfma_f32_16x16x32_bf16 a[64:67], a[208:211], v[196:199], a[64:67]
    s_add_u32 m0, s56, 147456
    ds_read_b64_tr_b16 a[200:201], v8 offset:2048
    v_cvt_pk_bf16_f32 v229, v50, v51
    v_mfma_f32_16x16x32_bf16 a[80:83], a[212:215], v[196:199], a[80:83]
    s_lshl_b32 s59, s59, 6
    ds_read_b64_tr_b16 a[202:203], v8 offset:8192
    v_add_f32 v24, v24, v51
    v_mfma_f32_16x16x32_bf16 a[84:87], a[212:215], v[204:207], a[84:87]
    buffer_load_dwordx4 v28, s[24:27], s57 offen sc1 lds
    v_mfma_f32_16x16x32_bf16 a[68:71], a[208:211], v[204:207], a[68:71]
    s_add_u32 s56, s3, 8
    v_exp_f32 v53, v165
    v_mfma_f32_16x16x32_bf16 a[72:75], a[208:211], v[212:215], a[72:75]
    s_min_u32 s56, s56, 9
    ds_read_b64_tr_b16 a[204:205], v9 offset:2048
    v_add_f32 v24, v24, v52
    v_mfma_f32_16x16x32_bf16 a[88:91], a[212:215], v[212:215], a[88:91]
    s_mul_i32 s57, s56, 24576
    ds_read_b64_tr_b16 a[206:207], v9 offset:8192
    v_cvt_pk_bf16_f32 v230, v52, v53
    v_mfma_f32_16x16x32_bf16 a[92:95], a[212:215], v[220:223], a[92:95]
    s_add_u32 s57, s57, s61
    v_exp_f32 v54, v166
    v_mfma_f32_16x16x32_bf16 a[76:79], a[208:211], v[220:223], a[76:79]
    s_waitcnt lgkmcnt(4)
    v_exp_f32 v55, v167
    v_mfma_f32_16x16x32_bf16 a[108:111], a[192:195], v[220:223], a[108:111]
    s_lshl_b32 s56, s56, 10
    ds_read_b64_tr_b16 a[208:209], v10 offset:2048
    v_add_f32 v24, v24, v53
    v_mfma_f32_16x16x32_bf16 a[124:127], a[196:199], v[220:223], a[124:127]
    s_add_u32 m0, s56, 147456
    ds_read_b64_tr_b16 a[210:211], v10 offset:8192
    v_add_f32 v24, v24, v54
    v_mfma_f32_16x16x32_bf16 a[120:123], a[196:199], v[212:215], a[120:123]
    buffer_load_dwordx4 v28, s[24:27], s57 offen sc1 lds
    v_mfma_f32_16x16x32_bf16 a[104:107], a[192:195], v[212:215], a[104:107]
    s_sub_u32 s44, s49, 73728
    v_add_u32 v12, s44, v12
    v_add_u32 v13, s44, v13
    v_mfma_f32_16x16x32_bf16 a[100:103], a[192:195], v[204:207], a[100:103]
    ds_read_b64_tr_b16 a[212:213], v11 offset:2048
    v_add_u32 v14, s44, v14
    v_mfma_f32_16x16x32_bf16 a[116:119], a[196:199], v[204:207], a[116:119]
    ds_read_b64_tr_b16 a[214:215], v11 offset:8192
    v_add_u32 v15, s44, v15
    v_mfma_f32_16x16x32_bf16 a[112:115], a[196:199], v[196:199], a[112:115]
    s_mov_b32 s39, s59
    v_exp_f32 v48, v140
    v_mfma_f32_16x16x32_bf16 a[96:99], a[192:195], v[196:199], a[96:99]
    s_waitcnt lgkmcnt(4)
    v_exp_f32 v49, v141
    v_mfma_f32_16x16x32_bf16 a[128:131], a[200:203], v[196:199], a[128:131]
    s_and_b32 s59, s3, 1
    ds_read_b64_tr_b16 a[192:193], v8 offset:12288
    v_cvt_pk_bf16_f32 v231, v54, v55
    v_mfma_f32_16x16x32_bf16 a[144:147], a[204:207], v[196:199], a[144:147]
    s_mul_i32 s59, s59, 20480
    ds_read_b64_tr_b16 a[194:195], v8 offset:18432
    v_add_f32 v24, v24, v55
    v_mfma_f32_16x16x32_bf16 a[148:151], a[204:207], v[204:207], a[148:151]
    s_lshl_b32 s36, s3, 10
    v_exp_f32 v50, v142
    v_mfma_f32_16x16x32_bf16 a[132:135], a[200:203], v[204:207], a[132:135]
    s_add_u32 s60, s51, 0
    v_exp_f32 v51, v143
    v_mfma_f32_16x16x32_bf16 a[136:139], a[200:203], v[212:215], a[136:139]
    s_and_b32 s60, s60, 3
    ds_read_b64_tr_b16 a[196:197], v9 offset:12288
    v_cvt_pk_bf16_f32 v236, v48, v49
    v_mfma_f32_16x16x32_bf16 a[152:155], a[204:207], v[212:215], a[152:155]
    s_mul_i32 s60, s60, 245760
    ds_read_b64_tr_b16 a[198:199], v9 offset:18432
    v_add_f32 v25, v48, v49
    v_mfma_f32_16x16x32_bf16 a[156:159], a[204:207], v[220:223], a[156:159]
    s_add_u32 s32, s60, s59
    v_exp_f32 v52, v172
    v_mfma_f32_16x16x32_bf16 a[140:143], a[200:203], v[220:223], a[140:143]
    s_waitcnt lgkmcnt(4)
    v_exp_f32 v53, v173
    v_mfma_f32_16x16x32_bf16 a[172:175], a[208:211], v[220:223], a[172:175]
    s_add_u32 s60, s51, 1
    ds_read_b64_tr_b16 a[200:201], v10 offset:12288
    v_add_f32 v25, v25, v50
    v_mfma_f32_16x16x32_bf16 a[188:191], a[212:215], v[220:223], a[188:191]
    s_and_b32 s60, s60, 3
    ds_read_b64_tr_b16 a[202:203], v10 offset:18432
    v_cvt_pk_bf16_f32 v237, v50, v51
    v_mfma_f32_16x16x32_bf16 a[184:187], a[212:215], v[212:215], a[184:187]
    s_mul_i32 s60, s60, 245760
    v_exp_f32 v54, v174
    v_mfma_f32_16x16x32_bf16 a[168:171], a[208:211], v[212:215], a[168:171]
    s_add_u32 s33, s60, s59
    v_exp_f32 v55, v175
    v_mfma_f32_16x16x32_bf16 a[164:167], a[208:211], v[204:207], a[164:167]
    s_add_u32 s60, s51, 2
    ds_read_b64_tr_b16 a[204:205], v11 offset:12288
    v_add_f32 v25, v25, v51
    v_mfma_f32_16x16x32_bf16 a[180:183], a[212:215], v[204:207], a[180:183]
    s_and_b32 s60, s60, 3
    ds_read_b64_tr_b16 a[206:207], v11 offset:18432
    v_add_f32 v25, v25, v52
    v_mfma_f32_16x16x32_bf16 a[176:179], a[212:215], v[196:199], a[176:179]
    s_mul_i32 s60, s60, 245760
    v_exp_f32 v48, v148
    v_mfma_f32_16x16x32_bf16 a[160:163], a[208:211], v[196:199], a[160:163]
    s_waitcnt lgkmcnt(4)
    v_exp_f32 v49, v149
    v_cvt_pk_bf16_f32 v238, v52, v53
    v_cvt_pk_bf16_f32 v239, v54, v55
    v_add_f32 v25, v25, v53
    v_add_f32 v25, v25, v54
    v_add_f32 v25, v25, v55
    v_cvt_pk_bf16_f32 v244, v48, v49
    v_exp_f32 v50, v150
    v_exp_f32 v51, v151
    s_add_u32 s34, s60, s59
    v_cvt_pk_bf16_f32 v245, v50, v51
    v_exp_f32 v52, v180
    v_exp_f32 v53, v181
    s_add_u32 s60, s51, 3
    v_cvt_pk_bf16_f32 v246, v52, v53
    v_exp_f32 v54, v182
    v_exp_f32 v55, v183
    s_and_b32 s60, s60, 3
    v_cvt_pk_bf16_f32 v247, v54, v55
    v_add_f32 v26, v48, v49
    v_add_f32 v26, v26, v50
    v_add_f32 v26, v26, v51
    v_add_f32 v26, v26, v52
    v_add_f32 v26, v26, v53
    v_add_f32 v26, v26, v54
    v_add_f32 v26, v26, v55
    v_max3_f32 v29, v24, v25, v26
    v_exp_f32 v48, v156
    v_exp_f32 v49, v157
    s_mul_i32 s60, s60, 245760
    v_cvt_pk_bf16_f32 v252, v48, v49
    v_exp_f32 v50, v158
    v_exp_f32 v51, v159
    s_add_u32 s35, s60, s59
    v_cvt_pk_bf16_f32 v253, v50, v51
    v_exp_f32 v52, v188
    v_exp_f32 v53, v189
    s_add_u32 s38, s33, 0
    v_cvt_pk_bf16_f32 v254, v52, v53
    v_exp_f32 v54, v190
    v_exp_f32 v55, v191
    s_add_u32 s57, s34, 0
    v_cvt_pk_bf16_f32 v255, v54, v55
    v_add_f32 v27, v48, v49
    v_add_f32 v27, v27, v50
    v_add_f32 v27, v27, v51
    v_add_f32 v27, v27, v52
    v_add_f32 v27, v27, v53
    v_add_f32 v27, v27, v54
    v_add_f32 v27, v27, v55
    v_max_f32 v29, v29, v27
    v_cmp_nle_f32 vcc, v29, v30
    s_cbranch_vccnz rare_e
rare_e_ret:
    v_mfma_f32_16x16x32_bf16 a[0:3], a[192:195], v[228:231], a[0:3]
    s_cmp_lt_u32 s3, 2
    s_cselect_b32 s38, s38, s57
    ds_read_b64_tr_b16 a[208:209], v8 offset:13312
    v_mfma_f32_16x16x32_bf16 a[16:19], a[196:199], v[228:231], a[16:19]
    s_add_u32 s76, s38, s63
    ds_read_b64_tr_b16 a[210:211], v8 offset:19456
    v_add_f32 v20, v20, v24
    v_mfma_f32_16x16x32_bf16 a[20:23], a[196:199], v[236:239], a[20:23]
    s_add_u32 m0, s49, 24576
    v_add_f32 v21, v21, v25
    v_add_f32 v22, v22, v26
    v_mfma_f32_16x16x32_bf16 a[4:7], a[192:195], v[236:239], a[4:7]
    buffer_load_dwordx4 v4, s[12:15], s38 offen offset:0 lds
    v_mfma_f32_16x16x32_bf16 a[8:11], a[192:195], v[244:247], a[8:11]
    s_add_u32 m0, s49, 25472
    ds_read_b64_tr_b16 a[212:213], v9 offset:13312
    v_add_f32 v23, v23, v27
    v_mfma_f32_16x16x32_bf16 a[24:27], a[196:199], v[244:247], a[24:27]
    ds_read_b64_tr_b16 a[214:215], v9 offset:19456
    v_mov_b32 v56, v20
    v_mfma_f32_16x16x32_bf16 a[28:31], a[196:199], v[252:255], a[28:31]
    buffer_load_dwordx4 v4, s[12:15], s38 offen offset:128 lds
    v_mfma_f32_16x16x32_bf16 a[12:15], a[192:195], v[252:255], a[12:15]
    s_waitcnt lgkmcnt(4)
    v_permlane16_swap_b32 v20, v56
    v_mfma_f32_16x16x32_bf16 a[44:47], a[200:203], v[252:255], a[44:47]
    s_add_u32 m0, s49, 26368
    ds_read_b64_tr_b16 a[192:193], v10 offset:13312
    v_add_f32 v20, v20, v56
    v_mfma_f32_16x16x32_bf16 a[60:63], a[204:207], v[252:255], a[60:63]
    ds_read_b64_tr_b16 a[194:195], v10 offset:19456
    v_mov_b32 v56, v20
    v_mfma_f32_16x16x32_bf16 a[56:59], a[204:207], v[244:247], a[56:59]
    buffer_load_dwordx4 v4, s[12:15], s76 offen offset:256 lds
    v_mfma_f32_16x16x32_bf16 a[40:43], a[200:203], v[244:247], a[40:43]
    s_add_u32 m0, s49, 27648
    v_permlane32_swap_b32 v20, v56
    v_mfma_f32_16x16x32_bf16 a[36:39], a[200:203], v[236:239], a[36:39]
    s_lshl_b32 s11, s54, 16
    ds_read_b64_tr_b16 a[196:197], v11 offset:13312
    v_add_f32 v20, v20, v56
    v_mfma_f32_16x16x32_bf16 a[52:55], a[204:207], v[236:239], a[52:55]
    s_and_b32 s72, s3, 1
    ds_read_b64_tr_b16 a[198:199], v11 offset:19456
    v_mov_b32 v57, v21
    v_mfma_f32_16x16x32_bf16 a[48:51], a[204:207], v[228:231], a[48:51]
pg_7:
    s_cbranch_execz pg_11
    buffer_load_dwordx4 v5, s[12:15], s38 offen offset:0 lds
    v_mfma_f32_16x16x32_bf16 a[32:35], a[200:203], v[228:231], a[32:35]
    s_waitcnt lgkmcnt(4)
    v_rcp_f32 v20, v20
    v_mfma_f32_16x16x32_bf16 a[64:67], a[208:211], v[228:231], a[64:67]
    s_add_u32 m0, s49, 28544
    ds_read_b64_tr_b16 a[200:201], v8 offset:14336
    v_mov_b32 v58, v22
    v_mfma_f32_16x16x32_bf16 a[80:83], a[212:215], v[228:231], a[80:83]
    s_lshl_b32 s72, s72, 14
    ds_read_b64_tr_b16 a[202:203], v8 offset:20480
    v_mov_b32 v59, v23
    v_mfma_f32_16x16x32_bf16 a[84:87], a[212:215], v[236:239], a[84:87]
    s_or_b32 s11, s11, s72
    v_permlane16_swap_b32 v21, v57
    v_mfma_f32_16x16x32_bf16 a[68:71], a[208:211], v[236:239], a[68:71]
    buffer_load_dwordx4 v5, s[12:15], s38 offen offset:128 lds
    v_mfma_f32_16x16x32_bf16 a[72:75], a[208:211], v[244:247], a[72:75]
    s_add_u32 m0, s49, 29440
    ds_read_b64_tr_b16 a[204:205], v9 offset:14336
    v_add_f32 v21, v21, v57
    v_mfma_f32_16x16x32_bf16 a[88:91], a[212:215], v[244:247], a[88:91]
    s_lshr_b32 s73, s93, 8
    ds_read_b64_tr_b16 a[206:207], v9 offset:20480
    v_mov_b32 v57, v21
    v_mfma_f32_16x16x32_bf16 a[92:95], a[212:215], v[252:255], a[92:95]
    s_add_u32 s8, s51, 1
    v_permlane32_swap_b32 v21, v57
    v_mfma_f32_16x16x32_bf16 a[76:79], a[208:211], v[252:255], a[76:79]
    s_waitcnt lgkmcnt(4)
    buffer_load_dwordx4 v5, s[12:15], s76 offen offset:256 lds
    v_mfma_f32_16x16x32_bf16 a[108:111], a[192:195], v[252:255], a[108:111]
    s_add_u32 s38, s35, 0
    ds_read_b64_tr_b16 a[208:209], v10 offset:14336
    v_add_f32 v21, v21, v57
    v_mfma_f32_16x16x32_bf16 a[124:127], a[196:199], v[252:255], a[124:127]
    s_add_u32 s57, s33, 40960
    ds_read_b64_tr_b16 a[210:211], v10 offset:20480
    v_add_u32 v8, 49152, v12
    v_mfma_f32_16x16x32_bf16 a[120:123], a[196:199], v[244:247], a[120:123]
    s_cmp_lt_u32 s3, 2
    s_cselect_b32 s38, s38, s57
    v_add_u32 v9, 49152, v13
    v_mfma_f32_16x16x32_bf16 a[104:107], a[192:195], v[244:247], a[104:107]
    s_add_u32 s76, s38, s63
    v_rcp_f32 v21, v21
    v_mfma_f32_16x16x32_bf16 a[100:103], a[192:195], v[236:239], a[100:103]
    s_add_u32 m0, s49, 73728
    ds_read_b64_tr_b16 a[212:213], v11 offset:14336
    v_add_u32 v10, 49152, v14
    v_mfma_f32_16x16x32_bf16 a[116:119], a[196:199], v[236:239], a[116:119]
    s_waitcnt vmcnt(29)
    ds_read_b64_tr_b16 a[214:215], v11 offset:20480
    v_accvgpr_read_b32 v64, a0
    v_mfma_f32_16x16x32_bf16 a[112:115], a[196:199], v[228:231], a[112:115]
    s_barrier
    v_mfma_f32_16x16x32_bf16 a[96:99], a[192:195], v[228:231], a[96:99]
    s_waitcnt lgkmcnt(4)
    buffer_load_dwordx4 v4, s[12:15], s38 offen offset:0 lds
    v_mfma_f32_16x16x32_bf16 a[128:131], a[200:203], v[228:231], a[128:131]
    s_add_u32 m0, s49, 74624
    ds_read_b64_tr_b16 a[192:193], v8 offset:0
    v_add_u32 v11, 49152, v15
    v_mfma_f32_16x16x32_bf16 a[144:147], a[204:207], v[228:231], a[144:147]
    s_and_b32 s8, s8, 3
    ds_read_b64_tr_b16 a[194:195], v8 offset:6144
    v_xor_b32 v18, s39, v8
    v_mfma_f32_16x16x32_bf16 a[148:151], a[204:207], v[236:239], a[148:151]
    buffer_load_dwordx4 v4, s[12:15], s38 offen offset:128 lds
    v_mfma_f32_16x16x32_bf16 a[132:135], a[200:203], v[236:239], a[132:135]
    s_add_u32 m0, s49, 75520
    v_permlane16_swap_b32 v22, v58
    v_mfma_f32_16x16x32_bf16 a[136:139], a[200:203], v[244:247], a[136:139]
    s_lshr_b32 s72, s73, s8
    ds_read_b64_tr_b16 a[196:197], v9 offset:0
    v_add_f32 v22, v22, v58
    v_mfma_f32_16x16x32_bf16 a[152:155], a[204:207], v[244:247], a[152:155]
    s_and_b32 s72, s72, 0x2000
    ds_read_b64_tr_b16 a[198:199], v9 offset:6144
    v_mov_b32 v58, v22
    v_mfma_f32_16x16x32_bf16 a[156:159], a[204:207], v[252:255], a[156:159]
    buffer_load_dwordx4 v4, s[12:15], s76 offen offset:256 lds
    v_mfma_f32_16x16x32_bf16 a[140:143], a[200:203], v[252:255], a[140:143]
    s_waitcnt lgkmcnt(4)
    v_permlane32_swap_b32 v22, v58
    v_mfma_f32_16x16x32_bf16 a[172:175], a[208:211], v[252:255], a[172:175]
    s_add_u32 m0, s49, 76800
    ds_read_b64_tr_b16 a[200:201], v10 offset:0
    v_add_f32 v22, v22, v58
    v_mfma_f32_16x16x32_bf16 a[188:191], a[212:215], v[252:255], a[188:191]
    s_mul_i32 s8, s8, 0x202000
    ds_read_b64_tr_b16 a[202:203], v10 offset:6144
    v_xor_b32 v19, s39, v9
    v_mfma_f32_16x16x32_bf16 a[184:187], a[212:215], v[244:247], a[184:187]
    buffer_load_dwordx4 v5, s[12:15], s38 offen offset:0 lds
    v_mfma_f32_16x16x32_bf16 a[168:171], a[208:211], v[244:247], a[168:171]
    s_add_u32 m0, s49, 77696
    v_rcp_f32 v22, v22
    v_mfma_f32_16x16x32_bf16 a[164:167], a[208:211], v[236:239], a[164:167]
    s_xor_b32 s8, s8, s72
    ds_read_b64_tr_b16 a[204:205], v11 offset:0
    v_accvgpr_read_b32 v65, a1
    v_mfma_f32_16x16x32_bf16 a[180:183], a[212:215], v[236:239], a[180:183]
    s_and_b32 s8, s8, 6299648
    ds_read_b64_tr_b16 a[206:207], v11 offset:6144
    v_accvgpr_read_b32 v66, a2
    v_accvgpr_read_b32 v24, a18
    v_mul_f32 v24, v20, v24
    v_accvgpr_read_b32 v25, a19
    v_mul_f32 v25, v20, v25
    v_mul_f32 v66, v20, v66
    v_accvgpr_read_b32 v67, a3
    v_mul_f32 v67, v20, v67
    v_mul_f32 v64, v20, v64
    v_mul_f32 v65, v20, v65
    v_cvt_pk_bf16_f32 v64, v64, v65
    v_cvt_pk_bf16_f32 v65, v66, v67
    v_accvgpr_read_b32 v66, a16
    v_mul_f32 v66, v20, v66
    v_accvgpr_read_b32 v67, a17
    v_mul_f32 v67, v20, v67
    v_cvt_pk_bf16_f32 v66, v66, v67
    v_cvt_pk_bf16_f32 v67, v24, v25
    v_accvgpr_read_b32 v26, a22
    v_mul_f32 v26, v21, v26
    v_accvgpr_read_b32 v27, a23
    v_mul_f32 v27, v21, v27
    v_accvgpr_read_b32 v74, a6
    v_mul_f32 v74, v21, v74
    v_accvgpr_read_b32 v75, a7
    v_mul_f32 v75, v21, v75
    v_accvgpr_read_b32 v72, a4
    v_mul_f32 v72, v21, v72
    v_accvgpr_read_b32 v73, a5
    v_mul_f32 v73, v21, v73
    v_cvt_pk_bf16_f32 v72, v72, v73
    v_cvt_pk_bf16_f32 v73, v74, v75
    v_accvgpr_read_b32 v74, a20
    v_mul_f32 v74, v21, v74
    v_accvgpr_read_b32 v75, a21
    v_mul_f32 v75, v21, v75
    v_cvt_pk_bf16_f32 v74, v74, v75
    v_cvt_pk_bf16_f32 v75, v26, v27
    v_accvgpr_read_b32 v30, a26
    v_mul_f32 v30, v22, v30
    v_accvgpr_read_b32 v31, a27
    v_mul_f32 v31, v22, v31
    v_accvgpr_read_b32 v82, a10
    v_mul_f32 v82, v22, v82
    v_accvgpr_read_b32 v83, a11
    v_mul_f32 v83, v22, v83
    v_accvgpr_read_b32 v80, a8
    v_mul_f32 v80, v22, v80
    v_accvgpr_read_b32 v81, a9
    v_mul_f32 v81, v22, v81
    v_cvt_pk_bf16_f32 v80, v80, v81
    v_cvt_pk_bf16_f32 v81, v82, v83
    v_accvgpr_read_b32 v82, a24
    v_mul_f32 v82, v22, v82
    v_accvgpr_read_b32 v83, a25
    v_mul_f32 v83, v22, v83
    v_cvt_pk_bf16_f32 v82, v82, v83
    v_cvt_pk_bf16_f32 v83, v30, v31
    v_permlane16_swap_b32 v23, v59
    s_xor_b32 s8, s8, s11
    v_add_f32 v23, v23, v59
    v_mov_b32 v59, v23
    s_add_u32 s9, s51, 2
    s_and_b32 s9, s9, 3
    v_permlane32_swap_b32 v23, v59
    s_lshr_b32 s72, s73, s9
    v_add_f32 v23, v23, v59
    v_rcp_f32 v23, v23
    v_accvgpr_read_b32 v24, a30
    v_mul_f32 v24, v23, v24
    v_accvgpr_read_b32 v25, a31
    v_mul_f32 v25, v23, v25
    v_accvgpr_read_b32 v90, a14
    v_mul_f32 v90, v23, v90
    v_accvgpr_read_b32 v91, a15
    v_mul_f32 v91, v23, v91
    v_accvgpr_read_b32 v88, a12
    v_mul_f32 v88, v23, v88
    v_accvgpr_read_b32 v89, a13
    v_mul_f32 v89, v23, v89
    v_cvt_pk_bf16_f32 v88, v88, v89
    v_cvt_pk_bf16_f32 v89, v90, v91
    v_accvgpr_read_b32 v90, a28
    v_mul_f32 v90, v23, v90
    v_accvgpr_read_b32 v91, a29
    v_mul_f32 v91, v23, v91
    v_cvt_pk_bf16_f32 v90, v90, v91
    v_cvt_pk_bf16_f32 v91, v24, v25
    v_mfma_f32_16x16x32_bf16 a[176:179], a[212:215], v[228:231], a[176:179]
    s_and_b32 s72, s72, 0x2000
    v_accvgpr_read_b32 v96, a32
    v_accvgpr_read_b32 v97, a33
    v_mfma_f32_16x16x32_bf16 a[160:163], a[208:211], v[228:231], a[160:163]
    s_waitcnt lgkmcnt(4)
    buffer_store_dwordx4 v[64:67], v28, s[20:23], s55 offen offset:0 sc1
    v_mfma_f32_16x16x32_bf16 a[224:227], a[192:195], v[64:67], 0
    s_mul_i32 s9, s9, 0x202000
    ds_read_b64_tr_b16 a[208:209], v8 offset:1024
    v_accvgpr_read_b32 v98, a34
    v_mfma_f32_16x16x32_bf16 a[240:243], a[196:199], v[64:67], 0
    s_xor_b32 s9, s9, s72
    ds_read_b64_tr_b16 a[210:211], v8 offset:7168
    v_accvgpr_read_b32 v99, a35
    v_mfma_f32_16x16x32_bf16 a[244:247], a[196:199], v[72:75], 0
    s_and_b32 s9, s9, 6299648
    v_mul_f32 v96, v20, v96
    v_mul_f32 v97, v20, v97
    v_mfma_f32_16x16x32_bf16 a[228:231], a[192:195], v[72:75], 0
    buffer_store_dwordx4 v[72:75], v28, s[20:23], s55 offen offset:1024 sc1
    v_mfma_f32_16x16x32_bf16 a[232:235], a[192:195], v[80:83], 0
    s_xor_b32 s9, s9, s11
    ds_read_b64_tr_b16 a[212:213], v9 offset:1024
    v_mul_f32 v98, v20, v98
    v_mfma_f32_16x16x32_bf16 a[248:251], a[196:199], v[80:83], 0
    s_add_u32 s10, s51, 3
    ds_read_b64_tr_b16 a[214:215], v9 offset:7168
    v_mul_f32 v99, v20, v99
    v_mfma_f32_16x16x32_bf16 a[252:255], a[196:199], v[88:91], 0
    s_and_b32 s10, s10, 3
    v_cvt_pk_bf16_f32 v96, v96, v97
    v_cvt_pk_bf16_f32 v97, v98, v99
    v_mfma_f32_16x16x32_bf16 a[236:239], a[192:195], v[88:91], 0
    s_waitcnt lgkmcnt(4)
    buffer_store_dwordx4 v[80:83], v28, s[20:23], s55 offen offset:2048 sc1
    buffer_store_dwordx4 v[88:91], v28, s[20:23], s55 offen offset:3072 sc1
    v_accvgpr_read_b32 v26, a50
    v_mul_f32 v26, v20, v26
    v_accvgpr_read_b32 v27, a51
    v_mul_f32 v27, v20, v27
    v_accvgpr_read_b32 v98, a48
    v_mul_f32 v98, v20, v98
    v_accvgpr_read_b32 v99, a49
    v_mul_f32 v99, v20, v99
    v_cvt_pk_bf16_f32 v98, v98, v99
    v_cvt_pk_bf16_f32 v99, v26, v27
    v_mfma_f32_16x16x32_bf16 v[92:95], a[200:203], v[88:91], 0
    s_add_u32 s55, s55, 4096
    ds_read_b64_tr_b16 a[192:193], v10 offset:1024
    v_accvgpr_read_b32 v104, a36
    v_mfma_f32_16x16x32_bf16 v[124:127], a[204:207], v[88:91], 0
    s_lshr_b32 s72, s73, s10
    ds_read_b64_tr_b16 a[194:195], v10 offset:7168
    v_accvgpr_read_b32 v105, a37
    v_mfma_f32_16x16x32_bf16 v[116:119], a[204:207], v[80:83], 0
    s_and_b32 s72, s72, 0x2000
    v_accvgpr_read_b32 v106, a38
    v_accvgpr_read_b32 v107, a39
    v_mfma_f32_16x16x32_bf16 v[84:87], a[200:203], v[80:83], 0
    s_mul_i32 s10, s10, 0x202000
    v_mul_f32 v104, v21, v104
    v_mul_f32 v105, v21, v105
    v_mfma_f32_16x16x32_bf16 v[76:79], a[200:203], v[72:75], 0
    s_xor_b32 s10, s10, s72
    ds_read_b64_tr_b16 a[196:197], v11 offset:1024
    v_mul_f32 v106, v21, v106
    v_mfma_f32_16x16x32_bf16 v[108:111], a[204:207], v[72:75], 0
    s_and_b32 s10, s10, 6299648
    ds_read_b64_tr_b16 a[198:199], v11 offset:7168
    v_mul_f32 v107, v21, v107
    v_mfma_f32_16x16x32_bf16 v[100:103], a[204:207], v[64:67], 0
    s_xor_b32 s10, s10, s11
    v_cvt_pk_bf16_f32 v104, v104, v105
    v_cvt_pk_bf16_f32 v105, v106, v107
    v_mfma_f32_16x16x32_bf16 v[68:71], a[200:203], v[64:67], 0
    s_waitcnt lgkmcnt(4)
    v_accvgpr_read_b32 v106, a52
    v_accvgpr_read_b32 v107, a53
    v_mfma_f32_16x16x32_bf16 v[132:135], a[208:211], v[64:67], 0
    s_lshl_b32 s72, 1, s51
    ds_read_b64_tr_b16 a[200:201], v18 offset:2048
    v_mov_b32 v16, s72
    v_mfma_f32_16x16x32_bf16 v[164:167], a[212:215], v[64:67], 0
    ds_read_b64_tr_b16 a[202:203], v18 offset:8192
    v_accvgpr_read_b32 v17, a223
    v_accvgpr_read_b32 v30, a54
    v_mul_f32 v30, v21, v30
    v_accvgpr_read_b32 v31, a55
    v_mul_f32 v31, v21, v31
    v_mul_f32 v106, v21, v106
    v_mul_f32 v107, v21, v107
    v_cvt_pk_bf16_f32 v106, v106, v107
    v_cvt_pk_bf16_f32 v107, v30, v31
    v_mfma_f32_16x16x32_bf16 v[172:175], a[212:215], v[72:75], 0
    buffer_load_dwordx4 v5, s[12:15], s38 offen offset:128 lds
    v_mfma_f32_16x16x32_bf16 v[140:143], a[208:211], v[72:75], 0
    s_add_u32 m0, s49, 78592
    v_accvgpr_read_b32 v112, a40
    v_accvgpr_read_b32 v113, a41
    v_mfma_f32_16x16x32_bf16 v[148:151], a[208:211], v[80:83], 0
    s_mov_b32 s72, 0
    ds_read_b64_tr_b16 a[204:205], v19 offset:2048
    v_accvgpr_read_b32 v114, a42
    v_mfma_f32_16x16x32_bf16 v[180:183], a[212:215], v[80:83], 0
    ds_read_b64_tr_b16 a[206:207], v19 offset:8192
    v_accvgpr_read_b32 v115, a43
    v_mfma_f32_16x16x32_bf16 v[188:191], a[212:215], v[88:91], 0
    buffer_load_dwordx4 v5, s[12:15], s76 offen offset:256 lds
    v_mfma_f32_16x16x32_bf16 v[156:159], a[208:211], v[88:91], 0
    s_waitcnt lgkmcnt(4)
    v_mul_f32 v112, v22, v112
    v_mul_f32 v113, v22, v113
    v_mfma_f32_16x16x32_bf16 v[220:223], a[192:195], v[88:91], 0
    s_add_u32 s38, s34, 40960
    ds_read_b64_tr_b16 a[208:209], v8 offset:12288
    v_mul_f32 v114, v22, v114
    v_mfma_f32_16x16x32_bf16 v[252:255], a[196:199], v[88:91], 0
    s_add_u32 s57, s35, 40960
    ds_read_b64_tr_b16 a[210:211], v8 offset:18432
    v_mul_f32 v115, v22, v115
    v_mfma_f32_16x16x32_bf16 v[244:247], a[196:199], v[80:83], 0
    buffer_store_dwordx4 v[96:99], v28, s[20:23], s55 offen offset:0 sc1
    v_mfma_f32_16x16x32_bf16 v[212:215], a[192:195], v[80:83], 0
    s_cmp_lt_u32 s3, 2
    s_cselect_b32 s38, s38, s57
    v_cvt_pk_bf16_f32 v112, v112, v113
    v_accvgpr_read_b32 v24, a58
    v_mul_f32 v24, v22, v24
    v_accvgpr_read_b32 v25, a59
    v_mul_f32 v25, v22, v25
    v_cvt_pk_bf16_f32 v113, v114, v115
    v_accvgpr_read_b32 v114, a56
    v_mul_f32 v114, v22, v114
    v_accvgpr_read_b32 v115, a57
    v_mul_f32 v115, v22, v115
    v_cvt_pk_bf16_f32 v114, v114, v115
    v_cvt_pk_bf16_f32 v115, v24, v25
    v_mfma_f32_16x16x32_bf16 v[204:207], a[192:195], v[72:75], 0
    s_add_u32 s76, s38, s63
    ds_read_b64_tr_b16 a[212:213], v9 offset:12288
    v_accvgpr_read_b32 v120, a44
    v_mfma_f32_16x16x32_bf16 v[236:239], a[196:199], v[72:75], 0
    s_add_u32 m0, s49, 98304
    ds_read_b64_tr_b16 a[214:215], v9 offset:18432
    v_accvgpr_read_b32 v121, a45
    v_mfma_f32_16x16x32_bf16 v[228:231], a[196:199], v[64:67], 0
    buffer_load_dwordx4 v4, s[12:15], s38 offen offset:0 lds
    v_mfma_f32_16x16x32_bf16 v[196:199], a[192:195], v[64:67], 0
    s_waitcnt lgkmcnt(4)
    v_accvgpr_read_b32 v122, a46
    v_accvgpr_read_b32 v123, a47
    v_mfma_f32_16x16x32_bf16 v[32:35], a[200:203], v[64:67], 0
    s_add_u32 m0, s49, 99200
    ds_read_b64_tr_b16 a[192:193], v10 offset:12288
    v_mul_f32 v120, v23, v120
    v_mfma_f32_16x16x32_bf16 v[48:51], a[204:207], v[64:67], 0
    ds_read_b64_tr_b16 a[194:195], v10 offset:18432
    v_mul_f32 v121, v23, v121
    v_mfma_f32_16x16x32_bf16 v[52:55], a[204:207], v[72:75], 0
    buffer_load_dwordx4 v4, s[12:15], s38 offen offset:128 lds
    v_mfma_f32_16x16x32_bf16 v[36:39], a[200:203], v[72:75], 0
    s_add_u32 m0, s49, 100096
    v_mul_f32 v122, v23, v122
    v_mul_f32 v123, v23, v123
    v_mfma_f32_16x16x32_bf16 v[40:43], a[200:203], v[80:83], 0
    ds_read_b64_tr_b16 a[196:197], v11 offset:12288
    v_cvt_pk_bf16_f32 v120, v120, v121
    v_mfma_f32_16x16x32_bf16 v[56:59], a[204:207], v[80:83], 0
    ds_read_b64_tr_b16 a[198:199], v11 offset:18432
    v_cvt_pk_bf16_f32 v121, v122, v123
    v_accvgpr_read_b32 v26, a62
    v_mul_f32 v26, v23, v26
    v_accvgpr_read_b32 v27, a63
    v_mul_f32 v27, v23, v27
    v_accvgpr_read_b32 v122, a60
    v_mul_f32 v122, v23, v122
    v_accvgpr_read_b32 v123, a61
    v_mul_f32 v123, v23, v123
    v_cvt_pk_bf16_f32 v122, v122, v123
    v_cvt_pk_bf16_f32 v123, v26, v27
    v_mfma_f32_16x16x32_bf16 v[60:63], a[204:207], v[88:91], 0
    buffer_load_dwordx4 v4, s[12:15], s76 offen offset:256 lds
    v_mfma_f32_16x16x32_bf16 v[44:47], a[200:203], v[88:91], 0
    s_waitcnt lgkmcnt(4)
    v_accvgpr_read_b32 v128, a64
    v_accvgpr_read_b32 v129, a65
    v_mfma_f32_16x16x32_bf16 a[236:239], a[208:211], v[120:123], a[236:239]
    s_add_u32 m0, s49, 101376
    ds_read_b64_tr_b16 a[200:201], v8 offset:13312
    v_accvgpr_read_b32 v130, a66
    v_mfma_f32_16x16x32_bf16 a[252:255], a[212:215], v[120:123], a[252:255]
    ds_read_b64_tr_b16 a[202:203], v8 offset:19456
    v_accvgpr_read_b32 v131, a67
    v_mfma_f32_16x16x32_bf16 a[248:251], a[212:215], v[112:115], a[248:251]
    buffer_load_dwordx4 v5, s[12:15], s38 offen offset:0 lds
    v_mfma_f32_16x16x32_bf16 a[232:235], a[208:211], v[112:115], a[232:235]
    s_add_u32 m0, s49, 102272
    v_mul_f32 v128, v20, v128
    v_mul_f32 v129, v20, v129
    v_mfma_f32_16x16x32_bf16 a[228:231], a[208:211], v[104:107], a[228:231]
    ds_read_b64_tr_b16 a[204:205], v9 offset:13312
    v_mul_f32 v130, v20, v130
    v_mfma_f32_16x16x32_bf16 a[244:247], a[212:215], v[104:107], a[244:247]
    ds_read_b64_tr_b16 a[206:207], v9 offset:19456
    v_mul_f32 v131, v20, v131
    v_mfma_f32_16x16x32_bf16 a[240:243], a[212:215], v[96:99], a[240:243]
    v_cvt_pk_bf16_f32 v128, v128, v129
    v_cvt_pk_bf16_f32 v129, v130, v131
    v_mfma_f32_16x16x32_bf16 a[224:227], a[208:211], v[96:99], a[224:227]
    s_waitcnt lgkmcnt(4)
    buffer_store_dwordx4 v[104:107], v28, s[20:23], s55 offen offset:1024 sc1
    v_accvgpr_read_b32 v30, a82
    v_mul_f32 v30, v20, v30
    v_accvgpr_read_b32 v31, a83
    v_mul_f32 v31, v20, v31
    v_accvgpr_read_b32 v130, a80
    v_mul_f32 v130, v20, v130
    v_accvgpr_read_b32 v131, a81
    v_mul_f32 v131, v20, v131
    v_cvt_pk_bf16_f32 v130, v130, v131
    v_cvt_pk_bf16_f32 v131, v30, v31
    v_mfma_f32_16x16x32_bf16 v[68:71], a[192:195], v[96:99], v[68:71]
    ds_read_b64_tr_b16 a[208:209], v10 offset:13312
    v_add_u32 v8, 0, v12
    v_mfma_f32_16x16x32_bf16 v[100:103], a[196:199], v[96:99], v[100:103]
    ds_read_b64_tr_b16 a[210:211], v10 offset:19456
    v_accvgpr_read_b32 v136, a68
    v_mfma_f32_16x16x32_bf16 v[108:111], a[196:199], v[104:107], v[108:111]
    v_accvgpr_read_b32 v137, a69
    v_accvgpr_read_b32 v138, a70
    v_mfma_f32_16x16x32_bf16 v[76:79], a[192:195], v[104:107], v[76:79]
    buffer_load_dwordx4 v5, s[12:15], s38 offen offset:128 lds
    v_mfma_f32_16x16x32_bf16 v[84:87], a[192:195], v[112:115], v[84:87]
    s_add_u32 m0, s49, 103168
    ds_read_b64_tr_b16 a[212:213], v11 offset:13312
    v_accvgpr_read_b32 v139, a71
    v_mfma_f32_16x16x32_bf16 v[116:119], a[196:199], v[112:115], v[116:119]
    ds_read_b64_tr_b16 a[214:215], v11 offset:19456
    v_mul_f32 v136, v21, v136
    v_mfma_f32_16x16x32_bf16 v[124:127], a[196:199], v[120:123], v[124:127]
    v_mul_f32 v137, v21, v137
    v_mul_f32 v138, v21, v138
    v_mfma_f32_16x16x32_bf16 v[92:95], a[192:195], v[120:123], v[92:95]
    s_waitcnt lgkmcnt(4)
    buffer_load_dwordx4 v5, s[12:15], s76 offen offset:256 lds
    v_mfma_f32_16x16x32_bf16 v[156:159], a[200:203], v[120:123], v[156:159]
    ds_read_b64_tr_b16 a[192:193], v18 offset:14336
    v_mul_f32 v139, v21, v139
    v_mfma_f32_16x16x32_bf16 v[188:191], a[204:207], v[120:123], v[188:191]
    ds_read_b64_tr_b16 a[194:195], v18 offset:20480
    v_cvt_pk_bf16_f32 v136, v136, v137
    v_accvgpr_read_b32 v24, a86
    v_mul_f32 v24, v21, v24
    v_accvgpr_read_b32 v25, a87
    v_mul_f32 v25, v21, v25
    v_cvt_pk_bf16_f32 v137, v138, v139
    v_accvgpr_read_b32 v138, a84
    v_mul_f32 v138, v21, v138
    v_accvgpr_read_b32 v139, a85
    v_mul_f32 v139, v21, v139
    v_cvt_pk_bf16_f32 v138, v138, v139
    v_cvt_pk_bf16_f32 v139, v24, v25
    v_mfma_f32_16x16x32_bf16 v[180:183], a[204:207], v[112:115], v[180:183]
    s_add_u32 s38, s33, 81920
    v_add_u32 v9, 0, v13
    v_add_u32 v10, 0, v14
    v_mfma_f32_16x16x32_bf16 v[148:151], a[200:203], v[112:115], v[148:151]
    s_add_u32 s57, s34, 81920
    v_accvgpr_read_b32 v144, a72
    v_accvgpr_read_b32 v145, a73
    v_mfma_f32_16x16x32_bf16 v[140:143], a[200:203], v[104:107], v[140:143]
    s_cmp_lt_u32 s3, 2
    s_cselect_b32 s38, s38, s57
    ds_read_b64_tr_b16 a[196:197], v19 offset:14336
    v_mfma_f32_16x16x32_bf16 v[172:175], a[204:207], v[104:107], v[172:175]
    s_waitcnt vmcnt(24)
    ds_read_b64_tr_b16 a[198:199], v19 offset:20480
    v_accvgpr_read_b32 v146, a74
    v_mfma_f32_16x16x32_bf16 v[164:167], a[204:207], v[96:99], v[164:167]
    s_barrier
    v_mfma_f32_16x16x32_bf16 v[132:135], a[200:203], v[96:99], v[132:135]
    s_waitcnt lgkmcnt(4)
    v_accvgpr_read_b32 v147, a75
    v_mul_f32 v144, v22, v144
    v_mfma_f32_16x16x32_bf16 v[196:199], a[208:211], v[96:99], v[196:199]
    s_add_u32 s76, s38, s63
    ds_read_b64_tr_b16 a[200:201], v8 offset:0
    v_mul_f32 v145, v22, v145
    v_mfma_f32_16x16x32_bf16 v[228:231], a[212:215], v[96:99], v[228:231]
    s_add_u32 m0, s49, 49152
    ds_read_b64_tr_b16 a[202:203], v8 offset:6144
    v_mul_f32 v146, v22, v146
    v_mfma_f32_16x16x32_bf16 v[236:239], a[212:215], v[104:107], v[236:239]
    buffer_store_dwordx4 v[112:115], v28, s[20:23], s55 offen offset:2048 sc1
    v_mfma_f32_16x16x32_bf16 v[204:207], a[208:211], v[104:107], v[204:207]
    s_waitcnt vmcnt(11)
    v_mul_f32 v147, v22, v147
    v_cvt_pk_bf16_f32 v144, v144, v145
    v_accvgpr_read_b32 v26, a90
    v_mul_f32 v26, v22, v26
    v_accvgpr_read_b32 v27, a91
    v_mul_f32 v27, v22, v27
    v_cvt_pk_bf16_f32 v145, v146, v147
    v_accvgpr_read_b32 v146, a88
    v_mul_f32 v146, v22, v146
    v_accvgpr_read_b32 v147, a89
    v_mul_f32 v147, v22, v147
    v_cvt_pk_bf16_f32 v146, v146, v147
    v_cvt_pk_bf16_f32 v147, v26, v27
    v_mfma_f32_16x16x32_bf16 v[212:215], a[208:211], v[112:115], v[212:215]
    ds_read_b64_tr_b16 a[204:205], v9 offset:0
    v_add_u32 v11, 0, v15
    v_mfma_f32_16x16x32_bf16 v[244:247], a[212:215], v[112:115], v[244:247]
    ds_read_b64_tr_b16 a[206:207], v9 offset:6144
    v_xor_b32 v18, s39, v8
    v_mfma_f32_16x16x32_bf16 v[252:255], a[212:215], v[120:123], v[252:255]
    buffer_atomic_or v16, v17, s[24:27], 0 offen
    v_mfma_f32_16x16x32_bf16 v[220:223], a[208:211], v[120:123], v[220:223]
    s_waitcnt lgkmcnt(4)
    buffer_load_dwordx4 v4, s[12:15], s38 offen offset:0 lds
    v_mfma_f32_16x16x32_bf16 v[44:47], a[192:195], v[120:123], v[44:47]
    s_add_u32 m0, s49, 50048
    ds_read_b64_tr_b16 a[208:209], v10 offset:0
    v_xor_b32 v19, s39, v9
    v_mfma_f32_16x16x32_bf16 v[60:63], a[196:199], v[120:123], v[60:63]
    ds_read_b64_tr_b16 a[210:211], v10 offset:6144
    v_accvgpr_read_b32 v152, a76
    v_mfma_f32_16x16x32_bf16 v[56:59], a[196:199], v[112:115], v[56:59]
    buffer_load_dwordx4 v4, s[12:15], s38 offen offset:128 lds
    v_mfma_f32_16x16x32_bf16 v[40:43], a[192:195], v[112:115], v[40:43]
    s_add_u32 m0, s49, 50944
    v_accvgpr_read_b32 v153, a77
    v_accvgpr_read_b32 v154, a78
    v_mfma_f32_16x16x32_bf16 v[36:39], a[192:195], v[104:107], v[36:39]
    ds_read_b64_tr_b16 a[212:213], v11 offset:0
    v_accvgpr_read_b32 v155, a79
    v_mfma_f32_16x16x32_bf16 v[52:55], a[196:199], v[104:107], v[52:55]
    ds_read_b64_tr_b16 a[214:215], v11 offset:6144
    v_mul_f32 v152, v23, v152
    v_accvgpr_read_b32 v30, a94
    v_mul_f32 v30, v23, v30
    v_accvgpr_read_b32 v31, a95
    v_mul_f32 v31, v23, v31
    v_mul_f32 v154, v23, v154
    v_mul_f32 v155, v23, v155
    v_mul_f32 v153, v23, v153
    v_cvt_pk_bf16_f32 v152, v152, v153
    v_cvt_pk_bf16_f32 v153, v154, v155
    v_accvgpr_read_b32 v154, a92
    v_mul_f32 v154, v23, v154
    v_accvgpr_read_b32 v155, a93
    v_mul_f32 v155, v23, v155
    v_cvt_pk_bf16_f32 v154, v154, v155
    v_cvt_pk_bf16_f32 v155, v30, v31
    v_mfma_f32_16x16x32_bf16 v[48:51], a[196:199], v[96:99], v[48:51]
    buffer_load_dwordx4 v4, s[12:15], s76 offen offset:256 lds
    v_mfma_f32_16x16x32_bf16 v[32:35], a[192:195], v[96:99], v[32:35]
    s_waitcnt lgkmcnt(4)
    v_accvgpr_read_b32 v160, a96
    v_accvgpr_read_b32 v161, a97
    v_mfma_f32_16x16x32_bf16 a[224:227], a[200:203], v[128:131], a[224:227]
    s_add_u32 m0, s49, 52224
    ds_read_b64_tr_b16 a[192:193], v8 offset:1024
    v_accvgpr_read_b32 v162, a98
    v_mfma_f32_16x16x32_bf16 a[240:243], a[204:207], v[128:131], a[240:243]
    ds_read_b64_tr_b16 a[194:195], v8 offset:7168
    v_accvgpr_read_b32 v163, a99
    v_mfma_f32_16x16x32_bf16 a[244:247], a[204:207], v[136:139], a[244:247]
    buffer_load_dwordx4 v5, s[12:15], s38 offen offset:0 lds
    v_mfma_f32_16x16x32_bf16 a[228:231], a[200:203], v[136:139], a[228:231]
    s_add_u32 m0, s49, 53120
    v_mul_f32 v160, v20, v160
    v_mul_f32 v161, v20, v161
    v_mfma_f32_16x16x32_bf16 a[232:235], a[200:203], v[144:147], a[232:235]
    ds_read_b64_tr_b16 a[196:197], v9 offset:1024
    v_mul_f32 v162, v20, v162
    v_mfma_f32_16x16x32_bf16 a[248:251], a[204:207], v[144:147], a[248:251]
    ds_read_b64_tr_b16 a[198:199], v9 offset:7168
    v_mul_f32 v163, v20, v163
    v_mfma_f32_16x16x32_bf16 a[252:255], a[204:207], v[152:155], a[252:255]
    v_cvt_pk_bf16_f32 v160, v160, v161
    v_cvt_pk_bf16_f32 v161, v162, v163
    v_mfma_f32_16x16x32_bf16 a[236:239], a[200:203], v[152:155], a[236:239]
    s_waitcnt lgkmcnt(4)
    buffer_load_dwordx4 v5, s[12:15], s38 offen offset:128 lds
    v_accvgpr_read_b32 v24, a114
    v_mul_f32 v24, v20, v24
    v_accvgpr_read_b32 v25, a115
    v_mul_f32 v25, v20, v25
    v_accvgpr_read_b32 v162, a112
    v_mul_f32 v162, v20, v162
    v_accvgpr_read_b32 v163, a113
    v_mul_f32 v163, v20, v163
    v_cvt_pk_bf16_f32 v162, v162, v163
    v_cvt_pk_bf16_f32 v163, v24, v25
    v_mfma_f32_16x16x32_bf16 v[92:95], a[208:211], v[152:155], v[92:95]
    s_add_u32 m0, s49, 54016
    ds_read_b64_tr_b16 a[200:201], v10 offset:1024
    v_accvgpr_read_b32 v168, a100
    v_mfma_f32_16x16x32_bf16 v[124:127], a[212:215], v[152:155], v[124:127]
    ds_read_b64_tr_b16 a[202:203], v10 offset:7168
    v_accvgpr_read_b32 v169, a101
    v_mfma_f32_16x16x32_bf16 v[116:119], a[212:215], v[144:147], v[116:119]
    v_accvgpr_read_b32 v170, a102
    v_accvgpr_read_b32 v171, a103
    v_mfma_f32_16x16x32_bf16 v[84:87], a[208:211], v[144:147], v[84:87]
    buffer_store_dwordx4 v[120:123], v28, s[20:23], s55 offen offset:3072 sc1
    v_mfma_f32_16x16x32_bf16 v[76:79], a[208:211], v[136:139], v[76:79]
    s_add_u32 s55, s55, 12288
    ds_read_b64_tr_b16 a[204:205], v11 offset:1024
    v_mul_f32 v168, v21, v168
    v_mfma_f32_16x16x32_bf16 v[108:111], a[212:215], v[136:139], v[108:111]
pg_8:
    s_cbranch_execz pg_12
    ds_read_b64_tr_b16 a[206:207], v11 offset:7168
    v_mul_f32 v169, v21, v169
    v_mfma_f32_16x16x32_bf16 v[100:103], a[212:215], v[128:131], v[100:103]
    v_mul_f32 v170, v21, v170
    v_mul_f32 v171, v21, v171
    v_mfma_f32_16x16x32_bf16 v[68:71], a[208:211], v[128:131], v[68:71]
    s_waitcnt lgkmcnt(4)
    buffer_load_dwordx4 v5, s[12:15], s76 offen offset:256 lds
    v_mfma_f32_16x16x32_bf16 v[132:135], a[192:195], v[128:131], v[132:135]
    ds_read_b64_tr_b16 a[208:209], v18 offset:2048
    v_cvt_pk_bf16_f32 v168, v168, v169
    v_mfma_f32_16x16x32_bf16 v[164:167], a[196:199], v[128:131], v[164:167]
    ds_read_b64_tr_b16 a[210:211], v18 offset:8192
    v_cvt_pk_bf16_f32 v169, v170, v171
    v_accvgpr_read_b32 v26, a118
    v_mul_f32 v26, v21, v26
    v_accvgpr_read_b32 v27, a119
    v_mul_f32 v27, v21, v27
    v_accvgpr_read_b32 v170, a116
    v_mul_f32 v170, v21, v170
    v_accvgpr_read_b32 v171, a117
    v_mul_f32 v171, v21, v171
    v_cvt_pk_bf16_f32 v170, v170, v171
    v_cvt_pk_bf16_f32 v171, v26, v27
    v_mfma_f32_16x16x32_bf16 v[172:175], a[196:199], v[136:139], v[172:175]
    v_accvgpr_read_b32 v176, a104
    v_accvgpr_read_b32 v177, a105
    v_mfma_f32_16x16x32_bf16 v[140:143], a[192:195], v[136:139], v[140:143]
    v_accvgpr_read_b32 v178, a106
    v_accvgpr_read_b32 v179, a107
    v_mfma_f32_16x16x32_bf16 v[148:151], a[192:195], v[144:147], v[148:151]
    ds_read_b64_tr_b16 a[212:213], v19 offset:2048
    v_mul_f32 v176, v22, v176
    v_mfma_f32_16x16x32_bf16 v[180:183], a[196:199], v[144:147], v[180:183]
    ds_read_b64_tr_b16 a[214:215], v19 offset:8192
    v_mul_f32 v177, v22, v177
    v_mfma_f32_16x16x32_bf16 v[188:191], a[196:199], v[152:155], v[188:191]
    buffer_store_dwordx4 v[128:131], v28, s[20:23], s55 offen offset:0 sc1
    v_mfma_f32_16x16x32_bf16 v[156:159], a[192:195], v[152:155], v[156:159]
    s_waitcnt lgkmcnt(4)
    v_mul_f32 v178, v22, v178
    v_mul_f32 v179, v22, v179
    v_mfma_f32_16x16x32_bf16 v[220:223], a[200:203], v[152:155], v[220:223]
    ds_read_b64_tr_b16 a[192:193], v8 offset:12288
    v_cvt_pk_bf16_f32 v176, v176, v177
    v_mfma_f32_16x16x32_bf16 v[252:255], a[204:207], v[152:155], v[252:255]
    ds_read_b64_tr_b16 a[194:195], v8 offset:18432
    v_cvt_pk_bf16_f32 v177, v178, v179
    v_mfma_f32_16x16x32_bf16 v[244:247], a[204:207], v[144:147], v[244:247]
    v_accvgpr_read_b32 v178, a120
    v_accvgpr_read_b32 v179, a121
    v_mfma_f32_16x16x32_bf16 v[212:215], a[200:203], v[144:147], v[212:215]
    v_accvgpr_read_b32 v30, a122
    v_accvgpr_read_b32 v31, a123
    v_mul_f32 v30, v22, v30
    v_mul_f32 v31, v22, v31
    v_mul_f32 v178, v22, v178
    v_mul_f32 v179, v22, v179
    v_cvt_pk_bf16_f32 v178, v178, v179
    v_cvt_pk_bf16_f32 v179, v30, v31
    v_mfma_f32_16x16x32_bf16 v[204:207], a[200:203], v[136:139], v[204:207]
    ds_read_b64_tr_b16 a[196:197], v9 offset:12288
    v_accvgpr_read_b32 v184, a108
    v_mfma_f32_16x16x32_bf16 v[236:239], a[204:207], v[136:139], v[236:239]
    ds_read_b64_tr_b16 a[198:199], v9 offset:18432
    v_accvgpr_read_b32 v185, a109
    v_mfma_f32_16x16x32_bf16 v[228:231], a[204:207], v[128:131], v[228:231]
    v_accvgpr_read_b32 v186, a110
    v_accvgpr_read_b32 v187, a111
    v_mfma_f32_16x16x32_bf16 v[196:199], a[200:203], v[128:131], v[196:199]
    s_waitcnt lgkmcnt(4)
    v_mul_f32 v184, v23, v184
    v_mul_f32 v185, v23, v185
    v_mfma_f32_16x16x32_bf16 v[32:35], a[208:211], v[128:131], v[32:35]
    ds_read_b64_tr_b16 a[200:201], v10 offset:12288
    v_mul_f32 v186, v23, v186
    v_mfma_f32_16x16x32_bf16 v[48:51], a[212:215], v[128:131], v[48:51]
    ds_read_b64_tr_b16 a[202:203], v10 offset:18432
    v_mul_f32 v187, v23, v187
    v_mfma_f32_16x16x32_bf16 v[52:55], a[212:215], v[136:139], v[52:55]
    v_cvt_pk_bf16_f32 v184, v184, v185
    v_cvt_pk_bf16_f32 v185, v186, v187
    v_mfma_f32_16x16x32_bf16 v[36:39], a[208:211], v[136:139], v[36:39]
    buffer_store_dwordx4 v[136:139], v28, s[20:23], s55 offen offset:1024 sc1
    v_mfma_f32_16x16x32_bf16 v[40:43], a[208:211], v[144:147], v[40:43]
    ds_read_b64_tr_b16 a[204:205], v11 offset:12288
    v_accvgpr_read_b32 v186, a124
    v_mfma_f32_16x16x32_bf16 v[56:59], a[212:215], v[144:147], v[56:59]
    ds_read_b64_tr_b16 a[206:207], v11 offset:18432
    v_accvgpr_read_b32 v187, a125
    v_accvgpr_read_b32 v24, a126
    v_mul_f32 v24, v23, v24
    v_accvgpr_read_b32 v25, a127
    v_mul_f32 v25, v23, v25
    v_mul_f32 v186, v23, v186
    v_mul_f32 v187, v23, v187
    v_cvt_pk_bf16_f32 v186, v186, v187
    v_cvt_pk_bf16_f32 v187, v24, v25
    v_mfma_f32_16x16x32_bf16 v[60:63], a[212:215], v[152:155], v[60:63]
    v_accvgpr_read_b32 v192, a128
    v_accvgpr_read_b32 v193, a129
    v_mfma_f32_16x16x32_bf16 v[44:47], a[208:211], v[152:155], v[44:47]
    s_waitcnt lgkmcnt(4)
    v_accvgpr_read_b32 v194, a130
    v_accvgpr_read_b32 v195, a131
    v_mfma_f32_16x16x32_bf16 a[236:239], a[192:195], v[184:187], a[236:239]
    ds_read_b64_tr_b16 a[208:209], v8 offset:13312
    v_mul_f32 v192, v20, v192
    v_mfma_f32_16x16x32_bf16 a[252:255], a[196:199], v[184:187], a[252:255]
    ds_read_b64_tr_b16 a[210:211], v8 offset:19456
    v_mul_f32 v193, v20, v193
    v_mfma_f32_16x16x32_bf16 a[248:251], a[196:199], v[176:179], a[248:251]
    v_mul_f32 v194, v20, v194
    v_mul_f32 v195, v20, v195
    v_mfma_f32_16x16x32_bf16 a[232:235], a[192:195], v[176:179], a[232:235]
    v_cvt_pk_bf16_f32 v192, v192, v193
    v_cvt_pk_bf16_f32 v193, v194, v195
    v_mfma_f32_16x16x32_bf16 a[228:231], a[192:195], v[168:171], a[228:231]
    ds_read_b64_tr_b16 a[212:213], v9 offset:13312
    v_accvgpr_read_b32 v194, a144
    v_mfma_f32_16x16x32_bf16 a[244:247], a[196:199], v[168:171], a[244:247]
    ds_read_b64_tr_b16 a[214:215], v9 offset:19456
    v_accvgpr_read_b32 v195, a145
    v_mfma_f32_16x16x32_bf16 a[240:243], a[196:199], v[160:163], a[240:243]
    v_accvgpr_read_b32 v26, a146
    v_accvgpr_read_b32 v27, a147
    v_mfma_f32_16x16x32_bf16 a[224:227], a[192:195], v[160:163], a[224:227]
    s_waitcnt lgkmcnt(4)
    v_mul_f32 v194, v20, v194
    v_mul_f32 v195, v20, v195
    v_mul_f32 v26, v20, v26
    v_mul_f32 v27, v20, v27
    v_cvt_pk_bf16_f32 v194, v194, v195
    v_cvt_pk_bf16_f32 v195, v26, v27
    v_mfma_f32_16x16x32_bf16 v[68:71], a[200:203], v[160:163], v[68:71]
    ds_read_b64_tr_b16 a[192:193], v10 offset:13312
    v_add_u32 v8, 122880, v12
    v_mfma_f32_16x16x32_bf16 v[100:103], a[204:207], v[160:163], v[100:103]
    ds_read_b64_tr_b16 a[194:195], v10 offset:19456
    v_accvgpr_read_b32 v200, a132
    v_mfma_f32_16x16x32_bf16 v[108:111], a[204:207], v[168:171], v[108:111]
    buffer_store_dwordx4 v[144:147], v28, s[20:23], s55 offen offset:2048 sc1
    v_mfma_f32_16x16x32_bf16 v[76:79], a[200:203], v[168:171], v[76:79]
    v_accvgpr_read_b32 v201, a133
    v_accvgpr_read_b32 v202, a134
    v_mfma_f32_16x16x32_bf16 v[84:87], a[200:203], v[176:179], v[84:87]
    ds_read_b64_tr_b16 a[196:197], v11 offset:13312
    v_accvgpr_read_b32 v203, a135
    v_mfma_f32_16x16x32_bf16 v[116:119], a[204:207], v[176:179], v[116:119]
    ds_read_b64_tr_b16 a[198:199], v11 offset:19456
    v_mul_f32 v200, v21, v200
    v_mfma_f32_16x16x32_bf16 v[124:127], a[204:207], v[184:187], v[124:127]
    v_mul_f32 v201, v21, v201
    v_mul_f32 v202, v21, v202
    v_mfma_f32_16x16x32_bf16 v[92:95], a[200:203], v[184:187], v[92:95]
    s_waitcnt lgkmcnt(4)
    v_mul_f32 v203, v21, v203
    v_cvt_pk_bf16_f32 v200, v200, v201
    v_mfma_f32_16x16x32_bf16 v[156:159], a[208:211], v[184:187], v[156:159]
    ds_read_b64_tr_b16 a[200:201], v18 offset:14336
    v_cvt_pk_bf16_f32 v201, v202, v203
    v_mfma_f32_16x16x32_bf16 v[188:191], a[212:215], v[184:187], v[188:191]
    ds_read_b64_tr_b16 a[202:203], v18 offset:20480
    v_accvgpr_read_b32 v202, a148
    v_accvgpr_read_b32 v30, a150
    v_mul_f32 v30, v21, v30
    v_accvgpr_read_b32 v31, a151
    v_mul_f32 v31, v21, v31
    v_mul_f32 v202, v21, v202
    v_accvgpr_read_b32 v203, a149
    v_mul_f32 v203, v21, v203
    v_cvt_pk_bf16_f32 v202, v202, v203
    v_cvt_pk_bf16_f32 v203, v30, v31
    v_mfma_f32_16x16x32_bf16 v[180:183], a[212:215], v[176:179], v[180:183]
    s_add_u32 s38, s35, 81920
    v_add_u32 v9, 122880, v13
    v_add_u32 v10, 122880, v14
    v_mfma_f32_16x16x32_bf16 v[148:151], a[208:211], v[176:179], v[148:151]
    s_add_u32 s57, s33, 122880
    v_accvgpr_read_b32 v208, a136
    v_accvgpr_read_b32 v209, a137
    v_mfma_f32_16x16x32_bf16 v[140:143], a[208:211], v[168:171], v[140:143]
    s_cmp_lt_u32 s3, 2
    s_cselect_b32 s38, s38, s57
    ds_read_b64_tr_b16 a[204:205], v19 offset:14336
    v_mfma_f32_16x16x32_bf16 v[172:175], a[212:215], v[168:171], v[172:175]
    s_waitcnt vmcnt(40)
    ds_read_b64_tr_b16 a[206:207], v19 offset:20480
    v_lshlrev_b32 v16, 4, v16
    v_mfma_f32_16x16x32_bf16 v[164:167], a[212:215], v[160:163], v[164:167]
    s_barrier
    v_mfma_f32_16x16x32_bf16 v[132:135], a[208:211], v[160:163], v[132:135]
    s_waitcnt lgkmcnt(4)
    v_accvgpr_read_b32 v210, a138
    v_accvgpr_read_b32 v211, a139
    v_mfma_f32_16x16x32_bf16 v[196:199], a[192:195], v[160:163], v[196:199]
    s_add_u32 s76, s38, s63
    ds_read_b64_tr_b16 a[208:209], v8 offset:0
    v_mul_f32 v208, v22, v208
    v_mfma_f32_16x16x32_bf16 v[228:231], a[196:199], v[160:163], v[228:231]
    s_add_u32 m0, s49, 0
    ds_read_b64_tr_b16 a[210:211], v8 offset:6144
    v_mul_f32 v209, v22, v209
    v_mfma_f32_16x16x32_bf16 v[236:239], a[196:199], v[168:171], v[236:239]
    buffer_store_dwordx4 v[152:155], v28, s[20:23], s55 offen offset:3072 sc1
    v_mfma_f32_16x16x32_bf16 v[204:207], a[192:195], v[168:171], v[204:207]
    s_add_u32 s55, s55, 4096
    v_mul_f32 v210, v22, v210
    v_mul_f32 v211, v22, v211
    v_accvgpr_read_b32 v24, a154
    v_mul_f32 v24, v22, v24
    v_accvgpr_read_b32 v25, a155
    v_mul_f32 v25, v22, v25
    v_cvt_pk_bf16_f32 v208, v208, v209
    v_cvt_pk_bf16_f32 v209, v210, v211
    v_accvgpr_read_b32 v210, a152
    v_mul_f32 v210, v22, v210
    v_accvgpr_read_b32 v211, a153
    v_mul_f32 v211, v22, v211
    v_cvt_pk_bf16_f32 v210, v210, v211
    v_cvt_pk_bf16_f32 v211, v24, v25
    v_mfma_f32_16x16x32_bf16 v[212:215], a[192:195], v[176:179], v[212:215]
    s_load_dword s72, s[86:87], s5 offset:4 glc
    ds_read_b64_tr_b16 a[212:213], v9 offset:0
    v_add_u32 v11, 122880, v15
    v_mfma_f32_16x16x32_bf16 v[244:247], a[196:199], v[176:179], v[244:247]
    s_waitcnt vmcnt(5)
    ds_read_b64_tr_b16 a[214:215], v9 offset:6144
    v_xor_b32 v18, s39, v8
    v_mfma_f32_16x16x32_bf16 v[252:255], a[196:199], v[184:187], v[252:255]
    buffer_atomic_or v16, v17, s[24:27], 0 offen
    v_mfma_f32_16x16x32_bf16 v[220:223], a[192:195], v[184:187], v[220:223]
    s_waitcnt lgkmcnt(4)
    buffer_load_dwordx4 v4, s[12:15], s38 offen offset:0 lds
    v_mfma_f32_16x16x32_bf16 v[44:47], a[200:203], v[184:187], v[44:47]
    s_add_u32 m0, s49, 896
    ds_read_b64_tr_b16 a[192:193], v10 offset:0
    v_xor_b32 v19, s39, v9
    v_mfma_f32_16x16x32_bf16 v[60:63], a[204:207], v[184:187], v[60:63]
    ds_read_b64_tr_b16 a[194:195], v10 offset:6144
    v_accvgpr_read_b32 v216, a140
    v_mfma_f32_16x16x32_bf16 v[56:59], a[204:207], v[176:179], v[56:59]
    buffer_load_dwordx4 v4, s[12:15], s38 offen offset:128 lds
    v_mfma_f32_16x16x32_bf16 v[40:43], a[200:203], v[176:179], v[40:43]
    s_add_u32 m0, s49, 1792
    v_accvgpr_read_b32 v217, a141
    v_accvgpr_read_b32 v218, a142
    v_mfma_f32_16x16x32_bf16 v[36:39], a[200:203], v[168:171], v[36:39]
    s_mov_b32 s28, s82
    ds_read_b64_tr_b16 a[196:197], v11 offset:0
    v_accvgpr_read_b32 v219, a143
    v_mfma_f32_16x16x32_bf16 v[52:55], a[204:207], v[168:171], v[52:55]
    s_and_b32 s29, s83, 0xffff
    ds_read_b64_tr_b16 a[198:199], v11 offset:6144
    v_mul_f32 v216, v23, v216
    v_accvgpr_read_b32 v26, a158
    v_mul_f32 v26, v23, v26
    v_accvgpr_read_b32 v27, a159
    v_mul_f32 v27, v23, v27
    v_mul_f32 v218, v23, v218
    v_mul_f32 v219, v23, v219
    v_mul_f32 v217, v23, v217
    v_cvt_pk_bf16_f32 v216, v216, v217
    v_cvt_pk_bf16_f32 v217, v218, v219
    v_accvgpr_read_b32 v218, a156
    v_mul_f32 v218, v23, v218
    v_accvgpr_read_b32 v219, a157
    v_mul_f32 v219, v23, v219
    v_cvt_pk_bf16_f32 v218, v218, v219
    v_cvt_pk_bf16_f32 v219, v26, v27
    v_mfma_f32_16x16x32_bf16 v[48:51], a[204:207], v[160:163], v[48:51]
    buffer_store_dwordx4 v[160:163], v28, s[20:23], s55 offen offset:0 sc1
    v_mfma_f32_16x16x32_bf16 v[32:35], a[200:203], v[160:163], v[32:35]
    s_waitcnt lgkmcnt(4)
    v_accvgpr_read_b32 v224, a160
    v_accvgpr_read_b32 v225, a161
    v_mfma_f32_16x16x32_bf16 a[224:227], a[208:211], v[192:195], a[224:227]
    s_mov_b32 s30, 1966080
    ds_read_b64_tr_b16 a[200:201], v8 offset:1024
    v_accvgpr_read_b32 v226, a162
    v_mfma_f32_16x16x32_bf16 a[240:243], a[212:215], v[192:195], a[240:243]
    s_mov_b32 s31, 0x00020000
    ds_read_b64_tr_b16 a[202:203], v8 offset:7168
    v_accvgpr_read_b32 v227, a163
    v_mfma_f32_16x16x32_bf16 a[244:247], a[212:215], v[200:203], a[244:247]
    buffer_load_dwordx4 v4, s[12:15], s76 offen offset:256 lds
    v_mfma_f32_16x16x32_bf16 a[228:231], a[208:211], v[200:203], a[228:231]
    s_add_u32 m0, s49, 3072
    v_mul_f32 v224, v20, v224
    v_mul_f32 v225, v20, v225
    v_mfma_f32_16x16x32_bf16 a[232:235], a[208:211], v[208:211], a[232:235]
    s_mul_i32 s44, s47, 10
    ds_read_b64_tr_b16 a[204:205], v9 offset:1024
    v_mul_f32 v226, v20, v226
    v_mfma_f32_16x16x32_bf16 a[248:251], a[212:215], v[208:211], a[248:251]
    s_sub_u32 s44, s58, s44
    ds_read_b64_tr_b16 a[206:207], v9 offset:7168
    v_mul_f32 v227, v20, v227
    v_mfma_f32_16x16x32_bf16 a[252:255], a[212:215], v[216:219], a[252:255]
    s_lshl_b32 s62, s44, 2
    v_cvt_pk_bf16_f32 v224, v224, v225
    v_cvt_pk_bf16_f32 v225, v226, v227
    v_mfma_f32_16x16x32_bf16 a[236:239], a[208:211], v[216:219], a[236:239]
    s_waitcnt lgkmcnt(4)
    buffer_load_dwordx4 v5, s[12:15], s38 offen offset:0 lds
    v_accvgpr_read_b32 v30, a178
    v_mul_f32 v30, v20, v30
    v_accvgpr_read_b32 v31, a179
    v_mul_f32 v31, v20, v31
    v_accvgpr_read_b32 v226, a176
    v_mul_f32 v226, v20, v226
    v_accvgpr_read_b32 v227, a177
    v_mul_f32 v227, v20, v227
    v_cvt_pk_bf16_f32 v226, v226, v227
    v_cvt_pk_bf16_f32 v227, v30, v31
    v_mfma_f32_16x16x32_bf16 v[92:95], a[192:195], v[216:219], v[92:95]
    s_add_u32 m0, s49, 3968
    ds_read_b64_tr_b16 a[208:209], v10 offset:1024
    v_accvgpr_read_b32 v232, a164
    v_mfma_f32_16x16x32_bf16 v[124:127], a[196:199], v[216:219], v[124:127]
    s_add_u32 s62, s62, s3
    ds_read_b64_tr_b16 a[210:211], v10 offset:7168
    v_accvgpr_read_b32 v233, a165
    v_mfma_f32_16x16x32_bf16 v[116:119], a[196:199], v[208:211], v[116:119]
    s_lshl_b32 s62, s62, 9
    v_accvgpr_read_b32 v234, a166
    v_accvgpr_read_b32 v235, a167
    v_mfma_f32_16x16x32_bf16 v[84:87], a[192:195], v[208:211], v[84:87]
    buffer_load_dwordx4 v5, s[12:15], s38 offen offset:128 lds
    v_mfma_f32_16x16x32_bf16 v[76:79], a[192:195], v[200:203], v[76:79]
    s_add_u32 m0, s49, 4864
    ds_read_b64_tr_b16 a[212:213], v11 offset:1024
    v_mul_f32 v232, v21, v232
    v_mfma_f32_16x16x32_bf16 v[108:111], a[196:199], v[200:203], v[108:111]
    s_add_u32 s62, s62, 3670016
    ds_read_b64_tr_b16 a[214:215], v11 offset:7168
    v_mul_f32 v233, v21, v233
    v_mfma_f32_16x16x32_bf16 v[100:103], a[196:199], v[192:195], v[100:103]
    s_cmp_lt_u32 s2, 240
    s_cselect_b32 s62, s62, 0x70000000
    v_mul_f32 v234, v21, v234
    v_mfma_f32_16x16x32_bf16 v[68:71], a[192:195], v[192:195], v[68:71]
    s_waitcnt lgkmcnt(4)
    buffer_store_dwordx4 v[168:171], v28, s[20:23], s55 offen offset:1024 sc1
    v_mfma_f32_16x16x32_bf16 v[132:135], a[200:203], v[192:195], v[132:135]
    s_lshl_b32 s59, s47, 6
    ds_read_b64_tr_b16 a[192:193], v18 offset:2048
    v_mul_f32 v235, v21, v235
    v_mfma_f32_16x16x32_bf16 v[164:167], a[204:207], v[192:195], v[164:167]
    s_lshr_b32 s56, s3, 1
    ds_read_b64_tr_b16 a[194:195], v18 offset:8192
    v_cvt_pk_bf16_f32 v232, v232, v233
    v_accvgpr_read_b32 v24, a182
    v_mul_f32 v24, v21, v24
    v_accvgpr_read_b32 v25, a183
    v_mul_f32 v25, v21, v25
    v_cvt_pk_bf16_f32 v233, v234, v235
    v_accvgpr_read_b32 v234, a180
    v_mul_f32 v234, v21, v234
    v_accvgpr_read_b32 v235, a181
    v_mul_f32 v235, v21, v235
    v_cvt_pk_bf16_f32 v234, v234, v235
    v_cvt_pk_bf16_f32 v235, v24, v25
    v_mfma_f32_16x16x32_bf16 v[172:175], a[204:207], v[200:203], v[172:175]
    s_lshl_b32 s56, s56, 5
    v_accvgpr_read_b32 v240, a168
    v_accvgpr_read_b32 v241, a169
    v_mfma_f32_16x16x32_bf16 v[140:143], a[200:203], v[200:203], v[140:143]
    s_add_u32 s59, s59, s56
    v_accvgpr_read_b32 v242, a170
    v_accvgpr_read_b32 v243, a171
    v_mfma_f32_16x16x32_bf16 v[148:151], a[200:203], v[208:211], v[148:151]
    s_and_b32 s56, s3, 1
    ds_read_b64_tr_b16 a[196:197], v19 offset:2048
    v_mul_f32 v240, v22, v240
    v_mfma_f32_16x16x32_bf16 v[180:183], a[204:207], v[208:211], v[180:183]
    s_lshl_b32 s56, s56, 2
    ds_read_b64_tr_b16 a[198:199], v19 offset:8192
    v_mul_f32 v241, v22, v241
    v_mfma_f32_16x16x32_bf16 v[188:191], a[204:207], v[216:219], v[188:191]
    s_bfe_u32 s88, s72, 262144
    s_cmp_lg_u32 s88, 15
    s_cbranch_scc1 spin_o0
spin_o0_ret:
    v_mul_f32 v242, v22, v242
    v_mfma_f32_16x16x32_bf16 v[156:159], a[200:203], v[216:219], v[156:159]
    s_waitcnt lgkmcnt(4)
    buffer_load_dwordx4 v5, s[12:15], s76 offen offset:256 lds
    v_mfma_f32_16x16x32_bf16 v[220:223], a[208:211], v[216:219], v[220:223]
    s_add_u32 s59, s59, s56
    ds_read_b64_tr_b16 a[200:201], v8 offset:12288
    v_mul_f32 v243, v22, v243
    v_mfma_f32_16x16x32_bf16 v[252:255], a[212:215], v[216:219], v[252:255]
    s_mul_i32 s59, s59, 1280
    ds_read_b64_tr_b16 a[202:203], v8 offset:18432
    v_cvt_pk_bf16_f32 v240, v240, v241
    v_mfma_f32_16x16x32_bf16 v[244:247], a[212:215], v[208:211], v[244:247]
    buffer_load_dwordx4 a[0:3], v28, s[20:23], s8 offen offset:0 sc1
    v_mfma_f32_16x16x32_bf16 v[212:215], a[208:211], v[208:211], v[212:215]
    s_lshl_b32 s44, s44, 7
    v_cvt_pk_bf16_f32 v241, v242, v243
    v_accvgpr_read_b32 v242, a184
    v_accvgpr_read_b32 v26, a186
    v_mul_f32 v26, v22, v26
    v_accvgpr_read_b32 v27, a187
    v_mul_f32 v27, v22, v27
    v_mul_f32 v242, v22, v242
    v_accvgpr_read_b32 v243, a185
    v_mul_f32 v243, v22, v243
    v_cvt_pk_bf16_f32 v242, v242, v243
    v_cvt_pk_bf16_f32 v243, v26, v27
    v_mfma_f32_16x16x32_bf16 v[204:207], a[208:211], v[200:203], v[204:207]
    s_add_u32 s59, s59, s44
    ds_read_b64_tr_b16 a[204:205], v9 offset:12288
    v_accvgpr_read_b32 v248, a172
    v_mfma_f32_16x16x32_bf16 v[236:239], a[212:215], v[200:203], v[236:239]
    s_lshl_b32 s44, s3, 11
    ds_read_b64_tr_b16 a[206:207], v9 offset:18432
    v_lshrrev_b32 v29, 5, v1
    v_mfma_f32_16x16x32_bf16 v[228:231], a[212:215], v[192:195], v[228:231]
    buffer_load_dwordx4 a[4:7], v28, s[20:23], s8 offen offset:1024 sc1
    v_mfma_f32_16x16x32_bf16 v[196:199], a[208:211], v[192:195], v[196:199]
    s_waitcnt lgkmcnt(4)
    v_lshlrev_b32 v29, 3, v29
    v_bfe_u32 v6, v1, 3, 2
    v_mfma_f32_16x16x32_bf16 v[32:35], a[192:195], v[192:195], v[32:35]
    ds_read_b64_tr_b16 a[208:209], v10 offset:12288
    v_add_u32 v6, v6, v29
    v_mfma_f32_16x16x32_bf16 v[48:51], a[196:199], v[192:195], v[48:51]
    ds_read_b64_tr_b16 a[210:211], v10 offset:18432
    v_mul_u32_u24 v6, 1280, v6
    v_mfma_f32_16x16x32_bf16 v[52:55], a[196:199], v[200:203], v[52:55]
    buffer_load_dwordx4 a[8:11], v28, s[20:23], s8 offen offset:2048 sc1
    v_mfma_f32_16x16x32_bf16 v[36:39], a[192:195], v[200:203], v[36:39]
    v_lshrrev_b32 v29, 4, v1
    v_lshlrev_b32 v29, 1, v29
    v_mfma_f32_16x16x32_bf16 v[40:43], a[192:195], v[208:211], v[40:43]
    ds_read_b64_tr_b16 a[212:213], v11 offset:12288
    v_and_b32 v7, 7, v1
    v_mfma_f32_16x16x32_bf16 v[56:59], a[196:199], v[208:211], v[56:59]
    ds_read_b64_tr_b16 a[214:215], v11 offset:18432
    v_xor_b32 v7, v7, v29
    buffer_store_dwordx4 v[176:179], v28, s[20:23], s55 offen offset:2048 sc1
    v_accvgpr_read_b32 v30, a190
    v_mul_f32 v30, v23, v30
    v_accvgpr_read_b32 v31, a191
    v_mul_f32 v31, v23, v31
    v_accvgpr_read_b32 v250, a174
    v_mul_f32 v250, v23, v250
    v_accvgpr_read_b32 v251, a175
    v_mul_f32 v251, v23, v251
    v_mul_f32 v248, v23, v248
    v_accvgpr_read_b32 v249, a173
    v_mul_f32 v249, v23, v249
    v_cvt_pk_bf16_f32 v248, v248, v249
    v_cvt_pk_bf16_f32 v249, v250, v251
    v_accvgpr_read_b32 v250, a188
    v_mul_f32 v250, v23, v250
    v_accvgpr_read_b32 v251, a189
    v_mul_f32 v251, v23, v251
    v_cvt_pk_bf16_f32 v250, v250, v251
    v_cvt_pk_bf16_f32 v251, v30, v31
    v_mfma_f32_16x16x32_bf16 v[60:63], a[196:199], v[216:219], v[60:63]
    v_lshlrev_b32 v16, 4, v16
    v_lshlrev_b32 v7, 4, v7
    v_mfma_f32_16x16x32_bf16 v[44:47], a[192:195], v[216:219], v[44:47]
    s_waitcnt lgkmcnt(4)
    v_add_u32 v6, v6, v7
    v_add_u32 v7, 20480, v6
    v_mfma_f32_16x16x32_bf16 a[236:239], a[200:203], v[248:251], a[236:239]
    s_waitcnt vmcnt(13)
    ds_read_b64_tr_b16 a[192:193], v8 offset:13312
    v_add_u32 v29, 147456, v28
    v_mfma_f32_16x16x32_bf16 a[252:255], a[204:207], v[248:251], a[252:255]
    ds_read_b64_tr_b16 a[194:195], v8 offset:19456
    v_mfma_f32_16x16x32_bf16 a[248:251], a[204:207], v[240:243], a[248:251]
    buffer_atomic_or v16, v17, s[24:27], 0 offen
    v_mfma_f32_16x16x32_bf16 a[232:235], a[200:203], v[240:243], a[232:235]
    buffer_load_dwordx4 a[12:15], v28, s[20:23], s8 offen offset:3072 sc1
    v_mfma_f32_16x16x32_bf16 a[228:231], a[200:203], v[232:235], a[228:231]
    s_add_u32 s8, s8, 4096
    ds_read_b64_tr_b16 a[196:197], v9 offset:13312
    v_add_u32 v8, 24576, v12
    v_mfma_f32_16x16x32_bf16 a[244:247], a[204:207], v[232:235], a[244:247]
    ds_read_b64_tr_b16 a[198:199], v9 offset:19456
    v_mfma_f32_16x16x32_bf16 a[240:243], a[204:207], v[224:227], a[240:243]
    v_add_u32 v9, 24576, v13
    v_mfma_f32_16x16x32_bf16 a[224:227], a[200:203], v[224:227], a[224:227]
    s_waitcnt lgkmcnt(4)
    buffer_store_dwordx4 v[184:187], v28, s[20:23], s55 offen offset:3072 sc1
    v_mfma_f32_16x16x32_bf16 v[68:71], a[208:211], v[224:227], v[68:71]
    s_add_u32 s55, s55, 12288
    ds_read_b64_tr_b16 a[200:201], v10 offset:13312
    s_mov_b32 s16, s64
    v_mfma_f32_16x16x32_bf16 v[100:103], a[212:215], v[224:227], v[100:103]
    s_and_b32 s17, s65, 0xffff
    ds_read_b64_tr_b16 a[202:203], v10 offset:19456
    s_mov_b32 s18, 2621440
    v_mfma_f32_16x16x32_bf16 v[108:111], a[212:215], v[232:235], v[108:111]
    s_mov_b32 s19, 0x00020000
    v_add_u32 v10, 24576, v14
    s_lshl_b32 s45, s52, 4
    v_mfma_f32_16x16x32_bf16 v[76:79], a[208:211], v[232:235], v[76:79]
    s_lshl_b32 s56, s53, 1
    s_add_u32 s45, s45, s56
    s_and_b32 s56, s3, 1
    v_mfma_f32_16x16x32_bf16 v[84:87], a[208:211], v[240:243], v[84:87]
    s_add_u32 s45, s45, s56
    ds_read_b64_tr_b16 a[204:205], v11 offset:13312
    s_lshl_b32 s56, s45, 4
    v_mfma_f32_16x16x32_bf16 v[116:119], a[212:215], v[240:243], v[116:119]
    ds_read_b64_tr_b16 a[206:207], v11 offset:19456
    v_and_b32 v20, 15, v1
    v_mfma_f32_16x16x32_bf16 v[124:127], a[212:215], v[248:251], v[124:127]
    buffer_load_dwordx4 a[16:19], v28, s[20:23], s9 offen offset:0 sc1
    v_mfma_f32_16x16x32_bf16 v[92:95], a[208:211], v[248:251], v[92:95]
    s_waitcnt lgkmcnt(4)
    v_add_u32 v20, s56, v20
    v_bfe_u32 v21, v1, 4, 1
    v_mfma_f32_16x16x32_bf16 v[156:159], a[192:195], v[248:251], v[156:159]
    ds_read_b64_tr_b16 a[208:209], v18 offset:14336
    v_bfe_u32 v22, v1, 5, 1
    v_mfma_f32_16x16x32_bf16 v[188:191], a[196:199], v[248:251], v[188:191]
    ds_read_b64_tr_b16 a[210:211], v18 offset:20480
    v_lshl_add_u32 v21, v21, 1, v22
    v_mfma_f32_16x16x32_bf16 v[180:183], a[196:199], v[240:243], v[180:183]
    buffer_store_dwordx4 v[192:195], v28, s[20:23], s55 offen offset:0 sc1
    v_mfma_f32_16x16x32_bf16 v[148:151], a[192:195], v[240:243], v[148:151]
    v_mul_u32_u24 v22, 1280, v20
    v_lshl_add_u32 v22, v21, 4, v22
    v_mfma_f32_16x16x32_bf16 v[140:143], a[192:195], v[232:235], v[140:143]
    ds_read_b64_tr_b16 a[212:213], v19 offset:14336
    v_lshlrev_b32 v23, 3, v20
    v_mfma_f32_16x16x32_bf16 v[172:175], a[196:199], v[232:235], v[172:175]
    s_waitcnt vmcnt(49)
    ds_read_b64_tr_b16 a[214:215], v19 offset:20480
    v_add_u32 v11, 24576, v15
    v_mfma_f32_16x16x32_bf16 v[164:167], a[196:199], v[224:227], v[164:167]
    s_barrier
    v_mfma_f32_16x16x32_bf16 v[132:135], a[192:195], v[224:227], v[132:135]
    s_waitcnt lgkmcnt(4)
    buffer_load_dwordx4 a[20:23], v28, s[20:23], s9 offen offset:1024 sc1
    v_mfma_f32_16x16x32_bf16 v[196:199], a[200:203], v[224:227], v[196:199]
    s_mul_i32 s56, s51, 5
    ds_read_b64_tr_b16 a[192:193], v8 offset:0
    v_xor_b32 v18, s39, v8
    v_mfma_f32_16x16x32_bf16 v[228:231], a[204:207], v[224:227], v[228:231]
    s_lshr_b32 s6, s3, 1
    ds_read_b64_tr_b16 a[194:195], v8 offset:6144
    v_xor_b32 v19, s39, v9
    v_mfma_f32_16x16x32_bf16 v[236:239], a[204:207], v[232:235], v[236:239]
    buffer_load_dwordx4 a[24:27], v28, s[20:23], s9 offen offset:2048 sc1
    v_mfma_f32_16x16x32_bf16 v[204:207], a[200:203], v[232:235], v[204:207]
    s_add_u32 s41, s56, s6
    s_add_u32 s42, s56, 2
    s_add_u32 s43, s56, 4
    v_mfma_f32_16x16x32_bf16 v[212:215], a[200:203], v[240:243], v[212:215]
    s_sub_u32 s43, s43, s6
    ds_read_b64_tr_b16 a[196:197], v9 offset:0
    s_lshr_b32 s48, s45, 2
    v_mfma_f32_16x16x32_bf16 v[244:247], a[204:207], v[240:243], v[244:247]
    s_lshr_b32 s56, s48, 1
    ds_read_b64_tr_b16 a[198:199], v9 offset:6144
    s_lshl_b32 s56, s56, 19
    v_mfma_f32_16x16x32_bf16 v[252:255], a[204:207], v[248:251], v[252:255]
    buffer_load_dwordx4 a[28:31], v28, s[20:23], s9 offen offset:3072 sc1
    v_mfma_f32_16x16x32_bf16 v[220:223], a[200:203], v[248:251], v[220:223]
    s_waitcnt lgkmcnt(4)
    s_add_u32 s9, s9, 4096
    s_and_b32 s40, s48, 1
    v_mfma_f32_16x16x32_bf16 v[44:47], a[208:211], v[248:251], v[44:47]
    s_lshl_b32 s40, s40, 12
    ds_read_b64_tr_b16 a[200:201], v10 offset:0
    s_or_b32 s56, s56, s40
    v_mfma_f32_16x16x32_bf16 v[60:63], a[212:215], v[248:251], v[60:63]
    s_lshl_b32 s40, s48, 10
    ds_read_b64_tr_b16 a[202:203], v10 offset:6144
    s_and_b32 s40, s40, 0x2000
    v_mfma_f32_16x16x32_bf16 v[56:59], a[212:215], v[240:243], v[56:59]
    buffer_store_dwordx4 v[200:203], v28, s[20:23], s55 offen offset:1024 sc1
    v_mfma_f32_16x16x32_bf16 v[40:43], a[208:211], v[240:243], v[40:43]
    s_or_b32 s56, s56, s40
    s_or_b32 s56, s56, 134217728
    s_and_b32 s45, s45, 3
    v_mfma_f32_16x16x32_bf16 v[36:39], a[208:211], v[232:235], v[36:39]
    s_lshl_b32 s45, s45, 10
    ds_read_b64_tr_b16 a[204:205], v11 offset:0
    s_add_u32 s45, s45, s56
    v_mfma_f32_16x16x32_bf16 v[52:55], a[212:215], v[232:235], v[52:55]
    s_waitcnt vmcnt(7)
    ds_read_b64_tr_b16 a[206:207], v11 offset:6144
    s_lshl_b32 s47, s41, 14
    v_mfma_f32_16x16x32_bf16 v[48:51], a[212:215], v[224:227], v[48:51]
    s_add_u32 s47, s47, s45
    s_sub_u32 s41, s41, s51
    s_lshl_b32 s48, s42, 14
    v_mfma_f32_16x16x32_bf16 v[32:35], a[208:211], v[224:227], v[32:35]
    s_waitcnt lgkmcnt(4)
    buffer_load_dwordx4 a[32:35], v28, s[20:23], s10 offen offset:0 sc1
    v_mfma_f32_16x16x32_bf16 a[224:227], a[192:195], a[0:3], a[224:227]
    s_load_dword s72, s[86:87], s5 offset:4 glc
    ds_read_b64_tr_b16 a[208:209], v8 offset:1024
    s_add_u32 s48, s48, s45
    v_mfma_f32_16x16x32_bf16 a[240:243], a[196:199], a[0:3], a[240:243]
pg_9:
    s_cbranch_execz pg_13
    s_sub_u32 s42, s42, s51
    ds_read_b64_tr_b16 a[210:211], v8 offset:7168
    s_lshl_b32 s40, s43, 14
    v_mfma_f32_16x16x32_bf16 a[244:247], a[196:199], a[4:7], a[244:247]
    s_add_u32 s40, s40, s45
    ds_read_b128 v[64:67], v29 offset:0
    s_sub_u32 s43, s43, s51
    v_mfma_f32_16x16x32_bf16 a[228:231], a[192:195], a[4:7], a[228:231]
    s_add_u32 s56, s51, 16
    ds_read_b128 v[72:75], v29 offset:1024
    s_cmp_lt_u32 s3, 2
    s_cselect_b32 s43, s56, s43
    v_mfma_f32_16x16x32_bf16 a[232:235], a[192:195], a[8:11], a[232:235]
    s_lshl_b32 s41, s41, 6
    ds_read_b64_tr_b16 a[212:213], v9 offset:1024
    s_lshl_b32 s42, s42, 6
    v_mfma_f32_16x16x32_bf16 a[248:251], a[196:199], a[8:11], a[248:251]
    s_lshl_b32 s43, s43, 6
    ds_read_b64_tr_b16 a[214:215], v9 offset:7168
    v_add_u32 v23, 3211264, v23
    v_mfma_f32_16x16x32_bf16 a[252:255], a[196:199], a[12:15], a[252:255]
    ds_read_b128 v[80:83], v29 offset:2048
    v_mfma_f32_16x16x32_bf16 a[236:239], a[192:195], a[12:15], a[236:239]
    s_waitcnt lgkmcnt(4)
    buffer_store_dwordx4 v[208:211], v28, s[20:23], s55 offen offset:2048 sc1
    v_mfma_f32_16x16x32_bf16 v[92:95], a[200:203], a[12:15], v[92:95]
    ds_read_b64_tr_b16 a[192:193], v10 offset:1024
    v_mfma_f32_16x16x32_bf16 v[124:127], a[204:207], a[12:15], v[124:127]
    ds_read_b64_tr_b16 a[194:195], v10 offset:7168
    v_mfma_f32_16x16x32_bf16 v[116:119], a[204:207], a[8:11], v[116:119]
    ds_read_b128 v[88:91], v29 offset:3072
    v_mfma_f32_16x16x32_bf16 v[84:87], a[200:203], a[8:11], v[84:87]
    ds_read_b128 v[96:99], v29 offset:4096
    v_mfma_f32_16x16x32_bf16 v[76:79], a[200:203], a[4:7], v[76:79]
    ds_read_b64_tr_b16 a[196:197], v11 offset:1024
    v_mfma_f32_16x16x32_bf16 v[108:111], a[204:207], a[4:7], v[108:111]
    ds_read_b64_tr_b16 a[198:199], v11 offset:7168
    v_mfma_f32_16x16x32_bf16 v[100:103], a[204:207], a[0:3], v[100:103]
    ds_read_b128 v[104:107], v29 offset:5120
    v_mfma_f32_16x16x32_bf16 v[68:71], a[200:203], a[0:3], v[68:71]
    s_waitcnt lgkmcnt(4)
    buffer_load_dwordx4 a[36:39], v28, s[20:23], s10 offen offset:1024 sc1
    v_mfma_f32_16x16x32_bf16 v[132:135], a[208:211], a[0:3], v[132:135]
    ds_read_b64_tr_b16 a[200:201], v18 offset:2048
    v_lshlrev_b32 v16, 4, v16
    v_mfma_f32_16x16x32_bf16 v[164:167], a[212:215], a[0:3], v[164:167]
    s_waitcnt vmcnt(9)
    ds_read_b64_tr_b16 a[202:203], v18 offset:8192
    v_mfma_f32_16x16x32_bf16 v[172:175], a[212:215], a[4:7], v[172:175]
    ds_read_b128 v[112:115], v29 offset:6144
    v_mfma_f32_16x16x32_bf16 v[140:143], a[208:211], a[4:7], v[140:143]
    ds_read_b128 v[120:123], v29 offset:7168
    v_mfma_f32_16x16x32_bf16 v[148:151], a[208:211], a[8:11], v[148:151]
    ds_read_b64_tr_b16 a[204:205], v19 offset:2048
    v_mfma_f32_16x16x32_bf16 v[180:183], a[212:215], a[8:11], v[180:183]
    ds_read_b64_tr_b16 a[206:207], v19 offset:8192
    v_mfma_f32_16x16x32_bf16 v[188:191], a[212:215], a[12:15], v[188:191]
    ds_read_b128 v[128:131], v29 offset:8192
    v_mfma_f32_16x16x32_bf16 v[156:159], a[208:211], a[12:15], v[156:159]
    s_waitcnt lgkmcnt(4)
    buffer_atomic_or v16, v17, s[24:27], 0 offen
    v_mfma_f32_16x16x32_bf16 v[220:223], a[192:195], a[12:15], v[220:223]
    ds_read_b64_tr_b16 a[208:209], v8 offset:12288
    v_mfma_f32_16x16x32_bf16 v[252:255], a[196:199], a[12:15], v[252:255]
    ds_read_b64_tr_b16 a[210:211], v8 offset:18432
    v_mfma_f32_16x16x32_bf16 v[244:247], a[196:199], a[8:11], v[244:247]
    ds_read_b128 v[136:139], v29 offset:9216
    v_mfma_f32_16x16x32_bf16 v[212:215], a[192:195], a[8:11], v[212:215]
    buffer_store_dwordx4 v[216:219], v28, s[20:23], s55 offen offset:3072 sc1
    v_mfma_f32_16x16x32_bf16 v[204:207], a[192:195], a[4:7], v[204:207]
    s_add_u32 s55, s55, 4096
    ds_read_b64_tr_b16 a[212:213], v9 offset:12288
    v_mfma_f32_16x16x32_bf16 v[236:239], a[196:199], a[4:7], v[236:239]
    ds_read_b64_tr_b16 a[214:215], v9 offset:18432
    v_mfma_f32_16x16x32_bf16 v[228:231], a[196:199], a[0:3], v[228:231]
    buffer_load_dwordx4 a[40:43], v28, s[20:23], s10 offen offset:2048 sc1
    v_mfma_f32_16x16x32_bf16 v[196:199], a[192:195], a[0:3], v[196:199]
    s_waitcnt lgkmcnt(4)
    v_mfma_f32_16x16x32_bf16 v[32:35], a[200:203], a[0:3], v[32:35]
    ds_read_b64_tr_b16 a[192:193], v10 offset:12288
    v_mfma_f32_16x16x32_bf16 v[48:51], a[204:207], a[0:3], v[48:51]
    ds_read_b64_tr_b16 a[194:195], v10 offset:18432
    v_mfma_f32_16x16x32_bf16 v[52:55], a[204:207], a[4:7], v[52:55]
    s_bfe_u32 s88, s72, 262148
    s_cmp_lg_u32 s88, 15
    s_cbranch_scc1 spin_o1
spin_o1_ret:
    v_mfma_f32_16x16x32_bf16 v[36:39], a[200:203], a[4:7], v[36:39]
    buffer_load_dwordx4 a[44:47], v28, s[20:23], s10 offen offset:3072 sc1
    v_mfma_f32_16x16x32_bf16 v[40:43], a[200:203], a[8:11], v[40:43]
    s_add_u32 s10, s10, 4096
    ds_read_b64_tr_b16 a[196:197], v11 offset:12288
    v_mfma_f32_16x16x32_bf16 v[56:59], a[204:207], a[8:11], v[56:59]
    s_waitcnt vmcnt(8)
    ds_read_b64_tr_b16 a[198:199], v11 offset:18432
    v_mfma_f32_16x16x32_bf16 v[60:63], a[204:207], a[12:15], v[60:63]
    buffer_load_dwordx4 a[48:51], v28, s[20:23], s8 offen offset:0 sc1
    v_mfma_f32_16x16x32_bf16 v[44:47], a[200:203], a[12:15], v[44:47]
    s_waitcnt lgkmcnt(4)
    v_mfma_f32_16x16x32_bf16 a[236:239], a[208:211], a[28:31], a[236:239]
    ds_read_b64_tr_b16 a[200:201], v8 offset:13312
    v_mfma_f32_16x16x32_bf16 a[252:255], a[212:215], a[28:31], a[252:255]
    ds_read_b64_tr_b16 a[202:203], v8 offset:19456
    v_mfma_f32_16x16x32_bf16 a[248:251], a[212:215], a[24:27], a[248:251]
    v_add_u32 v8, 73728, v12
    v_mfma_f32_16x16x32_bf16 a[232:235], a[208:211], a[24:27], a[232:235]
    buffer_load_dwordx4 a[52:55], v28, s[20:23], s8 offen offset:1024 sc1
    v_mfma_f32_16x16x32_bf16 a[228:231], a[208:211], a[20:23], a[228:231]
    ds_read_b64_tr_b16 a[204:205], v9 offset:13312
    v_add_f32 v64, v64, v72
    buffer_store_dwordx4 v[224:227], v28, s[20:23], s55 offen offset:0 sc1
    v_mfma_f32_16x16x32_bf16 a[244:247], a[212:215], a[20:23], a[244:247]
    ds_read_b64_tr_b16 a[206:207], v9 offset:19456
    v_add_f32 v65, v65, v73
    v_mfma_f32_16x16x32_bf16 a[240:243], a[212:215], a[16:19], a[240:243]
    v_add_f32 v66, v66, v74
    v_add_f32 v67, v67, v75
    v_mfma_f32_16x16x32_bf16 a[224:227], a[208:211], a[16:19], a[224:227]
    s_waitcnt lgkmcnt(4)
    v_add_f32 v64, v64, v80
    v_add_f32 v65, v65, v81
    v_mfma_f32_16x16x32_bf16 v[68:71], a[192:195], a[16:19], v[68:71]
    ds_read_b64_tr_b16 a[208:209], v10 offset:13312
    v_add_f32 v66, v66, v82
    v_mfma_f32_16x16x32_bf16 v[100:103], a[196:199], a[16:19], v[100:103]
    ds_read_b64_tr_b16 a[210:211], v10 offset:19456
    v_add_f32 v67, v67, v83
    v_mfma_f32_16x16x32_bf16 v[108:111], a[196:199], a[20:23], v[108:111]
    v_add_f32 v64, v64, v88
    v_add_f32 v65, v65, v89
    v_mfma_f32_16x16x32_bf16 v[76:79], a[192:195], a[20:23], v[76:79]
    buffer_load_dwordx4 a[56:59], v28, s[20:23], s8 offen offset:2048 sc1
    v_mfma_f32_16x16x32_bf16 v[84:87], a[192:195], a[24:27], v[84:87]
    ds_read_b64_tr_b16 a[212:213], v11 offset:13312
    v_add_f32 v66, v66, v90
    v_mfma_f32_16x16x32_bf16 v[116:119], a[196:199], a[24:27], v[116:119]
    ds_read_b64_tr_b16 a[214:215], v11 offset:19456
    v_add_f32 v67, v67, v91
    v_mfma_f32_16x16x32_bf16 v[124:127], a[196:199], a[28:31], v[124:127]
    v_add_f32 v64, v64, v96
    v_add_f32 v65, v65, v97
    v_mfma_f32_16x16x32_bf16 v[92:95], a[192:195], a[28:31], v[92:95]
    s_waitcnt lgkmcnt(4)
    v_add_f32 v66, v66, v98
    v_add_f32 v67, v67, v99
    v_mfma_f32_16x16x32_bf16 v[156:159], a[200:203], a[28:31], v[156:159]
    ds_read_b64_tr_b16 a[192:193], v18 offset:14336
    v_add_f32 v64, v64, v104
    v_mfma_f32_16x16x32_bf16 v[188:191], a[204:207], a[28:31], v[188:191]
    ds_read_b64_tr_b16 a[194:195], v18 offset:20480
    v_add_f32 v65, v65, v105
    v_mfma_f32_16x16x32_bf16 v[180:183], a[204:207], a[24:27], v[180:183]
    buffer_load_dwordx4 a[60:63], v28, s[20:23], s8 offen offset:3072 sc1
    v_mfma_f32_16x16x32_bf16 v[148:151], a[200:203], a[24:27], v[148:151]
    s_add_u32 s8, s8, 12288
    v_add_f32 v66, v66, v106
    v_add_f32 v67, v67, v107
    buffer_store_dwordx4 v[232:235], v28, s[20:23], s55 offen offset:1024 sc1
    v_mfma_f32_16x16x32_bf16 v[140:143], a[200:203], a[20:23], v[140:143]
    ds_read_b64_tr_b16 a[196:197], v19 offset:14336
    v_add_f32 v64, v64, v112
    v_mfma_f32_16x16x32_bf16 v[172:175], a[204:207], a[20:23], v[172:175]
    s_waitcnt vmcnt(56)
    ds_read_b64_tr_b16 a[198:199], v19 offset:20480
    v_add_f32 v65, v65, v113
    v_mfma_f32_16x16x32_bf16 v[164:167], a[204:207], a[16:19], v[164:167]
    s_barrier
    v_mfma_f32_16x16x32_bf16 v[132:135], a[200:203], a[16:19], v[132:135]
    s_waitcnt lgkmcnt(4)
    v_add_f32 v66, v66, v114
    v_add_f32 v67, v67, v115
    v_mfma_f32_16x16x32_bf16 v[196:199], a[208:211], a[16:19], v[196:199]
    ds_read_b64_tr_b16 a[200:201], v8 offset:0
    v_add_f32 v64, v64, v120
    v_mfma_f32_16x16x32_bf16 v[228:231], a[212:215], a[16:19], v[228:231]
    ds_read_b64_tr_b16 a[202:203], v8 offset:6144
    v_add_f32 v65, v65, v121
    v_mfma_f32_16x16x32_bf16 v[236:239], a[212:215], a[20:23], v[236:239]
    buffer_store_dwordx4 v[240:243], v28, s[20:23], s55 offen offset:2048 sc1
    v_mfma_f32_16x16x32_bf16 v[204:207], a[208:211], a[20:23], v[204:207]
    v_add_f32 v66, v66, v122
    v_add_f32 v67, v67, v123
    v_add_u32 v9, 73728, v13
    v_mfma_f32_16x16x32_bf16 v[212:215], a[208:211], a[24:27], v[212:215]
    ds_read_b64_tr_b16 a[204:205], v9 offset:0
    v_add_f32 v64, v64, v128
    v_mfma_f32_16x16x32_bf16 v[244:247], a[212:215], a[24:27], v[244:247]
    ds_read_b64_tr_b16 a[206:207], v9 offset:6144
    v_add_f32 v65, v65, v129
    v_mfma_f32_16x16x32_bf16 v[252:255], a[212:215], a[28:31], v[252:255]
    buffer_load_dwordx4 a[64:67], v28, s[20:23], s9 offen offset:0 sc1
    v_mfma_f32_16x16x32_bf16 v[220:223], a[208:211], a[28:31], v[220:223]
    s_waitcnt lgkmcnt(4)
    v_add_f32 v66, v66, v130
    v_add_f32 v67, v67, v131
    v_add_u32 v10, 73728, v14
    v_mfma_f32_16x16x32_bf16 v[44:47], a[192:195], a[28:31], v[44:47]
    s_load_dword s72, s[86:87], s5 offset:4 glc
    ds_read_b64_tr_b16 a[208:209], v10 offset:0
    v_add_f32 v64, v64, v136
    v_mfma_f32_16x16x32_bf16 v[60:63], a[196:199], a[28:31], v[60:63]
    ds_read_b64_tr_b16 a[210:211], v10 offset:6144
    v_add_f32 v65, v65, v137
    v_mfma_f32_16x16x32_bf16 v[56:59], a[196:199], a[24:27], v[56:59]
    buffer_load_dwordx4 a[68:71], v28, s[20:23], s9 offen offset:1024 sc1
    v_mfma_f32_16x16x32_bf16 v[40:43], a[192:195], a[24:27], v[40:43]
    v_lshlrev_b32 v16, 4, v16
    v_add_f32 v66, v66, v138
    v_add_u32 v11, 73728, v15
    v_mfma_f32_16x16x32_bf16 v[36:39], a[192:195], a[20:23], v[36:39]
    s_waitcnt vmcnt(11)
    ds_read_b64_tr_b16 a[212:213], v11 offset:0
    v_add_f32 v67, v67, v139
    v_mfma_f32_16x16x32_bf16 v[52:55], a[196:199], a[20:23], v[52:55]
    s_waitcnt vmcnt(9)
    ds_read_b64_tr_b16 a[214:215], v11 offset:6144
    v_cvt_pk_bf16_f32 v64, v64, v64
    v_mfma_f32_16x16x32_bf16 v[48:51], a[196:199], a[16:19], v[48:51]
    buffer_atomic_or v16, v17, s[24:27], 0 offen
    v_mfma_f32_16x16x32_bf16 v[32:35], a[192:195], a[16:19], v[32:35]
    s_waitcnt lgkmcnt(4)
    buffer_load_dwordx4 a[72:75], v28, s[20:23], s9 offen offset:2048 sc1
    v_mfma_f32_16x16x32_bf16 a[224:227], a[200:203], a[32:35], a[224:227]
    ds_read_b64_tr_b16 a[192:193], v8 offset:1024
    v_and_b32 v64, 0xffff0000, v64
    v_mfma_f32_16x16x32_bf16 a[240:243], a[204:207], a[32:35], a[240:243]
    ds_read_b64_tr_b16 a[194:195], v8 offset:7168
    v_cvt_pk_bf16_f32 v65, v65, v65
    v_mfma_f32_16x16x32_bf16 a[244:247], a[204:207], a[36:39], a[244:247]
    buffer_store_dwordx4 v[248:251], v28, s[20:23], s55 offen offset:3072 sc1
    v_mfma_f32_16x16x32_bf16 a[228:231], a[200:203], a[36:39], a[228:231]
    s_add_u32 s55, s55, 12288
    v_and_b32 v65, 0xffff0000, v65
    v_cvt_pk_bf16_f32 v66, v66, v66
    v_mfma_f32_16x16x32_bf16 a[232:235], a[200:203], a[40:43], a[232:235]
    ds_read_b64_tr_b16 a[196:197], v9 offset:1024
    v_and_b32 v66, 0xffff0000, v66
    v_mfma_f32_16x16x32_bf16 a[248:251], a[204:207], a[40:43], a[248:251]
    ds_read_b64_tr_b16 a[198:199], v9 offset:7168
    v_cvt_pk_bf16_f32 v67, v67, v67
    v_mfma_f32_16x16x32_bf16 a[252:255], a[204:207], a[44:47], a[252:255]
    v_and_b32 v67, 0xffff0000, v67
    v_mul_f32 v72, s92, v64
    v_mfma_f32_16x16x32_bf16 a[236:239], a[200:203], a[44:47], a[236:239]
    s_waitcnt lgkmcnt(4)
    buffer_load_dwordx4 a[76:79], v28, s[20:23], s9 offen offset:3072 sc1
    v_mfma_f32_16x16x32_bf16 v[92:95], a[208:211], a[44:47], v[92:95]
    s_add_u32 s9, s9, 12288
    ds_read_b64_tr_b16 a[200:201], v10 offset:1024
    v_xor_b32 v18, s39, v8
    v_mfma_f32_16x16x32_bf16 v[124:127], a[212:215], a[44:47], v[124:127]
    ds_read_b64_tr_b16 a[202:203], v10 offset:7168
    v_xor_b32 v19, s39, v9
    v_mfma_f32_16x16x32_bf16 v[116:119], a[212:215], a[40:43], v[116:119]
    v_exp_f32 v72, v72
    v_mfma_f32_16x16x32_bf16 v[84:87], a[208:211], a[40:43], v[84:87]
    buffer_load_dwordx4 a[80:83], v28, s[20:23], s10 offen offset:0 sc1
    v_mfma_f32_16x16x32_bf16 v[76:79], a[208:211], a[36:39], v[76:79]
    ds_read_b64_tr_b16 a[204:205], v11 offset:1024
    v_add_f32 v72, 1.0, v72
    v_mfma_f32_16x16x32_bf16 v[108:111], a[212:215], a[36:39], v[108:111]
    ds_read_b64_tr_b16 a[206:207], v11 offset:7168
    v_mfma_f32_16x16x32_bf16 v[100:103], a[212:215], a[32:35], v[100:103]
    v_rcp_f32 v72, v72
    v_mfma_f32_16x16x32_bf16 v[68:71], a[208:211], a[32:35], v[68:71]
    s_waitcnt lgkmcnt(4)
    buffer_load_dwordx4 a[84:87], v28, s[20:23], s10 offen offset:1024 sc1
    v_mfma_f32_16x16x32_bf16 v[132:135], a[192:195], a[32:35], v[132:135]
    ds_read_b64_tr_b16 a[208:209], v18 offset:2048
    v_mul_f32 v64, v64, v72
    v_mfma_f32_16x16x32_bf16 v[164:167], a[196:199], a[32:35], v[164:167]
    ds_read_b64_tr_b16 a[210:211], v18 offset:8192
    v_cvt_pk_bf16_f32 v64, v64, v64
    v_mfma_f32_16x16x32_bf16 v[172:175], a[196:199], a[36:39], v[172:175]
    v_and_b32 v64, 0xffff0000, v64
    v_mul_f32 v64, v64, v66
    v_mfma_f32_16x16x32_bf16 v[140:143], a[192:195], a[36:39], v[140:143]
    v_mul_f32 v73, s92, v65
    v_mfma_f32_16x16x32_bf16 v[148:151], a[192:195], a[40:43], v[148:151]
    ds_read_b64_tr_b16 a[212:213], v19 offset:2048
    v_mfma_f32_16x16x32_bf16 v[180:183], a[196:199], a[40:43], v[180:183]
    ds_read_b64_tr_b16 a[214:215], v19 offset:8192
    v_mfma_f32_16x16x32_bf16 v[188:191], a[196:199], a[44:47], v[188:191]
    buffer_load_dwordx4 a[88:91], v28, s[20:23], s10 offen offset:2048 sc1
    v_mfma_f32_16x16x32_bf16 v[156:159], a[192:195], a[44:47], v[156:159]
    s_waitcnt lgkmcnt(4)
    v_exp_f32 v73, v73
    v_mfma_f32_16x16x32_bf16 v[220:223], a[200:203], a[44:47], v[220:223]
    ds_read_b64_tr_b16 a[192:193], v8 offset:12288
    v_add_f32 v73, 1.0, v73
    v_mfma_f32_16x16x32_bf16 v[252:255], a[204:207], a[44:47], v[252:255]
    ds_read_b64_tr_b16 a[194:195], v8 offset:18432
    v_cmp_lt_u32 s[78:79], 31, v1
    v_mfma_f32_16x16x32_bf16 v[244:247], a[204:207], a[40:43], v[244:247]
    s_bfe_u32 s88, s72, 262152
    s_cmp_lg_u32 s88, 15
    s_cbranch_scc1 spin_o2
spin_o2_ret:
    v_mov_b32 v195, s70
    v_mfma_f32_16x16x32_bf16 v[212:215], a[200:203], a[40:43], v[212:215]
    buffer_load_dwordx4 a[92:95], v28, s[20:23], s10 offen offset:3072 sc1
    v_mfma_f32_16x16x32_bf16 v[204:207], a[200:203], a[36:39], v[204:207]
    s_add_u32 s10, s10, 12288
    ds_read_b64_tr_b16 a[196:197], v9 offset:12288
    v_mov_b32 v192, s71
    v_mfma_f32_16x16x32_bf16 v[236:239], a[204:207], a[36:39], v[236:239]
    ds_read_b64_tr_b16 a[198:199], v9 offset:18432
    v_cndmask_b32 v195, v195, v192, s[78:79]
    v_mfma_f32_16x16x32_bf16 v[228:231], a[204:207], a[32:35], v[228:231]
    buffer_load_dwordx4 a[96:99], v28, s[20:23], s8 offen offset:0 sc1
    v_mfma_f32_16x16x32_bf16 v[196:199], a[200:203], a[32:35], v[196:199]
    s_waitcnt lgkmcnt(4)
    v_rcp_f32 v73, v73
    v_mfma_f32_16x16x32_bf16 v[32:35], a[208:211], a[32:35], v[32:35]
    ds_read_b64_tr_b16 a[200:201], v10 offset:12288
    v_mul_f32 v65, v65, v73
    v_mfma_f32_16x16x32_bf16 v[48:51], a[212:215], a[32:35], v[48:51]
    ds_read_b64_tr_b16 a[202:203], v10 offset:18432
    v_cvt_pk_bf16_f32 v65, v65, v65
    v_mfma_f32_16x16x32_bf16 v[52:55], a[212:215], a[36:39], v[52:55]
    buffer_load_dwordx4 a[100:103], v28, s[20:23], s8 offen offset:1024 sc1
    v_mfma_f32_16x16x32_bf16 v[36:39], a[208:211], a[36:39], v[36:39]
    v_and_b32 v65, 0xffff0000, v65
    v_mul_f32 v65, v65, v67
    v_mfma_f32_16x16x32_bf16 v[40:43], a[208:211], a[40:43], v[40:43]
    ds_read_b64_tr_b16 a[204:205], v11 offset:12288
    v_cvt_pk_bf16_f32 v64, v64, v65
    v_mfma_f32_16x16x32_bf16 v[56:59], a[212:215], a[40:43], v[56:59]
    s_waitcnt vmcnt(14)
    ds_read_b64_tr_b16 a[206:207], v11 offset:18432
    v_bfe_u32 v194, v1, 3, 2
    v_mfma_f32_16x16x32_bf16 v[60:63], a[212:215], a[44:47], v[60:63]
    buffer_load_dwordx4 a[104:107], v28, s[20:23], s8 offen offset:2048 sc1
    v_mfma_f32_16x16x32_bf16 v[44:47], a[208:211], a[44:47], v[44:47]
    s_waitcnt lgkmcnt(4)
    v_mov_b32 v192, s41
    v_mov_b32 v193, s42
    v_mfma_f32_16x16x32_bf16 a[236:239], a[192:195], a[60:63], a[236:239]
    s_lshl_b32 s61, s3, 8
    ds_read_b64_tr_b16 a[208:209], v8 offset:13312
    v_cmp_eq_u32 s[78:79], 1, v194
    v_mfma_f32_16x16x32_bf16 a[252:255], a[196:199], a[60:63], a[252:255]
    s_add_u32 s61, s61, 157696
    ds_read_b64_tr_b16 a[210:211], v8 offset:19456
    v_lshlrev_b32 v80, 1, v1
    v_mfma_f32_16x16x32_bf16 a[248:251], a[196:199], a[56:59], a[248:251]
    v_add_u32 v80, s61, v80
    v_and_b32 v81, 1, v1
    v_mfma_f32_16x16x32_bf16 a[232:235], a[192:195], a[56:59], a[232:235]
    buffer_load_dwordx4 a[108:111], v28, s[20:23], s8 offen offset:3072 sc1
    v_mfma_f32_16x16x32_bf16 a[228:231], a[192:195], a[52:55], a[228:231]
    s_add_u32 s8, s8, 4096
    ds_read_b64_tr_b16 a[212:213], v9 offset:13312
    v_lshlrev_b32 v81, 7, v81
    v_mfma_f32_16x16x32_bf16 a[244:247], a[196:199], a[52:55], a[244:247]
    s_add_u32 m0, s44, 147456
    ds_read_b64_tr_b16 a[214:215], v9 offset:19456
    v_lshrrev_b32 v83, 4, v1
    v_mfma_f32_16x16x32_bf16 a[240:243], a[196:199], a[48:51], a[240:243]
    v_lshl_add_u32 v81, v83, 4, v81
    v_add_u32 v81, s61, v81
    v_mfma_f32_16x16x32_bf16 a[224:227], a[192:195], a[48:51], a[224:227]
    s_waitcnt lgkmcnt(4)
    buffer_load_dwordx4 v6, s[28:31], s59 offen lds
    v_mfma_f32_16x16x32_bf16 v[68:71], a[200:203], a[48:51], v[68:71]
    s_add_u32 m0, s44, 148480
    ds_read_b64_tr_b16 a[192:193], v10 offset:13312
    v_bfe_u32 v83, v1, 2, 3
    v_mfma_f32_16x16x32_bf16 v[100:103], a[204:207], a[48:51], v[100:103]
    ds_read_b64_tr_b16 a[194:195], v10 offset:19456
    v_lshlrev_b32 v82, 7, v83
    v_mfma_f32_16x16x32_bf16 v[108:111], a[204:207], a[52:55], v[108:111]
    v_lshrrev_b32 v83, 1, v83
    v_xor_b32 v83, s3, v83
    v_mfma_f32_16x16x32_bf16 v[76:79], a[200:203], a[52:55], v[76:79]
    buffer_load_dwordx4 v7, s[28:31], s59 offen lds
    v_mfma_f32_16x16x32_bf16 v[84:87], a[200:203], a[56:59], v[84:87]
    ds_read_b64_tr_b16 a[196:197], v11 offset:13312
    v_lshlrev_b32 v16, 4, v16
    v_mfma_f32_16x16x32_bf16 v[116:119], a[204:207], a[56:59], v[116:119]
    s_waitcnt vmcnt(11)
    ds_read_b64_tr_b16 a[198:199], v11 offset:19456
    v_lshl_add_u32 v82, v83, 5, v82
    v_mfma_f32_16x16x32_bf16 v[124:127], a[204:207], a[60:63], v[124:127]
    buffer_atomic_or v16, v17, s[24:27], 0 offen
    v_mfma_f32_16x16x32_bf16 v[92:95], a[200:203], a[60:63], v[92:95]
    s_waitcnt lgkmcnt(4)
    v_and_b32 v83, 3, v1
    v_lshl_add_u32 v82, v83, 3, v82
    v_mfma_f32_16x16x32_bf16 v[156:159], a[208:211], a[60:63], v[156:159]
    ds_read_b64_tr_b16 a[200:201], v18 offset:14336
    v_lshrrev_b32 v83, 5, v1
    v_mfma_f32_16x16x32_bf16 v[188:191], a[212:215], a[60:63], v[188:191]
    ds_read_b64_tr_b16 a[202:203], v18 offset:20480
    v_mul_u32_u24 v83, 1024, v83
    v_mfma_f32_16x16x32_bf16 v[180:183], a[212:215], a[56:59], v[180:183]
    buffer_load_dwordx4 a[112:115], v28, s[20:23], s9 offen offset:0 sc1
    v_mfma_f32_16x16x32_bf16 v[148:151], a[208:211], a[56:59], v[148:151]
    v_add_u32 v82, v82, v83
    v_add_u32 v82, 147456, v82
    v_mfma_f32_16x16x32_bf16 v[140:143], a[208:211], a[52:55], v[140:143]
    ds_read_b64_tr_b16 a[204:205], v19 offset:14336
    v_lshlrev_b32 v74, 2, v1
    v_mfma_f32_16x16x32_bf16 v[172:175], a[212:215], a[52:55], v[172:175]
    s_waitcnt vmcnt(63)
    ds_read_b64_tr_b16 a[206:207], v19 offset:20480
    v_cmp_gt_u32 vcc, 16, v1
    v_mfma_f32_16x16x32_bf16 v[164:167], a[212:215], a[48:51], v[164:167]
    s_barrier
    v_mfma_f32_16x16x32_bf16 v[132:135], a[208:211], a[48:51], v[132:135]
    s_waitcnt lgkmcnt(4)
    buffer_load_dwordx4 a[116:119], v28, s[20:23], s9 offen offset:1024 sc1
    v_add_u32 v8, 98304, v12
    v_mfma_f32_16x16x32_bf16 v[196:199], a[192:195], a[48:51], v[196:199]
    s_load_dword s72, s[86:87], s5 offset:4 glc
    ds_read_b64_tr_b16 a[208:209], v8 offset:0
    v_mov_b32 v83, 0x7ffffff0
    v_mfma_f32_16x16x32_bf16 v[228:231], a[196:199], a[48:51], v[228:231]
    ds_read_b64_tr_b16 a[210:211], v8 offset:6144
    v_cndmask_b32 v74, v83, v74, vcc
    v_mfma_f32_16x16x32_bf16 v[236:239], a[196:199], a[52:55], v[236:239]
    buffer_load_dwordx4 a[120:123], v28, s[20:23], s9 offen offset:2048 sc1
    v_mfma_f32_16x16x32_bf16 v[204:207], a[192:195], a[52:55], v[204:207]
    v_cndmask_b32 v192, v192, v193, s[78:79]
    v_mov_b32 v193, s43
    v_add_u32 v9, 98304, v13
    v_mfma_f32_16x16x32_bf16 v[212:215], a[192:195], a[56:59], v[212:215]
    ds_read_b64_tr_b16 a[212:213], v9 offset:0
    v_cmp_lt_u32 s[78:79], 1, v194
    v_mfma_f32_16x16x32_bf16 v[244:247], a[196:199], a[56:59], v[244:247]
    ds_read_b64_tr_b16 a[214:215], v9 offset:6144
    v_cndmask_b32 v192, v192, v193, s[78:79]
    v_mfma_f32_16x16x32_bf16 v[252:255], a[196:199], a[60:63], v[252:255]
    buffer_load_dwordx4 a[124:127], v28, s[20:23], s9 offen offset:3072 sc1
    v_mfma_f32_16x16x32_bf16 v[220:223], a[192:195], a[60:63], v[220:223]
    s_waitcnt lgkmcnt(4)
    v_and_b32 v193, 7, v1
    v_lshl_add_u32 v192, v193, 3, v192
    v_add_u32 v10, 98304, v14
    v_mfma_f32_16x16x32_bf16 v[44:47], a[200:203], a[60:63], v[44:47]
    s_add_u32 s9, s9, 4096
    ds_read_b64_tr_b16 a[192:193], v10 offset:0
    v_and_b32 v194, 0x7ff, v195
    v_mfma_f32_16x16x32_bf16 v[60:63], a[204:207], a[60:63], v[60:63]
    ds_read_b64_tr_b16 a[194:195], v10 offset:6144
    v_sub_u32 v194, 2047, v194
    v_mfma_f32_16x16x32_bf16 v[56:59], a[204:207], a[56:59], v[56:59]
    buffer_load_dwordx4 a[128:131], v28, s[20:23], s10 offen offset:0 sc1
    v_mfma_f32_16x16x32_bf16 v[40:43], a[200:203], a[56:59], v[40:43]
    v_mul_u32_u24 v193, 1280, v194
    v_add_u32 v193, v193, v192
    v_add_u32 v11, 98304, v15
    v_mfma_f32_16x16x32_bf16 v[36:39], a[200:203], a[52:55], v[36:39]
    ds_read_b64_tr_b16 a[196:197], v11 offset:0
    v_lshlrev_b32 v194, 3, v194
    v_mfma_f32_16x16x32_bf16 v[52:55], a[204:207], a[52:55], v[52:55]
    s_waitcnt vmcnt(16)
    ds_read_b64_tr_b16 a[198:199], v11 offset:6144
    v_add_u32 v194, 3211264, v194
    v_mfma_f32_16x16x32_bf16 v[48:51], a[204:207], a[48:51], v[48:51]
    v_xor_b32 v18, s39, v8
    v_xor_b32 v19, s39, v9
    v_mfma_f32_16x16x32_bf16 v[32:35], a[200:203], a[48:51], v[32:35]
    s_waitcnt lgkmcnt(4)
    buffer_load_dwordx4 a[132:135], v28, s[20:23], s10 offen offset:1024 sc1
    v_mfma_f32_16x16x32_bf16 a[224:227], a[208:211], a[64:67], a[224:227]
    ds_read_b64_tr_b16 a[200:201], v8 offset:1024
    v_mfma_f32_16x16x32_bf16 a[240:243], a[212:215], a[64:67], a[240:243]
    ds_read_b64_tr_b16 a[202:203], v8 offset:7168
    v_mfma_f32_16x16x32_bf16 a[244:247], a[212:215], a[68:71], a[244:247]
    v_mfma_f32_16x16x32_bf16 a[228:231], a[208:211], a[68:71], a[228:231]
    buffer_load_dwordx4 a[136:139], v28, s[20:23], s10 offen offset:2048 sc1
    v_mfma_f32_16x16x32_bf16 a[232:235], a[208:211], a[72:75], a[232:235]
    s_lshr_b32 s55, s54, 1
    ds_read_b64_tr_b16 a[204:205], v9 offset:1024
    v_mfma_f32_16x16x32_bf16 a[248:251], a[212:215], a[72:75], a[248:251]
    s_lshl_b32 s55, s55, 19
    ds_read_b64_tr_b16 a[206:207], v9 offset:7168
    v_mfma_f32_16x16x32_bf16 a[252:255], a[212:215], a[76:79], a[252:255]
    s_and_b32 s60, s54, 1
    s_lshl_b32 s60, s60, 12
    s_or_b32 s55, s55, s60
    v_mfma_f32_16x16x32_bf16 a[236:239], a[208:211], a[76:79], a[236:239]
    s_waitcnt lgkmcnt(4)
    buffer_load_dwordx4 a[140:143], v28, s[20:23], s10 offen offset:3072 sc1
    v_mfma_f32_16x16x32_bf16 v[92:95], a[192:195], a[76:79], v[92:95]
    s_add_u32 s10, s10, 4096
    ds_read_b64_tr_b16 a[208:209], v10 offset:1024
    s_lshl_b32 s60, s54, 10
    v_mfma_f32_16x16x32_bf16 v[124:127], a[196:199], a[76:79], v[124:127]
    s_and_b32 s60, s60, 0x2000
    ds_read_b64_tr_b16 a[210:211], v10 offset:7168
    s_or_b32 s55, s55, s60
    v_mfma_f32_16x16x32_bf16 v[116:119], a[196:199], a[72:75], v[116:119]
    s_or_b32 s55, s55, 134217728
    s_mul_i32 s60, s51, 81920
    s_add_u32 s55, s55, s60
    v_mfma_f32_16x16x32_bf16 v[84:87], a[192:195], a[72:75], v[84:87]
    s_mul_i32 s60, s53, 8389632
    s_xor_b32 s55, s55, s60
    s_add_u32 s60, s51, 8
    v_mfma_f32_16x16x32_bf16 v[76:79], a[192:195], a[68:71], v[76:79]
    s_lshr_b32 s60, s93, s60
    ds_read_b64_tr_b16 a[212:213], v11 offset:1024
    s_and_b32 s60, s60, 0x2000
    v_mfma_f32_16x16x32_bf16 v[108:111], a[196:199], a[68:71], v[108:111]
    s_xor_b32 s55, s55, s60
    ds_read_b64_tr_b16 a[214:215], v11 offset:7168
    v_mfma_f32_16x16x32_bf16 v[100:103], a[196:199], a[64:67], v[100:103]
    v_mfma_f32_16x16x32_bf16 v[68:71], a[192:195], a[64:67], v[68:71]
    s_waitcnt lgkmcnt(4)
    v_mfma_f32_16x16x32_bf16 v[132:135], a[200:203], a[64:67], v[132:135]
    ds_read_b64_tr_b16 a[192:193], v18 offset:2048
    v_mfma_f32_16x16x32_bf16 v[164:167], a[204:207], a[64:67], v[164:167]
    ds_read_b64_tr_b16 a[194:195], v18 offset:8192
    v_mfma_f32_16x16x32_bf16 v[172:175], a[204:207], a[68:71], v[172:175]
    s_bfe_u32 s88, s72, 262156
    s_cmp_lg_u32 s88, 15
    s_cbranch_scc1 spin_o3
spin_o3_ret:
    v_mfma_f32_16x16x32_bf16 v[140:143], a[200:203], a[68:71], v[140:143]
    v_mfma_f32_16x16x32_bf16 v[148:151], a[200:203], a[72:75], v[148:151]
    ds_read_b64_tr_b16 a[196:197], v19 offset:2048
    v_mfma_f32_16x16x32_bf16 v[180:183], a[204:207], a[72:75], v[180:183]
    ds_read_b64_tr_b16 a[198:199], v19 offset:8192
    v_mfma_f32_16x16x32_bf16 v[188:191], a[204:207], a[76:79], v[188:191]
    buffer_load_dwordx4 a[144:147], v28, s[20:23], s8 offen offset:0 sc1
    v_mfma_f32_16x16x32_bf16 v[156:159], a[200:203], a[76:79], v[156:159]
    s_waitcnt lgkmcnt(4)
    v_mfma_f32_16x16x32_bf16 v[220:223], a[208:211], a[76:79], v[220:223]
    ds_read_b64_tr_b16 a[200:201], v8 offset:12288
    v_mfma_f32_16x16x32_bf16 v[252:255], a[212:215], a[76:79], v[252:255]
    ds_read_b64_tr_b16 a[202:203], v8 offset:18432
    v_mfma_f32_16x16x32_bf16 v[244:247], a[212:215], a[72:75], v[244:247]
    buffer_load_dwordx2 v[24:25], v23, s[24:27], 0 offen sc1
    v_mfma_f32_16x16x32_bf16 v[212:215], a[208:211], a[72:75], v[212:215]
    buffer_load_dwordx4 a[148:151], v28, s[20:23], s8 offen offset:1024 sc1
    v_mfma_f32_16x16x32_bf16 v[204:207], a[208:211], a[68:71], v[204:207]
    ds_read_b64_tr_b16 a[204:205], v9 offset:12288
    v_mfma_f32_16x16x32_bf16 v[236:239], a[212:215], a[68:71], v[236:239]
    ds_read_b64_tr_b16 a[206:207], v9 offset:18432
    v_mfma_f32_16x16x32_bf16 v[228:231], a[212:215], a[64:67], v[228:231]
    buffer_load_dwordx2 v[200:201], v193, s[16:19], 0 offen
    v_mfma_f32_16x16x32_bf16 v[196:199], a[208:211], a[64:67], v[196:199]
    s_waitcnt lgkmcnt(4)
    buffer_load_dwordx4 a[152:155], v28, s[20:23], s8 offen offset:2048 sc1
    v_mfma_f32_16x16x32_bf16 v[32:35], a[192:195], a[64:67], v[32:35]
    ds_read_b64_tr_b16 a[208:209], v10 offset:12288
    v_mfma_f32_16x16x32_bf16 v[48:51], a[196:199], a[64:67], v[48:51]
    ds_read_b64_tr_b16 a[210:211], v10 offset:18432
    v_mfma_f32_16x16x32_bf16 v[52:55], a[196:199], a[68:71], v[52:55]
    buffer_load_dwordx2 v[202:203], v194, s[24:27], 0 offen sc1
    v_mfma_f32_16x16x32_bf16 v[36:39], a[192:195], a[68:71], v[36:39]
    buffer_load_dwordx4 a[156:159], v28, s[20:23], s8 offen offset:3072 sc1
    v_mfma_f32_16x16x32_bf16 v[40:43], a[192:195], a[72:75], v[40:43]
    s_add_u32 s8, s8, 12288
    ds_read_b64_tr_b16 a[212:213], v11 offset:12288
    v_mfma_f32_16x16x32_bf16 v[56:59], a[196:199], a[72:75], v[56:59]
    s_waitcnt vmcnt(22)
    ds_read_b64_tr_b16 a[214:215], v11 offset:18432
    v_mfma_f32_16x16x32_bf16 v[60:63], a[196:199], a[76:79], v[60:63]
    buffer_load_dwordx4 v[144:147], v22, s[16:19], s41 offen
    v_mfma_f32_16x16x32_bf16 v[44:47], a[192:195], a[76:79], v[44:47]
    s_waitcnt lgkmcnt(4)
    v_mfma_f32_16x16x32_bf16 a[236:239], a[200:203], a[92:95], a[236:239]
    ds_read_b64_tr_b16 a[192:193], v8 offset:13312
    v_mfma_f32_16x16x32_bf16 a[252:255], a[204:207], a[92:95], a[252:255]
    ds_read_b64_tr_b16 a[194:195], v8 offset:19456
    v_mfma_f32_16x16x32_bf16 a[248:251], a[204:207], a[88:91], a[248:251]
    v_add_u32 v8, 49152, v12
    v_mfma_f32_16x16x32_bf16 a[232:235], a[200:203], a[88:91], a[232:235]
    buffer_load_dwordx4 v[152:155], v22, s[16:19], s42 offen
    v_mfma_f32_16x16x32_bf16 a[228:231], a[200:203], a[84:87], a[228:231]
    ds_read_b64_tr_b16 a[196:197], v9 offset:13312
    v_lshrrev_b32 v136, 5, v192
    v_mfma_f32_16x16x32_bf16 a[244:247], a[204:207], a[84:87], a[244:247]
    ds_read_b64_tr_b16 a[198:199], v9 offset:19456
    v_lshlrev_b32 v136, 9, v136
    v_mfma_f32_16x16x32_bf16 a[240:243], a[204:207], a[80:83], a[240:243]
    v_and_b32 v192, 31, v192
    v_lshl_add_u32 v192, v192, 1, v136
    v_mfma_f32_16x16x32_bf16 a[224:227], a[200:203], a[80:83], a[224:227]
    s_waitcnt lgkmcnt(4)
    buffer_load_dwordx4 v[160:163], v22, s[16:19], s43 offen
    v_mfma_f32_16x16x32_bf16 v[68:71], a[208:211], a[80:83], v[68:71]
    ds_read_b64_tr_b16 a[200:201], v10 offset:13312
    v_lshrrev_b32 v193, 5, v1
    v_mfma_f32_16x16x32_bf16 v[100:103], a[212:215], a[80:83], v[100:103]
    ds_read_b64_tr_b16 a[202:203], v10 offset:19456
    v_lshl_add_u32 v192, v193, 8, v192
    v_mfma_f32_16x16x32_bf16 v[108:111], a[212:215], a[84:87], v[108:111]
    v_and_b32 v195, 0xffff0000, v195
    v_ashrrev_i32 v193, 31, v195
    v_mfma_f32_16x16x32_bf16 v[76:79], a[208:211], a[84:87], v[76:79]
pg_10:
    s_cbranch_execz pg_ret2
    buffer_load_dwordx4 a[160:163], v28, s[20:23], s9 offen offset:0 sc1
    v_mfma_f32_16x16x32_bf16 v[84:87], a[208:211], a[88:91], v[84:87]
    ds_read_b64_tr_b16 a[204:205], v11 offset:13312
    v_not_b32 v193, v193
    v_mfma_f32_16x16x32_bf16 v[116:119], a[212:215], a[88:91], v[116:119]
    ds_read_b64_tr_b16 a[206:207], v11 offset:19456
    v_or_b32 v193, 0x80000000, v193
    v_mfma_f32_16x16x32_bf16 v[124:127], a[212:215], a[92:95], v[124:127]
    v_xor_b32 v195, v195, v193
    v_and_b32 v195, 0xffff0000, v195
    v_mfma_f32_16x16x32_bf16 v[92:95], a[208:211], a[92:95], v[92:95]
    s_waitcnt lgkmcnt(4)
    v_mul_f32 v195, s92, v195
    v_add_u32 v9, 49152, v13
    v_mfma_f32_16x16x32_bf16 v[156:159], a[192:195], a[92:95], v[156:159]
    s_load_dword s72, s[86:87], s5 offset:4 glc
    ds_read_b64_tr_b16 a[208:209], v18 offset:14336
    v_add_u32 v10, 49152, v14
    v_mfma_f32_16x16x32_bf16 v[188:191], a[196:199], a[92:95], v[188:191]
    ds_read_b64_tr_b16 a[210:211], v18 offset:20480
    v_add_u32 v11, 49152, v15
    v_mfma_f32_16x16x32_bf16 v[180:183], a[196:199], a[88:91], v[180:183]
    buffer_load_dwordx4 a[164:167], v28, s[20:23], s9 offen offset:1024 sc1
    v_mfma_f32_16x16x32_bf16 v[148:151], a[192:195], a[88:91], v[148:151]
    v_exp_f32 v195, v195
    v_mfma_f32_16x16x32_bf16 v[140:143], a[192:195], a[84:87], v[140:143]
    ds_read_b64_tr_b16 a[212:213], v19 offset:14336
    v_add_f32 v195, 1.0, v195
    v_mfma_f32_16x16x32_bf16 v[172:175], a[196:199], a[84:87], v[172:175]
    s_waitcnt vmcnt(21)
    ds_read_b64_tr_b16 a[214:215], v19 offset:20480
    v_xor_b32 v18, s39, v8
    v_mfma_f32_16x16x32_bf16 v[164:167], a[196:199], a[80:83], v[164:167]
    s_barrier
    v_mfma_f32_16x16x32_bf16 v[132:135], a[192:195], a[80:83], v[132:135]
    s_waitcnt lgkmcnt(4)
    buffer_load_dwordx4 a[168:171], v28, s[20:23], s9 offen offset:2048 sc1
    v_mfma_f32_16x16x32_bf16 v[196:199], a[200:203], a[80:83], v[196:199]
    ds_read_b64_tr_b16 a[192:193], v8 offset:0
    v_xor_b32 v19, s39, v9
    v_mfma_f32_16x16x32_bf16 v[228:231], a[204:207], a[80:83], v[228:231]
    ds_read_b64_tr_b16 a[194:195], v8 offset:6144
    v_mfma_f32_16x16x32_bf16 v[236:239], a[204:207], a[84:87], v[236:239]
    buffer_load_dwordx4 a[172:175], v28, s[20:23], s9 offen offset:3072 sc1
    v_mfma_f32_16x16x32_bf16 v[204:207], a[200:203], a[84:87], v[204:207]
    s_add_u32 s9, s9, 12288
    v_rcp_f32 v195, v195
    v_mfma_f32_16x16x32_bf16 v[212:215], a[200:203], a[88:91], v[212:215]
    ds_read_b64_tr_b16 a[196:197], v9 offset:0
    v_cvt_pk_bf16_f32 v195, v195, v195
    v_mfma_f32_16x16x32_bf16 v[244:247], a[204:207], a[88:91], v[244:247]
    ds_read_b64_tr_b16 a[198:199], v9 offset:6144
    v_and_b32 v195, 0xffff0000, v195
    v_mfma_f32_16x16x32_bf16 v[252:255], a[204:207], a[92:95], v[252:255]
    ds_write_b16 v80, v64
    v_mfma_f32_16x16x32_bf16 v[220:223], a[200:203], a[92:95], v[220:223]
    s_waitcnt lgkmcnt(4)
    ds_write_b16_d16_hi v80, v64 offset:128
    v_mfma_f32_16x16x32_bf16 v[44:47], a[208:211], a[92:95], v[44:47]
    ds_read_b64_tr_b16 a[200:201], v10 offset:0
    v_mfma_f32_16x16x32_bf16 v[60:63], a[212:215], a[92:95], v[60:63]
    ds_read_b64_tr_b16 a[202:203], v10 offset:6144
    v_mfma_f32_16x16x32_bf16 v[56:59], a[212:215], a[88:91], v[56:59]
    ds_read_b128 v[88:91], v81
    v_mfma_f32_16x16x32_bf16 v[40:43], a[208:211], a[88:91], v[40:43]
    buffer_load_dwordx4 a[176:179], v28, s[20:23], s10 offen offset:0 sc1
    v_mfma_f32_16x16x32_bf16 v[36:39], a[208:211], a[84:87], v[36:39]
    ds_read_b64_tr_b16 a[204:205], v11 offset:0
    v_mfma_f32_16x16x32_bf16 v[52:55], a[212:215], a[84:87], v[52:55]
    s_waitcnt vmcnt(26)
    ds_read_b64_tr_b16 a[206:207], v11 offset:6144
    v_mfma_f32_16x16x32_bf16 v[48:51], a[212:215], a[80:83], v[48:51]
    ds_read_b128 v[96:99], v81 offset:64
    v_mfma_f32_16x16x32_bf16 v[32:35], a[208:211], a[80:83], v[32:35]
    s_waitcnt lgkmcnt(4)
    ds_read_b64_tr_b16 v[104:105], v82
    v_mfma_f32_16x16x32_bf16 a[224:227], a[192:195], a[96:99], a[224:227]
    ds_read_b64_tr_b16 a[208:209], v8 offset:1024
    v_mfma_f32_16x16x32_bf16 a[240:243], a[196:199], a[96:99], a[240:243]
    ds_read_b64_tr_b16 a[210:211], v8 offset:7168
    v_mfma_f32_16x16x32_bf16 a[244:247], a[196:199], a[100:103], a[244:247]
    ds_read_b64_tr_b16 v[106:107], v82 offset:2048
    v_mfma_f32_16x16x32_bf16 a[228:231], a[192:195], a[100:103], a[228:231]
    buffer_load_dwordx4 a[180:183], v28, s[20:23], s10 offen offset:1024 sc1
    v_mfma_f32_16x16x32_bf16 a[232:235], a[192:195], a[104:107], a[232:235]
    s_lshl1_add_u32 m0, s36, 81920
    ds_read_b64_tr_b16 a[212:213], v9 offset:1024
    s_add_u32 s38, s34, 122880
    v_mfma_f32_16x16x32_bf16 a[248:251], a[196:199], a[104:107], a[248:251]
    s_add_u32 s57, s35, 122880
    ds_read_b64_tr_b16 a[214:215], v9 offset:7168
    s_cmp_lt_u32 s3, 2
    s_cselect_b32 s38, s38, s57
    v_mfma_f32_16x16x32_bf16 a[252:255], a[196:199], a[108:111], a[252:255]
    ds_read_b64_tr_b16 v[112:113], v82 offset:4096
    v_mfma_f32_16x16x32_bf16 a[236:239], a[192:195], a[108:111], a[236:239]
    s_waitcnt lgkmcnt(4)
    ds_read_b64_tr_b16 v[114:115], v82 offset:6144
    v_mfma_f32_16x16x32_bf16 v[92:95], a[200:203], a[108:111], v[92:95]
    ds_read_b64_tr_b16 a[192:193], v10 offset:1024
    v_mfma_f32_16x16x32_bf16 v[124:127], a[204:207], a[108:111], v[124:127]
    ds_read_b64_tr_b16 a[194:195], v10 offset:7168
    v_mfma_f32_16x16x32_bf16 v[116:119], a[204:207], a[104:107], v[116:119]
    s_bfe_u32 s88, s72, 262160
    s_cmp_lg_u32 s88, 15
    s_cbranch_scc1 spin_o4
spin_o4_ret:
    v_mfma_f32_16x16x32_bf16 v[84:87], a[200:203], a[104:107], v[84:87]
    buffer_load_dwordx4 v4, s[12:15], s38 offen lds
    v_mfma_f32_16x16x32_bf16 v[76:79], a[200:203], a[100:103], v[76:79]
    s_lshl1_add_u32 m0, s36, 82944
    ds_read_b64_tr_b16 a[196:197], v11 offset:1024
    v_mfma_f32_16x16x32_bf16 v[108:111], a[204:207], a[100:103], v[108:111]
    ds_read_b64_tr_b16 a[198:199], v11 offset:7168
    v_mfma_f32_16x16x32_bf16 v[100:103], a[204:207], a[96:99], v[100:103]
    buffer_load_dwordx4 a[0:3], v28, s[20:23], s8 offen offset:0 sc1
    v_mfma_f32_16x16x32_bf16 v[68:71], a[200:203], a[96:99], v[68:71]
    s_waitcnt lgkmcnt(4)
    v_mfma_f32_16x16x32_bf16 v[132:135], a[208:211], a[96:99], v[132:135]
    ds_read_b64_tr_b16 a[200:201], v18 offset:2048
    v_mfma_f32_16x16x32_bf16 v[164:167], a[212:215], a[96:99], v[164:167]
    ds_read_b64_tr_b16 a[202:203], v18 offset:8192
    v_mfma_f32_16x16x32_bf16 v[172:175], a[212:215], a[100:103], v[172:175]
    buffer_load_dwordx4 a[4:7], v28, s[20:23], s8 offen offset:1024 sc1
    v_mfma_f32_16x16x32_bf16 v[140:143], a[208:211], a[100:103], v[140:143]
    v_mfma_f32_16x16x32_bf16 v[148:151], a[208:211], a[104:107], v[148:151]
    ds_read_b64_tr_b16 a[204:205], v19 offset:2048
    v_mfma_f32_16x16x32_bf16 v[180:183], a[212:215], a[104:107], v[180:183]
    ds_read_b64_tr_b16 a[206:207], v19 offset:8192
    v_mfma_f32_16x16x32_bf16 v[188:191], a[212:215], a[108:111], v[188:191]
    v_mfma_f32_16x16x32_bf16 v[120:123], v[88:91], v[104:107], 0
    v_mfma_f32_16x16x32_bf16 v[120:123], v[96:99], v[112:115], v[120:123]
    v_mfma_f32_16x16x32_bf16 v[156:159], a[208:211], a[108:111], v[156:159]
    s_waitcnt lgkmcnt(4)
    buffer_load_dwordx4 a[8:11], v28, s[20:23], s8 offen offset:2048 sc1
    v_mfma_f32_16x16x32_bf16 v[220:223], a[192:195], a[108:111], v[220:223]
    ds_read_b64_tr_b16 a[208:209], v8 offset:12288
    v_lshrrev_b32 v233, 5, v1
    v_mfma_f32_16x16x32_bf16 v[252:255], a[196:199], a[108:111], v[252:255]
    ds_read_b64_tr_b16 a[210:211], v8 offset:18432
    v_lshlrev_b32 v233, 11, v233
    v_mfma_f32_16x16x32_bf16 v[244:247], a[196:199], a[104:107], v[244:247]
    v_sub_u32 v233, 81920, v233
    v_mfma_f32_16x16x32_bf16 v[212:215], a[192:195], a[104:107], v[212:215]
    buffer_load_dwordx4 a[12:15], v28, s[20:23], s8 offen offset:3072 sc1
    v_mfma_f32_16x16x32_bf16 v[204:207], a[192:195], a[100:103], v[204:207]
    s_add_u32 s8, s8, 4096
    ds_read_b64_tr_b16 a[212:213], v9 offset:12288
    v_mfma_f32_16x16x32_bf16 v[236:239], a[196:199], a[100:103], v[236:239]
    ds_read_b64_tr_b16 a[214:215], v9 offset:18432
    v_mfma_f32_16x16x32_bf16 v[228:231], a[196:199], a[96:99], v[228:231]
    buffer_atomic_add_f32 v120, v74, s[24:27], s62 offen
    v_mfma_f32_16x16x32_bf16 v[196:199], a[192:195], a[96:99], v[196:199]
    s_waitcnt lgkmcnt(4)
    buffer_load_dwordx4 v5, s[12:15], s38 offen lds
    v_mfma_f32_16x16x32_bf16 v[32:35], a[200:203], a[96:99], v[32:35]
    s_lshl1_add_u32 m0, s36, 90112
    ds_read_b64_tr_b16 a[192:193], v10 offset:12288
    s_add_u32 s38, s33, 163840
    v_mfma_f32_16x16x32_bf16 v[48:51], a[204:207], a[96:99], v[48:51]
    s_add_u32 s57, s34, 163840
    ds_read_b64_tr_b16 a[194:195], v10 offset:18432
    s_cmp_lt_u32 s3, 2
    s_cselect_b32 s38, s38, s57
    v_mfma_f32_16x16x32_bf16 v[52:55], a[204:207], a[100:103], v[52:55]
    buffer_atomic_add_f32 v121, v74, s[24:27], s62 offen offset:256
    v_mfma_f32_16x16x32_bf16 v[36:39], a[200:203], a[100:103], v[36:39]
    buffer_load_dwordx4 v4, s[12:15], s38 offen lds
    v_mfma_f32_16x16x32_bf16 v[40:43], a[200:203], a[104:107], v[40:43]
    s_lshl1_add_u32 m0, s36, 91136
    ds_read_b64_tr_b16 a[196:197], v11 offset:12288
    v_mov_b32 v122, 1
    v_mfma_f32_16x16x32_bf16 v[56:59], a[204:207], a[104:107], v[56:59]
    s_waitcnt vmcnt(29)
    ds_read_b64_tr_b16 a[198:199], v11 offset:18432
    v_min_u32 v123, 1, v1
    v_mfma_f32_16x16x32_bf16 v[60:63], a[204:207], a[108:111], v[60:63]
    v_lshlrev_b32 v123, 30, v123
    v_mfma_f32_16x16x32_bf16 v[44:47], a[200:203], a[108:111], v[44:47]
    s_waitcnt lgkmcnt(4)
    v_mfma_f32_16x16x32_bf16 a[236:239], a[208:211], a[124:127], a[236:239]
    ds_read_b64_tr_b16 a[200:201], v8 offset:13312
    v_mfma_f32_16x16x32_bf16 a[252:255], a[212:215], a[124:127], a[252:255]
    ds_read_b64_tr_b16 a[202:203], v8 offset:19456
    v_mfma_f32_16x16x32_bf16 a[248:251], a[212:215], a[120:123], a[248:251]
    buffer_load_dwordx4 v5, s[12:15], s38 offen lds
    v_mfma_f32_16x16x32_bf16 a[232:235], a[208:211], a[120:123], a[232:235]
    s_lshl1_add_u32 m0, s36, 98304
    v_add_u32 v8, 0, v12
    s_add_u32 s38, s35, 163840
    v_mfma_f32_16x16x32_bf16 a[228:231], a[208:211], a[116:119], a[228:231]
    s_add_u32 s57, s33, 204800
    ds_read_b64_tr_b16 a[204:205], v9 offset:13312
    s_cmp_lt_u32 s3, 2
    s_cselect_b32 s38, s38, s57
    v_mfma_f32_16x16x32_bf16 a[244:247], a[212:215], a[116:119], a[244:247]
    ds_read_b64_tr_b16 a[206:207], v9 offset:19456
    v_mfma_f32_16x16x32_bf16 a[240:243], a[212:215], a[112:115], a[240:243]
    buffer_load_dwordx4 v4, s[12:15], s38 offen lds
    v_mfma_f32_16x16x32_bf16 a[224:227], a[208:211], a[112:115], a[224:227]
    s_waitcnt lgkmcnt(4)
    v_add_u32 v9, 0, v13
    s_lshl1_add_u32 m0, s36, 99328
    v_mfma_f32_16x16x32_bf16 v[68:71], a[192:195], a[112:115], v[68:71]
    s_load_dword s72, s[86:87], s5 offset:4 glc
    ds_read_b64_tr_b16 a[208:209], v10 offset:13312
    v_mfma_f32_16x16x32_bf16 v[100:103], a[196:199], a[112:115], v[100:103]
    ds_read_b64_tr_b16 a[210:211], v10 offset:19456
    v_mfma_f32_16x16x32_bf16 v[108:111], a[196:199], a[116:119], v[108:111]
    buffer_load_dwordx4 v5, s[12:15], s38 offen lds
    v_mfma_f32_16x16x32_bf16 v[76:79], a[192:195], a[116:119], v[76:79]
    s_waitcnt vmcnt(18)
    v_lshlrev_b32 v248, 16, v200
    v_and_b32 v249, 0xffff0000, v200
    v_mfma_f32_16x16x32_bf16 v[84:87], a[192:195], a[120:123], v[84:87]
    s_lshl1_add_u32 m0, s36, 106496
    ds_read_b64_tr_b16 a[212:213], v11 offset:13312
    v_sub_f32 v248, v248, v202
    v_mfma_f32_16x16x32_bf16 v[116:119], a[196:199], a[120:123], v[116:119]
    s_add_u32 s38, s34, 204800
    ds_read_b64_tr_b16 a[214:215], v11 offset:19456
    v_sub_f32 v249, v249, v202
    v_mfma_f32_16x16x32_bf16 v[124:127], a[196:199], a[124:127], v[124:127]
    buffer_load_dwordx4 a[184:187], v28, s[20:23], s10 offen offset:2048 sc1
    v_mfma_f32_16x16x32_bf16 v[92:95], a[192:195], a[124:127], v[92:95]
    s_waitcnt lgkmcnt(4)
    v_cvt_pk_bf16_f32 v193, v248, v249
    v_lshlrev_b32 v248, 16, v193
    v_mfma_f32_16x16x32_bf16 v[156:159], a[200:203], a[124:127], v[156:159]
    s_add_u32 s57, s35, 204800
    ds_read_b64_tr_b16 a[192:193], v18 offset:14336
    v_and_b32 v249, 0xffff0000, v193
    v_mfma_f32_16x16x32_bf16 v[188:191], a[204:207], a[124:127], v[188:191]
    s_cmp_lt_u32 s3, 2
    s_cselect_b32 s38, s38, s57
    ds_read_b64_tr_b16 a[194:195], v18 offset:20480
    v_mfma_f32_16x16x32_bf16 v[180:183], a[204:207], a[120:123], v[180:183]
    buffer_load_dwordx4 v4, s[12:15], s38 offen lds
    v_mfma_f32_16x16x32_bf16 v[148:151], a[200:203], a[120:123], v[148:151]
    v_mul_f32 v248, v248, v203
    v_mul_f32 v249, v249, v203
    v_mfma_f32_16x16x32_bf16 v[140:143], a[200:203], a[116:119], v[140:143]
    s_lshl1_add_u32 m0, s36, 107520
    ds_read_b64_tr_b16 a[196:197], v19 offset:14336
    v_cvt_pk_bf16_f32 v193, v248, v249
    v_mfma_f32_16x16x32_bf16 v[172:175], a[204:207], a[116:119], v[172:175]
    s_waitcnt vmcnt(63)
    ds_read_b64_tr_b16 a[198:199], v19 offset:20480
    v_lshlrev_b32 v248, 16, v193
    v_mfma_f32_16x16x32_bf16 v[164:167], a[204:207], a[112:115], v[164:167]
    s_barrier
    v_mfma_f32_16x16x32_bf16 v[132:135], a[200:203], a[112:115], v[132:135]
    s_waitcnt lgkmcnt(4)
    buffer_load_dwordx4 a[188:191], v28, s[20:23], s10 offen offset:3072 sc1
    v_mfma_f32_16x16x32_bf16 v[196:199], a[208:211], a[112:115], v[196:199]
    s_add_u32 s10, s10, 12288
    ds_read_b64_tr_b16 a[200:201], v8 offset:0
    v_and_b32 v249, 0xffff0000, v193
    v_mfma_f32_16x16x32_bf16 v[228:231], a[212:215], a[112:115], v[228:231]
    ds_read_b64_tr_b16 a[202:203], v8 offset:6144
    v_lshlrev_b32 v250, 16, v201
    v_mfma_f32_16x16x32_bf16 v[236:239], a[212:215], a[116:119], v[236:239]
    buffer_load_dwordx4 v5, s[12:15], s38 offen lds
    v_mfma_f32_16x16x32_bf16 v[204:207], a[208:211], a[116:119], v[204:207]
    v_and_b32 v251, 0xffff0000, v201
    v_sub_f32 v250, v250, v202
    v_mfma_f32_16x16x32_bf16 v[212:215], a[208:211], a[120:123], v[212:215]
    ds_read_b64_tr_b16 a[204:205], v9 offset:0
    v_sub_f32 v251, v251, v202
    v_mfma_f32_16x16x32_bf16 v[244:247], a[212:215], a[120:123], v[244:247]
    ds_read_b64_tr_b16 a[206:207], v9 offset:6144
    v_cvt_pk_bf16_f32 v193, v250, v251
    v_mfma_f32_16x16x32_bf16 v[252:255], a[212:215], a[124:127], v[252:255]
    v_lshlrev_b32 v250, 16, v193
    v_and_b32 v251, 0xffff0000, v193
    v_mfma_f32_16x16x32_bf16 v[220:223], a[208:211], a[124:127], v[220:223]
    s_waitcnt lgkmcnt(4)
    buffer_load_dwordx4 a[16:19], v28, s[20:23], s9 offen offset:0 sc1
    v_add_u32 v10, 0, v14
    v_mfma_f32_16x16x32_bf16 v[44:47], a[192:195], a[124:127], v[44:47]
    ds_read_b64_tr_b16 a[208:209], v10 offset:0
    v_mul_f32 v250, v250, v203
    v_mfma_f32_16x16x32_bf16 v[60:63], a[196:199], a[124:127], v[60:63]
    ds_read_b64_tr_b16 a[210:211], v10 offset:6144
    v_mul_f32 v251, v251, v203
    v_mfma_f32_16x16x32_bf16 v[56:59], a[196:199], a[120:123], v[56:59]
    v_cvt_pk_bf16_f32 v193, v250, v251
    v_lshlrev_b32 v250, 16, v193
    v_mfma_f32_16x16x32_bf16 v[40:43], a[192:195], a[120:123], v[40:43]
    buffer_load_dwordx4 a[20:23], v28, s[20:23], s9 offen offset:1024 sc1
    v_add_u32 v11, 0, v15
    v_mfma_f32_16x16x32_bf16 v[36:39], a[192:195], a[116:119], v[36:39]
    ds_read_b64_tr_b16 a[212:213], v11 offset:0
    v_and_b32 v251, 0xffff0000, v193
    v_mfma_f32_16x16x32_bf16 v[52:55], a[196:199], a[116:119], v[52:55]
    s_waitcnt vmcnt(34)
    ds_read_b64_tr_b16 a[214:215], v11 offset:6144
    v_mul_f32 v24, v24, -v25
    v_mfma_f32_16x16x32_bf16 v[48:51], a[196:199], a[112:115], v[48:51]
    v_lshlrev_b32 v26, 16, v144
    v_and_b32 v27, 0xffff0000, v144
    v_mfma_f32_16x16x32_bf16 v[32:35], a[192:195], a[112:115], v[32:35]
    s_waitcnt lgkmcnt(4)
    buffer_load_dwordx4 a[24:27], v28, s[20:23], s9 offen offset:2048 sc1
    v_mfma_f32_16x16x32_bf16 a[224:227], a[200:203], a[128:131], a[224:227]
    ds_read_b64_tr_b16 a[192:193], v8 offset:1024
    v_fma_f32 v26, v26, v25, v24
    v_mfma_f32_16x16x32_bf16 a[240:243], a[204:207], a[128:131], a[240:243]
    ds_read_b64_tr_b16 a[194:195], v8 offset:7168
    v_fma_f32 v27, v27, v25, v24
    v_mfma_f32_16x16x32_bf16 a[244:247], a[204:207], a[132:135], a[244:247]
    s_bfe_u32 s88, s72, 262164
    s_cmp_lg_u32 s88, 15
    s_cbranch_scc1 spin_o5
spin_o5_ret:
    v_mul_f32 v30, s92, v26
    v_mfma_f32_16x16x32_bf16 a[228:231], a[200:203], a[132:135], a[228:231]
    buffer_load_dwordx4 a[28:31], v28, s[20:23], s9 offen offset:3072 sc1
    v_mfma_f32_16x16x32_bf16 a[232:235], a[200:203], a[136:139], a[232:235]
    s_add_u32 s9, s9, 4096
    ds_read_b64_tr_b16 a[196:197], v9 offset:1024
    v_mul_f32 v31, s92, v27
    v_mfma_f32_16x16x32_bf16 a[248:251], a[204:207], a[136:139], a[248:251]
    ds_read_b64_tr_b16 a[198:199], v9 offset:7168
    v_xor_b32 v18, s39, v8
    v_mfma_f32_16x16x32_bf16 a[252:255], a[204:207], a[140:143], a[252:255]
    v_exp_f32 v30, v30
    v_mfma_f32_16x16x32_bf16 a[236:239], a[200:203], a[140:143], a[236:239]
    s_waitcnt lgkmcnt(4)
    v_exp_f32 v31, v31
    v_mfma_f32_16x16x32_bf16 v[92:95], a[208:211], a[140:143], v[92:95]
    ds_read_b64_tr_b16 a[200:201], v10 offset:1024
    v_add_f32 v30, 1.0, v30
    v_mfma_f32_16x16x32_bf16 v[124:127], a[212:215], a[140:143], v[124:127]
    ds_read_b64_tr_b16 a[202:203], v10 offset:7168
    v_add_f32 v31, 1.0, v31
    v_mfma_f32_16x16x32_bf16 v[116:119], a[212:215], a[136:139], v[116:119]
    buffer_load_dwordx4 a[48:51], v28, s[20:23], s8 offen offset:0 sc1
    v_mfma_f32_16x16x32_bf16 v[84:87], a[208:211], a[136:139], v[84:87]
    v_rcp_f32 v30, v30
    v_mfma_f32_16x16x32_bf16 v[76:79], a[208:211], a[132:135], v[76:79]
    ds_read_b64_tr_b16 a[204:205], v11 offset:1024
    v_xor_b32 v19, s39, v9
    v_mfma_f32_16x16x32_bf16 v[108:111], a[212:215], a[132:135], v[108:111]
    ds_read_b64_tr_b16 a[206:207], v11 offset:7168
    v_mfma_f32_16x16x32_bf16 v[100:103], a[212:215], a[128:131], v[100:103]
    buffer_load_dwordx4 a[52:55], v28, s[20:23], s8 offen offset:1024 sc1
    v_mfma_f32_16x16x32_bf16 v[68:71], a[208:211], a[128:131], v[68:71]
    s_waitcnt lgkmcnt(4)
    v_rcp_f32 v31, v31
    v_mfma_f32_16x16x32_bf16 v[132:135], a[192:195], a[128:131], v[132:135]
    ds_read_b64_tr_b16 a[208:209], v18 offset:2048
    v_mul_f32 v26, v26, v30
    v_mfma_f32_16x16x32_bf16 v[164:167], a[196:199], a[128:131], v[164:167]
    ds_read_b64_tr_b16 a[210:211], v18 offset:8192
    v_mul_f32 v27, v27, v31
    v_mfma_f32_16x16x32_bf16 v[172:175], a[196:199], a[132:135], v[172:175]
    buffer_load_dwordx4 a[56:59], v28, s[20:23], s8 offen offset:2048 sc1
    v_mfma_f32_16x16x32_bf16 v[140:143], a[192:195], a[132:135], v[140:143]
    v_cvt_pk_bf16_f32 v168, v26, v27
    v_lshlrev_b32 v26, 16, v145
    v_mfma_f32_16x16x32_bf16 v[148:151], a[192:195], a[136:139], v[148:151]
    ds_read_b64_tr_b16 a[212:213], v19 offset:2048
    v_and_b32 v27, 0xffff0000, v145
    v_mfma_f32_16x16x32_bf16 v[180:183], a[196:199], a[136:139], v[180:183]
    ds_read_b64_tr_b16 a[214:215], v19 offset:8192
    v_fma_f32 v26, v26, v25, v24
    v_mfma_f32_16x16x32_bf16 v[188:191], a[196:199], a[140:143], v[188:191]
    buffer_load_dwordx4 a[60:63], v28, s[20:23], s8 offen offset:3072 sc1
    v_mfma_f32_16x16x32_bf16 v[156:159], a[192:195], a[140:143], v[156:159]
    s_waitcnt lgkmcnt(4)
    v_fma_f32 v27, v27, v25, v24
    v_mul_f32 v30, s92, v26
    v_mfma_f32_16x16x32_bf16 v[220:223], a[200:203], a[140:143], v[220:223]
    s_add_u32 s8, s8, 12288
    ds_read_b64_tr_b16 a[192:193], v8 offset:12288
    v_mul_f32 v31, s92, v27
    v_mfma_f32_16x16x32_bf16 v[252:255], a[204:207], a[140:143], v[252:255]
    ds_read_b64_tr_b16 a[194:195], v8 offset:18432
    v_mfma_f32_16x16x32_bf16 v[244:247], a[204:207], a[136:139], v[244:247]
    buffer_load_dwordx4 a[32:35], v28, s[20:23], s10 offen offset:0 sc1
    v_mfma_f32_16x16x32_bf16 v[212:215], a[200:203], a[136:139], v[212:215]
    v_exp_f32 v30, v30
    v_mfma_f32_16x16x32_bf16 v[204:207], a[200:203], a[132:135], v[204:207]
    ds_read_b64_tr_b16 a[196:197], v9 offset:12288
    v_mfma_f32_16x16x32_bf16 v[236:239], a[204:207], a[132:135], v[236:239]
    ds_read_b64_tr_b16 a[198:199], v9 offset:18432
    v_mfma_f32_16x16x32_bf16 v[228:231], a[204:207], a[128:131], v[228:231]
    buffer_load_dwordx4 a[36:39], v28, s[20:23], s10 offen offset:1024 sc1
    v_mfma_f32_16x16x32_bf16 v[196:199], a[200:203], a[128:131], v[196:199]
    s_waitcnt lgkmcnt(4)
    v_exp_f32 v31, v31
    v_mfma_f32_16x16x32_bf16 v[32:35], a[208:211], a[128:131], v[32:35]
    s_waitcnt vmcnt(18)
    ds_read_b64_tr_b16 a[200:201], v10 offset:12288
    v_add_f32 v30, 1.0, v30
    v_mfma_f32_16x16x32_bf16 v[48:51], a[212:215], a[128:131], v[48:51]
    ds_read_b64_tr_b16 a[202:203], v10 offset:18432
    v_add_f32 v31, 1.0, v31
    v_mfma_f32_16x16x32_bf16 v[52:55], a[212:215], a[132:135], v[52:55]
    buffer_atomic_add v122, v123, s[24:27], s62 offen offset:128
    v_mfma_f32_16x16x32_bf16 v[36:39], a[208:211], a[132:135], v[36:39]
    buffer_load_dwordx4 a[40:43], v28, s[20:23], s10 offen offset:2048 sc1
    v_mfma_f32_16x16x32_bf16 v[40:43], a[208:211], a[136:139], v[40:43]
    ds_read_b64_tr_b16 a[204:205], v11 offset:12288
    v_mfma_f32_16x16x32_bf16 v[56:59], a[212:215], a[136:139], v[56:59]
    s_waitcnt vmcnt(37)
    ds_read_b64_tr_b16 a[206:207], v11 offset:18432
    v_mfma_f32_16x16x32_bf16 v[60:63], a[212:215], a[140:143], v[60:63]
    v_rcp_f32 v30, v30
    v_mfma_f32_16x16x32_bf16 v[44:47], a[208:211], a[140:143], v[44:47]
    s_waitcnt lgkmcnt(4)
    buffer_load_dwordx4 a[44:47], v28, s[20:23], s10 offen offset:3072 sc1
    v_mfma_f32_16x16x32_bf16 a[236:239], a[192:195], a[156:159], a[236:239]
    s_add_u32 s10, s10, 4096
    ds_read_b64_tr_b16 a[208:209], v8 offset:13312
    v_mfma_f32_16x16x32_bf16 a[252:255], a[196:199], a[156:159], a[252:255]
    ds_read_b64_tr_b16 a[210:211], v8 offset:19456
    v_mfma_f32_16x16x32_bf16 a[248:251], a[196:199], a[152:155], a[248:251]
    v_rcp_f32 v31, v31
    v_mfma_f32_16x16x32_bf16 a[232:235], a[192:195], a[152:155], a[232:235]
    buffer_load_dwordx4 a[64:67], v28, s[20:23], s9 offen offset:0 sc1
    v_mfma_f32_16x16x32_bf16 a[228:231], a[192:195], a[148:151], a[228:231]
    s_lshl_b32 s77, s3, 1
    s_add_u32 s77, s77, 0
    s_cmp_eq_u32 s77, s53
    s_cselect_b32 s77, 0x7ffffff0, 0
    ds_read_b64_tr_b16 a[212:213], v9 offset:13312
    v_mfma_f32_16x16x32_bf16 a[244:247], a[196:199], a[148:151], a[244:247]
    ds_read_b64_tr_b16 a[214:215], v9 offset:19456
    v_mul_f32 v26, v26, v30
    v_mfma_f32_16x16x32_bf16 a[240:243], a[196:199], a[144:147], a[240:243]
    v_mul_f32 v27, v27, v31
    v_cvt_pk_bf16_f32 v169, v26, v27
    v_mfma_f32_16x16x32_bf16 a[224:227], a[192:195], a[144:147], a[224:227]
    s_waitcnt lgkmcnt(4)
    buffer_load_dwordx4 a[68:71], v28, s[20:23], s9 offen offset:1024 sc1
    v_mfma_f32_16x16x32_bf16 v[68:71], a[200:203], a[144:147], v[68:71]
    ds_read_b64_tr_b16 a[192:193], v10 offset:13312
    v_lshlrev_b32 v26, 16, v146
    v_mfma_f32_16x16x32_bf16 v[100:103], a[204:207], a[144:147], v[100:103]
    ds_read_b64_tr_b16 a[194:195], v10 offset:19456
    v_and_b32 v27, 0xffff0000, v146
    v_mfma_f32_16x16x32_bf16 v[108:111], a[204:207], a[148:151], v[108:111]
    v_fma_f32 v26, v26, v25, v24
    v_fma_f32 v27, v27, v25, v24
    v_mfma_f32_16x16x32_bf16 v[76:79], a[200:203], a[148:151], v[76:79]
    buffer_load_dwordx4 a[72:75], v28, s[20:23], s9 offen offset:2048 sc1
    v_mfma_f32_16x16x32_bf16 v[84:87], a[200:203], a[152:155], v[84:87]
    s_lshl1_add_u32 m0, s36, 114688
    ds_read_b64_tr_b16 a[196:197], v11 offset:13312
    v_mul_f32 v30, s92, v26
    v_mfma_f32_16x16x32_bf16 v[116:119], a[204:207], a[152:155], v[116:119]
    s_add_u32 s38, s34, 123008
    ds_read_b64_tr_b16 a[198:199], v11 offset:19456
    v_mul_f32 v31, s92, v27
    v_mfma_f32_16x16x32_bf16 v[124:127], a[204:207], a[156:159], v[124:127]
    s_add_u32 s57, s35, 123008
    v_exp_f32 v30, v30
    v_mfma_f32_16x16x32_bf16 v[92:95], a[200:203], a[156:159], v[92:95]
    s_waitcnt lgkmcnt(4)
    v_exp_f32 v31, v31
    v_mfma_f32_16x16x32_bf16 v[156:159], a[208:211], a[156:159], v[156:159]
    s_cmp_lt_u32 s3, 2
    s_cselect_b32 s38, s38, s57
    ds_read_b64_tr_b16 a[200:201], v18 offset:14336
    v_mfma_f32_16x16x32_bf16 v[188:191], a[212:215], a[156:159], v[188:191]
    ds_read_b64_tr_b16 a[202:203], v18 offset:20480
    v_add_f32 v30, 1.0, v30
    v_mfma_f32_16x16x32_bf16 v[180:183], a[212:215], a[152:155], v[180:183]
    buffer_load_dwordx4 a[76:79], v28, s[20:23], s9 offen offset:3072 sc1
    v_mfma_f32_16x16x32_bf16 v[148:151], a[208:211], a[152:155], v[148:151]
    s_add_u32 s9, s9, 12288
    v_add_f32 v31, 1.0, v31
    v_add_u32 v8, v233, v12
    v_mfma_f32_16x16x32_bf16 v[140:143], a[208:211], a[148:151], v[140:143]
    ds_read_b64_tr_b16 a[204:205], v19 offset:14336
    v_or_b32 v6, s77, v28
    v_mfma_f32_16x16x32_bf16 v[172:175], a[212:215], a[148:151], v[172:175]
    s_waitcnt vmcnt(17)
    ds_read_b64_tr_b16 a[206:207], v19 offset:20480
    v_add_u32 v9, v233, v13
    v_mfma_f32_16x16x32_bf16 v[164:167], a[212:215], a[144:147], v[164:167]
    s_barrier
    v_mfma_f32_16x16x32_bf16 v[132:135], a[208:211], a[144:147], v[132:135]
    s_waitcnt lgkmcnt(4)
    buffer_load_dwordx4 a[80:83], v28, s[20:23], s10 offen offset:0 sc1
    v_mfma_f32_16x16x32_bf16 v[196:199], a[192:195], a[144:147], v[196:199]
    s_lshl_b32 s77, s3, 1
    s_add_u32 s77, s77, 1
    s_cmp_eq_u32 s77, s53
    s_cselect_b32 s77, 0x7ffffff0, 0
    ds_read_b64_tr_b16 a[208:209], v8 offset:0
    v_mfma_f32_16x16x32_bf16 v[228:231], a[196:199], a[144:147], v[228:231]
    ds_read_b64_tr_b16 a[210:211], v8 offset:2048
    v_lshrrev_b32 v2, 2, v1
    v_mfma_f32_16x16x32_bf16 v[236:239], a[196:199], a[148:151], v[236:239]
    buffer_load_dwordx4 a[84:87], v28, s[20:23], s10 offen offset:1024 sc1
    v_mfma_f32_16x16x32_bf16 v[204:207], a[192:195], a[148:151], v[204:207]
    v_lshlrev_b32 v18, 6, v2
    v_mul_u32_u24 v2, 1280, v2
    v_mfma_f32_16x16x32_bf16 v[212:215], a[192:195], a[152:155], v[212:215]
    ds_read_b64_tr_b16 a[212:213], v9 offset:0
    v_and_b32 v19, 3, v1
    v_mfma_f32_16x16x32_bf16 v[244:247], a[196:199], a[152:155], v[244:247]
    ds_read_b64_tr_b16 a[214:215], v9 offset:2048
    v_lshl_add_u32 v18, v19, 3, v18
    v_mfma_f32_16x16x32_bf16 v[252:255], a[196:199], a[156:159], v[252:255]
    buffer_load_dwordx4 a[88:91], v28, s[20:23], s10 offen offset:2048 sc1
    v_mfma_f32_16x16x32_bf16 v[220:223], a[192:195], a[156:159], v[220:223]
    s_waitcnt lgkmcnt(4)
    v_lshl_add_u32 v2, v19, 4, v2
    v_and_b32 v19, 16, v1
    v_mfma_f32_16x16x32_bf16 v[44:47], a[200:203], a[156:159], v[44:47]
    ds_read_b64_tr_b16 a[192:193], v8 offset:4096
    v_lshlrev_b32 v19, 1, v19
    v_mfma_f32_16x16x32_bf16 v[60:63], a[204:207], a[156:159], v[60:63]
    ds_read_b64_tr_b16 a[194:195], v8 offset:6144
    v_xor_b32 v2, v2, v19
    v_mfma_f32_16x16x32_bf16 v[56:59], a[204:207], a[152:155], v[56:59]
    buffer_load_dwordx4 a[92:95], v28, s[20:23], s10 offen offset:3072 sc1
    v_mfma_f32_16x16x32_bf16 v[40:43], a[200:203], a[152:155], v[40:43]
    s_add_u32 s10, s10, 12288
    v_or_b32 v18, v18, v19
    v_xor_b32 v19, 32, v18
    v_mfma_f32_16x16x32_bf16 v[36:39], a[200:203], a[148:151], v[36:39]
    ds_read_b64_tr_b16 a[196:197], v9 offset:4096
    v_add_u32 v2, s39, v2
    v_mfma_f32_16x16x32_bf16 v[52:55], a[204:207], a[148:151], v[52:55]
    s_waitcnt vmcnt(39)
    ds_read_b64_tr_b16 a[198:199], v9 offset:6144
    v_add_u32 v2, s63, v2
    v_mfma_f32_16x16x32_bf16 v[48:51], a[204:207], a[144:147], v[48:51]
    v_add_u32 v18, 147456, v18
    v_add_u32 v19, 147456, v19
    v_mfma_f32_16x16x32_bf16 v[32:35], a[200:203], a[144:147], v[32:35]
    s_waitcnt lgkmcnt(4)
    buffer_load_dwordx4 v4, s[12:15], s38 offen lds
    v_mfma_f32_16x16x32_bf16 a[224:227], a[208:211], a[160:163], a[224:227]
    s_lshl1_add_u32 m0, s36, 115712
    ds_read_b64_tr_b16 a[200:201], v8 offset:8192
    v_or_b32 v7, s77, v28
    v_mfma_f32_16x16x32_bf16 a[240:243], a[212:215], a[160:163], a[240:243]
    ds_read_b64_tr_b16 a[202:203], v8 offset:10240
    v_add_u32 v10, v233, v14
    v_mfma_f32_16x16x32_bf16 a[244:247], a[212:215], a[164:167], a[244:247]
    v_rcp_f32 v30, v30
    v_mfma_f32_16x16x32_bf16 a[228:231], a[208:211], a[164:167], a[228:231]
    buffer_load_dwordx4 v5, s[12:15], s38 offen lds
    v_mfma_f32_16x16x32_bf16 a[232:235], a[208:211], a[168:171], a[232:235]
    s_lshl1_add_u32 m0, s36, 122880
    ds_read_b64_tr_b16 a[204:205], v9 offset:8192
    v_add_u32 v11, v233, v15
    v_mfma_f32_16x16x32_bf16 a[248:251], a[212:215], a[168:171], a[248:251]
    s_waitcnt vmcnt(24)
    ds_read_b64_tr_b16 a[206:207], v9 offset:10240
    s_add_u32 s38, s33, 163968
    v_mfma_f32_16x16x32_bf16 a[252:255], a[212:215], a[172:175], a[252:255]
    s_add_u32 s57, s34, 163968
    v_rcp_f32 v31, v31
    v_mfma_f32_16x16x32_bf16 a[236:239], a[208:211], a[172:175], a[236:239]
    s_waitcnt lgkmcnt(4)
    v_mul_f32 v26, v26, v30
    v_mul_f32 v27, v27, v31
    v_mfma_f32_16x16x32_bf16 a[236:239], a[192:195], a[188:191], a[236:239]
    s_cmp_lt_u32 s3, 2
    s_cselect_b32 s38, s38, s57
    ds_read_b64_tr_b16 a[208:209], v8 offset:12288
    v_mfma_f32_16x16x32_bf16 a[252:255], a[196:199], a[188:191], a[252:255]
    s_and_b32 s56, s70, 0x7ff
    ds_read_b64_tr_b16 a[210:211], v8 offset:14336
    v_cvt_pk_bf16_f32 v170, v26, v27
    v_mfma_f32_16x16x32_bf16 a[248:251], a[196:199], a[184:187], a[248:251]
    buffer_load_dwordx4 v4, s[12:15], s38 offen lds
    v_mfma_f32_16x16x32_bf16 a[232:235], a[192:195], a[184:187], a[232:235]
    s_lshl1_add_u32 m0, s36, 123904
    v_lshlrev_b32 v26, 16, v147
    v_and_b32 v27, 0xffff0000, v147
    v_mfma_f32_16x16x32_bf16 a[228:231], a[192:195], a[180:183], a[228:231]
pg_11:
    s_cbranch_execz pg_ret2
    s_sub_u32 s56, 2047, s56
    ds_read_b64_tr_b16 a[212:213], v9 offset:12288
    v_cmp_eq_u32 s[78:79], s56, v20
    v_mfma_f32_16x16x32_bf16 a[244:247], a[196:199], a[180:183], a[244:247]
    s_waitcnt vmcnt(35)
    ds_read_b64_tr_b16 a[214:215], v9 offset:14336
    v_fma_f32 v26, v26, v25, v24
    v_mfma_f32_16x16x32_bf16 a[240:243], a[196:199], a[176:179], a[240:243]
    buffer_load_dwordx4 v5, s[12:15], s38 offen lds
    v_mfma_f32_16x16x32_bf16 a[224:227], a[192:195], a[176:179], a[224:227]
    s_waitcnt lgkmcnt(4)
    v_fma_f32 v27, v27, v25, v24
    v_mul_f32 v30, s92, v26
    v_mfma_f32_16x16x32_bf16 a[224:227], a[200:203], a[0:3], a[224:227]
    s_lshl1_add_u32 m0, s36, 131072
    ds_read_b64_tr_b16 a[192:193], v8 offset:16384
    v_mul_f32 v31, s92, v27
    v_mfma_f32_16x16x32_bf16 a[240:243], a[204:207], a[0:3], a[240:243]
    s_add_u32 s38, s35, 163968
    ds_read_b64_tr_b16 a[194:195], v8 offset:18432
    s_add_u32 s57, s33, 204928
    v_mfma_f32_16x16x32_bf16 a[244:247], a[204:207], a[4:7], a[244:247]
    s_cmp_lt_u32 s3, 2
    s_cselect_b32 s38, s38, s57
    s_and_b32 s56, s71, 0x7ff
    v_mfma_f32_16x16x32_bf16 a[228:231], a[200:203], a[4:7], a[228:231]
    buffer_load_dwordx4 v4, s[12:15], s38 offen lds
    v_mfma_f32_16x16x32_bf16 a[232:235], a[200:203], a[8:11], a[232:235]
    s_lshl1_add_u32 m0, s36, 132096
    ds_read_b64_tr_b16 a[196:197], v9 offset:16384
    s_sub_u32 s56, 2047, s56
    v_mfma_f32_16x16x32_bf16 a[248:251], a[204:207], a[8:11], a[248:251]
    s_waitcnt vmcnt(22)
    ds_read_b64_tr_b16 a[198:199], v9 offset:18432
    v_cmp_eq_u32 s[80:81], s56, v20
    v_mfma_f32_16x16x32_bf16 a[252:255], a[204:207], a[12:15], a[252:255]
    buffer_load_dwordx4 v5, s[12:15], s38 offen lds
    v_mfma_f32_16x16x32_bf16 a[236:239], a[200:203], a[12:15], a[236:239]
    s_waitcnt lgkmcnt(4)
    v_exp_f32 v30, v30
    v_mfma_f32_16x16x32_bf16 a[236:239], a[208:211], a[28:31], a[236:239]
    s_lshl1_add_u32 m0, s36, 139264
    ds_read_b64_tr_b16 a[200:201], v8 offset:20480
    s_add_u32 s38, s34, 204928
    v_mfma_f32_16x16x32_bf16 a[252:255], a[212:215], a[28:31], a[252:255]
    s_add_u32 s57, s35, 204928
    ds_read_b64_tr_b16 a[202:203], v8 offset:22528
    s_cmp_lt_u32 s3, 2
    s_cselect_b32 s38, s38, s57
    v_mfma_f32_16x16x32_bf16 a[248:251], a[212:215], a[24:27], a[248:251]
    buffer_load_dwordx4 v4, s[12:15], s38 offen lds
    v_mfma_f32_16x16x32_bf16 a[232:235], a[208:211], a[24:27], a[232:235]
    s_cmp_ge_u32 s3, 2
    s_cselect_b32 s68, 0, 0xff00
    s_lshl_b32 s69, 0x10101, s53
    s_or_b32 s68, s68, s69
    s_sub_u32 s48, s48, s47
    v_mfma_f32_16x16x32_bf16 a[228:231], a[208:211], a[20:23], a[228:231]
    s_lshl1_add_u32 m0, s36, 140288
    ds_read_b64_tr_b16 a[204:205], v9 offset:20480
    v_bfe_u32 v12, v1, 3, 2
    v_mfma_f32_16x16x32_bf16 a[244:247], a[212:215], a[20:23], a[244:247]
    s_waitcnt vmcnt(15)
    ds_read_b64_tr_b16 a[206:207], v9 offset:22528
    v_mul_u32_u24 v23, s48, v12
    v_mfma_f32_16x16x32_bf16 a[240:243], a[212:215], a[16:19], a[240:243]
    v_add_u32 v23, s47, v23
    v_and_b32 v12, 7, v1
    v_mfma_f32_16x16x32_bf16 a[224:227], a[208:211], a[16:19], a[224:227]
    s_waitcnt lgkmcnt(4)
    v_mul_u32_u24 v13, 8389632, v12
    v_xor_b32 v23, v23, v13
    v_mfma_f32_16x16x32_bf16 a[224:227], a[192:195], a[32:35], a[224:227]
    ds_read_b64_tr_b16 a[208:209], v8 offset:24576
    v_lshrrev_b32 v13, v12, s93
    v_mfma_f32_16x16x32_bf16 a[240:243], a[196:199], a[32:35], a[240:243]
    ds_read_b64_tr_b16 a[210:211], v8 offset:26624
    v_and_b32 v13, 0x2000, v13
    v_mfma_f32_16x16x32_bf16 a[244:247], a[196:199], a[36:39], a[244:247]
    buffer_load_dwordx4 v5, s[12:15], s38 offen lds
    v_mfma_f32_16x16x32_bf16 a[228:231], a[192:195], a[36:39], a[228:231]
    v_xor_b32 v23, v23, v13
    s_lshr_b32 s56, s2, 4
    v_mfma_f32_16x16x32_bf16 a[232:235], a[192:195], a[40:43], a[232:235]
    s_lshl_b32 s56, s56, 14
    ds_read_b64_tr_b16 a[212:213], v9 offset:24576
    s_and_b32 s46, s2, 8
    v_mfma_f32_16x16x32_bf16 a[248:251], a[196:199], a[40:43], a[248:251]
    s_waitcnt vmcnt(21)
    ds_read_b64_tr_b16 a[214:215], v9 offset:26624
    s_lshl_b32 s46, s46, 9
    v_mfma_f32_16x16x32_bf16 a[252:255], a[196:199], a[44:47], a[252:255]
    s_add_u32 s56, s56, s46
    v_exp_f32 v31, v31
    v_mfma_f32_16x16x32_bf16 a[236:239], a[192:195], a[44:47], a[236:239]
    s_waitcnt lgkmcnt(4)
    v_add_f32 v30, 1.0, v30
    v_add_f32 v31, 1.0, v31
    v_mfma_f32_16x16x32_bf16 a[236:239], a[200:203], a[60:63], a[236:239]
    s_add_u32 s56, s56, 4456448
    ds_read_b64_tr_b16 a[192:193], v8 offset:28672
    s_lshl_b32 s46, s3, 1
    v_mfma_f32_16x16x32_bf16 a[252:255], a[204:207], a[60:63], a[252:255]
    ds_read_b64_tr_b16 a[194:195], v8 offset:30720
    v_bfe_u32 v12, v1, 1, 1
    v_mfma_f32_16x16x32_bf16 a[248:251], a[204:207], a[56:59], a[248:251]
    v_add_u32 v12, s46, v12
    v_lshrrev_b32 v3, v12, s93
    v_mfma_f32_16x16x32_bf16 a[232:235], a[200:203], a[56:59], a[232:235]
    v_and_b32 v3, 0x2000, v3
    v_lshl_add_u32 v3, v12, 9, v3
    v_mfma_f32_16x16x32_bf16 a[228:231], a[200:203], a[52:55], a[228:231]
    ds_read_b64_tr_b16 a[196:197], v9 offset:28672
    v_add_u32 v3, s56, v3
    v_mfma_f32_16x16x32_bf16 a[244:247], a[204:207], a[52:55], a[244:247]
    s_waitcnt vmcnt(12)
    ds_read_b64_tr_b16 a[198:199], v9 offset:30720
    v_and_b32 v12, 1, v1
    v_mfma_f32_16x16x32_bf16 a[240:243], a[204:207], a[48:51], a[240:243]
    v_lshl_add_u32 v3, v12, 7, v3
    v_lshrrev_b32 v12, 2, v1
    v_mfma_f32_16x16x32_bf16 a[224:227], a[200:203], a[48:51], a[224:227]
    s_waitcnt lgkmcnt(4)
    v_min_u32 v12, 1, v12
    v_lshl_or_b32 v3, v12, 30, v3
    v_mfma_f32_16x16x32_bf16 a[224:227], a[208:211], a[64:67], a[224:227]
    s_lshl_b32 s56, 1, s53
    ds_read_b64_tr_b16 a[200:201], v10 offset:0
    v_mov_b32 v128, s56
    v_mfma_f32_16x16x32_bf16 a[240:243], a[212:215], a[64:67], a[240:243]
    ds_read_b64_tr_b16 a[202:203], v10 offset:2048
    v_lshlrev_b32 v129, 8, v128
    v_mfma_f32_16x16x32_bf16 a[244:247], a[212:215], a[68:71], a[244:247]
    v_lshlrev_b32 v130, 16, v128
    v_or_b32 v131, v129, v130
    v_mfma_f32_16x16x32_bf16 a[228:231], a[208:211], a[68:71], a[228:231]
    s_mov_b32 s67, 0
    v_rcp_f32 v30, v30
    v_mfma_f32_16x16x32_bf16 a[232:235], a[208:211], a[72:75], a[232:235]
    s_lshl_b32 s37, s3, 2
    ds_read_b64_tr_b16 a[204:205], v11 offset:0
    s_lshr_b32 s37, 0x7410, s37
    v_mfma_f32_16x16x32_bf16 a[248:251], a[212:215], a[72:75], a[248:251]
    s_waitcnt vmcnt(8)
    ds_read_b64_tr_b16 a[206:207], v11 offset:2048
    s_and_b32 s37, s37, 7
    v_mfma_f32_16x16x32_bf16 a[252:255], a[212:215], a[76:79], a[252:255]
    s_lshl_b32 s37, s37, 13
    v_rcp_f32 v31, v31
    v_mfma_f32_16x16x32_bf16 a[236:239], a[208:211], a[76:79], a[236:239]
    s_waitcnt lgkmcnt(4)
    v_mul_f32 v26, v26, v30
    v_mul_f32 v27, v27, v31
    v_mfma_f32_16x16x32_bf16 a[236:239], a[192:195], a[92:95], a[236:239]
    s_lshl_b32 s56, s3, 9
    ds_read_b64_tr_b16 a[208:209], v10 offset:4096
    v_cvt_pk_bf16_f32 v171, v26, v27
    v_mfma_f32_16x16x32_bf16 a[252:255], a[196:199], a[92:95], a[252:255]
    s_add_u32 s56, s56, 159744
    ds_read_b64_tr_b16 a[210:211], v10 offset:6144
    v_lshlrev_b32 v138, 3, v1
    v_mfma_f32_16x16x32_bf16 a[248:251], a[196:199], a[88:91], a[248:251]
    v_add_u32 v138, s56, v138
    v_mov_b32 v139, 256
    v_mfma_f32_16x16x32_bf16 a[232:235], a[192:195], a[88:91], a[232:235]
    v_cndmask_b32 v139, 0, v139, s[80:81]
    v_lshl_add_u32 v139, v21, 4, v139
    v_mfma_f32_16x16x32_bf16 a[228:231], a[192:195], a[84:87], a[228:231]
    ds_read_b64_tr_b16 a[212:213], v11 offset:4096
    v_add_u32 v139, s56, v139
    v_mfma_f32_16x16x32_bf16 a[244:247], a[196:199], a[84:87], a[244:247]
    s_mov_b32 s59, 3670016
    ds_read_b64_tr_b16 a[214:215], v11 offset:6144
    v_lshlrev_b32 v26, 16, v152
    v_mfma_f32_16x16x32_bf16 a[240:243], a[196:199], a[80:83], a[240:243]
    s_or_b64 s[88:89], s[78:79], s[80:81]
    s_cselect_b32 s59, s59, 0x70000000
    v_and_b32 v27, 0xffff0000, v152
    v_mfma_f32_16x16x32_bf16 a[224:227], a[192:195], a[80:83], a[224:227]
    s_waitcnt lgkmcnt(4)
    v_fma_f32 v26, v26, v25, v24
    v_fma_f32 v27, v27, v25, v24
    v_mfma_f32_16x16x32_bf16 v[68:71], a[200:203], a[160:163], v[68:71]
    ds_read_b64_tr_b16 a[192:193], v10 offset:8192
    v_mul_f32 v30, s92, v26
    v_mfma_f32_16x16x32_bf16 v[100:103], a[204:207], a[160:163], v[100:103]
    ds_read_b64_tr_b16 a[194:195], v10 offset:10240
    v_mul_f32 v31, s92, v27
    v_mfma_f32_16x16x32_bf16 v[108:111], a[204:207], a[164:167], v[108:111]
    v_exp_f32 v30, v30
    v_mfma_f32_16x16x32_bf16 v[76:79], a[200:203], a[164:167], v[76:79]
    v_exp_f32 v31, v31
    v_mfma_f32_16x16x32_bf16 v[84:87], a[200:203], a[168:171], v[84:87]
    ds_read_b64_tr_b16 a[196:197], v11 offset:8192
    v_add_f32 v30, 1.0, v30
    v_mfma_f32_16x16x32_bf16 v[116:119], a[204:207], a[168:171], v[116:119]
    ds_read_b64_tr_b16 a[198:199], v11 offset:10240
    v_add_f32 v31, 1.0, v31
    v_mfma_f32_16x16x32_bf16 v[124:127], a[204:207], a[172:175], v[124:127]
    v_accvgpr_read_b32 v64, a224
    v_accvgpr_read_b32 v65, a225
    v_mfma_f32_16x16x32_bf16 v[92:95], a[200:203], a[172:175], v[92:95]
    s_waitcnt lgkmcnt(4)
    v_accvgpr_read_b32 v66, a226
    v_accvgpr_read_b32 v67, a227
    v_mfma_f32_16x16x32_bf16 v[92:95], a[208:211], a[188:191], v[92:95]
    ds_read_b64_tr_b16 a[200:201], v10 offset:12288
    v_accvgpr_read_b32 v72, a240
    v_mfma_f32_16x16x32_bf16 v[124:127], a[212:215], a[188:191], v[124:127]
    ds_read_b64_tr_b16 a[202:203], v10 offset:14336
    v_accvgpr_read_b32 v73, a241
    v_mfma_f32_16x16x32_bf16 v[116:119], a[212:215], a[184:187], v[116:119]
    v_accvgpr_read_b32 v74, a242
    v_accvgpr_read_b32 v75, a243
    v_mfma_f32_16x16x32_bf16 v[84:87], a[208:211], a[184:187], v[84:87]
    v_cvt_pk_bf16_f32 v64, v64, v65
    v_cvt_pk_bf16_f32 v65, v66, v67
    v_mfma_f32_16x16x32_bf16 v[76:79], a[208:211], a[180:183], v[76:79]
    ds_read_b64_tr_b16 a[204:205], v11 offset:12288
    v_cvt_pk_bf16_f32 v66, v72, v73
    v_mfma_f32_16x16x32_bf16 v[108:111], a[212:215], a[180:183], v[108:111]
    ds_read_b64_tr_b16 a[206:207], v11 offset:14336
    v_cvt_pk_bf16_f32 v67, v74, v75
    v_mfma_f32_16x16x32_bf16 v[100:103], a[212:215], a[176:179], v[100:103]
    buffer_store_dwordx4 v[64:67], v6, s[24:27], s55 offen sc1
    v_mfma_f32_16x16x32_bf16 v[68:71], a[208:211], a[176:179], v[68:71]
    s_waitcnt lgkmcnt(4)
    v_accvgpr_read_b32 v80, a228
    v_accvgpr_read_b32 v81, a229
    v_mfma_f32_16x16x32_bf16 v[68:71], a[192:195], a[0:3], v[68:71]
    s_xor_b32 s55, s55, 1024
    ds_read_b64_tr_b16 a[208:209], v10 offset:16384
    v_accvgpr_read_b32 v82, a230
    v_mfma_f32_16x16x32_bf16 v[100:103], a[196:199], a[0:3], v[100:103]
    ds_read_b64_tr_b16 a[210:211], v10 offset:18432
    v_accvgpr_read_b32 v83, a231
    v_mfma_f32_16x16x32_bf16 v[108:111], a[196:199], a[4:7], v[108:111]
    v_accvgpr_read_b32 v88, a244
    v_accvgpr_read_b32 v89, a245
    v_mfma_f32_16x16x32_bf16 v[76:79], a[192:195], a[4:7], v[76:79]
    v_accvgpr_read_b32 v90, a246
    v_accvgpr_read_b32 v91, a247
    v_mfma_f32_16x16x32_bf16 v[84:87], a[192:195], a[8:11], v[84:87]
    ds_read_b64_tr_b16 a[212:213], v11 offset:16384
    v_cvt_pk_bf16_f32 v80, v80, v81
    v_mfma_f32_16x16x32_bf16 v[116:119], a[196:199], a[8:11], v[116:119]
    ds_read_b64_tr_b16 a[214:215], v11 offset:18432
    v_cvt_pk_bf16_f32 v81, v82, v83
    v_mfma_f32_16x16x32_bf16 v[124:127], a[196:199], a[12:15], v[124:127]
    v_cvt_pk_bf16_f32 v82, v88, v89
    v_cvt_pk_bf16_f32 v83, v90, v91
    v_mfma_f32_16x16x32_bf16 v[92:95], a[192:195], a[12:15], v[92:95]
    s_waitcnt lgkmcnt(4)
    buffer_store_dwordx4 v[80:83], v6, s[24:27], s55 offen sc1
    v_mfma_f32_16x16x32_bf16 v[92:95], a[200:203], a[28:31], v[92:95]
    s_xor_b32 s55, s55, 3072
    ds_read_b64_tr_b16 a[192:193], v10 offset:20480
    v_accvgpr_read_b32 v96, a232
    v_mfma_f32_16x16x32_bf16 v[124:127], a[204:207], a[28:31], v[124:127]
    ds_read_b64_tr_b16 a[194:195], v10 offset:22528
    v_accvgpr_read_b32 v97, a233
    v_mfma_f32_16x16x32_bf16 v[116:119], a[204:207], a[24:27], v[116:119]
    v_accvgpr_read_b32 v98, a234
    v_accvgpr_read_b32 v99, a235
    v_mfma_f32_16x16x32_bf16 v[84:87], a[200:203], a[24:27], v[84:87]
    v_accvgpr_read_b32 v104, a248
    v_accvgpr_read_b32 v105, a249
    v_mfma_f32_16x16x32_bf16 v[76:79], a[200:203], a[20:23], v[76:79]
    ds_read_b64_tr_b16 a[196:197], v11 offset:20480
    v_accvgpr_read_b32 v106, a250
    v_mfma_f32_16x16x32_bf16 v[108:111], a[204:207], a[20:23], v[108:111]
    ds_read_b64_tr_b16 a[198:199], v11 offset:22528
    v_accvgpr_read_b32 v107, a251
    v_mfma_f32_16x16x32_bf16 v[100:103], a[204:207], a[16:19], v[100:103]
    v_cvt_pk_bf16_f32 v96, v96, v97
    v_cvt_pk_bf16_f32 v97, v98, v99
    v_mfma_f32_16x16x32_bf16 v[68:71], a[200:203], a[16:19], v[68:71]
    s_waitcnt lgkmcnt(4)
    v_cvt_pk_bf16_f32 v98, v104, v105
    v_cvt_pk_bf16_f32 v99, v106, v107
    v_mfma_f32_16x16x32_bf16 v[68:71], a[208:211], a[32:35], v[68:71]
    ds_read_b64_tr_b16 a[200:201], v10 offset:24576
    v_accvgpr_read_b32 v112, a236
    v_mfma_f32_16x16x32_bf16 v[100:103], a[212:215], a[32:35], v[100:103]
    ds_read_b64_tr_b16 a[202:203], v10 offset:26624
    v_accvgpr_read_b32 v113, a237
    v_mfma_f32_16x16x32_bf16 v[108:111], a[212:215], a[36:39], v[108:111]
    buffer_store_dwordx4 v[96:99], v7, s[24:27], s55 offen sc1
    v_mfma_f32_16x16x32_bf16 v[76:79], a[208:211], a[36:39], v[76:79]
    s_xor_b32 s55, s55, 1024
    v_accvgpr_read_b32 v114, a238
    v_accvgpr_read_b32 v115, a239
    v_mfma_f32_16x16x32_bf16 v[84:87], a[208:211], a[40:43], v[84:87]
    s_add_u32 m0, s36, 147456
    ds_read_b64_tr_b16 a[204:205], v11 offset:24576
    v_accvgpr_read_b32 v120, a252
    v_mfma_f32_16x16x32_bf16 v[116:119], a[212:215], a[40:43], v[116:119]
    s_add_u32 s38, s34, 123136
    ds_read_b64_tr_b16 a[206:207], v11 offset:26624
    v_accvgpr_read_b32 v121, a253
    v_mfma_f32_16x16x32_bf16 v[124:127], a[212:215], a[44:47], v[124:127]
    s_add_u32 s57, s35, 123136
    v_accvgpr_read_b32 v122, a254
    v_accvgpr_read_b32 v123, a255
    v_mfma_f32_16x16x32_bf16 v[92:95], a[208:211], a[44:47], v[92:95]
    s_waitcnt lgkmcnt(4)
    v_cvt_pk_bf16_f32 v112, v112, v113
    v_cvt_pk_bf16_f32 v113, v114, v115
    v_mfma_f32_16x16x32_bf16 v[92:95], a[192:195], a[60:63], v[92:95]
    s_cmp_lt_u32 s3, 2
    s_cselect_b32 s38, s38, s57
    ds_read_b64_tr_b16 a[208:209], v10 offset:28672
    v_mfma_f32_16x16x32_bf16 v[124:127], a[196:199], a[60:63], v[124:127]
    ds_read_b64_tr_b16 a[210:211], v10 offset:30720
    v_cvt_pk_bf16_f32 v114, v120, v121
    v_mfma_f32_16x16x32_bf16 v[116:119], a[196:199], a[56:59], v[116:119]
    buffer_load_dwordx4 v2, s[12:15], s38 offen lds
    v_mfma_f32_16x16x32_bf16 v[84:87], a[192:195], a[56:59], v[84:87]
    s_add_u32 m0, s36, 151552
    v_cvt_pk_bf16_f32 v115, v122, v123
    v_add_u32 v4, s37, v28
    v_mfma_f32_16x16x32_bf16 v[76:79], a[192:195], a[52:55], v[76:79]
    s_add_u32 s38, s33, 164096
    ds_read_b64_tr_b16 a[212:213], v11 offset:28672
    v_and_b32 v14, 15, v1
    v_mfma_f32_16x16x32_bf16 v[108:111], a[196:199], a[52:55], v[108:111]
    s_waitcnt vmcnt(4)
    ds_read_b64_tr_b16 a[214:215], v11 offset:30720
    v_lshl_add_u32 v14, s3, 4, v14
    v_mfma_f32_16x16x32_bf16 v[100:103], a[196:199], a[48:51], v[100:103]
    s_barrier
    v_mfma_f32_16x16x32_bf16 v[68:71], a[192:195], a[48:51], v[68:71]
    s_waitcnt lgkmcnt(4)
    buffer_store_dwordx4 v[112:115], v7, s[24:27], s55 offen sc1
    v_mfma_f32_16x16x32_bf16 v[68:71], a[200:203], a[64:67], v[68:71]
    s_add_u32 s57, s34, 164096
    ds_read_b64_tr_b16 a[192:193], v8 offset:32768
    v_lshlrev_b32 v14, 6, v14
    v_mfma_f32_16x16x32_bf16 v[100:103], a[204:207], a[64:67], v[100:103]
    s_cmp_lt_u32 s3, 2
    s_cselect_b32 s38, s38, s57
    ds_read_b64_tr_b16 a[194:195], v8 offset:34816
    v_mfma_f32_16x16x32_bf16 v[108:111], a[204:207], a[68:71], v[108:111]
    s_getpc_b64 s[8:9]
ct5:
    s_add_u32 s8, s8, post_code-ct5
    s_addc_u32 s9, s9, 0
    global_load_dword a216, v14, s[8:9]
    v_mfma_f32_16x16x32_bf16 v[76:79], a[200:203], a[68:71], v[76:79]
    buffer_load_dwordx4 v2, s[12:15], s38 offen lds
    v_mfma_f32_16x16x32_bf16 v[84:87], a[200:203], a[72:75], v[84:87]
    s_add_u32 m0, s36, 155648
    ds_read_b64_tr_b16 a[196:197], v9 offset:32768
    s_add_u32 s38, s35, 164096
    v_mfma_f32_16x16x32_bf16 v[116:119], a[204:207], a[72:75], v[116:119]
    s_add_u32 s57, s33, 205056
    ds_read_b64_tr_b16 a[198:199], v9 offset:34816
    s_cmp_lt_u32 s3, 2
    s_cselect_b32 s38, s38, s57
    v_mfma_f32_16x16x32_bf16 v[124:127], a[204:207], a[76:79], v[124:127]
    buffer_load_dwordx4 v2, s[12:15], s38 offen lds
    v_mfma_f32_16x16x32_bf16 v[92:95], a[200:203], a[76:79], v[92:95]
    s_waitcnt lgkmcnt(4)
    v_rcp_f32 v30, v30
    v_mfma_f32_16x16x32_bf16 v[92:95], a[208:211], a[92:95], v[92:95]
    s_add_u32 m0, s36, 159744
    ds_read_b64_tr_b16 a[200:201], v8 offset:36864
    s_add_u32 s38, s34, 205056
    v_mfma_f32_16x16x32_bf16 v[124:127], a[212:215], a[92:95], v[124:127]
    s_add_u32 s57, s35, 205056
    ds_read_b64_tr_b16 a[202:203], v8 offset:38912
    s_cmp_lt_u32 s3, 2
    s_cselect_b32 s38, s38, s57
    v_mfma_f32_16x16x32_bf16 v[116:119], a[212:215], a[88:91], v[116:119]
    buffer_load_dwordx4 v2, s[12:15], s38 offen lds
    v_mfma_f32_16x16x32_bf16 v[84:87], a[208:211], a[88:91], v[84:87]
    s_xor_b32 s55, s55, 3072
    v_rcp_f32 v31, v31
    v_mfma_f32_16x16x32_bf16 v[76:79], a[208:211], a[84:87], v[76:79]
    s_add_u32 s55, s55, 16384
    ds_read_b64_tr_b16 a[204:205], v9 offset:36864
    v_mul_f32 v26, v26, v30
    v_mfma_f32_16x16x32_bf16 v[108:111], a[212:215], a[84:87], v[108:111]
    ds_read_b64_tr_b16 a[206:207], v9 offset:38912
    v_mul_f32 v27, v27, v31
    v_mfma_f32_16x16x32_bf16 v[100:103], a[212:215], a[80:83], v[100:103]
    v_cvt_pk_bf16_f32 v176, v26, v27
    v_lshlrev_b32 v26, 16, v153
    v_mfma_f32_16x16x32_bf16 v[68:71], a[208:211], a[80:83], v[68:71]
    s_waitcnt lgkmcnt(4)
    v_and_b32 v27, 0xffff0000, v153
    v_fma_f32 v26, v26, v25, v24
    v_mfma_f32_16x16x32_bf16 v[132:135], a[192:195], a[160:163], v[132:135]
    ds_read_b64_tr_b16 a[208:209], v8 offset:40960
    v_fma_f32 v27, v27, v25, v24
    v_mfma_f32_16x16x32_bf16 v[164:167], a[196:199], a[160:163], v[164:167]
    ds_read_b64_tr_b16 a[210:211], v8 offset:43008
    v_mul_f32 v30, s92, v26
    v_mfma_f32_16x16x32_bf16 v[172:175], a[196:199], a[164:167], v[172:175]
    v_mul_f32 v31, s92, v27
    v_mfma_f32_16x16x32_bf16 v[140:143], a[192:195], a[164:167], v[140:143]
    v_exp_f32 v30, v30
    v_mfma_f32_16x16x32_bf16 v[148:151], a[192:195], a[168:171], v[148:151]
    ds_read_b64_tr_b16 a[212:213], v9 offset:40960
    v_mfma_f32_16x16x32_bf16 v[180:183], a[196:199], a[168:171], v[180:183]
    ds_read_b64_tr_b16 a[214:215], v9 offset:43008
    v_mfma_f32_16x16x32_bf16 v[188:191], a[196:199], a[172:175], v[188:191]
    v_cvt_pk_bf16_f32 v68, v68, v69
    v_cvt_pk_bf16_f32 v69, v70, v71
    v_mfma_f32_16x16x32_bf16 v[156:159], a[192:195], a[172:175], v[156:159]
    s_waitcnt lgkmcnt(4)
    v_cvt_pk_bf16_f32 v70, v100, v101
    v_cvt_pk_bf16_f32 v71, v102, v103
    v_mfma_f32_16x16x32_bf16 v[156:159], a[200:203], a[188:191], v[156:159]
    ds_read_b64_tr_b16 a[192:193], v8 offset:45056
    v_cvt_pk_bf16_f32 v76, v76, v77
    v_mfma_f32_16x16x32_bf16 v[188:191], a[204:207], a[188:191], v[188:191]
    ds_read_b64_tr_b16 a[194:195], v8 offset:47104
    v_cvt_pk_bf16_f32 v77, v78, v79
    v_mfma_f32_16x16x32_bf16 v[180:183], a[204:207], a[184:187], v[180:183]
    buffer_store_dwordx4 v[68:71], v6, s[24:27], s55 offen sc1
    v_mfma_f32_16x16x32_bf16 v[148:151], a[200:203], a[184:187], v[148:151]
    s_xor_b32 s55, s55, 1024
    v_cvt_pk_bf16_f32 v78, v108, v109
    v_cvt_pk_bf16_f32 v79, v110, v111
    v_mfma_f32_16x16x32_bf16 v[140:143], a[200:203], a[180:183], v[140:143]
    ds_read_b64_tr_b16 a[196:197], v9 offset:45056
    v_cvt_pk_bf16_f32 v84, v84, v85
    v_mfma_f32_16x16x32_bf16 v[172:175], a[204:207], a[180:183], v[172:175]
    ds_read_b64_tr_b16 a[198:199], v9 offset:47104
    v_cvt_pk_bf16_f32 v85, v86, v87
    v_mfma_f32_16x16x32_bf16 v[164:167], a[204:207], a[176:179], v[164:167]
    v_cvt_pk_bf16_f32 v86, v116, v117
    v_cvt_pk_bf16_f32 v87, v118, v119
    v_mfma_f32_16x16x32_bf16 v[132:135], a[200:203], a[176:179], v[132:135]
    s_waitcnt lgkmcnt(4)
    v_cvt_pk_bf16_f32 v92, v92, v93
    v_cvt_pk_bf16_f32 v93, v94, v95
    v_mfma_f32_16x16x32_bf16 v[132:135], a[208:211], a[0:3], v[132:135]
    ds_read_b64_tr_b16 a[200:201], v8 offset:49152
    v_cvt_pk_bf16_f32 v94, v124, v125
    v_mfma_f32_16x16x32_bf16 v[164:167], a[212:215], a[0:3], v[164:167]
    ds_read_b64_tr_b16 a[202:203], v8 offset:51200
    v_cvt_pk_bf16_f32 v95, v126, v127
    v_mfma_f32_16x16x32_bf16 v[172:175], a[212:215], a[4:7], v[172:175]
    buffer_store_dwordx4 v[76:79], v6, s[24:27], s55 offen sc1
    v_mfma_f32_16x16x32_bf16 v[140:143], a[208:211], a[4:7], v[140:143]
    s_xor_b32 s55, s55, 3072
    v_exp_f32 v31, v31
    v_mfma_f32_16x16x32_bf16 v[148:151], a[208:211], a[8:11], v[148:151]
    ds_read_b64_tr_b16 a[204:205], v9 offset:49152
    v_add_f32 v30, 1.0, v30
    v_mfma_f32_16x16x32_bf16 v[180:183], a[212:215], a[8:11], v[180:183]
    ds_read_b64_tr_b16 a[206:207], v9 offset:51200
    v_add_f32 v31, 1.0, v31
    v_mfma_f32_16x16x32_bf16 v[188:191], a[212:215], a[12:15], v[188:191]
    v_rcp_f32 v30, v30
    v_mfma_f32_16x16x32_bf16 v[156:159], a[208:211], a[12:15], v[156:159]
    s_waitcnt lgkmcnt(4)
    v_rcp_f32 v31, v31
    v_mfma_f32_16x16x32_bf16 v[156:159], a[192:195], a[28:31], v[156:159]
    ds_read_b64_tr_b16 a[208:209], v8 offset:53248
    v_mul_f32 v26, v26, v30
    v_mfma_f32_16x16x32_bf16 v[188:191], a[196:199], a[28:31], v[188:191]
    ds_read_b64_tr_b16 a[210:211], v8 offset:55296
    v_mul_f32 v27, v27, v31
    v_mfma_f32_16x16x32_bf16 v[180:183], a[196:199], a[24:27], v[180:183]
    v_cvt_pk_bf16_f32 v177, v26, v27
    v_lshlrev_b32 v26, 16, v154
    v_mfma_f32_16x16x32_bf16 v[148:151], a[192:195], a[24:27], v[148:151]
    v_and_b32 v27, 0xffff0000, v154
    v_fma_f32 v26, v26, v25, v24
    v_mfma_f32_16x16x32_bf16 v[140:143], a[192:195], a[20:23], v[140:143]
    ds_read_b64_tr_b16 a[212:213], v9 offset:53248
    v_fma_f32 v27, v27, v25, v24
    v_mfma_f32_16x16x32_bf16 v[172:175], a[196:199], a[20:23], v[172:175]
    ds_read_b64_tr_b16 a[214:215], v9 offset:55296
    v_mul_f32 v30, s92, v26
    v_mfma_f32_16x16x32_bf16 v[164:167], a[196:199], a[16:19], v[164:167]
    buffer_store_dwordx4 v[84:87], v7, s[24:27], s55 offen sc1
    v_mfma_f32_16x16x32_bf16 v[132:135], a[192:195], a[16:19], v[132:135]
    s_waitcnt lgkmcnt(4)
    v_mul_f32 v31, s92, v27
    s_xor_b32 s55, s55, 1024
    v_mfma_f32_16x16x32_bf16 v[132:135], a[200:203], a[32:35], v[132:135]
    ds_read_b64_tr_b16 a[192:193], v8 offset:57344
    v_mfma_f32_16x16x32_bf16 v[164:167], a[204:207], a[32:35], v[164:167]
    ds_read_b64_tr_b16 a[194:195], v8 offset:59392
    v_mfma_f32_16x16x32_bf16 v[172:175], a[204:207], a[36:39], v[172:175]
    v_exp_f32 v30, v30
    v_mfma_f32_16x16x32_bf16 v[140:143], a[200:203], a[36:39], v[140:143]
    v_exp_f32 v31, v31
    v_mfma_f32_16x16x32_bf16 v[148:151], a[200:203], a[40:43], v[148:151]
    ds_read_b64_tr_b16 a[196:197], v9 offset:57344
    v_add_f32 v30, 1.0, v30
    v_mfma_f32_16x16x32_bf16 v[180:183], a[204:207], a[40:43], v[180:183]
    ds_read_b64_tr_b16 a[198:199], v9 offset:59392
    v_add_f32 v31, 1.0, v31
    v_mfma_f32_16x16x32_bf16 v[188:191], a[204:207], a[44:47], v[188:191]
    v_rcp_f32 v30, v30
    v_mfma_f32_16x16x32_bf16 v[156:159], a[200:203], a[44:47], v[156:159]
    s_waitcnt lgkmcnt(4)
    v_rcp_f32 v31, v31
    v_mfma_f32_16x16x32_bf16 v[156:159], a[208:211], a[60:63], v[156:159]
    ds_read_b64_tr_b16 a[200:201], v8 offset:61440
    v_mul_f32 v26, v26, v30
    v_mfma_f32_16x16x32_bf16 v[188:191], a[212:215], a[60:63], v[188:191]
    ds_read_b64_tr_b16 a[202:203], v8 offset:63488
    v_mul_f32 v27, v27, v31
    v_mfma_f32_16x16x32_bf16 v[180:183], a[212:215], a[56:59], v[180:183]
    buffer_load_dword v137, v136, s[24:27], s59 offen offset:128 sc1
    v_mfma_f32_16x16x32_bf16 v[148:151], a[208:211], a[56:59], v[148:151]
    buffer_store_dwordx4 v[92:95], v7, s[24:27], s55 offen sc1
    v_mfma_f32_16x16x32_bf16 v[140:143], a[208:211], a[52:55], v[140:143]
    s_xor_b32 s55, s55, 3072
    ds_read_b64_tr_b16 a[204:205], v9 offset:61440
    v_cvt_pk_bf16_f32 v178, v26, v27
    v_mfma_f32_16x16x32_bf16 v[172:175], a[212:215], a[52:55], v[172:175]
    s_add_u32 s55, s55, 16384
    ds_read_b64_tr_b16 a[206:207], v9 offset:63488
    v_lshlrev_b32 v26, 16, v155
    v_mfma_f32_16x16x32_bf16 v[164:167], a[212:215], a[48:51], v[164:167]
    v_and_b32 v27, 0xffff0000, v155
    v_fma_f32 v26, v26, v25, v24
    v_mfma_f32_16x16x32_bf16 v[132:135], a[208:211], a[48:51], v[132:135]
    s_waitcnt lgkmcnt(4)
    v_fma_f32 v27, v27, v25, v24
    v_mul_f32 v30, s92, v26
    v_mfma_f32_16x16x32_bf16 v[132:135], a[192:195], a[64:67], v[132:135]
    ds_read_b64_tr_b16 a[208:209], v10 offset:32768
    v_mul_f32 v31, s92, v27
    v_mfma_f32_16x16x32_bf16 v[164:167], a[196:199], a[64:67], v[164:167]
    ds_read_b64_tr_b16 a[210:211], v10 offset:34816
    v_bfe_u32 v224, v1, 3, 1
    v_mfma_f32_16x16x32_bf16 v[172:175], a[196:199], a[68:71], v[172:175]
    s_load_dword s67, s[86:87], s5 glc
    v_exp_f32 v30, v30
    v_mfma_f32_16x16x32_bf16 v[140:143], a[192:195], a[68:71], v[140:143]
    v_exp_f32 v31, v31
    v_mfma_f32_16x16x32_bf16 v[148:151], a[192:195], a[72:75], v[148:151]
    ds_read_b64_tr_b16 a[212:213], v11 offset:32768
    v_add_f32 v30, 1.0, v30
    v_mfma_f32_16x16x32_bf16 v[180:183], a[196:199], a[72:75], v[180:183]
    ds_read_b64_tr_b16 a[214:215], v11 offset:34816
    v_add_f32 v31, 1.0, v31
    v_mfma_f32_16x16x32_bf16 v[188:191], a[196:199], a[76:79], v[188:191]
    v_rcp_f32 v30, v30
    v_mfma_f32_16x16x32_bf16 v[156:159], a[192:195], a[76:79], v[156:159]
    s_waitcnt lgkmcnt(4)
    v_rcp_f32 v31, v31
    v_mfma_f32_16x16x32_bf16 v[156:159], a[200:203], a[92:95], v[156:159]
    ds_read_b64_tr_b16 a[192:193], v10 offset:36864
    v_mul_f32 v26, v26, v30
    v_mfma_f32_16x16x32_bf16 v[188:191], a[204:207], a[92:95], v[188:191]
    ds_read_b64_tr_b16 a[194:195], v10 offset:38912
    v_mul_f32 v27, v27, v31
    v_mfma_f32_16x16x32_bf16 v[180:183], a[204:207], a[88:91], v[180:183]
    v_cvt_pk_bf16_f32 v179, v26, v27
    v_lshlrev_b32 v26, 16, v160
    v_mfma_f32_16x16x32_bf16 v[148:151], a[200:203], a[88:91], v[148:151]
    v_and_b32 v27, 0xffff0000, v160
    v_fma_f32 v26, v26, v25, v24
    v_mfma_f32_16x16x32_bf16 v[140:143], a[200:203], a[84:87], v[140:143]
    ds_read_b64_tr_b16 a[196:197], v11 offset:36864
    v_fma_f32 v27, v27, v25, v24
    v_mfma_f32_16x16x32_bf16 v[172:175], a[204:207], a[84:87], v[172:175]
    ds_read_b64_tr_b16 a[198:199], v11 offset:38912
    v_mul_f32 v30, s92, v26
    v_mfma_f32_16x16x32_bf16 v[164:167], a[204:207], a[80:83], v[164:167]
    s_waitcnt vmcnt(9)
    v_mul_f32 v31, s92, v27
    v_lshlrev_b32 v224, 1, v224
    v_mfma_f32_16x16x32_bf16 v[132:135], a[200:203], a[80:83], v[132:135]
    s_waitcnt lgkmcnt(4)
    v_exp_f32 v30, v30
    v_mfma_f32_16x16x32_bf16 v[196:199], a[208:211], a[160:163], v[196:199]
    ds_read_b64_tr_b16 a[200:201], v10 offset:40960
    v_lshrrev_b32 v225, 4, v1
    v_mfma_f32_16x16x32_bf16 v[228:231], a[212:215], a[160:163], v[228:231]
    ds_read_b64_tr_b16 a[202:203], v10 offset:43008
    v_sub_u32 v224, v225, v224
    v_mfma_f32_16x16x32_bf16 v[236:239], a[212:215], a[164:167], v[236:239]
    buffer_atomic_or v128, v3, s[24:27], 0 offen offset:0
    v_mfma_f32_16x16x32_bf16 v[204:207], a[208:211], a[164:167], v[204:207]
pg_12:
    s_cbranch_execz pg_ret2
    v_exp_f32 v31, v31
    v_mfma_f32_16x16x32_bf16 v[212:215], a[208:211], a[168:171], v[212:215]
    ds_read_b64_tr_b16 a[204:205], v11 offset:40960
    v_add_f32 v30, 1.0, v30
    v_mfma_f32_16x16x32_bf16 v[244:247], a[212:215], a[168:171], v[244:247]
    ds_read_b64_tr_b16 a[206:207], v11 offset:43008
    v_add_f32 v31, 1.0, v31
    v_mfma_f32_16x16x32_bf16 v[252:255], a[212:215], a[172:175], v[252:255]
    v_cvt_pk_bf16_f32 v132, v132, v133
    v_cvt_pk_bf16_f32 v133, v134, v135
    v_mfma_f32_16x16x32_bf16 v[220:223], a[208:211], a[172:175], v[220:223]
    s_waitcnt lgkmcnt(4)
    v_cvt_pk_bf16_f32 v134, v164, v165
    v_cvt_pk_bf16_f32 v135, v166, v167
    v_mfma_f32_16x16x32_bf16 v[220:223], a[192:195], a[188:191], v[220:223]
    ds_read_b64_tr_b16 a[208:209], v10 offset:45056
    v_cvt_pk_bf16_f32 v140, v140, v141
    v_mfma_f32_16x16x32_bf16 v[252:255], a[196:199], a[188:191], v[252:255]
    ds_read_b64_tr_b16 a[210:211], v10 offset:47104
    v_cvt_pk_bf16_f32 v141, v142, v143
    v_mfma_f32_16x16x32_bf16 v[244:247], a[196:199], a[184:187], v[244:247]
    buffer_store_dwordx4 v[132:135], v6, s[24:27], s55 offen sc1
    v_mfma_f32_16x16x32_bf16 v[212:215], a[192:195], a[184:187], v[212:215]
    s_xor_b32 s55, s55, 1024
    v_cvt_pk_bf16_f32 v142, v172, v173
    v_cvt_pk_bf16_f32 v143, v174, v175
    v_mfma_f32_16x16x32_bf16 v[204:207], a[192:195], a[180:183], v[204:207]
    ds_read_b64_tr_b16 a[212:213], v11 offset:45056
    v_cvt_pk_bf16_f32 v148, v148, v149
    v_mfma_f32_16x16x32_bf16 v[236:239], a[196:199], a[180:183], v[236:239]
    ds_read_b64_tr_b16 a[214:215], v11 offset:47104
    v_cvt_pk_bf16_f32 v149, v150, v151
    v_mfma_f32_16x16x32_bf16 v[228:231], a[196:199], a[176:179], v[228:231]
    v_cvt_pk_bf16_f32 v150, v180, v181
    v_cvt_pk_bf16_f32 v151, v182, v183
    v_mfma_f32_16x16x32_bf16 v[196:199], a[192:195], a[176:179], v[196:199]
    s_waitcnt lgkmcnt(4)
    v_cvt_pk_bf16_f32 v156, v156, v157
    v_cvt_pk_bf16_f32 v157, v158, v159
    v_mfma_f32_16x16x32_bf16 v[196:199], a[200:203], a[0:3], v[196:199]
    ds_read_b64_tr_b16 a[192:193], v10 offset:49152
    v_cvt_pk_bf16_f32 v158, v188, v189
    v_mfma_f32_16x16x32_bf16 v[228:231], a[204:207], a[0:3], v[228:231]
    ds_read_b64_tr_b16 a[194:195], v10 offset:51200
    v_cvt_pk_bf16_f32 v159, v190, v191
    v_mfma_f32_16x16x32_bf16 v[236:239], a[204:207], a[4:7], v[236:239]
    buffer_store_dwordx4 v[140:143], v6, s[24:27], s55 offen sc1
    v_mfma_f32_16x16x32_bf16 v[204:207], a[200:203], a[4:7], v[204:207]
    s_xor_b32 s55, s55, 3072
    v_rcp_f32 v30, v30
    v_mfma_f32_16x16x32_bf16 v[212:215], a[200:203], a[8:11], v[212:215]
    ds_read_b64_tr_b16 a[196:197], v11 offset:49152
    v_and_b32 v225, 1, v1
    v_mfma_f32_16x16x32_bf16 v[244:247], a[204:207], a[8:11], v[244:247]
    ds_read_b64_tr_b16 a[198:199], v11 offset:51200
    v_lshlrev_b32 v225, 4, v225
    v_mfma_f32_16x16x32_bf16 v[252:255], a[204:207], a[12:15], v[252:255]
    s_andn2_b32 s69, s67, s68
    s_and_b32 s69, s69, 255
    s_or_b32 s68, s68, s69
    v_mfma_f32_16x16x32_bf16 v[220:223], a[200:203], a[12:15], v[220:223]
    s_waitcnt lgkmcnt(4)
    v_readlane_b32 s56, v23, 0
    v_mov_b32 v226, 0x3f80
    v_mfma_f32_16x16x32_bf16 v[220:223], a[208:211], a[28:31], v[220:223]
    s_add_u32 m0, s37, 0
    ds_read_b64_tr_b16 a[200:201], v10 offset:53248
    v_lshlrev_b32 v225, v225, v226
    v_mfma_f32_16x16x32_bf16 v[252:255], a[212:215], a[28:31], v[252:255]
    s_bitcmp1_b32 s69, 0
    s_cselect_b32 s56, s56, 0x70000000
    s_cselect_b32 m0, m0, 0x30000
    ds_read_b64_tr_b16 a[202:203], v10 offset:55296
    v_mfma_f32_16x16x32_bf16 v[244:247], a[212:215], a[24:27], v[244:247]
    buffer_load_dwordx4 v28, s[24:27], s56 offen sc1 lds
    v_mfma_f32_16x16x32_bf16 v[212:215], a[208:211], a[24:27], v[212:215]
    v_readlane_b32 s56, v23, 1
    v_bfe_u32 v226, v1, 1, 2
    v_mfma_f32_16x16x32_bf16 v[204:207], a[208:211], a[20:23], v[204:207]
    s_waitcnt vmcnt(5)
    ds_read_b64_tr_b16 a[204:205], v11 offset:53248
    v_cmp_ne_u32 s[78:79], 24, v137
    v_mfma_f32_16x16x32_bf16 v[236:239], a[212:215], a[20:23], v[236:239]
    s_cmp_eq_u64 s[78:79], 0
    s_cselect_b32 s44, s59, 0x70000000
    ds_read_b64_tr_b16 a[206:207], v11 offset:55296
    v_mfma_f32_16x16x32_bf16 v[228:231], a[212:215], a[16:19], v[228:231]
    buffer_load_dwordx4 v[240:243], v192, s[24:27], s44 offen sc1
    v_mfma_f32_16x16x32_bf16 v[196:199], a[208:211], a[16:19], v[196:199]
    s_waitcnt lgkmcnt(4)
    v_rcp_f32 v31, v31
    v_mfma_f32_16x16x32_bf16 v[196:199], a[192:195], a[32:35], v[196:199]
    s_add_u32 m0, s37, 1024
    ds_read_b64_tr_b16 a[208:209], v10 offset:57344
    v_mul_f32 v26, v26, v30
    v_mfma_f32_16x16x32_bf16 v[228:231], a[196:199], a[32:35], v[228:231]
    s_bitcmp1_b32 s69, 1
    s_cselect_b32 s56, s56, 0x70000000
    s_cselect_b32 m0, m0, 0x30000
    ds_read_b64_tr_b16 a[210:211], v10 offset:59392
    v_mfma_f32_16x16x32_bf16 v[236:239], a[196:199], a[36:39], v[236:239]
    buffer_load_dwordx4 v28, s[24:27], s56 offen sc1 lds
    v_mfma_f32_16x16x32_bf16 v[204:207], a[192:195], a[36:39], v[204:207]
    v_readlane_b32 s56, v23, 2
    v_mul_f32 v27, v27, v31
    v_mfma_f32_16x16x32_bf16 v[212:215], a[192:195], a[40:43], v[212:215]
    s_add_u32 m0, s37, 2048
    ds_read_b64_tr_b16 a[212:213], v11 offset:57344
    v_cvt_pk_bf16_f32 v184, v26, v27
    v_mfma_f32_16x16x32_bf16 v[244:247], a[196:199], a[40:43], v[244:247]
    s_bitcmp1_b32 s69, 2
    s_cselect_b32 s56, s56, 0x70000000
    s_cselect_b32 m0, m0, 0x30000
    ds_read_b64_tr_b16 a[214:215], v11 offset:59392
    v_mfma_f32_16x16x32_bf16 v[252:255], a[196:199], a[44:47], v[252:255]
    buffer_load_dwordx4 v28, s[24:27], s56 offen sc1 lds
    v_mfma_f32_16x16x32_bf16 v[220:223], a[192:195], a[44:47], v[220:223]
    s_waitcnt lgkmcnt(4)
    v_readlane_b32 s56, v23, 3
    v_lshlrev_b32 v26, 16, v161
    v_mfma_f32_16x16x32_bf16 v[220:223], a[200:203], a[60:63], v[220:223]
    s_add_u32 m0, s37, 3072
    ds_read_b64_tr_b16 a[192:193], v10 offset:61440
    v_and_b32 v27, 0xffff0000, v161
    v_mfma_f32_16x16x32_bf16 v[252:255], a[204:207], a[60:63], v[252:255]
    s_bitcmp1_b32 s69, 3
    s_cselect_b32 s56, s56, 0x70000000
    s_cselect_b32 m0, m0, 0x30000
    ds_read_b64_tr_b16 a[194:195], v10 offset:63488
    v_mfma_f32_16x16x32_bf16 v[244:247], a[204:207], a[56:59], v[244:247]
    buffer_store_dwordx4 v[148:151], v7, s[24:27], s55 offen sc1
    v_mfma_f32_16x16x32_bf16 v[212:215], a[200:203], a[56:59], v[212:215]
    s_xor_b32 s55, s55, 1024
    v_fma_f32 v26, v26, v25, v24
    v_fma_f32 v27, v27, v25, v24
    v_mfma_f32_16x16x32_bf16 v[204:207], a[200:203], a[52:55], v[204:207]
    ds_read_b64_tr_b16 a[196:197], v11 offset:61440
    v_mul_f32 v30, s92, v26
    v_mfma_f32_16x16x32_bf16 v[236:239], a[204:207], a[52:55], v[236:239]
    s_waitcnt vmcnt(13)
    ds_read_b64_tr_b16 a[198:199], v11 offset:63488
    v_mul_f32 v31, s92, v27
    v_mfma_f32_16x16x32_bf16 v[228:231], a[204:207], a[48:51], v[228:231]
    s_barrier
    v_mfma_f32_16x16x32_bf16 v[196:199], a[200:203], a[48:51], v[196:199]
    s_waitcnt lgkmcnt(4)
    buffer_load_dwordx4 v28, s[24:27], s56 offen sc1 lds
    v_mfma_f32_16x16x32_bf16 v[196:199], a[208:211], a[64:67], v[196:199]
    ds_read_b64_tr_b16 a[200:201], v18 offset:0
    v_readlane_b32 s56, v23, 4
    v_mfma_f32_16x16x32_bf16 v[228:231], a[212:215], a[64:67], v[228:231]
    s_add_u32 m0, s37, 4096
    ds_read_b64_tr_b16 a[202:203], v18 offset:1024
    v_lshl_add_u32 v226, v224, 2, v226
    v_mfma_f32_16x16x32_bf16 v[236:239], a[212:215], a[68:71], v[236:239]
    buffer_store_dwordx4 v[156:159], v7, s[24:27], s55 offen sc1
    v_mfma_f32_16x16x32_bf16 v[204:207], a[208:211], a[68:71], v[204:207]
    s_bitcmp1_b32 s69, 4
    s_cselect_b32 s56, s56, 0x70000000
    s_cselect_b32 m0, m0, 0x30000
    v_mfma_f32_16x16x32_bf16 v[212:215], a[208:211], a[72:75], v[212:215]
    s_xor_b32 s55, s55, 3072
    ds_read_b64_tr_b16 a[204:205], v19 offset:0
    v_cmp_eq_u32 s[10:11], 0, v226
    v_mfma_f32_16x16x32_bf16 v[244:247], a[212:215], a[72:75], v[244:247]
    s_add_u32 s55, s55, 16384
    ds_read_b64_tr_b16 a[206:207], v19 offset:1024
    v_cndmask_b32 v208, 0, v225, s[10:11]
    v_mfma_f32_16x16x32_bf16 v[252:255], a[212:215], a[76:79], v[252:255]
    v_exp_f32 v30, v30
    v_mfma_f32_16x16x32_bf16 v[220:223], a[208:211], a[76:79], v[220:223]
    s_waitcnt lgkmcnt(4)
    buffer_load_dwordx4 v28, s[24:27], s56 offen sc1 lds
    v_mfma_f32_16x16x32_bf16 v[220:223], a[192:195], a[92:95], v[220:223]
    ds_read_b64_tr_b16 a[208:209], v18 offset:2048
    v_readlane_b32 s56, v23, 5
    v_mfma_f32_16x16x32_bf16 v[252:255], a[196:199], a[92:95], v[252:255]
    s_add_u32 m0, s37, 5120
    ds_read_b64_tr_b16 a[210:211], v18 offset:3072
    v_cmp_eq_u32 s[10:11], 1, v226
    v_mfma_f32_16x16x32_bf16 v[244:247], a[196:199], a[88:91], v[244:247]
    s_bitcmp1_b32 s69, 5
    s_cselect_b32 s56, s56, 0x70000000
    s_cselect_b32 m0, m0, 0x30000
    v_mfma_f32_16x16x32_bf16 v[212:215], a[192:195], a[88:91], v[212:215]
    buffer_load_dwordx4 v28, s[24:27], s56 offen sc1 lds
    v_mfma_f32_16x16x32_bf16 v[204:207], a[192:195], a[84:87], v[204:207]
    ds_read_b64_tr_b16 a[212:213], v19 offset:2048
    v_readlane_b32 s56, v23, 6
    v_mfma_f32_16x16x32_bf16 v[236:239], a[196:199], a[84:87], v[236:239]
    s_add_u32 m0, s37, 6144
    ds_read_b64_tr_b16 a[214:215], v19 offset:3072
    v_cndmask_b32 v209, 0, v225, s[10:11]
    v_mfma_f32_16x16x32_bf16 v[228:231], a[196:199], a[80:83], v[228:231]
    s_waitcnt vmcnt(12)
    v_exp_f32 v31, v31
    v_mfma_f32_16x16x32_bf16 v[196:199], a[192:195], a[80:83], v[196:199]
    s_waitcnt lgkmcnt(4)
    v_add_f32 v30, 1.0, v30
    v_add_f32 v31, 1.0, v31
    v_mfma_f32_16x16x32_bf16 v[32:35], a[200:203], a[160:163], v[32:35]
    s_bitcmp1_b32 s69, 6
    s_cselect_b32 s56, s56, 0x70000000
    s_cselect_b32 m0, m0, 0x30000
    ds_read_b64_tr_b16 a[192:193], v18 offset:4096
    v_mfma_f32_16x16x32_bf16 v[48:51], a[204:207], a[160:163], v[48:51]
    ds_read_b64_tr_b16 a[194:195], v18 offset:5120
    v_cmp_eq_u32 s[10:11], 2, v226
    v_mfma_f32_16x16x32_bf16 v[52:55], a[204:207], a[164:167], v[52:55]
    buffer_atomic_or v128, v3, s[24:27], 0 offen offset:256
    v_mfma_f32_16x16x32_bf16 v[36:39], a[200:203], a[164:167], v[36:39]
    buffer_load_dwordx4 v28, s[24:27], s56 offen sc1 lds
    v_mfma_f32_16x16x32_bf16 v[40:43], a[200:203], a[168:171], v[40:43]
    ds_read_b64_tr_b16 a[196:197], v19 offset:4096
    v_readlane_b32 s56, v23, 7
    v_mfma_f32_16x16x32_bf16 v[56:59], a[204:207], a[168:171], v[56:59]
    s_add_u32 m0, s37, 7168
    ds_read_b64_tr_b16 a[198:199], v19 offset:5120
    v_cndmask_b32 v210, 0, v225, s[10:11]
    v_mfma_f32_16x16x32_bf16 v[60:63], a[204:207], a[172:175], v[60:63]
    s_bitcmp1_b32 s69, 7
    s_cselect_b32 s56, s56, 0x70000000
    s_cselect_b32 m0, m0, 0x30000
    v_mfma_f32_16x16x32_bf16 v[44:47], a[200:203], a[172:175], v[44:47]
    s_waitcnt lgkmcnt(4)
    buffer_load_dwordx4 v28, s[24:27], s56 offen sc1 lds
    v_mfma_f32_16x16x32_bf16 v[44:47], a[208:211], a[188:191], v[44:47]
    ds_read_b64_tr_b16 a[200:201], v18 offset:6144
    v_cvt_pk_bf16_f32 v196, v196, v197
    v_mfma_f32_16x16x32_bf16 v[60:63], a[212:215], a[188:191], v[60:63]
    ds_read_b64_tr_b16 a[202:203], v18 offset:7168
    v_cvt_pk_bf16_f32 v197, v198, v199
    v_mfma_f32_16x16x32_bf16 v[56:59], a[212:215], a[184:187], v[56:59]
    v_cvt_pk_bf16_f32 v198, v228, v229
    v_cvt_pk_bf16_f32 v199, v230, v231
    v_mfma_f32_16x16x32_bf16 v[40:43], a[208:211], a[184:187], v[40:43]
    buffer_store_dwordx4 v[196:199], v6, s[24:27], s55 offen sc1
    v_mfma_f32_16x16x32_bf16 v[36:39], a[208:211], a[180:183], v[36:39]
    s_xor_b32 s55, s55, 1024
    ds_read_b64_tr_b16 a[204:205], v19 offset:6144
    v_cvt_pk_bf16_f32 v204, v204, v205
    v_mfma_f32_16x16x32_bf16 v[52:55], a[212:215], a[180:183], v[52:55]
    ds_read_b64_tr_b16 a[206:207], v19 offset:7168
    v_cvt_pk_bf16_f32 v205, v206, v207
    v_mfma_f32_16x16x32_bf16 v[48:51], a[212:215], a[176:179], v[48:51]
    v_cvt_pk_bf16_f32 v206, v236, v237
    v_cvt_pk_bf16_f32 v207, v238, v239
    v_mfma_f32_16x16x32_bf16 v[32:35], a[208:211], a[176:179], v[32:35]
    s_waitcnt lgkmcnt(4)
    v_cvt_pk_bf16_f32 v212, v212, v213
    v_cvt_pk_bf16_f32 v213, v214, v215
    v_mfma_f32_16x16x32_bf16 v[32:35], a[192:195], a[0:3], v[32:35]
    ds_read_b64_tr_b16 a[208:209], v18 offset:8192
    v_cvt_pk_bf16_f32 v214, v244, v245
    v_mfma_f32_16x16x32_bf16 v[48:51], a[196:199], a[0:3], v[48:51]
    ds_read_b64_tr_b16 a[210:211], v18 offset:9216
    v_cvt_pk_bf16_f32 v215, v246, v247
    v_mfma_f32_16x16x32_bf16 v[52:55], a[196:199], a[4:7], v[52:55]
    buffer_store_dwordx4 v[204:207], v6, s[24:27], s55 offen sc1
    v_mfma_f32_16x16x32_bf16 v[36:39], a[192:195], a[4:7], v[36:39]
    s_xor_b32 s55, s55, 3072
    v_cvt_pk_bf16_f32 v220, v220, v221
    v_cvt_pk_bf16_f32 v221, v222, v223
    v_mfma_f32_16x16x32_bf16 v[40:43], a[192:195], a[8:11], v[40:43]
    ds_read_b64_tr_b16 a[212:213], v19 offset:8192
    v_cvt_pk_bf16_f32 v222, v252, v253
    v_mfma_f32_16x16x32_bf16 v[56:59], a[196:199], a[8:11], v[56:59]
    ds_read_b64_tr_b16 a[214:215], v19 offset:9216
    v_cvt_pk_bf16_f32 v223, v254, v255
    v_mfma_f32_16x16x32_bf16 v[60:63], a[196:199], a[12:15], v[60:63]
    v_rcp_f32 v30, v30
    v_mfma_f32_16x16x32_bf16 v[44:47], a[192:195], a[12:15], v[44:47]
    s_waitcnt lgkmcnt(4)
    v_rcp_f32 v31, v31
    v_mfma_f32_16x16x32_bf16 v[44:47], a[200:203], a[28:31], v[44:47]
    ds_read_b64_tr_b16 a[192:193], v18 offset:10240
    v_mul_f32 v26, v26, v30
    v_mfma_f32_16x16x32_bf16 v[60:63], a[204:207], a[28:31], v[60:63]
    ds_read_b64_tr_b16 a[194:195], v18 offset:11264
    v_mul_f32 v27, v27, v31
    v_mfma_f32_16x16x32_bf16 v[56:59], a[204:207], a[24:27], v[56:59]
    v_cvt_pk_bf16_f32 v185, v26, v27
    v_lshlrev_b32 v26, 16, v162
    v_mfma_f32_16x16x32_bf16 v[40:43], a[200:203], a[24:27], v[40:43]
    v_and_b32 v27, 0xffff0000, v162
    v_fma_f32 v26, v26, v25, v24
    v_mfma_f32_16x16x32_bf16 v[36:39], a[200:203], a[20:23], v[36:39]
    ds_read_b64_tr_b16 a[196:197], v19 offset:10240
    v_fma_f32 v27, v27, v25, v24
    v_mfma_f32_16x16x32_bf16 v[52:55], a[204:207], a[20:23], v[52:55]
    ds_read_b64_tr_b16 a[198:199], v19 offset:11264
    v_mul_f32 v30, s92, v26
    v_mfma_f32_16x16x32_bf16 v[48:51], a[204:207], a[16:19], v[48:51]
    buffer_store_dwordx4 v[212:215], v7, s[24:27], s55 offen sc1
    v_mfma_f32_16x16x32_bf16 v[32:35], a[200:203], a[16:19], v[32:35]
    s_waitcnt lgkmcnt(4)
    v_mul_f32 v31, s92, v27
    v_cmp_eq_u32 s[10:11], 3, v226
    v_mfma_f32_16x16x32_bf16 v[32:35], a[208:211], a[32:35], v[32:35]
    s_xor_b32 s55, s55, 1024
    ds_read_b64_tr_b16 a[200:201], v18 offset:12288
    v_cndmask_b32 v211, 0, v225, s[10:11]
    v_mfma_f32_16x16x32_bf16 v[48:51], a[212:215], a[32:35], v[48:51]
    ds_read_b64_tr_b16 a[202:203], v18 offset:13312
    v_cmp_eq_u32 s[10:11], 4, v226
    v_mfma_f32_16x16x32_bf16 v[52:55], a[212:215], a[36:39], v[52:55]
    v_exp_f32 v30, v30
    v_mfma_f32_16x16x32_bf16 v[36:39], a[208:211], a[36:39], v[36:39]
    v_exp_f32 v31, v31
    v_mfma_f32_16x16x32_bf16 v[40:43], a[208:211], a[40:43], v[40:43]
    ds_read_b64_tr_b16 a[204:205], v19 offset:12288
    v_add_f32 v30, 1.0, v30
    v_mfma_f32_16x16x32_bf16 v[56:59], a[212:215], a[40:43], v[56:59]
    ds_read_b64_tr_b16 a[206:207], v19 offset:13312
    v_add_f32 v31, 1.0, v31
    v_mfma_f32_16x16x32_bf16 v[60:63], a[212:215], a[44:47], v[60:63]
    s_waitcnt vmcnt(8)
    v_rcp_f32 v30, v30
    v_mfma_f32_16x16x32_bf16 v[44:47], a[208:211], a[44:47], v[44:47]
    s_waitcnt lgkmcnt(4)
    v_rcp_f32 v31, v31
    v_mfma_f32_16x16x32_bf16 v[44:47], a[192:195], a[60:63], v[44:47]
    ds_read_b64_tr_b16 a[208:209], v18 offset:14336
    v_mul_f32 v26, v26, v30
    v_mfma_f32_16x16x32_bf16 v[60:63], a[196:199], a[60:63], v[60:63]
    ds_read_b64_tr_b16 a[210:211], v18 offset:15360
    v_mul_f32 v27, v27, v31
    v_mfma_f32_16x16x32_bf16 v[56:59], a[196:199], a[56:59], v[56:59]
    buffer_atomic_or v129, v3, s[24:27], 0 offen offset:256
    v_mfma_f32_16x16x32_bf16 v[40:43], a[192:195], a[56:59], v[40:43]
    buffer_store_dwordx4 v[220:223], v7, s[24:27], s55 offen sc1
    v_mfma_f32_16x16x32_bf16 v[36:39], a[192:195], a[52:55], v[36:39]
    s_xor_b32 s55, s55, 3072
    ds_read_b64_tr_b16 a[212:213], v19 offset:14336
    v_cvt_pk_bf16_f32 v186, v26, v27
    v_mfma_f32_16x16x32_bf16 v[52:55], a[196:199], a[52:55], v[52:55]
    s_add_u32 s55, s55, 16384
    ds_read_b64_tr_b16 a[214:215], v19 offset:15360
    v_lshlrev_b32 v26, 16, v163
    v_mfma_f32_16x16x32_bf16 v[48:51], a[196:199], a[48:51], v[48:51]
    v_and_b32 v27, 0xffff0000, v163
    v_fma_f32 v26, v26, v25, v24
    v_mfma_f32_16x16x32_bf16 v[32:35], a[192:195], a[48:51], v[32:35]
    s_waitcnt lgkmcnt(4)
    v_fma_f32 v27, v27, v25, v24
    v_mul_f32 v30, s92, v26
    v_mfma_f32_16x16x32_bf16 v[32:35], a[200:203], a[64:67], v[32:35]
    s_load_dword s67, s[86:87], s5 glc
    v_mul_f32 v31, s92, v27
    v_cndmask_b32 v216, 0, v225, s[10:11]
    v_mfma_f32_16x16x32_bf16 v[48:51], a[204:207], a[64:67], v[48:51]
    v_exp_f32 v30, v30
    v_mfma_f32_16x16x32_bf16 v[52:55], a[204:207], a[68:71], v[52:55]
    v_exp_f32 v31, v31
    v_mfma_f32_16x16x32_bf16 v[36:39], a[200:203], a[68:71], v[36:39]
    v_add_f32 v30, 1.0, v30
    v_add_f32 v31, 1.0, v31
    v_mfma_f32_16x16x32_bf16 v[40:43], a[200:203], a[72:75], v[40:43]
    v_rcp_f32 v30, v30
    v_mfma_f32_16x16x32_bf16 v[56:59], a[204:207], a[72:75], v[56:59]
    v_rcp_f32 v31, v31
    v_mfma_f32_16x16x32_bf16 v[60:63], a[204:207], a[76:79], v[60:63]
    v_mul_f32 v26, v26, v30
    v_mul_f32 v27, v27, v31
    v_mfma_f32_16x16x32_bf16 v[44:47], a[200:203], a[76:79], v[44:47]
    s_waitcnt lgkmcnt(0)
    v_cvt_pk_bf16_f32 v187, v26, v27
    v_cmp_eq_u32 s[10:11], 5, v226
    v_mfma_f32_16x16x32_bf16 v[44:47], a[208:211], a[92:95], v[44:47]
    v_mfma_f32_16x16x32_bf16 v[60:63], a[212:215], a[92:95], v[60:63]
    v_cndmask_b32 v217, 0, v225, s[10:11]
    v_cmp_eq_u32 s[10:11], 6, v226
    v_mfma_f32_16x16x32_bf16 v[56:59], a[212:215], a[88:91], v[56:59]
    v_mfma_f32_16x16x32_bf16 v[40:43], a[208:211], a[88:91], v[40:43]
    v_cndmask_b32 v218, 0, v225, s[10:11]
    v_cmp_eq_u32 s[10:11], 7, v226
    v_mfma_f32_16x16x32_bf16 v[36:39], a[208:211], a[84:87], v[36:39]
    v_mfma_f32_16x16x32_bf16 v[52:55], a[212:215], a[84:87], v[52:55]
    v_cndmask_b32 v219, 0, v225, s[10:11]
    s_mov_b32 s32, s84
    v_mfma_f32_16x16x32_bf16 v[48:51], a[212:215], a[80:83], v[48:51]
    s_and_b32 s33, s85, 0xffff
    s_mov_b32 s34, 2621440
    s_mov_b32 s35, 0x00020000
    v_mfma_f32_16x16x32_bf16 v[32:35], a[208:211], a[80:83], v[32:35]
    s_nop 7
    v_cvt_pk_bf16_f32 v32, v32, v33
    v_cvt_pk_bf16_f32 v33, v34, v35
    v_cvt_pk_bf16_f32 v34, v48, v49
    v_cvt_pk_bf16_f32 v35, v50, v51
    buffer_store_dwordx4 v[32:35], v6, s[24:27], s55 offen sc1
    s_xor_b32 s55, s55, 1024
    v_cvt_pk_bf16_f32 v36, v36, v37
    v_cvt_pk_bf16_f32 v37, v38, v39
    v_cvt_pk_bf16_f32 v38, v52, v53
    v_cvt_pk_bf16_f32 v39, v54, v55
    buffer_store_dwordx4 v[36:39], v6, s[24:27], s55 offen sc1
    s_xor_b32 s55, s55, 3072
    v_cvt_pk_bf16_f32 v40, v40, v41
    v_cvt_pk_bf16_f32 v41, v42, v43
    v_cvt_pk_bf16_f32 v42, v56, v57
    v_cvt_pk_bf16_f32 v43, v58, v59
    buffer_store_dwordx4 v[40:43], v7, s[24:27], s55 offen sc1
    s_xor_b32 s55, s55, 1024
    v_cvt_pk_bf16_f32 v44, v44, v45
    v_cvt_pk_bf16_f32 v45, v46, v47
    v_cvt_pk_bf16_f32 v46, v60, v61
    v_cvt_pk_bf16_f32 v47, v62, v63
    buffer_store_dwordx4 v[44:47], v7, s[24:27], s55 offen sc1
    s_xor_b32 s55, s55, 3072
    s_add_u32 s55, s55, 16384
post_code:
    s_cmp_ge_u32 s3, 2
    s_cselect_b32 s60, 0, 0xff00
    s_mov_b32 s9, 1
    s_mov_b32 s55, s68
    s_waitcnt vmcnt(4) lgkmcnt(0)
    buffer_atomic_or v130, v3, s[24:27], 0 offen offset:256
    s_andn2_b32 s69, s67, s68
    s_load_dword s67, s[86:87], s5 glc
    s_or_b32 s68, s68, s69
    s_and_b32 s8, s69, 0xff00ff
    s_andn2_b32 s69, s69, s8
    s_cmp_lg_u32 s8, 0
    s_cbranch_scc0 e0_issued
e0_iss:
    s_ff1_i32_b32 s56, s8
    v_readlane_b32 s57, v23, s56
    s_lshl_b32 s39, s56, 10
    s_add_u32 m0, s37, s39
    s_bitset0_b32 s8, s56
    s_add_u32 s9, s9, 1
    s_cmp_lg_u32 s8, 0
    buffer_load_dwordx4 v28, s[24:27], s57 offen sc1 lds
    s_cbranch_scc1 e0_iss
e0_issued:
w4:
    s_getreg_b32 s56, hwreg(HW_REG_IB_STS)
    s_bfe_u32 s57, s56, 0x20016
    s_and_b32 s56, s56, 15
    s_lshl4_add_u32 s56, s57, s56
    s_cmp_gt_u32 s56, s9
    s_cbranch_scc1 w4
    buffer_atomic_or v130, v3, s[24:27], 0 offen offset:0
    s_lshr_b32 s56, s53, 1
    s_cmp_eq_u32 s56, s3
    s_cbranch_scc0 own_share_ret
    s_lshl_b32 s56, s53, 10
    v_add_u32 v8, s56, v28
    v_add_u32 v11, 57344, v8
    v_add_u32 v10, 32768, v8
    v_add_u32 v9, 8192, v8
    v_add_u32 v8, 0, v8
    s_bitcmp1_b32 s53, 0
    s_cbranch_scc1 own_odd
    ds_write_b128 v8, v[32:35] offset:16384
    ds_write_b128 v9, v[36:39] offset:16384
    ds_write_b128 v10, v[196:199] offset:16384
    ds_write_b128 v11, v[204:207] offset:16384
    ds_write_b128 v10, v[132:135] offset:8192
    ds_write_b128 v11, v[140:143] offset:8192
    ds_write_b128 v10, v[68:71] offset:0
    ds_write_b128 v11, v[76:79] offset:0
    ds_write_b128 v8, v[64:67] offset:0
    ds_write_b128 v9, v[80:83] offset:0
    s_branch own_share_ret
own_odd:
    ds_write_b128 v8, v[40:43] offset:16384
    ds_write_b128 v9, v[44:47] offset:16384
    ds_write_b128 v10, v[212:215] offset:16384
    ds_write_b128 v11, v[220:223] offset:16384
    ds_write_b128 v10, v[148:151] offset:8192
    ds_write_b128 v11, v[156:159] offset:8192
    ds_write_b128 v10, v[84:87] offset:0
    ds_write_b128 v11, v[92:95] offset:0
    ds_write_b128 v8, v[96:99] offset:0
    ds_write_b128 v9, v[112:115] offset:0
own_share_ret:
    s_cmp_lg_u32 s69, 0
    s_cbranch_scc0 e1_issued
e1_iss:
    s_ff1_i32_b32 s56, s69
    v_readlane_b32 s57, v23, s56
    s_lshl_b32 s39, s56, 10
    s_add_u32 m0, s37, s39
    s_bitset0_b32 s69, s56
    s_add_u32 s9, s9, 1
    s_cmp_lg_u32 s69, 0
    buffer_load_dwordx4 v28, s[24:27], s57 offen sc1 lds
    s_cbranch_scc1 e1_iss
e1_issued:
    s_waitcnt lgkmcnt(0)
    s_barrier
    s_cmp_lg_u64 s[88:89], 0
    s_cbranch_scc1 routed
routed_ret:
ev_loop:
    s_waitcnt lgkmcnt(0)
    s_getreg_b32 s56, hwreg(HW_REG_IB_STS)
    s_and_b32 s56, s56, 0xc0000f
    s_cselect_b32 s55, s55, s68
    s_andn2_b32 s69, s67, s68
    s_or_b32 s68, s68, s69
    s_cmp_eq_u32 s68, 0xffffff
    s_cbranch_scc1 ev_nopoll
    s_load_dword s67, s[86:87], s5 glc
ev_nopoll:
    s_cmp_lg_u32 s69, 0
    s_cbranch_scc0 ev_issued
ev_iss:
    s_ff1_i32_b32 s56, s69
    v_readlane_b32 s57, v23, s56
    s_lshl_b32 s39, s56, 10
    s_add_u32 m0, s37, s39
    s_bitset0_b32 s69, s56
    s_add_u32 s9, s9, 1
    s_cmp_lg_u32 s69, 0
    buffer_load_dwordx4 v28, s[24:27], s57 offen sc1 lds
    s_cbranch_scc1 ev_iss
ev_issued:
ev_sel:
    s_andn2_b32 s8, s55, s60
    s_bfe_u32 s56, s8, 524288
    s_cmp_eq_u32 s56, 0xff
    s_cbranch_scc0 ev_r0
    s_or_b32 s60, s60, 255
    s_mov_b32 s38, s41
    ds_read_b128 v[132:135], v4 offset:0
    ds_read_b128 v[140:143], v4 offset:1024
    ds_read_b128 v[148:151], v4 offset:2048
    ds_read_b128 v[156:159], v4 offset:3072
    ds_read_b128 v[164:167], v4 offset:4096
    ds_read_b128 v[172:175], v4 offset:5120
    ds_read_b128 v[180:183], v4 offset:6144
    ds_read_b128 v[188:191], v4 offset:7168
    v_lshlrev_b32 v84, 16, v168
    v_and_b32 v85, 0xffff0000, v168
    v_lshlrev_b32 v100, 16, v144
    v_and_b32 v101, 0xffff0000, v144
    v_lshlrev_b32 v86, 16, v169
    v_and_b32 v87, 0xffff0000, v169
    v_lshlrev_b32 v102, 16, v145
    v_and_b32 v103, 0xffff0000, v145
    v_lshlrev_b32 v92, 16, v170
    v_and_b32 v93, 0xffff0000, v170
    v_lshlrev_b32 v108, 16, v146
    v_and_b32 v109, 0xffff0000, v146
    v_lshlrev_b32 v94, 16, v171
    v_and_b32 v95, 0xffff0000, v171
    v_lshlrev_b32 v110, 16, v147
    v_and_b32 v111, 0xffff0000, v147
    s_branch ev_go
ev_r0:
    s_bfe_u32 s56, s8, 524296
    s_cmp_eq_u32 s56, 0xff
    s_cbranch_scc0 ev_r1
    s_or_b32 s60, s60, 65280
    s_mov_b32 s38, s42
    ds_read_b128 v[132:135], v4 offset:8192
    ds_read_b128 v[140:143], v4 offset:9216
    ds_read_b128 v[148:151], v4 offset:10240
    ds_read_b128 v[156:159], v4 offset:11264
    ds_read_b128 v[164:167], v4 offset:12288
    ds_read_b128 v[172:175], v4 offset:13312
    ds_read_b128 v[180:183], v4 offset:14336
    ds_read_b128 v[188:191], v4 offset:15360
    v_lshlrev_b32 v84, 16, v176
    v_and_b32 v85, 0xffff0000, v176
    v_lshlrev_b32 v100, 16, v152
    v_and_b32 v101, 0xffff0000, v152
    v_lshlrev_b32 v86, 16, v177
    v_and_b32 v87, 0xffff0000, v177
    v_lshlrev_b32 v102, 16, v153
    v_and_b32 v103, 0xffff0000, v153
    v_lshlrev_b32 v92, 16, v178
    v_and_b32 v93, 0xffff0000, v178
    v_lshlrev_b32 v108, 16, v154
    v_and_b32 v109, 0xffff0000, v154
    v_lshlrev_b32 v94, 16, v179
    v_and_b32 v95, 0xffff0000, v179
    v_lshlrev_b32 v110, 16, v155
    v_and_b32 v111, 0xffff0000, v155
    s_branch ev_go
ev_r1:
    s_bfe_u32 s56, s8, 524304
    s_cmp_eq_u32 s56, 0xff
    s_cbranch_scc0 ev_r2
    s_or_b32 s60, s60, 16711680
    s_mov_b32 s38, s43
    ds_read_b128 v[132:135], v4 offset:16384
    ds_read_b128 v[140:143], v4 offset:17408
    ds_read_b128 v[148:151], v4 offset:18432
    ds_read_b128 v[156:159], v4 offset:19456
    ds_read_b128 v[164:167], v4 offset:20480
    ds_read_b128 v[172:175], v4 offset:21504
    ds_read_b128 v[180:183], v4 offset:22528
    ds_read_b128 v[188:191], v4 offset:23552
    v_lshlrev_b32 v84, 16, v184
    v_and_b32 v85, 0xffff0000, v184
    v_lshlrev_b32 v100, 16, v160
    v_and_b32 v101, 0xffff0000, v160
    v_lshlrev_b32 v86, 16, v185
    v_and_b32 v87, 0xffff0000, v185
    v_lshlrev_b32 v102, 16, v161
    v_and_b32 v103, 0xffff0000, v161
    v_lshlrev_b32 v92, 16, v186
    v_and_b32 v93, 0xffff0000, v186
    v_lshlrev_b32 v108, 16, v162
    v_and_b32 v109, 0xffff0000, v162
    v_lshlrev_b32 v94, 16, v187
    v_and_b32 v95, 0xffff0000, v187
pg_13:
    s_cbranch_execz pg_ret2
    v_lshlrev_b32 v110, 16, v163
    v_and_b32 v111, 0xffff0000, v163
    s_branch ev_go
ev_r2:
    s_cmp_eq_u32 s68, 0xffffff
    s_cbranch_scc0 ev_more
    s_waitcnt vmcnt(0)
    s_mov_b32 s55, s68
    s_branch ev_sel
ev_more:
    s_add_u32 s101, s101, 1
    s_cmp_gt_u32 s101, 0x2000000
    s_cbranch_scc0 ev_loop
    s_branch ev_done
ev_go:
    s_waitcnt lgkmcnt(7)
    v_mfma_f32_16x16x32_bf16 v[68:71], v[208:211], v[132:135], 0
    v_mfma_f32_16x16x32_bf16 v[76:79], v[216:219], v[132:135], 0
    s_waitcnt lgkmcnt(6)
    v_mfma_f32_16x16x32_bf16 v[68:71], v[208:211], v[140:143], v[68:71]
    v_mfma_f32_16x16x32_bf16 v[76:79], v[216:219], v[140:143], v[76:79]
    s_waitcnt lgkmcnt(5)
    v_mfma_f32_16x16x32_bf16 v[68:71], v[208:211], v[148:151], v[68:71]
    v_mfma_f32_16x16x32_bf16 v[76:79], v[216:219], v[148:151], v[76:79]
    s_waitcnt lgkmcnt(4)
    v_mfma_f32_16x16x32_bf16 v[68:71], v[208:211], v[156:159], v[68:71]
    v_mfma_f32_16x16x32_bf16 v[76:79], v[216:219], v[156:159], v[76:79]
    s_waitcnt lgkmcnt(3)
    v_mfma_f32_16x16x32_bf16 v[68:71], v[208:211], v[164:167], v[68:71]
    v_mfma_f32_16x16x32_bf16 v[76:79], v[216:219], v[164:167], v[76:79]
    s_waitcnt lgkmcnt(2)
    v_mfma_f32_16x16x32_bf16 v[68:71], v[208:211], v[172:175], v[68:71]
    v_mfma_f32_16x16x32_bf16 v[76:79], v[216:219], v[172:175], v[76:79]
    s_waitcnt lgkmcnt(1)
    v_mfma_f32_16x16x32_bf16 v[68:71], v[208:211], v[180:183], v[68:71]
    v_mfma_f32_16x16x32_bf16 v[76:79], v[216:219], v[180:183], v[76:79]
    s_waitcnt lgkmcnt(0)
    v_mfma_f32_16x16x32_bf16 v[68:71], v[208:211], v[188:191], v[68:71]
    v_mfma_f32_16x16x32_bf16 v[76:79], v[216:219], v[188:191], v[76:79]
    s_nop 6
    v_pk_fma_f32 v[68:69], v[68:69], v[84:85], v[100:101]
    v_pk_fma_f32 v[70:71], v[70:71], v[86:87], v[102:103]
    v_pk_fma_f32 v[76:77], v[76:77], v[92:93], v[108:109]
    v_pk_fma_f32 v[78:79], v[78:79], v[94:95], v[110:111]
    v_cvt_pk_bf16_f32 v124, v68, v69
    v_cvt_pk_bf16_f32 v125, v70, v71
    v_cvt_pk_bf16_f32 v126, v76, v77
    v_cvt_pk_bf16_f32 v127, v78, v79
    buffer_store_dwordx4 v[124:127], v22, s[32:35], s38 offen sc1
    s_cmp_lg_u32 s60, 0xffffff
    s_cbranch_scc1 ev_sel
ev_done:
    s_or_b32 s56, s2, s3
    s_cbranch_scc1 main_fin
    v_mov_b32 v8, s7
    v_mov_b32 v9, 3203072
    s_mov_b64 exec, 1
    buffer_store_dword v8, v9, s[24:27], 0 offen
main_fin:
main_end:
    s_endpgm
spin_o0:
    s_load_dword s72, s[86:87], s5 offset:4 glc
    s_add_u32 s101, s101, 1
    s_cmp_gt_u32 s101, 0x2000000
    s_waitcnt lgkmcnt(0)
    s_cbranch_scc1 spin_o0_ret
    s_bfe_u32 s88, s72, 262144
    s_cmp_lg_u32 s88, 15
    s_cbranch_scc1 spin_o0
    s_branch spin_o0_ret
spin_o1:
    s_load_dword s72, s[86:87], s5 offset:4 glc
    s_add_u32 s101, s101, 1
    s_cmp_gt_u32 s101, 0x2000000
    s_waitcnt lgkmcnt(0)
    s_cbranch_scc1 spin_o1_ret
    s_bfe_u32 s88, s72, 262148
    s_cmp_lg_u32 s88, 15
    s_cbranch_scc1 spin_o1
    s_branch spin_o1_ret
spin_o2:
    s_load_dword s72, s[86:87], s5 offset:4 glc
    s_add_u32 s101, s101, 1
    s_cmp_gt_u32 s101, 0x2000000
    s_waitcnt lgkmcnt(0)
    s_cbranch_scc1 spin_o2_ret
    s_bfe_u32 s88, s72, 262152
    s_cmp_lg_u32 s88, 15
    s_cbranch_scc1 spin_o2
    s_branch spin_o2_ret
spin_o3:
    s_load_dword s72, s[86:87], s5 offset:4 glc
    s_add_u32 s101, s101, 1
    s_cmp_gt_u32 s101, 0x2000000
    s_waitcnt lgkmcnt(0)
    s_cbranch_scc1 spin_o3_ret
    s_bfe_u32 s88, s72, 262156
    s_cmp_lg_u32 s88, 15
    s_cbranch_scc1 spin_o3
    s_branch spin_o3_ret
spin_o4:
    s_load_dword s72, s[86:87], s5 offset:4 glc
    s_add_u32 s101, s101, 1
    s_cmp_gt_u32 s101, 0x2000000
    s_waitcnt lgkmcnt(0)
    s_cbranch_scc1 spin_o4_ret
    s_bfe_u32 s88, s72, 262160
    s_cmp_lg_u32 s88, 15
    s_cbranch_scc1 spin_o4
    s_branch spin_o4_ret
spin_o5:
    s_load_dword s72, s[86:87], s5 offset:4 glc
    s_add_u32 s101, s101, 1
    s_cmp_gt_u32 s101, 0x2000000
    s_waitcnt lgkmcnt(0)
    s_cbranch_scc1 spin_o5_ret
    s_bfe_u32 s88, s72, 262164
    s_cmp_lg_u32 s88, 15
    s_cbranch_scc1 spin_o5
    s_branch spin_o5_ret
routed:
    s_cmp_eq_u32 s44, s59
    s_cbranch_scc0 spin_y
spin_y_ret:
    v_cvt_pk_bf16_f32 v200, v240, v241
    v_cvt_pk_bf16_f32 v201, v242, v243
    v_lshlrev_b32 v240, 16, v200
    v_and_b32 v241, 0xffff0000, v200
    v_lshlrev_b32 v242, 16, v201
    v_and_b32 v243, 0xffff0000, v201
    v_mul_f32 v240, v240, v195
    v_mul_f32 v241, v241, v195
    v_mul_f32 v242, v242, v195
    v_mul_f32 v243, v243, v195
    v_cvt_pk_bf16_f32 v200, v240, v241
    v_cvt_pk_bf16_f32 v201, v242, v243
    v_lshlrev_b32 v240, 16, v200
    v_and_b32 v241, 0xffff0000, v200
    v_lshlrev_b32 v242, 16, v201
    v_and_b32 v243, 0xffff0000, v201
    v_add_f32 v240, v240, v248
    v_add_f32 v241, v241, v249
    v_add_f32 v242, v242, v250
    v_add_f32 v243, v243, v251
    v_cvt_pk_bf16_f32 v200, v240, v241
    v_cvt_pk_bf16_f32 v201, v242, v243
    v_lshlrev_b32 v240, 16, v200
    v_and_b32 v241, 0xffff0000, v200
    v_lshlrev_b32 v242, 16, v201
    v_and_b32 v243, 0xffff0000, v201
    v_mul_f32 v200, s92, v240
    v_mul_f32 v201, s92, v241
    v_mul_f32 v202, s92, v242
    v_mul_f32 v203, s92, v243
    v_exp_f32 v200, v200
    v_exp_f32 v201, v201
    v_exp_f32 v202, v202
    v_exp_f32 v203, v203
    v_add_f32 v200, 1.0, v200
    v_add_f32 v201, 1.0, v201
    v_add_f32 v202, 1.0, v202
    v_add_f32 v203, 1.0, v203
    v_rcp_f32 v200, v200
    v_rcp_f32 v201, v201
    v_rcp_f32 v202, v202
    v_rcp_f32 v203, v203
    v_mul_f32 v240, v240, v200
    v_mul_f32 v241, v241, v201
    v_mul_f32 v242, v242, v202
    v_mul_f32 v243, v243, v203
    v_cvt_pk_bf16_f32 v240, v240, v241
    v_cvt_pk_bf16_f32 v241, v242, v243
    ds_write_b64 v138, v[240:241]
    s_mov_b64 exec, s[88:89]
    ds_read_b128 v[168:171], v139 offset:0
    ds_read_b128 v[176:179], v139 offset:64
    ds_read_b128 v[184:187], v139 offset:128
    s_waitcnt lgkmcnt(0)
    s_mov_b64 exec, -1
    s_branch routed_ret
spin_y:
    s_add_u32 s101, s101, 1
    s_cmp_gt_u32 s101, 0x2000000
    s_cbranch_scc1 spin_y_x
    buffer_load_dword v137, v136, s[24:27], s59 offen offset:128 sc1
    s_waitcnt vmcnt(0)
    v_cmp_ne_u32 vcc, 24, v137
    s_cbranch_vccnz spin_y
spin_y_x:
    buffer_load_dwordx4 v[240:243], v192, s[24:27], s59 offen sc1
    s_waitcnt vmcnt(0)
    s_branch spin_y_ret
spin_rec:
    s_add_u32 s101, s101, 1
    s_cmp_gt_u32 s101, 0x2000000
    s_cbranch_scc1 spin_rec_x
    buffer_load_dwordx4 v[32:35], v17, s[24:27], s47 offen offset:0 sc1
    buffer_load_dwordx4 v[36:39], v17, s[24:27], s47 offen offset:1024 sc1
    buffer_load_dwordx4 v[40:43], v17, s[24:27], s47 offen offset:2048 sc1
    buffer_load_dwordx4 v[44:47], v17, s[24:27], s47 offen offset:3072 sc1
    s_waitcnt vmcnt(0)
    v_xor_b32 v34, s7, v34
    v_xor_b32 v38, s7, v38
    v_xor_b32 v42, s7, v42
    v_xor_b32 v46, s7, v46
    v_or3_b32 v34, v34, v38, v42
    v_or_b32 v34, v34, v46
    v_cmp_ne_u32 vcc, 0, v34
    s_cbranch_vccnz spin_rec
spin_rec_x:
    s_branch spin_rec_ret
spin_gu:
    s_add_u32 s101, s101, 1
    s_cmp_gt_u32 s101, 0x2000000
    s_cbranch_scc1 spin_gu_x
    buffer_load_dword v61, v60, s[24:27], s37 offen sc1
    s_waitcnt vmcnt(0)
    v_cmp_ne_u32 vcc, s7, v61
    s_cbranch_vccnz spin_gu
spin_gu_x:
    s_branch spin_gu_ret
rare_p:
    s_nop 7
    s_nop 7
    v_max3_f32 v56, v68, v69, v70
    v_max3_f32 v56, v56, v71, v100
    v_max3_f32 v56, v56, v101, v102
    v_max3_f32 v56, v56, v103, 0
    v_mov_b32 v58, v56
    s_nop 1
    v_permlane16_swap_b32 v56, v58
    s_nop 1
    v_max_f32 v56, v56, v58
    v_mov_b32 v58, v56
    s_nop 1
    v_permlane32_swap_b32 v56, v58
    s_nop 1
    v_max_f32 v56, v56, v58
    v_exp_f32 v57, -v56
    v_sub_f32 v32, v32, v56
    v_sub_f32 v33, v33, v56
    v_sub_f32 v34, v34, v56
    v_sub_f32 v35, v35, v56
    v_mul_f32 v20, v20, v57
    v_sub_f32 v68, v68, v56
    v_sub_f32 v69, v69, v56
    v_sub_f32 v70, v70, v56
    v_sub_f32 v71, v71, v56
    v_sub_f32 v100, v100, v56
    v_sub_f32 v101, v101, v56
    v_sub_f32 v102, v102, v56
    v_sub_f32 v103, v103, v56
    v_sub_f32 v132, v132, v56
    v_sub_f32 v133, v133, v56
    v_sub_f32 v134, v134, v56
    v_sub_f32 v135, v135, v56
    v_sub_f32 v164, v164, v56
    v_sub_f32 v165, v165, v56
    v_sub_f32 v166, v166, v56
    v_sub_f32 v167, v167, v56
    v_accvgpr_read_b32 v48, a0
    v_accvgpr_read_b32 v49, a1
    v_accvgpr_read_b32 v50, a2
    v_accvgpr_read_b32 v51, a3
    v_mul_f32 v48, v48, v57
    v_mul_f32 v49, v49, v57
    v_mul_f32 v50, v50, v57
    v_mul_f32 v51, v51, v57
    v_accvgpr_write_b32 a0, v48
    v_accvgpr_write_b32 a1, v49
    v_accvgpr_write_b32 a2, v50
    v_accvgpr_write_b32 a3, v51
    v_accvgpr_read_b32 v48, a16
    v_accvgpr_read_b32 v49, a17
    v_accvgpr_read_b32 v50, a18
    v_accvgpr_read_b32 v51, a19
    v_mul_f32 v48, v48, v57
    v_mul_f32 v49, v49, v57
    v_mul_f32 v50, v50, v57
    v_mul_f32 v51, v51, v57
    v_accvgpr_write_b32 a16, v48
    v_accvgpr_write_b32 a17, v49
    v_accvgpr_write_b32 a18, v50
    v_accvgpr_write_b32 a19, v51
    v_accvgpr_read_b32 v48, a32
    v_accvgpr_read_b32 v49, a33
    v_accvgpr_read_b32 v50, a34
    v_accvgpr_read_b32 v51, a35
    v_mul_f32 v48, v48, v57
    v_mul_f32 v49, v49, v57
    v_mul_f32 v50, v50, v57
    v_mul_f32 v51, v51, v57
    v_accvgpr_write_b32 a32, v48
    v_accvgpr_write_b32 a33, v49
    v_accvgpr_write_b32 a34, v50
    v_accvgpr_write_b32 a35, v51
    v_accvgpr_read_b32 v48, a48
    v_accvgpr_read_b32 v49, a49
    v_accvgpr_read_b32 v50, a50
    v_accvgpr_read_b32 v51, a51
    v_mul_f32 v48, v48, v57
    v_mul_f32 v49, v49, v57
    v_mul_f32 v50, v50, v57
    v_mul_f32 v51, v51, v57
    v_accvgpr_write_b32 a48, v48
    v_accvgpr_write_b32 a49, v49
    v_accvgpr_write_b32 a50, v50
    v_accvgpr_write_b32 a51, v51
    v_accvgpr_read_b32 v48, a64
    v_accvgpr_read_b32 v49, a65
    v_accvgpr_read_b32 v50, a66
    v_accvgpr_read_b32 v51, a67
    v_mul_f32 v48, v48, v57
    v_mul_f32 v49, v49, v57
    v_mul_f32 v50, v50, v57
    v_mul_f32 v51, v51, v57
    v_accvgpr_write_b32 a64, v48
    v_accvgpr_write_b32 a65, v49
    v_accvgpr_write_b32 a66, v50
    v_accvgpr_write_b32 a67, v51
    v_accvgpr_read_b32 v48, a80
    v_accvgpr_read_b32 v49, a81
    v_accvgpr_read_b32 v50, a82
    v_accvgpr_read_b32 v51, a83
    v_mul_f32 v48, v48, v57
    v_mul_f32 v49, v49, v57
    v_mul_f32 v50, v50, v57
    v_mul_f32 v51, v51, v57
    v_accvgpr_write_b32 a80, v48
    v_accvgpr_write_b32 a81, v49
    v_accvgpr_write_b32 a82, v50
    v_accvgpr_write_b32 a83, v51
    v_accvgpr_read_b32 v48, a96
    v_accvgpr_read_b32 v49, a97
    v_accvgpr_read_b32 v50, a98
    v_accvgpr_read_b32 v51, a99
    v_mul_f32 v48, v48, v57
    v_mul_f32 v49, v49, v57
    v_mul_f32 v50, v50, v57
    v_mul_f32 v51, v51, v57
    v_accvgpr_write_b32 a96, v48
    v_accvgpr_write_b32 a97, v49
    v_accvgpr_write_b32 a98, v50
    v_accvgpr_write_b32 a99, v51
    v_accvgpr_read_b32 v48, a112
    v_accvgpr_read_b32 v49, a113
    v_accvgpr_read_b32 v50, a114
    v_accvgpr_read_b32 v51, a115
    v_mul_f32 v48, v48, v57
    v_mul_f32 v49, v49, v57
    v_mul_f32 v50, v50, v57
    v_mul_f32 v51, v51, v57
    v_accvgpr_write_b32 a112, v48
    v_accvgpr_write_b32 a113, v49
    v_accvgpr_write_b32 a114, v50
    v_accvgpr_write_b32 a115, v51
    v_accvgpr_read_b32 v48, a128
    v_accvgpr_read_b32 v49, a129
    v_accvgpr_read_b32 v50, a130
    v_accvgpr_read_b32 v51, a131
    v_mul_f32 v48, v48, v57
    v_mul_f32 v49, v49, v57
    v_mul_f32 v50, v50, v57
    v_mul_f32 v51, v51, v57
    v_accvgpr_write_b32 a128, v48
    v_accvgpr_write_b32 a129, v49
    v_accvgpr_write_b32 a130, v50
    v_accvgpr_write_b32 a131, v51
    v_accvgpr_read_b32 v48, a144
    v_accvgpr_read_b32 v49, a145
    v_accvgpr_read_b32 v50, a146
    v_accvgpr_read_b32 v51, a147
    v_mul_f32 v48, v48, v57
    v_mul_f32 v49, v49, v57
    v_mul_f32 v50, v50, v57
    v_mul_f32 v51, v51, v57
    v_accvgpr_write_b32 a144, v48
    v_accvgpr_write_b32 a145, v49
    v_accvgpr_write_b32 a146, v50
    v_accvgpr_write_b32 a147, v51
    v_accvgpr_read_b32 v48, a160
    v_accvgpr_read_b32 v49, a161
    v_accvgpr_read_b32 v50, a162
    v_accvgpr_read_b32 v51, a163
    v_mul_f32 v48, v48, v57
    v_mul_f32 v49, v49, v57
    v_mul_f32 v50, v50, v57
    v_mul_f32 v51, v51, v57
    v_accvgpr_write_b32 a160, v48
    v_accvgpr_write_b32 a161, v49
    v_accvgpr_write_b32 a162, v50
    v_accvgpr_write_b32 a163, v51
    v_accvgpr_read_b32 v48, a176
    v_accvgpr_read_b32 v49, a177
    v_accvgpr_read_b32 v50, a178
    v_accvgpr_read_b32 v51, a179
    v_mul_f32 v48, v48, v57
    v_mul_f32 v49, v49, v57
    v_mul_f32 v50, v50, v57
    v_mul_f32 v51, v51, v57
    v_accvgpr_write_b32 a176, v48
    v_accvgpr_write_b32 a177, v49
    v_accvgpr_write_b32 a178, v50
    v_accvgpr_write_b32 a179, v51
    v_exp_f32 v48, v68
    v_exp_f32 v49, v69
    v_exp_f32 v50, v70
    v_exp_f32 v51, v71
    v_exp_f32 v52, v100
    v_exp_f32 v53, v101
    v_exp_f32 v54, v102
    v_exp_f32 v55, v103
    s_nop 0
    v_cvt_pk_bf16_f32 v196, v48, v49
    v_cvt_pk_bf16_f32 v197, v50, v51
    v_cvt_pk_bf16_f32 v198, v52, v53
    v_cvt_pk_bf16_f32 v199, v54, v55
    v_add_f32 v24, v48, v49
    v_add_f32 v24, v24, v50
    v_add_f32 v24, v24, v51
    v_add_f32 v24, v24, v52
    v_add_f32 v24, v24, v53
    v_add_f32 v24, v24, v54
    v_add_f32 v24, v24, v55
    v_max3_f32 v56, v76, v77, v78
    v_max3_f32 v56, v56, v79, v108
    v_max3_f32 v56, v56, v109, v110
    v_max3_f32 v56, v56, v111, 0
    v_mov_b32 v58, v56
    s_nop 1
    v_permlane16_swap_b32 v56, v58
    s_nop 1
    v_max_f32 v56, v56, v58
    v_mov_b32 v58, v56
    s_nop 1
    v_permlane32_swap_b32 v56, v58
    s_nop 1
    v_max_f32 v56, v56, v58
    v_exp_f32 v57, -v56
    v_sub_f32 v36, v36, v56
    v_sub_f32 v37, v37, v56
    v_sub_f32 v38, v38, v56
    v_sub_f32 v39, v39, v56
    v_mul_f32 v21, v21, v57
    v_sub_f32 v76, v76, v56
    v_sub_f32 v77, v77, v56
    v_sub_f32 v78, v78, v56
    v_sub_f32 v79, v79, v56
    v_sub_f32 v108, v108, v56
    v_sub_f32 v109, v109, v56
    v_sub_f32 v110, v110, v56
    v_sub_f32 v111, v111, v56
    v_sub_f32 v140, v140, v56
    v_sub_f32 v141, v141, v56
    v_sub_f32 v142, v142, v56
    v_sub_f32 v143, v143, v56
    v_sub_f32 v172, v172, v56
    v_sub_f32 v173, v173, v56
    v_sub_f32 v174, v174, v56
    v_sub_f32 v175, v175, v56
    v_accvgpr_read_b32 v48, a4
    v_accvgpr_read_b32 v49, a5
    v_accvgpr_read_b32 v50, a6
    v_accvgpr_read_b32 v51, a7
    v_mul_f32 v48, v48, v57
    v_mul_f32 v49, v49, v57
    v_mul_f32 v50, v50, v57
    v_mul_f32 v51, v51, v57
    v_accvgpr_write_b32 a4, v48
    v_accvgpr_write_b32 a5, v49
    v_accvgpr_write_b32 a6, v50
    v_accvgpr_write_b32 a7, v51
    v_accvgpr_read_b32 v48, a20
    v_accvgpr_read_b32 v49, a21
    v_accvgpr_read_b32 v50, a22
    v_accvgpr_read_b32 v51, a23
    v_mul_f32 v48, v48, v57
    v_mul_f32 v49, v49, v57
    v_mul_f32 v50, v50, v57
    v_mul_f32 v51, v51, v57
    v_accvgpr_write_b32 a20, v48
    v_accvgpr_write_b32 a21, v49
    v_accvgpr_write_b32 a22, v50
    v_accvgpr_write_b32 a23, v51
    v_accvgpr_read_b32 v48, a36
    v_accvgpr_read_b32 v49, a37
    v_accvgpr_read_b32 v50, a38
    v_accvgpr_read_b32 v51, a39
    v_mul_f32 v48, v48, v57
    v_mul_f32 v49, v49, v57
    v_mul_f32 v50, v50, v57
    v_mul_f32 v51, v51, v57
    v_accvgpr_write_b32 a36, v48
    v_accvgpr_write_b32 a37, v49
    v_accvgpr_write_b32 a38, v50
    v_accvgpr_write_b32 a39, v51
    v_accvgpr_read_b32 v48, a52
    v_accvgpr_read_b32 v49, a53
    v_accvgpr_read_b32 v50, a54
    v_accvgpr_read_b32 v51, a55
    v_mul_f32 v48, v48, v57
    v_mul_f32 v49, v49, v57
    v_mul_f32 v50, v50, v57
    v_mul_f32 v51, v51, v57
    v_accvgpr_write_b32 a52, v48
    v_accvgpr_write_b32 a53, v49
    v_accvgpr_write_b32 a54, v50
    v_accvgpr_write_b32 a55, v51
    v_accvgpr_read_b32 v48, a68
    v_accvgpr_read_b32 v49, a69
    v_accvgpr_read_b32 v50, a70
    v_accvgpr_read_b32 v51, a71
    v_mul_f32 v48, v48, v57
    v_mul_f32 v49, v49, v57
    v_mul_f32 v50, v50, v57
    v_mul_f32 v51, v51, v57
    v_accvgpr_write_b32 a68, v48
    v_accvgpr_write_b32 a69, v49
    v_accvgpr_write_b32 a70, v50
    v_accvgpr_write_b32 a71, v51
    v_accvgpr_read_b32 v48, a84
    v_accvgpr_read_b32 v49, a85
    v_accvgpr_read_b32 v50, a86
    v_accvgpr_read_b32 v51, a87
    v_mul_f32 v48, v48, v57
    v_mul_f32 v49, v49, v57
    v_mul_f32 v50, v50, v57
    v_mul_f32 v51, v51, v57
    v_accvgpr_write_b32 a84, v48
    v_accvgpr_write_b32 a85, v49
    v_accvgpr_write_b32 a86, v50
    v_accvgpr_write_b32 a87, v51
    v_accvgpr_read_b32 v48, a100
    v_accvgpr_read_b32 v49, a101
    v_accvgpr_read_b32 v50, a102
    v_accvgpr_read_b32 v51, a103
    v_mul_f32 v48, v48, v57
    v_mul_f32 v49, v49, v57
    v_mul_f32 v50, v50, v57
    v_mul_f32 v51, v51, v57
    v_accvgpr_write_b32 a100, v48
    v_accvgpr_write_b32 a101, v49
    v_accvgpr_write_b32 a102, v50
    v_accvgpr_write_b32 a103, v51
    v_accvgpr_read_b32 v48, a116
    v_accvgpr_read_b32 v49, a117
    v_accvgpr_read_b32 v50, a118
    v_accvgpr_read_b32 v51, a119
    v_mul_f32 v48, v48, v57
    v_mul_f32 v49, v49, v57
    v_mul_f32 v50, v50, v57
    v_mul_f32 v51, v51, v57
    v_accvgpr_write_b32 a116, v48
    v_accvgpr_write_b32 a117, v49
    v_accvgpr_write_b32 a118, v50
    v_accvgpr_write_b32 a119, v51
    v_accvgpr_read_b32 v48, a132
    v_accvgpr_read_b32 v49, a133
    v_accvgpr_read_b32 v50, a134
    v_accvgpr_read_b32 v51, a135
    v_mul_f32 v48, v48, v57
    v_mul_f32 v49, v49, v57
    v_mul_f32 v50, v50, v57
    v_mul_f32 v51, v51, v57
    v_accvgpr_write_b32 a132, v48
    v_accvgpr_write_b32 a133, v49
    v_accvgpr_write_b32 a134, v50
    v_accvgpr_write_b32 a135, v51
    v_accvgpr_read_b32 v48, a148
    v_accvgpr_read_b32 v49, a149
    v_accvgpr_read_b32 v50, a150
    v_accvgpr_read_b32 v51, a151
    v_mul_f32 v48, v48, v57
    v_mul_f32 v49, v49, v57
    v_mul_f32 v50, v50, v57
    v_mul_f32 v51, v51, v57
    v_accvgpr_write_b32 a148, v48
    v_accvgpr_write_b32 a149, v49
    v_accvgpr_write_b32 a150, v50
    v_accvgpr_write_b32 a151, v51
    v_accvgpr_read_b32 v48, a164
    v_accvgpr_read_b32 v49, a165
    v_accvgpr_read_b32 v50, a166
    v_accvgpr_read_b32 v51, a167
    v_mul_f32 v48, v48, v57
    v_mul_f32 v49, v49, v57
    v_mul_f32 v50, v50, v57
    v_mul_f32 v51, v51, v57
    v_accvgpr_write_b32 a164, v48
    v_accvgpr_write_b32 a165, v49
    v_accvgpr_write_b32 a166, v50
    v_accvgpr_write_b32 a167, v51
    v_accvgpr_read_b32 v48, a180
    v_accvgpr_read_b32 v49, a181
    v_accvgpr_read_b32 v50, a182
    v_accvgpr_read_b32 v51, a183
    v_mul_f32 v48, v48, v57
    v_mul_f32 v49, v49, v57
    v_mul_f32 v50, v50, v57
    v_mul_f32 v51, v51, v57
    v_accvgpr_write_b32 a180, v48
    v_accvgpr_write_b32 a181, v49
    v_accvgpr_write_b32 a182, v50
    v_accvgpr_write_b32 a183, v51
    v_exp_f32 v48, v76
    v_exp_f32 v49, v77
    v_exp_f32 v50, v78
    v_exp_f32 v51, v79
    v_exp_f32 v52, v108
    v_exp_f32 v53, v109
    v_exp_f32 v54, v110
    v_exp_f32 v55, v111
    s_nop 0
    v_cvt_pk_bf16_f32 v204, v48, v49
    v_cvt_pk_bf16_f32 v205, v50, v51
    v_cvt_pk_bf16_f32 v206, v52, v53
    v_cvt_pk_bf16_f32 v207, v54, v55
    v_add_f32 v25, v48, v49
    v_add_f32 v25, v25, v50
    v_add_f32 v25, v25, v51
    v_add_f32 v25, v25, v52
    v_add_f32 v25, v25, v53
    v_add_f32 v25, v25, v54
    v_add_f32 v25, v25, v55
    v_max3_f32 v56, v84, v85, v86
    v_max3_f32 v56, v56, v87, v116
    v_max3_f32 v56, v56, v117, v118
    v_max3_f32 v56, v56, v119, 0
    v_mov_b32 v58, v56
    s_nop 1
    v_permlane16_swap_b32 v56, v58
    s_nop 1
    v_max_f32 v56, v56, v58
    v_mov_b32 v58, v56
    s_nop 1
    v_permlane32_swap_b32 v56, v58
    s_nop 1
    v_max_f32 v56, v56, v58
    v_exp_f32 v57, -v56
    v_sub_f32 v40, v40, v56
    v_sub_f32 v41, v41, v56
    v_sub_f32 v42, v42, v56
    v_sub_f32 v43, v43, v56
    v_mul_f32 v22, v22, v57
    v_sub_f32 v84, v84, v56
    v_sub_f32 v85, v85, v56
    v_sub_f32 v86, v86, v56
    v_sub_f32 v87, v87, v56
    v_sub_f32 v116, v116, v56
    v_sub_f32 v117, v117, v56
    v_sub_f32 v118, v118, v56
    v_sub_f32 v119, v119, v56
    v_sub_f32 v148, v148, v56
    v_sub_f32 v149, v149, v56
    v_sub_f32 v150, v150, v56
    v_sub_f32 v151, v151, v56
    v_sub_f32 v180, v180, v56
    v_sub_f32 v181, v181, v56
    v_sub_f32 v182, v182, v56
    v_sub_f32 v183, v183, v56
    v_accvgpr_read_b32 v48, a8
    v_accvgpr_read_b32 v49, a9
    v_accvgpr_read_b32 v50, a10
    v_accvgpr_read_b32 v51, a11
    v_mul_f32 v48, v48, v57
    v_mul_f32 v49, v49, v57
    v_mul_f32 v50, v50, v57
    v_mul_f32 v51, v51, v57
    v_accvgpr_write_b32 a8, v48
    v_accvgpr_write_b32 a9, v49
    v_accvgpr_write_b32 a10, v50
    v_accvgpr_write_b32 a11, v51
    v_accvgpr_read_b32 v48, a24
    v_accvgpr_read_b32 v49, a25
    v_accvgpr_read_b32 v50, a26
    v_accvgpr_read_b32 v51, a27
    v_mul_f32 v48, v48, v57
    v_mul_f32 v49, v49, v57
    v_mul_f32 v50, v50, v57
    v_mul_f32 v51, v51, v57
    v_accvgpr_write_b32 a24, v48
    v_accvgpr_write_b32 a25, v49
    v_accvgpr_write_b32 a26, v50
    v_accvgpr_write_b32 a27, v51
    v_accvgpr_read_b32 v48, a40
    v_accvgpr_read_b32 v49, a41
    v_accvgpr_read_b32 v50, a42
    v_accvgpr_read_b32 v51, a43
    v_mul_f32 v48, v48, v57
    v_mul_f32 v49, v49, v57
    v_mul_f32 v50, v50, v57
    v_mul_f32 v51, v51, v57
    v_accvgpr_write_b32 a40, v48
    v_accvgpr_write_b32 a41, v49
    v_accvgpr_write_b32 a42, v50
    v_accvgpr_write_b32 a43, v51
    v_accvgpr_read_b32 v48, a56
    v_accvgpr_read_b32 v49, a57
    v_accvgpr_read_b32 v50, a58
    v_accvgpr_read_b32 v51, a59
    v_mul_f32 v48, v48, v57
    v_mul_f32 v49, v49, v57
    v_mul_f32 v50, v50, v57
    v_mul_f32 v51, v51, v57
    v_accvgpr_write_b32 a56, v48
    v_accvgpr_write_b32 a57, v49
    v_accvgpr_write_b32 a58, v50
    v_accvgpr_write_b32 a59, v51
    v_accvgpr_read_b32 v48, a72
    v_accvgpr_read_b32 v49, a73
    v_accvgpr_read_b32 v50, a74
    v_accvgpr_read_b32 v51, a75
    v_mul_f32 v48, v48, v57
    v_mul_f32 v49, v49, v57
    v_mul_f32 v50, v50, v57
    v_mul_f32 v51, v51, v57
    v_accvgpr_write_b32 a72, v48
    v_accvgpr_write_b32 a73, v49
    v_accvgpr_write_b32 a74, v50
    v_accvgpr_write_b32 a75, v51
    v_accvgpr_read_b32 v48, a88
    v_accvgpr_read_b32 v49, a89
    v_accvgpr_read_b32 v50, a90
    v_accvgpr_read_b32 v51, a91
    v_mul_f32 v48, v48, v57
    v_mul_f32 v49, v49, v57
    v_mul_f32 v50, v50, v57
    v_mul_f32 v51, v51, v57
    v_accvgpr_write_b32 a88, v48
    v_accvgpr_write_b32 a89, v49
    v_accvgpr_write_b32 a90, v50
    v_accvgpr_write_b32 a91, v51
    v_accvgpr_read_b32 v48, a104
    v_accvgpr_read_b32 v49, a105
    v_accvgpr_read_b32 v50, a106
    v_accvgpr_read_b32 v51, a107
    v_mul_f32 v48, v48, v57
    v_mul_f32 v49, v49, v57
    v_mul_f32 v50, v50, v57
    v_mul_f32 v51, v51, v57
    v_accvgpr_write_b32 a104, v48
    v_accvgpr_write_b32 a105, v49
    v_accvgpr_write_b32 a106, v50
    v_accvgpr_write_b32 a107, v51
    v_accvgpr_read_b32 v48, a120
    v_accvgpr_read_b32 v49, a121
    v_accvgpr_read_b32 v50, a122
    v_accvgpr_read_b32 v51, a123
    v_mul_f32 v48, v48, v57
    v_mul_f32 v49, v49, v57
    v_mul_f32 v50, v50, v57
    v_mul_f32 v51, v51, v57
    v_accvgpr_write_b32 a120, v48
    v_accvgpr_write_b32 a121, v49
    v_accvgpr_write_b32 a122, v50
    v_accvgpr_write_b32 a123, v51
    v_accvgpr_read_b32 v48, a136
    v_accvgpr_read_b32 v49, a137
    v_accvgpr_read_b32 v50, a138
    v_accvgpr_read_b32 v51, a139
    v_mul_f32 v48, v48, v57
    v_mul_f32 v49, v49, v57
    v_mul_f32 v50, v50, v57
    v_mul_f32 v51, v51, v57
    v_accvgpr_write_b32 a136, v48
    v_accvgpr_write_b32 a137, v49
    v_accvgpr_write_b32 a138, v50
    v_accvgpr_write_b32 a139, v51
    v_accvgpr_read_b32 v48, a152
    v_accvgpr_read_b32 v49, a153
    v_accvgpr_read_b32 v50, a154
    v_accvgpr_read_b32 v51, a155
    v_mul_f32 v48, v48, v57
    v_mul_f32 v49, v49, v57
    v_mul_f32 v50, v50, v57
    v_mul_f32 v51, v51, v57
    v_accvgpr_write_b32 a152, v48
    v_accvgpr_write_b32 a153, v49
    v_accvgpr_write_b32 a154, v50
    v_accvgpr_write_b32 a155, v51
    v_accvgpr_read_b32 v48, a168
    v_accvgpr_read_b32 v49, a169
    v_accvgpr_read_b32 v50, a170
    v_accvgpr_read_b32 v51, a171
    v_mul_f32 v48, v48, v57
    v_mul_f32 v49, v49, v57
    v_mul_f32 v50, v50, v57
    v_mul_f32 v51, v51, v57
    v_accvgpr_write_b32 a168, v48
    v_accvgpr_write_b32 a169, v49
    v_accvgpr_write_b32 a170, v50
    v_accvgpr_write_b32 a171, v51
    v_accvgpr_read_b32 v48, a184
    v_accvgpr_read_b32 v49, a185
    v_accvgpr_read_b32 v50, a186
    v_accvgpr_read_b32 v51, a187
    v_mul_f32 v48, v48, v57
    v_mul_f32 v49, v49, v57
    v_mul_f32 v50, v50, v57
    v_mul_f32 v51, v51, v57
    v_accvgpr_write_b32 a184, v48
    v_accvgpr_write_b32 a185, v49
    v_accvgpr_write_b32 a186, v50
    v_accvgpr_write_b32 a187, v51
    v_exp_f32 v48, v84
    v_exp_f32 v49, v85
    v_exp_f32 v50, v86
    v_exp_f32 v51, v87
    v_exp_f32 v52, v116
    v_exp_f32 v53, v117
    v_exp_f32 v54, v118
    v_exp_f32 v55, v119
    s_nop 0
    v_cvt_pk_bf16_f32 v212, v48, v49
    v_cvt_pk_bf16_f32 v213, v50, v51
    v_cvt_pk_bf16_f32 v214, v52, v53
    v_cvt_pk_bf16_f32 v215, v54, v55
    v_add_f32 v26, v48, v49
    v_add_f32 v26, v26, v50
    v_add_f32 v26, v26, v51
    v_add_f32 v26, v26, v52
    v_add_f32 v26, v26, v53
    v_add_f32 v26, v26, v54
    v_add_f32 v26, v26, v55
    v_max3_f32 v56, v92, v93, v94
    v_max3_f32 v56, v56, v95, v124
    v_max3_f32 v56, v56, v125, v126
    v_max3_f32 v56, v56, v127, 0
    v_mov_b32 v58, v56
    s_nop 1
    v_permlane16_swap_b32 v56, v58
    s_nop 1
    v_max_f32 v56, v56, v58
    v_mov_b32 v58, v56
    s_nop 1
    v_permlane32_swap_b32 v56, v58
    s_nop 1
    v_max_f32 v56, v56, v58
    v_exp_f32 v57, -v56
    v_sub_f32 v44, v44, v56
    v_sub_f32 v45, v45, v56
    v_sub_f32 v46, v46, v56
    v_sub_f32 v47, v47, v56
    v_mul_f32 v23, v23, v57
    v_sub_f32 v92, v92, v56
    v_sub_f32 v93, v93, v56
    v_sub_f32 v94, v94, v56
    v_sub_f32 v95, v95, v56
    v_sub_f32 v124, v124, v56
    v_sub_f32 v125, v125, v56
    v_sub_f32 v126, v126, v56
    v_sub_f32 v127, v127, v56
    v_sub_f32 v156, v156, v56
    v_sub_f32 v157, v157, v56
    v_sub_f32 v158, v158, v56
    v_sub_f32 v159, v159, v56
    v_sub_f32 v188, v188, v56
    v_sub_f32 v189, v189, v56
    v_sub_f32 v190, v190, v56
    v_sub_f32 v191, v191, v56
    v_accvgpr_read_b32 v48, a12
    v_accvgpr_read_b32 v49, a13
    v_accvgpr_read_b32 v50, a14
    v_accvgpr_read_b32 v51, a15
    v_mul_f32 v48, v48, v57
    v_mul_f32 v49, v49, v57
    v_mul_f32 v50, v50, v57
    v_mul_f32 v51, v51, v57
    v_accvgpr_write_b32 a12, v48
    v_accvgpr_write_b32 a13, v49
    v_accvgpr_write_b32 a14, v50
    v_accvgpr_write_b32 a15, v51
    v_accvgpr_read_b32 v48, a28
    v_accvgpr_read_b32 v49, a29
    v_accvgpr_read_b32 v50, a30
    v_accvgpr_read_b32 v51, a31
    v_mul_f32 v48, v48, v57
    v_mul_f32 v49, v49, v57
    v_mul_f32 v50, v50, v57
    v_mul_f32 v51, v51, v57
    v_accvgpr_write_b32 a28, v48
    v_accvgpr_write_b32 a29, v49
    v_accvgpr_write_b32 a30, v50
    v_accvgpr_write_b32 a31, v51
    v_accvgpr_read_b32 v48, a44
    v_accvgpr_read_b32 v49, a45
    v_accvgpr_read_b32 v50, a46
    v_accvgpr_read_b32 v51, a47
    v_mul_f32 v48, v48, v57
    v_mul_f32 v49, v49, v57
    v_mul_f32 v50, v50, v57
    v_mul_f32 v51, v51, v57
    v_accvgpr_write_b32 a44, v48
    v_accvgpr_write_b32 a45, v49
    v_accvgpr_write_b32 a46, v50
    v_accvgpr_write_b32 a47, v51
    v_accvgpr_read_b32 v48, a60
    v_accvgpr_read_b32 v49, a61
    v_accvgpr_read_b32 v50, a62
    v_accvgpr_read_b32 v51, a63
    v_mul_f32 v48, v48, v57
    v_mul_f32 v49, v49, v57
    v_mul_f32 v50, v50, v57
    v_mul_f32 v51, v51, v57
    v_accvgpr_write_b32 a60, v48
    v_accvgpr_write_b32 a61, v49
    v_accvgpr_write_b32 a62, v50
    v_accvgpr_write_b32 a63, v51
    v_accvgpr_read_b32 v48, a76
    v_accvgpr_read_b32 v49, a77
    v_accvgpr_read_b32 v50, a78
    v_accvgpr_read_b32 v51, a79
    v_mul_f32 v48, v48, v57
    v_mul_f32 v49, v49, v57
    v_mul_f32 v50, v50, v57
    v_mul_f32 v51, v51, v57
    v_accvgpr_write_b32 a76, v48
    v_accvgpr_write_b32 a77, v49
    v_accvgpr_write_b32 a78, v50
    v_accvgpr_write_b32 a79, v51
    v_accvgpr_read_b32 v48, a92
    v_accvgpr_read_b32 v49, a93
    v_accvgpr_read_b32 v50, a94
    v_accvgpr_read_b32 v51, a95
    v_mul_f32 v48, v48, v57
    v_mul_f32 v49, v49, v57
    v_mul_f32 v50, v50, v57
    v_mul_f32 v51, v51, v57
    v_accvgpr_write_b32 a92, v48
    v_accvgpr_write_b32 a93, v49
    v_accvgpr_write_b32 a94, v50
    v_accvgpr_write_b32 a95, v51
    v_accvgpr_read_b32 v48, a108
    v_accvgpr_read_b32 v49, a109
    v_accvgpr_read_b32 v50, a110
    v_accvgpr_read_b32 v51, a111
    v_mul_f32 v48, v48, v57
    v_mul_f32 v49, v49, v57
    v_mul_f32 v50, v50, v57
    v_mul_f32 v51, v51, v57
    v_accvgpr_write_b32 a108, v48
    v_accvgpr_write_b32 a109, v49
    v_accvgpr_write_b32 a110, v50
    v_accvgpr_write_b32 a111, v51
    v_accvgpr_read_b32 v48, a124
    v_accvgpr_read_b32 v49, a125
    v_accvgpr_read_b32 v50, a126
    v_accvgpr_read_b32 v51, a127
    v_mul_f32 v48, v48, v57
    v_mul_f32 v49, v49, v57
    v_mul_f32 v50, v50, v57
    v_mul_f32 v51, v51, v57
    v_accvgpr_write_b32 a124, v48
    v_accvgpr_write_b32 a125, v49
    v_accvgpr_write_b32 a126, v50
    v_accvgpr_write_b32 a127, v51
    v_accvgpr_read_b32 v48, a140
    v_accvgpr_read_b32 v49, a141
    v_accvgpr_read_b32 v50, a142
    v_accvgpr_read_b32 v51, a143
    v_mul_f32 v48, v48, v57
    v_mul_f32 v49, v49, v57
    v_mul_f32 v50, v50, v57
    v_mul_f32 v51, v51, v57
    v_accvgpr_write_b32 a140, v48
    v_accvgpr_write_b32 a141, v49
    v_accvgpr_write_b32 a142, v50
    v_accvgpr_write_b32 a143, v51
    v_accvgpr_read_b32 v48, a156
    v_accvgpr_read_b32 v49, a157
    v_accvgpr_read_b32 v50, a158
    v_accvgpr_read_b32 v51, a159
    v_mul_f32 v48, v48, v57
    v_mul_f32 v49, v49, v57
    v_mul_f32 v50, v50, v57
    v_mul_f32 v51, v51, v57
    v_accvgpr_write_b32 a156, v48
    v_accvgpr_write_b32 a157, v49
    v_accvgpr_write_b32 a158, v50
    v_accvgpr_write_b32 a159, v51
    v_accvgpr_read_b32 v48, a172
    v_accvgpr_read_b32 v49, a173
    v_accvgpr_read_b32 v50, a174
    v_accvgpr_read_b32 v51, a175
    v_mul_f32 v48, v48, v57
    v_mul_f32 v49, v49, v57
    v_mul_f32 v50, v50, v57
    v_mul_f32 v51, v51, v57
    v_accvgpr_write_b32 a172, v48
    v_accvgpr_write_b32 a173, v49
    v_accvgpr_write_b32 a174, v50
    v_accvgpr_write_b32 a175, v51
    v_accvgpr_read_b32 v48, a188
    v_accvgpr_read_b32 v49, a189
    v_accvgpr_read_b32 v50, a190
    v_accvgpr_read_b32 v51, a191
    v_mul_f32 v48, v48, v57
    v_mul_f32 v49, v49, v57
    v_mul_f32 v50, v50, v57
    v_mul_f32 v51, v51, v57
    v_accvgpr_write_b32 a188, v48
    v_accvgpr_write_b32 a189, v49
    v_accvgpr_write_b32 a190, v50
    v_accvgpr_write_b32 a191, v51
    v_exp_f32 v48, v92
    v_exp_f32 v49, v93
    v_exp_f32 v50, v94
    v_exp_f32 v51, v95
    v_exp_f32 v52, v124
    v_exp_f32 v53, v125
    v_exp_f32 v54, v126
    v_exp_f32 v55, v127
    s_nop 0
    v_cvt_pk_bf16_f32 v220, v48, v49
    v_cvt_pk_bf16_f32 v221, v50, v51
    v_cvt_pk_bf16_f32 v222, v52, v53
    v_cvt_pk_bf16_f32 v223, v54, v55
    v_add_f32 v27, v48, v49
    v_add_f32 v27, v27, v50
    v_add_f32 v27, v27, v51
    v_add_f32 v27, v27, v52
    v_add_f32 v27, v27, v53
    v_add_f32 v27, v27, v54
    v_add_f32 v27, v27, v55
    s_nop 1
    s_branch rare_p_ret
rare_a:
    s_nop 7
    s_nop 7
    v_max3_f32 v56, v132, v133, v134
    v_max3_f32 v56, v56, v135, v164
    v_max3_f32 v56, v56, v165, v166
    v_max3_f32 v56, v56, v167, 0
    v_mov_b32 v58, v56
    s_nop 1
    v_permlane16_swap_b32 v56, v58
    s_nop 1
    v_max_f32 v56, v56, v58
    v_mov_b32 v58, v56
    s_nop 1
    v_permlane32_swap_b32 v56, v58
    s_nop 1
    v_max_f32 v56, v56, v58
    v_exp_f32 v57, -v56
    v_sub_f32 v32, v32, v56
    v_sub_f32 v33, v33, v56
    v_sub_f32 v34, v34, v56
    v_sub_f32 v35, v35, v56
    v_mul_f32 v20, v20, v57
    v_sub_f32 v132, v132, v56
    v_sub_f32 v133, v133, v56
    v_sub_f32 v134, v134, v56
    v_sub_f32 v135, v135, v56
    v_sub_f32 v164, v164, v56
    v_sub_f32 v165, v165, v56
    v_sub_f32 v166, v166, v56
    v_sub_f32 v167, v167, v56
    v_sub_f32 v68, v68, v56
    v_sub_f32 v69, v69, v56
    v_sub_f32 v70, v70, v56
    v_sub_f32 v71, v71, v56
    v_sub_f32 v100, v100, v56
    v_sub_f32 v101, v101, v56
    v_sub_f32 v102, v102, v56
    v_sub_f32 v103, v103, v56
    v_accvgpr_read_b32 v48, a0
    v_accvgpr_read_b32 v49, a1
    v_accvgpr_read_b32 v50, a2
    v_accvgpr_read_b32 v51, a3
    v_mul_f32 v48, v48, v57
    v_mul_f32 v49, v49, v57
    v_mul_f32 v50, v50, v57
    v_mul_f32 v51, v51, v57
    v_accvgpr_write_b32 a0, v48
    v_accvgpr_write_b32 a1, v49
    v_accvgpr_write_b32 a2, v50
    v_accvgpr_write_b32 a3, v51
    v_accvgpr_read_b32 v48, a16
    v_accvgpr_read_b32 v49, a17
    v_accvgpr_read_b32 v50, a18
    v_accvgpr_read_b32 v51, a19
    v_mul_f32 v48, v48, v57
    v_mul_f32 v49, v49, v57
    v_mul_f32 v50, v50, v57
    v_mul_f32 v51, v51, v57
    v_accvgpr_write_b32 a16, v48
    v_accvgpr_write_b32 a17, v49
    v_accvgpr_write_b32 a18, v50
    v_accvgpr_write_b32 a19, v51
    v_accvgpr_read_b32 v48, a32
    v_accvgpr_read_b32 v49, a33
    v_accvgpr_read_b32 v50, a34
    v_accvgpr_read_b32 v51, a35
    v_mul_f32 v48, v48, v57
    v_mul_f32 v49, v49, v57
    v_mul_f32 v50, v50, v57
    v_mul_f32 v51, v51, v57
    v_accvgpr_write_b32 a32, v48
    v_accvgpr_write_b32 a33, v49
    v_accvgpr_write_b32 a34, v50
    v_accvgpr_write_b32 a35, v51
    v_accvgpr_read_b32 v48, a48
    v_accvgpr_read_b32 v49, a49
    v_accvgpr_read_b32 v50, a50
    v_accvgpr_read_b32 v51, a51
    v_mul_f32 v48, v48, v57
    v_mul_f32 v49, v49, v57
    v_mul_f32 v50, v50, v57
    v_mul_f32 v51, v51, v57
    v_accvgpr_write_b32 a48, v48
    v_accvgpr_write_b32 a49, v49
    v_accvgpr_write_b32 a50, v50
    v_accvgpr_write_b32 a51, v51
    v_accvgpr_read_b32 v48, a64
    v_accvgpr_read_b32 v49, a65
    v_accvgpr_read_b32 v50, a66
    v_accvgpr_read_b32 v51, a67
    v_mul_f32 v48, v48, v57
    v_mul_f32 v49, v49, v57
    v_mul_f32 v50, v50, v57
    v_mul_f32 v51, v51, v57
    v_accvgpr_write_b32 a64, v48
    v_accvgpr_write_b32 a65, v49
    v_accvgpr_write_b32 a66, v50
    v_accvgpr_write_b32 a67, v51
    v_accvgpr_read_b32 v48, a80
    v_accvgpr_read_b32 v49, a81
    v_accvgpr_read_b32 v50, a82
    v_accvgpr_read_b32 v51, a83
    v_mul_f32 v48, v48, v57
    v_mul_f32 v49, v49, v57
    v_mul_f32 v50, v50, v57
    v_mul_f32 v51, v51, v57
    v_accvgpr_write_b32 a80, v48
    v_accvgpr_write_b32 a81, v49
    v_accvgpr_write_b32 a82, v50
    v_accvgpr_write_b32 a83, v51
    v_accvgpr_read_b32 v48, a96
    v_accvgpr_read_b32 v49, a97
    v_accvgpr_read_b32 v50, a98
    v_accvgpr_read_b32 v51, a99
    v_mul_f32 v48, v48, v57
    v_mul_f32 v49, v49, v57
    v_mul_f32 v50, v50, v57
    v_mul_f32 v51, v51, v57
    v_accvgpr_write_b32 a96, v48
    v_accvgpr_write_b32 a97, v49
    v_accvgpr_write_b32 a98, v50
    v_accvgpr_write_b32 a99, v51
    v_accvgpr_read_b32 v48, a112
    v_accvgpr_read_b32 v49, a113
    v_accvgpr_read_b32 v50, a114
    v_accvgpr_read_b32 v51, a115
    v_mul_f32 v48, v48, v57
    v_mul_f32 v49, v49, v57
    v_mul_f32 v50, v50, v57
    v_mul_f32 v51, v51, v57
    v_accvgpr_write_b32 a112, v48
    v_accvgpr_write_b32 a113, v49
    v_accvgpr_write_b32 a114, v50
    v_accvgpr_write_b32 a115, v51
    v_accvgpr_read_b32 v48, a128
    v_accvgpr_read_b32 v49, a129
    v_accvgpr_read_b32 v50, a130
    v_accvgpr_read_b32 v51, a131
    v_mul_f32 v48, v48, v57
    v_mul_f32 v49, v49, v57
    v_mul_f32 v50, v50, v57
    v_mul_f32 v51, v51, v57
    v_accvgpr_write_b32 a128, v48
    v_accvgpr_write_b32 a129, v49
    v_accvgpr_write_b32 a130, v50
    v_accvgpr_write_b32 a131, v51
    v_accvgpr_read_b32 v48, a144
    v_accvgpr_read_b32 v49, a145
    v_accvgpr_read_b32 v50, a146
    v_accvgpr_read_b32 v51, a147
    v_mul_f32 v48, v48, v57
    v_mul_f32 v49, v49, v57
    v_mul_f32 v50, v50, v57
    v_mul_f32 v51, v51, v57
    v_accvgpr_write_b32 a144, v48
    v_accvgpr_write_b32 a145, v49
    v_accvgpr_write_b32 a146, v50
    v_accvgpr_write_b32 a147, v51
    v_accvgpr_read_b32 v48, a160
    v_accvgpr_read_b32 v49, a161
    v_accvgpr_read_b32 v50, a162
    v_accvgpr_read_b32 v51, a163
    v_mul_f32 v48, v48, v57
    v_mul_f32 v49, v49, v57
    v_mul_f32 v50, v50, v57
    v_mul_f32 v51, v51, v57
    v_accvgpr_write_b32 a160, v48
    v_accvgpr_write_b32 a161, v49
    v_accvgpr_write_b32 a162, v50
    v_accvgpr_write_b32 a163, v51
    v_accvgpr_read_b32 v48, a176
    v_accvgpr_read_b32 v49, a177
    v_accvgpr_read_b32 v50, a178
    v_accvgpr_read_b32 v51, a179
    v_mul_f32 v48, v48, v57
    v_mul_f32 v49, v49, v57
    v_mul_f32 v50, v50, v57
    v_mul_f32 v51, v51, v57
    v_accvgpr_write_b32 a176, v48
    v_accvgpr_write_b32 a177, v49
    v_accvgpr_write_b32 a178, v50
    v_accvgpr_write_b32 a179, v51
    v_exp_f32 v48, v132
    v_exp_f32 v49, v133
    v_exp_f32 v50, v134
    v_exp_f32 v51, v135
    v_exp_f32 v52, v164
    v_exp_f32 v53, v165
    v_exp_f32 v54, v166
    v_exp_f32 v55, v167
    s_nop 0
    v_cvt_pk_bf16_f32 v228, v48, v49
    v_cvt_pk_bf16_f32 v229, v50, v51
    v_cvt_pk_bf16_f32 v230, v52, v53
    v_cvt_pk_bf16_f32 v231, v54, v55
    v_add_f32 v24, v48, v49
    v_add_f32 v24, v24, v50
    v_add_f32 v24, v24, v51
    v_add_f32 v24, v24, v52
    v_add_f32 v24, v24, v53
    v_add_f32 v24, v24, v54
    v_add_f32 v24, v24, v55
    v_max3_f32 v56, v140, v141, v142
    v_max3_f32 v56, v56, v143, v172
    v_max3_f32 v56, v56, v173, v174
    v_max3_f32 v56, v56, v175, 0
    v_mov_b32 v58, v56
    s_nop 1
    v_permlane16_swap_b32 v56, v58
    s_nop 1
    v_max_f32 v56, v56, v58
    v_mov_b32 v58, v56
    s_nop 1
    v_permlane32_swap_b32 v56, v58
    s_nop 1
    v_max_f32 v56, v56, v58
    v_exp_f32 v57, -v56
    v_sub_f32 v36, v36, v56
    v_sub_f32 v37, v37, v56
    v_sub_f32 v38, v38, v56
    v_sub_f32 v39, v39, v56
    v_mul_f32 v21, v21, v57
    v_sub_f32 v140, v140, v56
    v_sub_f32 v141, v141, v56
    v_sub_f32 v142, v142, v56
    v_sub_f32 v143, v143, v56
    v_sub_f32 v172, v172, v56
    v_sub_f32 v173, v173, v56
    v_sub_f32 v174, v174, v56
    v_sub_f32 v175, v175, v56
    v_sub_f32 v76, v76, v56
    v_sub_f32 v77, v77, v56
    v_sub_f32 v78, v78, v56
    v_sub_f32 v79, v79, v56
    v_sub_f32 v108, v108, v56
    v_sub_f32 v109, v109, v56
    v_sub_f32 v110, v110, v56
    v_sub_f32 v111, v111, v56
    v_accvgpr_read_b32 v48, a4
    v_accvgpr_read_b32 v49, a5
    v_accvgpr_read_b32 v50, a6
    v_accvgpr_read_b32 v51, a7
    v_mul_f32 v48, v48, v57
    v_mul_f32 v49, v49, v57
    v_mul_f32 v50, v50, v57
    v_mul_f32 v51, v51, v57
    v_accvgpr_write_b32 a4, v48
    v_accvgpr_write_b32 a5, v49
    v_accvgpr_write_b32 a6, v50
    v_accvgpr_write_b32 a7, v51
    v_accvgpr_read_b32 v48, a20
    v_accvgpr_read_b32 v49, a21
    v_accvgpr_read_b32 v50, a22
    v_accvgpr_read_b32 v51, a23
    v_mul_f32 v48, v48, v57
    v_mul_f32 v49, v49, v57
    v_mul_f32 v50, v50, v57
    v_mul_f32 v51, v51, v57
    v_accvgpr_write_b32 a20, v48
    v_accvgpr_write_b32 a21, v49
    v_accvgpr_write_b32 a22, v50
    v_accvgpr_write_b32 a23, v51
    v_accvgpr_read_b32 v48, a36
    v_accvgpr_read_b32 v49, a37
    v_accvgpr_read_b32 v50, a38
    v_accvgpr_read_b32 v51, a39
    v_mul_f32 v48, v48, v57
    v_mul_f32 v49, v49, v57
    v_mul_f32 v50, v50, v57
    v_mul_f32 v51, v51, v57
    v_accvgpr_write_b32 a36, v48
    v_accvgpr_write_b32 a37, v49
    v_accvgpr_write_b32 a38, v50
    v_accvgpr_write_b32 a39, v51
    v_accvgpr_read_b32 v48, a52
    v_accvgpr_read_b32 v49, a53
    v_accvgpr_read_b32 v50, a54
    v_accvgpr_read_b32 v51, a55
    v_mul_f32 v48, v48, v57
    v_mul_f32 v49, v49, v57
    v_mul_f32 v50, v50, v57
    v_mul_f32 v51, v51, v57
    v_accvgpr_write_b32 a52, v48
    v_accvgpr_write_b32 a53, v49
    v_accvgpr_write_b32 a54, v50
    v_accvgpr_write_b32 a55, v51
    v_accvgpr_read_b32 v48, a68
    v_accvgpr_read_b32 v49, a69
    v_accvgpr_read_b32 v50, a70
    v_accvgpr_read_b32 v51, a71
    v_mul_f32 v48, v48, v57
    v_mul_f32 v49, v49, v57
    v_mul_f32 v50, v50, v57
    v_mul_f32 v51, v51, v57
    v_accvgpr_write_b32 a68, v48
    v_accvgpr_write_b32 a69, v49
    v_accvgpr_write_b32 a70, v50
    v_accvgpr_write_b32 a71, v51
    v_accvgpr_read_b32 v48, a84
    v_accvgpr_read_b32 v49, a85
    v_accvgpr_read_b32 v50, a86
    v_accvgpr_read_b32 v51, a87
    v_mul_f32 v48, v48, v57
    v_mul_f32 v49, v49, v57
    v_mul_f32 v50, v50, v57
    v_mul_f32 v51, v51, v57
    v_accvgpr_write_b32 a84, v48
    v_accvgpr_write_b32 a85, v49
    v_accvgpr_write_b32 a86, v50
    v_accvgpr_write_b32 a87, v51
    v_accvgpr_read_b32 v48, a100
    v_accvgpr_read_b32 v49, a101
    v_accvgpr_read_b32 v50, a102
    v_accvgpr_read_b32 v51, a103
    v_mul_f32 v48, v48, v57
    v_mul_f32 v49, v49, v57
    v_mul_f32 v50, v50, v57
    v_mul_f32 v51, v51, v57
    v_accvgpr_write_b32 a100, v48
    v_accvgpr_write_b32 a101, v49
    v_accvgpr_write_b32 a102, v50
    v_accvgpr_write_b32 a103, v51
    v_accvgpr_read_b32 v48, a116
    v_accvgpr_read_b32 v49, a117
    v_accvgpr_read_b32 v50, a118
    v_accvgpr_read_b32 v51, a119
    v_mul_f32 v48, v48, v57
    v_mul_f32 v49, v49, v57
    v_mul_f32 v50, v50, v57
    v_mul_f32 v51, v51, v57
    v_accvgpr_write_b32 a116, v48
    v_accvgpr_write_b32 a117, v49
    v_accvgpr_write_b32 a118, v50
    v_accvgpr_write_b32 a119, v51
    v_accvgpr_read_b32 v48, a132
    v_accvgpr_read_b32 v49, a133
    v_accvgpr_read_b32 v50, a134
    v_accvgpr_read_b32 v51, a135
    v_mul_f32 v48, v48, v57
    v_mul_f32 v49, v49, v57
    v_mul_f32 v50, v50, v57
    v_mul_f32 v51, v51, v57
    v_accvgpr_write_b32 a132, v48
    v_accvgpr_write_b32 a133, v49
    v_accvgpr_write_b32 a134, v50
    v_accvgpr_write_b32 a135, v51
    v_accvgpr_read_b32 v48, a148
    v_accvgpr_read_b32 v49, a149
    v_accvgpr_read_b32 v50, a150
    v_accvgpr_read_b32 v51, a151
    v_mul_f32 v48, v48, v57
    v_mul_f32 v49, v49, v57
    v_mul_f32 v50, v50, v57
    v_mul_f32 v51, v51, v57
    v_accvgpr_write_b32 a148, v48
    v_accvgpr_write_b32 a149, v49
    v_accvgpr_write_b32 a150, v50
    v_accvgpr_write_b32 a151, v51
    v_accvgpr_read_b32 v48, a164
    v_accvgpr_read_b32 v49, a165
    v_accvgpr_read_b32 v50, a166
    v_accvgpr_read_b32 v51, a167
    v_mul_f32 v48, v48, v57
    v_mul_f32 v49, v49, v57
    v_mul_f32 v50, v50, v57
    v_mul_f32 v51, v51, v57
    v_accvgpr_write_b32 a164, v48
    v_accvgpr_write_b32 a165, v49
    v_accvgpr_write_b32 a166, v50
    v_accvgpr_write_b32 a167, v51
    v_accvgpr_read_b32 v48, a180
    v_accvgpr_read_b32 v49, a181
    v_accvgpr_read_b32 v50, a182
    v_accvgpr_read_b32 v51, a183
    v_mul_f32 v48, v48, v57
    v_mul_f32 v49, v49, v57
    v_mul_f32 v50, v50, v57
    v_mul_f32 v51, v51, v57
    v_accvgpr_write_b32 a180, v48
    v_accvgpr_write_b32 a181, v49
    v_accvgpr_write_b32 a182, v50
    v_accvgpr_write_b32 a183, v51
    v_exp_f32 v48, v140
    v_exp_f32 v49, v141
    v_exp_f32 v50, v142
    v_exp_f32 v51, v143
    v_exp_f32 v52, v172
    v_exp_f32 v53, v173
    v_exp_f32 v54, v174
    v_exp_f32 v55, v175
    s_nop 0
    v_cvt_pk_bf16_f32 v236, v48, v49
    v_cvt_pk_bf16_f32 v237, v50, v51
    v_cvt_pk_bf16_f32 v238, v52, v53
    v_cvt_pk_bf16_f32 v239, v54, v55
    v_add_f32 v25, v48, v49
    v_add_f32 v25, v25, v50
    v_add_f32 v25, v25, v51
    v_add_f32 v25, v25, v52
    v_add_f32 v25, v25, v53
    v_add_f32 v25, v25, v54
    v_add_f32 v25, v25, v55
    v_max3_f32 v56, v148, v149, v150
    v_max3_f32 v56, v56, v151, v180
    v_max3_f32 v56, v56, v181, v182
    v_max3_f32 v56, v56, v183, 0
    v_mov_b32 v58, v56
    s_nop 1
    v_permlane16_swap_b32 v56, v58
    s_nop 1
    v_max_f32 v56, v56, v58
    v_mov_b32 v58, v56
    s_nop 1
    v_permlane32_swap_b32 v56, v58
    s_nop 1
    v_max_f32 v56, v56, v58
    v_exp_f32 v57, -v56
    v_sub_f32 v40, v40, v56
    v_sub_f32 v41, v41, v56
    v_sub_f32 v42, v42, v56
    v_sub_f32 v43, v43, v56
    v_mul_f32 v22, v22, v57
    v_sub_f32 v148, v148, v56
    v_sub_f32 v149, v149, v56
    v_sub_f32 v150, v150, v56
    v_sub_f32 v151, v151, v56
    v_sub_f32 v180, v180, v56
    v_sub_f32 v181, v181, v56
    v_sub_f32 v182, v182, v56
    v_sub_f32 v183, v183, v56
    v_sub_f32 v84, v84, v56
    v_sub_f32 v85, v85, v56
    v_sub_f32 v86, v86, v56
    v_sub_f32 v87, v87, v56
    v_sub_f32 v116, v116, v56
    v_sub_f32 v117, v117, v56
    v_sub_f32 v118, v118, v56
    v_sub_f32 v119, v119, v56
    v_accvgpr_read_b32 v48, a8
    v_accvgpr_read_b32 v49, a9
    v_accvgpr_read_b32 v50, a10
    v_accvgpr_read_b32 v51, a11
    v_mul_f32 v48, v48, v57
    v_mul_f32 v49, v49, v57
    v_mul_f32 v50, v50, v57
    v_mul_f32 v51, v51, v57
    v_accvgpr_write_b32 a8, v48
    v_accvgpr_write_b32 a9, v49
    v_accvgpr_write_b32 a10, v50
    v_accvgpr_write_b32 a11, v51
    v_accvgpr_read_b32 v48, a24
    v_accvgpr_read_b32 v49, a25
    v_accvgpr_read_b32 v50, a26
    v_accvgpr_read_b32 v51, a27
    v_mul_f32 v48, v48, v57
    v_mul_f32 v49, v49, v57
    v_mul_f32 v50, v50, v57
    v_mul_f32 v51, v51, v57
    v_accvgpr_write_b32 a24, v48
    v_accvgpr_write_b32 a25, v49
    v_accvgpr_write_b32 a26, v50
    v_accvgpr_write_b32 a27, v51
    v_accvgpr_read_b32 v48, a40
    v_accvgpr_read_b32 v49, a41
    v_accvgpr_read_b32 v50, a42
    v_accvgpr_read_b32 v51, a43
    v_mul_f32 v48, v48, v57
    v_mul_f32 v49, v49, v57
    v_mul_f32 v50, v50, v57
    v_mul_f32 v51, v51, v57
    v_accvgpr_write_b32 a40, v48
    v_accvgpr_write_b32 a41, v49
    v_accvgpr_write_b32 a42, v50
    v_accvgpr_write_b32 a43, v51
    v_accvgpr_read_b32 v48, a56
    v_accvgpr_read_b32 v49, a57
    v_accvgpr_read_b32 v50, a58
    v_accvgpr_read_b32 v51, a59
    v_mul_f32 v48, v48, v57
    v_mul_f32 v49, v49, v57
    v_mul_f32 v50, v50, v57
    v_mul_f32 v51, v51, v57
    v_accvgpr_write_b32 a56, v48
    v_accvgpr_write_b32 a57, v49
    v_accvgpr_write_b32 a58, v50
    v_accvgpr_write_b32 a59, v51
    v_accvgpr_read_b32 v48, a72
    v_accvgpr_read_b32 v49, a73
    v_accvgpr_read_b32 v50, a74
    v_accvgpr_read_b32 v51, a75
    v_mul_f32 v48, v48, v57
    v_mul_f32 v49, v49, v57
    v_mul_f32 v50, v50, v57
    v_mul_f32 v51, v51, v57
    v_accvgpr_write_b32 a72, v48
    v_accvgpr_write_b32 a73, v49
    v_accvgpr_write_b32 a74, v50
    v_accvgpr_write_b32 a75, v51
    v_accvgpr_read_b32 v48, a88
    v_accvgpr_read_b32 v49, a89
    v_accvgpr_read_b32 v50, a90
    v_accvgpr_read_b32 v51, a91
    v_mul_f32 v48, v48, v57
    v_mul_f32 v49, v49, v57
    v_mul_f32 v50, v50, v57
    v_mul_f32 v51, v51, v57
    v_accvgpr_write_b32 a88, v48
    v_accvgpr_write_b32 a89, v49
    v_accvgpr_write_b32 a90, v50
    v_accvgpr_write_b32 a91, v51
    v_accvgpr_read_b32 v48, a104
    v_accvgpr_read_b32 v49, a105
    v_accvgpr_read_b32 v50, a106
    v_accvgpr_read_b32 v51, a107
    v_mul_f32 v48, v48, v57
    v_mul_f32 v49, v49, v57
    v_mul_f32 v50, v50, v57
    v_mul_f32 v51, v51, v57
    v_accvgpr_write_b32 a104, v48
    v_accvgpr_write_b32 a105, v49
    v_accvgpr_write_b32 a106, v50
    v_accvgpr_write_b32 a107, v51
    v_accvgpr_read_b32 v48, a120
    v_accvgpr_read_b32 v49, a121
    v_accvgpr_read_b32 v50, a122
    v_accvgpr_read_b32 v51, a123
    v_mul_f32 v48, v48, v57
    v_mul_f32 v49, v49, v57
    v_mul_f32 v50, v50, v57
    v_mul_f32 v51, v51, v57
    v_accvgpr_write_b32 a120, v48
    v_accvgpr_write_b32 a121, v49
    v_accvgpr_write_b32 a122, v50
    v_accvgpr_write_b32 a123, v51
    v_accvgpr_read_b32 v48, a136
    v_accvgpr_read_b32 v49, a137
    v_accvgpr_read_b32 v50, a138
    v_accvgpr_read_b32 v51, a139
    v_mul_f32 v48, v48, v57
    v_mul_f32 v49, v49, v57
    v_mul_f32 v50, v50, v57
    v_mul_f32 v51, v51, v57
    v_accvgpr_write_b32 a136, v48
    v_accvgpr_write_b32 a137, v49
    v_accvgpr_write_b32 a138, v50
    v_accvgpr_write_b32 a139, v51
    v_accvgpr_read_b32 v48, a152
    v_accvgpr_read_b32 v49, a153
    v_accvgpr_read_b32 v50, a154
    v_accvgpr_read_b32 v51, a155
    v_mul_f32 v48, v48, v57
    v_mul_f32 v49, v49, v57
    v_mul_f32 v50, v50, v57
    v_mul_f32 v51, v51, v57
    v_accvgpr_write_b32 a152, v48
    v_accvgpr_write_b32 a153, v49
    v_accvgpr_write_b32 a154, v50
    v_accvgpr_write_b32 a155, v51
    v_accvgpr_read_b32 v48, a168
    v_accvgpr_read_b32 v49, a169
    v_accvgpr_read_b32 v50, a170
    v_accvgpr_read_b32 v51, a171
    v_mul_f32 v48, v48, v57
    v_mul_f32 v49, v49, v57
    v_mul_f32 v50, v50, v57
    v_mul_f32 v51, v51, v57
    v_accvgpr_write_b32 a168, v48
    v_accvgpr_write_b32 a169, v49
    v_accvgpr_write_b32 a170, v50
    v_accvgpr_write_b32 a171, v51
    v_accvgpr_read_b32 v48, a184
    v_accvgpr_read_b32 v49, a185
    v_accvgpr_read_b32 v50, a186
    v_accvgpr_read_b32 v51, a187
    v_mul_f32 v48, v48, v57
    v_mul_f32 v49, v49, v57
    v_mul_f32 v50, v50, v57
    v_mul_f32 v51, v51, v57
    v_accvgpr_write_b32 a184, v48
    v_accvgpr_write_b32 a185, v49
    v_accvgpr_write_b32 a186, v50
    v_accvgpr_write_b32 a187, v51
    v_exp_f32 v48, v148
    v_exp_f32 v49, v149
    v_exp_f32 v50, v150
    v_exp_f32 v51, v151
    v_exp_f32 v52, v180
    v_exp_f32 v53, v181
    v_exp_f32 v54, v182
    v_exp_f32 v55, v183
    s_nop 0
    v_cvt_pk_bf16_f32 v244, v48, v49
    v_cvt_pk_bf16_f32 v245, v50, v51
    v_cvt_pk_bf16_f32 v246, v52, v53
    v_cvt_pk_bf16_f32 v247, v54, v55
    v_add_f32 v26, v48, v49
    v_add_f32 v26, v26, v50
    v_add_f32 v26, v26, v51
    v_add_f32 v26, v26, v52
    v_add_f32 v26, v26, v53
    v_add_f32 v26, v26, v54
    v_add_f32 v26, v26, v55
    v_max3_f32 v56, v156, v157, v158
    v_max3_f32 v56, v56, v159, v188
    v_max3_f32 v56, v56, v189, v190
    v_max3_f32 v56, v56, v191, 0
    v_mov_b32 v58, v56
    s_nop 1
    v_permlane16_swap_b32 v56, v58
    s_nop 1
    v_max_f32 v56, v56, v58
    v_mov_b32 v58, v56
    s_nop 1
    v_permlane32_swap_b32 v56, v58
    s_nop 1
    v_max_f32 v56, v56, v58
    v_exp_f32 v57, -v56
    v_sub_f32 v44, v44, v56
    v_sub_f32 v45, v45, v56
    v_sub_f32 v46, v46, v56
    v_sub_f32 v47, v47, v56
    v_mul_f32 v23, v23, v57
    v_sub_f32 v156, v156, v56
    v_sub_f32 v157, v157, v56
    v_sub_f32 v158, v158, v56
    v_sub_f32 v159, v159, v56
    v_sub_f32 v188, v188, v56
    v_sub_f32 v189, v189, v56
    v_sub_f32 v190, v190, v56
    v_sub_f32 v191, v191, v56
    v_sub_f32 v92, v92, v56
    v_sub_f32 v93, v93, v56
    v_sub_f32 v94, v94, v56
    v_sub_f32 v95, v95, v56
    v_sub_f32 v124, v124, v56
    v_sub_f32 v125, v125, v56
    v_sub_f32 v126, v126, v56
    v_sub_f32 v127, v127, v56
    v_accvgpr_read_b32 v48, a12
    v_accvgpr_read_b32 v49, a13
    v_accvgpr_read_b32 v50, a14
    v_accvgpr_read_b32 v51, a15
    v_mul_f32 v48, v48, v57
    v_mul_f32 v49, v49, v57
    v_mul_f32 v50, v50, v57
    v_mul_f32 v51, v51, v57
    v_accvgpr_write_b32 a12, v48
    v_accvgpr_write_b32 a13, v49
    v_accvgpr_write_b32 a14, v50
    v_accvgpr_write_b32 a15, v51
    v_accvgpr_read_b32 v48, a28
    v_accvgpr_read_b32 v49, a29
    v_accvgpr_read_b32 v50, a30
    v_accvgpr_read_b32 v51, a31
    v_mul_f32 v48, v48, v57
    v_mul_f32 v49, v49, v57
    v_mul_f32 v50, v50, v57
    v_mul_f32 v51, v51, v57
    v_accvgpr_write_b32 a28, v48
    v_accvgpr_write_b32 a29, v49
    v_accvgpr_write_b32 a30, v50
    v_accvgpr_write_b32 a31, v51
    v_accvgpr_read_b32 v48, a44
    v_accvgpr_read_b32 v49, a45
    v_accvgpr_read_b32 v50, a46
    v_accvgpr_read_b32 v51, a47
    v_mul_f32 v48, v48, v57
    v_mul_f32 v49, v49, v57
    v_mul_f32 v50, v50, v57
    v_mul_f32 v51, v51, v57
    v_accvgpr_write_b32 a44, v48
    v_accvgpr_write_b32 a45, v49
    v_accvgpr_write_b32 a46, v50
    v_accvgpr_write_b32 a47, v51
    v_accvgpr_read_b32 v48, a60
    v_accvgpr_read_b32 v49, a61
    v_accvgpr_read_b32 v50, a62
    v_accvgpr_read_b32 v51, a63
    v_mul_f32 v48, v48, v57
    v_mul_f32 v49, v49, v57
    v_mul_f32 v50, v50, v57
    v_mul_f32 v51, v51, v57
    v_accvgpr_write_b32 a60, v48
    v_accvgpr_write_b32 a61, v49
    v_accvgpr_write_b32 a62, v50
    v_accvgpr_write_b32 a63, v51
    v_accvgpr_read_b32 v48, a76
    v_accvgpr_read_b32 v49, a77
    v_accvgpr_read_b32 v50, a78
    v_accvgpr_read_b32 v51, a79
    v_mul_f32 v48, v48, v57
    v_mul_f32 v49, v49, v57
    v_mul_f32 v50, v50, v57
    v_mul_f32 v51, v51, v57
    v_accvgpr_write_b32 a76, v48
    v_accvgpr_write_b32 a77, v49
    v_accvgpr_write_b32 a78, v50
    v_accvgpr_write_b32 a79, v51
    v_accvgpr_read_b32 v48, a92
    v_accvgpr_read_b32 v49, a93
    v_accvgpr_read_b32 v50, a94
    v_accvgpr_read_b32 v51, a95
    v_mul_f32 v48, v48, v57
    v_mul_f32 v49, v49, v57
    v_mul_f32 v50, v50, v57
    v_mul_f32 v51, v51, v57
    v_accvgpr_write_b32 a92, v48
    v_accvgpr_write_b32 a93, v49
    v_accvgpr_write_b32 a94, v50
    v_accvgpr_write_b32 a95, v51
    v_accvgpr_read_b32 v48, a108
    v_accvgpr_read_b32 v49, a109
    v_accvgpr_read_b32 v50, a110
    v_accvgpr_read_b32 v51, a111
    v_mul_f32 v48, v48, v57
    v_mul_f32 v49, v49, v57
    v_mul_f32 v50, v50, v57
    v_mul_f32 v51, v51, v57
    v_accvgpr_write_b32 a108, v48
    v_accvgpr_write_b32 a109, v49
    v_accvgpr_write_b32 a110, v50
    v_accvgpr_write_b32 a111, v51
    v_accvgpr_read_b32 v48, a124
    v_accvgpr_read_b32 v49, a125
    v_accvgpr_read_b32 v50, a126
    v_accvgpr_read_b32 v51, a127
    v_mul_f32 v48, v48, v57
    v_mul_f32 v49, v49, v57
    v_mul_f32 v50, v50, v57
    v_mul_f32 v51, v51, v57
    v_accvgpr_write_b32 a124, v48
    v_accvgpr_write_b32 a125, v49
    v_accvgpr_write_b32 a126, v50
    v_accvgpr_write_b32 a127, v51
    v_accvgpr_read_b32 v48, a140
    v_accvgpr_read_b32 v49, a141
    v_accvgpr_read_b32 v50, a142
    v_accvgpr_read_b32 v51, a143
    v_mul_f32 v48, v48, v57
    v_mul_f32 v49, v49, v57
    v_mul_f32 v50, v50, v57
    v_mul_f32 v51, v51, v57
    v_accvgpr_write_b32 a140, v48
    v_accvgpr_write_b32 a141, v49
    v_accvgpr_write_b32 a142, v50
    v_accvgpr_write_b32 a143, v51
    v_accvgpr_read_b32 v48, a156
    v_accvgpr_read_b32 v49, a157
    v_accvgpr_read_b32 v50, a158
    v_accvgpr_read_b32 v51, a159
    v_mul_f32 v48, v48, v57
    v_mul_f32 v49, v49, v57
    v_mul_f32 v50, v50, v57
    v_mul_f32 v51, v51, v57
    v_accvgpr_write_b32 a156, v48
    v_accvgpr_write_b32 a157, v49
    v_accvgpr_write_b32 a158, v50
    v_accvgpr_write_b32 a159, v51
    v_accvgpr_read_b32 v48, a172
    v_accvgpr_read_b32 v49, a173
    v_accvgpr_read_b32 v50, a174
    v_accvgpr_read_b32 v51, a175
    v_mul_f32 v48, v48, v57
    v_mul_f32 v49, v49, v57
    v_mul_f32 v50, v50, v57
    v_mul_f32 v51, v51, v57
    v_accvgpr_write_b32 a172, v48
    v_accvgpr_write_b32 a173, v49
    v_accvgpr_write_b32 a174, v50
    v_accvgpr_write_b32 a175, v51
    v_accvgpr_read_b32 v48, a188
    v_accvgpr_read_b32 v49, a189
    v_accvgpr_read_b32 v50, a190
    v_accvgpr_read_b32 v51, a191
    v_mul_f32 v48, v48, v57
    v_mul_f32 v49, v49, v57
    v_mul_f32 v50, v50, v57
    v_mul_f32 v51, v51, v57
    v_accvgpr_write_b32 a188, v48
    v_accvgpr_write_b32 a189, v49
    v_accvgpr_write_b32 a190, v50
    v_accvgpr_write_b32 a191, v51
    v_exp_f32 v48, v156
    v_exp_f32 v49, v157
    v_exp_f32 v50, v158
    v_exp_f32 v51, v159
    v_exp_f32 v52, v188
    v_exp_f32 v53, v189
    v_exp_f32 v54, v190
    v_exp_f32 v55, v191
    s_nop 0
    v_cvt_pk_bf16_f32 v252, v48, v49
    v_cvt_pk_bf16_f32 v253, v50, v51
    v_cvt_pk_bf16_f32 v254, v52, v53
    v_cvt_pk_bf16_f32 v255, v54, v55
    v_add_f32 v27, v48, v49
    v_add_f32 v27, v27, v50
    v_add_f32 v27, v27, v51
    v_add_f32 v27, v27, v52
    v_add_f32 v27, v27, v53
    v_add_f32 v27, v27, v54
    v_add_f32 v27, v27, v55
    s_nop 1
    s_branch rare_a_ret
rare_b:
    s_nop 7
    s_nop 7
    v_max3_f32 v56, v68, v69, v70
    v_max3_f32 v56, v56, v71, v100
    v_max3_f32 v56, v56, v101, v102
    v_max3_f32 v56, v56, v103, 0
    v_mov_b32 v58, v56
    s_nop 1
    v_permlane16_swap_b32 v56, v58
    s_nop 1
    v_max_f32 v56, v56, v58
    v_mov_b32 v58, v56
    s_nop 1
    v_permlane32_swap_b32 v56, v58
    s_nop 1
    v_max_f32 v56, v56, v58
    v_exp_f32 v57, -v56
    v_sub_f32 v32, v32, v56
    v_sub_f32 v33, v33, v56
    v_sub_f32 v34, v34, v56
    v_sub_f32 v35, v35, v56
    v_mul_f32 v20, v20, v57
    v_sub_f32 v68, v68, v56
    v_sub_f32 v69, v69, v56
    v_sub_f32 v70, v70, v56
    v_sub_f32 v71, v71, v56
    v_sub_f32 v100, v100, v56
    v_sub_f32 v101, v101, v56
    v_sub_f32 v102, v102, v56
    v_sub_f32 v103, v103, v56
    v_sub_f32 v132, v132, v56
    v_sub_f32 v133, v133, v56
    v_sub_f32 v134, v134, v56
    v_sub_f32 v135, v135, v56
    v_sub_f32 v164, v164, v56
    v_sub_f32 v165, v165, v56
    v_sub_f32 v166, v166, v56
    v_sub_f32 v167, v167, v56
    v_accvgpr_read_b32 v48, a0
    v_accvgpr_read_b32 v49, a1
    v_accvgpr_read_b32 v50, a2
    v_accvgpr_read_b32 v51, a3
    v_mul_f32 v48, v48, v57
    v_mul_f32 v49, v49, v57
    v_mul_f32 v50, v50, v57
    v_mul_f32 v51, v51, v57
    v_accvgpr_write_b32 a0, v48
    v_accvgpr_write_b32 a1, v49
    v_accvgpr_write_b32 a2, v50
    v_accvgpr_write_b32 a3, v51
    v_accvgpr_read_b32 v48, a16
    v_accvgpr_read_b32 v49, a17
    v_accvgpr_read_b32 v50, a18
    v_accvgpr_read_b32 v51, a19
    v_mul_f32 v48, v48, v57
    v_mul_f32 v49, v49, v57
    v_mul_f32 v50, v50, v57
    v_mul_f32 v51, v51, v57
    v_accvgpr_write_b32 a16, v48
    v_accvgpr_write_b32 a17, v49
    v_accvgpr_write_b32 a18, v50
    v_accvgpr_write_b32 a19, v51
    v_accvgpr_read_b32 v48, a32
    v_accvgpr_read_b32 v49, a33
    v_accvgpr_read_b32 v50, a34
    v_accvgpr_read_b32 v51, a35
    v_mul_f32 v48, v48, v57
    v_mul_f32 v49, v49, v57
    v_mul_f32 v50, v50, v57
    v_mul_f32 v51, v51, v57
    v_accvgpr_write_b32 a32, v48
    v_accvgpr_write_b32 a33, v49
    v_accvgpr_write_b32 a34, v50
    v_accvgpr_write_b32 a35, v51
    v_accvgpr_read_b32 v48, a48
    v_accvgpr_read_b32 v49, a49
    v_accvgpr_read_b32 v50, a50
    v_accvgpr_read_b32 v51, a51
    v_mul_f32 v48, v48, v57
    v_mul_f32 v49, v49, v57
    v_mul_f32 v50, v50, v57
    v_mul_f32 v51, v51, v57
    v_accvgpr_write_b32 a48, v48
    v_accvgpr_write_b32 a49, v49
    v_accvgpr_write_b32 a50, v50
    v_accvgpr_write_b32 a51, v51
    v_accvgpr_read_b32 v48, a64
    v_accvgpr_read_b32 v49, a65
    v_accvgpr_read_b32 v50, a66
    v_accvgpr_read_b32 v51, a67
    v_mul_f32 v48, v48, v57
    v_mul_f32 v49, v49, v57
    v_mul_f32 v50, v50, v57
    v_mul_f32 v51, v51, v57
    v_accvgpr_write_b32 a64, v48
    v_accvgpr_write_b32 a65, v49
    v_accvgpr_write_b32 a66, v50
    v_accvgpr_write_b32 a67, v51
    v_accvgpr_read_b32 v48, a80
    v_accvgpr_read_b32 v49, a81
    v_accvgpr_read_b32 v50, a82
    v_accvgpr_read_b32 v51, a83
    v_mul_f32 v48, v48, v57
    v_mul_f32 v49, v49, v57
    v_mul_f32 v50, v50, v57
    v_mul_f32 v51, v51, v57
    v_accvgpr_write_b32 a80, v48
    v_accvgpr_write_b32 a81, v49
    v_accvgpr_write_b32 a82, v50
    v_accvgpr_write_b32 a83, v51
    v_accvgpr_read_b32 v48, a96
    v_accvgpr_read_b32 v49, a97
    v_accvgpr_read_b32 v50, a98
    v_accvgpr_read_b32 v51, a99
    v_mul_f32 v48, v48, v57
    v_mul_f32 v49, v49, v57
    v_mul_f32 v50, v50, v57
    v_mul_f32 v51, v51, v57
    v_accvgpr_write_b32 a96, v48
    v_accvgpr_write_b32 a97, v49
    v_accvgpr_write_b32 a98, v50
    v_accvgpr_write_b32 a99, v51
    v_accvgpr_read_b32 v48, a112
    v_accvgpr_read_b32 v49, a113
    v_accvgpr_read_b32 v50, a114
    v_accvgpr_read_b32 v51, a115
    v_mul_f32 v48, v48, v57
    v_mul_f32 v49, v49, v57
    v_mul_f32 v50, v50, v57
    v_mul_f32 v51, v51, v57
    v_accvgpr_write_b32 a112, v48
    v_accvgpr_write_b32 a113, v49
    v_accvgpr_write_b32 a114, v50
    v_accvgpr_write_b32 a115, v51
    v_accvgpr_read_b32 v48, a128
    v_accvgpr_read_b32 v49, a129
    v_accvgpr_read_b32 v50, a130
    v_accvgpr_read_b32 v51, a131
    v_mul_f32 v48, v48, v57
    v_mul_f32 v49, v49, v57
    v_mul_f32 v50, v50, v57
    v_mul_f32 v51, v51, v57
    v_accvgpr_write_b32 a128, v48
    v_accvgpr_write_b32 a129, v49
    v_accvgpr_write_b32 a130, v50
    v_accvgpr_write_b32 a131, v51
    v_accvgpr_read_b32 v48, a144
    v_accvgpr_read_b32 v49, a145
    v_accvgpr_read_b32 v50, a146
    v_accvgpr_read_b32 v51, a147
    v_mul_f32 v48, v48, v57
    v_mul_f32 v49, v49, v57
    v_mul_f32 v50, v50, v57
    v_mul_f32 v51, v51, v57
    v_accvgpr_write_b32 a144, v48
    v_accvgpr_write_b32 a145, v49
    v_accvgpr_write_b32 a146, v50
    v_accvgpr_write_b32 a147, v51
    v_accvgpr_read_b32 v48, a160
    v_accvgpr_read_b32 v49, a161
    v_accvgpr_read_b32 v50, a162
    v_accvgpr_read_b32 v51, a163
    v_mul_f32 v48, v48, v57
    v_mul_f32 v49, v49, v57
    v_mul_f32 v50, v50, v57
    v_mul_f32 v51, v51, v57
    v_accvgpr_write_b32 a160, v48
    v_accvgpr_write_b32 a161, v49
    v_accvgpr_write_b32 a162, v50
    v_accvgpr_write_b32 a163, v51
    v_accvgpr_read_b32 v48, a176
    v_accvgpr_read_b32 v49, a177
    v_accvgpr_read_b32 v50, a178
    v_accvgpr_read_b32 v51, a179
    v_mul_f32 v48, v48, v57
    v_mul_f32 v49, v49, v57
    v_mul_f32 v50, v50, v57
    v_mul_f32 v51, v51, v57
    v_accvgpr_write_b32 a176, v48
    v_accvgpr_write_b32 a177, v49
    v_accvgpr_write_b32 a178, v50
    v_accvgpr_write_b32 a179, v51
    v_exp_f32 v48, v68
    v_exp_f32 v49, v69
    v_exp_f32 v50, v70
    v_exp_f32 v51, v71
    v_exp_f32 v52, v100
    v_exp_f32 v53, v101
    v_exp_f32 v54, v102
    v_exp_f32 v55, v103
    s_nop 0
    v_cvt_pk_bf16_f32 v196, v48, v49
    v_cvt_pk_bf16_f32 v197, v50, v51
    v_cvt_pk_bf16_f32 v198, v52, v53
    v_cvt_pk_bf16_f32 v199, v54, v55
    v_add_f32 v24, v48, v49
    v_add_f32 v24, v24, v50
    v_add_f32 v24, v24, v51
    v_add_f32 v24, v24, v52
    v_add_f32 v24, v24, v53
    v_add_f32 v24, v24, v54
    v_add_f32 v24, v24, v55
    v_max3_f32 v56, v76, v77, v78
    v_max3_f32 v56, v56, v79, v108
    v_max3_f32 v56, v56, v109, v110
    v_max3_f32 v56, v56, v111, 0
    v_mov_b32 v58, v56
    s_nop 1
    v_permlane16_swap_b32 v56, v58
    s_nop 1
    v_max_f32 v56, v56, v58
    v_mov_b32 v58, v56
    s_nop 1
    v_permlane32_swap_b32 v56, v58
    s_nop 1
    v_max_f32 v56, v56, v58
    v_exp_f32 v57, -v56
    v_sub_f32 v36, v36, v56
    v_sub_f32 v37, v37, v56
    v_sub_f32 v38, v38, v56
    v_sub_f32 v39, v39, v56
    v_mul_f32 v21, v21, v57
    v_sub_f32 v76, v76, v56
    v_sub_f32 v77, v77, v56
    v_sub_f32 v78, v78, v56
    v_sub_f32 v79, v79, v56
    v_sub_f32 v108, v108, v56
    v_sub_f32 v109, v109, v56
    v_sub_f32 v110, v110, v56
    v_sub_f32 v111, v111, v56
    v_sub_f32 v140, v140, v56
    v_sub_f32 v141, v141, v56
    v_sub_f32 v142, v142, v56
    v_sub_f32 v143, v143, v56
    v_sub_f32 v172, v172, v56
    v_sub_f32 v173, v173, v56
    v_sub_f32 v174, v174, v56
    v_sub_f32 v175, v175, v56
    v_accvgpr_read_b32 v48, a4
    v_accvgpr_read_b32 v49, a5
    v_accvgpr_read_b32 v50, a6
    v_accvgpr_read_b32 v51, a7
    v_mul_f32 v48, v48, v57
    v_mul_f32 v49, v49, v57
    v_mul_f32 v50, v50, v57
    v_mul_f32 v51, v51, v57
    v_accvgpr_write_b32 a4, v48
    v_accvgpr_write_b32 a5, v49
    v_accvgpr_write_b32 a6, v50
    v_accvgpr_write_b32 a7, v51
    v_accvgpr_read_b32 v48, a20
    v_accvgpr_read_b32 v49, a21
    v_accvgpr_read_b32 v50, a22
    v_accvgpr_read_b32 v51, a23
    v_mul_f32 v48, v48, v57
    v_mul_f32 v49, v49, v57
    v_mul_f32 v50, v50, v57
    v_mul_f32 v51, v51, v57
    v_accvgpr_write_b32 a20, v48
    v_accvgpr_write_b32 a21, v49
    v_accvgpr_write_b32 a22, v50
    v_accvgpr_write_b32 a23, v51
    v_accvgpr_read_b32 v48, a36
    v_accvgpr_read_b32 v49, a37
    v_accvgpr_read_b32 v50, a38
    v_accvgpr_read_b32 v51, a39
    v_mul_f32 v48, v48, v57
    v_mul_f32 v49, v49, v57
    v_mul_f32 v50, v50, v57
    v_mul_f32 v51, v51, v57
    v_accvgpr_write_b32 a36, v48
    v_accvgpr_write_b32 a37, v49
    v_accvgpr_write_b32 a38, v50
    v_accvgpr_write_b32 a39, v51
    v_accvgpr_read_b32 v48, a52
    v_accvgpr_read_b32 v49, a53
    v_accvgpr_read_b32 v50, a54
    v_accvgpr_read_b32 v51, a55
    v_mul_f32 v48, v48, v57
    v_mul_f32 v49, v49, v57
    v_mul_f32 v50, v50, v57
    v_mul_f32 v51, v51, v57
    v_accvgpr_write_b32 a52, v48
    v_accvgpr_write_b32 a53, v49
    v_accvgpr_write_b32 a54, v50
    v_accvgpr_write_b32 a55, v51
    v_accvgpr_read_b32 v48, a68
    v_accvgpr_read_b32 v49, a69
    v_accvgpr_read_b32 v50, a70
    v_accvgpr_read_b32 v51, a71
    v_mul_f32 v48, v48, v57
    v_mul_f32 v49, v49, v57
    v_mul_f32 v50, v50, v57
    v_mul_f32 v51, v51, v57
    v_accvgpr_write_b32 a68, v48
    v_accvgpr_write_b32 a69, v49
    v_accvgpr_write_b32 a70, v50
    v_accvgpr_write_b32 a71, v51
    v_accvgpr_read_b32 v48, a84
    v_accvgpr_read_b32 v49, a85
    v_accvgpr_read_b32 v50, a86
    v_accvgpr_read_b32 v51, a87
    v_mul_f32 v48, v48, v57
    v_mul_f32 v49, v49, v57
    v_mul_f32 v50, v50, v57
    v_mul_f32 v51, v51, v57
    v_accvgpr_write_b32 a84, v48
    v_accvgpr_write_b32 a85, v49
    v_accvgpr_write_b32 a86, v50
    v_accvgpr_write_b32 a87, v51
    v_accvgpr_read_b32 v48, a100
    v_accvgpr_read_b32 v49, a101
    v_accvgpr_read_b32 v50, a102
    v_accvgpr_read_b32 v51, a103
    v_mul_f32 v48, v48, v57
    v_mul_f32 v49, v49, v57
    v_mul_f32 v50, v50, v57
    v_mul_f32 v51, v51, v57
    v_accvgpr_write_b32 a100, v48
    v_accvgpr_write_b32 a101, v49
    v_accvgpr_write_b32 a102, v50
    v_accvgpr_write_b32 a103, v51
    v_accvgpr_read_b32 v48, a116
    v_accvgpr_read_b32 v49, a117
    v_accvgpr_read_b32 v50, a118
    v_accvgpr_read_b32 v51, a119
    v_mul_f32 v48, v48, v57
    v_mul_f32 v49, v49, v57
    v_mul_f32 v50, v50, v57
    v_mul_f32 v51, v51, v57
    v_accvgpr_write_b32 a116, v48
    v_accvgpr_write_b32 a117, v49
    v_accvgpr_write_b32 a118, v50
    v_accvgpr_write_b32 a119, v51
    v_accvgpr_read_b32 v48, a132
    v_accvgpr_read_b32 v49, a133
    v_accvgpr_read_b32 v50, a134
    v_accvgpr_read_b32 v51, a135
    v_mul_f32 v48, v48, v57
    v_mul_f32 v49, v49, v57
    v_mul_f32 v50, v50, v57
    v_mul_f32 v51, v51, v57
    v_accvgpr_write_b32 a132, v48
    v_accvgpr_write_b32 a133, v49
    v_accvgpr_write_b32 a134, v50
    v_accvgpr_write_b32 a135, v51
    v_accvgpr_read_b32 v48, a148
    v_accvgpr_read_b32 v49, a149
    v_accvgpr_read_b32 v50, a150
    v_accvgpr_read_b32 v51, a151
    v_mul_f32 v48, v48, v57
    v_mul_f32 v49, v49, v57
    v_mul_f32 v50, v50, v57
    v_mul_f32 v51, v51, v57
    v_accvgpr_write_b32 a148, v48
    v_accvgpr_write_b32 a149, v49
    v_accvgpr_write_b32 a150, v50
    v_accvgpr_write_b32 a151, v51
    v_accvgpr_read_b32 v48, a164
    v_accvgpr_read_b32 v49, a165
    v_accvgpr_read_b32 v50, a166
    v_accvgpr_read_b32 v51, a167
    v_mul_f32 v48, v48, v57
    v_mul_f32 v49, v49, v57
    v_mul_f32 v50, v50, v57
    v_mul_f32 v51, v51, v57
    v_accvgpr_write_b32 a164, v48
    v_accvgpr_write_b32 a165, v49
    v_accvgpr_write_b32 a166, v50
    v_accvgpr_write_b32 a167, v51
    v_accvgpr_read_b32 v48, a180
    v_accvgpr_read_b32 v49, a181
    v_accvgpr_read_b32 v50, a182
    v_accvgpr_read_b32 v51, a183
    v_mul_f32 v48, v48, v57
    v_mul_f32 v49, v49, v57
    v_mul_f32 v50, v50, v57
    v_mul_f32 v51, v51, v57
    v_accvgpr_write_b32 a180, v48
    v_accvgpr_write_b32 a181, v49
    v_accvgpr_write_b32 a182, v50
    v_accvgpr_write_b32 a183, v51
    v_exp_f32 v48, v76
    v_exp_f32 v49, v77
    v_exp_f32 v50, v78
    v_exp_f32 v51, v79
    v_exp_f32 v52, v108
    v_exp_f32 v53, v109
    v_exp_f32 v54, v110
    v_exp_f32 v55, v111
    s_nop 0
    v_cvt_pk_bf16_f32 v204, v48, v49
    v_cvt_pk_bf16_f32 v205, v50, v51
    v_cvt_pk_bf16_f32 v206, v52, v53
    v_cvt_pk_bf16_f32 v207, v54, v55
    v_add_f32 v25, v48, v49
    v_add_f32 v25, v25, v50
    v_add_f32 v25, v25, v51
    v_add_f32 v25, v25, v52
    v_add_f32 v25, v25, v53
    v_add_f32 v25, v25, v54
    v_add_f32 v25, v25, v55
    v_max3_f32 v56, v84, v85, v86
    v_max3_f32 v56, v56, v87, v116
    v_max3_f32 v56, v56, v117, v118
    v_max3_f32 v56, v56, v119, 0
    v_mov_b32 v58, v56
    s_nop 1
    v_permlane16_swap_b32 v56, v58
    s_nop 1
    v_max_f32 v56, v56, v58
    v_mov_b32 v58, v56
    s_nop 1
    v_permlane32_swap_b32 v56, v58
    s_nop 1
    v_max_f32 v56, v56, v58
    v_exp_f32 v57, -v56
    v_sub_f32 v40, v40, v56
    v_sub_f32 v41, v41, v56
    v_sub_f32 v42, v42, v56
    v_sub_f32 v43, v43, v56
    v_mul_f32 v22, v22, v57
    v_sub_f32 v84, v84, v56
    v_sub_f32 v85, v85, v56
    v_sub_f32 v86, v86, v56
    v_sub_f32 v87, v87, v56
    v_sub_f32 v116, v116, v56
    v_sub_f32 v117, v117, v56
    v_sub_f32 v118, v118, v56
    v_sub_f32 v119, v119, v56
    v_sub_f32 v148, v148, v56
    v_sub_f32 v149, v149, v56
    v_sub_f32 v150, v150, v56
    v_sub_f32 v151, v151, v56
    v_sub_f32 v180, v180, v56
    v_sub_f32 v181, v181, v56
    v_sub_f32 v182, v182, v56
    v_sub_f32 v183, v183, v56
    v_accvgpr_read_b32 v48, a8
    v_accvgpr_read_b32 v49, a9
    v_accvgpr_read_b32 v50, a10
    v_accvgpr_read_b32 v51, a11
    v_mul_f32 v48, v48, v57
    v_mul_f32 v49, v49, v57
    v_mul_f32 v50, v50, v57
    v_mul_f32 v51, v51, v57
    v_accvgpr_write_b32 a8, v48
    v_accvgpr_write_b32 a9, v49
    v_accvgpr_write_b32 a10, v50
    v_accvgpr_write_b32 a11, v51
    v_accvgpr_read_b32 v48, a24
    v_accvgpr_read_b32 v49, a25
    v_accvgpr_read_b32 v50, a26
    v_accvgpr_read_b32 v51, a27
    v_mul_f32 v48, v48, v57
    v_mul_f32 v49, v49, v57
    v_mul_f32 v50, v50, v57
    v_mul_f32 v51, v51, v57
    v_accvgpr_write_b32 a24, v48
    v_accvgpr_write_b32 a25, v49
    v_accvgpr_write_b32 a26, v50
    v_accvgpr_write_b32 a27, v51
    v_accvgpr_read_b32 v48, a40
    v_accvgpr_read_b32 v49, a41
    v_accvgpr_read_b32 v50, a42
    v_accvgpr_read_b32 v51, a43
    v_mul_f32 v48, v48, v57
    v_mul_f32 v49, v49, v57
    v_mul_f32 v50, v50, v57
    v_mul_f32 v51, v51, v57
    v_accvgpr_write_b32 a40, v48
    v_accvgpr_write_b32 a41, v49
    v_accvgpr_write_b32 a42, v50
    v_accvgpr_write_b32 a43, v51
    v_accvgpr_read_b32 v48, a56
    v_accvgpr_read_b32 v49, a57
    v_accvgpr_read_b32 v50, a58
    v_accvgpr_read_b32 v51, a59
    v_mul_f32 v48, v48, v57
    v_mul_f32 v49, v49, v57
    v_mul_f32 v50, v50, v57
    v_mul_f32 v51, v51, v57
    v_accvgpr_write_b32 a56, v48
    v_accvgpr_write_b32 a57, v49
    v_accvgpr_write_b32 a58, v50
    v_accvgpr_write_b32 a59, v51
    v_accvgpr_read_b32 v48, a72
    v_accvgpr_read_b32 v49, a73
    v_accvgpr_read_b32 v50, a74
    v_accvgpr_read_b32 v51, a75
    v_mul_f32 v48, v48, v57
    v_mul_f32 v49, v49, v57
    v_mul_f32 v50, v50, v57
    v_mul_f32 v51, v51, v57
    v_accvgpr_write_b32 a72, v48
    v_accvgpr_write_b32 a73, v49
    v_accvgpr_write_b32 a74, v50
    v_accvgpr_write_b32 a75, v51
    v_accvgpr_read_b32 v48, a88
    v_accvgpr_read_b32 v49, a89
    v_accvgpr_read_b32 v50, a90
    v_accvgpr_read_b32 v51, a91
    v_mul_f32 v48, v48, v57
    v_mul_f32 v49, v49, v57
    v_mul_f32 v50, v50, v57
    v_mul_f32 v51, v51, v57
    v_accvgpr_write_b32 a88, v48
    v_accvgpr_write_b32 a89, v49
    v_accvgpr_write_b32 a90, v50
    v_accvgpr_write_b32 a91, v51
    v_accvgpr_read_b32 v48, a104
    v_accvgpr_read_b32 v49, a105
    v_accvgpr_read_b32 v50, a106
    v_accvgpr_read_b32 v51, a107
    v_mul_f32 v48, v48, v57
    v_mul_f32 v49, v49, v57
    v_mul_f32 v50, v50, v57
    v_mul_f32 v51, v51, v57
    v_accvgpr_write_b32 a104, v48
    v_accvgpr_write_b32 a105, v49
    v_accvgpr_write_b32 a106, v50
    v_accvgpr_write_b32 a107, v51
    v_accvgpr_read_b32 v48, a120
    v_accvgpr_read_b32 v49, a121
    v_accvgpr_read_b32 v50, a122
    v_accvgpr_read_b32 v51, a123
    v_mul_f32 v48, v48, v57
    v_mul_f32 v49, v49, v57
    v_mul_f32 v50, v50, v57
    v_mul_f32 v51, v51, v57
    v_accvgpr_write_b32 a120, v48
    v_accvgpr_write_b32 a121, v49
    v_accvgpr_write_b32 a122, v50
    v_accvgpr_write_b32 a123, v51
    v_accvgpr_read_b32 v48, a136
    v_accvgpr_read_b32 v49, a137
    v_accvgpr_read_b32 v50, a138
    v_accvgpr_read_b32 v51, a139
    v_mul_f32 v48, v48, v57
    v_mul_f32 v49, v49, v57
    v_mul_f32 v50, v50, v57
    v_mul_f32 v51, v51, v57
    v_accvgpr_write_b32 a136, v48
    v_accvgpr_write_b32 a137, v49
    v_accvgpr_write_b32 a138, v50
    v_accvgpr_write_b32 a139, v51
    v_accvgpr_read_b32 v48, a152
    v_accvgpr_read_b32 v49, a153
    v_accvgpr_read_b32 v50, a154
    v_accvgpr_read_b32 v51, a155
    v_mul_f32 v48, v48, v57
    v_mul_f32 v49, v49, v57
    v_mul_f32 v50, v50, v57
    v_mul_f32 v51, v51, v57
    v_accvgpr_write_b32 a152, v48
    v_accvgpr_write_b32 a153, v49
    v_accvgpr_write_b32 a154, v50
    v_accvgpr_write_b32 a155, v51
    v_accvgpr_read_b32 v48, a168
    v_accvgpr_read_b32 v49, a169
    v_accvgpr_read_b32 v50, a170
    v_accvgpr_read_b32 v51, a171
    v_mul_f32 v48, v48, v57
    v_mul_f32 v49, v49, v57
    v_mul_f32 v50, v50, v57
    v_mul_f32 v51, v51, v57
    v_accvgpr_write_b32 a168, v48
    v_accvgpr_write_b32 a169, v49
    v_accvgpr_write_b32 a170, v50
    v_accvgpr_write_b32 a171, v51
    v_accvgpr_read_b32 v48, a184
    v_accvgpr_read_b32 v49, a185
    v_accvgpr_read_b32 v50, a186
    v_accvgpr_read_b32 v51, a187
    v_mul_f32 v48, v48, v57
    v_mul_f32 v49, v49, v57
    v_mul_f32 v50, v50, v57
    v_mul_f32 v51, v51, v57
    v_accvgpr_write_b32 a184, v48
    v_accvgpr_write_b32 a185, v49
    v_accvgpr_write_b32 a186, v50
    v_accvgpr_write_b32 a187, v51
    v_exp_f32 v48, v84
    v_exp_f32 v49, v85
    v_exp_f32 v50, v86
    v_exp_f32 v51, v87
    v_exp_f32 v52, v116
    v_exp_f32 v53, v117
    v_exp_f32 v54, v118
    v_exp_f32 v55, v119
    s_nop 0
    v_cvt_pk_bf16_f32 v212, v48, v49
    v_cvt_pk_bf16_f32 v213, v50, v51
    v_cvt_pk_bf16_f32 v214, v52, v53
    v_cvt_pk_bf16_f32 v215, v54, v55
    v_add_f32 v26, v48, v49
    v_add_f32 v26, v26, v50
    v_add_f32 v26, v26, v51
    v_add_f32 v26, v26, v52
    v_add_f32 v26, v26, v53
    v_add_f32 v26, v26, v54
    v_add_f32 v26, v26, v55
    v_max3_f32 v56, v92, v93, v94
    v_max3_f32 v56, v56, v95, v124
    v_max3_f32 v56, v56, v125, v126
    v_max3_f32 v56, v56, v127, 0
    v_mov_b32 v58, v56
    s_nop 1
    v_permlane16_swap_b32 v56, v58
    s_nop 1
    v_max_f32 v56, v56, v58
    v_mov_b32 v58, v56
    s_nop 1
    v_permlane32_swap_b32 v56, v58
    s_nop 1
    v_max_f32 v56, v56, v58
    v_exp_f32 v57, -v56
    v_sub_f32 v44, v44, v56
    v_sub_f32 v45, v45, v56
    v_sub_f32 v46, v46, v56
    v_sub_f32 v47, v47, v56
    v_mul_f32 v23, v23, v57
    v_sub_f32 v92, v92, v56
    v_sub_f32 v93, v93, v56
    v_sub_f32 v94, v94, v56
    v_sub_f32 v95, v95, v56
    v_sub_f32 v124, v124, v56
    v_sub_f32 v125, v125, v56
    v_sub_f32 v126, v126, v56
    v_sub_f32 v127, v127, v56
    v_sub_f32 v156, v156, v56
    v_sub_f32 v157, v157, v56
    v_sub_f32 v158, v158, v56
    v_sub_f32 v159, v159, v56
    v_sub_f32 v188, v188, v56
    v_sub_f32 v189, v189, v56
    v_sub_f32 v190, v190, v56
    v_sub_f32 v191, v191, v56
    v_accvgpr_read_b32 v48, a12
    v_accvgpr_read_b32 v49, a13
    v_accvgpr_read_b32 v50, a14
    v_accvgpr_read_b32 v51, a15
    v_mul_f32 v48, v48, v57
    v_mul_f32 v49, v49, v57
    v_mul_f32 v50, v50, v57
    v_mul_f32 v51, v51, v57
    v_accvgpr_write_b32 a12, v48
    v_accvgpr_write_b32 a13, v49
    v_accvgpr_write_b32 a14, v50
    v_accvgpr_write_b32 a15, v51
    v_accvgpr_read_b32 v48, a28
    v_accvgpr_read_b32 v49, a29
    v_accvgpr_read_b32 v50, a30
    v_accvgpr_read_b32 v51, a31
    v_mul_f32 v48, v48, v57
    v_mul_f32 v49, v49, v57
    v_mul_f32 v50, v50, v57
    v_mul_f32 v51, v51, v57
    v_accvgpr_write_b32 a28, v48
    v_accvgpr_write_b32 a29, v49
    v_accvgpr_write_b32 a30, v50
    v_accvgpr_write_b32 a31, v51
    v_accvgpr_read_b32 v48, a44
    v_accvgpr_read_b32 v49, a45
    v_accvgpr_read_b32 v50, a46
    v_accvgpr_read_b32 v51, a47
    v_mul_f32 v48, v48, v57
    v_mul_f32 v49, v49, v57
    v_mul_f32 v50, v50, v57
    v_mul_f32 v51, v51, v57
    v_accvgpr_write_b32 a44, v48
    v_accvgpr_write_b32 a45, v49
    v_accvgpr_write_b32 a46, v50
    v_accvgpr_write_b32 a47, v51
    v_accvgpr_read_b32 v48, a60
    v_accvgpr_read_b32 v49, a61
    v_accvgpr_read_b32 v50, a62
    v_accvgpr_read_b32 v51, a63
    v_mul_f32 v48, v48, v57
    v_mul_f32 v49, v49, v57
    v_mul_f32 v50, v50, v57
    v_mul_f32 v51, v51, v57
    v_accvgpr_write_b32 a60, v48
    v_accvgpr_write_b32 a61, v49
    v_accvgpr_write_b32 a62, v50
    v_accvgpr_write_b32 a63, v51
    v_accvgpr_read_b32 v48, a76
    v_accvgpr_read_b32 v49, a77
    v_accvgpr_read_b32 v50, a78
    v_accvgpr_read_b32 v51, a79
    v_mul_f32 v48, v48, v57
    v_mul_f32 v49, v49, v57
    v_mul_f32 v50, v50, v57
    v_mul_f32 v51, v51, v57
    v_accvgpr_write_b32 a76, v48
    v_accvgpr_write_b32 a77, v49
    v_accvgpr_write_b32 a78, v50
    v_accvgpr_write_b32 a79, v51
    v_accvgpr_read_b32 v48, a92
    v_accvgpr_read_b32 v49, a93
    v_accvgpr_read_b32 v50, a94
    v_accvgpr_read_b32 v51, a95
    v_mul_f32 v48, v48, v57
    v_mul_f32 v49, v49, v57
    v_mul_f32 v50, v50, v57
    v_mul_f32 v51, v51, v57
    v_accvgpr_write_b32 a92, v48
    v_accvgpr_write_b32 a93, v49
    v_accvgpr_write_b32 a94, v50
    v_accvgpr_write_b32 a95, v51
    v_accvgpr_read_b32 v48, a108
    v_accvgpr_read_b32 v49, a109
    v_accvgpr_read_b32 v50, a110
    v_accvgpr_read_b32 v51, a111
    v_mul_f32 v48, v48, v57
    v_mul_f32 v49, v49, v57
    v_mul_f32 v50, v50, v57
    v_mul_f32 v51, v51, v57
    v_accvgpr_write_b32 a108, v48
    v_accvgpr_write_b32 a109, v49
    v_accvgpr_write_b32 a110, v50
    v_accvgpr_write_b32 a111, v51
    v_accvgpr_read_b32 v48, a124
    v_accvgpr_read_b32 v49, a125
    v_accvgpr_read_b32 v50, a126
    v_accvgpr_read_b32 v51, a127
    v_mul_f32 v48, v48, v57
    v_mul_f32 v49, v49, v57
    v_mul_f32 v50, v50, v57
    v_mul_f32 v51, v51, v57
    v_accvgpr_write_b32 a124, v48
    v_accvgpr_write_b32 a125, v49
    v_accvgpr_write_b32 a126, v50
    v_accvgpr_write_b32 a127, v51
    v_accvgpr_read_b32 v48, a140
    v_accvgpr_read_b32 v49, a141
    v_accvgpr_read_b32 v50, a142
    v_accvgpr_read_b32 v51, a143
    v_mul_f32 v48, v48, v57
    v_mul_f32 v49, v49, v57
    v_mul_f32 v50, v50, v57
    v_mul_f32 v51, v51, v57
    v_accvgpr_write_b32 a140, v48
    v_accvgpr_write_b32 a141, v49
    v_accvgpr_write_b32 a142, v50
    v_accvgpr_write_b32 a143, v51
    v_accvgpr_read_b32 v48, a156
    v_accvgpr_read_b32 v49, a157
    v_accvgpr_read_b32 v50, a158
    v_accvgpr_read_b32 v51, a159
    v_mul_f32 v48, v48, v57
    v_mul_f32 v49, v49, v57
    v_mul_f32 v50, v50, v57
    v_mul_f32 v51, v51, v57
    v_accvgpr_write_b32 a156, v48
    v_accvgpr_write_b32 a157, v49
    v_accvgpr_write_b32 a158, v50
    v_accvgpr_write_b32 a159, v51
    v_accvgpr_read_b32 v48, a172
    v_accvgpr_read_b32 v49, a173
    v_accvgpr_read_b32 v50, a174
    v_accvgpr_read_b32 v51, a175
    v_mul_f32 v48, v48, v57
    v_mul_f32 v49, v49, v57
    v_mul_f32 v50, v50, v57
    v_mul_f32 v51, v51, v57
    v_accvgpr_write_b32 a172, v48
    v_accvgpr_write_b32 a173, v49
    v_accvgpr_write_b32 a174, v50
    v_accvgpr_write_b32 a175, v51
    v_accvgpr_read_b32 v48, a188
    v_accvgpr_read_b32 v49, a189
    v_accvgpr_read_b32 v50, a190
    v_accvgpr_read_b32 v51, a191
    v_mul_f32 v48, v48, v57
    v_mul_f32 v49, v49, v57
    v_mul_f32 v50, v50, v57
    v_mul_f32 v51, v51, v57
    v_accvgpr_write_b32 a188, v48
    v_accvgpr_write_b32 a189, v49
    v_accvgpr_write_b32 a190, v50
    v_accvgpr_write_b32 a191, v51
    v_exp_f32 v48, v92
    v_exp_f32 v49, v93
    v_exp_f32 v50, v94
    v_exp_f32 v51, v95
    v_exp_f32 v52, v124
    v_exp_f32 v53, v125
    v_exp_f32 v54, v126
    v_exp_f32 v55, v127
    s_nop 0
    v_cvt_pk_bf16_f32 v220, v48, v49
    v_cvt_pk_bf16_f32 v221, v50, v51
    v_cvt_pk_bf16_f32 v222, v52, v53
    v_cvt_pk_bf16_f32 v223, v54, v55
    v_add_f32 v27, v48, v49
    v_add_f32 v27, v27, v50
    v_add_f32 v27, v27, v51
    v_add_f32 v27, v27, v52
    v_add_f32 v27, v27, v53
    v_add_f32 v27, v27, v54
    v_add_f32 v27, v27, v55
    s_nop 1
    s_branch rare_b_ret
rare_e:
    s_nop 7
    s_nop 7
    v_max3_f32 v56, v132, v133, v134
    v_max3_f32 v56, v56, v135, v164
    v_max3_f32 v56, v56, v165, v166
    v_max3_f32 v56, v56, v167, 0
    v_mov_b32 v58, v56
    s_nop 1
    v_permlane16_swap_b32 v56, v58
    s_nop 1
    v_max_f32 v56, v56, v58
    v_mov_b32 v58, v56
    s_nop 1
    v_permlane32_swap_b32 v56, v58
    s_nop 1
    v_max_f32 v56, v56, v58
    v_exp_f32 v57, -v56
    v_sub_f32 v32, v32, v56
    v_sub_f32 v33, v33, v56
    v_sub_f32 v34, v34, v56
    v_sub_f32 v35, v35, v56
    v_mul_f32 v20, v20, v57
    v_sub_f32 v132, v132, v56
    v_sub_f32 v133, v133, v56
    v_sub_f32 v134, v134, v56
    v_sub_f32 v135, v135, v56
    v_sub_f32 v164, v164, v56
    v_sub_f32 v165, v165, v56
    v_sub_f32 v166, v166, v56
    v_sub_f32 v167, v167, v56
    v_accvgpr_read_b32 v48, a0
    v_accvgpr_read_b32 v49, a1
    v_accvgpr_read_b32 v50, a2
    v_accvgpr_read_b32 v51, a3
    v_mul_f32 v48, v48, v57
    v_mul_f32 v49, v49, v57
    v_mul_f32 v50, v50, v57
    v_mul_f32 v51, v51, v57
    v_accvgpr_write_b32 a0, v48
    v_accvgpr_write_b32 a1, v49
    v_accvgpr_write_b32 a2, v50
    v_accvgpr_write_b32 a3, v51
    v_accvgpr_read_b32 v48, a16
    v_accvgpr_read_b32 v49, a17
    v_accvgpr_read_b32 v50, a18
    v_accvgpr_read_b32 v51, a19
    v_mul_f32 v48, v48, v57
    v_mul_f32 v49, v49, v57
    v_mul_f32 v50, v50, v57
    v_mul_f32 v51, v51, v57
    v_accvgpr_write_b32 a16, v48
    v_accvgpr_write_b32 a17, v49
    v_accvgpr_write_b32 a18, v50
    v_accvgpr_write_b32 a19, v51
    v_accvgpr_read_b32 v48, a32
    v_accvgpr_read_b32 v49, a33
    v_accvgpr_read_b32 v50, a34
    v_accvgpr_read_b32 v51, a35
    v_mul_f32 v48, v48, v57
    v_mul_f32 v49, v49, v57
    v_mul_f32 v50, v50, v57
    v_mul_f32 v51, v51, v57
    v_accvgpr_write_b32 a32, v48
    v_accvgpr_write_b32 a33, v49
    v_accvgpr_write_b32 a34, v50
    v_accvgpr_write_b32 a35, v51
    v_accvgpr_read_b32 v48, a48
    v_accvgpr_read_b32 v49, a49
    v_accvgpr_read_b32 v50, a50
    v_accvgpr_read_b32 v51, a51
    v_mul_f32 v48, v48, v57
    v_mul_f32 v49, v49, v57
    v_mul_f32 v50, v50, v57
    v_mul_f32 v51, v51, v57
    v_accvgpr_write_b32 a48, v48
    v_accvgpr_write_b32 a49, v49
    v_accvgpr_write_b32 a50, v50
    v_accvgpr_write_b32 a51, v51
    v_accvgpr_read_b32 v48, a64
    v_accvgpr_read_b32 v49, a65
    v_accvgpr_read_b32 v50, a66
    v_accvgpr_read_b32 v51, a67
    v_mul_f32 v48, v48, v57
    v_mul_f32 v49, v49, v57
    v_mul_f32 v50, v50, v57
    v_mul_f32 v51, v51, v57
    v_accvgpr_write_b32 a64, v48
    v_accvgpr_write_b32 a65, v49
    v_accvgpr_write_b32 a66, v50
    v_accvgpr_write_b32 a67, v51
    v_accvgpr_read_b32 v48, a80
    v_accvgpr_read_b32 v49, a81
    v_accvgpr_read_b32 v50, a82
    v_accvgpr_read_b32 v51, a83
    v_mul_f32 v48, v48, v57
    v_mul_f32 v49, v49, v57
    v_mul_f32 v50, v50, v57
    v_mul_f32 v51, v51, v57
    v_accvgpr_write_b32 a80, v48
    v_accvgpr_write_b32 a81, v49
    v_accvgpr_write_b32 a82, v50
    v_accvgpr_write_b32 a83, v51
    v_accvgpr_read_b32 v48, a96
    v_accvgpr_read_b32 v49, a97
    v_accvgpr_read_b32 v50, a98
    v_accvgpr_read_b32 v51, a99
    v_mul_f32 v48, v48, v57
    v_mul_f32 v49, v49, v57
    v_mul_f32 v50, v50, v57
    v_mul_f32 v51, v51, v57
    v_accvgpr_write_b32 a96, v48
    v_accvgpr_write_b32 a97, v49
    v_accvgpr_write_b32 a98, v50
    v_accvgpr_write_b32 a99, v51
    v_accvgpr_read_b32 v48, a112
    v_accvgpr_read_b32 v49, a113
    v_accvgpr_read_b32 v50, a114
    v_accvgpr_read_b32 v51, a115
    v_mul_f32 v48, v48, v57
    v_mul_f32 v49, v49, v57
    v_mul_f32 v50, v50, v57
    v_mul_f32 v51, v51, v57
    v_accvgpr_write_b32 a112, v48
    v_accvgpr_write_b32 a113, v49
    v_accvgpr_write_b32 a114, v50
    v_accvgpr_write_b32 a115, v51
    v_accvgpr_read_b32 v48, a128
    v_accvgpr_read_b32 v49, a129
    v_accvgpr_read_b32 v50, a130
    v_accvgpr_read_b32 v51, a131
    v_mul_f32 v48, v48, v57
    v_mul_f32 v49, v49, v57
    v_mul_f32 v50, v50, v57
    v_mul_f32 v51, v51, v57
    v_accvgpr_write_b32 a128, v48
    v_accvgpr_write_b32 a129, v49
    v_accvgpr_write_b32 a130, v50
    v_accvgpr_write_b32 a131, v51
    v_accvgpr_read_b32 v48, a144
    v_accvgpr_read_b32 v49, a145
    v_accvgpr_read_b32 v50, a146
    v_accvgpr_read_b32 v51, a147
    v_mul_f32 v48, v48, v57
    v_mul_f32 v49, v49, v57
    v_mul_f32 v50, v50, v57
    v_mul_f32 v51, v51, v57
    v_accvgpr_write_b32 a144, v48
    v_accvgpr_write_b32 a145, v49
    v_accvgpr_write_b32 a146, v50
    v_accvgpr_write_b32 a147, v51
    v_accvgpr_read_b32 v48, a160
    v_accvgpr_read_b32 v49, a161
    v_accvgpr_read_b32 v50, a162
    v_accvgpr_read_b32 v51, a163
    v_mul_f32 v48, v48, v57
    v_mul_f32 v49, v49, v57
    v_mul_f32 v50, v50, v57
    v_mul_f32 v51, v51, v57
    v_accvgpr_write_b32 a160, v48
    v_accvgpr_write_b32 a161, v49
    v_accvgpr_write_b32 a162, v50
    v_accvgpr_write_b32 a163, v51
    v_accvgpr_read_b32 v48, a176
    v_accvgpr_read_b32 v49, a177
    v_accvgpr_read_b32 v50, a178
    v_accvgpr_read_b32 v51, a179
    v_mul_f32 v48, v48, v57
    v_mul_f32 v49, v49, v57
    v_mul_f32 v50, v50, v57
    v_mul_f32 v51, v51, v57
    v_accvgpr_write_b32 a176, v48
    v_accvgpr_write_b32 a177, v49
    v_accvgpr_write_b32 a178, v50
    v_accvgpr_write_b32 a179, v51
    v_exp_f32 v48, v132
    v_exp_f32 v49, v133
    v_exp_f32 v50, v134
    v_exp_f32 v51, v135
    v_exp_f32 v52, v164
    v_exp_f32 v53, v165
    v_exp_f32 v54, v166
    v_exp_f32 v55, v167
    s_nop 0
    v_cvt_pk_bf16_f32 v228, v48, v49
    v_cvt_pk_bf16_f32 v229, v50, v51
    v_cvt_pk_bf16_f32 v230, v52, v53
    v_cvt_pk_bf16_f32 v231, v54, v55
    v_add_f32 v24, v48, v49
    v_add_f32 v24, v24, v50
    v_add_f32 v24, v24, v51
    v_add_f32 v24, v24, v52
    v_add_f32 v24, v24, v53
    v_add_f32 v24, v24, v54
    v_add_f32 v24, v24, v55
    v_max3_f32 v56, v140, v141, v142
    v_max3_f32 v56, v56, v143, v172
    v_max3_f32 v56, v56, v173, v174
    v_max3_f32 v56, v56, v175, 0
    v_mov_b32 v58, v56
    s_nop 1
    v_permlane16_swap_b32 v56, v58
    s_nop 1
    v_max_f32 v56, v56, v58
    v_mov_b32 v58, v56
    s_nop 1
    v_permlane32_swap_b32 v56, v58
    s_nop 1
    v_max_f32 v56, v56, v58
    v_exp_f32 v57, -v56
    v_sub_f32 v36, v36, v56
    v_sub_f32 v37, v37, v56
    v_sub_f32 v38, v38, v56
    v_sub_f32 v39, v39, v56
    v_mul_f32 v21, v21, v57
    v_sub_f32 v140, v140, v56
    v_sub_f32 v141, v141, v56
    v_sub_f32 v142, v142, v56
    v_sub_f32 v143, v143, v56
    v_sub_f32 v172, v172, v56
    v_sub_f32 v173, v173, v56
    v_sub_f32 v174, v174, v56
    v_sub_f32 v175, v175, v56
    v_accvgpr_read_b32 v48, a4
    v_accvgpr_read_b32 v49, a5
    v_accvgpr_read_b32 v50, a6
    v_accvgpr_read_b32 v51, a7
    v_mul_f32 v48, v48, v57
    v_mul_f32 v49, v49, v57
    v_mul_f32 v50, v50, v57
    v_mul_f32 v51, v51, v57
    v_accvgpr_write_b32 a4, v48
    v_accvgpr_write_b32 a5, v49
    v_accvgpr_write_b32 a6, v50
    v_accvgpr_write_b32 a7, v51
    v_accvgpr_read_b32 v48, a20
    v_accvgpr_read_b32 v49, a21
    v_accvgpr_read_b32 v50, a22
    v_accvgpr_read_b32 v51, a23
    v_mul_f32 v48, v48, v57
    v_mul_f32 v49, v49, v57
    v_mul_f32 v50, v50, v57
    v_mul_f32 v51, v51, v57
    v_accvgpr_write_b32 a20, v48
    v_accvgpr_write_b32 a21, v49
    v_accvgpr_write_b32 a22, v50
    v_accvgpr_write_b32 a23, v51
    v_accvgpr_read_b32 v48, a36
    v_accvgpr_read_b32 v49, a37
    v_accvgpr_read_b32 v50, a38
    v_accvgpr_read_b32 v51, a39
    v_mul_f32 v48, v48, v57
    v_mul_f32 v49, v49, v57
    v_mul_f32 v50, v50, v57
    v_mul_f32 v51, v51, v57
    v_accvgpr_write_b32 a36, v48
    v_accvgpr_write_b32 a37, v49
    v_accvgpr_write_b32 a38, v50
    v_accvgpr_write_b32 a39, v51
    v_accvgpr_read_b32 v48, a52
    v_accvgpr_read_b32 v49, a53
    v_accvgpr_read_b32 v50, a54
    v_accvgpr_read_b32 v51, a55
    v_mul_f32 v48, v48, v57
    v_mul_f32 v49, v49, v57
    v_mul_f32 v50, v50, v57
    v_mul_f32 v51, v51, v57
    v_accvgpr_write_b32 a52, v48
    v_accvgpr_write_b32 a53, v49
    v_accvgpr_write_b32 a54, v50
    v_accvgpr_write_b32 a55, v51
    v_accvgpr_read_b32 v48, a68
    v_accvgpr_read_b32 v49, a69
    v_accvgpr_read_b32 v50, a70
    v_accvgpr_read_b32 v51, a71
    v_mul_f32 v48, v48, v57
    v_mul_f32 v49, v49, v57
    v_mul_f32 v50, v50, v57
    v_mul_f32 v51, v51, v57
    v_accvgpr_write_b32 a68, v48
    v_accvgpr_write_b32 a69, v49
    v_accvgpr_write_b32 a70, v50
    v_accvgpr_write_b32 a71, v51
    v_accvgpr_read_b32 v48, a84
    v_accvgpr_read_b32 v49, a85
    v_accvgpr_read_b32 v50, a86
    v_accvgpr_read_b32 v51, a87
    v_mul_f32 v48, v48, v57
    v_mul_f32 v49, v49, v57
    v_mul_f32 v50, v50, v57
    v_mul_f32 v51, v51, v57
    v_accvgpr_write_b32 a84, v48
    v_accvgpr_write_b32 a85, v49
    v_accvgpr_write_b32 a86, v50
    v_accvgpr_write_b32 a87, v51
    v_accvgpr_read_b32 v48, a100
    v_accvgpr_read_b32 v49, a101
    v_accvgpr_read_b32 v50, a102
    v_accvgpr_read_b32 v51, a103
    v_mul_f32 v48, v48, v57
    v_mul_f32 v49, v49, v57
    v_mul_f32 v50, v50, v57
    v_mul_f32 v51, v51, v57
    v_accvgpr_write_b32 a100, v48
    v_accvgpr_write_b32 a101, v49
    v_accvgpr_write_b32 a102, v50
    v_accvgpr_write_b32 a103, v51
    v_accvgpr_read_b32 v48, a116
    v_accvgpr_read_b32 v49, a117
    v_accvgpr_read_b32 v50, a118
    v_accvgpr_read_b32 v51, a119
    v_mul_f32 v48, v48, v57
    v_mul_f32 v49, v49, v57
    v_mul_f32 v50, v50, v57
    v_mul_f32 v51, v51, v57
    v_accvgpr_write_b32 a116, v48
    v_accvgpr_write_b32 a117, v49
    v_accvgpr_write_b32 a118, v50
    v_accvgpr_write_b32 a119, v51
    v_accvgpr_read_b32 v48, a132
    v_accvgpr_read_b32 v49, a133
    v_accvgpr_read_b32 v50, a134
    v_accvgpr_read_b32 v51, a135
    v_mul_f32 v48, v48, v57
    v_mul_f32 v49, v49, v57
    v_mul_f32 v50, v50, v57
    v_mul_f32 v51, v51, v57
    v_accvgpr_write_b32 a132, v48
    v_accvgpr_write_b32 a133, v49
    v_accvgpr_write_b32 a134, v50
    v_accvgpr_write_b32 a135, v51
    v_accvgpr_read_b32 v48, a148
    v_accvgpr_read_b32 v49, a149
    v_accvgpr_read_b32 v50, a150
    v_accvgpr_read_b32 v51, a151
    v_mul_f32 v48, v48, v57
    v_mul_f32 v49, v49, v57
    v_mul_f32 v50, v50, v57
    v_mul_f32 v51, v51, v57
    v_accvgpr_write_b32 a148, v48
    v_accvgpr_write_b32 a149, v49
    v_accvgpr_write_b32 a150, v50
    v_accvgpr_write_b32 a151, v51
    v_accvgpr_read_b32 v48, a164
    v_accvgpr_read_b32 v49, a165
    v_accvgpr_read_b32 v50, a166
    v_accvgpr_read_b32 v51, a167
    v_mul_f32 v48, v48, v57
    v_mul_f32 v49, v49, v57
    v_mul_f32 v50, v50, v57
    v_mul_f32 v51, v51, v57
    v_accvgpr_write_b32 a164, v48
    v_accvgpr_write_b32 a165, v49
    v_accvgpr_write_b32 a166, v50
    v_accvgpr_write_b32 a167, v51
    v_accvgpr_read_b32 v48, a180
    v_accvgpr_read_b32 v49, a181
    v_accvgpr_read_b32 v50, a182
    v_accvgpr_read_b32 v51, a183
    v_mul_f32 v48, v48, v57
    v_mul_f32 v49, v49, v57
    v_mul_f32 v50, v50, v57
    v_mul_f32 v51, v51, v57
    v_accvgpr_write_b32 a180, v48
    v_accvgpr_write_b32 a181, v49
    v_accvgpr_write_b32 a182, v50
    v_accvgpr_write_b32 a183, v51
    v_exp_f32 v48, v140
    v_exp_f32 v49, v141
    v_exp_f32 v50, v142
    v_exp_f32 v51, v143
    v_exp_f32 v52, v172
    v_exp_f32 v53, v173
    v_exp_f32 v54, v174
    v_exp_f32 v55, v175
    s_nop 0
    v_cvt_pk_bf16_f32 v236, v48, v49
    v_cvt_pk_bf16_f32 v237, v50, v51
    v_cvt_pk_bf16_f32 v238, v52, v53
    v_cvt_pk_bf16_f32 v239, v54, v55
    v_add_f32 v25, v48, v49
    v_add_f32 v25, v25, v50
    v_add_f32 v25, v25, v51
    v_add_f32 v25, v25, v52
    v_add_f32 v25, v25, v53
    v_add_f32 v25, v25, v54
    v_add_f32 v25, v25, v55
    v_max3_f32 v56, v148, v149, v150
    v_max3_f32 v56, v56, v151, v180
    v_max3_f32 v56, v56, v181, v182
    v_max3_f32 v56, v56, v183, 0
    v_mov_b32 v58, v56
    s_nop 1
    v_permlane16_swap_b32 v56, v58
    s_nop 1
    v_max_f32 v56, v56, v58
    v_mov_b32 v58, v56
    s_nop 1
    v_permlane32_swap_b32 v56, v58
    s_nop 1
    v_max_f32 v56, v56, v58
    v_exp_f32 v57, -v56
    v_sub_f32 v40, v40, v56
    v_sub_f32 v41, v41, v56
    v_sub_f32 v42, v42, v56
    v_sub_f32 v43, v43, v56
    v_mul_f32 v22, v22, v57
    v_sub_f32 v148, v148, v56
    v_sub_f32 v149, v149, v56
    v_sub_f32 v150, v150, v56
    v_sub_f32 v151, v151, v56
    v_sub_f32 v180, v180, v56
    v_sub_f32 v181, v181, v56
    v_sub_f32 v182, v182, v56
    v_sub_f32 v183, v183, v56
    v_accvgpr_read_b32 v48, a8
    v_accvgpr_read_b32 v49, a9
    v_accvgpr_read_b32 v50, a10
    v_accvgpr_read_b32 v51, a11
    v_mul_f32 v48, v48, v57
    v_mul_f32 v49, v49, v57
    v_mul_f32 v50, v50, v57
    v_mul_f32 v51, v51, v57
    v_accvgpr_write_b32 a8, v48
    v_accvgpr_write_b32 a9, v49
    v_accvgpr_write_b32 a10, v50
    v_accvgpr_write_b32 a11, v51
    v_accvgpr_read_b32 v48, a24
    v_accvgpr_read_b32 v49, a25
    v_accvgpr_read_b32 v50, a26
    v_accvgpr_read_b32 v51, a27
    v_mul_f32 v48, v48, v57
    v_mul_f32 v49, v49, v57
    v_mul_f32 v50, v50, v57
    v_mul_f32 v51, v51, v57
    v_accvgpr_write_b32 a24, v48
    v_accvgpr_write_b32 a25, v49
    v_accvgpr_write_b32 a26, v50
    v_accvgpr_write_b32 a27, v51
    v_accvgpr_read_b32 v48, a40
    v_accvgpr_read_b32 v49, a41
    v_accvgpr_read_b32 v50, a42
    v_accvgpr_read_b32 v51, a43
    v_mul_f32 v48, v48, v57
    v_mul_f32 v49, v49, v57
    v_mul_f32 v50, v50, v57
    v_mul_f32 v51, v51, v57
    v_accvgpr_write_b32 a40, v48
    v_accvgpr_write_b32 a41, v49
    v_accvgpr_write_b32 a42, v50
    v_accvgpr_write_b32 a43, v51
    v_accvgpr_read_b32 v48, a56
    v_accvgpr_read_b32 v49, a57
    v_accvgpr_read_b32 v50, a58
    v_accvgpr_read_b32 v51, a59
    v_mul_f32 v48, v48, v57
    v_mul_f32 v49, v49, v57
    v_mul_f32 v50, v50, v57
    v_mul_f32 v51, v51, v57
    v_accvgpr_write_b32 a56, v48
    v_accvgpr_write_b32 a57, v49
    v_accvgpr_write_b32 a58, v50
    v_accvgpr_write_b32 a59, v51
    v_accvgpr_read_b32 v48, a72
    v_accvgpr_read_b32 v49, a73
    v_accvgpr_read_b32 v50, a74
    v_accvgpr_read_b32 v51, a75
    v_mul_f32 v48, v48, v57
    v_mul_f32 v49, v49, v57
    v_mul_f32 v50, v50, v57
    v_mul_f32 v51, v51, v57
    v_accvgpr_write_b32 a72, v48
    v_accvgpr_write_b32 a73, v49
    v_accvgpr_write_b32 a74, v50
    v_accvgpr_write_b32 a75, v51
    v_accvgpr_read_b32 v48, a88
    v_accvgpr_read_b32 v49, a89
    v_accvgpr_read_b32 v50, a90
    v_accvgpr_read_b32 v51, a91
    v_mul_f32 v48, v48, v57
    v_mul_f32 v49, v49, v57
    v_mul_f32 v50, v50, v57
    v_mul_f32 v51, v51, v57
    v_accvgpr_write_b32 a88, v48
    v_accvgpr_write_b32 a89, v49
    v_accvgpr_write_b32 a90, v50
    v_accvgpr_write_b32 a91, v51
    v_accvgpr_read_b32 v48, a104
    v_accvgpr_read_b32 v49, a105
    v_accvgpr_read_b32 v50, a106
    v_accvgpr_read_b32 v51, a107
    v_mul_f32 v48, v48, v57
    v_mul_f32 v49, v49, v57
    v_mul_f32 v50, v50, v57
    v_mul_f32 v51, v51, v57
    v_accvgpr_write_b32 a104, v48
    v_accvgpr_write_b32 a105, v49
    v_accvgpr_write_b32 a106, v50
    v_accvgpr_write_b32 a107, v51
    v_accvgpr_read_b32 v48, a120
    v_accvgpr_read_b32 v49, a121
    v_accvgpr_read_b32 v50, a122
    v_accvgpr_read_b32 v51, a123
    v_mul_f32 v48, v48, v57
    v_mul_f32 v49, v49, v57
    v_mul_f32 v50, v50, v57
    v_mul_f32 v51, v51, v57
    v_accvgpr_write_b32 a120, v48
    v_accvgpr_write_b32 a121, v49
    v_accvgpr_write_b32 a122, v50
    v_accvgpr_write_b32 a123, v51
    v_accvgpr_read_b32 v48, a136
    v_accvgpr_read_b32 v49, a137
    v_accvgpr_read_b32 v50, a138
    v_accvgpr_read_b32 v51, a139
    v_mul_f32 v48, v48, v57
    v_mul_f32 v49, v49, v57
    v_mul_f32 v50, v50, v57
    v_mul_f32 v51, v51, v57
    v_accvgpr_write_b32 a136, v48
    v_accvgpr_write_b32 a137, v49
    v_accvgpr_write_b32 a138, v50
    v_accvgpr_write_b32 a139, v51
    v_accvgpr_read_b32 v48, a152
    v_accvgpr_read_b32 v49, a153
    v_accvgpr_read_b32 v50, a154
    v_accvgpr_read_b32 v51, a155
    v_mul_f32 v48, v48, v57
    v_mul_f32 v49, v49, v57
    v_mul_f32 v50, v50, v57
    v_mul_f32 v51, v51, v57
    v_accvgpr_write_b32 a152, v48
    v_accvgpr_write_b32 a153, v49
    v_accvgpr_write_b32 a154, v50
    v_accvgpr_write_b32 a155, v51
    v_accvgpr_read_b32 v48, a168
    v_accvgpr_read_b32 v49, a169
    v_accvgpr_read_b32 v50, a170
    v_accvgpr_read_b32 v51, a171
    v_mul_f32 v48, v48, v57
    v_mul_f32 v49, v49, v57
    v_mul_f32 v50, v50, v57
    v_mul_f32 v51, v51, v57
    v_accvgpr_write_b32 a168, v48
    v_accvgpr_write_b32 a169, v49
    v_accvgpr_write_b32 a170, v50
    v_accvgpr_write_b32 a171, v51
    v_accvgpr_read_b32 v48, a184
    v_accvgpr_read_b32 v49, a185
    v_accvgpr_read_b32 v50, a186
    v_accvgpr_read_b32 v51, a187
    v_mul_f32 v48, v48, v57
    v_mul_f32 v49, v49, v57
    v_mul_f32 v50, v50, v57
    v_mul_f32 v51, v51, v57
    v_accvgpr_write_b32 a184, v48
    v_accvgpr_write_b32 a185, v49
    v_accvgpr_write_b32 a186, v50
    v_accvgpr_write_b32 a187, v51
    v_exp_f32 v48, v148
    v_exp_f32 v49, v149
    v_exp_f32 v50, v150
    v_exp_f32 v51, v151
    v_exp_f32 v52, v180
    v_exp_f32 v53, v181
    v_exp_f32 v54, v182
    v_exp_f32 v55, v183
    s_nop 0
    v_cvt_pk_bf16_f32 v244, v48, v49
    v_cvt_pk_bf16_f32 v245, v50, v51
    v_cvt_pk_bf16_f32 v246, v52, v53
    v_cvt_pk_bf16_f32 v247, v54, v55
    v_add_f32 v26, v48, v49
    v_add_f32 v26, v26, v50
    v_add_f32 v26, v26, v51
    v_add_f32 v26, v26, v52
    v_add_f32 v26, v26, v53
    v_add_f32 v26, v26, v54
    v_add_f32 v26, v26, v55
    v_max3_f32 v56, v156, v157, v158
    v_max3_f32 v56, v56, v159, v188
    v_max3_f32 v56, v56, v189, v190
    v_max3_f32 v56, v56, v191, 0
    v_mov_b32 v58, v56
    s_nop 1
    v_permlane16_swap_b32 v56, v58
    s_nop 1
    v_max_f32 v56, v56, v58
    v_mov_b32 v58, v56
    s_nop 1
    v_permlane32_swap_b32 v56, v58
    s_nop 1
    v_max_f32 v56, v56, v58
    v_exp_f32 v57, -v56
    v_sub_f32 v44, v44, v56
    v_sub_f32 v45, v45, v56
    v_sub_f32 v46, v46, v56
    v_sub_f32 v47, v47, v56
    v_mul_f32 v23, v23, v57
    v_sub_f32 v156, v156, v56
    v_sub_f32 v157, v157, v56
    v_sub_f32 v158, v158, v56
    v_sub_f32 v159, v159, v56
    v_sub_f32 v188, v188, v56
    v_sub_f32 v189, v189, v56
    v_sub_f32 v190, v190, v56
    v_sub_f32 v191, v191, v56
    v_accvgpr_read_b32 v48, a12
    v_accvgpr_read_b32 v49, a13
    v_accvgpr_read_b32 v50, a14
    v_accvgpr_read_b32 v51, a15
    v_mul_f32 v48, v48, v57
    v_mul_f32 v49, v49, v57
    v_mul_f32 v50, v50, v57
    v_mul_f32 v51, v51, v57
    v_accvgpr_write_b32 a12, v48
    v_accvgpr_write_b32 a13, v49
    v_accvgpr_write_b32 a14, v50
    v_accvgpr_write_b32 a15, v51
    v_accvgpr_read_b32 v48, a28
    v_accvgpr_read_b32 v49, a29
    v_accvgpr_read_b32 v50, a30
    v_accvgpr_read_b32 v51, a31
    v_mul_f32 v48, v48, v57
    v_mul_f32 v49, v49, v57
    v_mul_f32 v50, v50, v57
    v_mul_f32 v51, v51, v57
    v_accvgpr_write_b32 a28, v48
    v_accvgpr_write_b32 a29, v49
    v_accvgpr_write_b32 a30, v50
    v_accvgpr_write_b32 a31, v51
    v_accvgpr_read_b32 v48, a44
    v_accvgpr_read_b32 v49, a45
    v_accvgpr_read_b32 v50, a46
    v_accvgpr_read_b32 v51, a47
    v_mul_f32 v48, v48, v57
    v_mul_f32 v49, v49, v57
    v_mul_f32 v50, v50, v57
    v_mul_f32 v51, v51, v57
    v_accvgpr_write_b32 a44, v48
    v_accvgpr_write_b32 a45, v49
    v_accvgpr_write_b32 a46, v50
    v_accvgpr_write_b32 a47, v51
    v_accvgpr_read_b32 v48, a60
    v_accvgpr_read_b32 v49, a61
    v_accvgpr_read_b32 v50, a62
    v_accvgpr_read_b32 v51, a63
    v_mul_f32 v48, v48, v57
    v_mul_f32 v49, v49, v57
    v_mul_f32 v50, v50, v57
    v_mul_f32 v51, v51, v57
    v_accvgpr_write_b32 a60, v48
    v_accvgpr_write_b32 a61, v49
    v_accvgpr_write_b32 a62, v50
    v_accvgpr_write_b32 a63, v51
    v_accvgpr_read_b32 v48, a76
    v_accvgpr_read_b32 v49, a77
    v_accvgpr_read_b32 v50, a78
    v_accvgpr_read_b32 v51, a79
    v_mul_f32 v48, v48, v57
    v_mul_f32 v49, v49, v57
    v_mul_f32 v50, v50, v57
    v_mul_f32 v51, v51, v57
    v_accvgpr_write_b32 a76, v48
    v_accvgpr_write_b32 a77, v49
    v_accvgpr_write_b32 a78, v50
    v_accvgpr_write_b32 a79, v51
    v_accvgpr_read_b32 v48, a92
    v_accvgpr_read_b32 v49, a93
    v_accvgpr_read_b32 v50, a94
    v_accvgpr_read_b32 v51, a95
    v_mul_f32 v48, v48, v57
    v_mul_f32 v49, v49, v57
    v_mul_f32 v50, v50, v57
    v_mul_f32 v51, v51, v57
    v_accvgpr_write_b32 a92, v48
    v_accvgpr_write_b32 a93, v49
    v_accvgpr_write_b32 a94, v50
    v_accvgpr_write_b32 a95, v51
    v_accvgpr_read_b32 v48, a108
    v_accvgpr_read_b32 v49, a109
    v_accvgpr_read_b32 v50, a110
    v_accvgpr_read_b32 v51, a111
    v_mul_f32 v48, v48, v57
    v_mul_f32 v49, v49, v57
    v_mul_f32 v50, v50, v57
    v_mul_f32 v51, v51, v57
    v_accvgpr_write_b32 a108, v48
    v_accvgpr_write_b32 a109, v49
    v_accvgpr_write_b32 a110, v50
    v_accvgpr_write_b32 a111, v51
    v_accvgpr_read_b32 v48, a124
    v_accvgpr_read_b32 v49, a125
    v_accvgpr_read_b32 v50, a126
    v_accvgpr_read_b32 v51, a127
    v_mul_f32 v48, v48, v57
    v_mul_f32 v49, v49, v57
    v_mul_f32 v50, v50, v57
    v_mul_f32 v51, v51, v57
    v_accvgpr_write_b32 a124, v48
    v_accvgpr_write_b32 a125, v49
    v_accvgpr_write_b32 a126, v50
    v_accvgpr_write_b32 a127, v51
    v_accvgpr_read_b32 v48, a140
    v_accvgpr_read_b32 v49, a141
    v_accvgpr_read_b32 v50, a142
    v_accvgpr_read_b32 v51, a143
    v_mul_f32 v48, v48, v57
    v_mul_f32 v49, v49, v57
    v_mul_f32 v50, v50, v57
    v_mul_f32 v51, v51, v57
    v_accvgpr_write_b32 a140, v48
    v_accvgpr_write_b32 a141, v49
    v_accvgpr_write_b32 a142, v50
    v_accvgpr_write_b32 a143, v51
    v_accvgpr_read_b32 v48, a156
    v_accvgpr_read_b32 v49, a157
    v_accvgpr_read_b32 v50, a158
    v_accvgpr_read_b32 v51, a159
    v_mul_f32 v48, v48, v57
    v_mul_f32 v49, v49, v57
    v_mul_f32 v50, v50, v57
    v_mul_f32 v51, v51, v57
    v_accvgpr_write_b32 a156, v48
    v_accvgpr_write_b32 a157, v49
    v_accvgpr_write_b32 a158, v50
    v_accvgpr_write_b32 a159, v51
    v_accvgpr_read_b32 v48, a172
    v_accvgpr_read_b32 v49, a173
    v_accvgpr_read_b32 v50, a174
    v_accvgpr_read_b32 v51, a175
    v_mul_f32 v48, v48, v57
    v_mul_f32 v49, v49, v57
    v_mul_f32 v50, v50, v57
    v_mul_f32 v51, v51, v57
    v_accvgpr_write_b32 a172, v48
    v_accvgpr_write_b32 a173, v49
    v_accvgpr_write_b32 a174, v50
    v_accvgpr_write_b32 a175, v51
    v_accvgpr_read_b32 v48, a188
    v_accvgpr_read_b32 v49, a189
    v_accvgpr_read_b32 v50, a190
    v_accvgpr_read_b32 v51, a191
    v_mul_f32 v48, v48, v57
    v_mul_f32 v49, v49, v57
    v_mul_f32 v50, v50, v57
    v_mul_f32 v51, v51, v57
    v_accvgpr_write_b32 a188, v48
    v_accvgpr_write_b32 a189, v49
    v_accvgpr_write_b32 a190, v50
    v_accvgpr_write_b32 a191, v51
    v_exp_f32 v48, v156
    v_exp_f32 v49, v157
    v_exp_f32 v50, v158
    v_exp_f32 v51, v159
    v_exp_f32 v52, v188
    v_exp_f32 v53, v189
    v_exp_f32 v54, v190
    v_exp_f32 v55, v191
    s_nop 0
    v_cvt_pk_bf16_f32 v252, v48, v49
    v_cvt_pk_bf16_f32 v253, v50, v51
    v_cvt_pk_bf16_f32 v254, v52, v53
    v_cvt_pk_bf16_f32 v255, v54, v55
    v_add_f32 v27, v48, v49
    v_add_f32 v27, v27, v50
    v_add_f32 v27, v27, v51
    v_add_f32 v27, v27, v52
    v_add_f32 v27, v27, v53
    v_add_f32 v27, v27, v54
    v_add_f32 v27, v27, v55
    s_nop 1
    s_branch rare_e_ret
.section .rodata,"a"
.p2align 6
.amdhsa_kernel recurrent_scan__sliding_block_cached__moe_arch_mod__prompt_kernel
  .amdhsa_next_free_vgpr 512
  .amdhsa_next_free_sgpr 102
  .amdhsa_accum_offset 256
  .amdhsa_group_segment_fixed_size 0
  .amdhsa_kernarg_size 104
  .amdhsa_user_sgpr_count 2
  .amdhsa_user_sgpr_kernarg_segment_ptr 1
  .amdhsa_system_sgpr_workgroup_id_x 1
  .amdhsa_float_denorm_mode_32 3
.end_amdhsa_kernel
```

```asm
; @launch grid=(256,1,1) block=(256,1,1) lds=163840
.amdgcn_target "amdgcn-amd-amdhsa--gfx950"
.text
.globl recurrent_scan__sliding_block_cached__moe_arch_mod__prompt_kernel
.p2align 8
.type recurrent_scan__sliding_block_cached__moe_arch_mod__prompt_kernel,@function
recurrent_scan__sliding_block_cached__moe_arch_mod__prompt_kernel:
    s_cmp_ge_u32 s2, 256
    s_cbranch_scc1 main_end
    s_load_dwordx16 s[64:79], s[0:1], 0
    s_load_dwordx4 s[80:83], s[0:1], 64
    s_load_dwordx2 s[84:85], s[0:1], 80
    s_load_dwordx2 s[86:87], s[0:1], 96
    s_bfe_u32 s30, s2, 0x20003
    s_lshl_b32 s30, s30, 3
    s_lshr_b32 s30, 0x18183060, s30
    s_and_b32 s30, s30, 0xff
    s_load_dwordx2 s[28:29], s[0:1], s30
    s_bfe_u32 s30, s2, 0x10003
    s_bfe_u32 s31, s2, 0x10005
    s_lshl1_add_u32 s30, s30, s31
    s_lshl_b32 s30, s30, 21
    s_bitcmp1_b32 s2, 3
    s_cselect_b32 s31, 0, 0x300000
    s_bitcmp1_b32 s2, 4
    s_cselect_b32 s30, s30, s31
    s_lshr_b32 s56, s2, 3
    s_lshl_b32 s56, s56, 11
    v_lshrrev_b32 v17, 4, v0
    v_lshlrev_b32 v17, 7, v17
    v_add_u32 v17, s56, v17
    s_getpc_b64 s[88:89]
    global_load_dword a220, v17, s[88:89]
    v_lshrrev_b32 v17, 6, v0
    v_lshlrev_b32 v17, 12, v17
    v_and_b32 v1, 63, v0
    v_lshl_add_u32 v17, v1, 4, v17
    v_and_b32 v1, 63, v0
    v_lshrrev_b32 v29, 6, v0
    v_mov_b32 v16, v0
    v_readfirstlane_b32 s3, v29
    s_and_b32 s53, s2, 7
    s_lshr_b32 s52, s2, 5
    s_bfe_u32 s51, s2, 0x20003
    s_lshl_b32 s50, s53, 2
    s_add_u32 s50, s50, s51
    s_lshl_b32 s60, s2, 3
    s_lshl_b32 s56, s3, 1
    s_add_u32 s60, s60, s56
    v_bfe_u32 v240, v1, 2, 1
    v_add_u32 v240, s60, v240
    v_lshrrev_b32 v241, 3, v1
    v_lshlrev_b32 v241, 6, v241
    v_and_b32 v29, 3, v1
    v_lshl_add_u32 v241, v29, 4, v241
    v_mul_u32_u24 v242, 1280, v240
    v_add_u32 v242, v242, v241
    v_lshrrev_b32 v29, 4, v1
    v_lshlrev_b32 v29, 1, v29
    v_and_b32 v7, 7, v1
    v_xor_b32 v7, v7, v29
    v_lshlrev_b32 v7, 4, v7
    v_lshrrev_b32 v29, 5, v1
    v_lshlrev_b32 v29, 3, v29
    v_bfe_u32 v5, v1, 3, 2
    v_add_u32 v5, v5, v29
    v_mul_u32_u24 v2, 12288, v5
    v_add_u32 v2, v2, v7
    v_add_u32 v3, 196608, v2
    s_lshl_b32 s54, s52, 2
    s_add_u32 s54, s54, s3
    s_mul_i32 s49, s3, 6144
    s_lshr_b32 s59, s3, 1
    s_lshl_b32 s59, s59, 5
    s_and_b32 s56, s3, 1
    s_lshl_b32 s56, s56, 2
    s_add_u32 s59, s59, s56
    s_mul_i32 s36, s59, 12288
    s_mov_b32 s37, 786432
    s_add_u32 s45, s51, s52
    s_and_b32 s45, s45, 3
    s_lshl_b32 s45, s45, 2
    s_lshr_b32 s45, 0x5050, s45
    s_and_b32 s45, s45, 15
    s_mul_i32 s56, s45, 786432
    s_add_u32 s36, s36, s56
    s_lshl_b32 s45, s45, 13
    s_lshr_b32 s56, s2, 3
    s_lshl_b32 s56, s56, 8
    v_add_u32 v22, s56, v16
    s_mov_b32 s56, 357913942
    v_mul_hi_u32 v23, s56, v22
    v_mul_u32_u24 v24, 12, v23
    v_sub_u32 v24, v22, v24
    v_mul_u32_u24 v23, 12288, v23
    v_lshl_add_u32 v23, v24, 7, v23
    s_mul_i32 s40, s51, 384
    s_sub_u32 s40, 1572864, s40
    v_lshlrev_b32 v24, 7, v1
    s_mul_i32 s47, s50, 786432
    s_add_u32 s47, s47, 589824
    s_lshl_b32 s48, s52, 13
    s_mul_i32 s56, s50, 384
    s_sub_u32 s57, 7864320, s56
    s_waitcnt lgkmcnt(0)
k_in:
    s_load_dword s4, s[28:29], s30 offset:1024
    s_mov_b32 s12, s64
    s_and_b32 s13, s65, 0xffff
    s_mov_b32 s14, 2621440
    s_mov_b32 s15, 0x00020000
    s_mov_b32 s16, s76
    s_and_b32 s17, s77, 0xffff
    s_mov_b32 s18, 1280
    s_mov_b32 s19, 0x00020000
    buffer_load_dwordx4 v[64:67], v242, s[12:15], 0 offen
    buffer_load_dwordx4 v[68:71], v242, s[12:15], 0 offen offset:512
    buffer_load_dwordx4 v[72:75], v242, s[12:15], 0 offen offset:1024
    v_mov_b32 v25, 3203072
    global_load_dword v26, v25, s[86:87] sc1
    s_lshr_b32 s44, s2, 3
    s_lshl_b32 s44, s44, 7
    s_add_u32 s44, s44, 4784128
    s_load_dword s92, s[86:87], s44 glc
    s_lshr_b32 s58, s2, 4
    s_lshl_b32 s58, s58, 14
    s_and_b32 s44, s2, 15
    s_lshl_b32 s44, s44, 2
    s_add_u32 s44, s44, s3
    s_lshl_b32 s44, s44, 7
    s_add_u32 s58, s58, s44
    s_add_u32 s58, s58, 4456448
    v_and_b32 v27, 31, v1
    v_lshlrev_b32 v27, 2, v27
    v_lshrrev_b32 v25, 5, v1
    v_lshl_add_u32 v27, v25, 13, v27
    v_add_u32 v27, s58, v27
    v_mov_b32 v25, 0
    global_store_dword v27, v25, s[86:87] sc1
    buffer_load_dwordx4 v[76:79], v241, s[16:19], 0 offen offset:0
    buffer_load_dwordx4 v[80:83], v241, s[16:19], 0 offen offset:512
    buffer_load_dwordx4 v[84:87], v241, s[16:19], 0 offen offset:1024
    s_add_u32 s8, s70, s56
    s_addc_u32 s9, s71, 0
    s_and_b32 s9, s9, 0xffff
    s_mov_b32 s10, s57
    s_mov_b32 s11, 0x00020000
    s_add_u32 m0, s49, 49152
    s_nop 0
    buffer_load_dwordx4 v2, s[8:11], s36 offen offset:0 lds
    s_add_u32 m0, s49, 50048
    s_nop 0
    buffer_load_dwordx4 v2, s[8:11], s36 offen offset:128 lds
    s_add_u32 m0, s49, 50944
    s_nop 0
    buffer_load_dwordx4 v2, s[8:11], s36 offen offset:256 lds
    s_add_u32 m0, s49, 52224
    s_nop 0
    buffer_load_dwordx4 v3, s[8:11], s36 offen offset:0 lds
    s_add_u32 m0, s49, 53120
    s_nop 0
    buffer_load_dwordx4 v3, s[8:11], s36 offen offset:128 lds
    s_add_u32 m0, s49, 54016
    s_nop 0
    buffer_load_dwordx4 v3, s[8:11], s36 offen offset:256 lds
    s_add_u32 s36, s36, s37
    s_sub_u32 s55, s36, 7864320
    s_min_u32 s36, s36, s55
    s_mov_b32 s24, s86
    s_and_b32 s25, s87, 0xffff
    s_mov_b32 s26, 268435456
    s_mov_b32 s27, 0x00020000
    s_lshl_b32 s56, s2, 2
    s_add_u32 s56, s56, s3
    s_cmp_lt_u32 s56, 20
    s_cselect_b32 s57, 0, 0x70000000
    s_add_u32 s57, s57, 3670016
    s_lshl_b32 s56, s56, 10
    s_add_u32 s56, s56, s57
    v_mov_b32 v160, 0
    v_mov_b32 v161, 0
    v_mov_b32 v162, 0
    v_mov_b32 v163, 0
    v_lshlrev_b32 v164, 4, v1
    buffer_store_dwordx4 v[160:163], v164, s[24:27], s56 offen sc1
    v_lshrrev_b32 v243, 6, v240
    v_mul_u32_u24 v243, 81920, v243
    v_bfe_u32 v29, v240, 4, 2
    v_lshl_add_u32 v243, v29, 10, v243
    v_and_b32 v29, 15, v240
    v_lshl_add_u32 v243, v29, 6, v243
    v_lshrrev_b32 v29, 3, v1
    v_lshl_add_u32 v243, v29, 12, v243
    v_and_b32 v29, 3, v1
    v_lshl_add_u32 v243, v29, 4, v243
    s_mov_b32 s38, 0x3acccccd
    s_mov_b32 s39, 0x3727c5ac
    s_mov_b32 s41, 0
    s_mov_b32 s42, 32768
    s_mov_b32 s43, 65536
    v_bfe_u32 v29, v1, 2, 3
    v_lshlrev_b32 v12, 7, v29
    v_lshrrev_b32 v29, 1, v29
    v_xor_b32 v29, 0, v29
    v_lshl_add_u32 v12, v29, 5, v12
    v_and_b32 v29, 3, v1
    v_lshl_add_u32 v12, v29, 3, v12
    v_lshrrev_b32 v29, 5, v1
    v_mul_u32_u24 v29, 3072, v29
    v_add_u32 v12, v12, v29
    v_xor_b32 v13, 32, v12
    v_xor_b32 v14, 64, v12
    v_xor_b32 v15, 96, v12
    v_add_u32 v8, 49152, v12
    v_add_u32 v9, 49152, v13
    v_add_u32 v10, 49152, v14
    v_add_u32 v11, 49152, v15
    v_and_b32 v28, 15, v1
    v_lshlrev_b32 v28, 6, v28
    v_lshrrev_b32 v29, 4, v1
    v_lshl_add_u32 v28, v29, 4, v28
    s_mul_i32 s56, s54, 81920
    s_add_u32 s56, s56, 0
    s_add_u32 s20, s86, s56
    s_addc_u32 s21, s87, 0
    s_and_b32 s21, s21, 0xffff
    s_mov_b32 s22, 81920
    s_mov_b32 s23, 0x00020000
    s_lshl_b32 s46, s54, 7
    s_add_u32 s46, s46, 4784128
    s_mov_b32 s101, 0
    s_bitcmp1_b32 s53, 1
    s_cselect_b32 s56, 0x4000, 0
    s_add_u32 s46, s46, s56
    s_and_b32 s56, s53, 1
    s_lshl_b32 s56, s56, 12
    s_add_u32 s46, s46, s56
    s_load_dword s47, s[86:87], s46 glc
    s_load_dword s48, s[86:87], s46 offset:0x2000 glc
    s_lshr_b32 s6, s2, 3
    s_lshl_b32 s6, s6, 7
    s_lshl_b32 s56, s53, 2
    s_add_u32 s6, s6, s56
    s_add_u32 s6, s6, 4784128
    s_cmp_eq_u32 s3, 0
    s_cselect_b32 s6, s6, 0x70000000
    v_lshlrev_b32 v20, 12, v1
    s_mov_b64 exec, 0
    s_cmp_eq_u32 s3, 0
    s_cbranch_scc1 pg_0
    s_cmp_eq_u32 s3, 1
    s_cbranch_scc1 pg_1
    s_cmp_eq_u32 s3, 2
    s_cbranch_scc1 pg_2
    s_cmp_eq_u32 s3, 3
    s_cbranch_scc1 pg_3
pg_ret:
    s_mov_b64 exec, -1
    s_waitcnt vmcnt(12)
x_in:
    v_lshlrev_b32 v96, 16, v64
    v_and_b32 v97, 0xffff0000, v64
    v_lshlrev_b32 v98, 16, v65
    v_and_b32 v99, 0xffff0000, v65
    v_lshlrev_b32 v100, 16, v66
    v_and_b32 v101, 0xffff0000, v66
    v_lshlrev_b32 v102, 16, v67
    v_and_b32 v103, 0xffff0000, v67
    v_lshlrev_b32 v104, 16, v68
    v_and_b32 v105, 0xffff0000, v68
    v_lshlrev_b32 v106, 16, v69
    v_and_b32 v107, 0xffff0000, v69
    v_lshlrev_b32 v108, 16, v70
    v_and_b32 v109, 0xffff0000, v70
    v_lshlrev_b32 v110, 16, v71
    v_and_b32 v111, 0xffff0000, v71
    v_lshlrev_b32 v112, 16, v72
    v_and_b32 v113, 0xffff0000, v72
    v_lshlrev_b32 v114, 16, v73
    v_and_b32 v115, 0xffff0000, v73
    v_lshlrev_b32 v116, 16, v74
    v_and_b32 v117, 0xffff0000, v74
    v_lshlrev_b32 v118, 16, v75
    v_and_b32 v119, 0xffff0000, v75
    v_pk_add_f32 v[120:121], v[96:97], v[98:99]
    v_pk_add_f32 v[122:123], v[100:101], v[102:103]
    v_pk_add_f32 v[120:121], v[120:121], v[104:105]
    v_pk_add_f32 v[122:123], v[122:123], v[106:107]
    v_pk_add_f32 v[120:121], v[120:121], v[108:109]
    v_pk_add_f32 v[122:123], v[122:123], v[110:111]
    s_mov_b32 exec_hi, 0
    v_pk_add_f32 v[120:121], v[120:121], v[112:113]
    v_pk_add_f32 v[122:123], v[122:123], v[114:115]
    v_pk_add_f32 v[120:121], v[120:121], v[116:117]
    v_pk_add_f32 v[122:123], v[122:123], v[118:119]
    s_mov_b64 exec, -1
    v_pk_add_f32 v[120:121], v[120:121], v[122:123]
    v_add_f32 v120, v120, v121
    s_nop 1
    v_add_f32_dpp v120, v120, v120 quad_perm:[1,0,3,2] row_mask:0xf bank_mask:0xf
    s_nop 1
    v_add_f32_dpp v120, v120, v120 quad_perm:[2,3,0,1] row_mask:0xf bank_mask:0xf
    s_nop 1
    v_add_f32_dpp v120, v120, v120 row_ror:8 row_mask:0xf bank_mask:0xf
    v_mov_b32 v124, v120
    s_nop 1
    v_permlane16_swap_b32 v120, v124
    s_nop 1
    v_add_f32 v120, v120, v124
    v_mov_b32 v124, v120
    s_nop 1
    v_permlane32_swap_b32 v120, v124
    s_nop 1
    v_add_f32 v120, v120, v124
    v_mul_f32 v126, s38, v120
    v_mul_f32 v128, s38, -v120
    v_mul_f32 v129, s38, -v120
    v_pk_add_f32 v[132:133], v[96:97], v[128:129]
    v_pk_mul_f32 v[120:121], v[132:133], v[132:133]
    v_pk_add_f32 v[134:135], v[98:99], v[128:129]
    v_pk_mul_f32 v[122:123], v[134:135], v[134:135]
    v_pk_add_f32 v[136:137], v[100:101], v[128:129]
    v_pk_fma_f32 v[120:121], v[136:137], v[136:137], v[120:121]
    v_pk_add_f32 v[138:139], v[102:103], v[128:129]
    v_pk_fma_f32 v[122:123], v[138:139], v[138:139], v[122:123]
    v_pk_add_f32 v[132:133], v[104:105], v[128:129]
    v_pk_fma_f32 v[120:121], v[132:133], v[132:133], v[120:121]
    v_pk_add_f32 v[134:135], v[106:107], v[128:129]
    v_pk_fma_f32 v[122:123], v[134:135], v[134:135], v[122:123]
    v_pk_add_f32 v[136:137], v[108:109], v[128:129]
    v_pk_fma_f32 v[120:121], v[136:137], v[136:137], v[120:121]
    v_pk_add_f32 v[138:139], v[110:111], v[128:129]
    v_pk_fma_f32 v[122:123], v[138:139], v[138:139], v[122:123]
    s_mov_b32 exec_hi, 0
    v_pk_add_f32 v[132:133], v[112:113], v[128:129]
    v_pk_fma_f32 v[120:121], v[132:133], v[132:133], v[120:121]
    v_pk_add_f32 v[134:135], v[114:115], v[128:129]
    v_pk_fma_f32 v[122:123], v[134:135], v[134:135], v[122:123]
    v_pk_add_f32 v[136:137], v[116:117], v[128:129]
    v_pk_fma_f32 v[120:121], v[136:137], v[136:137], v[120:121]
    v_pk_add_f32 v[138:139], v[118:119], v[128:129]
    v_pk_fma_f32 v[122:123], v[138:139], v[138:139], v[122:123]
    s_mov_b64 exec, -1
    v_pk_add_f32 v[120:121], v[120:121], v[122:123]
    v_add_f32 v120, v120, v121
    s_nop 1
    v_add_f32_dpp v120, v120, v120 quad_perm:[1,0,3,2] row_mask:0xf bank_mask:0xf
    s_nop 1
    v_add_f32_dpp v120, v120, v120 quad_perm:[2,3,0,1] row_mask:0xf bank_mask:0xf
    s_nop 1
    v_add_f32_dpp v120, v120, v120 row_ror:8 row_mask:0xf bank_mask:0xf
    v_mov_b32 v124, v120
    s_nop 1
    v_permlane16_swap_b32 v120, v124
    s_nop 1
    v_add_f32 v120, v120, v124
    v_mov_b32 v124, v120
    s_nop 1
    v_permlane32_swap_b32 v120, v124
    s_nop 1
    v_add_f32 v120, v120, v124
    v_mul_f32 v130, s38, v120
    v_cvt_pk_bf16_f32 v126, v126, v126
    v_and_b32 v126, 0xffff0000, v126
    v_cvt_pk_bf16_f32 v130, v130, v130
    v_and_b32 v130, 0xffff0000, v130
    v_add_f32 v130, s39, v130
    v_cvt_pk_bf16_f32 v130, v130, v130
    v_and_b32 v130, 0xffff0000, v130
    v_sqrt_f32 v130, v130
    v_sub_f32 v128, 0, v126
    v_cvt_pk_bf16_f32 v130, v130, v130
    v_and_b32 v130, 0xffff0000, v130
    v_rcp_f32 v127, v130
    v_sub_f32 v129, 0, v126
    v_mul_f32 v120, 0x3dd53b95, v127
    v_mul_f32 v121, 0x3dd53b95, v127
    v_mov_b32 v130, v127
    v_mov_b32 v131, v127
    v_pk_add_f32 v[96:97], v[96:97], v[128:129]
    v_pk_mul_f32 v[132:133], v[96:97], v[120:121]
    v_cvt_pk_bf16_f32 v144, v132, v133
    v_pk_add_f32 v[98:99], v[98:99], v[128:129]
    v_pk_mul_f32 v[134:135], v[98:99], v[120:121]
    v_cvt_pk_bf16_f32 v145, v134, v135
    v_pk_add_f32 v[100:101], v[100:101], v[128:129]
    v_pk_mul_f32 v[136:137], v[100:101], v[120:121]
    v_cvt_pk_bf16_f32 v146, v136, v137
    v_pk_add_f32 v[102:103], v[102:103], v[128:129]
    v_pk_mul_f32 v[138:139], v[102:103], v[120:121]
    v_cvt_pk_bf16_f32 v147, v138, v139
    buffer_store_dwordx4 v[144:147], v243, s[24:27], s41 offen sc1
    v_pk_add_f32 v[104:105], v[104:105], v[128:129]
    v_pk_mul_f32 v[132:133], v[104:105], v[120:121]
    v_cvt_pk_bf16_f32 v148, v132, v133
    v_pk_add_f32 v[106:107], v[106:107], v[128:129]
    v_pk_mul_f32 v[134:135], v[106:107], v[120:121]
    v_cvt_pk_bf16_f32 v149, v134, v135
    v_pk_add_f32 v[108:109], v[108:109], v[128:129]
    v_pk_mul_f32 v[136:137], v[108:109], v[120:121]
    v_cvt_pk_bf16_f32 v150, v136, v137
    v_pk_add_f32 v[110:111], v[110:111], v[128:129]
    v_pk_mul_f32 v[138:139], v[110:111], v[120:121]
    v_cvt_pk_bf16_f32 v151, v138, v139
    buffer_store_dwordx4 v[148:151], v243, s[24:27], s42 offen sc1
    v_pk_add_f32 v[112:113], v[112:113], v[128:129]
    v_pk_mul_f32 v[132:133], v[112:113], v[120:121]
    v_cvt_pk_bf16_f32 v152, v132, v133
    v_pk_add_f32 v[114:115], v[114:115], v[128:129]
    v_pk_mul_f32 v[134:135], v[114:115], v[120:121]
    v_cvt_pk_bf16_f32 v153, v134, v135
    v_pk_add_f32 v[116:117], v[116:117], v[128:129]
    v_pk_mul_f32 v[136:137], v[116:117], v[120:121]
    v_cvt_pk_bf16_f32 v154, v136, v137
    v_pk_add_f32 v[118:119], v[118:119], v[128:129]
    v_pk_mul_f32 v[138:139], v[118:119], v[120:121]
    v_cvt_pk_bf16_f32 v155, v138, v139
    s_mov_b32 exec_hi, 0
    buffer_store_dwordx4 v[152:155], v243, s[24:27], s43 offen sc1
    s_mov_b64 exec, -1
    s_branch pg_start
    .p2align 12
pg_0:
    s_cbranch_execz pg_ret
pg_start:
    s_waitcnt vmcnt(10)
    v_readfirstlane_b32 s7, v26
    v_cvt_pk_bf16_f32 v64, v96, v97
    v_lshlrev_b32 v96, 16, v64
    v_and_b32 v97, 0xffff0000, v64
    v_pk_mul_f32 v[96:97], v[96:97], v[130:131]
    v_cvt_pk_bf16_f32 v64, v96, v97
    v_lshlrev_b32 v96, 16, v64
    v_and_b32 v97, 0xffff0000, v64
    v_lshlrev_b32 v132, 16, v76
    v_and_b32 v133, 0xffff0000, v76
    v_pk_mul_f32 v[120:121], v[96:97], v[132:133]
    s_add_u32 m0, s49, 73728
    s_nop 0
    buffer_load_dwordx4 v2, s[8:11], s36 offen offset:0 lds
    s_add_u32 m0, s49, 74624
    s_nop 0
    buffer_load_dwordx4 v2, s[8:11], s36 offen offset:128 lds
    v_cvt_pk_bf16_f32 v65, v98, v99
    v_lshlrev_b32 v98, 16, v65
    v_and_b32 v99, 0xffff0000, v65
    v_pk_mul_f32 v[98:99], v[98:99], v[130:131]
    v_cvt_pk_bf16_f32 v65, v98, v99
    v_lshlrev_b32 v98, 16, v65
    v_and_b32 v99, 0xffff0000, v65
    v_lshlrev_b32 v134, 16, v77
    v_and_b32 v135, 0xffff0000, v77
    v_pk_mul_f32 v[122:123], v[98:99], v[134:135]
    s_add_u32 m0, s49, 75520
    s_nop 0
    buffer_load_dwordx4 v2, s[8:11], s36 offen offset:256 lds
    s_add_u32 m0, s49, 76800
    s_nop 0
    buffer_load_dwordx4 v3, s[8:11], s36 offen offset:0 lds
    v_cvt_pk_bf16_f32 v66, v100, v101
    v_lshlrev_b32 v100, 16, v66
    v_and_b32 v101, 0xffff0000, v66
    v_pk_mul_f32 v[100:101], v[100:101], v[130:131]
    v_cvt_pk_bf16_f32 v66, v100, v101
    v_lshlrev_b32 v100, 16, v66
    v_and_b32 v101, 0xffff0000, v66
    v_lshlrev_b32 v136, 16, v78
    v_and_b32 v137, 0xffff0000, v78
    v_pk_fma_f32 v[120:121], v[100:101], v[136:137], v[120:121]
    s_add_u32 m0, s49, 77696
    s_nop 0
    buffer_load_dwordx4 v3, s[8:11], s36 offen offset:128 lds
    s_add_u32 m0, s49, 78592
    s_nop 0
    buffer_load_dwordx4 v3, s[8:11], s36 offen offset:256 lds
    s_add_u32 s36, s36, s37
    s_sub_u32 s55, s36, 7864320
    s_min_u32 s36, s36, s55
    s_waitcnt vmcnt(6) lgkmcnt(0)
    s_lshr_b32 s7, s7, 4
    s_mul_i32 s7, s7, 0x2c9277b5
    s_add_u32 s7, s7, 0x6c564b05
    s_lshl_b32 s7, s7, 4
    s_barrier
    v_mov_b32 v21, s7
    s_mov_b64 exec, 255
    buffer_store_dword v21, v20, s[24:27], s6 offen sc1
    s_mov_b64 exec, 0x11
    v_lshlrev_b32 v29, 3, v240
    s_mov_b32 s56, 3211264
    buffer_store_dwordx2 v[126:127], v29, s[24:27], s56 offen sc1
    s_mov_b64 exec, -1
    v_cvt_pk_bf16_f32 v67, v102, v103
    v_lshlrev_b32 v102, 16, v67
    v_and_b32 v103, 0xffff0000, v67
    v_pk_mul_f32 v[102:103], v[102:103], v[130:131]
    v_cvt_pk_bf16_f32 v67, v102, v103
    v_lshlrev_b32 v102, 16, v67
    v_and_b32 v103, 0xffff0000, v67
    v_lshlrev_b32 v138, 16, v79
    v_and_b32 v139, 0xffff0000, v79
    v_pk_fma_f32 v[122:123], v[102:103], v[138:139], v[122:123]
    s_add_u32 m0, s49, 98304
    s_nop 0
    buffer_load_dwordx4 v2, s[8:11], s36 offen offset:0 lds
    s_add_u32 m0, s49, 99200
    s_nop 0
    buffer_load_dwordx4 v2, s[8:11], s36 offen offset:128 lds
    v_cvt_pk_bf16_f32 v68, v104, v105
    v_lshlrev_b32 v104, 16, v68
    v_and_b32 v105, 0xffff0000, v68
    v_pk_mul_f32 v[104:105], v[104:105], v[130:131]
    v_cvt_pk_bf16_f32 v68, v104, v105
    v_lshlrev_b32 v104, 16, v68
    v_and_b32 v105, 0xffff0000, v68
    v_lshlrev_b32 v132, 16, v80
    v_and_b32 v133, 0xffff0000, v80
    v_pk_fma_f32 v[120:121], v[104:105], v[132:133], v[120:121]
    s_add_u32 m0, s49, 100096
    s_nop 0
    buffer_load_dwordx4 v2, s[8:11], s36 offen offset:256 lds
    s_add_u32 m0, s49, 101376
    s_nop 0
    buffer_load_dwordx4 v3, s[8:11], s36 offen offset:0 lds
    s_waitcnt lgkmcnt(0)
    s_mov_b32 s63, -1
    s_load_dword s4, s[86:87], s58 offset:0x2000 glc
    s_load_dword s63, s[86:87], s58 glc
    s_waitcnt lgkmcnt(1)
    v_cvt_pk_bf16_f32 v69, v106, v107
    v_lshlrev_b32 v106, 16, v69
    v_and_b32 v107, 0xffff0000, v69
    v_pk_mul_f32 v[106:107], v[106:107], v[130:131]
    v_cvt_pk_bf16_f32 v69, v106, v107
    v_lshlrev_b32 v106, 16, v69
    v_and_b32 v107, 0xffff0000, v69
    v_lshlrev_b32 v134, 16, v81
    v_and_b32 v135, 0xffff0000, v81
    v_pk_fma_f32 v[122:123], v[106:107], v[134:135], v[122:123]
    s_and_b32 s93, s63, 0x2000
    s_add_u32 s46, s46, s93
    s_getreg_b32 s61, hwreg(HW_REG_XCC_ID, 2, 1)
    s_mul_i32 s61, s61, 0x6000
    s_lshl_b32 s93, s93, 1
    s_xor_b32 s93, s93, s61
    s_add_u32 m0, s49, 102272
    s_nop 0
    buffer_load_dwordx4 v3, s[8:11], s36 offen offset:128 lds
    s_add_u32 m0, s49, 103168
    s_nop 0
    buffer_load_dwordx4 v3, s[8:11], s36 offen offset:256 lds
    s_add_u32 s36, s36, s37
    s_sub_u32 s55, s36, 7864320
    s_min_u32 s36, s36, s55
    s_mov_b64 exec, -1
    s_add_u32 m0, s49, 122880
    s_nop 0
    buffer_load_dwordx4 v2, s[8:11], s36 offen offset:0 lds
    s_add_u32 m0, s49, 123776
    s_nop 0
    buffer_load_dwordx4 v2, s[8:11], s36 offen offset:128 lds
    s_add_u32 m0, s49, 124672
    s_nop 0
    buffer_load_dwordx4 v2, s[8:11], s36 offen offset:256 lds
    s_add_u32 m0, s49, 125952
    s_nop 0
    buffer_load_dwordx4 v3, s[8:11], s36 offen offset:0 lds
    s_add_u32 m0, s49, 126848
    s_nop 0
    buffer_load_dwordx4 v3, s[8:11], s36 offen offset:128 lds
    s_add_u32 m0, s49, 127744
    s_nop 0
    buffer_load_dwordx4 v3, s[8:11], s36 offen offset:256 lds
    s_add_u32 s36, s36, s37
    s_sub_u32 s55, s36, 7864320
    s_min_u32 s36, s36, s55
    s_mov_b64 exec, 0
    s_cmp_eq_u32 s3, 0
    s_cbranch_scc1 pg_4
    s_cmp_eq_u32 s3, 1
    s_cbranch_scc1 pg_5
    s_cmp_eq_u32 s3, 2
    s_cbranch_scc1 pg_6
    s_cmp_eq_u32 s3, 3
    s_cbranch_scc1 pg_7
pg_ret2:
    s_mov_b64 exec, -1
    ds_read_b64_tr_b16 a[192:193], v8 offset:0
    ds_read_b64_tr_b16 a[194:195], v8 offset:6144
    ds_read_b64_tr_b16 a[196:197], v9 offset:0
    ds_read_b64_tr_b16 a[198:199], v9 offset:6144
    ds_read_b64_tr_b16 a[200:201], v10 offset:0
    ds_read_b64_tr_b16 a[202:203], v10 offset:6144
    ds_read_b64_tr_b16 a[204:205], v11 offset:0
    ds_read_b64_tr_b16 a[206:207], v11 offset:6144
spin_ln:
    s_load_dwordx8 s[28:35], s[86:87], s46 glc
    s_add_u32 s101, s101, 1
    s_cmp_gt_u32 s101, 0x2000000
    s_cselect_b32 s57, 0, -1
    s_waitcnt lgkmcnt(0)
    s_xor_b32 s56, s28, s7
    s_xor_b32 s29, s29, s7
    s_or_b32 s56, s56, s29
    s_xor_b32 s30, s30, s7
    s_or_b32 s56, s56, s30
    s_xor_b32 s31, s31, s7
    s_or_b32 s56, s56, s31
    s_xor_b32 s32, s32, s7
    s_or_b32 s56, s56, s32
    s_xor_b32 s33, s33, s7
    s_or_b32 s56, s56, s33
    s_xor_b32 s34, s34, s7
    s_or_b32 s56, s56, s34
    s_xor_b32 s35, s35, s7
    s_or_b32 s56, s56, s35
    s_and_b32 s56, s56, s57
    s_cbranch_scc1 spin_ln
z_skip:
    s_add_u32 s46, s45, 0
    s_sub_u32 s5, s46, 81920
    s_min_u32 s46, s46, s5
    buffer_load_dwordx4 a[0:3], v28, s[20:23], s46 offen offset:0 sc1
    buffer_load_dwordx4 a[4:7], v28, s[20:23], s46 offen offset:1024 sc1
    buffer_load_dwordx4 a[8:11], v28, s[20:23], s46 offen offset:2048 sc1
    buffer_load_dwordx4 a[12:15], v28, s[20:23], s46 offen offset:3072 sc1
    s_add_u32 s46, s45, 4096
    s_sub_u32 s5, s46, 81920
    s_min_u32 s46, s46, s5
    buffer_load_dwordx4 a[16:19], v28, s[20:23], s46 offen offset:0 sc1
    buffer_load_dwordx4 a[20:23], v28, s[20:23], s46 offen offset:1024 sc1
    buffer_load_dwordx4 a[24:27], v28, s[20:23], s46 offen offset:2048 sc1
    buffer_load_dwordx4 a[28:31], v28, s[20:23], s46 offen offset:3072 sc1
    v_cvt_pk_bf16_f32 v70, v108, v109
    v_lshlrev_b32 v108, 16, v70
    v_and_b32 v109, 0xffff0000, v70
    v_pk_mul_f32 v[108:109], v[108:109], v[130:131]
    v_cvt_pk_bf16_f32 v70, v108, v109
    v_lshlrev_b32 v108, 16, v70
    v_and_b32 v109, 0xffff0000, v70
    v_lshlrev_b32 v136, 16, v82
    v_and_b32 v137, 0xffff0000, v82
    v_pk_fma_f32 v[120:121], v[108:109], v[136:137], v[120:121]
    v_cvt_pk_bf16_f32 v71, v110, v111
    v_lshlrev_b32 v110, 16, v71
    v_and_b32 v111, 0xffff0000, v71
    v_pk_mul_f32 v[110:111], v[110:111], v[130:131]
    v_cvt_pk_bf16_f32 v71, v110, v111
    v_lshlrev_b32 v110, 16, v71
    v_and_b32 v111, 0xffff0000, v71
    v_lshlrev_b32 v138, 16, v83
    v_and_b32 v139, 0xffff0000, v83
    v_pk_fma_f32 v[122:123], v[110:111], v[138:139], v[122:123]
    s_mov_b32 exec_hi, 0
    v_cvt_pk_bf16_f32 v72, v112, v113
    v_lshlrev_b32 v112, 16, v72
    v_and_b32 v113, 0xffff0000, v72
    v_pk_mul_f32 v[112:113], v[112:113], v[130:131]
    v_cvt_pk_bf16_f32 v72, v112, v113
    v_lshlrev_b32 v112, 16, v72
    v_and_b32 v113, 0xffff0000, v72
    v_lshlrev_b32 v132, 16, v84
    v_and_b32 v133, 0xffff0000, v84
    v_pk_fma_f32 v[120:121], v[112:113], v[132:133], v[120:121]
    v_cvt_pk_bf16_f32 v73, v114, v115
    v_lshlrev_b32 v114, 16, v73
    v_and_b32 v115, 0xffff0000, v73
    v_pk_mul_f32 v[114:115], v[114:115], v[130:131]
    v_cvt_pk_bf16_f32 v73, v114, v115
    v_lshlrev_b32 v114, 16, v73
    v_and_b32 v115, 0xffff0000, v73
    v_lshlrev_b32 v134, 16, v85
    v_and_b32 v135, 0xffff0000, v85
    v_pk_fma_f32 v[122:123], v[114:115], v[134:135], v[122:123]
    v_cvt_pk_bf16_f32 v74, v116, v117
    v_lshlrev_b32 v116, 16, v74
    v_and_b32 v117, 0xffff0000, v74
    v_pk_mul_f32 v[116:117], v[116:117], v[130:131]
    v_cvt_pk_bf16_f32 v74, v116, v117
    v_lshlrev_b32 v116, 16, v74
    v_and_b32 v117, 0xffff0000, v74
    v_lshlrev_b32 v136, 16, v86
    v_and_b32 v137, 0xffff0000, v86
    v_pk_fma_f32 v[120:121], v[116:117], v[136:137], v[120:121]
    v_cvt_pk_bf16_f32 v75, v118, v119
    v_lshlrev_b32 v118, 16, v75
    v_and_b32 v119, 0xffff0000, v75
    v_pk_mul_f32 v[118:119], v[118:119], v[130:131]
    v_cvt_pk_bf16_f32 v75, v118, v119
    v_lshlrev_b32 v118, 16, v75
    v_and_b32 v119, 0xffff0000, v75
    v_lshlrev_b32 v138, 16, v87
    v_and_b32 v139, 0xffff0000, v87
    v_pk_fma_f32 v[122:123], v[118:119], v[138:139], v[122:123]
    s_mov_b64 exec, -1
    v_pk_add_f32 v[120:121], v[120:121], v[122:123]
    v_add_f32 v120, v120, v121
    s_nop 1
    v_add_f32_dpp v120, v120, v120 quad_perm:[1,0,3,2] row_mask:0xf bank_mask:0xf
    s_nop 1
    v_add_f32_dpp v120, v120, v120 quad_perm:[2,3,0,1] row_mask:0xf bank_mask:0xf
    s_nop 1
    v_add_f32_dpp v120, v120, v120 row_ror:8 row_mask:0xf bank_mask:0xf
    v_mov_b32 v124, v120
    s_nop 1
    v_permlane16_swap_b32 v120, v124
    s_nop 1
    v_add_f32 v120, v120, v124
    v_mov_b32 v124, v120
    s_nop 1
    v_permlane32_swap_b32 v120, v124
    s_nop 1
    v_add_f32 v120, v120, v124
    v_cvt_pk_bf16_f32 v120, v120, v120
    v_and_b32 v120, 0xffff0000, v120
    v_ashrrev_i32 v122, 31, v120
    v_or_b32 v122, 0x80000000, v122
    v_xor_b32 v120, v120, v122
    v_and_b32 v120, 0xffff0000, v120
    v_sub_u32 v122, 2047, v240
    v_or_b32 v120, v120, v122
    s_nop 1
    v_mov_b32_dpp v121, v120 row_ror:4 row_mask:0xf bank_mask:0xf
    v_mov_b32 v122, s7
    v_mov_b32 v123, s93
    s_lshl_b32 s56, s2, 2
    s_add_u32 s56, s56, s3
    s_lshl_b32 s56, s56, 4
    s_add_u32 s56, s56, 3162112
    v_mov_b32 v29, 0
    s_mov_b64 s[74:75], s[66:67]
    s_mul_i32 s57, s50, 786432
    s_add_u32 s57, s57, 688128
    s_cmp_eq_u32 s3, 1
    s_cselect_b64 s[74:75], s[68:69], s[74:75]
    s_cmp_eq_u32 s3, 2
    s_cselect_b64 s[74:75], s[78:79], s[74:75]
    s_cselect_b32 s57, 0, s57
    s_cmp_eq_u32 s3, 3
    s_cselect_b64 s[74:75], s[80:81], s[74:75]
    s_cselect_b32 s57, 0, s57
    s_load_dword s76, s[74:75], s57
    s_mov_b64 s[74:75], s[72:73]
    s_mul_i32 s57, s50, 245760
    s_cmp_eq_u32 s3, 1
    s_cselect_b64 s[74:75], s[82:83], s[74:75]
    s_cselect_b32 s57, 0, s57
    s_mul_i32 s77, s2, 10240
    s_cmp_eq_u32 s3, 2
    s_cselect_b64 s[74:75], s[84:85], s[74:75]
    s_cselect_b32 s57, s77, s57
    s_lshr_b32 s77, s2, 3
    s_lshl_b32 s77, s77, 22
    s_add_u32 s77, s77, 67563520
    s_cmp_eq_u32 s3, 3
    s_cselect_b64 s[74:75], s[86:87], s[74:75]
    s_cselect_b32 s57, s77, s57
    s_load_dword s76, s[74:75], s57
    s_waitcnt vmcnt(4)
    s_mov_b64 exec, 1
    s_waitcnt vmcnt(20)
    buffer_store_dwordx4 v[120:123], v29, s[24:27], s56 offen sc1
    s_mov_b64 exec, -1
head_code:
    v_mfma_f32_16x16x32_bf16 v[64:67], a[192:195], a[0:3], 0
    s_add_u32 s46, s45, 8192
    ds_read_b64_tr_b16 a[208:209], v8 offset:1024
    s_sub_u32 s77, s46, 81920
    v_mfma_f32_16x16x32_bf16 v[68:71], a[196:199], a[0:3], 0
    s_min_u32 s46, s46, s77
    ds_read_b64_tr_b16 a[210:211], v8 offset:7168
    v_mfma_f32_16x16x32_bf16 v[76:79], a[196:199], a[4:7], 0
    buffer_load_dwordx4 a[32:35], v28, s[20:23], s46 offen offset:0 sc1
    v_mfma_f32_16x16x32_bf16 v[72:75], a[192:195], a[4:7], 0
    v_mfma_f32_16x16x32_bf16 v[80:83], a[192:195], a[8:11], 0
    ds_read_b64_tr_b16 a[212:213], v9 offset:1024
    v_mfma_f32_16x16x32_bf16 v[84:87], a[196:199], a[8:11], 0
    ds_read_b64_tr_b16 a[214:215], v9 offset:7168
    v_mfma_f32_16x16x32_bf16 v[92:95], a[196:199], a[12:15], 0
    v_mfma_f32_16x16x32_bf16 v[88:91], a[192:195], a[12:15], 0
    s_waitcnt lgkmcnt(4)
    v_mfma_f32_16x16x32_bf16 v[120:123], a[200:203], a[12:15], 0
    ds_read_b64_tr_b16 a[192:193], v10 offset:1024
    v_mul_u32_u24 v56, 3072, v5
    v_mfma_f32_16x16x32_bf16 v[124:127], a[204:207], a[12:15], 0
    ds_read_b64_tr_b16 a[194:195], v10 offset:7168
    v_add_u32 v56, v56, v7
    v_mfma_f32_16x16x32_bf16 v[116:119], a[204:207], a[8:11], 0
    buffer_load_dwordx4 a[36:39], v28, s[20:23], s46 offen offset:1024 sc1
    v_mfma_f32_16x16x32_bf16 v[112:115], a[200:203], a[8:11], 0
    v_add_u32 v57, 49152, v56
    v_lshrrev_b32 v29, 3, v1
    v_mfma_f32_16x16x32_bf16 v[104:107], a[200:203], a[4:7], 0
    ds_read_b64_tr_b16 a[196:197], v11 offset:1024
    v_mul_u32_u24 v62, 1280, v29
    v_mfma_f32_16x16x32_bf16 v[108:111], a[204:207], a[4:7], 0
    ds_read_b64_tr_b16 a[198:199], v11 offset:7168
    v_add_u32 v62, v62, v7
    v_mfma_f32_16x16x32_bf16 v[100:103], a[204:207], a[0:3], 0
    v_add_u32 v63, 10240, v62
    v_mul_u32_u24 v31, 384, v29
    v_mfma_f32_16x16x32_bf16 v[96:99], a[200:203], a[0:3], 0
    s_waitcnt lgkmcnt(4)
    v_add_u32 v6, v31, v7
    v_add_u32 v7, 3072, v6
    v_mfma_f32_16x16x32_bf16 v[128:131], a[208:211], a[0:3], 0
    ds_read_b64_tr_b16 a[200:201], v8 offset:2048
    v_bfe_u32 v29, v1, 4, 1
    v_mfma_f32_16x16x32_bf16 v[132:135], a[212:215], a[0:3], 0
    ds_read_b64_tr_b16 a[202:203], v8 offset:8192
    v_bfe_u32 v30, v1, 5, 1
    v_mfma_f32_16x16x32_bf16 v[140:143], a[212:215], a[4:7], 0
    buffer_load_dwordx4 a[40:43], v28, s[20:23], s46 offen offset:2048 sc1
    v_mfma_f32_16x16x32_bf16 v[136:139], a[208:211], a[4:7], 0
    v_lshl_add_u32 v29, v29, 1, v30
    v_and_b32 v30, 7, v1
    v_mfma_f32_16x16x32_bf16 v[144:147], a[208:211], a[8:11], 0
    ds_read_b64_tr_b16 a[204:205], v9 offset:2048
    v_xor_b32 v30, v30, v29
    v_mfma_f32_16x16x32_bf16 v[148:151], a[212:215], a[8:11], 0
    ds_read_b64_tr_b16 a[206:207], v9 offset:8192
    v_lshl_add_u32 v4, v30, 4, v31
    v_mfma_f32_16x16x32_bf16 v[156:159], a[212:215], a[12:15], 0
    buffer_load_dwordx4 a[44:47], v28, s[20:23], s46 offen offset:3072 sc1
    v_mfma_f32_16x16x32_bf16 v[152:155], a[208:211], a[12:15], 0
    s_waitcnt lgkmcnt(4)
    v_xor_b32 v30, 4, v30
    v_lshl_add_u32 v5, v30, 4, v31
    v_mfma_f32_16x16x32_bf16 v[184:187], a[192:195], a[12:15], 0
    s_add_u32 s46, s45, 12288
    ds_read_b64_tr_b16 a[208:209], v10 offset:2048
    v_add_u32 v5, 3072, v5
    v_mfma_f32_16x16x32_bf16 v[188:191], a[196:199], a[12:15], 0
    s_sub_u32 s77, s46, 81920
    ds_read_b64_tr_b16 a[210:211], v10 offset:8192
    v_bfe_u32 v30, v1, 1, 1
    v_mfma_f32_16x16x32_bf16 v[180:183], a[196:199], a[8:11], 0
    s_min_u32 s46, s46, s77
    v_bfe_u32 v31, v1, 2, 1
    v_lshl_add_u32 v30, v30, 1, v31
    v_mfma_f32_16x16x32_bf16 v[176:179], a[192:195], a[8:11], 0
    v_bfe_u32 v31, v1, 3, 1
    v_lshl_add_u32 v30, v31, 2, v30
    v_mfma_f32_16x16x32_bf16 v[168:171], a[192:195], a[4:7], 0
    ds_read_b64_tr_b16 a[212:213], v11 offset:2048
    v_xor_b32 v30, v30, v29
    v_mfma_f32_16x16x32_bf16 v[172:175], a[196:199], a[4:7], 0
    ds_read_b64_tr_b16 a[214:215], v11 offset:8192
    v_lshlrev_b32 v30, 4, v30
    v_mfma_f32_16x16x32_bf16 v[164:167], a[196:199], a[0:3], 0
    buffer_load_dwordx4 a[48:51], v28, s[20:23], s46 offen offset:0 sc1
    v_mfma_f32_16x16x32_bf16 v[160:163], a[192:195], a[0:3], 0
    s_waitcnt lgkmcnt(4)
    v_mul_u32_u24 v31, 3072, v31
    v_and_b32 v29, 7, v1
    v_mfma_f32_16x16x32_bf16 v[192:195], a[200:203], a[0:3], 0
    ds_read_b64_tr_b16 a[192:193], v8 offset:12288
    v_lshl_add_u32 v31, v29, 7, v31
    v_mfma_f32_16x16x32_bf16 v[196:199], a[204:207], a[0:3], 0
    ds_read_b64_tr_b16 a[194:195], v8 offset:18432
    v_subrev_u32 v31, s49, v31
    v_mfma_f32_16x16x32_bf16 v[204:207], a[204:207], a[4:7], 0
    buffer_load_dwordx4 a[52:55], v28, s[20:23], s46 offen offset:1024 sc1
    v_mfma_f32_16x16x32_bf16 v[200:203], a[200:203], a[4:7], 0
    v_add_u32 v18, v31, v30
    v_xor_b32 v30, 64, v30
    v_mfma_f32_16x16x32_bf16 v[208:211], a[200:203], a[8:11], 0
    ds_read_b64_tr_b16 a[196:197], v9 offset:12288
    v_add_u32 v19, v31, v30
    v_mfma_f32_16x16x32_bf16 v[212:215], a[204:207], a[8:11], 0
    s_mul_i32 s56, s50, 786432
    ds_read_b64_tr_b16 a[198:199], v9 offset:18432
    s_add_u32 s56, s56, 589824
    v_mfma_f32_16x16x32_bf16 v[220:223], a[204:207], a[12:15], 0
    s_add_u32 s12, s66, s56
    s_addc_u32 s13, s67, 0
    s_and_b32 s13, s13, 0xffff
    v_mfma_f32_16x16x32_bf16 v[216:219], a[200:203], a[12:15], 0
    s_waitcnt lgkmcnt(4)
    s_mov_b32 s14, 196608
    s_mov_b32 s15, 0x00020000
    v_mfma_f32_16x16x32_bf16 v[248:251], a[208:211], a[12:15], 0
    s_add_u32 s16, s68, s56
    s_addc_u32 s17, s69, 0
    ds_read_b64_tr_b16 a[200:201], v10 offset:12288
    v_mfma_f32_16x16x32_bf16 v[252:255], a[212:215], a[12:15], 0
    s_and_b32 s17, s17, 0xffff
    ds_read_b64_tr_b16 a[202:203], v10 offset:18432
    s_mov_b32 s18, 196608
    v_mfma_f32_16x16x32_bf16 v[244:247], a[212:215], a[8:11], 0
    buffer_load_dwordx4 a[56:59], v28, s[20:23], s46 offen offset:2048 sc1
    v_mfma_f32_16x16x32_bf16 v[240:243], a[208:211], a[8:11], 0
    s_mov_b32 s19, 0x00020000
    s_mov_b32 s28, s78
    s_and_b32 s29, s79, 0xffff
    v_mfma_f32_16x16x32_bf16 v[232:235], a[208:211], a[4:7], 0
    s_mov_b32 s30, 1966080
    ds_read_b64_tr_b16 a[204:205], v11 offset:12288
    s_mov_b32 s31, 0x00020000
    v_mfma_f32_16x16x32_bf16 v[236:239], a[212:215], a[4:7], 0
    s_waitcnt vmcnt(8)
    ds_read_b64_tr_b16 a[206:207], v11 offset:18432
    s_mov_b32 s32, s80
    v_mfma_f32_16x16x32_bf16 v[228:231], a[212:215], a[0:3], 0
    s_and_b32 s33, s81, 0xffff
    s_mov_b32 s34, 1966080
    s_mov_b32 s35, 0x00020000
    v_mfma_f32_16x16x32_bf16 v[224:227], a[208:211], a[0:3], 0
    s_waitcnt lgkmcnt(4)
    s_mov_b32 s5, s58
    s_min_u32 s58, s2, 239
    v_mfma_f32_16x16x32_bf16 v[64:67], a[192:195], a[16:19], v[64:67]
    s_mul_hi_u32 s56, s58, 178956971
    ds_read_b64_tr_b16 a[208:209], v8 offset:13312
    s_mul_i32 s57, s56, 24
    v_mfma_f32_16x16x32_bf16 v[68:71], a[196:199], a[16:19], v[68:71]
    s_sub_u32 s57, s58, s57
    ds_read_b64_tr_b16 a[210:211], v8 offset:19456
    s_lshl_b32 s60, s56, 6
    v_mfma_f32_16x16x32_bf16 v[76:79], a[196:199], a[20:23], v[76:79]
    buffer_load_dwordx4 a[60:63], v28, s[20:23], s46 offen offset:3072 sc1
    v_mfma_f32_16x16x32_bf16 v[72:75], a[192:195], a[20:23], v[72:75]
    s_add_u32 s46, s45, 16384
    s_sub_u32 s77, s46, 81920
    s_min_u32 s46, s46, s77
    v_mfma_f32_16x16x32_bf16 v[80:83], a[192:195], a[24:27], v[80:83]
    s_add_u32 s60, s60, s59
    ds_read_b64_tr_b16 a[212:213], v9 offset:13312
    s_mul_i32 s60, s60, 3072
    v_mfma_f32_16x16x32_bf16 v[84:87], a[196:199], a[24:27], v[84:87]
    s_lshl_b32 s44, s57, 7
    ds_read_b64_tr_b16 a[214:215], v9 offset:19456
    s_add_u32 s60, s60, s44
    v_mfma_f32_16x16x32_bf16 v[92:95], a[196:199], a[28:31], v[92:95]
    buffer_load_dwordx4 a[64:67], v28, s[20:23], s46 offen offset:0 sc1
    v_mfma_f32_16x16x32_bf16 v[88:91], a[192:195], a[28:31], v[88:91]
    s_waitcnt lgkmcnt(4)
    s_lshl_b32 s61, s56, 7
    s_mul_i32 s62, s56, 1536
    v_mfma_f32_16x16x32_bf16 v[120:123], a[200:203], a[28:31], v[120:123]
    s_lshl_b32 s44, s57, 6
    ds_read_b64_tr_b16 a[192:193], v10 offset:13312
    s_add_u32 s62, s62, s44
    v_mfma_f32_16x16x32_bf16 v[124:127], a[204:207], a[28:31], v[124:127]
    s_lshl_b32 s44, s3, 4
    ds_read_b64_tr_b16 a[194:195], v10 offset:19456
    s_add_u32 s62, s62, s44
    v_mfma_f32_16x16x32_bf16 v[116:119], a[204:207], a[24:27], v[116:119]
    s_lshl_b32 s62, s62, 4
    s_add_u32 s62, s62, 3276800
    s_lshl_b32 s4, s2, 8
    v_mfma_f32_16x16x32_bf16 v[112:115], a[200:203], a[24:27], v[112:115]
    s_lshl_b32 s44, s3, 2
    s_add_u32 s4, s4, s44
    s_add_u32 s4, s4, 4718592
    v_mfma_f32_16x16x32_bf16 v[104:107], a[200:203], a[20:23], v[104:107]
    s_mov_b32 s92, 0xbfb8aa3b
    ds_read_b64_tr_b16 a[196:197], v11 offset:13312
    s_lshl_b32 s44, s3, 12
    v_mfma_f32_16x16x32_bf16 v[108:111], a[204:207], a[20:23], v[108:111]
    s_mov_b32 s38, s49
    ds_read_b64_tr_b16 a[198:199], v11 offset:19456
    s_mov_b32 s40, s49
    v_mfma_f32_16x16x32_bf16 v[100:103], a[204:207], a[16:19], v[100:103]
    buffer_load_dwordx4 a[68:71], v28, s[20:23], s46 offen offset:1024 sc1
    v_mfma_f32_16x16x32_bf16 v[96:99], a[200:203], a[16:19], v[96:99]
    s_waitcnt lgkmcnt(4)
    s_mov_b32 s39, 24576
    s_mov_b32 s47, 3162112
    v_mfma_f32_16x16x32_bf16 v[128:131], a[208:211], a[16:19], v[128:131]
    s_mov_b32 s88, 0xaaaaaaaa
    ds_read_b64_tr_b16 a[200:201], v8 offset:14336
    s_mov_b32 s89, 0xaaaaaaaa
    v_mfma_f32_16x16x32_bf16 v[132:135], a[212:215], a[16:19], v[132:135]
    ds_read_b64_tr_b16 a[202:203], v8 offset:20480
    v_mfma_f32_16x16x32_bf16 v[140:143], a[212:215], a[20:23], v[140:143]
    v_add_u32 v8, 73728, v12
    v_mfma_f32_16x16x32_bf16 v[136:139], a[208:211], a[20:23], v[136:139]
    buffer_load_dwordx4 a[72:75], v28, s[20:23], s46 offen offset:2048 sc1
    v_mfma_f32_16x16x32_bf16 v[144:147], a[208:211], a[24:27], v[144:147]
    ds_read_b64_tr_b16 a[204:205], v9 offset:14336
    v_mfma_f32_16x16x32_bf16 v[148:151], a[212:215], a[24:27], v[148:151]
    ds_read_b64_tr_b16 a[206:207], v9 offset:20480
    v_mfma_f32_16x16x32_bf16 v[156:159], a[212:215], a[28:31], v[156:159]
    v_add_u32 v9, 73728, v13
    v_mfma_f32_16x16x32_bf16 v[152:155], a[208:211], a[28:31], v[152:155]
    s_waitcnt lgkmcnt(4)
    v_mfma_f32_16x16x32_bf16 v[184:187], a[192:195], a[28:31], v[184:187]
    ds_read_b64_tr_b16 a[208:209], v10 offset:14336
    v_mfma_f32_16x16x32_bf16 v[188:191], a[196:199], a[28:31], v[188:191]
    ds_read_b64_tr_b16 a[210:211], v10 offset:20480
    v_mfma_f32_16x16x32_bf16 v[180:183], a[196:199], a[24:27], v[180:183]
    buffer_load_dwordx4 a[76:79], v28, s[20:23], s46 offen offset:3072 sc1
    v_mfma_f32_16x16x32_bf16 v[176:179], a[192:195], a[24:27], v[176:179]
    v_add_u32 v10, 73728, v14
    v_mfma_f32_16x16x32_bf16 v[168:171], a[192:195], a[20:23], v[168:171]
    s_add_u32 s46, s45, 20480
    ds_read_b64_tr_b16 a[212:213], v11 offset:14336
    s_sub_u32 s77, s46, 81920
    v_mfma_f32_16x16x32_bf16 v[172:175], a[196:199], a[20:23], v[172:175]
    s_waitcnt vmcnt(35)
    ds_read_b64_tr_b16 a[214:215], v11 offset:20480
    s_min_u32 s46, s46, s77
    v_mfma_f32_16x16x32_bf16 v[164:167], a[196:199], a[16:19], v[164:167]
    s_barrier
    v_mfma_f32_16x16x32_bf16 v[160:163], a[192:195], a[16:19], v[160:163]
    s_waitcnt lgkmcnt(4)
    v_add_u32 v11, 73728, v15
    v_mfma_f32_16x16x32_bf16 v[192:195], a[200:203], a[16:19], v[192:195]
    ds_read_b64_tr_b16 a[192:193], v8 offset:0
    v_mfma_f32_16x16x32_bf16 v[196:199], a[204:207], a[16:19], v[196:199]
    ds_read_b64_tr_b16 a[194:195], v8 offset:6144
    v_mfma_f32_16x16x32_bf16 v[204:207], a[204:207], a[20:23], v[204:207]
    buffer_load_dwordx4 a[80:83], v28, s[20:23], s46 offen offset:0 sc1
    v_mfma_f32_16x16x32_bf16 v[200:203], a[200:203], a[20:23], v[200:203]
    v_mfma_f32_16x16x32_bf16 v[208:211], a[200:203], a[24:27], v[208:211]
    ds_read_b64_tr_b16 a[196:197], v8 offset:12288
    v_mfma_f32_16x16x32_bf16 v[212:215], a[204:207], a[24:27], v[212:215]
    ds_read_b64_tr_b16 a[198:199], v8 offset:18432
    v_mfma_f32_16x16x32_bf16 v[220:223], a[204:207], a[28:31], v[220:223]
    buffer_load_dwordx4 a[84:87], v28, s[20:23], s46 offen offset:1024 sc1
    v_mfma_f32_16x16x32_bf16 v[216:219], a[200:203], a[28:31], v[216:219]
    s_waitcnt lgkmcnt(4)
    v_mfma_f32_16x16x32_bf16 v[248:251], a[208:211], a[28:31], v[248:251]
    ds_read_b64_tr_b16 a[200:201], v9 offset:0
    v_mfma_f32_16x16x32_bf16 v[252:255], a[212:215], a[28:31], v[252:255]
    ds_read_b64_tr_b16 a[202:203], v9 offset:6144
    v_mfma_f32_16x16x32_bf16 v[244:247], a[212:215], a[24:27], v[244:247]
    v_mfma_f32_16x16x32_bf16 v[240:243], a[208:211], a[24:27], v[240:243]
    v_mfma_f32_16x16x32_bf16 v[232:235], a[208:211], a[20:23], v[232:235]
    ds_read_b64_tr_b16 a[204:205], v9 offset:12288
    v_mfma_f32_16x16x32_bf16 v[236:239], a[212:215], a[20:23], v[236:239]
    s_waitcnt vmcnt(10)
    s_waitcnt vmcnt(6)
    ds_read_b64_tr_b16 a[206:207], v9 offset:18432
    v_mfma_f32_16x16x32_bf16 v[228:231], a[212:215], a[16:19], v[228:231]
    buffer_load_dwordx4 a[88:91], v28, s[20:23], s46 offen offset:2048 sc1
    v_mfma_f32_16x16x32_bf16 v[224:227], a[208:211], a[16:19], v[224:227]
    s_waitcnt lgkmcnt(4)
    v_mfma_f32_16x16x32_bf16 v[64:67], a[192:195], a[32:35], v[64:67]
    ds_read_b64_tr_b16 a[208:209], v10 offset:0
    v_mfma_f32_16x16x32_bf16 v[64:67], a[196:199], a[48:51], v[64:67]
    ds_read_b64_tr_b16 a[210:211], v10 offset:6144
    v_mfma_f32_16x16x32_bf16 v[72:75], a[196:199], a[52:55], v[72:75]
    v_mfma_f32_16x16x32_bf16 v[72:75], a[192:195], a[36:39], v[72:75]
    buffer_load_dwordx4 a[92:95], v28, s[20:23], s46 offen offset:3072 sc1
    v_mfma_f32_16x16x32_bf16 v[80:83], a[192:195], a[40:43], v[80:83]
    ds_read_b64_tr_b16 a[212:213], v10 offset:12288
    v_mfma_f32_16x16x32_bf16 v[80:83], a[196:199], a[56:59], v[80:83]
    ds_read_b64_tr_b16 a[214:215], v10 offset:18432
    v_mfma_f32_16x16x32_bf16 v[88:91], a[196:199], a[60:63], v[88:91]
    s_add_u32 s46, s45, 24576
    s_sub_u32 s77, s46, 81920
    s_min_u32 s46, s46, s77
    v_mfma_f32_16x16x32_bf16 v[88:91], a[192:195], a[44:47], v[88:91]
pg_1:
    s_cbranch_execz pg_ret
    s_waitcnt lgkmcnt(4)
    v_mfma_f32_16x16x32_bf16 v[92:95], a[200:203], a[44:47], v[92:95]
    ds_read_b64_tr_b16 a[192:193], v11 offset:0
    v_mfma_f32_16x16x32_bf16 v[92:95], a[204:207], a[60:63], v[92:95]
    ds_read_b64_tr_b16 a[194:195], v11 offset:6144
    v_mfma_f32_16x16x32_bf16 v[84:87], a[204:207], a[56:59], v[84:87]
    buffer_load_dwordx4 a[96:99], v28, s[20:23], s46 offen offset:0 sc1
    v_mfma_f32_16x16x32_bf16 v[84:87], a[200:203], a[40:43], v[84:87]
    v_mfma_f32_16x16x32_bf16 v[76:79], a[200:203], a[36:39], v[76:79]
    ds_read_b64_tr_b16 a[196:197], v11 offset:12288
    v_mfma_f32_16x16x32_bf16 v[76:79], a[204:207], a[52:55], v[76:79]
    ds_read_b64_tr_b16 a[198:199], v11 offset:18432
    v_mfma_f32_16x16x32_bf16 v[68:71], a[204:207], a[48:51], v[68:71]
    v_mfma_f32_16x16x32_bf16 v[68:71], a[200:203], a[32:35], v[68:71]
    s_waitcnt lgkmcnt(4)
    v_mfma_f32_16x16x32_bf16 v[96:99], a[208:211], a[32:35], v[96:99]
    ds_read_b64_tr_b16 a[200:201], v8 offset:1024
    v_mfma_f32_16x16x32_bf16 v[96:99], a[212:215], a[48:51], v[96:99]
    ds_read_b64_tr_b16 a[202:203], v8 offset:7168
    v_mfma_f32_16x16x32_bf16 v[104:107], a[212:215], a[52:55], v[104:107]
    buffer_load_dwordx4 a[100:103], v28, s[20:23], s46 offen offset:1024 sc1
    v_mfma_f32_16x16x32_bf16 v[104:107], a[208:211], a[36:39], v[104:107]
    v_mfma_f32_16x16x32_bf16 v[112:115], a[208:211], a[40:43], v[112:115]
    ds_read_b64_tr_b16 a[204:205], v8 offset:13312
    v_mfma_f32_16x16x32_bf16 v[112:115], a[212:215], a[56:59], v[112:115]
    ds_read_b64_tr_b16 a[206:207], v8 offset:19456
    v_mfma_f32_16x16x32_bf16 v[120:123], a[212:215], a[60:63], v[120:123]
    v_mfma_f32_16x16x32_bf16 v[120:123], a[208:211], a[44:47], v[120:123]
    s_waitcnt lgkmcnt(4)
    v_mfma_f32_16x16x32_bf16 v[124:127], a[192:195], a[44:47], v[124:127]
    ds_read_b64_tr_b16 a[208:209], v9 offset:1024
    v_mfma_f32_16x16x32_bf16 v[124:127], a[196:199], a[60:63], v[124:127]
    ds_read_b64_tr_b16 a[210:211], v9 offset:7168
    v_mfma_f32_16x16x32_bf16 v[116:119], a[196:199], a[56:59], v[116:119]
    buffer_load_dwordx4 a[104:107], v28, s[20:23], s46 offen offset:2048 sc1
    v_mfma_f32_16x16x32_bf16 v[116:119], a[192:195], a[40:43], v[116:119]
    v_mfma_f32_16x16x32_bf16 v[108:111], a[192:195], a[36:39], v[108:111]
    ds_read_b64_tr_b16 a[212:213], v9 offset:13312
    v_mfma_f32_16x16x32_bf16 v[108:111], a[196:199], a[52:55], v[108:111]
    ds_read_b64_tr_b16 a[214:215], v9 offset:19456
    v_mfma_f32_16x16x32_bf16 v[100:103], a[196:199], a[48:51], v[100:103]
    buffer_load_dwordx4 a[108:111], v28, s[20:23], s46 offen offset:3072 sc1
    v_mfma_f32_16x16x32_bf16 v[100:103], a[192:195], a[32:35], v[100:103]
    s_waitcnt lgkmcnt(4)
    v_mfma_f32_16x16x32_bf16 v[128:131], a[200:203], a[32:35], v[128:131]
    ds_read_b64_tr_b16 a[192:193], v10 offset:1024
    v_mfma_f32_16x16x32_bf16 v[128:131], a[204:207], a[48:51], v[128:131]
    ds_read_b64_tr_b16 a[194:195], v10 offset:7168
    v_mfma_f32_16x16x32_bf16 v[136:139], a[204:207], a[52:55], v[136:139]
    v_mfma_f32_16x16x32_bf16 v[136:139], a[200:203], a[36:39], v[136:139]
    s_add_u32 m0, s49, 0
    v_mfma_f32_16x16x32_bf16 v[144:147], a[200:203], a[40:43], v[144:147]
    ds_read_b64_tr_b16 a[196:197], v10 offset:13312
    v_mfma_f32_16x16x32_bf16 v[144:147], a[204:207], a[56:59], v[144:147]
    ds_read_b64_tr_b16 a[198:199], v10 offset:19456
    v_mfma_f32_16x16x32_bf16 v[152:155], a[204:207], a[60:63], v[152:155]
    buffer_load_dwordx4 v2, s[8:11], s36 offen offset:0 lds
    v_mfma_f32_16x16x32_bf16 v[152:155], a[200:203], a[44:47], v[152:155]
    s_waitcnt lgkmcnt(4)
    v_mfma_f32_16x16x32_bf16 v[156:159], a[208:211], a[44:47], v[156:159]
    ds_read_b64_tr_b16 a[200:201], v11 offset:1024
    v_mfma_f32_16x16x32_bf16 v[156:159], a[212:215], a[60:63], v[156:159]
    s_add_u32 m0, s49, 896
    ds_read_b64_tr_b16 a[202:203], v11 offset:7168
    v_mfma_f32_16x16x32_bf16 v[148:151], a[212:215], a[56:59], v[148:151]
    buffer_load_dwordx4 v2, s[8:11], s36 offen offset:128 lds
    v_mfma_f32_16x16x32_bf16 v[148:151], a[208:211], a[40:43], v[148:151]
    v_mfma_f32_16x16x32_bf16 v[140:143], a[208:211], a[36:39], v[140:143]
    ds_read_b64_tr_b16 a[204:205], v11 offset:13312
    v_mfma_f32_16x16x32_bf16 v[140:143], a[212:215], a[52:55], v[140:143]
    ds_read_b64_tr_b16 a[206:207], v11 offset:19456
    v_mfma_f32_16x16x32_bf16 v[132:135], a[212:215], a[48:51], v[132:135]
    v_mfma_f32_16x16x32_bf16 v[132:135], a[208:211], a[32:35], v[132:135]
    s_waitcnt lgkmcnt(4)
    v_mfma_f32_16x16x32_bf16 v[160:163], a[192:195], a[32:35], v[160:163]
    s_add_u32 m0, s49, 1792
    ds_read_b64_tr_b16 a[208:209], v8 offset:2048
    v_mfma_f32_16x16x32_bf16 v[160:163], a[196:199], a[48:51], v[160:163]
    ds_read_b64_tr_b16 a[210:211], v8 offset:8192
    v_mfma_f32_16x16x32_bf16 v[168:171], a[196:199], a[52:55], v[168:171]
    buffer_load_dwordx4 v2, s[8:11], s36 offen offset:256 lds
    v_mfma_f32_16x16x32_bf16 v[168:171], a[192:195], a[36:39], v[168:171]
    v_mfma_f32_16x16x32_bf16 v[176:179], a[192:195], a[40:43], v[176:179]
    ds_read_b64_tr_b16 a[212:213], v8 offset:14336
    v_mfma_f32_16x16x32_bf16 v[176:179], a[196:199], a[56:59], v[176:179]
    ds_read_b64_tr_b16 a[214:215], v8 offset:20480
    v_mfma_f32_16x16x32_bf16 v[184:187], a[196:199], a[60:63], v[184:187]
    s_add_u32 m0, s49, 3072
    v_add_u32 v8, 98304, v12
    v_mfma_f32_16x16x32_bf16 v[184:187], a[192:195], a[44:47], v[184:187]
    s_waitcnt lgkmcnt(4)
    v_mfma_f32_16x16x32_bf16 v[188:191], a[200:203], a[44:47], v[188:191]
    ds_read_b64_tr_b16 a[192:193], v9 offset:2048
    v_mfma_f32_16x16x32_bf16 v[188:191], a[204:207], a[60:63], v[188:191]
    ds_read_b64_tr_b16 a[194:195], v9 offset:8192
    v_mfma_f32_16x16x32_bf16 v[180:183], a[204:207], a[56:59], v[180:183]
    buffer_load_dwordx4 v3, s[8:11], s36 offen offset:0 lds
    v_mfma_f32_16x16x32_bf16 v[180:183], a[200:203], a[40:43], v[180:183]
    v_mfma_f32_16x16x32_bf16 v[172:175], a[200:203], a[36:39], v[172:175]
    ds_read_b64_tr_b16 a[196:197], v9 offset:14336
    v_mfma_f32_16x16x32_bf16 v[172:175], a[204:207], a[52:55], v[172:175]
    s_add_u32 m0, s49, 3968
    ds_read_b64_tr_b16 a[198:199], v9 offset:20480
    v_mfma_f32_16x16x32_bf16 v[164:167], a[204:207], a[48:51], v[164:167]
    buffer_load_dwordx4 v3, s[8:11], s36 offen offset:128 lds
    v_mfma_f32_16x16x32_bf16 v[164:167], a[200:203], a[32:35], v[164:167]
    s_waitcnt lgkmcnt(4)
    v_add_u32 v9, 98304, v13
    v_mfma_f32_16x16x32_bf16 v[192:195], a[208:211], a[32:35], v[192:195]
    ds_read_b64_tr_b16 a[200:201], v10 offset:2048
    v_mfma_f32_16x16x32_bf16 v[192:195], a[212:215], a[48:51], v[192:195]
    ds_read_b64_tr_b16 a[202:203], v10 offset:8192
    v_mfma_f32_16x16x32_bf16 v[200:203], a[212:215], a[52:55], v[200:203]
    v_mfma_f32_16x16x32_bf16 v[200:203], a[208:211], a[36:39], v[200:203]
    s_add_u32 m0, s49, 4864
    v_mfma_f32_16x16x32_bf16 v[208:211], a[208:211], a[40:43], v[208:211]
    ds_read_b64_tr_b16 a[204:205], v10 offset:14336
    v_mfma_f32_16x16x32_bf16 v[208:211], a[212:215], a[56:59], v[208:211]
    ds_read_b64_tr_b16 a[206:207], v10 offset:20480
    v_mfma_f32_16x16x32_bf16 v[216:219], a[212:215], a[60:63], v[216:219]
    buffer_load_dwordx4 v3, s[8:11], s36 offen offset:256 lds
    v_mfma_f32_16x16x32_bf16 v[216:219], a[208:211], a[44:47], v[216:219]
    s_waitcnt lgkmcnt(4)
    v_add_u32 v10, 98304, v14
    s_add_u32 s36, s36, s37
    v_mfma_f32_16x16x32_bf16 v[220:223], a[192:195], a[44:47], v[220:223]
    s_sub_u32 s55, s36, 7864320
    ds_read_b64_tr_b16 a[208:209], v11 offset:2048
    s_min_u32 s36, s36, s55
    v_mfma_f32_16x16x32_bf16 v[220:223], a[196:199], a[60:63], v[220:223]
    s_add_u32 s46, s45, 28672
    ds_read_b64_tr_b16 a[210:211], v11 offset:8192
    s_sub_u32 s77, s46, 81920
    v_mfma_f32_16x16x32_bf16 v[212:215], a[196:199], a[56:59], v[212:215]
    s_min_u32 s46, s46, s77
    v_mfma_f32_16x16x32_bf16 v[212:215], a[192:195], a[40:43], v[212:215]
    buffer_load_dwordx4 a[112:115], v28, s[20:23], s46 offen offset:0 sc1
    v_mfma_f32_16x16x32_bf16 v[204:207], a[192:195], a[36:39], v[204:207]
    ds_read_b64_tr_b16 a[212:213], v11 offset:14336
    v_mfma_f32_16x16x32_bf16 v[204:207], a[196:199], a[52:55], v[204:207]
    s_waitcnt vmcnt(42)
    ds_read_b64_tr_b16 a[214:215], v11 offset:20480
    v_mfma_f32_16x16x32_bf16 v[196:199], a[196:199], a[48:51], v[196:199]
    s_barrier
    v_mfma_f32_16x16x32_bf16 v[196:199], a[192:195], a[32:35], v[196:199]
    s_waitcnt lgkmcnt(4)
    v_add_u32 v11, 98304, v15
    v_mfma_f32_16x16x32_bf16 v[224:227], a[200:203], a[32:35], v[224:227]
    ds_read_b64_tr_b16 a[192:193], v8 offset:0
    v_mfma_f32_16x16x32_bf16 v[224:227], a[204:207], a[48:51], v[224:227]
    ds_read_b64_tr_b16 a[194:195], v8 offset:6144
    v_mfma_f32_16x16x32_bf16 v[232:235], a[204:207], a[52:55], v[232:235]
    buffer_load_dwordx4 a[116:119], v28, s[20:23], s46 offen offset:1024 sc1
    v_mfma_f32_16x16x32_bf16 v[232:235], a[200:203], a[36:39], v[232:235]
    v_mfma_f32_16x16x32_bf16 v[240:243], a[200:203], a[40:43], v[240:243]
    ds_read_b64_tr_b16 a[196:197], v8 offset:12288
    v_mov_b32 v23, 0
    v_mfma_f32_16x16x32_bf16 v[240:243], a[204:207], a[56:59], v[240:243]
    ds_read_b64_tr_b16 a[198:199], v8 offset:18432
    v_mfma_f32_16x16x32_bf16 v[248:251], a[204:207], a[60:63], v[248:251]
    buffer_load_dword a218, v23, s[24:27], s4 offen offset:128 sc1
    v_mfma_f32_16x16x32_bf16 v[248:251], a[200:203], a[44:47], v[248:251]
    s_waitcnt lgkmcnt(4)
    v_mfma_f32_16x16x32_bf16 v[252:255], a[208:211], a[44:47], v[252:255]
    ds_read_b64_tr_b16 a[200:201], v9 offset:0
    v_mfma_f32_16x16x32_bf16 v[252:255], a[212:215], a[60:63], v[252:255]
    ds_read_b64_tr_b16 a[202:203], v9 offset:6144
    v_mfma_f32_16x16x32_bf16 v[244:247], a[212:215], a[56:59], v[244:247]
    buffer_load_dwordx4 a[120:123], v28, s[20:23], s46 offen offset:2048 sc1
    v_mfma_f32_16x16x32_bf16 v[244:247], a[208:211], a[40:43], v[244:247]
    v_mfma_f32_16x16x32_bf16 v[236:239], a[208:211], a[36:39], v[236:239]
    ds_read_b64_tr_b16 a[204:205], v9 offset:12288
    v_mfma_f32_16x16x32_bf16 v[236:239], a[212:215], a[52:55], v[236:239]
    s_waitcnt vmcnt(18)
    s_waitcnt vmcnt(14)
    ds_read_b64_tr_b16 a[206:207], v9 offset:18432
    v_mfma_f32_16x16x32_bf16 v[228:231], a[212:215], a[48:51], v[228:231]
    buffer_load_dwordx4 a[124:127], v28, s[20:23], s46 offen offset:3072 sc1
    v_mfma_f32_16x16x32_bf16 v[228:231], a[208:211], a[32:35], v[228:231]
    s_waitcnt lgkmcnt(4)
    v_mfma_f32_16x16x32_bf16 v[64:67], a[192:195], a[64:67], v[64:67]
    ds_read_b64_tr_b16 a[208:209], v10 offset:0
    v_mfma_f32_16x16x32_bf16 v[64:67], a[196:199], a[80:83], v[64:67]
    s_add_u32 s46, s45, 32768
    ds_read_b64_tr_b16 a[210:211], v10 offset:6144
    s_sub_u32 s77, s46, 81920
    v_mfma_f32_16x16x32_bf16 v[72:75], a[196:199], a[84:87], v[72:75]
    s_min_u32 s46, s46, s77
    v_mfma_f32_16x16x32_bf16 v[72:75], a[192:195], a[68:71], v[72:75]
    v_mfma_f32_16x16x32_bf16 v[80:83], a[192:195], a[72:75], v[80:83]
    ds_read_b64_tr_b16 a[212:213], v10 offset:12288
    v_mfma_f32_16x16x32_bf16 v[80:83], a[196:199], a[88:91], v[80:83]
    ds_read_b64_tr_b16 a[214:215], v10 offset:18432
    v_mfma_f32_16x16x32_bf16 v[88:91], a[196:199], a[92:95], v[88:91]
    buffer_load_dwordx4 a[128:131], v28, s[20:23], s46 offen offset:0 sc1
    v_mfma_f32_16x16x32_bf16 v[88:91], a[192:195], a[76:79], v[88:91]
    s_waitcnt lgkmcnt(4)
    v_mfma_f32_16x16x32_bf16 v[92:95], a[200:203], a[76:79], v[92:95]
    ds_read_b64_tr_b16 a[192:193], v11 offset:0
    v_mfma_f32_16x16x32_bf16 v[92:95], a[204:207], a[92:95], v[92:95]
    ds_read_b64_tr_b16 a[194:195], v11 offset:6144
    v_mfma_f32_16x16x32_bf16 v[84:87], a[204:207], a[88:91], v[84:87]
    v_mfma_f32_16x16x32_bf16 v[84:87], a[200:203], a[72:75], v[84:87]
    buffer_load_dwordx4 a[132:135], v28, s[20:23], s46 offen offset:1024 sc1
    v_mfma_f32_16x16x32_bf16 v[76:79], a[200:203], a[68:71], v[76:79]
    ds_read_b64_tr_b16 a[196:197], v11 offset:12288
    v_mfma_f32_16x16x32_bf16 v[76:79], a[204:207], a[84:87], v[76:79]
    ds_read_b64_tr_b16 a[198:199], v11 offset:18432
    v_mfma_f32_16x16x32_bf16 v[68:71], a[204:207], a[80:83], v[68:71]
    v_mfma_f32_16x16x32_bf16 v[68:71], a[200:203], a[64:67], v[68:71]
    s_waitcnt lgkmcnt(4)
    v_mfma_f32_16x16x32_bf16 v[96:99], a[208:211], a[64:67], v[96:99]
    ds_read_b64_tr_b16 a[200:201], v8 offset:1024
    v_mfma_f32_16x16x32_bf16 v[96:99], a[212:215], a[80:83], v[96:99]
    ds_read_b64_tr_b16 a[202:203], v8 offset:7168
    v_mfma_f32_16x16x32_bf16 v[104:107], a[212:215], a[84:87], v[104:107]
    buffer_load_dwordx4 a[136:139], v28, s[20:23], s46 offen offset:2048 sc1
    v_mfma_f32_16x16x32_bf16 v[104:107], a[208:211], a[68:71], v[104:107]
    v_mfma_f32_16x16x32_bf16 v[112:115], a[208:211], a[72:75], v[112:115]
    ds_read_b64_tr_b16 a[204:205], v8 offset:13312
    v_mfma_f32_16x16x32_bf16 v[112:115], a[212:215], a[88:91], v[112:115]
    ds_read_b64_tr_b16 a[206:207], v8 offset:19456
    v_mfma_f32_16x16x32_bf16 v[120:123], a[212:215], a[92:95], v[120:123]
    v_mfma_f32_16x16x32_bf16 v[120:123], a[208:211], a[76:79], v[120:123]
    s_waitcnt lgkmcnt(4)
    v_mfma_f32_16x16x32_bf16 v[124:127], a[192:195], a[76:79], v[124:127]
    ds_read_b64_tr_b16 a[208:209], v9 offset:1024
    v_mfma_f32_16x16x32_bf16 v[124:127], a[196:199], a[92:95], v[124:127]
    ds_read_b64_tr_b16 a[210:211], v9 offset:7168
    v_mfma_f32_16x16x32_bf16 v[116:119], a[196:199], a[88:91], v[116:119]
    buffer_load_dwordx4 a[140:143], v28, s[20:23], s46 offen offset:3072 sc1
    v_mfma_f32_16x16x32_bf16 v[116:119], a[192:195], a[72:75], v[116:119]
    v_mfma_f32_16x16x32_bf16 v[108:111], a[192:195], a[68:71], v[108:111]
    ds_read_b64_tr_b16 a[212:213], v9 offset:13312
    v_mfma_f32_16x16x32_bf16 v[108:111], a[196:199], a[84:87], v[108:111]
    ds_read_b64_tr_b16 a[214:215], v9 offset:19456
    v_mfma_f32_16x16x32_bf16 v[100:103], a[196:199], a[80:83], v[100:103]
    s_add_u32 m0, s49, 24576
    v_mfma_f32_16x16x32_bf16 v[100:103], a[192:195], a[64:67], v[100:103]
    s_waitcnt lgkmcnt(4)
    v_mfma_f32_16x16x32_bf16 v[128:131], a[200:203], a[64:67], v[128:131]
    ds_read_b64_tr_b16 a[192:193], v10 offset:1024
    v_mfma_f32_16x16x32_bf16 v[128:131], a[204:207], a[80:83], v[128:131]
    ds_read_b64_tr_b16 a[194:195], v10 offset:7168
    v_mfma_f32_16x16x32_bf16 v[136:139], a[204:207], a[84:87], v[136:139]
    buffer_load_dwordx4 v2, s[8:11], s36 offen offset:0 lds
    v_mfma_f32_16x16x32_bf16 v[136:139], a[200:203], a[68:71], v[136:139]
    v_mfma_f32_16x16x32_bf16 v[144:147], a[200:203], a[72:75], v[144:147]
    s_add_u32 m0, s49, 25472
    ds_read_b64_tr_b16 a[196:197], v10 offset:13312
    v_mfma_f32_16x16x32_bf16 v[144:147], a[204:207], a[88:91], v[144:147]
    ds_read_b64_tr_b16 a[198:199], v10 offset:19456
    v_mfma_f32_16x16x32_bf16 v[152:155], a[204:207], a[92:95], v[152:155]
    buffer_load_dwordx4 v2, s[8:11], s36 offen offset:128 lds
    v_mfma_f32_16x16x32_bf16 v[152:155], a[200:203], a[76:79], v[152:155]
    s_waitcnt lgkmcnt(4)
    v_mfma_f32_16x16x32_bf16 v[156:159], a[208:211], a[76:79], v[156:159]
    ds_read_b64_tr_b16 a[200:201], v11 offset:1024
    v_mfma_f32_16x16x32_bf16 v[156:159], a[212:215], a[92:95], v[156:159]
    ds_read_b64_tr_b16 a[202:203], v11 offset:7168
    v_mfma_f32_16x16x32_bf16 v[148:151], a[212:215], a[88:91], v[148:151]
    buffer_load_dwordx4 v[32:35], v17, s[24:27], s47 offen offset:0 sc1
    v_mfma_f32_16x16x32_bf16 v[148:151], a[208:211], a[72:75], v[148:151]
    s_add_u32 m0, s49, 26368
    v_mfma_f32_16x16x32_bf16 v[140:143], a[208:211], a[68:71], v[140:143]
    ds_read_b64_tr_b16 a[204:205], v11 offset:13312
    v_mfma_f32_16x16x32_bf16 v[140:143], a[212:215], a[84:87], v[140:143]
    ds_read_b64_tr_b16 a[206:207], v11 offset:19456
    v_mfma_f32_16x16x32_bf16 v[132:135], a[212:215], a[80:83], v[132:135]
    buffer_load_dwordx4 v2, s[8:11], s36 offen offset:256 lds
    v_mfma_f32_16x16x32_bf16 v[132:135], a[208:211], a[64:67], v[132:135]
    s_waitcnt lgkmcnt(4)
    v_mfma_f32_16x16x32_bf16 v[160:163], a[192:195], a[64:67], v[160:163]
    ds_read_b64_tr_b16 a[208:209], v8 offset:2048
    v_mfma_f32_16x16x32_bf16 v[160:163], a[196:199], a[80:83], v[160:163]
    s_add_u32 m0, s49, 27648
    ds_read_b64_tr_b16 a[210:211], v8 offset:8192
    v_mfma_f32_16x16x32_bf16 v[168:171], a[196:199], a[84:87], v[168:171]
    buffer_load_dwordx4 v3, s[8:11], s36 offen offset:0 lds
    v_mfma_f32_16x16x32_bf16 v[168:171], a[192:195], a[68:71], v[168:171]
    v_mfma_f32_16x16x32_bf16 v[176:179], a[192:195], a[72:75], v[176:179]
    ds_read_b64_tr_b16 a[212:213], v8 offset:14336
    v_mfma_f32_16x16x32_bf16 v[176:179], a[196:199], a[88:91], v[176:179]
    ds_read_b64_tr_b16 a[214:215], v8 offset:20480
    v_mfma_f32_16x16x32_bf16 v[184:187], a[196:199], a[92:95], v[184:187]
    buffer_load_dwordx4 v[36:39], v17, s[24:27], s47 offen offset:1024 sc1
    v_mfma_f32_16x16x32_bf16 v[184:187], a[192:195], a[76:79], v[184:187]
    s_waitcnt lgkmcnt(4)
    v_add_u32 v8, 122880, v12
    v_mfma_f32_16x16x32_bf16 v[188:191], a[200:203], a[76:79], v[188:191]
    s_add_u32 m0, s49, 28544
    ds_read_b64_tr_b16 a[192:193], v9 offset:2048
    v_mfma_f32_16x16x32_bf16 v[188:191], a[204:207], a[92:95], v[188:191]
    ds_read_b64_tr_b16 a[194:195], v9 offset:8192
    v_mfma_f32_16x16x32_bf16 v[180:183], a[204:207], a[88:91], v[180:183]
    buffer_load_dwordx4 v3, s[8:11], s36 offen offset:128 lds
    v_mfma_f32_16x16x32_bf16 v[180:183], a[200:203], a[72:75], v[180:183]
    v_mfma_f32_16x16x32_bf16 v[172:175], a[200:203], a[68:71], v[172:175]
    ds_read_b64_tr_b16 a[196:197], v9 offset:14336
    v_mfma_f32_16x16x32_bf16 v[172:175], a[204:207], a[84:87], v[172:175]
    ds_read_b64_tr_b16 a[198:199], v9 offset:20480
    v_mfma_f32_16x16x32_bf16 v[164:167], a[204:207], a[80:83], v[164:167]
    s_add_u32 m0, s49, 29440
    v_add_u32 v9, 122880, v13
    v_mfma_f32_16x16x32_bf16 v[164:167], a[200:203], a[64:67], v[164:167]
    s_waitcnt lgkmcnt(4)
    v_mfma_f32_16x16x32_bf16 v[192:195], a[208:211], a[64:67], v[192:195]
    ds_read_b64_tr_b16 a[200:201], v10 offset:2048
    v_mfma_f32_16x16x32_bf16 v[192:195], a[212:215], a[80:83], v[192:195]
    ds_read_b64_tr_b16 a[202:203], v10 offset:8192
    v_mfma_f32_16x16x32_bf16 v[200:203], a[212:215], a[84:87], v[200:203]
    buffer_load_dwordx4 v3, s[8:11], s36 offen offset:256 lds
    v_mfma_f32_16x16x32_bf16 v[200:203], a[208:211], a[68:71], v[200:203]
    buffer_load_dwordx4 v[40:43], v17, s[24:27], s47 offen offset:2048 sc1
    v_mfma_f32_16x16x32_bf16 v[208:211], a[208:211], a[72:75], v[208:211]
    s_add_u32 s36, s36, s37
    ds_read_b64_tr_b16 a[204:205], v10 offset:14336
    s_sub_u32 s55, s36, 7864320
    v_mfma_f32_16x16x32_bf16 v[208:211], a[212:215], a[88:91], v[208:211]
    s_min_u32 s36, s36, s55
    ds_read_b64_tr_b16 a[206:207], v10 offset:20480
    s_add_u32 s46, s45, 36864
    v_mfma_f32_16x16x32_bf16 v[216:219], a[212:215], a[92:95], v[216:219]
    s_sub_u32 s77, s46, 81920
    v_add_u32 v10, 122880, v14
    s_min_u32 s46, s46, s77
    v_mfma_f32_16x16x32_bf16 v[216:219], a[208:211], a[76:79], v[216:219]
    s_waitcnt lgkmcnt(4)
    v_mfma_f32_16x16x32_bf16 v[220:223], a[192:195], a[76:79], v[220:223]
    ds_read_b64_tr_b16 a[208:209], v11 offset:2048
    v_mfma_f32_16x16x32_bf16 v[220:223], a[196:199], a[92:95], v[220:223]
    ds_read_b64_tr_b16 a[210:211], v11 offset:8192
    v_mfma_f32_16x16x32_bf16 v[212:215], a[196:199], a[88:91], v[212:215]
    buffer_load_dwordx4 a[144:147], v28, s[20:23], s46 offen offset:0 sc1
    v_mfma_f32_16x16x32_bf16 v[212:215], a[192:195], a[72:75], v[212:215]
    v_mfma_f32_16x16x32_bf16 v[204:207], a[192:195], a[68:71], v[204:207]
    ds_read_b64_tr_b16 a[212:213], v11 offset:14336
    v_mfma_f32_16x16x32_bf16 v[204:207], a[196:199], a[84:87], v[204:207]
    s_waitcnt vmcnt(54)
    ds_read_b64_tr_b16 a[214:215], v11 offset:20480
    v_mfma_f32_16x16x32_bf16 v[196:199], a[196:199], a[80:83], v[196:199]
    s_barrier
    v_mfma_f32_16x16x32_bf16 v[196:199], a[192:195], a[64:67], v[196:199]
    s_waitcnt lgkmcnt(4)
    buffer_load_dwordx4 a[148:151], v28, s[20:23], s46 offen offset:1024 sc1
    v_mfma_f32_16x16x32_bf16 v[224:227], a[200:203], a[64:67], v[224:227]
    ds_read_b64_tr_b16 a[192:193], v8 offset:0
    v_add_u32 v11, 122880, v15
    v_mfma_f32_16x16x32_bf16 v[224:227], a[204:207], a[80:83], v[224:227]
    ds_read_b64_tr_b16 a[194:195], v8 offset:6144
    v_mfma_f32_16x16x32_bf16 v[232:235], a[204:207], a[84:87], v[232:235]
    buffer_load_dwordx4 v[44:47], v17, s[24:27], s47 offen offset:3072 sc1
    v_mfma_f32_16x16x32_bf16 v[232:235], a[200:203], a[68:71], v[232:235]
    buffer_load_dwordx4 a[152:155], v28, s[20:23], s46 offen offset:2048 sc1
    v_mfma_f32_16x16x32_bf16 v[240:243], a[200:203], a[72:75], v[240:243]
    ds_read_b64_tr_b16 a[196:197], v8 offset:12288
    v_mfma_f32_16x16x32_bf16 v[240:243], a[204:207], a[88:91], v[240:243]
    ds_read_b64_tr_b16 a[198:199], v8 offset:18432
    v_mfma_f32_16x16x32_bf16 v[248:251], a[204:207], a[92:95], v[248:251]
    v_mfma_f32_16x16x32_bf16 v[248:251], a[200:203], a[76:79], v[248:251]
    s_waitcnt lgkmcnt(4)
    v_mfma_f32_16x16x32_bf16 v[252:255], a[208:211], a[76:79], v[252:255]
    ds_read_b64_tr_b16 a[200:201], v9 offset:0
    v_mfma_f32_16x16x32_bf16 v[252:255], a[212:215], a[92:95], v[252:255]
    ds_read_b64_tr_b16 a[202:203], v9 offset:6144
    v_mfma_f32_16x16x32_bf16 v[244:247], a[212:215], a[88:91], v[244:247]
    buffer_load_dwordx4 a[156:159], v28, s[20:23], s46 offen offset:3072 sc1
    v_mfma_f32_16x16x32_bf16 v[244:247], a[208:211], a[72:75], v[244:247]
    v_mfma_f32_16x16x32_bf16 v[236:239], a[208:211], a[68:71], v[236:239]
    s_add_u32 s46, s45, 40960
    ds_read_b64_tr_b16 a[204:205], v9 offset:12288
    s_sub_u32 s77, s46, 81920
    v_mfma_f32_16x16x32_bf16 v[236:239], a[212:215], a[84:87], v[236:239]
    s_waitcnt vmcnt(29)
    s_waitcnt vmcnt(18)
    ds_read_b64_tr_b16 a[206:207], v9 offset:18432
    v_mfma_f32_16x16x32_bf16 v[228:231], a[212:215], a[80:83], v[228:231]
    s_min_u32 s46, s46, s77
    v_mfma_f32_16x16x32_bf16 v[228:231], a[208:211], a[64:67], v[228:231]
    s_waitcnt lgkmcnt(4)
    v_mfma_f32_16x16x32_bf16 v[64:67], a[192:195], a[96:99], v[64:67]
    ds_read_b64_tr_b16 a[208:209], v10 offset:0
    v_mfma_f32_16x16x32_bf16 v[64:67], a[196:199], a[112:115], v[64:67]
    ds_read_b64_tr_b16 a[210:211], v10 offset:6144
    v_mfma_f32_16x16x32_bf16 v[72:75], a[196:199], a[116:119], v[72:75]
    buffer_load_dwordx4 a[160:163], v28, s[20:23], s46 offen offset:0 sc1
    v_mfma_f32_16x16x32_bf16 v[72:75], a[192:195], a[100:103], v[72:75]
    v_mfma_f32_16x16x32_bf16 v[80:83], a[192:195], a[104:107], v[80:83]
    ds_read_b64_tr_b16 a[212:213], v10 offset:12288
    v_mfma_f32_16x16x32_bf16 v[80:83], a[196:199], a[120:123], v[80:83]
    ds_read_b64_tr_b16 a[214:215], v10 offset:18432
    v_mfma_f32_16x16x32_bf16 v[88:91], a[196:199], a[124:127], v[88:91]
    buffer_load_dwordx4 a[164:167], v28, s[20:23], s46 offen offset:1024 sc1
    v_mfma_f32_16x16x32_bf16 v[88:91], a[192:195], a[108:111], v[88:91]
    s_waitcnt lgkmcnt(4)
    v_mfma_f32_16x16x32_bf16 v[92:95], a[200:203], a[108:111], v[92:95]
    ds_read_b64_tr_b16 a[192:193], v11 offset:0
    v_mfma_f32_16x16x32_bf16 v[92:95], a[204:207], a[124:127], v[92:95]
    ds_read_b64_tr_b16 a[194:195], v11 offset:6144
    v_mfma_f32_16x16x32_bf16 v[84:87], a[204:207], a[120:123], v[84:87]
    v_mfma_f32_16x16x32_bf16 v[84:87], a[200:203], a[104:107], v[84:87]
    v_mfma_f32_16x16x32_bf16 v[76:79], a[200:203], a[100:103], v[76:79]
    ds_read_b64_tr_b16 a[196:197], v11 offset:12288
    v_mfma_f32_16x16x32_bf16 v[76:79], a[204:207], a[116:119], v[76:79]
    ds_read_b64_tr_b16 a[198:199], v11 offset:18432
    v_mfma_f32_16x16x32_bf16 v[68:71], a[204:207], a[112:115], v[68:71]
    buffer_load_dwordx4 a[168:171], v28, s[20:23], s46 offen offset:2048 sc1
    v_mfma_f32_16x16x32_bf16 v[68:71], a[200:203], a[96:99], v[68:71]
    s_waitcnt lgkmcnt(4)
    v_mfma_f32_16x16x32_bf16 v[96:99], a[208:211], a[96:99], v[96:99]
    ds_read_b64_tr_b16 a[200:201], v8 offset:1024
    v_mfma_f32_16x16x32_bf16 v[96:99], a[212:215], a[112:115], v[96:99]
    ds_read_b64_tr_b16 a[202:203], v8 offset:7168
    v_mfma_f32_16x16x32_bf16 v[104:107], a[212:215], a[116:119], v[104:107]
    v_mfma_f32_16x16x32_bf16 v[104:107], a[208:211], a[100:103], v[104:107]
    buffer_load_dwordx4 a[172:175], v28, s[20:23], s46 offen offset:3072 sc1
    v_mfma_f32_16x16x32_bf16 v[112:115], a[208:211], a[104:107], v[112:115]
    ds_read_b64_tr_b16 a[204:205], v8 offset:13312
    v_mfma_f32_16x16x32_bf16 v[112:115], a[212:215], a[120:123], v[112:115]
    ds_read_b64_tr_b16 a[206:207], v8 offset:19456
    v_mfma_f32_16x16x32_bf16 v[120:123], a[212:215], a[124:127], v[120:123]
    v_mfma_f32_16x16x32_bf16 v[120:123], a[208:211], a[108:111], v[120:123]
    s_waitcnt lgkmcnt(4)
    v_mfma_f32_16x16x32_bf16 v[124:127], a[192:195], a[108:111], v[124:127]
    ds_read_b64_tr_b16 a[208:209], v9 offset:1024
    v_mfma_f32_16x16x32_bf16 v[124:127], a[196:199], a[124:127], v[124:127]
    s_add_u32 m0, s49, 49152
    ds_read_b64_tr_b16 a[210:211], v9 offset:7168
    v_mfma_f32_16x16x32_bf16 v[116:119], a[196:199], a[120:123], v[116:119]
    buffer_load_dwordx4 v2, s[8:11], s36 offen offset:0 lds
    v_mfma_f32_16x16x32_bf16 v[116:119], a[192:195], a[104:107], v[116:119]
    v_mfma_f32_16x16x32_bf16 v[108:111], a[192:195], a[100:103], v[108:111]
    ds_read_b64_tr_b16 a[212:213], v9 offset:13312
    v_mfma_f32_16x16x32_bf16 v[108:111], a[196:199], a[116:119], v[108:111]
    ds_read_b64_tr_b16 a[214:215], v9 offset:19456
    v_mfma_f32_16x16x32_bf16 v[100:103], a[196:199], a[112:115], v[100:103]
    v_mfma_f32_16x16x32_bf16 v[100:103], a[192:195], a[96:99], v[100:103]
    s_waitcnt lgkmcnt(4)
    s_add_u32 m0, s49, 50048
    v_mfma_f32_16x16x32_bf16 v[128:131], a[200:203], a[96:99], v[128:131]
    ds_read_b64_tr_b16 a[192:193], v10 offset:1024
    v_mfma_f32_16x16x32_bf16 v[128:131], a[204:207], a[112:115], v[128:131]
    ds_read_b64_tr_b16 a[194:195], v10 offset:7168
    v_mfma_f32_16x16x32_bf16 v[136:139], a[204:207], a[116:119], v[136:139]
    buffer_load_dwordx4 v2, s[8:11], s36 offen offset:128 lds
    v_mfma_f32_16x16x32_bf16 v[136:139], a[200:203], a[100:103], v[136:139]
    v_mfma_f32_16x16x32_bf16 v[144:147], a[200:203], a[104:107], v[144:147]
    ds_read_b64_tr_b16 a[196:197], v10 offset:13312
    v_mfma_f32_16x16x32_bf16 v[144:147], a[204:207], a[120:123], v[144:147]
    ds_read_b64_tr_b16 a[198:199], v10 offset:19456
    v_mfma_f32_16x16x32_bf16 v[152:155], a[204:207], a[124:127], v[152:155]
    s_add_u32 m0, s49, 50944
    v_mfma_f32_16x16x32_bf16 v[152:155], a[200:203], a[108:111], v[152:155]
    s_waitcnt lgkmcnt(4)
    v_mfma_f32_16x16x32_bf16 v[156:159], a[208:211], a[108:111], v[156:159]
    ds_read_b64_tr_b16 a[200:201], v11 offset:1024
    v_mfma_f32_16x16x32_bf16 v[156:159], a[212:215], a[124:127], v[156:159]
    ds_read_b64_tr_b16 a[202:203], v11 offset:7168
    v_mfma_f32_16x16x32_bf16 v[148:151], a[212:215], a[120:123], v[148:151]
    buffer_load_dwordx4 v2, s[8:11], s36 offen offset:256 lds
    v_mfma_f32_16x16x32_bf16 v[148:151], a[208:211], a[104:107], v[148:151]
    v_mfma_f32_16x16x32_bf16 v[140:143], a[208:211], a[100:103], v[140:143]
    s_add_u32 m0, s49, 52224
    ds_read_b64_tr_b16 a[204:205], v11 offset:13312
    v_mfma_f32_16x16x32_bf16 v[140:143], a[212:215], a[116:119], v[140:143]
    ds_read_b64_tr_b16 a[206:207], v11 offset:19456
    v_mfma_f32_16x16x32_bf16 v[132:135], a[212:215], a[112:115], v[132:135]
    buffer_load_dwordx4 v3, s[8:11], s36 offen offset:0 lds
    v_mfma_f32_16x16x32_bf16 v[132:135], a[208:211], a[96:99], v[132:135]
    s_waitcnt lgkmcnt(4)
    v_mfma_f32_16x16x32_bf16 v[160:163], a[192:195], a[96:99], v[160:163]
    ds_read_b64_tr_b16 a[208:209], v8 offset:2048
    v_mfma_f32_16x16x32_bf16 v[160:163], a[196:199], a[112:115], v[160:163]
    ds_read_b64_tr_b16 a[210:211], v8 offset:8192
    v_mfma_f32_16x16x32_bf16 v[168:171], a[196:199], a[116:119], v[168:171]
    v_mfma_f32_16x16x32_bf16 v[168:171], a[192:195], a[100:103], v[168:171]
    s_add_u32 m0, s49, 53120
    v_mfma_f32_16x16x32_bf16 v[176:179], a[192:195], a[104:107], v[176:179]
    ds_read_b64_tr_b16 a[212:213], v8 offset:14336
    v_mfma_f32_16x16x32_bf16 v[176:179], a[196:199], a[120:123], v[176:179]
    ds_read_b64_tr_b16 a[214:215], v8 offset:20480
    v_mfma_f32_16x16x32_bf16 v[184:187], a[196:199], a[124:127], v[184:187]
    buffer_load_dwordx4 v3, s[8:11], s36 offen offset:128 lds
    v_mfma_f32_16x16x32_bf16 v[184:187], a[192:195], a[108:111], v[184:187]
    s_waitcnt lgkmcnt(4)
    v_add_u32 v8, 0, v12
    v_mfma_f32_16x16x32_bf16 v[188:191], a[200:203], a[108:111], v[188:191]
    ds_read_b64_tr_b16 a[192:193], v9 offset:2048
    v_mfma_f32_16x16x32_bf16 v[188:191], a[204:207], a[124:127], v[188:191]
    s_add_u32 m0, s49, 54016
    ds_read_b64_tr_b16 a[194:195], v9 offset:8192
    v_mfma_f32_16x16x32_bf16 v[180:183], a[204:207], a[120:123], v[180:183]
    buffer_load_dwordx4 v3, s[8:11], s36 offen offset:256 lds
    v_mfma_f32_16x16x32_bf16 v[180:183], a[200:203], a[104:107], v[180:183]
    s_add_u32 s36, s36, s37
    s_sub_u32 s55, s36, 7864320
    s_min_u32 s36, s36, s55
    v_mfma_f32_16x16x32_bf16 v[172:175], a[200:203], a[100:103], v[172:175]
    ds_read_b64_tr_b16 a[196:197], v9 offset:14336
    v_mfma_f32_16x16x32_bf16 v[172:175], a[204:207], a[116:119], v[172:175]
    s_add_u32 s46, s45, 45056
    ds_read_b64_tr_b16 a[198:199], v9 offset:20480
    s_sub_u32 s77, s46, 81920
    v_mfma_f32_16x16x32_bf16 v[164:167], a[204:207], a[112:115], v[164:167]
    s_min_u32 s46, s46, s77
    v_add_u32 v9, 0, v13
    v_mfma_f32_16x16x32_bf16 v[164:167], a[200:203], a[96:99], v[164:167]
    s_waitcnt lgkmcnt(4)
    v_mfma_f32_16x16x32_bf16 v[192:195], a[208:211], a[96:99], v[192:195]
    ds_read_b64_tr_b16 a[200:201], v10 offset:2048
    v_mfma_f32_16x16x32_bf16 v[192:195], a[212:215], a[112:115], v[192:195]
    ds_read_b64_tr_b16 a[202:203], v10 offset:8192
    v_mfma_f32_16x16x32_bf16 v[200:203], a[212:215], a[116:119], v[200:203]
    buffer_load_dwordx4 a[176:179], v28, s[20:23], s46 offen offset:0 sc1
    v_mfma_f32_16x16x32_bf16 v[200:203], a[208:211], a[100:103], v[200:203]
    v_mfma_f32_16x16x32_bf16 v[208:211], a[208:211], a[104:107], v[208:211]
    ds_read_b64_tr_b16 a[204:205], v10 offset:14336
    v_mfma_f32_16x16x32_bf16 v[208:211], a[212:215], a[120:123], v[208:211]
    ds_read_b64_tr_b16 a[206:207], v10 offset:20480
    v_mfma_f32_16x16x32_bf16 v[216:219], a[212:215], a[124:127], v[216:219]
    v_add_u32 v10, 0, v14
    v_mfma_f32_16x16x32_bf16 v[216:219], a[208:211], a[108:111], v[216:219]
    s_waitcnt lgkmcnt(4)
    v_mfma_f32_16x16x32_bf16 v[220:223], a[192:195], a[108:111], v[220:223]
    s_waitcnt vmcnt(13)
    ds_read_b64_tr_b16 a[208:209], v11 offset:2048
    v_xor_b32 v34, s7, v34
    v_mfma_f32_16x16x32_bf16 v[220:223], a[196:199], a[124:127], v[220:223]
    ds_read_b64_tr_b16 a[210:211], v11 offset:8192
    v_xor_b32 v38, s7, v38
    v_mfma_f32_16x16x32_bf16 v[212:215], a[196:199], a[120:123], v[212:215]
    buffer_load_dwordx4 a[180:183], v28, s[20:23], s46 offen offset:1024 sc1
    v_mfma_f32_16x16x32_bf16 v[212:215], a[192:195], a[104:107], v[212:215]
    v_xor_b32 v42, s7, v42
    v_xor_b32 v46, s7, v46
    v_mfma_f32_16x16x32_bf16 v[204:207], a[192:195], a[100:103], v[204:207]
    ds_read_b64_tr_b16 a[212:213], v11 offset:14336
    v_or3_b32 v34, v34, v38, v42
    v_mfma_f32_16x16x32_bf16 v[204:207], a[196:199], a[116:119], v[204:207]
    s_waitcnt vmcnt(35)
    ds_read_b64_tr_b16 a[214:215], v11 offset:20480
    v_or_b32 v34, v34, v46
    v_mfma_f32_16x16x32_bf16 v[196:199], a[196:199], a[112:115], v[196:199]
pg_2:
    s_cbranch_execz pg_ret
    s_barrier
    v_mfma_f32_16x16x32_bf16 v[196:199], a[192:195], a[96:99], v[196:199]
    s_waitcnt lgkmcnt(4)
    v_cmp_ne_u32 vcc, 0, v34
    v_add_u32 v11, 0, v15
    v_mfma_f32_16x16x32_bf16 v[224:227], a[200:203], a[96:99], v[224:227]
    ds_read_b64_tr_b16 a[192:193], v8 offset:0
    v_mfma_f32_16x16x32_bf16 v[224:227], a[204:207], a[112:115], v[224:227]
    ds_read_b64_tr_b16 a[194:195], v8 offset:6144
    v_mfma_f32_16x16x32_bf16 v[232:235], a[204:207], a[116:119], v[232:235]
    s_cbranch_vccnz spin_rec
spin_rec_ret:
    v_max_u32 v20, v32, v33
    v_mfma_f32_16x16x32_bf16 v[232:235], a[200:203], a[100:103], v[232:235]
    buffer_load_dwordx4 a[184:187], v28, s[20:23], s46 offen offset:2048 sc1
    v_mfma_f32_16x16x32_bf16 v[240:243], a[200:203], a[104:107], v[240:243]
    ds_read_b64_tr_b16 a[196:197], v8 offset:12288
    v_min_u32 v21, v32, v33
    v_mfma_f32_16x16x32_bf16 v[240:243], a[204:207], a[120:123], v[240:243]
    ds_read_b64_tr_b16 a[198:199], v8 offset:18432
    v_med3_u32 v21, v20, v21, v36
    v_mfma_f32_16x16x32_bf16 v[248:251], a[204:207], a[124:127], v[248:251]
    buffer_load_dwordx4 a[188:191], v28, s[20:23], s46 offen offset:3072 sc1
    v_mfma_f32_16x16x32_bf16 v[248:251], a[200:203], a[108:111], v[248:251]
    s_waitcnt lgkmcnt(4)
    v_max_u32 v20, v20, v36
    v_med3_u32 v21, v20, v21, v37
    v_mfma_f32_16x16x32_bf16 v[252:255], a[208:211], a[108:111], v[252:255]
    s_add_u32 s46, s45, 49152
    ds_read_b64_tr_b16 a[200:201], v9 offset:0
    v_max_u32 v20, v20, v37
    v_mfma_f32_16x16x32_bf16 v[252:255], a[212:215], a[124:127], v[252:255]
    s_sub_u32 s77, s46, 81920
    ds_read_b64_tr_b16 a[202:203], v9 offset:6144
    v_med3_u32 v21, v20, v21, v40
    v_mfma_f32_16x16x32_bf16 v[244:247], a[212:215], a[120:123], v[244:247]
    s_min_u32 s46, s46, s77
    v_max_u32 v20, v20, v40
    v_med3_u32 v21, v20, v21, v41
    v_mfma_f32_16x16x32_bf16 v[244:247], a[208:211], a[104:107], v[244:247]
    buffer_load_dwordx4 a[0:3], v28, s[20:23], s46 offen offset:0 sc1
    v_mfma_f32_16x16x32_bf16 v[236:239], a[208:211], a[100:103], v[236:239]
    ds_read_b64_tr_b16 a[204:205], v9 offset:12288
    v_max_u32 v20, v20, v41
    v_mfma_f32_16x16x32_bf16 v[236:239], a[212:215], a[116:119], v[236:239]
    s_waitcnt vmcnt(29)
    s_waitcnt vmcnt(15)
    ds_read_b64_tr_b16 a[206:207], v9 offset:18432
    v_mfma_f32_16x16x32_bf16 v[228:231], a[212:215], a[112:115], v[228:231]
    v_med3_u32 v21, v20, v21, v44
    v_max_u32 v20, v20, v44
    v_mfma_f32_16x16x32_bf16 v[228:231], a[208:211], a[96:99], v[228:231]
    s_waitcnt lgkmcnt(4)
    v_med3_u32 v21, v20, v21, v45
    v_max_u32 v20, v20, v45
    v_mfma_f32_16x16x32_bf16 v[64:67], a[192:195], a[128:131], v[64:67]
    ds_read_b64_tr_b16 a[208:209], v10 offset:0
    v_mov_b32_dpp v22, v20 row_ror:8 row_mask:0xf bank_mask:0xf
    v_mfma_f32_16x16x32_bf16 v[64:67], a[196:199], a[144:147], v[64:67]
    ds_read_b64_tr_b16 a[210:211], v10 offset:6144
    v_mov_b32_dpp v23, v21 row_ror:8 row_mask:0xf bank_mask:0xf
    v_mfma_f32_16x16x32_bf16 v[72:75], a[196:199], a[148:151], v[72:75]
    buffer_load_dwordx4 a[4:7], v28, s[20:23], s46 offen offset:1024 sc1
    v_mfma_f32_16x16x32_bf16 v[72:75], a[192:195], a[132:135], v[72:75]
    v_min_u32 v24, v20, v22
    v_max_u32 v20, v20, v22
    v_mfma_f32_16x16x32_bf16 v[80:83], a[192:195], a[136:139], v[80:83]
    ds_read_b64_tr_b16 a[212:213], v10 offset:12288
    v_max3_u32 v21, v24, v21, v23
    v_mfma_f32_16x16x32_bf16 v[80:83], a[196:199], a[152:155], v[80:83]
    ds_read_b64_tr_b16 a[214:215], v10 offset:18432
    v_mov_b32_dpp v22, v20 row_ror:4 row_mask:0xf bank_mask:0xf
    v_mfma_f32_16x16x32_bf16 v[88:91], a[196:199], a[156:159], v[88:91]
    v_mov_b32_dpp v23, v21 row_ror:4 row_mask:0xf bank_mask:0xf
    v_min_u32 v24, v20, v22
    v_mfma_f32_16x16x32_bf16 v[88:91], a[192:195], a[140:143], v[88:91]
    s_waitcnt lgkmcnt(4)
    v_max_u32 v20, v20, v22
    v_max3_u32 v21, v24, v21, v23
    v_mfma_f32_16x16x32_bf16 v[92:95], a[200:203], a[140:143], v[92:95]
    ds_read_b64_tr_b16 a[192:193], v11 offset:0
    v_mov_b32_dpp v22, v20 row_ror:2 row_mask:0xf bank_mask:0xf
    v_mfma_f32_16x16x32_bf16 v[92:95], a[204:207], a[156:159], v[92:95]
    ds_read_b64_tr_b16 a[194:195], v11 offset:6144
    v_mov_b32_dpp v23, v21 row_ror:2 row_mask:0xf bank_mask:0xf
    v_mfma_f32_16x16x32_bf16 v[84:87], a[204:207], a[152:155], v[84:87]
    buffer_load_dwordx4 a[8:11], v28, s[20:23], s46 offen offset:2048 sc1
    v_mfma_f32_16x16x32_bf16 v[84:87], a[200:203], a[136:139], v[84:87]
    v_min_u32 v24, v20, v22
    v_max_u32 v20, v20, v22
    v_mfma_f32_16x16x32_bf16 v[76:79], a[200:203], a[132:135], v[76:79]
    ds_read_b64_tr_b16 a[196:197], v11 offset:12288
    v_max3_u32 v21, v24, v21, v23
    v_mfma_f32_16x16x32_bf16 v[76:79], a[204:207], a[148:151], v[76:79]
    ds_read_b64_tr_b16 a[198:199], v11 offset:18432
    v_mov_b32_dpp v22, v20 row_ror:1 row_mask:0xf bank_mask:0xf
    v_mfma_f32_16x16x32_bf16 v[68:71], a[204:207], a[144:147], v[68:71]
    buffer_load_dwordx4 a[12:15], v28, s[20:23], s46 offen offset:3072 sc1
    v_mfma_f32_16x16x32_bf16 v[68:71], a[200:203], a[128:131], v[68:71]
    s_waitcnt lgkmcnt(4)
    v_mov_b32_dpp v23, v21 row_ror:1 row_mask:0xf bank_mask:0xf
    v_min_u32 v24, v20, v22
    v_mfma_f32_16x16x32_bf16 v[96:99], a[208:211], a[128:131], v[96:99]
    s_andn2_b32 s88, s2, 7
    ds_read_b64_tr_b16 a[200:201], v8 offset:1024
    v_max_u32 v20, v20, v22
    v_mfma_f32_16x16x32_bf16 v[96:99], a[212:215], a[144:147], v[96:99]
    s_lshl_b32 s88, s88, 2
    ds_read_b64_tr_b16 a[202:203], v8 offset:7168
    v_max3_u32 v21, v24, v21, v23
    v_mfma_f32_16x16x32_bf16 v[104:107], a[212:215], a[148:151], v[104:107]
    s_lshr_b32 s89, s53, 1
    v_mov_b32 v22, v20
    v_mov_b32 v23, v21
    v_mfma_f32_16x16x32_bf16 v[104:107], a[208:211], a[132:135], v[104:107]
    s_add_u32 s88, s88, s89
    v_permlane16_swap_b32 v20, v22
    v_mfma_f32_16x16x32_bf16 v[112:115], a[208:211], a[136:139], v[112:115]
    s_add_u32 m0, s49, 73728
    ds_read_b64_tr_b16 a[204:205], v8 offset:13312
    v_lshl_add_u32 v60, v1, 2, s88
    v_mfma_f32_16x16x32_bf16 v[112:115], a[212:215], a[152:155], v[112:115]
    s_andn2_b32 s88, s2, 0x18
    ds_read_b64_tr_b16 a[206:207], v8 offset:19456
    v_accvgpr_write_b32 a96, 1.0
    v_mfma_f32_16x16x32_bf16 v[120:123], a[212:215], a[156:159], v[120:123]
    buffer_load_dwordx4 v2, s[8:11], s36 offen offset:0 lds
    v_mfma_f32_16x16x32_bf16 v[120:123], a[208:211], a[140:143], v[120:123]
    s_waitcnt lgkmcnt(4)
    v_permlane16_swap_b32 v21, v23
    v_mfma_f32_16x16x32_bf16 v[124:127], a[192:195], a[140:143], v[124:127]
    s_lshl_b32 s88, s88, 2
    ds_read_b64_tr_b16 a[208:209], v9 offset:1024
    v_min_u32 v24, v20, v22
    v_mfma_f32_16x16x32_bf16 v[124:127], a[196:199], a[156:159], v[124:127]
    s_add_u32 s88, s88, s3
    ds_read_b64_tr_b16 a[210:211], v9 offset:7168
    v_max_u32 v20, v20, v22
    v_mfma_f32_16x16x32_bf16 v[116:119], a[196:199], a[152:155], v[116:119]
    s_add_u32 m0, s49, 74624
    v_max3_u32 v21, v24, v21, v23
    v_mov_b32 v22, v20
    v_mfma_f32_16x16x32_bf16 v[116:119], a[192:195], a[136:139], v[116:119]
    buffer_load_dwordx4 v2, s[8:11], s36 offen offset:128 lds
    v_mfma_f32_16x16x32_bf16 v[108:111], a[192:195], a[132:135], v[108:111]
    ds_read_b64_tr_b16 a[212:213], v9 offset:13312
    v_mov_b32 v23, v21
    v_mfma_f32_16x16x32_bf16 v[108:111], a[196:199], a[148:151], v[108:111]
    ds_read_b64_tr_b16 a[214:215], v9 offset:19456
    v_and_b32 v61, 3, v1
    v_mfma_f32_16x16x32_bf16 v[100:103], a[196:199], a[144:147], v[100:103]
    v_permlane32_swap_b32 v20, v22
    v_mfma_f32_16x16x32_bf16 v[100:103], a[192:195], a[128:131], v[100:103]
    s_waitcnt lgkmcnt(4)
    v_permlane32_swap_b32 v21, v23
    v_mfma_f32_16x16x32_bf16 v[128:131], a[200:203], a[128:131], v[128:131]
    ds_read_b64_tr_b16 a[192:193], v10 offset:1024
    v_min_u32 v24, v20, v22
    v_mfma_f32_16x16x32_bf16 v[128:131], a[204:207], a[144:147], v[128:131]
    s_add_u32 m0, s49, 75520
    ds_read_b64_tr_b16 a[194:195], v10 offset:7168
    v_max_u32 v20, v20, v22
    v_mfma_f32_16x16x32_bf16 v[136:139], a[204:207], a[148:151], v[136:139]
    buffer_load_dwordx4 v2, s[8:11], s36 offen offset:256 lds
    v_mfma_f32_16x16x32_bf16 v[136:139], a[200:203], a[132:135], v[136:139]
    v_max3_u32 v21, v24, v21, v23
    v_lshl_add_u32 v61, v61, 5, s88
    v_mfma_f32_16x16x32_bf16 v[144:147], a[200:203], a[136:139], v[144:147]
    s_lshl_b32 s56, s3, 3
    ds_read_b64_tr_b16 a[196:197], v10 offset:13312
    v_cmp_gt_u32 s[88:89], 8, v1
    v_mfma_f32_16x16x32_bf16 v[144:147], a[204:207], a[152:155], v[144:147]
    s_add_u32 s56, s56, 147456
    ds_read_b64_tr_b16 a[198:199], v10 offset:19456
    v_mov_b32 v22, s56
    v_mfma_f32_16x16x32_bf16 v[152:155], a[204:207], a[156:159], v[152:155]
    v_mov_b32 v23, 147456
    v_cndmask_b32 v60, v61, v60, s[88:89]
    v_mfma_f32_16x16x32_bf16 v[152:155], a[200:203], a[140:143], v[152:155]
    s_waitcnt lgkmcnt(4)
    v_lshlrev_b32 v61, 2, v1
    v_cmp_gt_u32 s[88:89], 12, v1
    v_mfma_f32_16x16x32_bf16 v[156:159], a[208:211], a[140:143], v[156:159]
    s_add_u32 m0, s49, 76800
    ds_read_b64_tr_b16 a[200:201], v11 offset:1024
    v_cndmask_b32 v60, v61, v60, s[88:89]
    v_mfma_f32_16x16x32_bf16 v[156:159], a[212:215], a[156:159], v[156:159]
    ds_read_b64_tr_b16 a[202:203], v11 offset:7168
    v_lshlrev_b32 v60, 4, v60
    v_mfma_f32_16x16x32_bf16 v[148:151], a[212:215], a[152:155], v[148:151]
    buffer_load_dwordx4 v3, s[8:11], s36 offen offset:0 lds
    v_mfma_f32_16x16x32_bf16 v[148:151], a[208:211], a[136:139], v[148:151]
    v_accvgpr_write_b32 a97, 1.0
    v_accvgpr_write_b32 a98, 1.0
    v_mfma_f32_16x16x32_bf16 v[140:143], a[208:211], a[132:135], v[140:143]
    ds_read_b64_tr_b16 a[204:205], v11 offset:13312
    v_accvgpr_write_b32 a99, 1.0
    v_mfma_f32_16x16x32_bf16 v[140:143], a[212:215], a[148:151], v[140:143]
    ds_read_b64_tr_b16 a[206:207], v11 offset:19456
    v_accvgpr_write_b32 a100, 1.0
    v_mfma_f32_16x16x32_bf16 v[132:135], a[212:215], a[144:147], v[132:135]
    s_add_u32 m0, s49, 77696
    v_accvgpr_write_b32 a101, 1.0
    v_accvgpr_write_b32 a102, 1.0
    v_mfma_f32_16x16x32_bf16 v[132:135], a[208:211], a[128:131], v[132:135]
    s_waitcnt lgkmcnt(4)
    v_accvgpr_write_b32 a103, 1.0
    v_accvgpr_write_b32 a104, 1.0
    v_mfma_f32_16x16x32_bf16 v[160:163], a[192:195], a[128:131], v[160:163]
    ds_read_b64_tr_b16 a[208:209], v8 offset:2048
    v_accvgpr_write_b32 a105, 1.0
    v_mfma_f32_16x16x32_bf16 v[160:163], a[196:199], a[144:147], v[160:163]
    ds_read_b64_tr_b16 a[210:211], v8 offset:8192
    v_accvgpr_write_b32 a106, 1.0
    v_mfma_f32_16x16x32_bf16 v[168:171], a[196:199], a[148:151], v[168:171]
    buffer_load_dwordx4 v3, s[8:11], s36 offen offset:128 lds
    v_mfma_f32_16x16x32_bf16 v[168:171], a[192:195], a[132:135], v[168:171]
    v_accvgpr_write_b32 a107, 1.0
    v_accvgpr_write_b32 a108, 1.0
    v_mfma_f32_16x16x32_bf16 v[176:179], a[192:195], a[136:139], v[176:179]
    s_add_u32 m0, s49, 78592
    ds_read_b64_tr_b16 a[212:213], v8 offset:14336
    v_accvgpr_write_b32 a109, 1.0
    v_mfma_f32_16x16x32_bf16 v[176:179], a[196:199], a[152:155], v[176:179]
    ds_read_b64_tr_b16 a[214:215], v8 offset:20480
    v_accvgpr_write_b32 a110, 1.0
    v_mfma_f32_16x16x32_bf16 v[184:187], a[196:199], a[156:159], v[184:187]
    buffer_load_dwordx4 v3, s[8:11], s36 offen offset:256 lds
    v_mfma_f32_16x16x32_bf16 v[184:187], a[192:195], a[140:143], v[184:187]
    s_waitcnt lgkmcnt(4)
    v_accvgpr_write_b32 a111, 1.0
    v_accvgpr_write_b32 a112, 1.0
    v_mfma_f32_16x16x32_bf16 v[188:191], a[200:203], a[140:143], v[188:191]
    s_add_u32 s36, s36, s37
    ds_read_b64_tr_b16 a[192:193], v9 offset:2048
    v_accvgpr_write_b32 a113, 1.0
    v_mfma_f32_16x16x32_bf16 v[188:191], a[204:207], a[156:159], v[188:191]
    s_sub_u32 s55, s36, 7864320
    ds_read_b64_tr_b16 a[194:195], v9 offset:8192
    v_accvgpr_write_b32 a114, 1.0
    v_mfma_f32_16x16x32_bf16 v[180:183], a[204:207], a[152:155], v[180:183]
    s_min_u32 s36, s36, s55
    ds_write_b64 v22, v[20:21]
    v_accvgpr_write_b32 a115, 1.0
    v_mfma_f32_16x16x32_bf16 v[180:183], a[200:203], a[136:139], v[180:183]
    s_add_u32 s46, s45, 53248
    v_accvgpr_write_b32 a116, 1.0
    v_accvgpr_write_b32 a117, 1.0
    v_mfma_f32_16x16x32_bf16 v[172:175], a[200:203], a[132:135], v[172:175]
    s_sub_u32 s77, s46, 81920
    ds_read_b64_tr_b16 a[196:197], v9 offset:14336
    v_accvgpr_write_b32 a118, 1.0
    v_mfma_f32_16x16x32_bf16 v[172:175], a[204:207], a[148:151], v[172:175]
    s_min_u32 s46, s46, s77
    ds_read_b64_tr_b16 a[198:199], v9 offset:20480
    v_accvgpr_write_b32 a119, 1.0
    v_mfma_f32_16x16x32_bf16 v[164:167], a[204:207], a[144:147], v[164:167]
    buffer_load_dwordx4 a[16:19], v28, s[20:23], s46 offen offset:0 sc1
    v_mfma_f32_16x16x32_bf16 v[164:167], a[200:203], a[128:131], v[164:167]
    s_waitcnt lgkmcnt(4)
    v_accvgpr_write_b32 a120, 1.0
    v_accvgpr_write_b32 a121, 1.0
    v_mfma_f32_16x16x32_bf16 v[192:195], a[208:211], a[128:131], v[192:195]
    ds_read_b64_tr_b16 a[200:201], v10 offset:2048
    v_accvgpr_write_b32 a122, 1.0
    v_mfma_f32_16x16x32_bf16 v[192:195], a[212:215], a[144:147], v[192:195]
    ds_read_b64_tr_b16 a[202:203], v10 offset:8192
    v_accvgpr_write_b32 a123, 1.0
    v_mfma_f32_16x16x32_bf16 v[200:203], a[212:215], a[148:151], v[200:203]
    buffer_load_dwordx4 a[20:23], v28, s[20:23], s46 offen offset:1024 sc1
    v_mfma_f32_16x16x32_bf16 v[200:203], a[208:211], a[132:135], v[200:203]
    v_accvgpr_write_b32 a124, 1.0
    v_accvgpr_write_b32 a125, 1.0
    v_mfma_f32_16x16x32_bf16 v[208:211], a[208:211], a[136:139], v[208:211]
    ds_read_b64_tr_b16 a[204:205], v10 offset:14336
    v_accvgpr_write_b32 a126, 1.0
    v_mfma_f32_16x16x32_bf16 v[208:211], a[212:215], a[152:155], v[208:211]
    ds_read_b64_tr_b16 a[206:207], v10 offset:20480
    v_accvgpr_write_b32 a127, 1.0
    v_mfma_f32_16x16x32_bf16 v[216:219], a[212:215], a[156:159], v[216:219]
    v_add_u32 v8, 24576, v12
    v_add_u32 v9, 24576, v13
    v_mfma_f32_16x16x32_bf16 v[216:219], a[208:211], a[140:143], v[216:219]
    s_waitcnt lgkmcnt(4)
    v_add_u32 v10, 24576, v14
    v_mfma_f32_16x16x32_bf16 v[220:223], a[192:195], a[140:143], v[220:223]
    ds_read_b64_tr_b16 a[208:209], v11 offset:2048
    v_mfma_f32_16x16x32_bf16 v[220:223], a[196:199], a[156:159], v[220:223]
    ds_read_b64_tr_b16 a[210:211], v11 offset:8192
    v_mfma_f32_16x16x32_bf16 v[212:215], a[196:199], a[152:155], v[212:215]
    buffer_load_dwordx4 a[24:27], v28, s[20:23], s46 offen offset:2048 sc1
    v_mfma_f32_16x16x32_bf16 v[212:215], a[192:195], a[136:139], v[212:215]
    v_mfma_f32_16x16x32_bf16 v[204:207], a[192:195], a[132:135], v[204:207]
    ds_read_b64_tr_b16 a[212:213], v11 offset:14336
    v_mfma_f32_16x16x32_bf16 v[204:207], a[196:199], a[148:151], v[204:207]
    s_waitcnt vmcnt(33)
    ds_read_b64_tr_b16 a[214:215], v11 offset:20480
    v_mfma_f32_16x16x32_bf16 v[196:199], a[196:199], a[144:147], v[196:199]
    s_barrier
    v_mfma_f32_16x16x32_bf16 v[196:199], a[192:195], a[128:131], v[196:199]
    s_waitcnt lgkmcnt(4)
    v_add_u32 v11, 24576, v15
    v_mfma_f32_16x16x32_bf16 v[224:227], a[200:203], a[128:131], v[224:227]
    ds_read_b64_tr_b16 a[192:193], v8 offset:0
    v_mfma_f32_16x16x32_bf16 v[224:227], a[204:207], a[144:147], v[224:227]
    ds_read_b64_tr_b16 a[194:195], v8 offset:6144
    v_mfma_f32_16x16x32_bf16 v[232:235], a[204:207], a[148:151], v[232:235]
    ds_read_b128 v[32:35], v23
    v_mfma_f32_16x16x32_bf16 v[232:235], a[200:203], a[132:135], v[232:235]
    ds_read_b128 v[36:39], v23 offset:16
    v_mfma_f32_16x16x32_bf16 v[240:243], a[200:203], a[136:139], v[240:243]
    ds_read_b64_tr_b16 a[196:197], v8 offset:12288
    v_mfma_f32_16x16x32_bf16 v[240:243], a[204:207], a[152:155], v[240:243]
    ds_read_b64_tr_b16 a[198:199], v8 offset:18432
    v_mfma_f32_16x16x32_bf16 v[248:251], a[204:207], a[156:159], v[248:251]
    buffer_load_dwordx4 a[28:31], v28, s[20:23], s46 offen offset:3072 sc1
    v_mfma_f32_16x16x32_bf16 v[248:251], a[200:203], a[140:143], v[248:251]
    s_waitcnt lgkmcnt(4)
    s_add_u32 s46, s45, 57344
    s_sub_u32 s77, s46, 81920
    v_mfma_f32_16x16x32_bf16 v[252:255], a[208:211], a[140:143], v[252:255]
    s_min_u32 s46, s46, s77
    ds_read_b64_tr_b16 a[200:201], v9 offset:0
    v_mfma_f32_16x16x32_bf16 v[252:255], a[212:215], a[156:159], v[252:255]
    ds_read_b64_tr_b16 a[202:203], v9 offset:6144
    v_mfma_f32_16x16x32_bf16 v[244:247], a[212:215], a[152:155], v[244:247]
    buffer_load_dwordx4 a[32:35], v28, s[20:23], s46 offen offset:0 sc1
    v_mfma_f32_16x16x32_bf16 v[244:247], a[208:211], a[136:139], v[244:247]
    v_mfma_f32_16x16x32_bf16 v[236:239], a[208:211], a[132:135], v[236:239]
    ds_read_b64_tr_b16 a[204:205], v9 offset:12288
    v_mfma_f32_16x16x32_bf16 v[236:239], a[212:215], a[148:151], v[236:239]
    s_waitcnt vmcnt(25)
    s_waitcnt vmcnt(15)
    ds_read_b64_tr_b16 a[206:207], v9 offset:18432
    v_mfma_f32_16x16x32_bf16 v[228:231], a[212:215], a[144:147], v[228:231]
    buffer_load_dwordx4 a[36:39], v28, s[20:23], s46 offen offset:1024 sc1
    v_mfma_f32_16x16x32_bf16 v[228:231], a[208:211], a[128:131], v[228:231]
    s_waitcnt lgkmcnt(4)
    v_mfma_f32_16x16x32_bf16 v[64:67], a[192:195], a[160:163], v[64:67]
    ds_read_b64_tr_b16 a[208:209], v10 offset:0
    v_mfma_f32_16x16x32_bf16 v[64:67], a[196:199], a[176:179], v[64:67]
    ds_read_b64_tr_b16 a[210:211], v10 offset:6144
    v_accvgpr_write_b32 a128, 1.0
    v_mfma_f32_16x16x32_bf16 v[72:75], a[196:199], a[180:183], v[72:75]
    v_accvgpr_write_b32 a129, 1.0
    v_mfma_f32_16x16x32_bf16 v[72:75], a[192:195], a[164:167], v[72:75]
    buffer_load_dwordx4 a[40:43], v28, s[20:23], s46 offen offset:2048 sc1
    v_mfma_f32_16x16x32_bf16 v[80:83], a[192:195], a[168:171], v[80:83]
    ds_read_b64_tr_b16 a[212:213], v10 offset:12288
    v_max_u32 v20, v32, v33
    v_mfma_f32_16x16x32_bf16 v[80:83], a[196:199], a[184:187], v[80:83]
    ds_read_b64_tr_b16 a[214:215], v10 offset:18432
    v_min_u32 v21, v32, v33
    v_mfma_f32_16x16x32_bf16 v[88:91], a[196:199], a[188:191], v[88:91]
    v_med3_u32 v21, v20, v21, v34
    v_max_u32 v20, v20, v34
    v_mfma_f32_16x16x32_bf16 v[88:91], a[192:195], a[172:175], v[88:91]
    s_waitcnt lgkmcnt(4)
    v_med3_u32 v21, v20, v21, v35
    v_max_u32 v20, v20, v35
    v_mfma_f32_16x16x32_bf16 v[92:95], a[200:203], a[172:175], v[92:95]
    ds_read_b64_tr_b16 a[192:193], v11 offset:0
    v_med3_u32 v21, v20, v21, v36
    v_mfma_f32_16x16x32_bf16 v[92:95], a[204:207], a[188:191], v[92:95]
    ds_read_b64_tr_b16 a[194:195], v11 offset:6144
    v_max_u32 v20, v20, v36
    v_mfma_f32_16x16x32_bf16 v[84:87], a[204:207], a[184:187], v[84:87]
    buffer_load_dwordx4 a[44:47], v28, s[20:23], s46 offen offset:3072 sc1
    v_mfma_f32_16x16x32_bf16 v[84:87], a[200:203], a[168:171], v[84:87]
    v_med3_u32 v21, v20, v21, v37
    v_max_u32 v20, v20, v37
    v_mfma_f32_16x16x32_bf16 v[76:79], a[200:203], a[164:167], v[76:79]
    ds_read_b64_tr_b16 a[196:197], v11 offset:12288
    v_med3_u32 v21, v20, v21, v38
    v_mfma_f32_16x16x32_bf16 v[76:79], a[204:207], a[180:183], v[76:79]
    ds_read_b64_tr_b16 a[198:199], v11 offset:18432
    v_max_u32 v20, v20, v38
    v_mfma_f32_16x16x32_bf16 v[68:71], a[204:207], a[176:179], v[68:71]
    v_med3_u32 v21, v20, v21, v39
    v_max_u32 v20, v20, v39
    v_mfma_f32_16x16x32_bf16 v[68:71], a[200:203], a[160:163], v[68:71]
    s_waitcnt lgkmcnt(4)
    v_and_b32 v22, 1, v1
    v_cmp_eq_u32 vcc, 1, v22
    v_mfma_f32_16x16x32_bf16 v[96:99], a[208:211], a[160:163], v[96:99]
    s_add_u32 m0, s49, 98304
    ds_read_b64_tr_b16 a[200:201], v8 offset:1024
    v_readfirstlane_b32 s70, v20
    v_mfma_f32_16x16x32_bf16 v[96:99], a[212:215], a[176:179], v[96:99]
    ds_read_b64_tr_b16 a[202:203], v8 offset:7168
    v_readfirstlane_b32 s71, v21
    v_mfma_f32_16x16x32_bf16 v[104:107], a[212:215], a[180:183], v[104:107]
    buffer_load_dwordx4 v2, s[8:11], s36 offen offset:0 lds
    v_mfma_f32_16x16x32_bf16 v[104:107], a[208:211], a[164:167], v[104:107]
    v_cndmask_b32 v22, v20, v21, vcc
    v_and_b32 v22, 0x7ff, v22
    v_mfma_f32_16x16x32_bf16 v[112:115], a[208:211], a[168:171], v[112:115]
    ds_read_b64_tr_b16 a[204:205], v8 offset:13312
    v_sub_u32 v22, 2047, v22
    v_mfma_f32_16x16x32_bf16 v[112:115], a[212:215], a[184:187], v[112:115]
    s_add_u32 m0, s49, 99200
    ds_read_b64_tr_b16 a[206:207], v8 offset:19456
    v_mul_u32_u24 v23, 1280, v22
    v_mfma_f32_16x16x32_bf16 v[120:123], a[212:215], a[188:191], v[120:123]
    buffer_load_dwordx4 v2, s[8:11], s36 offen offset:128 lds
    v_mfma_f32_16x16x32_bf16 v[120:123], a[208:211], a[172:175], v[120:123]
    s_waitcnt lgkmcnt(4)
    v_lshrrev_b32 v24, 4, v1
    v_lshl_add_u32 v23, v24, 4, v23
    v_mfma_f32_16x16x32_bf16 v[124:127], a[192:195], a[172:175], v[124:127]
    ds_read_b64_tr_b16 a[208:209], v9 offset:1024
    v_add_u32 v23, s61, v23
    v_mfma_f32_16x16x32_bf16 v[124:127], a[196:199], a[188:191], v[124:127]
    ds_read_b64_tr_b16 a[210:211], v9 offset:7168
    v_lshlrev_b32 v24, 3, v22
    v_mfma_f32_16x16x32_bf16 v[116:119], a[196:199], a[184:187], v[116:119]
    s_mov_b32 s56, 3211264
    v_accvgpr_write_b32 a130, 1.0
    v_accvgpr_write_b32 a131, 1.0
    v_mfma_f32_16x16x32_bf16 v[116:119], a[192:195], a[168:171], v[116:119]
    v_accvgpr_write_b32 a132, 1.0
    v_accvgpr_write_b32 a133, 1.0
    v_mfma_f32_16x16x32_bf16 v[108:111], a[192:195], a[164:167], v[108:111]
    s_add_u32 m0, s49, 100096
    ds_read_b64_tr_b16 a[212:213], v9 offset:13312
    v_accvgpr_write_b32 a134, 1.0
    v_mfma_f32_16x16x32_bf16 v[108:111], a[196:199], a[180:183], v[108:111]
    ds_read_b64_tr_b16 a[214:215], v9 offset:19456
    v_accvgpr_write_b32 a135, 1.0
    v_mfma_f32_16x16x32_bf16 v[100:103], a[196:199], a[176:179], v[100:103]
    buffer_load_dwordx4 v2, s[8:11], s36 offen offset:256 lds
    v_mfma_f32_16x16x32_bf16 v[100:103], a[192:195], a[160:163], v[100:103]
    s_waitcnt lgkmcnt(4)
    v_accvgpr_write_b32 a136, 1.0
    v_accvgpr_write_b32 a137, 1.0
    v_mfma_f32_16x16x32_bf16 v[128:131], a[200:203], a[160:163], v[128:131]
    ds_read_b64_tr_b16 a[192:193], v10 offset:1024
    v_accvgpr_write_b32 a138, 1.0
    v_mfma_f32_16x16x32_bf16 v[128:131], a[204:207], a[176:179], v[128:131]
    ds_read_b64_tr_b16 a[194:195], v10 offset:7168
    v_accvgpr_write_b32 a139, 1.0
    v_mfma_f32_16x16x32_bf16 v[136:139], a[204:207], a[180:183], v[136:139]
    s_add_u32 m0, s49, 101376
    v_accvgpr_write_b32 a140, 1.0
    v_accvgpr_write_b32 a141, 1.0
    v_mfma_f32_16x16x32_bf16 v[136:139], a[200:203], a[164:167], v[136:139]
    buffer_load_dwordx4 v3, s[8:11], s36 offen offset:0 lds
    v_mfma_f32_16x16x32_bf16 v[144:147], a[200:203], a[168:171], v[144:147]
    ds_read_b64_tr_b16 a[196:197], v10 offset:13312
    v_accvgpr_write_b32 a142, 1.0
    v_mfma_f32_16x16x32_bf16 v[144:147], a[204:207], a[184:187], v[144:147]
    ds_read_b64_tr_b16 a[198:199], v10 offset:19456
    v_accvgpr_write_b32 a143, 1.0
    v_mfma_f32_16x16x32_bf16 v[152:155], a[204:207], a[188:191], v[152:155]
    v_accvgpr_write_b32 a144, 1.0
    v_accvgpr_write_b32 a145, 1.0
    v_mfma_f32_16x16x32_bf16 v[152:155], a[200:203], a[172:175], v[152:155]
    s_waitcnt lgkmcnt(4)
    v_accvgpr_write_b32 a146, 1.0
    v_accvgpr_write_b32 a147, 1.0
    v_mfma_f32_16x16x32_bf16 v[156:159], a[208:211], a[172:175], v[156:159]
    ds_read_b64_tr_b16 a[200:201], v11 offset:1024
    v_accvgpr_write_b32 a148, 1.0
    v_mfma_f32_16x16x32_bf16 v[156:159], a[212:215], a[188:191], v[156:159]
    s_add_u32 m0, s49, 102272
    ds_read_b64_tr_b16 a[202:203], v11 offset:7168
    v_accvgpr_write_b32 a149, 1.0
    v_mfma_f32_16x16x32_bf16 v[148:151], a[212:215], a[184:187], v[148:151]
    buffer_load_dwordx4 v3, s[8:11], s36 offen offset:128 lds
    v_mfma_f32_16x16x32_bf16 v[148:151], a[208:211], a[168:171], v[148:151]
    v_accvgpr_write_b32 a150, 1.0
    v_accvgpr_write_b32 a151, 1.0
    v_mfma_f32_16x16x32_bf16 v[140:143], a[208:211], a[164:167], v[140:143]
    ds_read_b64_tr_b16 a[204:205], v11 offset:13312
    v_accvgpr_write_b32 a152, 1.0
    v_mfma_f32_16x16x32_bf16 v[140:143], a[212:215], a[180:183], v[140:143]
    ds_read_b64_tr_b16 a[206:207], v11 offset:19456
    v_accvgpr_write_b32 a153, 1.0
    v_mfma_f32_16x16x32_bf16 v[132:135], a[212:215], a[176:179], v[132:135]
    v_accvgpr_write_b32 a154, 1.0
    v_accvgpr_write_b32 a155, 1.0
    v_mfma_f32_16x16x32_bf16 v[132:135], a[208:211], a[160:163], v[132:135]
    s_waitcnt lgkmcnt(4)
    v_accvgpr_write_b32 a156, 1.0
    v_accvgpr_write_b32 a157, 1.0
    v_mfma_f32_16x16x32_bf16 v[160:163], a[192:195], a[160:163], v[160:163]
    s_add_u32 m0, s49, 103168
    ds_read_b64_tr_b16 a[208:209], v8 offset:2048
    v_accvgpr_write_b32 a158, 1.0
    v_mfma_f32_16x16x32_bf16 v[160:163], a[196:199], a[176:179], v[160:163]
    ds_read_b64_tr_b16 a[210:211], v8 offset:8192
    v_accvgpr_write_b32 a159, 1.0
    v_mfma_f32_16x16x32_bf16 v[168:171], a[196:199], a[180:183], v[168:171]
    buffer_load_dwordx4 v3, s[8:11], s36 offen offset:256 lds
    v_mfma_f32_16x16x32_bf16 v[168:171], a[192:195], a[164:167], v[168:171]
    s_add_u32 s36, s36, s37
    s_sub_u32 s55, s36, 7864320
    s_min_u32 s36, s36, s55
    v_mfma_f32_16x16x32_bf16 v[176:179], a[192:195], a[168:171], v[176:179]
    s_add_u32 s46, s45, 61440
    ds_read_b64_tr_b16 a[212:213], v8 offset:14336
    s_sub_u32 s77, s46, 81920
    v_mfma_f32_16x16x32_bf16 v[176:179], a[196:199], a[184:187], v[176:179]
    s_min_u32 s46, s46, s77
    ds_read_b64_tr_b16 a[214:215], v8 offset:20480
    v_mfma_f32_16x16x32_bf16 v[184:187], a[196:199], a[188:191], v[184:187]
    v_add_u32 v8, 49152, v12
    v_mfma_f32_16x16x32_bf16 v[184:187], a[192:195], a[172:175], v[184:187]
    s_waitcnt lgkmcnt(4)
    v_mfma_f32_16x16x32_bf16 v[188:191], a[200:203], a[172:175], v[188:191]
    ds_read_b64_tr_b16 a[192:193], v9 offset:2048
    v_mfma_f32_16x16x32_bf16 v[188:191], a[204:207], a[188:191], v[188:191]
    ds_read_b64_tr_b16 a[194:195], v9 offset:8192
    v_mfma_f32_16x16x32_bf16 v[180:183], a[204:207], a[184:187], v[180:183]
    buffer_load_dwordx4 a[48:51], v28, s[20:23], s46 offen offset:0 sc1
    v_mfma_f32_16x16x32_bf16 v[180:183], a[200:203], a[168:171], v[180:183]
    v_mfma_f32_16x16x32_bf16 v[172:175], a[200:203], a[164:167], v[172:175]
    ds_read_b64_tr_b16 a[196:197], v9 offset:14336
    v_mfma_f32_16x16x32_bf16 v[172:175], a[204:207], a[180:183], v[172:175]
    ds_read_b64_tr_b16 a[198:199], v9 offset:20480
    v_mfma_f32_16x16x32_bf16 v[164:167], a[204:207], a[176:179], v[164:167]
    buffer_load_dwordx4 a[52:55], v28, s[20:23], s46 offen offset:1024 sc1
    v_mfma_f32_16x16x32_bf16 v[164:167], a[200:203], a[160:163], v[164:167]
    s_waitcnt lgkmcnt(4)
    v_add_u32 v9, 49152, v13
    v_mfma_f32_16x16x32_bf16 v[192:195], a[208:211], a[160:163], v[192:195]
    ds_read_b64_tr_b16 a[200:201], v10 offset:2048
    v_mfma_f32_16x16x32_bf16 v[192:195], a[212:215], a[176:179], v[192:195]
    ds_read_b64_tr_b16 a[202:203], v10 offset:8192
    v_mfma_f32_16x16x32_bf16 v[200:203], a[212:215], a[180:183], v[200:203]
    v_mfma_f32_16x16x32_bf16 v[200:203], a[208:211], a[164:167], v[200:203]
    v_mfma_f32_16x16x32_bf16 v[208:211], a[208:211], a[168:171], v[208:211]
    ds_read_b64_tr_b16 a[204:205], v10 offset:14336
    v_mfma_f32_16x16x32_bf16 v[208:211], a[212:215], a[184:187], v[208:211]
    ds_read_b64_tr_b16 a[206:207], v10 offset:20480
    v_mfma_f32_16x16x32_bf16 v[216:219], a[212:215], a[188:191], v[216:219]
    buffer_load_dwordx4 a[56:59], v28, s[20:23], s46 offen offset:2048 sc1
    v_mfma_f32_16x16x32_bf16 v[216:219], a[208:211], a[172:175], v[216:219]
    s_waitcnt lgkmcnt(4)
    v_add_u32 v10, 49152, v14
    v_mfma_f32_16x16x32_bf16 v[220:223], a[192:195], a[172:175], v[220:223]
    ds_read_b64_tr_b16 a[208:209], v11 offset:2048
    v_mfma_f32_16x16x32_bf16 v[220:223], a[196:199], a[188:191], v[220:223]
    ds_read_b64_tr_b16 a[210:211], v11 offset:8192
    v_mfma_f32_16x16x32_bf16 v[212:215], a[196:199], a[184:187], v[212:215]
    buffer_load_dwordx4 a[60:63], v28, s[20:23], s46 offen offset:3072 sc1
    v_mfma_f32_16x16x32_bf16 v[212:215], a[192:195], a[168:171], v[212:215]
    v_mfma_f32_16x16x32_bf16 v[204:207], a[192:195], a[164:167], v[204:207]
    ds_read_b64_tr_b16 a[212:213], v11 offset:14336
    v_mfma_f32_16x16x32_bf16 v[204:207], a[196:199], a[180:183], v[204:207]
    s_waitcnt vmcnt(32)
    ds_read_b64_tr_b16 a[214:215], v11 offset:20480
    v_mfma_f32_16x16x32_bf16 v[196:199], a[196:199], a[176:179], v[196:199]
    s_barrier
    v_mfma_f32_16x16x32_bf16 v[196:199], a[192:195], a[160:163], v[196:199]
    s_waitcnt lgkmcnt(4)
    global_load_dwordx4 v[48:51], v23, s[64:65]
    v_mfma_f32_16x16x32_bf16 v[224:227], a[200:203], a[160:163], v[224:227]
    ds_read_b64_tr_b16 a[192:193], v8 offset:0
    v_add_u32 v11, 49152, v15
    v_mfma_f32_16x16x32_bf16 v[224:227], a[204:207], a[176:179], v[224:227]
    s_add_u32 m0, s44, 147456
    ds_read_b64_tr_b16 a[194:195], v8 offset:6144
    v_mfma_f32_16x16x32_bf16 v[232:235], a[204:207], a[180:183], v[232:235]
pg_3:
    s_cbranch_execz pg_ret
    global_load_dwordx4 v[52:55], v23, s[64:65] offset:64
    v_mfma_f32_16x16x32_bf16 v[232:235], a[200:203], a[164:167], v[232:235]
    buffer_load_dwordx2 v[40:41], v24, s[24:27], s56 offen sc1
    v_mfma_f32_16x16x32_bf16 v[240:243], a[200:203], a[168:171], v[240:243]
    ds_read_b64_tr_b16 a[196:197], v8 offset:12288
    v_bfe_u32 v26, v1, 2, 3
    v_mfma_f32_16x16x32_bf16 v[240:243], a[204:207], a[184:187], v[240:243]
    ds_read_b64_tr_b16 a[198:199], v8 offset:18432
    v_lshlrev_b32 v25, 7, v26
    v_mfma_f32_16x16x32_bf16 v[248:251], a[204:207], a[188:191], v[248:251]
    buffer_load_dword v61, v60, s[24:27], s47 offen offset:12 sc1
    v_mfma_f32_16x16x32_bf16 v[248:251], a[200:203], a[172:175], v[248:251]
    s_waitcnt lgkmcnt(4)
    buffer_load_dwordx4 v56, s[28:31], s60 offen lds
    v_mfma_f32_16x16x32_bf16 v[252:255], a[208:211], a[172:175], v[252:255]
    s_add_u32 m0, s44, 148480
    ds_read_b64_tr_b16 a[200:201], v9 offset:0
    v_lshrrev_b32 v26, 1, v26
    v_mfma_f32_16x16x32_bf16 v[252:255], a[212:215], a[188:191], v[252:255]
    ds_read_b64_tr_b16 a[202:203], v9 offset:6144
    v_xor_b32 v26, s3, v26
    v_mfma_f32_16x16x32_bf16 v[244:247], a[212:215], a[184:187], v[244:247]
    buffer_load_dwordx4 v56, s[32:35], s60 offen lds
    v_mfma_f32_16x16x32_bf16 v[244:247], a[208:211], a[168:171], v[244:247]
    s_add_u32 m0, s44, 149504
    v_lshl_add_u32 v25, v26, 5, v25
    v_and_b32 v26, 3, v1
    v_mfma_f32_16x16x32_bf16 v[236:239], a[208:211], a[164:167], v[236:239]
    ds_read_b64_tr_b16 a[204:205], v9 offset:12288
    v_lshl_add_u32 v25, v26, 3, v25
    v_mfma_f32_16x16x32_bf16 v[236:239], a[212:215], a[180:183], v[236:239]
    s_waitcnt vmcnt(30)
    s_waitcnt vmcnt(20)
    ds_read_b64_tr_b16 a[206:207], v9 offset:18432
    v_mfma_f32_16x16x32_bf16 v[228:231], a[212:215], a[176:179], v[228:231]
    buffer_load_dwordx4 v57, s[28:31], s60 offen lds
    v_mfma_f32_16x16x32_bf16 v[228:231], a[208:211], a[160:163], v[228:231]
    s_waitcnt lgkmcnt(4)
    v_lshrrev_b32 v26, 5, v1
    v_mul_u32_u24 v26, 2048, v26
    v_mfma_f32_16x16x32_bf16 v[64:67], a[192:195], a[0:3], v[64:67]
    s_add_u32 m0, s44, 150528
    ds_read_b64_tr_b16 a[208:209], v10 offset:0
    v_add_u32 v25, v25, v26
    v_mfma_f32_16x16x32_bf16 v[64:67], a[196:199], a[16:19], v[64:67]
    ds_read_b64_tr_b16 a[210:211], v10 offset:6144
    v_add_u32 v25, 147456, v25
    v_mfma_f32_16x16x32_bf16 v[72:75], a[196:199], a[20:23], v[72:75]
    buffer_load_dwordx4 v57, s[32:35], s60 offen lds
    v_mfma_f32_16x16x32_bf16 v[72:75], a[192:195], a[4:7], v[72:75]
    v_lshlrev_b32 v26, 4, v1
    v_cmp_gt_u32 vcc, 16, v1
    v_mfma_f32_16x16x32_bf16 v[80:83], a[192:195], a[8:11], v[80:83]
    ds_read_b64_tr_b16 a[212:213], v10 offset:12288
    v_mov_b32 v27, 0x7ffffff0
    v_mfma_f32_16x16x32_bf16 v[80:83], a[196:199], a[24:27], v[80:83]
    ds_read_b64_tr_b16 a[214:215], v10 offset:18432
    v_cndmask_b32 v26, v27, v26, vcc
    v_mfma_f32_16x16x32_bf16 v[88:91], a[196:199], a[28:31], v[88:91]
    v_accvgpr_write_b32 a160, 1.0
    v_mfma_f32_16x16x32_bf16 v[88:91], a[192:195], a[12:15], v[88:91]
    s_waitcnt lgkmcnt(4)
    v_accvgpr_write_b32 a161, 1.0
    v_mfma_f32_16x16x32_bf16 v[92:95], a[200:203], a[12:15], v[92:95]
    s_add_u32 s46, s45, 65536
    ds_read_b64_tr_b16 a[192:193], v11 offset:0
    v_accvgpr_write_b32 a162, 1.0
    v_mfma_f32_16x16x32_bf16 v[92:95], a[204:207], a[28:31], v[92:95]
    s_sub_u32 s77, s46, 81920
    ds_read_b64_tr_b16 a[194:195], v11 offset:6144
    v_accvgpr_write_b32 a163, 1.0
    v_mfma_f32_16x16x32_bf16 v[84:87], a[204:207], a[24:27], v[84:87]
    s_min_u32 s46, s46, s77
    v_accvgpr_write_b32 a164, 1.0
    v_mfma_f32_16x16x32_bf16 v[84:87], a[200:203], a[8:11], v[84:87]
    buffer_load_dwordx4 a[64:67], v28, s[20:23], s46 offen offset:0 sc1
    v_mfma_f32_16x16x32_bf16 v[76:79], a[200:203], a[4:7], v[76:79]
    ds_read_b64_tr_b16 a[196:197], v11 offset:12288
    v_accvgpr_write_b32 a165, 1.0
    v_mfma_f32_16x16x32_bf16 v[76:79], a[204:207], a[20:23], v[76:79]
    ds_read_b64_tr_b16 a[198:199], v11 offset:18432
    v_accvgpr_write_b32 a166, 1.0
    v_mfma_f32_16x16x32_bf16 v[68:71], a[204:207], a[16:19], v[68:71]
    v_accvgpr_write_b32 a167, 1.0
    v_mfma_f32_16x16x32_bf16 v[68:71], a[200:203], a[0:3], v[68:71]
    s_waitcnt lgkmcnt(4)
    v_accvgpr_write_b32 a168, 1.0
    v_mfma_f32_16x16x32_bf16 v[96:99], a[208:211], a[0:3], v[96:99]
    ds_read_b64_tr_b16 a[200:201], v8 offset:1024
    v_accvgpr_write_b32 a169, 1.0
    v_mfma_f32_16x16x32_bf16 v[96:99], a[212:215], a[16:19], v[96:99]
    ds_read_b64_tr_b16 a[202:203], v8 offset:7168
    v_accvgpr_write_b32 a170, 1.0
    v_mfma_f32_16x16x32_bf16 v[104:107], a[212:215], a[20:23], v[104:107]
    buffer_load_dwordx4 a[68:71], v28, s[20:23], s46 offen offset:1024 sc1
    v_mfma_f32_16x16x32_bf16 v[104:107], a[208:211], a[4:7], v[104:107]
    v_accvgpr_write_b32 a171, 1.0
    v_accvgpr_write_b32 a172, 1.0
    v_mfma_f32_16x16x32_bf16 v[112:115], a[208:211], a[8:11], v[112:115]
    ds_read_b64_tr_b16 a[204:205], v8 offset:13312
    v_accvgpr_write_b32 a173, 1.0
    v_mfma_f32_16x16x32_bf16 v[112:115], a[212:215], a[24:27], v[112:115]
    ds_read_b64_tr_b16 a[206:207], v8 offset:19456
    v_accvgpr_write_b32 a174, 1.0
    v_mfma_f32_16x16x32_bf16 v[120:123], a[212:215], a[28:31], v[120:123]
    v_accvgpr_write_b32 a175, 1.0
    v_accvgpr_write_b32 a176, 1.0
    v_mfma_f32_16x16x32_bf16 v[120:123], a[208:211], a[12:15], v[120:123]
    s_waitcnt lgkmcnt(4)
    v_accvgpr_write_b32 a177, 1.0
    v_accvgpr_write_b32 a178, 1.0
    v_mfma_f32_16x16x32_bf16 v[124:127], a[192:195], a[12:15], v[124:127]
    ds_read_b64_tr_b16 a[208:209], v9 offset:1024
    v_accvgpr_write_b32 a179, 1.0
    v_mfma_f32_16x16x32_bf16 v[124:127], a[196:199], a[28:31], v[124:127]
    ds_read_b64_tr_b16 a[210:211], v9 offset:7168
    v_accvgpr_write_b32 a180, 1.0
    v_mfma_f32_16x16x32_bf16 v[116:119], a[196:199], a[24:27], v[116:119]
    buffer_load_dwordx4 a[72:75], v28, s[20:23], s46 offen offset:2048 sc1
    v_mfma_f32_16x16x32_bf16 v[116:119], a[192:195], a[8:11], v[116:119]
    v_accvgpr_write_b32 a181, 1.0
    v_accvgpr_write_b32 a182, 1.0
    v_mfma_f32_16x16x32_bf16 v[108:111], a[192:195], a[4:7], v[108:111]
    ds_read_b64_tr_b16 a[212:213], v9 offset:13312
    v_accvgpr_write_b32 a183, 1.0
    v_mfma_f32_16x16x32_bf16 v[108:111], a[196:199], a[20:23], v[108:111]
    ds_read_b64_tr_b16 a[214:215], v9 offset:19456
    v_accvgpr_write_b32 a184, 1.0
    v_mfma_f32_16x16x32_bf16 v[100:103], a[196:199], a[16:19], v[100:103]
    buffer_load_dwordx4 a[76:79], v28, s[20:23], s46 offen offset:3072 sc1
    v_mfma_f32_16x16x32_bf16 v[100:103], a[192:195], a[0:3], v[100:103]
    s_waitcnt lgkmcnt(4)
    v_accvgpr_write_b32 a185, 1.0
    v_accvgpr_write_b32 a186, 1.0
    v_mfma_f32_16x16x32_bf16 v[128:131], a[200:203], a[0:3], v[128:131]
    ds_read_b64_tr_b16 a[192:193], v10 offset:1024
    v_accvgpr_write_b32 a187, 1.0
    v_mfma_f32_16x16x32_bf16 v[128:131], a[204:207], a[16:19], v[128:131]
    ds_read_b64_tr_b16 a[194:195], v10 offset:7168
    v_accvgpr_write_b32 a188, 1.0
    v_mfma_f32_16x16x32_bf16 v[136:139], a[204:207], a[20:23], v[136:139]
    v_accvgpr_write_b32 a189, 1.0
    v_accvgpr_write_b32 a190, 1.0
    v_mfma_f32_16x16x32_bf16 v[136:139], a[200:203], a[4:7], v[136:139]
    v_accvgpr_write_b32 a191, 1.0
    v_mfma_f32_16x16x32_bf16 v[144:147], a[200:203], a[8:11], v[144:147]
    s_add_u32 m0, s49, 122880
    ds_read_b64_tr_b16 a[196:197], v10 offset:13312
    v_mfma_f32_16x16x32_bf16 v[144:147], a[204:207], a[24:27], v[144:147]
    ds_read_b64_tr_b16 a[198:199], v10 offset:19456
    v_mfma_f32_16x16x32_bf16 v[152:155], a[204:207], a[28:31], v[152:155]
    buffer_load_dwordx4 v2, s[8:11], s36 offen offset:0 lds
    v_mfma_f32_16x16x32_bf16 v[152:155], a[200:203], a[12:15], v[152:155]
    s_waitcnt lgkmcnt(4)
    v_mfma_f32_16x16x32_bf16 v[156:159], a[208:211], a[12:15], v[156:159]
    ds_read_b64_tr_b16 a[200:201], v11 offset:1024
    v_mfma_f32_16x16x32_bf16 v[156:159], a[212:215], a[28:31], v[156:159]
    ds_read_b64_tr_b16 a[202:203], v11 offset:7168
    v_mfma_f32_16x16x32_bf16 v[148:151], a[212:215], a[24:27], v[148:151]
    s_add_u32 m0, s49, 123776
    v_mfma_f32_16x16x32_bf16 v[148:151], a[208:211], a[8:11], v[148:151]
    buffer_load_dwordx4 v2, s[8:11], s36 offen offset:128 lds
    v_mfma_f32_16x16x32_bf16 v[140:143], a[208:211], a[4:7], v[140:143]
    ds_read_b64_tr_b16 a[204:205], v11 offset:13312
    v_mfma_f32_16x16x32_bf16 v[140:143], a[212:215], a[20:23], v[140:143]
    ds_read_b64_tr_b16 a[206:207], v11 offset:19456
    v_mfma_f32_16x16x32_bf16 v[132:135], a[212:215], a[16:19], v[132:135]
    v_mfma_f32_16x16x32_bf16 v[132:135], a[208:211], a[0:3], v[132:135]
    s_waitcnt lgkmcnt(4)
    v_mfma_f32_16x16x32_bf16 v[160:163], a[192:195], a[0:3], v[160:163]
    ds_read_b64_tr_b16 a[208:209], v8 offset:2048
    v_mfma_f32_16x16x32_bf16 v[160:163], a[196:199], a[16:19], v[160:163]
    s_add_u32 m0, s49, 124672
    ds_read_b64_tr_b16 a[210:211], v8 offset:8192
    v_mfma_f32_16x16x32_bf16 v[168:171], a[196:199], a[20:23], v[168:171]
    buffer_load_dwordx4 v2, s[8:11], s36 offen offset:256 lds
    v_mfma_f32_16x16x32_bf16 v[168:171], a[192:195], a[4:7], v[168:171]
    v_mfma_f32_16x16x32_bf16 v[176:179], a[192:195], a[8:11], v[176:179]
    ds_read_b64_tr_b16 a[212:213], v8 offset:14336
    v_mfma_f32_16x16x32_bf16 v[176:179], a[196:199], a[24:27], v[176:179]
    ds_read_b64_tr_b16 a[214:215], v8 offset:20480
    v_mfma_f32_16x16x32_bf16 v[184:187], a[196:199], a[28:31], v[184:187]
    v_add_u32 v8, 73728, v12
    v_mfma_f32_16x16x32_bf16 v[184:187], a[192:195], a[12:15], v[184:187]
    s_waitcnt lgkmcnt(4)
    s_add_u32 m0, s49, 125952
    v_mfma_f32_16x16x32_bf16 v[188:191], a[200:203], a[12:15], v[188:191]
    ds_read_b64_tr_b16 a[192:193], v9 offset:2048
    v_mfma_f32_16x16x32_bf16 v[188:191], a[204:207], a[28:31], v[188:191]
    ds_read_b64_tr_b16 a[194:195], v9 offset:8192
    v_mfma_f32_16x16x32_bf16 v[180:183], a[204:207], a[24:27], v[180:183]
    buffer_load_dwordx4 v3, s[8:11], s36 offen offset:0 lds
    v_mfma_f32_16x16x32_bf16 v[180:183], a[200:203], a[8:11], v[180:183]
    v_mfma_f32_16x16x32_bf16 v[172:175], a[200:203], a[4:7], v[172:175]
    ds_read_b64_tr_b16 a[196:197], v9 offset:14336
    v_mfma_f32_16x16x32_bf16 v[172:175], a[204:207], a[20:23], v[172:175]
    ds_read_b64_tr_b16 a[198:199], v9 offset:20480
    v_mfma_f32_16x16x32_bf16 v[164:167], a[204:207], a[16:19], v[164:167]
    s_add_u32 m0, s49, 126848
    v_add_u32 v9, 73728, v13
    v_mfma_f32_16x16x32_bf16 v[164:167], a[200:203], a[0:3], v[164:167]
    s_waitcnt lgkmcnt(4)
    v_mfma_f32_16x16x32_bf16 v[192:195], a[208:211], a[0:3], v[192:195]
    ds_read_b64_tr_b16 a[200:201], v10 offset:2048
    v_mfma_f32_16x16x32_bf16 v[192:195], a[212:215], a[16:19], v[192:195]
    ds_read_b64_tr_b16 a[202:203], v10 offset:8192
    v_mfma_f32_16x16x32_bf16 v[200:203], a[212:215], a[20:23], v[200:203]
    buffer_load_dwordx4 v3, s[8:11], s36 offen offset:128 lds
    v_mfma_f32_16x16x32_bf16 v[200:203], a[208:211], a[4:7], v[200:203]
    v_mfma_f32_16x16x32_bf16 v[208:211], a[208:211], a[8:11], v[208:211]
    s_add_u32 m0, s49, 127744
    ds_read_b64_tr_b16 a[204:205], v10 offset:14336
    v_mfma_f32_16x16x32_bf16 v[208:211], a[212:215], a[24:27], v[208:211]
    ds_read_b64_tr_b16 a[206:207], v10 offset:20480
    v_mfma_f32_16x16x32_bf16 v[216:219], a[212:215], a[28:31], v[216:219]
    buffer_load_dwordx4 v3, s[8:11], s36 offen offset:256 lds
    v_mfma_f32_16x16x32_bf16 v[216:219], a[208:211], a[12:15], v[216:219]
    s_waitcnt lgkmcnt(4)
    v_add_u32 v10, 73728, v14
    s_add_u32 s36, s36, s37
    v_mfma_f32_16x16x32_bf16 v[220:223], a[192:195], a[12:15], v[220:223]
    s_sub_u32 s55, s36, 7864320
    ds_read_b64_tr_b16 a[208:209], v11 offset:2048
    s_min_u32 s36, s36, s55
    v_mfma_f32_16x16x32_bf16 v[220:223], a[196:199], a[28:31], v[220:223]
    s_add_u32 s46, s45, 69632
    ds_read_b64_tr_b16 a[210:211], v11 offset:8192
    s_sub_u32 s77, s46, 81920
    v_mfma_f32_16x16x32_bf16 v[212:215], a[196:199], a[24:27], v[212:215]
    s_min_u32 s46, s46, s77
    v_mfma_f32_16x16x32_bf16 v[212:215], a[192:195], a[8:11], v[212:215]
    v_mfma_f32_16x16x32_bf16 v[204:207], a[192:195], a[4:7], v[204:207]
    ds_read_b64_tr_b16 a[212:213], v11 offset:14336
    v_mfma_f32_16x16x32_bf16 v[204:207], a[196:199], a[20:23], v[204:207]
    s_waitcnt vmcnt(36)
    ds_read_b64_tr_b16 a[214:215], v11 offset:20480
    v_mfma_f32_16x16x32_bf16 v[196:199], a[196:199], a[16:19], v[196:199]
    s_barrier
    v_mfma_f32_16x16x32_bf16 v[196:199], a[192:195], a[0:3], v[196:199]
    s_waitcnt lgkmcnt(4)
    buffer_load_dwordx4 a[80:83], v28, s[20:23], s46 offen offset:0 sc1
    v_mfma_f32_16x16x32_bf16 v[224:227], a[200:203], a[0:3], v[224:227]
    ds_read_b64_tr_b16 a[192:193], v8 offset:0
    v_add_u32 v11, 73728, v15
    v_mfma_f32_16x16x32_bf16 v[224:227], a[204:207], a[16:19], v[224:227]
    ds_read_b64_tr_b16 a[194:195], v8 offset:6144
    v_mfma_f32_16x16x32_bf16 v[232:235], a[204:207], a[20:23], v[232:235]
    buffer_load_dwordx4 a[84:87], v28, s[20:23], s46 offen offset:1024 sc1
    v_mfma_f32_16x16x32_bf16 v[232:235], a[200:203], a[4:7], v[232:235]
    v_mfma_f32_16x16x32_bf16 v[240:243], a[200:203], a[8:11], v[240:243]
    ds_read_b64_tr_b16 a[196:197], v8 offset:12288
    v_mfma_f32_16x16x32_bf16 v[240:243], a[204:207], a[24:27], v[240:243]
    ds_read_b64_tr_b16 a[198:199], v8 offset:18432
    v_mfma_f32_16x16x32_bf16 v[248:251], a[204:207], a[28:31], v[248:251]
    v_mfma_f32_16x16x32_bf16 v[248:251], a[200:203], a[12:15], v[248:251]
    s_waitcnt lgkmcnt(4)
    v_mfma_f32_16x16x32_bf16 v[252:255], a[208:211], a[12:15], v[252:255]
    ds_read_b64_tr_b16 a[200:201], v9 offset:0
    v_mfma_f32_16x16x32_bf16 v[252:255], a[212:215], a[28:31], v[252:255]
    ds_read_b64_tr_b16 a[202:203], v9 offset:6144
    v_mfma_f32_16x16x32_bf16 v[244:247], a[212:215], a[24:27], v[244:247]
    buffer_load_dwordx4 a[88:91], v28, s[20:23], s46 offen offset:2048 sc1
    v_mfma_f32_16x16x32_bf16 v[244:247], a[208:211], a[8:11], v[244:247]
    v_mfma_f32_16x16x32_bf16 v[236:239], a[208:211], a[4:7], v[236:239]
    ds_read_b64_tr_b16 a[204:205], v9 offset:12288
    v_mfma_f32_16x16x32_bf16 v[236:239], a[212:215], a[20:23], v[236:239]
    s_waitcnt vmcnt(31)
    s_waitcnt vmcnt(21)
    ds_read_b64_tr_b16 a[206:207], v9 offset:18432
    v_mfma_f32_16x16x32_bf16 v[228:231], a[212:215], a[16:19], v[228:231]
    v_mfma_f32_16x16x32_bf16 v[228:231], a[208:211], a[0:3], v[228:231]
    s_waitcnt lgkmcnt(4)
    v_mfma_f32_16x16x32_bf16 v[64:67], a[192:195], a[32:35], v[64:67]
    ds_read_b64_tr_b16 a[208:209], v10 offset:0
    v_mfma_f32_16x16x32_bf16 v[64:67], a[196:199], a[48:51], v[64:67]
    ds_read_b64_tr_b16 a[210:211], v10 offset:6144
    v_accvgpr_write_b32 a0, 1.0
    v_mfma_f32_16x16x32_bf16 v[72:75], a[196:199], a[52:55], v[72:75]
    buffer_load_dwordx4 a[92:95], v28, s[20:23], s46 offen offset:3072 sc1
    v_mfma_f32_16x16x32_bf16 v[72:75], a[192:195], a[36:39], v[72:75]
    s_add_u32 s46, s45, 73728
    v_accvgpr_write_b32 a1, 1.0
    v_mfma_f32_16x16x32_bf16 v[80:83], a[192:195], a[40:43], v[80:83]
    s_sub_u32 s77, s46, 81920
    ds_read_b64_tr_b16 a[212:213], v10 offset:12288
    v_accvgpr_write_b32 a2, 1.0
    v_mfma_f32_16x16x32_bf16 v[80:83], a[196:199], a[56:59], v[80:83]
    s_min_u32 s46, s46, s77
    ds_read_b64_tr_b16 a[214:215], v10 offset:18432
    v_accvgpr_write_b32 a3, 1.0
    v_mfma_f32_16x16x32_bf16 v[88:91], a[196:199], a[60:63], v[88:91]
    buffer_load_dwordx4 a[224:227], v28, s[20:23], s46 offen offset:0 sc1
    v_mfma_f32_16x16x32_bf16 v[88:91], a[192:195], a[44:47], v[88:91]
    s_waitcnt lgkmcnt(4)
    v_accvgpr_write_b32 a4, 1.0
    v_mfma_f32_16x16x32_bf16 v[92:95], a[200:203], a[44:47], v[92:95]
    s_waitcnt vmcnt(20)
    ds_read_b64_tr_b16 a[192:193], v11 offset:0
    v_lshlrev_b32 v42, 16, v48
    v_mfma_f32_16x16x32_bf16 v[92:95], a[204:207], a[60:63], v[92:95]
    ds_read_b64_tr_b16 a[194:195], v11 offset:6144
    v_and_b32 v43, 0xffff0000, v48
    v_mfma_f32_16x16x32_bf16 v[84:87], a[204:207], a[56:59], v[84:87]
    v_sub_f32 v42, v42, v40
    v_sub_f32 v43, v43, v40
    v_mfma_f32_16x16x32_bf16 v[84:87], a[200:203], a[40:43], v[84:87]
    v_cvt_pk_bf16_f32 v44, v42, v43
    v_lshlrev_b32 v42, 16, v44
    v_mfma_f32_16x16x32_bf16 v[76:79], a[200:203], a[36:39], v[76:79]
    ds_read_b64_tr_b16 a[196:197], v11 offset:12288
    v_and_b32 v43, 0xffff0000, v44
    v_mfma_f32_16x16x32_bf16 v[76:79], a[204:207], a[52:55], v[76:79]
    ds_read_b64_tr_b16 a[198:199], v11 offset:18432
    v_mul_f32 v42, v42, v41
    v_mfma_f32_16x16x32_bf16 v[68:71], a[204:207], a[48:51], v[68:71]
    buffer_load_dwordx4 a[228:231], v28, s[20:23], s46 offen offset:1024 sc1
    v_mfma_f32_16x16x32_bf16 v[68:71], a[200:203], a[32:35], v[68:71]
    s_waitcnt lgkmcnt(4)
    v_mul_f32 v43, v43, v41
    v_cvt_pk_bf16_f32 v48, v42, v43
    v_mfma_f32_16x16x32_bf16 v[96:99], a[208:211], a[32:35], v[96:99]
    ds_read_b64_tr_b16 a[200:201], v8 offset:1024
    v_lshlrev_b32 v42, 16, v49
    v_mfma_f32_16x16x32_bf16 v[96:99], a[212:215], a[48:51], v[96:99]
    ds_read_b64_tr_b16 a[202:203], v8 offset:7168
    v_and_b32 v43, 0xffff0000, v49
    v_mfma_f32_16x16x32_bf16 v[104:107], a[212:215], a[52:55], v[104:107]
    s_waitcnt vmcnt(20)
    v_sub_f32 v42, v42, v40
    v_sub_f32 v43, v43, v40
    v_mfma_f32_16x16x32_bf16 v[104:107], a[208:211], a[36:39], v[104:107]
    buffer_load_dwordx4 a[232:235], v28, s[20:23], s46 offen offset:2048 sc1
    v_mfma_f32_16x16x32_bf16 v[112:115], a[208:211], a[40:43], v[112:115]
    ds_read_b64_tr_b16 a[204:205], v8 offset:13312
    v_cvt_pk_bf16_f32 v44, v42, v43
    v_mfma_f32_16x16x32_bf16 v[112:115], a[212:215], a[56:59], v[112:115]
    ds_read_b64_tr_b16 a[206:207], v8 offset:19456
    v_lshlrev_b32 v42, 16, v44
    v_mfma_f32_16x16x32_bf16 v[120:123], a[212:215], a[60:63], v[120:123]
    v_and_b32 v43, 0xffff0000, v44
    v_mul_f32 v42, v42, v41
    v_mfma_f32_16x16x32_bf16 v[120:123], a[208:211], a[44:47], v[120:123]
    s_waitcnt lgkmcnt(4)
    v_mul_f32 v43, v43, v41
    v_cvt_pk_bf16_f32 v49, v42, v43
    v_mfma_f32_16x16x32_bf16 v[124:127], a[192:195], a[44:47], v[124:127]
    ds_read_b64_tr_b16 a[208:209], v9 offset:1024
    v_lshlrev_b32 v42, 16, v50
    v_mfma_f32_16x16x32_bf16 v[124:127], a[196:199], a[60:63], v[124:127]
    ds_read_b64_tr_b16 a[210:211], v9 offset:7168
    v_and_b32 v43, 0xffff0000, v50
    v_mfma_f32_16x16x32_bf16 v[116:119], a[196:199], a[56:59], v[116:119]
    buffer_load_dwordx4 a[236:239], v28, s[20:23], s46 offen offset:3072 sc1
    v_mfma_f32_16x16x32_bf16 v[116:119], a[192:195], a[40:43], v[116:119]
    v_sub_f32 v42, v42, v40
    v_sub_f32 v43, v43, v40
    v_mfma_f32_16x16x32_bf16 v[108:111], a[192:195], a[36:39], v[108:111]
    s_add_u32 s46, s45, 77824
    ds_read_b64_tr_b16 a[212:213], v9 offset:13312
    v_cvt_pk_bf16_f32 v44, v42, v43
    v_mfma_f32_16x16x32_bf16 v[108:111], a[196:199], a[52:55], v[108:111]
    s_sub_u32 s77, s46, 81920
    ds_read_b64_tr_b16 a[214:215], v9 offset:19456
    v_lshlrev_b32 v42, 16, v44
    v_mfma_f32_16x16x32_bf16 v[100:103], a[196:199], a[48:51], v[100:103]
    s_min_u32 s46, s46, s77
    v_and_b32 v43, 0xffff0000, v44
    v_mul_f32 v42, v42, v41
    v_mfma_f32_16x16x32_bf16 v[100:103], a[192:195], a[32:35], v[100:103]
    s_waitcnt lgkmcnt(4)
    v_mul_f32 v43, v43, v41
    v_cvt_pk_bf16_f32 v50, v42, v43
    v_mfma_f32_16x16x32_bf16 v[128:131], a[200:203], a[32:35], v[128:131]
    ds_read_b64_tr_b16 a[192:193], v10 offset:1024
    v_lshlrev_b32 v42, 16, v51
    v_mfma_f32_16x16x32_bf16 v[128:131], a[204:207], a[48:51], v[128:131]
    ds_read_b64_tr_b16 a[194:195], v10 offset:7168
    v_and_b32 v43, 0xffff0000, v51
    v_mfma_f32_16x16x32_bf16 v[136:139], a[204:207], a[52:55], v[136:139]
    buffer_load_dwordx4 a[240:243], v28, s[20:23], s46 offen offset:0 sc1
    v_mfma_f32_16x16x32_bf16 v[136:139], a[200:203], a[36:39], v[136:139]
    v_sub_f32 v42, v42, v40
    v_sub_f32 v43, v43, v40
    v_mfma_f32_16x16x32_bf16 v[144:147], a[200:203], a[40:43], v[144:147]
    ds_read_b64_tr_b16 a[196:197], v10 offset:13312
    v_cvt_pk_bf16_f32 v44, v42, v43
    v_mfma_f32_16x16x32_bf16 v[144:147], a[204:207], a[56:59], v[144:147]
    ds_read_b64_tr_b16 a[198:199], v10 offset:19456
    v_lshlrev_b32 v42, 16, v44
    v_mfma_f32_16x16x32_bf16 v[152:155], a[204:207], a[60:63], v[152:155]
    buffer_load_dwordx4 a[244:247], v28, s[20:23], s46 offen offset:1024 sc1
    v_mfma_f32_16x16x32_bf16 v[152:155], a[200:203], a[44:47], v[152:155]
    s_waitcnt lgkmcnt(4)
    v_and_b32 v43, 0xffff0000, v44
    v_mul_f32 v42, v42, v41
    v_mfma_f32_16x16x32_bf16 v[156:159], a[208:211], a[44:47], v[156:159]
    ds_read_b64_tr_b16 a[200:201], v11 offset:1024
    v_mul_f32 v43, v43, v41
    v_mfma_f32_16x16x32_bf16 v[156:159], a[212:215], a[60:63], v[156:159]
    ds_read_b64_tr_b16 a[202:203], v11 offset:7168
    v_cvt_pk_bf16_f32 v51, v42, v43
    v_mfma_f32_16x16x32_bf16 v[148:151], a[212:215], a[56:59], v[148:151]
    v_lshlrev_b32 v42, 16, v52
    v_and_b32 v43, 0xffff0000, v52
    v_mfma_f32_16x16x32_bf16 v[148:151], a[208:211], a[40:43], v[148:151]
    v_sub_f32 v42, v42, v40
    v_sub_f32 v43, v43, v40
    v_mfma_f32_16x16x32_bf16 v[140:143], a[208:211], a[36:39], v[140:143]
    ds_read_b64_tr_b16 a[204:205], v11 offset:13312
    v_cvt_pk_bf16_f32 v44, v42, v43
    v_mfma_f32_16x16x32_bf16 v[140:143], a[212:215], a[52:55], v[140:143]
    ds_read_b64_tr_b16 a[206:207], v11 offset:19456
    v_lshlrev_b32 v42, 16, v44
    v_mfma_f32_16x16x32_bf16 v[132:135], a[212:215], a[48:51], v[132:135]
    buffer_load_dwordx4 a[248:251], v28, s[20:23], s46 offen offset:2048 sc1
    v_mfma_f32_16x16x32_bf16 v[132:135], a[208:211], a[32:35], v[132:135]
    s_waitcnt lgkmcnt(4)
    v_and_b32 v43, 0xffff0000, v44
    v_mul_f32 v42, v42, v41
    v_mfma_f32_16x16x32_bf16 v[160:163], a[192:195], a[32:35], v[160:163]
    ds_read_b64_tr_b16 a[208:209], v8 offset:2048
    v_mul_f32 v43, v43, v41
    v_mfma_f32_16x16x32_bf16 v[160:163], a[196:199], a[48:51], v[160:163]
    ds_read_b64_tr_b16 a[210:211], v8 offset:8192
    v_cvt_pk_bf16_f32 v52, v42, v43
    v_mfma_f32_16x16x32_bf16 v[168:171], a[196:199], a[52:55], v[168:171]
    v_lshlrev_b32 v42, 16, v53
    v_and_b32 v43, 0xffff0000, v53
    v_mfma_f32_16x16x32_bf16 v[168:171], a[192:195], a[36:39], v[168:171]
    buffer_load_dwordx4 a[252:255], v28, s[20:23], s46 offen offset:3072 sc1
    v_mfma_f32_16x16x32_bf16 v[176:179], a[192:195], a[40:43], v[176:179]
    ds_read_b64_tr_b16 a[212:213], v8 offset:14336
    v_sub_f32 v42, v42, v40
    v_mfma_f32_16x16x32_bf16 v[176:179], a[196:199], a[56:59], v[176:179]
    ds_read_b64_tr_b16 a[214:215], v8 offset:20480
    v_sub_f32 v43, v43, v40
    v_mfma_f32_16x16x32_bf16 v[184:187], a[196:199], a[60:63], v[184:187]
    v_cvt_pk_bf16_f32 v44, v42, v43
    v_lshlrev_b32 v42, 16, v44
    v_mfma_f32_16x16x32_bf16 v[184:187], a[192:195], a[44:47], v[184:187]
    s_waitcnt lgkmcnt(4)
    v_and_b32 v43, 0xffff0000, v44
    v_mul_f32 v42, v42, v41
    v_mfma_f32_16x16x32_bf16 v[188:191], a[200:203], a[44:47], v[188:191]
    ds_read_b64_tr_b16 a[192:193], v9 offset:2048
    v_mul_f32 v43, v43, v41
    v_mfma_f32_16x16x32_bf16 v[188:191], a[204:207], a[60:63], v[188:191]
    s_add_u32 m0, s49, 0
    ds_read_b64_tr_b16 a[194:195], v9 offset:8192
    v_cvt_pk_bf16_f32 v53, v42, v43
    v_mfma_f32_16x16x32_bf16 v[180:183], a[204:207], a[56:59], v[180:183]
    buffer_load_dwordx4 v4, s[12:15], s38 offen offset:0 lds
    v_mfma_f32_16x16x32_bf16 v[180:183], a[200:203], a[40:43], v[180:183]
    v_lshlrev_b32 v42, 16, v54
    v_and_b32 v43, 0xffff0000, v54
    v_mfma_f32_16x16x32_bf16 v[172:175], a[200:203], a[36:39], v[172:175]
    ds_read_b64_tr_b16 a[196:197], v9 offset:14336
    v_sub_f32 v42, v42, v40
    v_mfma_f32_16x16x32_bf16 v[172:175], a[204:207], a[52:55], v[172:175]
    ds_read_b64_tr_b16 a[198:199], v9 offset:20480
    v_sub_f32 v43, v43, v40
    v_mfma_f32_16x16x32_bf16 v[164:167], a[204:207], a[48:51], v[164:167]
    v_cvt_pk_bf16_f32 v44, v42, v43
    v_lshlrev_b32 v42, 16, v44
    v_mfma_f32_16x16x32_bf16 v[164:167], a[200:203], a[32:35], v[164:167]
    s_waitcnt lgkmcnt(4)
    v_and_b32 v43, 0xffff0000, v44
    v_mul_f32 v42, v42, v41
    v_mfma_f32_16x16x32_bf16 v[192:195], a[208:211], a[32:35], v[192:195]
    s_add_u32 m0, s49, 896
    ds_read_b64_tr_b16 a[200:201], v10 offset:2048
    v_mul_f32 v43, v43, v41
    v_mfma_f32_16x16x32_bf16 v[192:195], a[212:215], a[48:51], v[192:195]
    ds_read_b64_tr_b16 a[202:203], v10 offset:8192
    v_cvt_pk_bf16_f32 v54, v42, v43
    v_mfma_f32_16x16x32_bf16 v[200:203], a[212:215], a[52:55], v[200:203]
    buffer_load_dwordx4 v4, s[12:15], s38 offen offset:128 lds
    v_mfma_f32_16x16x32_bf16 v[200:203], a[208:211], a[36:39], v[200:203]
    v_lshlrev_b32 v42, 16, v55
    v_and_b32 v43, 0xffff0000, v55
    v_mfma_f32_16x16x32_bf16 v[208:211], a[208:211], a[40:43], v[208:211]
    ds_read_b64_tr_b16 a[204:205], v10 offset:14336
    v_sub_f32 v42, v42, v40
    v_mfma_f32_16x16x32_bf16 v[208:211], a[212:215], a[56:59], v[208:211]
    ds_read_b64_tr_b16 a[206:207], v10 offset:20480
    v_sub_f32 v43, v43, v40
    v_mfma_f32_16x16x32_bf16 v[216:219], a[212:215], a[60:63], v[216:219]
    s_add_u32 m0, s49, 1792
    v_cvt_pk_bf16_f32 v44, v42, v43
    v_lshlrev_b32 v42, 16, v44
    v_mfma_f32_16x16x32_bf16 v[216:219], a[208:211], a[44:47], v[216:219]
    s_waitcnt lgkmcnt(4)
    v_and_b32 v43, 0xffff0000, v44
    v_mul_f32 v42, v42, v41
    v_mfma_f32_16x16x32_bf16 v[220:223], a[192:195], a[44:47], v[220:223]
    ds_read_b64_tr_b16 a[208:209], v11 offset:2048
    v_mul_f32 v43, v43, v41
    v_mfma_f32_16x16x32_bf16 v[220:223], a[196:199], a[60:63], v[220:223]
    ds_read_b64_tr_b16 a[210:211], v11 offset:8192
    v_cvt_pk_bf16_f32 v55, v42, v43
    v_mfma_f32_16x16x32_bf16 v[212:215], a[196:199], a[56:59], v[212:215]
    buffer_load_dwordx4 v4, s[12:15], s38 offen offset:256 lds
    v_mfma_f32_16x16x32_bf16 v[212:215], a[192:195], a[40:43], v[212:215]
    v_lshrrev_b32 v60, 14, v61
    v_and_b32 v61, 0x2000, v61
    v_mfma_f32_16x16x32_bf16 v[204:207], a[192:195], a[36:39], v[204:207]
    s_add_u32 m0, s49, 3072
    ds_read_b64_tr_b16 a[212:213], v11 offset:14336
    v_cmp_ne_u32 s[88:89], 0, v60
    v_mfma_f32_16x16x32_bf16 v[204:207], a[196:199], a[52:55], v[204:207]
    s_waitcnt vmcnt(25)
    ds_read_b64_tr_b16 a[214:215], v11 offset:20480
    v_accvgpr_write_b32 a5, 1.0
    v_mfma_f32_16x16x32_bf16 v[196:199], a[196:199], a[48:51], v[196:199]
    s_barrier
    v_mfma_f32_16x16x32_bf16 v[196:199], a[192:195], a[32:35], v[196:199]
    s_waitcnt lgkmcnt(4)
    buffer_load_dwordx4 v5, s[12:15], s38 offen offset:0 lds
    v_add_u32 v8, 98304, v12
    v_mfma_f32_16x16x32_bf16 v[224:227], a[200:203], a[32:35], v[224:227]
    s_lshr_b64 s[88:89], s[88:89], 12
    ds_read_b64_tr_b16 a[192:193], v8 offset:0
    v_accvgpr_write_b32 a6, 1.0
    v_mfma_f32_16x16x32_bf16 v[224:227], a[204:207], a[48:51], v[224:227]
    s_bcnt1_i32_b64 s93, s[88:89]
    ds_read_b64_tr_b16 a[194:195], v8 offset:6144
    v_cmp_ne_u32 s[88:89], 0, v61
    v_mfma_f32_16x16x32_bf16 v[232:235], a[204:207], a[52:55], v[232:235]
    s_cmp_gt_u32 s93, 26
    s_cselect_b32 s93, -1, 0
    v_accvgpr_write_b32 a7, 1.0
    v_mfma_f32_16x16x32_bf16 v[232:235], a[200:203], a[36:39], v[232:235]
    s_add_u32 m0, s49, 3968
    v_accvgpr_write_b32 a8, 1.0
    v_accvgpr_write_b32 a9, 1.0
    v_mfma_f32_16x16x32_bf16 v[240:243], a[200:203], a[40:43], v[240:243]
    s_xor_b32 s88, s88, s93
    ds_read_b64_tr_b16 a[196:197], v8 offset:12288
    v_accvgpr_write_b32 a10, 1.0
    v_mfma_f32_16x16x32_bf16 v[240:243], a[204:207], a[56:59], v[240:243]
    s_and_b32 s88, s88, 0xfff
    ds_read_b64_tr_b16 a[198:199], v8 offset:18432
    v_accvgpr_write_b32 a11, 1.0
    v_mfma_f32_16x16x32_bf16 v[248:251], a[204:207], a[60:63], v[248:251]
    buffer_load_dwordx4 v5, s[12:15], s38 offen offset:128 lds
    v_mfma_f32_16x16x32_bf16 v[248:251], a[200:203], a[44:47], v[248:251]
    s_waitcnt lgkmcnt(4)
    v_accvgpr_write_b32 a12, 1.0
    v_accvgpr_write_b32 a13, 1.0
    v_add_u32 v9, 98304, v13
    v_mfma_f32_16x16x32_bf16 v[252:255], a[208:211], a[44:47], v[252:255]
    s_lshl_b32 s93, s88, 13
    ds_read_b64_tr_b16 a[200:201], v9 offset:0
    v_accvgpr_write_b32 a14, 1.0
    v_mfma_f32_16x16x32_bf16 v[252:255], a[212:215], a[60:63], v[252:255]
    s_add_u32 m0, s49, 4864
    ds_read_b64_tr_b16 a[202:203], v9 offset:6144
    v_accvgpr_write_b32 a15, 1.0
    v_mfma_f32_16x16x32_bf16 v[244:247], a[212:215], a[56:59], v[244:247]
    buffer_load_dwordx4 v5, s[12:15], s38 offen offset:256 lds
    v_mfma_f32_16x16x32_bf16 v[244:247], a[208:211], a[40:43], v[244:247]
pg_4:
    s_cbranch_execz pg_8
    s_add_u32 s38, s38, 24576
    v_accvgpr_write_b32 a16, 1.0
    v_accvgpr_write_b32 a17, 1.0
    v_mfma_f32_16x16x32_bf16 v[236:239], a[208:211], a[36:39], v[236:239]
    s_add_u32 s88, s51, 8
    ds_read_b64_tr_b16 a[204:205], v9 offset:12288
    v_accvgpr_write_b32 a18, 1.0
    v_mfma_f32_16x16x32_bf16 v[236:239], a[212:215], a[52:55], v[236:239]
    s_waitcnt vmcnt(24)
    s_waitcnt vmcnt(14)
    ds_read_b64_tr_b16 a[206:207], v9 offset:18432
    v_mfma_f32_16x16x32_bf16 v[228:231], a[212:215], a[48:51], v[228:231]
    s_lshr_b32 s88, s93, s88
    v_accvgpr_write_b32 a19, 1.0
    v_accvgpr_write_b32 a20, 1.0
    v_mfma_f32_16x16x32_bf16 v[228:231], a[208:211], a[32:35], v[228:231]
    s_waitcnt lgkmcnt(4)
    v_accvgpr_write_b32 a21, 1.0
    v_accvgpr_write_b32 a22, 1.0
    v_add_u32 v10, 98304, v14
    v_mfma_f32_16x16x32_bf16 v[64:67], a[192:195], a[64:67], v[64:67]
    s_add_u32 m0, s49, 24576
    ds_read_b64_tr_b16 a[208:209], v10 offset:0
    v_accvgpr_write_b32 a23, 1.0
    v_mfma_f32_16x16x32_bf16 v[64:67], a[196:199], a[80:83], v[64:67]
    s_and_b32 s88, s88, 0x2000
    ds_read_b64_tr_b16 a[210:211], v10 offset:6144
    v_accvgpr_write_b32 a24, 1.0
    v_mfma_f32_16x16x32_bf16 v[72:75], a[196:199], a[84:87], v[72:75]
    s_add_u32 s5, s5, s88
    ds_read_b64_tr_b16 v[32:33], v25 offset:0
    v_accvgpr_write_b32 a25, 1.0
    v_mfma_f32_16x16x32_bf16 v[72:75], a[192:195], a[68:71], v[72:75]
    s_lshl_b32 s88, s52, 15
    ds_read_b64_tr_b16 v[34:35], v25 offset:4096
    v_accvgpr_write_b32 a26, 1.0
    v_mfma_f32_16x16x32_bf16 v[80:83], a[192:195], a[72:75], v[80:83]
    s_lshl_b32 s89, s53, 9
    ds_read_b64_tr_b16 a[212:213], v10 offset:12288
    v_accvgpr_write_b32 a27, 1.0
    v_mfma_f32_16x16x32_bf16 v[80:83], a[196:199], a[88:91], v[80:83]
    s_add_u32 s88, s88, s89
    ds_read_b64_tr_b16 a[214:215], v10 offset:18432
    v_accvgpr_write_b32 a28, 1.0
    v_mfma_f32_16x16x32_bf16 v[88:91], a[196:199], a[92:95], v[88:91]
    s_lshl_b32 s89, s3, 7
    ds_read_b64_tr_b16 v[36:37], v25 offset:1024
    v_accvgpr_write_b32 a29, 1.0
    v_mfma_f32_16x16x32_bf16 v[88:91], a[192:195], a[76:79], v[88:91]
    s_waitcnt lgkmcnt(4)
    buffer_load_dwordx4 v4, s[12:15], s38 offen offset:0 lds
    v_add_u32 v11, 98304, v15
    v_mfma_f32_16x16x32_bf16 v[92:95], a[200:203], a[76:79], v[92:95]
    s_add_u32 m0, s49, 25472
    ds_read_b64_tr_b16 a[192:193], v11 offset:0
    v_accvgpr_write_b32 a30, 1.0
    v_mfma_f32_16x16x32_bf16 v[92:95], a[204:207], a[92:95], v[92:95]
    s_add_u32 s88, s88, s89
    ds_read_b64_tr_b16 a[194:195], v11 offset:6144
    v_accvgpr_write_b32 a31, 1.0
    v_mfma_f32_16x16x32_bf16 v[84:87], a[204:207], a[88:91], v[84:87]
    s_add_u32 s88, s88, 4456452
    ds_read_b64_tr_b16 v[38:39], v25 offset:5120
    v_accvgpr_write_b32 a32, 1.0
    v_mfma_f32_16x16x32_bf16 v[84:87], a[200:203], a[72:75], v[84:87]
    s_lshr_b32 s89, s93, 8
    ds_read_b64_tr_b16 v[40:41], v25 offset:8192
    v_lshrrev_b32 v60, v1, s89
    v_mfma_f32_16x16x32_bf16 v[76:79], a[200:203], a[68:71], v[76:79]
    ds_read_b64_tr_b16 a[196:197], v11 offset:12288
    v_and_b32 v60, 0x2000, v60
    v_mfma_f32_16x16x32_bf16 v[76:79], a[204:207], a[84:87], v[76:79]
    ds_read_b64_tr_b16 a[198:199], v11 offset:18432
    v_add_u32 v60, s88, v60
    v_mfma_f32_16x16x32_bf16 v[68:71], a[204:207], a[80:83], v[68:71]
    ds_read_b64_tr_b16 v[42:43], v25 offset:12288
    v_bfe_u32 v61, v1, 1, 1
    v_mfma_f32_16x16x32_bf16 v[68:71], a[200:203], a[64:67], v[68:71]
    s_waitcnt lgkmcnt(4)
    buffer_load_dwordx4 v4, s[12:15], s38 offen offset:128 lds
    v_mfma_f32_16x16x32_bf16 v[96:99], a[208:211], a[64:67], v[96:99]
    s_add_u32 m0, s49, 26368
    ds_read_b64_tr_b16 a[200:201], v8 offset:1024
    v_lshl_add_u32 v60, v61, 14, v60
    v_mfma_f32_16x16x32_bf16 v[96:99], a[212:215], a[80:83], v[96:99]
    ds_read_b64_tr_b16 a[202:203], v8 offset:7168
    v_and_b32 v61, 1, v1
    v_mfma_f32_16x16x32_bf16 v[104:107], a[212:215], a[84:87], v[104:107]
    ds_read_b64_tr_b16 v[44:45], v25 offset:9216
    v_lshl_add_u32 v60, v61, 12, v60
    v_mfma_f32_16x16x32_bf16 v[104:107], a[208:211], a[68:71], v[104:107]
    ds_read_b64_tr_b16 v[46:47], v25 offset:13312
    v_lshrrev_b32 v61, 2, v1
    v_mfma_f32_16x16x32_bf16 v[112:115], a[208:211], a[72:75], v[112:115]
    ds_read_b64_tr_b16 a[204:205], v8 offset:13312
    v_min_u32 v61, 1, v61
    v_mfma_f32_16x16x32_bf16 v[112:115], a[212:215], a[88:91], v[112:115]
    ds_read_b64_tr_b16 a[206:207], v8 offset:19456
    v_lshl_or_b32 v60, v61, 30, v60
    v_mfma_f32_16x16x32_bf16 v[120:123], a[212:215], a[92:95], v[120:123]
    buffer_load_dwordx4 v4, s[12:15], s38 offen offset:256 lds
    v_accvgpr_write_b32 a223, v60
    v_mfma_f32_16x16x32_bf16 v[120:123], a[208:211], a[76:79], v[120:123]
    s_waitcnt lgkmcnt(4)
    v_accvgpr_write_b32 a33, 1.0
    v_accvgpr_write_b32 a34, 1.0
    v_mfma_f32_16x16x32_bf16 v[124:127], a[192:195], a[76:79], v[124:127]
    s_add_u32 m0, s49, 27648
    ds_read_b64_tr_b16 a[208:209], v9 offset:1024
    v_accvgpr_write_b32 a35, 1.0
    v_mfma_f32_16x16x32_bf16 v[124:127], a[196:199], a[92:95], v[124:127]
    s_mul_hi_u32 s47, s58, 429496730
    ds_read_b64_tr_b16 a[210:211], v9 offset:7168
    v_accvgpr_write_b32 a36, 1.0
    v_mfma_f32_16x16x32_bf16 v[116:119], a[196:199], a[88:91], v[116:119]
    buffer_load_dwordx4 v5, s[12:15], s38 offen offset:0 lds
    v_mfma_f32_16x16x32_bf16 v[116:119], a[192:195], a[72:75], v[116:119]
    s_add_u32 m0, s49, 28544
    v_accvgpr_write_b32 a37, 1.0
    v_accvgpr_write_b32 a38, 1.0
    v_mfma_f32_16x16x32_bf16 v[108:111], a[192:195], a[68:71], v[108:111]
    s_lshl_b32 s37, s47, 8
    ds_read_b64_tr_b16 a[212:213], v9 offset:13312
    v_accvgpr_write_b32 a39, 1.0
    v_mfma_f32_16x16x32_bf16 v[108:111], a[196:199], a[84:87], v[108:111]
    s_add_u32 s37, s37, 4718736
    ds_read_b64_tr_b16 a[214:215], v9 offset:19456
    v_accvgpr_write_b32 a40, 1.0
    v_mfma_f32_16x16x32_bf16 v[100:103], a[196:199], a[80:83], v[100:103]
    buffer_load_dwordx4 v5, s[12:15], s38 offen offset:128 lds
    v_mfma_f32_16x16x32_bf16 v[100:103], a[192:195], a[64:67], v[100:103]
    s_waitcnt lgkmcnt(4)
    v_accvgpr_write_b32 a41, 1.0
    v_accvgpr_write_b32 a42, 1.0
    v_mfma_f32_16x16x32_bf16 v[128:131], a[200:203], a[64:67], v[128:131]
    s_add_u32 m0, s49, 29440
    ds_read_b64_tr_b16 a[192:193], v10 offset:1024
    v_accvgpr_write_b32 a43, 1.0
    v_mfma_f32_16x16x32_bf16 v[128:131], a[204:207], a[80:83], v[128:131]
    s_mov_b32 s32, s82
    ds_read_b64_tr_b16 a[194:195], v10 offset:7168
    v_accvgpr_write_b32 a44, 1.0
    v_mfma_f32_16x16x32_bf16 v[136:139], a[204:207], a[84:87], v[136:139]
    v_mfma_f32_16x16x32_bf16 v[20:23], v[48:51], v[32:35], 0
    v_mfma_f32_16x16x32_bf16 v[58:61], v[48:51], v[36:39], 0
    v_mfma_f32_16x16x32_bf16 v[20:23], v[52:55], v[40:43], v[20:23]
    v_mfma_f32_16x16x32_bf16 v[58:61], v[52:55], v[44:47], v[58:61]
    v_mfma_f32_16x16x32_bf16 v[136:139], a[200:203], a[68:71], v[136:139]
    buffer_load_dwordx4 v5, s[12:15], s38 offen offset:256 lds
    v_mfma_f32_16x16x32_bf16 v[144:147], a[200:203], a[72:75], v[144:147]
    s_add_u32 s38, s38, 24576
    ds_read_b64_tr_b16 a[196:197], v10 offset:13312
    v_accvgpr_write_b32 a45, 1.0
    v_mfma_f32_16x16x32_bf16 v[144:147], a[204:207], a[88:91], v[144:147]
    s_and_b32 s33, s83, 0xffff
    ds_read_b64_tr_b16 a[198:199], v10 offset:19456
    v_accvgpr_write_b32 a46, 1.0
    v_mfma_f32_16x16x32_bf16 v[152:155], a[204:207], a[92:95], v[152:155]
    s_mov_b32 s34, 1966080
    v_accvgpr_write_b32 a47, 1.0
    v_accvgpr_write_b32 a48, 1.0
    v_mfma_f32_16x16x32_bf16 v[152:155], a[200:203], a[76:79], v[152:155]
    s_waitcnt lgkmcnt(4)
    v_accvgpr_write_b32 a49, 1.0
    v_accvgpr_write_b32 a50, 1.0
    v_mfma_f32_16x16x32_bf16 v[156:159], a[208:211], a[76:79], v[156:159]
    s_add_u32 m0, s49, 73728
    ds_read_b64_tr_b16 a[200:201], v11 offset:1024
    v_accvgpr_write_b32 a51, 1.0
    v_mfma_f32_16x16x32_bf16 v[156:159], a[212:215], a[92:95], v[156:159]
    s_mov_b32 s35, 0x00020000
    ds_read_b64_tr_b16 a[202:203], v11 offset:7168
    v_accvgpr_write_b32 a52, 1.0
    v_mfma_f32_16x16x32_bf16 v[148:151], a[212:215], a[88:91], v[148:151]
    buffer_load_dwordx4 v6, s[16:19], s40 offen offset:0 lds
    v_mfma_f32_16x16x32_bf16 v[148:151], a[208:211], a[72:75], v[148:151]
    s_mul_i32 s60, s47, 80640
    v_accvgpr_write_b32 a53, 1.0
    v_accvgpr_write_b32 a54, 1.0
    v_mfma_f32_16x16x32_bf16 v[140:143], a[208:211], a[68:71], v[140:143]
    s_lshl_b32 s56, s58, 7
    ds_read_b64_tr_b16 a[204:205], v11 offset:13312
    v_accvgpr_write_b32 a55, 1.0
    v_mfma_f32_16x16x32_bf16 v[140:143], a[212:215], a[84:87], v[140:143]
    s_add_u32 m0, s49, 74624
    ds_read_b64_tr_b16 a[206:207], v11 offset:19456
    v_accvgpr_write_b32 a56, 1.0
    v_mfma_f32_16x16x32_bf16 v[132:135], a[212:215], a[80:83], v[132:135]
    buffer_load_dwordx4 v6, s[16:19], s40 offen offset:128 lds
    v_mfma_f32_16x16x32_bf16 v[132:135], a[208:211], a[64:67], v[132:135]
    s_waitcnt lgkmcnt(4)
    v_accvgpr_write_b32 a57, 1.0
    v_accvgpr_write_b32 a58, 1.0
    v_mfma_f32_16x16x32_bf16 v[160:163], a[192:195], a[64:67], v[160:163]
    s_add_u32 s60, s60, s56
    ds_read_b64_tr_b16 a[208:209], v8 offset:2048
    v_accvgpr_write_b32 a59, 1.0
    v_mfma_f32_16x16x32_bf16 v[160:163], a[196:199], a[80:83], v[160:163]
    s_mul_i32 s56, s53, 983040
    ds_read_b64_tr_b16 a[210:211], v8 offset:8192
    v_accvgpr_write_b32 a60, 1.0
    v_mfma_f32_16x16x32_bf16 v[168:171], a[196:199], a[84:87], v[168:171]
    s_add_u32 s28, s72, s56
    s_addc_u32 s29, s73, 0
    v_accvgpr_write_b32 a61, 1.0
    v_mfma_f32_16x16x32_bf16 v[168:171], a[192:195], a[68:71], v[168:171]
    s_and_b32 s29, s29, 0xffff
    v_accvgpr_write_b32 a62, 1.0
    v_accvgpr_write_b32 a63, 1.0
    v_mfma_f32_16x16x32_bf16 v[176:179], a[192:195], a[72:75], v[176:179]
    s_add_u32 m0, s49, 75520
    ds_read_b64_tr_b16 a[212:213], v8 offset:14336
    v_mov_b32 v22, v58
    v_mfma_f32_16x16x32_bf16 v[176:179], a[196:199], a[88:91], v[176:179]
    s_mov_b32 s30, 983040
    ds_read_b64_tr_b16 a[214:215], v8 offset:20480
    v_mov_b32 v23, v59
    v_mfma_f32_16x16x32_bf16 v[184:187], a[196:199], a[92:95], v[184:187]
    buffer_store_dwordx4 v[20:23], v26, s[24:27], s62 offen sc1
    v_mfma_f32_16x16x32_bf16 v[184:187], a[192:195], a[76:79], v[184:187]
    s_waitcnt lgkmcnt(4)
    buffer_load_dwordx4 v6, s[16:19], s40 offen offset:256 lds
    v_mfma_f32_16x16x32_bf16 v[188:191], a[200:203], a[76:79], v[188:191]
    s_mov_b32 s31, 0x00020000
    ds_read_b64_tr_b16 a[192:193], v9 offset:2048
    v_mov_b32 v32, 0xc0933333
    v_mfma_f32_16x16x32_bf16 v[188:191], a[204:207], a[92:95], v[188:191]
    s_lshr_b32 s48, s2, 3
    ds_read_b64_tr_b16 a[194:195], v9 offset:8192
    v_mov_b32 v33, 0xc0933333
    v_mfma_f32_16x16x32_bf16 v[180:183], a[204:207], a[88:91], v[180:183]
    s_add_u32 m0, s49, 76800
    v_mov_b32 v34, 0xc0933333
    v_mov_b32 v35, 0xc0933333
    v_mfma_f32_16x16x32_bf16 v[180:183], a[200:203], a[72:75], v[180:183]
    buffer_load_dwordx4 v7, s[16:19], s40 offen offset:0 lds
    v_mfma_f32_16x16x32_bf16 v[172:175], a[200:203], a[68:71], v[172:175]
    s_lshl_b32 s48, s48, 2
    ds_read_b64_tr_b16 a[196:197], v9 offset:14336
    v_mov_b32 v36, 0xc0933333
    v_mfma_f32_16x16x32_bf16 v[172:175], a[204:207], a[84:87], v[172:175]
    s_add_u32 s48, s48, s3
    ds_read_b64_tr_b16 a[198:199], v9 offset:20480
    v_mov_b32 v37, 0xc0933333
    v_mfma_f32_16x16x32_bf16 v[164:167], a[204:207], a[80:83], v[164:167]
    s_mul_i32 s6, s48, 7680
    v_lshlrev_b32 v16, 7, v16
    v_mov_b32 v38, 0xc0933333
    v_mfma_f32_16x16x32_bf16 v[164:167], a[200:203], a[64:67], v[164:167]
    s_waitcnt lgkmcnt(4)
    v_mov_b32 v39, 0xc0933333
    v_mov_b32 v40, 0xc0933333
    v_mfma_f32_16x16x32_bf16 v[192:195], a[208:211], a[64:67], v[192:195]
    s_lshl_b32 s57, s51, 8
    ds_read_b64_tr_b16 a[200:201], v10 offset:2048
    v_mov_b32 v41, 0xc0933333
    v_mfma_f32_16x16x32_bf16 v[192:195], a[212:215], a[80:83], v[192:195]
    s_add_u32 m0, s49, 77696
    ds_read_b64_tr_b16 a[202:203], v10 offset:8192
    v_mov_b32 v42, 0xc0933333
    v_mfma_f32_16x16x32_bf16 v[200:203], a[212:215], a[84:87], v[200:203]
    buffer_load_dwordx4 v7, s[16:19], s40 offen offset:128 lds
    v_mfma_f32_16x16x32_bf16 v[200:203], a[208:211], a[68:71], v[200:203]
    s_add_u32 s56, s56, s57
    v_mov_b32 v43, 0xc0933333
    v_mov_b32 v44, 0xc0933333
    v_mfma_f32_16x16x32_bf16 v[208:211], a[208:211], a[72:75], v[208:211]
    s_lshr_b32 s63, s51, 1
    ds_read_b64_tr_b16 a[204:205], v10 offset:14336
    v_mov_b32 v45, 0xc0933333
    v_mfma_f32_16x16x32_bf16 v[208:211], a[212:215], a[88:91], v[208:211]
    s_lshl_b32 s63, s63, 7
    ds_read_b64_tr_b16 a[206:207], v10 offset:20480
    v_mov_b32 v46, 0xc0933333
    v_mfma_f32_16x16x32_bf16 v[216:219], a[212:215], a[92:95], v[216:219]
    s_add_u32 s63, s63, 768
    v_mov_b32 v47, 0xc0933333
    v_add_u32 v8, 122880, v12
    v_mfma_f32_16x16x32_bf16 v[216:219], a[208:211], a[76:79], v[216:219]
    s_waitcnt lgkmcnt(4)
    v_add_u32 v9, 122880, v13
    v_lshrrev_b32 v60, 2, v1
    v_mfma_f32_16x16x32_bf16 v[220:223], a[192:195], a[76:79], v[220:223]
    s_add_u32 m0, s49, 78592
    ds_read_b64_tr_b16 a[208:209], v11 offset:2048
    v_min_u32 v60, 9, v60
    v_mfma_f32_16x16x32_bf16 v[220:223], a[196:199], a[92:95], v[220:223]
    s_sub_u32 s63, s63, s57
    ds_read_b64_tr_b16 a[210:211], v11 offset:8192
    v_mul_u32_u24 v60, 6144, v60
    v_mfma_f32_16x16x32_bf16 v[212:215], a[196:199], a[88:91], v[212:215]
    buffer_load_dwordx4 v7, s[16:19], s40 offen offset:256 lds
    v_mfma_f32_16x16x32_bf16 v[212:215], a[192:195], a[72:75], v[212:215]
    s_add_u32 s40, s40, 24576
    v_and_b32 v61, 3, v1
    v_lshl_add_u32 v60, v61, 2, v60
    v_mfma_f32_16x16x32_bf16 v[204:207], a[192:195], a[68:71], v[204:207]
    s_mov_b32 s66, 0
    ds_read_b64_tr_b16 a[212:213], v11 offset:14336
    v_add_u32 v10, 122880, v14
    v_mfma_f32_16x16x32_bf16 v[204:207], a[196:199], a[84:87], v[204:207]
    s_waitcnt vmcnt(31)
    ds_read_b64_tr_b16 a[214:215], v11 offset:20480
    s_sub_u32 s57, 7864320, s56
    v_mfma_f32_16x16x32_bf16 v[196:199], a[196:199], a[80:83], v[196:199]
    s_barrier
    v_mfma_f32_16x16x32_bf16 v[196:199], a[192:195], a[64:67], v[196:199]
    s_waitcnt lgkmcnt(4)
    v_add_u32 v11, 122880, v15
    s_add_u32 s8, s72, s56
    s_addc_u32 s9, s73, 0
    v_mfma_f32_16x16x32_bf16 v[224:227], a[200:203], a[64:67], v[224:227]
    s_and_b32 s9, s9, 0xffff
    ds_read_b64_tr_b16 a[192:193], v8 offset:0
    s_mov_b32 s10, s57
    v_mfma_f32_16x16x32_bf16 v[224:227], a[204:207], a[80:83], v[224:227]
    s_mov_b32 s11, 0x00020000
    ds_read_b64_tr_b16 a[194:195], v8 offset:6144
    s_mul_i32 s36, s51, 245760
    v_mfma_f32_16x16x32_bf16 v[232:235], a[204:207], a[84:87], v[232:235]
    s_mul_i32 s56, s3, 20480
    s_add_u32 s36, s36, s56
    s_lshl_b32 s59, s53, 23
    v_mfma_f32_16x16x32_bf16 v[232:235], a[200:203], a[68:71], v[232:235]
    s_add_u32 s59, s59, 67108864
    s_add_u32 s20, s86, s59
    s_addc_u32 s21, s87, 0
    v_mfma_f32_16x16x32_bf16 v[240:243], a[200:203], a[72:75], v[240:243]
    s_and_b32 s21, s21, 0xffff
    ds_read_b64_tr_b16 a[196:197], v8 offset:12288
    s_mov_b32 s22, 8388608
    v_mfma_f32_16x16x32_bf16 v[240:243], a[204:207], a[88:91], v[240:243]
    s_mov_b32 s23, 0x00020000
    ds_read_b64_tr_b16 a[198:199], v8 offset:18432
    s_add_u32 s55, s51, 8
    v_mfma_f32_16x16x32_bf16 v[248:251], a[204:207], a[92:95], v[248:251]
    s_lshr_b32 s55, s93, s55
    s_and_b32 s55, s55, 0x2000
    s_lshl_b32 s59, s54, 16
    v_mfma_f32_16x16x32_bf16 v[248:251], a[200:203], a[76:79], v[248:251]
    s_waitcnt lgkmcnt(4)
    s_or_b32 s55, s55, s59
    s_and_b32 s59, s3, 1
    v_mfma_f32_16x16x32_bf16 v[252:255], a[208:211], a[76:79], v[252:255]
    s_lshl_b32 s59, s59, 14
    ds_read_b64_tr_b16 a[200:201], v9 offset:0
    s_or_b32 s55, s55, s59
    v_mfma_f32_16x16x32_bf16 v[252:255], a[212:215], a[92:95], v[252:255]
    s_mul_i32 s59, s51, 0x202000
    ds_read_b64_tr_b16 a[202:203], v9 offset:6144
    s_and_b32 s59, s59, 6299648
    v_mfma_f32_16x16x32_bf16 v[244:247], a[212:215], a[88:91], v[244:247]
    s_xor_b32 s55, s55, s59
    v_lshlrev_b32 v2, 7, v1
    v_and_b32 v3, 3, v1
    v_mfma_f32_16x16x32_bf16 v[244:247], a[208:211], a[72:75], v[244:247]
    v_lshlrev_b32 v3, 11, v3
    v_lshlrev_b32 v28, 4, v1
    v_mfma_f32_16x16x32_bf16 v[236:239], a[208:211], a[68:71], v[236:239]
    ds_read_b64_tr_b16 a[204:205], v9 offset:12288
    v_mov_b32 v31, v16
    v_mfma_f32_16x16x32_bf16 v[236:239], a[212:215], a[84:87], v[236:239]
    s_waitcnt vmcnt(23)
    s_waitcnt vmcnt(19)
    ds_read_b64_tr_b16 a[206:207], v9 offset:18432
    v_mfma_f32_16x16x32_bf16 v[228:231], a[212:215], a[80:83], v[228:231]
    s_mov_b32 s41, s49
    s_add_u32 s42, s49, 24576
    s_add_u32 s43, s49, 49152
    v_mfma_f32_16x16x32_bf16 v[228:231], a[208:211], a[64:67], v[228:231]
    s_waitcnt lgkmcnt(4)
    s_mov_b32 s45, 6
    s_sub_u32 s56, 73728, s49
    v_mfma_f32_16x16x32_bf16 v[64:67], a[192:195], a[224:227], v[64:67]
    ds_read_b64_tr_b16 a[208:209], v10 offset:0
    v_add_u32 v16, s49, v18
    v_mfma_f32_16x16x32_bf16 v[64:67], a[196:199], a[240:243], v[64:67]
    ds_read_b64_tr_b16 a[210:211], v10 offset:6144
    v_add_u32 v17, s49, v19
    v_mfma_f32_16x16x32_bf16 v[72:75], a[196:199], a[244:247], v[72:75]
    v_add_u32 v12, s56, v12
    v_add_u32 v13, s56, v13
    v_mfma_f32_16x16x32_bf16 v[72:75], a[192:195], a[228:231], v[72:75]
    v_add_u32 v14, s56, v14
    v_add_u32 v15, s56, v15
    v_mfma_f32_16x16x32_bf16 v[80:83], a[192:195], a[232:235], v[80:83]
    ds_read_b64_tr_b16 a[212:213], v10 offset:12288
    v_mov_b32 v30, 0x47800000
    v_mfma_f32_16x16x32_bf16 v[80:83], a[196:199], a[248:251], v[80:83]
    ds_read_b64_tr_b16 a[214:215], v10 offset:18432
    v_mov_b32 v20, 0
    v_mfma_f32_16x16x32_bf16 v[88:91], a[196:199], a[252:255], v[88:91]
    v_mov_b32 v21, 0
    v_mov_b32 v22, 0
    v_mfma_f32_16x16x32_bf16 v[88:91], a[192:195], a[236:239], v[88:91]
    s_waitcnt lgkmcnt(4)
    v_mov_b32 v23, 0
    v_mov_b32 v56, 0x3c000000
    v_mfma_f32_16x16x32_bf16 v[92:95], a[200:203], a[236:239], v[92:95]
    ds_read_b64_tr_b16 a[192:193], v11 offset:0
    v_accvgpr_write_b32 a64, 1.0
    v_mfma_f32_16x16x32_bf16 v[92:95], a[204:207], a[252:255], v[92:95]
    ds_read_b64_tr_b16 a[194:195], v11 offset:6144
    v_accvgpr_write_b32 a65, 1.0
    v_mfma_f32_16x16x32_bf16 v[84:87], a[204:207], a[248:251], v[84:87]
    s_getpc_b64 s[74:75]
ct3:
    s_add_u32 s74, s74, at_switch-ct3
    s_addc_u32 s75, s75, 0
    global_load_dword a222, v2, s[74:75]
    v_mfma_f32_16x16x32_bf16 v[84:87], a[200:203], a[232:235], v[84:87]
    v_min_u32 v2, 15, v1
    v_mfma_f32_16x16x32_bf16 v[76:79], a[200:203], a[228:231], v[76:79]
    s_lshl_b32 s59, s3, 4
    ds_read_b64_tr_b16 a[196:197], v11 offset:12288
    v_add_u32 v2, s59, v2
    v_mfma_f32_16x16x32_bf16 v[76:79], a[204:207], a[244:247], v[76:79]
    ds_read_b64_tr_b16 a[198:199], v11 offset:18432
    v_mul_u32_u24 v2, 1280, v2
    v_mfma_f32_16x16x32_bf16 v[68:71], a[204:207], a[240:243], v[68:71]
    buffer_load_dword a217, v2, s[32:35], s60 offen
    v_mfma_f32_16x16x32_bf16 v[68:71], a[200:203], a[224:227], v[68:71]
    s_waitcnt lgkmcnt(4)
    v_and_b32 v2, 1, v1
    v_lshlrev_b32 v2, 7, v2
    v_mfma_f32_16x16x32_bf16 v[96:99], a[208:211], a[224:227], v[96:99]
    s_lshl_b32 s59, s48, 8
    ds_read_b64_tr_b16 a[200:201], v8 offset:1024
    v_add_u32 v2, s59, v2
    v_mfma_f32_16x16x32_bf16 v[96:99], a[212:215], a[240:243], v[96:99]
    ds_read_b64_tr_b16 a[202:203], v8 offset:7168
    v_accvgpr_write_b32 a66, 1.0
    v_mfma_f32_16x16x32_bf16 v[104:107], a[212:215], a[244:247], v[104:107]
    v_accvgpr_write_b32 a67, 1.0
    v_mfma_f32_16x16x32_bf16 v[104:107], a[208:211], a[228:231], v[104:107]
    v_accvgpr_write_b32 a68, 1.0
    v_mfma_f32_16x16x32_bf16 v[112:115], a[208:211], a[232:235], v[112:115]
    ds_read_b64_tr_b16 a[204:205], v8 offset:13312
    v_accvgpr_write_b32 a69, 1.0
    v_mfma_f32_16x16x32_bf16 v[112:115], a[212:215], a[248:251], v[112:115]
    ds_read_b64_tr_b16 a[206:207], v8 offset:19456
    v_cvt_pk_bf16_f32 v64, v64, v65
    v_mfma_f32_16x16x32_bf16 v[120:123], a[212:215], a[252:255], v[120:123]
    s_getpc_b64 s[74:75]
ct4:
    s_add_u32 s74, s74, tail_code-ct4
    s_addc_u32 s75, s75, 0
    global_load_dword a218, v2, s[74:75]
    v_mfma_f32_16x16x32_bf16 v[120:123], a[208:211], a[236:239], v[120:123]
    s_waitcnt lgkmcnt(4)
    v_and_b32 v31, 3, v1
    v_lshlrev_b32 v31, 7, v31
    v_mfma_f32_16x16x32_bf16 v[124:127], a[192:195], a[236:239], v[124:127]
    s_lshl_b32 s59, s48, 9
    ds_read_b64_tr_b16 a[208:209], v9 offset:1024
    v_cvt_pk_bf16_f32 v65, v66, v67
    v_mfma_f32_16x16x32_bf16 v[124:127], a[196:199], a[252:255], v[124:127]
    s_and_b32 s59, s59, 0x7fff
    ds_read_b64_tr_b16 a[210:211], v9 offset:7168
    v_add_u32 v31, s59, v31
    v_mfma_f32_16x16x32_bf16 v[116:119], a[196:199], a[248:251], v[116:119]
    v_min_u32 v2, 11, v1
    v_lshlrev_b32 v2, 7, v2
    v_mfma_f32_16x16x32_bf16 v[116:119], a[192:195], a[232:235], v[116:119]
    v_cvt_pk_bf16_f32 v66, v68, v69
    v_cvt_pk_bf16_f32 v67, v70, v71
    v_mfma_f32_16x16x32_bf16 v[108:111], a[192:195], a[228:231], v[108:111]
    ds_read_b64_tr_b16 a[212:213], v9 offset:13312
    v_cvt_pk_bf16_f32 v72, v72, v73
    v_mfma_f32_16x16x32_bf16 v[108:111], a[196:199], a[244:247], v[108:111]
    ds_read_b64_tr_b16 a[214:215], v9 offset:19456
    v_cvt_pk_bf16_f32 v73, v74, v75
    v_mfma_f32_16x16x32_bf16 v[100:103], a[196:199], a[240:243], v[100:103]
    s_and_b32 s88, s3, 1
    v_permlane16_swap_b32 v64, v66
    v_mfma_f32_16x16x32_bf16 v[100:103], a[192:195], a[224:227], v[100:103]
    s_waitcnt lgkmcnt(4)
    v_permlane16_swap_b32 v65, v67
    v_mfma_f32_16x16x32_bf16 v[128:131], a[200:203], a[224:227], v[128:131]
    s_mul_i32 s88, s88, 20480
    ds_read_b64_tr_b16 a[192:193], v10 offset:1024
    v_cvt_pk_bf16_f32 v74, v76, v77
    v_mfma_f32_16x16x32_bf16 v[128:131], a[204:207], a[240:243], v[128:131]
    s_add_u32 s89, s51, 0
    ds_read_b64_tr_b16 a[194:195], v10 offset:7168
    v_cvt_pk_bf16_f32 v75, v78, v79
    v_mfma_f32_16x16x32_bf16 v[136:139], a[204:207], a[244:247], v[136:139]
    s_and_b32 s89, s89, 3
    v_permlane16_swap_b32 v72, v74
    v_mfma_f32_16x16x32_bf16 v[136:139], a[200:203], a[228:231], v[136:139]
    s_mul_i32 s89, s89, 245760
    v_permlane16_swap_b32 v73, v75
    v_mfma_f32_16x16x32_bf16 v[144:147], a[200:203], a[232:235], v[144:147]
    s_add_u32 s32, s89, s88
    ds_read_b64_tr_b16 a[196:197], v10 offset:13312
    v_cvt_pk_bf16_f32 v80, v80, v81
    v_mfma_f32_16x16x32_bf16 v[144:147], a[204:207], a[248:251], v[144:147]
    s_add_u32 s89, s51, 1
    ds_read_b64_tr_b16 a[198:199], v10 offset:19456
    v_cvt_pk_bf16_f32 v81, v82, v83
    v_mfma_f32_16x16x32_bf16 v[152:155], a[204:207], a[252:255], v[152:155]
    s_and_b32 s89, s89, 3
    v_cvt_pk_bf16_f32 v82, v84, v85
    v_cvt_pk_bf16_f32 v83, v86, v87
    v_mfma_f32_16x16x32_bf16 v[152:155], a[200:203], a[236:239], v[152:155]
    s_waitcnt lgkmcnt(4)
    v_permlane16_swap_b32 v80, v82
    v_mfma_f32_16x16x32_bf16 v[156:159], a[208:211], a[236:239], v[156:159]
    s_mul_i32 s89, s89, 245760
    ds_read_b64_tr_b16 a[200:201], v11 offset:1024
    v_cvt_pk_bf16_f32 v88, v88, v89
    v_mfma_f32_16x16x32_bf16 v[156:159], a[212:215], a[252:255], v[156:159]
    s_add_u32 s33, s89, s88
    ds_read_b64_tr_b16 a[202:203], v11 offset:7168
    v_cvt_pk_bf16_f32 v89, v90, v91
    v_mfma_f32_16x16x32_bf16 v[148:151], a[212:215], a[248:251], v[148:151]
    s_add_u32 s89, s51, 2
    v_permlane16_swap_b32 v81, v83
    v_mfma_f32_16x16x32_bf16 v[148:151], a[208:211], a[232:235], v[148:151]
    s_and_b32 s89, s89, 3
    v_cvt_pk_bf16_f32 v90, v92, v93
    v_cvt_pk_bf16_f32 v91, v94, v95
    v_mfma_f32_16x16x32_bf16 v[140:143], a[208:211], a[228:231], v[140:143]
    s_mul_i32 s89, s89, 245760
    ds_read_b64_tr_b16 a[204:205], v11 offset:13312
    v_cvt_pk_bf16_f32 v96, v96, v97
    v_mfma_f32_16x16x32_bf16 v[140:143], a[212:215], a[244:247], v[140:143]
    s_add_u32 s34, s89, s88
    ds_read_b64_tr_b16 a[206:207], v11 offset:19456
    v_cvt_pk_bf16_f32 v97, v98, v99
    v_mfma_f32_16x16x32_bf16 v[132:135], a[212:215], a[240:243], v[132:135]
    s_add_u32 s89, s51, 3
    v_permlane16_swap_b32 v88, v90
    v_mfma_f32_16x16x32_bf16 v[132:135], a[208:211], a[224:227], v[132:135]
    s_waitcnt lgkmcnt(4)
    v_permlane16_swap_b32 v89, v91
    v_mfma_f32_16x16x32_bf16 v[160:163], a[192:195], a[224:227], v[160:163]
    s_and_b32 s89, s89, 3
    ds_read_b64_tr_b16 a[208:209], v8 offset:2048
    v_cvt_pk_bf16_f32 v98, v100, v101
    v_mfma_f32_16x16x32_bf16 v[160:163], a[196:199], a[240:243], v[160:163]
    s_mul_i32 s89, s89, 245760
    ds_read_b64_tr_b16 a[210:211], v8 offset:8192
    v_cvt_pk_bf16_f32 v99, v102, v103
    v_mfma_f32_16x16x32_bf16 v[168:171], a[196:199], a[244:247], v[168:171]
    s_add_u32 s35, s89, s88
    v_permlane16_swap_b32 v96, v98
    v_mfma_f32_16x16x32_bf16 v[168:171], a[192:195], a[228:231], v[168:171]
    v_permlane16_swap_b32 v97, v99
    v_mfma_f32_16x16x32_bf16 v[176:179], a[192:195], a[232:235], v[176:179]
    ds_read_b64_tr_b16 a[212:213], v8 offset:14336
    v_cvt_pk_bf16_f32 v104, v104, v105
    v_mfma_f32_16x16x32_bf16 v[176:179], a[196:199], a[248:251], v[176:179]
    ds_read_b64_tr_b16 a[214:215], v8 offset:20480
    v_cvt_pk_bf16_f32 v105, v106, v107
    v_mfma_f32_16x16x32_bf16 v[184:187], a[196:199], a[252:255], v[184:187]
    v_cvt_pk_bf16_f32 v106, v108, v109
    v_cvt_pk_bf16_f32 v107, v110, v111
    v_mfma_f32_16x16x32_bf16 v[184:187], a[192:195], a[236:239], v[184:187]
    s_waitcnt lgkmcnt(4)
    v_permlane16_swap_b32 v104, v106
    v_mfma_f32_16x16x32_bf16 v[188:191], a[200:203], a[236:239], v[188:191]
    ds_read_b64_tr_b16 a[192:193], v9 offset:2048
    v_cvt_pk_bf16_f32 v112, v112, v113
    v_mfma_f32_16x16x32_bf16 v[188:191], a[204:207], a[252:255], v[188:191]
    ds_read_b64_tr_b16 a[194:195], v9 offset:8192
    v_cvt_pk_bf16_f32 v113, v114, v115
    v_mfma_f32_16x16x32_bf16 v[180:183], a[204:207], a[248:251], v[180:183]
    v_permlane16_swap_b32 v105, v107
    v_mfma_f32_16x16x32_bf16 v[180:183], a[200:203], a[232:235], v[180:183]
    v_cvt_pk_bf16_f32 v114, v116, v117
    v_cvt_pk_bf16_f32 v115, v118, v119
    v_mfma_f32_16x16x32_bf16 v[172:175], a[200:203], a[228:231], v[172:175]
    ds_read_b64_tr_b16 a[196:197], v9 offset:14336
    v_cvt_pk_bf16_f32 v120, v120, v121
    v_mfma_f32_16x16x32_bf16 v[172:175], a[204:207], a[244:247], v[172:175]
    ds_read_b64_tr_b16 a[198:199], v9 offset:20480
    v_cvt_pk_bf16_f32 v121, v122, v123
    v_mfma_f32_16x16x32_bf16 v[164:167], a[204:207], a[240:243], v[164:167]
    v_permlane16_swap_b32 v112, v114
    v_mfma_f32_16x16x32_bf16 v[164:167], a[200:203], a[224:227], v[164:167]
pg_5:
    s_cbranch_execz pg_9
    s_waitcnt lgkmcnt(4)
    v_permlane16_swap_b32 v113, v115
    v_mfma_f32_16x16x32_bf16 v[192:195], a[208:211], a[224:227], v[192:195]
    ds_read_b64_tr_b16 a[200:201], v10 offset:2048
    v_cvt_pk_bf16_f32 v122, v124, v125
    v_mfma_f32_16x16x32_bf16 v[192:195], a[212:215], a[240:243], v[192:195]
    ds_read_b64_tr_b16 a[202:203], v10 offset:8192
    v_cvt_pk_bf16_f32 v123, v126, v127
    v_mfma_f32_16x16x32_bf16 v[200:203], a[212:215], a[244:247], v[200:203]
    v_permlane16_swap_b32 v120, v122
    v_mfma_f32_16x16x32_bf16 v[200:203], a[208:211], a[228:231], v[200:203]
    v_permlane16_swap_b32 v121, v123
    v_mfma_f32_16x16x32_bf16 v[208:211], a[208:211], a[232:235], v[208:211]
    ds_read_b64_tr_b16 a[204:205], v10 offset:14336
    v_cvt_pk_bf16_f32 v128, v128, v129
    v_mfma_f32_16x16x32_bf16 v[208:211], a[212:215], a[248:251], v[208:211]
    ds_read_b64_tr_b16 a[206:207], v10 offset:20480
    v_cvt_pk_bf16_f32 v129, v130, v131
    v_mfma_f32_16x16x32_bf16 v[216:219], a[212:215], a[252:255], v[216:219]
    v_cvt_pk_bf16_f32 v130, v132, v133
    v_cvt_pk_bf16_f32 v131, v134, v135
    v_mfma_f32_16x16x32_bf16 v[216:219], a[208:211], a[236:239], v[216:219]
    s_waitcnt lgkmcnt(4)
    v_permlane16_swap_b32 v128, v130
    v_mfma_f32_16x16x32_bf16 v[220:223], a[192:195], a[236:239], v[220:223]
    ds_read_b64_tr_b16 a[208:209], v11 offset:2048
    v_cvt_pk_bf16_f32 v136, v136, v137
    v_mfma_f32_16x16x32_bf16 v[220:223], a[196:199], a[252:255], v[220:223]
    ds_read_b64_tr_b16 a[210:211], v11 offset:8192
    v_cvt_pk_bf16_f32 v137, v138, v139
    v_mfma_f32_16x16x32_bf16 v[212:215], a[196:199], a[248:251], v[212:215]
    v_permlane16_swap_b32 v129, v131
    v_mfma_f32_16x16x32_bf16 v[212:215], a[192:195], a[232:235], v[212:215]
    v_cvt_pk_bf16_f32 v138, v140, v141
    v_cvt_pk_bf16_f32 v139, v142, v143
    v_mfma_f32_16x16x32_bf16 v[204:207], a[192:195], a[228:231], v[204:207]
    ds_read_b64_tr_b16 a[212:213], v11 offset:14336
    v_cvt_pk_bf16_f32 v144, v144, v145
    v_mfma_f32_16x16x32_bf16 v[204:207], a[196:199], a[244:247], v[204:207]
    s_waitcnt vmcnt(16)
    ds_read_b64_tr_b16 a[214:215], v11 offset:20480
    v_cvt_pk_bf16_f32 v145, v146, v147
    v_mfma_f32_16x16x32_bf16 v[196:199], a[196:199], a[240:243], v[196:199]
    s_barrier
    v_mfma_f32_16x16x32_bf16 v[196:199], a[192:195], a[224:227], v[196:199]
    s_waitcnt lgkmcnt(4)
    v_permlane16_swap_b32 v136, v138
    v_mfma_f32_16x16x32_bf16 v[224:227], a[200:203], a[224:227], v[224:227]
    ds_read_b128 a[192:195], v16 offset:0
    v_cvt_pk_bf16_f32 v146, v148, v149
    v_mfma_f32_16x16x32_bf16 v[224:227], a[204:207], a[240:243], v[224:227]
    v_permlane16_swap_b32 v137, v139
    v_mfma_f32_16x16x32_bf16 v[232:235], a[204:207], a[244:247], v[232:235]
    v_permlane16_swap_b32 v144, v146
    v_mfma_f32_16x16x32_bf16 v[232:235], a[200:203], a[228:231], v[232:235]
    v_cvt_pk_bf16_f32 v147, v150, v151
    v_cvt_pk_bf16_f32 v152, v152, v153
    v_mfma_f32_16x16x32_bf16 v[240:243], a[200:203], a[232:235], v[240:243]
    ds_read_b128 a[196:199], v17 offset:0
    v_cvt_pk_bf16_f32 v153, v154, v155
    v_mfma_f32_16x16x32_bf16 v[240:243], a[204:207], a[248:251], v[240:243]
    v_permlane16_swap_b32 v145, v147
    v_mfma_f32_16x16x32_bf16 v[248:251], a[204:207], a[252:255], v[248:251]
    v_cvt_pk_bf16_f32 v154, v156, v157
    v_cvt_pk_bf16_f32 v155, v158, v159
    v_mfma_f32_16x16x32_bf16 v[248:251], a[200:203], a[236:239], v[248:251]
    s_waitcnt lgkmcnt(2)
    v_permlane16_swap_b32 v152, v154
    v_mfma_f32_16x16x32_bf16 v[252:255], a[208:211], a[236:239], v[252:255]
    ds_read_b128 a[200:203], v16 offset:1024
    v_mov_b32 v26, s7
    v_mfma_f32_16x16x32_bf16 v[252:255], a[212:215], a[252:255], v[252:255]
    v_permlane16_swap_b32 v153, v155
    v_mfma_f32_16x16x32_bf16 v[244:247], a[212:215], a[248:251], v[244:247]
    v_min_u32 v27, 1, v1
    v_lshlrev_b32 v27, 30, v27
    v_mfma_f32_16x16x32_bf16 v[244:247], a[208:211], a[232:235], v[244:247]
    s_waitcnt vmcnt(7)
    v_cvt_pk_bf16_f32 v160, v160, v161
    v_cvt_pk_bf16_f32 v161, v162, v163
    v_mfma_f32_16x16x32_bf16 v[236:239], a[208:211], a[228:231], v[236:239]
    ds_read_b128 a[204:207], v17 offset:1024
    v_cvt_pk_bf16_f32 v162, v164, v165
    v_mfma_f32_16x16x32_bf16 v[236:239], a[212:215], a[244:247], v[236:239]
    buffer_store_dword v26, v27, s[24:27], s4 offen offset:144 sc1
    v_mfma_f32_16x16x32_bf16 v[228:231], a[212:215], a[240:243], v[228:231]
    v_permlane16_swap_b32 v160, v162
    v_mfma_f32_16x16x32_bf16 v[228:231], a[208:211], a[224:227], v[228:231]
    s_waitcnt lgkmcnt(2)
    v_cvt_pk_bf16_f32 v163, v166, v167
    v_cvt_pk_bf16_f32 v168, v168, v169
    v_mfma_f32_16x16x32_bf16 v[68:71], a[192:195], v[64:67], v[32:35]
    ds_read_b128 a[208:211], v16 offset:2048
    v_cvt_pk_bf16_f32 v169, v170, v171
    v_mfma_f32_16x16x32_bf16 v[68:71], a[196:199], v[96:99], v[68:71]
    v_permlane16_swap_b32 v161, v163
    v_mfma_f32_16x16x32_bf16 v[76:79], a[196:199], v[104:107], v[36:39]
    v_cvt_pk_bf16_f32 v170, v172, v173
    v_cvt_pk_bf16_f32 v171, v174, v175
    v_mfma_f32_16x16x32_bf16 v[76:79], a[192:195], v[72:75], v[76:79]
    v_permlane16_swap_b32 v168, v170
    v_mfma_f32_16x16x32_bf16 v[84:87], a[192:195], v[80:83], v[40:43]
    ds_read_b128 a[212:215], v17 offset:2048
    v_cvt_pk_bf16_f32 v176, v176, v177
    v_mfma_f32_16x16x32_bf16 v[84:87], a[196:199], v[112:115], v[84:87]
    v_permlane16_swap_b32 v169, v171
    v_cvt_pk_bf16_f32 v177, v178, v179
    v_cvt_pk_bf16_f32 v178, v180, v181
    v_cvt_pk_bf16_f32 v179, v182, v183
    v_cvt_pk_bf16_f32 v184, v184, v185
    v_permlane16_swap_b32 v176, v178
    v_permlane16_swap_b32 v177, v179
    v_cvt_pk_bf16_f32 v185, v186, v187
    v_cvt_pk_bf16_f32 v186, v188, v189
    v_cvt_pk_bf16_f32 v187, v190, v191
    v_cvt_pk_bf16_f32 v192, v192, v193
    v_permlane16_swap_b32 v184, v186
    v_permlane16_swap_b32 v185, v187
    v_mfma_f32_16x16x32_bf16 v[92:95], a[196:199], v[120:123], v[44:47]
    v_cvt_pk_bf16_f32 v193, v194, v195
    v_cvt_pk_bf16_f32 v194, v196, v197
    v_mfma_f32_16x16x32_bf16 v[92:95], a[192:195], v[88:91], v[92:95]
    s_waitcnt lgkmcnt(2)
    v_permlane16_swap_b32 v192, v194
    v_mfma_f32_16x16x32_bf16 v[92:95], a[200:203], v[152:155], v[92:95]
    ds_read_b128 a[192:195], v16 offset:6144
    v_cvt_pk_bf16_f32 v195, v198, v199
    v_mfma_f32_16x16x32_bf16 v[92:95], a[204:207], v[184:187], v[92:95]
    v_cvt_pk_bf16_f32 v200, v200, v201
    v_cvt_pk_bf16_f32 v201, v202, v203
    v_mfma_f32_16x16x32_bf16 v[84:87], a[204:207], v[176:179], v[84:87]
    v_permlane16_swap_b32 v193, v195
    v_mfma_f32_16x16x32_bf16 v[84:87], a[200:203], v[144:147], v[84:87]
    v_cvt_pk_bf16_f32 v202, v204, v205
    v_cvt_pk_bf16_f32 v203, v206, v207
    v_mfma_f32_16x16x32_bf16 v[76:79], a[200:203], v[136:139], v[76:79]
    ds_read_b128 a[196:199], v17 offset:6144
    v_cvt_pk_bf16_f32 v208, v208, v209
    v_mfma_f32_16x16x32_bf16 v[76:79], a[204:207], v[168:171], v[76:79]
    s_add_u32 m0, s49, 49152
    v_permlane16_swap_b32 v200, v202
    v_permlane16_swap_b32 v201, v203
    v_cvt_pk_bf16_f32 v209, v210, v211
    v_cvt_pk_bf16_f32 v210, v212, v213
    v_cvt_pk_bf16_f32 v211, v214, v215
    v_cvt_pk_bf16_f32 v216, v216, v217
    v_permlane16_swap_b32 v208, v210
    v_permlane16_swap_b32 v209, v211
    v_cvt_pk_bf16_f32 v217, v218, v219
    v_cvt_pk_bf16_f32 v218, v220, v221
    v_cvt_pk_bf16_f32 v219, v222, v223
    v_cvt_pk_bf16_f32 v224, v224, v225
    v_permlane16_swap_b32 v216, v218
    v_permlane16_swap_b32 v217, v219
    v_cvt_pk_bf16_f32 v225, v226, v227
    v_cvt_pk_bf16_f32 v226, v228, v229
    v_cvt_pk_bf16_f32 v227, v230, v231
    v_cvt_pk_bf16_f32 v232, v232, v233
    v_permlane16_swap_b32 v224, v226
    v_permlane16_swap_b32 v225, v227
    v_cvt_pk_bf16_f32 v233, v234, v235
    v_cvt_pk_bf16_f32 v234, v236, v237
    v_cvt_pk_bf16_f32 v235, v238, v239
    v_cvt_pk_bf16_f32 v240, v240, v241
    v_permlane16_swap_b32 v232, v234
    v_permlane16_swap_b32 v233, v235
    v_cvt_pk_bf16_f32 v241, v242, v243
    v_cvt_pk_bf16_f32 v242, v244, v245
    v_cvt_pk_bf16_f32 v243, v246, v247
    v_cvt_pk_bf16_f32 v248, v248, v249
    v_permlane16_swap_b32 v240, v242
    v_permlane16_swap_b32 v241, v243
    v_cvt_pk_bf16_f32 v249, v250, v251
    v_cvt_pk_bf16_f32 v250, v252, v253
    v_cvt_pk_bf16_f32 v251, v254, v255
    v_accvgpr_write_b32 a70, 1.0
    v_permlane16_swap_b32 v248, v250
    v_permlane16_swap_b32 v249, v251
    v_mfma_f32_16x16x32_bf16 v[68:71], a[204:207], v[160:163], v[68:71]
    buffer_load_dwordx4 v4, s[12:15], s38 offen offset:0 lds
    v_mfma_f32_16x16x32_bf16 v[68:71], a[200:203], v[128:131], v[68:71]
    s_waitcnt lgkmcnt(2)
    v_accvgpr_write_b32 a71, 1.0
    v_accvgpr_write_b32 a72, 1.0
    v_mfma_f32_16x16x32_bf16 v[68:71], a[208:211], v[192:195], v[68:71]
    ds_read_b128 a[200:203], v16 offset:7168
    v_accvgpr_write_b32 a73, 1.0
    v_mfma_f32_16x16x32_bf16 v[68:71], a[212:215], v[224:227], v[68:71]
    v_accvgpr_write_b32 a74, 1.0
    v_accvgpr_write_b32 a75, 1.0
    v_mfma_f32_16x16x32_bf16 v[76:79], a[212:215], v[232:235], v[76:79]
    v_accvgpr_write_b32 a76, 1.0
    v_accvgpr_write_b32 a77, 1.0
    v_mfma_f32_16x16x32_bf16 v[76:79], a[208:211], v[200:203], v[76:79]
    s_add_u32 m0, s49, 50048
    v_accvgpr_write_b32 a78, 1.0
    v_accvgpr_write_b32 a79, 1.0
    v_mfma_f32_16x16x32_bf16 v[84:87], a[208:211], v[208:211], v[84:87]
    ds_read_b128 a[204:207], v17 offset:7168
    v_accvgpr_write_b32 a80, 1.0
    v_mfma_f32_16x16x32_bf16 v[84:87], a[212:215], v[240:243], v[84:87]
    buffer_load_dwordx4 v4, s[12:15], s38 offen offset:128 lds
    v_mfma_f32_16x16x32_bf16 v[92:95], a[212:215], v[248:251], v[92:95]
    v_accvgpr_write_b32 a81, 1.0
    v_accvgpr_write_b32 a82, 1.0
    v_mfma_f32_16x16x32_bf16 v[92:95], a[208:211], v[216:219], v[92:95]
    s_waitcnt lgkmcnt(2)
    v_accvgpr_write_b32 a83, 1.0
    v_accvgpr_write_b32 a84, 1.0
    v_mfma_f32_16x16x32_bf16 v[124:127], a[192:195], v[88:91], v[44:47]
    ds_read_b128 a[208:211], v16 offset:8192
    v_accvgpr_write_b32 a85, 1.0
    v_mfma_f32_16x16x32_bf16 v[124:127], a[196:199], v[120:123], v[124:127]
    v_accvgpr_write_b32 a86, 1.0
    v_accvgpr_write_b32 a87, 1.0
    v_mfma_f32_16x16x32_bf16 v[116:119], a[196:199], v[112:115], v[40:43]
    s_add_u32 m0, s49, 50944
    v_accvgpr_write_b32 a88, 1.0
    v_accvgpr_write_b32 a89, 1.0
    v_mfma_f32_16x16x32_bf16 v[116:119], a[192:195], v[80:83], v[116:119]
    buffer_load_dwordx4 v4, s[12:15], s38 offen offset:256 lds
    v_mfma_f32_16x16x32_bf16 v[108:111], a[192:195], v[72:75], v[36:39]
    ds_read_b128 a[212:215], v17 offset:8192
    v_accvgpr_write_b32 a90, 1.0
    v_mfma_f32_16x16x32_bf16 v[108:111], a[196:199], v[104:107], v[108:111]
    v_accvgpr_write_b32 a91, 1.0
    v_accvgpr_write_b32 a92, 1.0
    v_mfma_f32_16x16x32_bf16 v[100:103], a[196:199], v[96:99], v[32:35]
    v_accvgpr_write_b32 a93, 1.0
    v_accvgpr_write_b32 a94, 1.0
    v_mfma_f32_16x16x32_bf16 v[100:103], a[192:195], v[64:67], v[100:103]
    s_waitcnt lgkmcnt(2)
    v_accvgpr_write_b32 a95, 1.0
    v_mfma_f32_16x16x32_bf16 v[100:103], a[200:203], v[128:131], v[100:103]
    s_add_u32 m0, s49, 52224
    ds_read_b128 a[192:195], v16 offset:12288
    v_mfma_f32_16x16x32_bf16 v[100:103], a[204:207], v[160:163], v[100:103]
    buffer_load_dwordx4 v5, s[12:15], s38 offen offset:0 lds
    v_mfma_f32_16x16x32_bf16 v[108:111], a[204:207], v[168:171], v[108:111]
    v_exp_f32 v48, v68
    v_mfma_f32_16x16x32_bf16 v[108:111], a[200:203], v[136:139], v[108:111]
    v_exp_f32 v49, v69
    v_mfma_f32_16x16x32_bf16 v[116:119], a[200:203], v[144:147], v[116:119]
    ds_read_b128 a[196:199], v17 offset:12288
    v_cvt_pk_bf16_f32 v196, v48, v49
    v_mfma_f32_16x16x32_bf16 v[116:119], a[204:207], v[176:179], v[116:119]
    v_exp_f32 v50, v70
    v_mfma_f32_16x16x32_bf16 v[124:127], a[204:207], v[184:187], v[124:127]
    v_exp_f32 v51, v71
    v_mfma_f32_16x16x32_bf16 v[124:127], a[200:203], v[152:155], v[124:127]
    s_waitcnt lgkmcnt(2)
    v_add_f32 v24, v48, v49
    v_add_f32 v24, v24, v50
    v_mfma_f32_16x16x32_bf16 v[124:127], a[208:211], v[216:219], v[124:127]
    s_add_u32 m0, s49, 53120
    ds_read_b128 a[200:203], v16 offset:13312
    v_cvt_pk_bf16_f32 v197, v50, v51
    v_mfma_f32_16x16x32_bf16 v[124:127], a[212:215], v[248:251], v[124:127]
    buffer_load_dwordx4 v5, s[12:15], s38 offen offset:128 lds
    v_mfma_f32_16x16x32_bf16 v[116:119], a[212:215], v[240:243], v[116:119]
    v_exp_f32 v48, v76
    v_mfma_f32_16x16x32_bf16 v[116:119], a[208:211], v[208:211], v[116:119]
    v_add_f32 v24, v24, v51
    v_mfma_f32_16x16x32_bf16 v[108:111], a[208:211], v[200:203], v[108:111]
    ds_read_b128 a[204:207], v17 offset:13312
    v_mfma_f32_16x16x32_bf16 v[108:111], a[212:215], v[232:235], v[108:111]
    s_add_u32 m0, s49, 54016
    v_exp_f32 v49, v77
    v_mfma_f32_16x16x32_bf16 v[100:103], a[212:215], v[224:227], v[100:103]
    buffer_load_dwordx4 v5, s[12:15], s38 offen offset:256 lds
    v_mfma_f32_16x16x32_bf16 v[100:103], a[208:211], v[192:195], v[100:103]
    s_waitcnt lgkmcnt(2)
    v_exp_f32 v50, v78
    v_mfma_f32_16x16x32_bf16 v[132:135], a[192:195], v[64:67], v[32:35]
    s_add_u32 s38, s38, 24576
    ds_read_b128 a[208:211], v16 offset:14336
    v_cvt_pk_bf16_f32 v204, v48, v49
    v_mfma_f32_16x16x32_bf16 v[132:135], a[196:199], v[96:99], v[132:135]
    v_exp_f32 v51, v79
    v_mfma_f32_16x16x32_bf16 v[140:143], a[196:199], v[104:107], v[36:39]
    v_add_f32 v25, v48, v49
    v_add_f32 v25, v25, v50
    v_mfma_f32_16x16x32_bf16 v[140:143], a[192:195], v[72:75], v[140:143]
    v_exp_f32 v48, v84
    v_mfma_f32_16x16x32_bf16 v[148:151], a[192:195], v[80:83], v[40:43]
    s_add_u32 m0, s49, 98304
    ds_read_b128 a[212:215], v17 offset:14336
    v_cvt_pk_bf16_f32 v205, v50, v51
    v_mfma_f32_16x16x32_bf16 v[148:151], a[196:199], v[112:115], v[148:151]
    buffer_load_dwordx4 v6, s[16:19], s40 offen offset:0 lds
    v_mfma_f32_16x16x32_bf16 v[156:159], a[196:199], v[120:123], v[44:47]
    v_exp_f32 v52, v100
    v_mfma_f32_16x16x32_bf16 v[156:159], a[192:195], v[88:91], v[156:159]
    s_waitcnt lgkmcnt(2)
    v_exp_f32 v53, v101
    v_mfma_f32_16x16x32_bf16 v[156:159], a[200:203], v[152:155], v[156:159]
    ds_read_b128 a[192:195], v16 offset:18432
    v_add_f32 v24, v24, v52
    v_mfma_f32_16x16x32_bf16 v[156:159], a[204:207], v[184:187], v[156:159]
    v_exp_f32 v54, v102
    v_mfma_f32_16x16x32_bf16 v[148:151], a[204:207], v[176:179], v[148:151]
    s_add_u32 m0, s49, 99200
    v_exp_f32 v55, v103
    v_mfma_f32_16x16x32_bf16 v[148:151], a[200:203], v[144:147], v[148:151]
    buffer_load_dwordx4 v6, s[16:19], s40 offen offset:128 lds
    v_mfma_f32_16x16x32_bf16 v[140:143], a[200:203], v[136:139], v[140:143]
    ds_read_b128 a[196:199], v17 offset:18432
    v_cvt_pk_bf16_f32 v198, v52, v53
    v_mfma_f32_16x16x32_bf16 v[140:143], a[204:207], v[168:171], v[140:143]
    v_add_f32 v24, v24, v53
    v_add_f32 v24, v24, v54
    v_mfma_f32_16x16x32_bf16 v[132:135], a[204:207], v[160:163], v[132:135]
    v_exp_f32 v52, v108
    v_mfma_f32_16x16x32_bf16 v[132:135], a[200:203], v[128:131], v[132:135]
    s_waitcnt lgkmcnt(2)
    v_cvt_pk_bf16_f32 v199, v54, v55
    v_add_f32 v24, v24, v55
    v_mfma_f32_16x16x32_bf16 v[132:135], a[208:211], v[192:195], v[132:135]
    ds_read_b128 a[200:203], v16 offset:19456
    v_add_f32 v25, v25, v51
    v_mfma_f32_16x16x32_bf16 v[132:135], a[212:215], v[224:227], v[132:135]
    s_add_u32 m0, s49, 100096
    v_exp_f32 v53, v109
    v_mfma_f32_16x16x32_bf16 v[140:143], a[212:215], v[232:235], v[140:143]
    buffer_load_dwordx4 v6, s[16:19], s40 offen offset:256 lds
    v_mfma_f32_16x16x32_bf16 v[140:143], a[208:211], v[200:203], v[140:143]
    v_exp_f32 v54, v110
    v_mfma_f32_16x16x32_bf16 v[148:151], a[208:211], v[208:211], v[148:151]
    ds_read_b128 a[204:207], v17 offset:19456
    v_add_f32 v25, v25, v52
    v_mfma_f32_16x16x32_bf16 v[148:151], a[212:215], v[240:243], v[148:151]
    v_exp_f32 v55, v111
    v_mfma_f32_16x16x32_bf16 v[156:159], a[212:215], v[248:251], v[156:159]
    v_exp_f32 v49, v85
    v_mfma_f32_16x16x32_bf16 v[156:159], a[208:211], v[216:219], v[156:159]
    s_waitcnt lgkmcnt(2)
    v_exp_f32 v50, v86
    v_mfma_f32_16x16x32_bf16 v[188:191], a[192:195], v[88:91], v[44:47]
    s_add_u32 m0, s49, 101376
    ds_read_b128 a[208:211], v16 offset:20480
    v_cvt_pk_bf16_f32 v206, v52, v53
    v_mfma_f32_16x16x32_bf16 v[188:191], a[196:199], v[120:123], v[188:191]
    buffer_load_dwordx4 v7, s[16:19], s40 offen offset:0 lds
    v_mfma_f32_16x16x32_bf16 v[180:183], a[196:199], v[112:115], v[40:43]
    v_add_f32 v25, v25, v53
    v_add_f32 v25, v25, v54
    v_mfma_f32_16x16x32_bf16 v[180:183], a[192:195], v[80:83], v[180:183]
    v_exp_f32 v51, v87
    v_mfma_f32_16x16x32_bf16 v[172:175], a[192:195], v[72:75], v[36:39]
    ds_read_b128 a[212:215], v17 offset:20480
    v_cvt_pk_bf16_f32 v207, v54, v55
    v_mfma_f32_16x16x32_bf16 v[172:175], a[196:199], v[104:107], v[172:175]
    s_waitcnt vmcnt(14)
    v_exp_f32 v52, v116
    v_mfma_f32_16x16x32_bf16 v[164:167], a[196:199], v[96:99], v[32:35]
    s_barrier
    v_mfma_f32_16x16x32_bf16 v[164:167], a[192:195], v[64:67], v[164:167]
    s_waitcnt lgkmcnt(2)
    v_add_f32 v25, v25, v55
    v_cvt_pk_bf16_f32 v212, v48, v49
    v_add_u32 v16, s42, v18
    v_mfma_f32_16x16x32_bf16 v[164:167], a[200:203], v[128:131], v[164:167]
    s_add_u32 m0, s49, 102272
    ds_read_b128 a[224:227], v16 offset:0
    v_add_f32 v26, v48, v49
    v_mfma_f32_16x16x32_bf16 v[164:167], a[204:207], v[160:163], v[164:167]
    buffer_load_dwordx4 v7, s[16:19], s40 offen offset:128 lds
    v_add_u32 v17, s42, v19
    v_mfma_f32_16x16x32_bf16 v[172:175], a[204:207], v[168:171], v[172:175]
    ds_read_b128 a[228:231], v17 offset:0
    v_add_f32 v26, v26, v50
    v_mfma_f32_16x16x32_bf16 v[172:175], a[200:203], v[136:139], v[172:175]
    v_exp_f32 v53, v117
    v_mfma_f32_16x16x32_bf16 v[180:183], a[200:203], v[144:147], v[180:183]
    s_add_u32 m0, s49, 103168
    ds_read_b128 a[232:235], v16 offset:1024
    v_cvt_pk_bf16_f32 v213, v50, v51
    v_mfma_f32_16x16x32_bf16 v[180:183], a[204:207], v[176:179], v[180:183]
    buffer_load_dwordx4 v7, s[16:19], s40 offen offset:256 lds
    v_mfma_f32_16x16x32_bf16 v[188:191], a[204:207], v[184:187], v[188:191]
    s_add_u32 s40, s40, 24576
    ds_read_b128 a[236:239], v17 offset:1024
    v_add_f32 v26, v26, v51
    v_mfma_f32_16x16x32_bf16 v[188:191], a[200:203], v[152:155], v[188:191]
    s_waitcnt lgkmcnt(4)
    v_exp_f32 v54, v118
    v_mfma_f32_16x16x32_bf16 v[188:191], a[208:211], v[216:219], v[188:191]
    ds_read_b128 a[240:243], v16 offset:2048
    v_add_f32 v26, v26, v52
    v_mfma_f32_16x16x32_bf16 v[188:191], a[212:215], v[248:251], v[188:191]
    v_exp_f32 v55, v119
    v_mfma_f32_16x16x32_bf16 v[180:183], a[212:215], v[240:243], v[180:183]
    ds_read_b128 a[244:247], v17 offset:2048
    v_cvt_pk_bf16_f32 v214, v52, v53
    v_mfma_f32_16x16x32_bf16 v[180:183], a[208:211], v[208:211], v[180:183]
    v_exp_f32 v48, v92
    v_mfma_f32_16x16x32_bf16 v[172:175], a[208:211], v[200:203], v[172:175]
    v_exp_f32 v49, v93
    v_mfma_f32_16x16x32_bf16 v[172:175], a[212:215], v[232:235], v[172:175]
    v_exp_f32 v50, v94
    v_mfma_f32_16x16x32_bf16 v[164:167], a[212:215], v[224:227], v[164:167]
    v_add_f32 v26, v26, v53
    v_add_f32 v26, v26, v54
    v_mfma_f32_16x16x32_bf16 v[164:167], a[208:211], v[192:195], v[164:167]
    v_cvt_pk_bf16_f32 v215, v54, v55
    v_add_f32 v26, v26, v55
    v_max3_f32 v29, v24, v25, v26
    v_cvt_pk_bf16_f32 v220, v48, v49
    v_exp_f32 v51, v95
    v_add_f32 v27, v48, v49
    v_cvt_pk_bf16_f32 v221, v50, v51
    v_exp_f32 v52, v124
    v_exp_f32 v53, v125
    v_add_f32 v27, v27, v50
    v_cvt_pk_bf16_f32 v222, v52, v53
    v_exp_f32 v54, v126
    v_exp_f32 v55, v127
    v_add_f32 v27, v27, v51
    v_cvt_pk_bf16_f32 v223, v54, v55
    v_add_f32 v27, v27, v52
    v_add_f32 v27, v27, v53
    v_add_f32 v27, v27, v54
    v_add_f32 v27, v27, v55
    v_max_f32 v29, v29, v27
    v_cmp_nle_f32 vcc, v29, v30
    v_min3_f32 v29, v24, v25, v26
    v_min_f32 v29, v29, v27
    v_cmp_gt_f32 s[88:89], v56, v29
    s_or_b64 vcc, vcc, s[88:89]
    s_cbranch_vccnz rare_p
rare_p_ret:
    s_waitcnt lgkmcnt(0)
at_switch:
at_dry:
    s_mov_b32 s76, 0
    s_branch at_loop
    .p2align 12
pg_6:
    s_cbranch_execz pg_10
at_loop:
    v_mfma_f32_16x16x32_bf16 v[68:71], a[224:227], v[64:67], v[32:35]
    ds_read_b128 a[192:195], v16 offset:6144
    v_add_f32 v20, v20, v24
    v_mfma_f32_16x16x32_bf16 v[68:71], a[228:231], v[96:99], v[68:71]
    s_add_u32 s77, s38, s76
    v_add_f32 v21, v21, v25
    v_add_f32 v22, v22, v26
    v_mfma_f32_16x16x32_bf16 v[68:71], a[232:235], v[128:131], v[68:71]
    v_add_f32 v23, v23, v27
    v_add_u32 v8, s41, v12
    v_mfma_f32_16x16x32_bf16 v[68:71], a[236:239], v[160:163], v[68:71]
    ds_read_b128 a[196:199], v17 offset:6144
    v_add_u32 v9, s41, v13
    v_mfma_f32_16x16x32_bf16 v[68:71], a[240:243], v[192:195], v[68:71]
    v_exp_f32 v48, v132
    v_mfma_f32_16x16x32_bf16 v[68:71], a[244:247], v[224:227], v[68:71]
    s_add_u32 m0, s41, 0
    v_exp_f32 v49, v133
    v_mfma_f32_16x16x32_bf16 v[76:79], a[244:247], v[232:235], v[36:39]
    ds_read_b128 a[200:203], v16 offset:7168
    v_cvt_pk_bf16_f32 v228, v48, v49
    v_mfma_f32_16x16x32_bf16 v[76:79], a[240:243], v[200:203], v[76:79]
    buffer_load_dwordx4 v4, s[12:15], s38 offen offset:0 lds
    v_mfma_f32_16x16x32_bf16 v[76:79], a[236:239], v[168:171], v[76:79]
    v_exp_f32 v50, v134
    v_mfma_f32_16x16x32_bf16 v[76:79], a[232:235], v[136:139], v[76:79]
    ds_read_b128 a[204:207], v17 offset:7168
    v_add_f32 v24, v48, v49
    v_mfma_f32_16x16x32_bf16 v[76:79], a[228:231], v[104:107], v[76:79]
    v_exp_f32 v51, v135
    v_mfma_f32_16x16x32_bf16 v[76:79], a[224:227], v[72:75], v[76:79]
    v_exp_f32 v52, v164
    v_mfma_f32_16x16x32_bf16 v[84:87], a[224:227], v[80:83], v[40:43]
    ds_read_b128 a[208:211], v16 offset:8192
    v_add_f32 v24, v24, v50
    v_mfma_f32_16x16x32_bf16 v[84:87], a[228:231], v[112:115], v[84:87]
    v_exp_f32 v53, v165
    v_mfma_f32_16x16x32_bf16 v[84:87], a[232:235], v[144:147], v[84:87]
    v_exp_f32 v54, v166
    v_mfma_f32_16x16x32_bf16 v[84:87], a[236:239], v[176:179], v[84:87]
    ds_read_b128 a[212:215], v17 offset:8192
    v_add_u32 v10, s41, v14
    v_mfma_f32_16x16x32_bf16 v[84:87], a[240:243], v[208:211], v[84:87]
    v_exp_f32 v55, v167
    v_mfma_f32_16x16x32_bf16 v[84:87], a[244:247], v[240:243], v[84:87]
    s_add_u32 m0, s41, 896
    v_cvt_pk_bf16_f32 v229, v50, v51
    v_add_f32 v24, v24, v51
    v_mfma_f32_16x16x32_bf16 v[92:95], a[244:247], v[248:251], v[44:47]
    buffer_load_dwordx4 v4, s[12:15], s38 offen offset:128 lds
    v_mfma_f32_16x16x32_bf16 v[92:95], a[240:243], v[216:219], v[92:95]
    v_exp_f32 v48, v140
    v_mfma_f32_16x16x32_bf16 v[92:95], a[236:239], v[184:187], v[92:95]
    v_add_u32 v11, s41, v15
    v_add_f32 v24, v24, v52
    v_mfma_f32_16x16x32_bf16 v[92:95], a[232:235], v[152:155], v[92:95]
    v_exp_f32 v49, v141
    v_mfma_f32_16x16x32_bf16 v[92:95], a[228:231], v[120:123], v[92:95]
    v_cvt_pk_bf16_f32 v230, v52, v53
    v_add_f32 v24, v24, v53
    v_mfma_f32_16x16x32_bf16 v[92:95], a[224:227], v[88:91], v[92:95]
    s_waitcnt lgkmcnt(0)
    v_exp_f32 v50, v142
    v_mfma_f32_16x16x32_bf16 v[124:127], a[192:195], v[88:91], v[44:47]
    ds_read_b64_tr_b16 a[224:225], v8 offset:0
    v_add_f32 v24, v24, v54
    v_mfma_f32_16x16x32_bf16 v[124:127], a[196:199], v[120:123], v[124:127]
    ds_read_b64_tr_b16 a[226:227], v8 offset:6144
    v_cvt_pk_bf16_f32 v231, v54, v55
    v_mfma_f32_16x16x32_bf16 v[124:127], a[200:203], v[152:155], v[124:127]
    v_exp_f32 v51, v143
    v_mfma_f32_16x16x32_bf16 v[124:127], a[204:207], v[184:187], v[124:127]
    ds_read_b64_tr_b16 a[228:229], v9 offset:0
    v_add_f32 v24, v24, v55
    v_mfma_f32_16x16x32_bf16 v[124:127], a[208:211], v[216:219], v[124:127]
    ds_read_b64_tr_b16 a[230:231], v9 offset:6144
    v_cvt_pk_bf16_f32 v236, v48, v49
    v_mfma_f32_16x16x32_bf16 v[124:127], a[212:215], v[248:251], v[124:127]
    v_exp_f32 v52, v172
    v_mfma_f32_16x16x32_bf16 v[116:119], a[212:215], v[240:243], v[40:43]
    ds_read_b64_tr_b16 a[232:233], v10 offset:0
    v_add_f32 v25, v48, v49
    v_mfma_f32_16x16x32_bf16 v[116:119], a[208:211], v[208:211], v[116:119]
    s_add_u32 m0, s41, 1792
    ds_read_b64_tr_b16 a[234:235], v10 offset:6144
    v_add_f32 v25, v25, v50
    v_mfma_f32_16x16x32_bf16 v[116:119], a[204:207], v[176:179], v[116:119]
    buffer_load_dwordx4 v4, s[12:15], s77 offen offset:256 lds
    v_mfma_f32_16x16x32_bf16 v[116:119], a[200:203], v[144:147], v[116:119]
    ds_read_b64_tr_b16 a[236:237], v11 offset:0
    v_cvt_pk_bf16_f32 v237, v50, v51
    v_mfma_f32_16x16x32_bf16 v[116:119], a[196:199], v[112:115], v[116:119]
    ds_read_b64_tr_b16 a[238:239], v11 offset:6144
    v_add_f32 v25, v25, v51
    v_mfma_f32_16x16x32_bf16 v[116:119], a[192:195], v[80:83], v[116:119]
    v_exp_f32 v53, v173
    v_mfma_f32_16x16x32_bf16 v[108:111], a[192:195], v[72:75], v[36:39]
    ds_read_b64_tr_b16 a[240:241], v8 offset:1024
    v_add_f32 v25, v25, v52
    v_mfma_f32_16x16x32_bf16 v[108:111], a[196:199], v[104:107], v[108:111]
    ds_read_b64_tr_b16 a[242:243], v8 offset:7168
    v_cvt_pk_bf16_f32 v238, v52, v53
    v_mfma_f32_16x16x32_bf16 v[108:111], a[200:203], v[136:139], v[108:111]
    v_exp_f32 v54, v174
    v_mfma_f32_16x16x32_bf16 v[108:111], a[204:207], v[168:171], v[108:111]
    ds_read_b64_tr_b16 a[244:245], v9 offset:1024
    v_add_f32 v25, v25, v53
    v_mfma_f32_16x16x32_bf16 v[108:111], a[208:211], v[200:203], v[108:111]
    ds_read_b64_tr_b16 a[246:247], v9 offset:7168
    v_add_f32 v25, v25, v54
    v_mfma_f32_16x16x32_bf16 v[108:111], a[212:215], v[232:235], v[108:111]
    v_exp_f32 v55, v175
    v_mfma_f32_16x16x32_bf16 v[100:103], a[212:215], v[224:227], v[32:35]
    v_exp_f32 v48, v148
    v_mfma_f32_16x16x32_bf16 v[100:103], a[208:211], v[192:195], v[100:103]
    v_exp_f32 v49, v149
    v_mfma_f32_16x16x32_bf16 v[100:103], a[204:207], v[160:163], v[100:103]
    v_exp_f32 v50, v150
    v_mfma_f32_16x16x32_bf16 v[100:103], a[200:203], v[128:131], v[100:103]
    s_add_u32 m0, s41, 3072
    v_exp_f32 v51, v151
    v_mfma_f32_16x16x32_bf16 v[100:103], a[196:199], v[96:99], v[100:103]
    buffer_load_dwordx4 v5, s[12:15], s38 offen offset:0 lds
    v_mfma_f32_16x16x32_bf16 v[100:103], a[192:195], v[64:67], v[100:103]
    s_waitcnt lgkmcnt(0)
    v_cvt_pk_bf16_f32 v239, v54, v55
    v_add_f32 v25, v25, v55
    v_mfma_f32_16x16x32_bf16 a[0:3], a[224:227], v[196:199], a[0:3]
    ds_read_b64_tr_b16 a[192:193], v10 offset:1024
    v_cvt_pk_bf16_f32 v244, v48, v49
    v_mfma_f32_16x16x32_bf16 a[16:19], a[228:231], v[196:199], a[16:19]
    ds_read_b64_tr_b16 a[194:195], v10 offset:7168
    v_add_f32 v26, v48, v49
    v_mfma_f32_16x16x32_bf16 a[32:35], a[232:235], v[196:199], a[32:35]
    v_exp_f32 v52, v180
    v_mfma_f32_16x16x32_bf16 a[48:51], a[236:239], v[196:199], a[48:51]
    ds_read_b64_tr_b16 a[196:197], v11 offset:1024
    v_add_f32 v26, v26, v50
    v_mfma_f32_16x16x32_bf16 a[64:67], a[240:243], v[196:199], a[64:67]
    ds_read_b64_tr_b16 a[198:199], v11 offset:7168
    v_cvt_pk_bf16_f32 v245, v50, v51
    v_mfma_f32_16x16x32_bf16 a[80:83], a[244:247], v[196:199], a[80:83]
    v_exp_f32 v53, v181
    v_mfma_f32_16x16x32_bf16 a[84:87], a[244:247], v[204:207], a[84:87]
    ds_read_b64_tr_b16 a[200:201], v8 offset:2048
    v_add_f32 v26, v26, v51
    v_mfma_f32_16x16x32_bf16 a[68:71], a[240:243], v[204:207], a[68:71]
    ds_read_b64_tr_b16 a[202:203], v8 offset:8192
    v_add_f32 v26, v26, v52
    v_mfma_f32_16x16x32_bf16 a[52:55], a[236:239], v[204:207], a[52:55]
    v_exp_f32 v54, v182
    v_mfma_f32_16x16x32_bf16 a[36:39], a[232:235], v[204:207], a[36:39]
    ds_read_b64_tr_b16 a[204:205], v9 offset:2048
    v_cvt_pk_bf16_f32 v246, v52, v53
    v_mfma_f32_16x16x32_bf16 a[20:23], a[228:231], v[204:207], a[20:23]
    ds_read_b64_tr_b16 a[206:207], v9 offset:8192
    v_add_f32 v26, v26, v53
    v_mfma_f32_16x16x32_bf16 a[4:7], a[224:227], v[204:207], a[4:7]
    s_add_u32 m0, s41, 3968
    v_exp_f32 v55, v183
    v_mfma_f32_16x16x32_bf16 a[8:11], a[224:227], v[212:215], a[8:11]
    ds_read_b64_tr_b16 a[208:209], v10 offset:2048
    v_add_f32 v26, v26, v54
    v_mfma_f32_16x16x32_bf16 a[24:27], a[228:231], v[212:215], a[24:27]
    ds_read_b64_tr_b16 a[210:211], v10 offset:8192
    v_cvt_pk_bf16_f32 v247, v54, v55
    v_mfma_f32_16x16x32_bf16 a[40:43], a[232:235], v[212:215], a[40:43]
    buffer_load_dwordx4 v5, s[12:15], s38 offen offset:128 lds
    v_mfma_f32_16x16x32_bf16 a[56:59], a[236:239], v[212:215], a[56:59]
    ds_read_b64_tr_b16 a[212:213], v11 offset:2048
    v_add_f32 v26, v26, v55
    v_mfma_f32_16x16x32_bf16 a[72:75], a[240:243], v[212:215], a[72:75]
    ds_read_b64_tr_b16 a[214:215], v11 offset:8192
    v_max3_f32 v29, v24, v25, v26
    v_mfma_f32_16x16x32_bf16 a[88:91], a[244:247], v[212:215], a[88:91]
    v_exp_f32 v48, v156
    v_mfma_f32_16x16x32_bf16 a[92:95], a[244:247], v[220:223], a[92:95]
    v_exp_f32 v49, v157
    v_mfma_f32_16x16x32_bf16 a[76:79], a[240:243], v[220:223], a[76:79]
    v_exp_f32 v50, v158
    v_mfma_f32_16x16x32_bf16 a[60:63], a[236:239], v[220:223], a[60:63]
    v_exp_f32 v51, v159
    v_mfma_f32_16x16x32_bf16 a[44:47], a[232:235], v[220:223], a[44:47]
    v_exp_f32 v52, v188
    v_mfma_f32_16x16x32_bf16 a[28:31], a[228:231], v[220:223], a[28:31]
    v_exp_f32 v53, v189
    v_mfma_f32_16x16x32_bf16 a[12:15], a[224:227], v[220:223], a[12:15]
    s_waitcnt lgkmcnt(0)
    v_cvt_pk_bf16_f32 v252, v48, v49
    v_add_f32 v27, v48, v49
    v_mfma_f32_16x16x32_bf16 a[108:111], a[192:195], v[220:223], a[108:111]
    ds_read_b128 a[224:227], v16 offset:12288
    v_add_f32 v27, v27, v50
    v_mfma_f32_16x16x32_bf16 a[124:127], a[196:199], v[220:223], a[124:127]
    s_add_u32 m0, s41, 4864
    v_exp_f32 v54, v190
    v_mfma_f32_16x16x32_bf16 a[140:143], a[200:203], v[220:223], a[140:143]
    buffer_load_dwordx4 v5, s[12:15], s77 offen offset:256 lds
    v_mfma_f32_16x16x32_bf16 a[156:159], a[204:207], v[220:223], a[156:159]
    ds_read_b128 a[228:231], v17 offset:12288
    v_cvt_pk_bf16_f32 v253, v50, v51
    v_mfma_f32_16x16x32_bf16 a[172:175], a[208:211], v[220:223], a[172:175]
    s_add_u32 s38, s38, s39
    v_exp_f32 v55, v191
    v_mfma_f32_16x16x32_bf16 a[188:191], a[212:215], v[220:223], a[188:191]
    s_add_u32 s77, s40, s66
    v_add_f32 v27, v27, v51
    v_mfma_f32_16x16x32_bf16 a[184:187], a[212:215], v[212:215], a[184:187]
    ds_read_b128 a[232:235], v16 offset:13312
    v_add_f32 v27, v27, v52
    v_mfma_f32_16x16x32_bf16 a[168:171], a[208:211], v[212:215], a[168:171]
    v_cvt_pk_bf16_f32 v254, v52, v53
    v_mfma_f32_16x16x32_bf16 a[152:155], a[204:207], v[212:215], a[152:155]
    v_add_f32 v27, v27, v53
    v_mfma_f32_16x16x32_bf16 a[136:139], a[200:203], v[212:215], a[136:139]
    ds_read_b128 a[236:239], v17 offset:13312
    v_add_f32 v27, v27, v54
    v_mfma_f32_16x16x32_bf16 a[120:123], a[196:199], v[212:215], a[120:123]
    v_cvt_pk_bf16_f32 v255, v54, v55
    v_mfma_f32_16x16x32_bf16 a[104:107], a[192:195], v[212:215], a[104:107]
    v_add_f32 v27, v27, v55
    v_mfma_f32_16x16x32_bf16 a[100:103], a[192:195], v[204:207], a[100:103]
    ds_read_b128 a[240:243], v16 offset:14336
    v_max_f32 v29, v29, v27
    v_mfma_f32_16x16x32_bf16 a[116:119], a[196:199], v[204:207], a[116:119]
    v_cmp_nle_f32 vcc, v29, v30
    v_mfma_f32_16x16x32_bf16 a[132:135], a[200:203], v[204:207], a[132:135]
    v_mfma_f32_16x16x32_bf16 a[148:151], a[204:207], v[204:207], a[148:151]
    s_add_u32 m0, s43, 73728
    ds_read_b128 a[244:247], v17 offset:14336
    v_mfma_f32_16x16x32_bf16 a[164:167], a[208:211], v[204:207], a[164:167]
    buffer_load_dwordx4 v6, s[16:19], s40 offen offset:0 lds
    v_mfma_f32_16x16x32_bf16 a[180:183], a[212:215], v[204:207], a[180:183]
    v_mfma_f32_16x16x32_bf16 a[176:179], a[212:215], v[196:199], a[176:179]
    s_cmp_eq_u32 s45, 2
    s_cselect_b64 s[88:89], -1, 0
    s_cselect_b64 s[12:13], s[8:9], s[12:13]
    v_mfma_f32_16x16x32_bf16 a[160:163], a[208:211], v[196:199], a[160:163]
    s_cmp_eq_u32 s45, 2
    s_cselect_b32 s14, s10, s14
    s_cselect_b32 s38, s36, s38
    v_mfma_f32_16x16x32_bf16 a[144:147], a[204:207], v[196:199], a[144:147]
    s_cmp_eq_u32 s45, 2
    s_cselect_b32 s39, 81920, s39
    s_cselect_b32 s76, s63, s76
    v_mfma_f32_16x16x32_bf16 a[128:131], a[200:203], v[196:199], a[128:131]
    v_cndmask_b32 v4, v4, v62, s[88:89]
    v_cndmask_b32 v5, v5, v63, s[88:89]
    v_mfma_f32_16x16x32_bf16 a[112:115], a[196:199], v[196:199], a[112:115]
    v_mfma_f32_16x16x32_bf16 a[96:99], a[192:195], v[196:199], a[96:99]
    s_waitcnt lgkmcnt(0)
    s_cbranch_vccnz rare_a
rare_a_ret:
    v_mfma_f32_16x16x32_bf16 v[132:135], a[224:227], v[64:67], v[32:35]
    ds_read_b128 a[192:195], v16 offset:18432
    v_add_f32 v20, v20, v24
    v_mfma_f32_16x16x32_bf16 v[132:135], a[228:231], v[96:99], v[132:135]
    v_add_f32 v21, v21, v25
    v_add_f32 v22, v22, v26
    v_mfma_f32_16x16x32_bf16 v[132:135], a[232:235], v[128:131], v[132:135]
    v_add_f32 v23, v23, v27
    v_mfma_f32_16x16x32_bf16 v[132:135], a[236:239], v[160:163], v[132:135]
    ds_read_b128 a[196:199], v17 offset:18432
    v_mfma_f32_16x16x32_bf16 v[132:135], a[240:243], v[192:195], v[132:135]
    v_exp_f32 v48, v68
    v_mfma_f32_16x16x32_bf16 v[132:135], a[244:247], v[224:227], v[132:135]
    s_add_u32 m0, s43, 74624
    v_exp_f32 v49, v69
    v_mfma_f32_16x16x32_bf16 v[140:143], a[244:247], v[232:235], v[36:39]
    ds_read_b128 a[200:203], v16 offset:19456
    v_cvt_pk_bf16_f32 v196, v48, v49
    v_mfma_f32_16x16x32_bf16 v[140:143], a[240:243], v[200:203], v[140:143]
    buffer_load_dwordx4 v6, s[16:19], s40 offen offset:128 lds
    v_mfma_f32_16x16x32_bf16 v[140:143], a[236:239], v[168:171], v[140:143]
    v_exp_f32 v50, v70
    v_mfma_f32_16x16x32_bf16 v[140:143], a[232:235], v[136:139], v[140:143]
    ds_read_b128 a[204:207], v17 offset:19456
    v_add_f32 v24, v48, v49
    v_mfma_f32_16x16x32_bf16 v[140:143], a[228:231], v[104:107], v[140:143]
    v_exp_f32 v51, v71
    v_mfma_f32_16x16x32_bf16 v[140:143], a[224:227], v[72:75], v[140:143]
    v_exp_f32 v52, v100
    v_mfma_f32_16x16x32_bf16 v[148:151], a[224:227], v[80:83], v[40:43]
    ds_read_b128 a[208:211], v16 offset:20480
    v_add_f32 v24, v24, v50
    v_mfma_f32_16x16x32_bf16 v[148:151], a[228:231], v[112:115], v[148:151]
    v_exp_f32 v53, v101
    v_mfma_f32_16x16x32_bf16 v[148:151], a[232:235], v[144:147], v[148:151]
    v_exp_f32 v54, v102
    v_mfma_f32_16x16x32_bf16 v[148:151], a[236:239], v[176:179], v[148:151]
    ds_read_b128 a[212:215], v17 offset:20480
    v_cvt_pk_bf16_f32 v197, v50, v51
    v_mfma_f32_16x16x32_bf16 v[148:151], a[240:243], v[208:211], v[148:151]
    v_exp_f32 v55, v103
    v_mfma_f32_16x16x32_bf16 v[148:151], a[244:247], v[240:243], v[148:151]
    v_add_f32 v24, v24, v51
    v_add_f32 v24, v24, v52
    v_mfma_f32_16x16x32_bf16 v[156:159], a[244:247], v[248:251], v[44:47]
    v_exp_f32 v48, v76
    v_mfma_f32_16x16x32_bf16 v[156:159], a[240:243], v[216:219], v[156:159]
    s_add_u32 m0, s43, 75520
    v_exp_f32 v49, v77
    v_mfma_f32_16x16x32_bf16 v[156:159], a[236:239], v[184:187], v[156:159]
    buffer_load_dwordx4 v6, s[16:19], s77 offen offset:256 lds
    v_mfma_f32_16x16x32_bf16 v[156:159], a[232:235], v[152:155], v[156:159]
    v_cvt_pk_bf16_f32 v198, v52, v53
    v_add_f32 v24, v24, v53
    v_mfma_f32_16x16x32_bf16 v[156:159], a[228:231], v[120:123], v[156:159]
    v_exp_f32 v50, v78
    v_mfma_f32_16x16x32_bf16 v[156:159], a[224:227], v[88:91], v[156:159]
    s_waitcnt lgkmcnt(0)
    v_add_f32 v24, v24, v54
    v_cvt_pk_bf16_f32 v199, v54, v55
    v_mfma_f32_16x16x32_bf16 v[188:191], a[192:195], v[88:91], v[44:47]
    ds_read_b64_tr_b16 a[224:225], v8 offset:12288
    v_add_f32 v24, v24, v55
    v_mfma_f32_16x16x32_bf16 v[188:191], a[196:199], v[120:123], v[188:191]
    ds_read_b64_tr_b16 a[226:227], v8 offset:18432
    v_cvt_pk_bf16_f32 v204, v48, v49
    v_mfma_f32_16x16x32_bf16 v[188:191], a[200:203], v[152:155], v[188:191]
    v_exp_f32 v51, v79
    v_mfma_f32_16x16x32_bf16 v[188:191], a[204:207], v[184:187], v[188:191]
    ds_read_b64_tr_b16 a[228:229], v9 offset:12288
    v_add_f32 v25, v48, v49
    v_mfma_f32_16x16x32_bf16 v[188:191], a[208:211], v[216:219], v[188:191]
    ds_read_b64_tr_b16 a[230:231], v9 offset:18432
    v_add_f32 v25, v25, v50
    v_mfma_f32_16x16x32_bf16 v[188:191], a[212:215], v[248:251], v[188:191]
    v_exp_f32 v52, v108
    v_mfma_f32_16x16x32_bf16 v[180:183], a[212:215], v[240:243], v[40:43]
    ds_read_b64_tr_b16 a[232:233], v10 offset:12288
    v_cvt_pk_bf16_f32 v205, v50, v51
    v_mfma_f32_16x16x32_bf16 v[180:183], a[208:211], v[208:211], v[180:183]
    ds_read_b64_tr_b16 a[234:235], v10 offset:18432
    v_add_f32 v25, v25, v51
    v_mfma_f32_16x16x32_bf16 v[180:183], a[204:207], v[176:179], v[180:183]
    v_exp_f32 v53, v109
    v_mfma_f32_16x16x32_bf16 v[180:183], a[200:203], v[144:147], v[180:183]
    s_add_u32 m0, s43, 76800
    ds_read_b64_tr_b16 a[236:237], v11 offset:12288
    v_add_f32 v25, v25, v52
    v_mfma_f32_16x16x32_bf16 v[180:183], a[196:199], v[112:115], v[180:183]
    ds_read_b64_tr_b16 a[238:239], v11 offset:18432
    v_cvt_pk_bf16_f32 v206, v52, v53
    v_mfma_f32_16x16x32_bf16 v[180:183], a[192:195], v[80:83], v[180:183]
    buffer_load_dwordx4 v7, s[16:19], s40 offen offset:0 lds
    v_mfma_f32_16x16x32_bf16 v[172:175], a[192:195], v[72:75], v[36:39]
    ds_read_b64_tr_b16 a[240:241], v8 offset:13312
    v_add_f32 v25, v25, v53
    v_mfma_f32_16x16x32_bf16 v[172:175], a[196:199], v[104:107], v[172:175]
    ds_read_b64_tr_b16 a[242:243], v8 offset:19456
    v_add_u32 v16, s43, v18
    v_mfma_f32_16x16x32_bf16 v[172:175], a[200:203], v[136:139], v[172:175]
    v_exp_f32 v54, v110
    v_mfma_f32_16x16x32_bf16 v[172:175], a[204:207], v[168:171], v[172:175]
    ds_read_b64_tr_b16 a[244:245], v9 offset:13312
    v_add_f32 v25, v25, v54
    v_mfma_f32_16x16x32_bf16 v[172:175], a[208:211], v[200:203], v[172:175]
    ds_read_b64_tr_b16 a[246:247], v9 offset:19456
    v_add_u32 v17, s43, v19
    v_mfma_f32_16x16x32_bf16 v[172:175], a[212:215], v[232:235], v[172:175]
    v_exp_f32 v55, v111
    v_mfma_f32_16x16x32_bf16 v[164:167], a[212:215], v[224:227], v[32:35]
    v_exp_f32 v48, v84
    v_mfma_f32_16x16x32_bf16 v[164:167], a[208:211], v[192:195], v[164:167]
    v_exp_f32 v49, v85
    v_mfma_f32_16x16x32_bf16 v[164:167], a[204:207], v[160:163], v[164:167]
    v_exp_f32 v50, v86
    v_mfma_f32_16x16x32_bf16 v[164:167], a[200:203], v[128:131], v[164:167]
    v_exp_f32 v51, v87
    v_mfma_f32_16x16x32_bf16 v[164:167], a[196:199], v[96:99], v[164:167]
    v_cvt_pk_bf16_f32 v207, v54, v55
    v_add_f32 v25, v25, v55
    v_mfma_f32_16x16x32_bf16 v[164:167], a[192:195], v[64:67], v[164:167]
    s_waitcnt lgkmcnt(0)
    v_exp_f32 v52, v116
    v_mfma_f32_16x16x32_bf16 a[0:3], a[224:227], v[228:231], a[0:3]
    s_add_u32 m0, s43, 77696
    ds_read_b64_tr_b16 a[192:193], v10 offset:13312
    v_cvt_pk_bf16_f32 v212, v48, v49
    v_mfma_f32_16x16x32_bf16 a[16:19], a[228:231], v[228:231], a[16:19]
    ds_read_b64_tr_b16 a[194:195], v10 offset:19456
    v_add_f32 v26, v48, v49
    v_mfma_f32_16x16x32_bf16 a[32:35], a[232:235], v[228:231], a[32:35]
    buffer_load_dwordx4 v7, s[16:19], s40 offen offset:128 lds
    v_mfma_f32_16x16x32_bf16 a[48:51], a[236:239], v[228:231], a[48:51]
    ds_read_b64_tr_b16 a[196:197], v11 offset:13312
    v_add_f32 v26, v26, v50
    v_mfma_f32_16x16x32_bf16 a[64:67], a[240:243], v[228:231], a[64:67]
    ds_read_b64_tr_b16 a[198:199], v11 offset:19456
    v_cvt_pk_bf16_f32 v213, v50, v51
    v_mfma_f32_16x16x32_bf16 a[80:83], a[244:247], v[228:231], a[80:83]
    v_exp_f32 v53, v117
    v_mfma_f32_16x16x32_bf16 a[84:87], a[244:247], v[236:239], a[84:87]
    ds_read_b64_tr_b16 a[200:201], v8 offset:14336
    v_add_f32 v26, v26, v51
    v_mfma_f32_16x16x32_bf16 a[68:71], a[240:243], v[236:239], a[68:71]
    ds_read_b64_tr_b16 a[202:203], v8 offset:20480
    v_add_f32 v26, v26, v52
    v_mfma_f32_16x16x32_bf16 a[52:55], a[236:239], v[236:239], a[52:55]
    v_exp_f32 v54, v118
    v_mfma_f32_16x16x32_bf16 a[36:39], a[232:235], v[236:239], a[36:39]
    ds_read_b64_tr_b16 a[204:205], v9 offset:14336
    v_cvt_pk_bf16_f32 v214, v52, v53
    v_mfma_f32_16x16x32_bf16 a[20:23], a[228:231], v[236:239], a[20:23]
    ds_read_b64_tr_b16 a[206:207], v9 offset:20480
    v_add_f32 v26, v26, v53
    v_mfma_f32_16x16x32_bf16 a[4:7], a[224:227], v[236:239], a[4:7]
    v_exp_f32 v55, v119
    v_mfma_f32_16x16x32_bf16 a[8:11], a[224:227], v[244:247], a[8:11]
    ds_read_b64_tr_b16 a[208:209], v10 offset:14336
    v_add_f32 v26, v26, v54
    v_mfma_f32_16x16x32_bf16 a[24:27], a[228:231], v[244:247], a[24:27]
    s_add_u32 m0, s43, 78592
    ds_read_b64_tr_b16 a[210:211], v10 offset:20480
    v_cvt_pk_bf16_f32 v215, v54, v55
    v_mfma_f32_16x16x32_bf16 a[40:43], a[232:235], v[244:247], a[40:43]
    buffer_load_dwordx4 v7, s[16:19], s77 offen offset:256 lds
    v_mfma_f32_16x16x32_bf16 a[56:59], a[236:239], v[244:247], a[56:59]
    ds_read_b64_tr_b16 a[212:213], v11 offset:14336
    v_add_f32 v26, v26, v55
    v_mfma_f32_16x16x32_bf16 a[72:75], a[240:243], v[244:247], a[72:75]
    s_add_u32 s40, s40, 24576
    ds_read_b64_tr_b16 a[214:215], v11 offset:20480
    v_max3_f32 v29, v24, v25, v26
    v_mfma_f32_16x16x32_bf16 a[88:91], a[244:247], v[244:247], a[88:91]
    s_add_u32 s77, s38, s39
    v_exp_f32 v48, v92
    v_mfma_f32_16x16x32_bf16 a[92:95], a[244:247], v[252:255], a[92:95]
    v_exp_f32 v49, v93
    v_mfma_f32_16x16x32_bf16 a[76:79], a[240:243], v[252:255], a[76:79]
    v_exp_f32 v50, v94
    v_mfma_f32_16x16x32_bf16 a[60:63], a[236:239], v[252:255], a[60:63]
    v_exp_f32 v51, v95
    v_mfma_f32_16x16x32_bf16 a[44:47], a[232:235], v[252:255], a[44:47]
    s_waitcnt vmcnt(12)
    v_exp_f32 v52, v124
    v_mfma_f32_16x16x32_bf16 a[28:31], a[228:231], v[252:255], a[28:31]
    s_barrier
    v_mfma_f32_16x16x32_bf16 a[12:15], a[224:227], v[252:255], a[12:15]
    s_waitcnt lgkmcnt(0)
    v_exp_f32 v53, v125
    v_mfma_f32_16x16x32_bf16 a[108:111], a[192:195], v[252:255], a[108:111]
    ds_read_b128 a[224:227], v16 offset:0
    v_cvt_pk_bf16_f32 v220, v48, v49
    v_mfma_f32_16x16x32_bf16 a[124:127], a[196:199], v[252:255], a[124:127]
    v_add_f32 v27, v48, v49
    v_mfma_f32_16x16x32_bf16 a[140:143], a[200:203], v[252:255], a[140:143]
    v_exp_f32 v54, v126
    v_mfma_f32_16x16x32_bf16 a[156:159], a[204:207], v[252:255], a[156:159]
    ds_read_b128 a[228:231], v17 offset:0
    v_add_f32 v27, v27, v50
    v_mfma_f32_16x16x32_bf16 a[172:175], a[208:211], v[252:255], a[172:175]
    v_exp_f32 v55, v127
    v_mfma_f32_16x16x32_bf16 a[188:191], a[212:215], v[252:255], a[188:191]
    v_cvt_pk_bf16_f32 v221, v50, v51
    v_add_f32 v27, v27, v51
    v_mfma_f32_16x16x32_bf16 a[184:187], a[212:215], v[244:247], a[184:187]
    ds_read_b128 a[232:235], v16 offset:1024
    v_add_f32 v27, v27, v52
    v_mfma_f32_16x16x32_bf16 a[168:171], a[208:211], v[244:247], a[168:171]
    v_cvt_pk_bf16_f32 v222, v52, v53
    v_mfma_f32_16x16x32_bf16 a[152:155], a[204:207], v[244:247], a[152:155]
    v_add_f32 v27, v27, v53
    v_mfma_f32_16x16x32_bf16 a[136:139], a[200:203], v[244:247], a[136:139]
    ds_read_b128 a[236:239], v17 offset:1024
    v_add_f32 v27, v27, v54
    v_mfma_f32_16x16x32_bf16 a[120:123], a[196:199], v[244:247], a[120:123]
    buffer_load_dword a216, v2, s[28:31], s6 offen
    v_mfma_f32_16x16x32_bf16 a[104:107], a[192:195], v[244:247], a[104:107]
    s_add_u32 s6, s6, 1536
    v_cvt_pk_bf16_f32 v223, v54, v55
    v_mfma_f32_16x16x32_bf16 a[100:103], a[192:195], v[236:239], a[100:103]
    s_mov_b32 s44, s41
    ds_read_b128 a[240:243], v16 offset:2048
    v_add_f32 v27, v27, v55
    v_mfma_f32_16x16x32_bf16 a[116:119], a[196:199], v[236:239], a[116:119]
    s_mov_b32 s41, s42
    v_max_f32 v29, v29, v27
    v_mfma_f32_16x16x32_bf16 a[132:135], a[200:203], v[236:239], a[132:135]
    s_mov_b32 s42, s43
    v_cmp_nle_f32 vcc, v29, v30
    s_mov_b32 s43, s44
    v_mfma_f32_16x16x32_bf16 a[148:151], a[204:207], v[236:239], a[148:151]
    ds_read_b128 a[244:247], v17 offset:2048
    v_mfma_f32_16x16x32_bf16 a[164:167], a[208:211], v[236:239], a[164:167]
    s_cmp_eq_u32 s45, 1
    s_cselect_b64 s[88:89], -1, 0
    s_cselect_b64 s[16:17], s[8:9], s[16:17]
    v_mfma_f32_16x16x32_bf16 a[180:183], a[212:215], v[236:239], a[180:183]
    s_cmp_eq_u32 s45, 1
    s_cselect_b32 s18, s10, s18
    s_cselect_b32 s40, s77, s40
    v_mfma_f32_16x16x32_bf16 a[176:179], a[212:215], v[228:231], a[176:179]
    s_cmp_eq_u32 s45, 1
    s_cselect_b32 s66, s63, s66
    v_mfma_f32_16x16x32_bf16 a[160:163], a[208:211], v[228:231], a[160:163]
    v_cndmask_b32 v6, v6, v62, s[88:89]
    v_cndmask_b32 v7, v7, v63, s[88:89]
    v_mfma_f32_16x16x32_bf16 a[144:147], a[204:207], v[228:231], a[144:147]
    s_sub_u32 s45, s45, 1
    v_mfma_f32_16x16x32_bf16 a[128:131], a[200:203], v[228:231], a[128:131]
    v_mfma_f32_16x16x32_bf16 a[112:115], a[196:199], v[228:231], a[112:115]
    s_waitcnt lgkmcnt(0)
    v_mfma_f32_16x16x32_bf16 a[96:99], a[192:195], v[228:231], a[96:99]
    s_cbranch_vccnz rare_b
rare_b_ret:
    s_cbranch_scc0 at_loop
tail_code:
    v_add_u32 v8, s41, v12
    v_add_u32 v9, s41, v13
    v_add_u32 v10, s41, v14
    v_add_u32 v11, s41, v15
    s_waitcnt lgkmcnt(0)
    ds_read_b64_tr_b16 a[192:193], v8 offset:0
    ds_read_b64_tr_b16 a[194:195], v8 offset:6144
    ds_read_b64_tr_b16 a[196:197], v9 offset:0
    ds_read_b64_tr_b16 a[198:199], v9 offset:6144
    ds_read_b64_tr_b16 a[200:201], v10 offset:0
    ds_read_b64_tr_b16 a[202:203], v10 offset:6144
    ds_read_b64_tr_b16 a[204:205], v11 offset:0
    ds_read_b64_tr_b16 a[206:207], v11 offset:6144
    s_waitcnt lgkmcnt(4)
    v_mfma_f32_16x16x32_bf16 a[0:3], a[192:195], v[196:199], a[0:3]
    s_add_u32 s38, s33, 0
    ds_read_b64_tr_b16 a[208:209], v8 offset:1024
    v_add_f32 v20, v20, v24
    v_mfma_f32_16x16x32_bf16 a[16:19], a[196:199], v[196:199], a[16:19]
    s_add_u32 s57, s34, 0
    ds_read_b64_tr_b16 a[210:211], v8 offset:7168
    v_add_f32 v21, v21, v25
    v_mfma_f32_16x16x32_bf16 a[20:23], a[196:199], v[204:207], a[20:23]
    buffer_load_dword v61, v60, s[24:27], s37 offen sc1
    v_mfma_f32_16x16x32_bf16 a[4:7], a[192:195], v[204:207], a[4:7]
    s_cmp_lt_u32 s3, 2
    s_cselect_b32 s38, s38, s57
    v_add_f32 v22, v22, v26
    v_mfma_f32_16x16x32_bf16 a[8:11], a[192:195], v[212:215], a[8:11]
    s_add_u32 s76, s38, s63
    ds_read_b64_tr_b16 a[212:213], v9 offset:1024
    v_add_f32 v23, v23, v27
    v_mfma_f32_16x16x32_bf16 a[24:27], a[196:199], v[212:215], a[24:27]
    s_add_u32 m0, s49, 24576
    ds_read_b64_tr_b16 a[214:215], v9 offset:7168
    s_and_b32 s59, s51, 1
    v_mfma_f32_16x16x32_bf16 a[28:31], a[196:199], v[220:223], a[28:31]
    buffer_load_dwordx4 v4, s[12:15], s38 offen offset:0 lds
    v_mfma_f32_16x16x32_bf16 a[12:15], a[192:195], v[220:223], a[12:15]
    s_waitcnt lgkmcnt(4)
    v_exp_f32 v48, v132
    v_mfma_f32_16x16x32_bf16 a[44:47], a[200:203], v[220:223], a[44:47]
    s_lshl_b32 s59, s59, 6
    ds_read_b64_tr_b16 a[192:193], v10 offset:1024
    s_sub_u32 s44, s49, 73728
    v_mfma_f32_16x16x32_bf16 a[60:63], a[204:207], v[220:223], a[60:63]
    s_add_u32 m0, s49, 25472
    ds_read_b64_tr_b16 a[194:195], v10 offset:7168
    v_add_u32 v12, s44, v12
    v_mfma_f32_16x16x32_bf16 a[56:59], a[204:207], v[212:215], a[56:59]
    buffer_load_dwordx4 v4, s[12:15], s38 offen offset:128 lds
    v_mfma_f32_16x16x32_bf16 a[40:43], a[200:203], v[212:215], a[40:43]
    v_add_u32 v13, s44, v13
    v_add_u32 v14, s44, v14
    v_mfma_f32_16x16x32_bf16 a[36:39], a[200:203], v[204:207], a[36:39]
    ds_read_b64_tr_b16 a[196:197], v11 offset:1024
    v_add_u32 v15, s44, v15
    v_mfma_f32_16x16x32_bf16 a[52:55], a[204:207], v[204:207], a[52:55]
    s_add_u32 m0, s49, 26368
    ds_read_b64_tr_b16 a[198:199], v11 offset:7168
    s_mov_b32 s39, s59
    v_mfma_f32_16x16x32_bf16 a[48:51], a[204:207], v[196:199], a[48:51]
    buffer_load_dwordx4 v4, s[12:15], s76 offen offset:256 lds
    v_mfma_f32_16x16x32_bf16 a[32:35], a[200:203], v[196:199], a[32:35]
    s_waitcnt lgkmcnt(4)
    v_exp_f32 v49, v133
    v_mfma_f32_16x16x32_bf16 a[64:67], a[208:211], v[196:199], a[64:67]
    s_lshl_b32 s36, s3, 10
    ds_read_b64_tr_b16 a[200:201], v8 offset:2048
    v_cvt_pk_bf16_f32 v228, v48, v49
    v_mfma_f32_16x16x32_bf16 a[80:83], a[212:215], v[196:199], a[80:83]
    s_add_u32 m0, s49, 27648
    ds_read_b64_tr_b16 a[202:203], v8 offset:8192
    v_add_f32 v24, v48, v49
    v_mfma_f32_16x16x32_bf16 a[84:87], a[212:215], v[204:207], a[84:87]
    buffer_load_dwordx4 v5, s[12:15], s38 offen offset:0 lds
    v_mfma_f32_16x16x32_bf16 a[68:71], a[208:211], v[204:207], a[68:71]
    v_exp_f32 v50, v134
    v_mfma_f32_16x16x32_bf16 a[72:75], a[208:211], v[212:215], a[72:75]
    ds_read_b64_tr_b16 a[204:205], v9 offset:2048
    v_add_f32 v24, v24, v50
    v_mfma_f32_16x16x32_bf16 a[88:91], a[212:215], v[212:215], a[88:91]
    s_add_u32 m0, s49, 28544
    ds_read_b64_tr_b16 a[206:207], v9 offset:8192
    v_mfma_f32_16x16x32_bf16 a[92:95], a[212:215], v[220:223], a[92:95]
    buffer_load_dwordx4 v5, s[12:15], s38 offen offset:128 lds
    v_mfma_f32_16x16x32_bf16 a[76:79], a[208:211], v[220:223], a[76:79]
    s_waitcnt lgkmcnt(4)
    v_exp_f32 v51, v135
    v_mfma_f32_16x16x32_bf16 a[108:111], a[192:195], v[220:223], a[108:111]
    ds_read_b64_tr_b16 a[208:209], v10 offset:2048
    v_cvt_pk_bf16_f32 v229, v50, v51
    v_mfma_f32_16x16x32_bf16 a[124:127], a[196:199], v[220:223], a[124:127]
    s_add_u32 m0, s49, 29440
    ds_read_b64_tr_b16 a[210:211], v10 offset:8192
    v_add_f32 v24, v24, v51
    v_mfma_f32_16x16x32_bf16 a[120:123], a[196:199], v[212:215], a[120:123]
    buffer_load_dwordx4 v5, s[12:15], s76 offen offset:256 lds
    v_mfma_f32_16x16x32_bf16 a[104:107], a[192:195], v[212:215], a[104:107]
    s_add_u32 s38, s35, 0
    v_exp_f32 v52, v164
    v_mfma_f32_16x16x32_bf16 a[100:103], a[192:195], v[204:207], a[100:103]
    s_add_u32 s57, s33, 40960
    ds_read_b64_tr_b16 a[212:213], v11 offset:2048
    v_add_f32 v24, v24, v52
    v_mfma_f32_16x16x32_bf16 a[116:119], a[196:199], v[204:207], a[116:119]
    s_cmp_lt_u32 s3, 2
    s_cselect_b32 s38, s38, s57
    ds_read_b64_tr_b16 a[214:215], v11 offset:8192
    v_mfma_f32_16x16x32_bf16 a[112:115], a[196:199], v[196:199], a[112:115]
    s_add_u32 s76, s38, s63
    v_exp_f32 v53, v165
    v_mfma_f32_16x16x32_bf16 a[96:99], a[192:195], v[196:199], a[96:99]
    s_waitcnt lgkmcnt(4)
    v_exp_f32 v54, v166
    v_mfma_f32_16x16x32_bf16 a[128:131], a[200:203], v[196:199], a[128:131]
    s_add_u32 m0, s49, 73728
    ds_read_b64_tr_b16 a[192:193], v8 offset:12288
    v_cvt_pk_bf16_f32 v230, v52, v53
    v_mfma_f32_16x16x32_bf16 a[144:147], a[204:207], v[196:199], a[144:147]
pg_7:
    s_cbranch_execz pg_11
    ds_read_b64_tr_b16 a[194:195], v8 offset:18432
    v_add_f32 v24, v24, v53
    v_mfma_f32_16x16x32_bf16 a[148:151], a[204:207], v[204:207], a[148:151]
    buffer_load_dwordx4 v4, s[12:15], s38 offen offset:0 lds
    v_mfma_f32_16x16x32_bf16 a[132:135], a[200:203], v[204:207], a[132:135]
    v_exp_f32 v55, v167
    v_mfma_f32_16x16x32_bf16 a[136:139], a[200:203], v[212:215], a[136:139]
    s_add_u32 m0, s49, 74624
    ds_read_b64_tr_b16 a[196:197], v9 offset:12288
    v_add_f32 v24, v24, v54
    v_mfma_f32_16x16x32_bf16 a[152:155], a[204:207], v[212:215], a[152:155]
    ds_read_b64_tr_b16 a[198:199], v9 offset:18432
    v_cvt_pk_bf16_f32 v231, v54, v55
    v_mfma_f32_16x16x32_bf16 a[156:159], a[204:207], v[220:223], a[156:159]
    buffer_load_dwordx4 v4, s[12:15], s38 offen offset:128 lds
    v_mfma_f32_16x16x32_bf16 a[140:143], a[200:203], v[220:223], a[140:143]
    s_waitcnt lgkmcnt(4)
    v_exp_f32 v48, v140
    v_mfma_f32_16x16x32_bf16 a[172:175], a[208:211], v[220:223], a[172:175]
    ds_read_b64_tr_b16 a[200:201], v10 offset:12288
    v_add_f32 v24, v24, v55
    v_mfma_f32_16x16x32_bf16 a[188:191], a[212:215], v[220:223], a[188:191]
    s_add_u32 m0, s49, 75520
    ds_read_b64_tr_b16 a[202:203], v10 offset:18432
    v_mfma_f32_16x16x32_bf16 a[184:187], a[212:215], v[212:215], a[184:187]
    buffer_load_dwordx4 v4, s[12:15], s76 offen offset:256 lds
    v_mfma_f32_16x16x32_bf16 a[168:171], a[208:211], v[212:215], a[168:171]
    v_exp_f32 v49, v141
    v_mfma_f32_16x16x32_bf16 a[164:167], a[208:211], v[204:207], a[164:167]
    ds_read_b64_tr_b16 a[204:205], v11 offset:12288
    v_cvt_pk_bf16_f32 v236, v48, v49
    v_mfma_f32_16x16x32_bf16 a[180:183], a[212:215], v[204:207], a[180:183]
    ds_read_b64_tr_b16 a[206:207], v11 offset:18432
    v_add_f32 v25, v48, v49
    v_mfma_f32_16x16x32_bf16 a[176:179], a[212:215], v[196:199], a[176:179]
    s_add_u32 m0, s49, 76800
    v_exp_f32 v50, v142
    v_mfma_f32_16x16x32_bf16 a[160:163], a[208:211], v[196:199], a[160:163]
    s_waitcnt lgkmcnt(4)
    v_exp_f32 v51, v143
    v_add_f32 v25, v25, v50
    v_cvt_pk_bf16_f32 v237, v50, v51
    v_exp_f32 v52, v172
    v_exp_f32 v53, v173
    v_add_f32 v25, v25, v51
    v_cvt_pk_bf16_f32 v238, v52, v53
    v_exp_f32 v54, v174
    v_exp_f32 v55, v175
    v_add_f32 v25, v25, v52
    v_cvt_pk_bf16_f32 v239, v54, v55
    v_add_f32 v25, v25, v53
    v_add_f32 v25, v25, v54
    v_add_f32 v25, v25, v55
    v_exp_f32 v48, v148
    v_exp_f32 v49, v149
    v_exp_f32 v50, v150
    v_cvt_pk_bf16_f32 v244, v48, v49
    v_exp_f32 v51, v151
    v_add_f32 v26, v48, v49
    v_cvt_pk_bf16_f32 v245, v50, v51
    v_exp_f32 v52, v180
    v_exp_f32 v53, v181
    v_add_f32 v26, v26, v50
    v_cvt_pk_bf16_f32 v246, v52, v53
    v_exp_f32 v54, v182
    v_exp_f32 v55, v183
    v_add_f32 v26, v26, v51
    v_cvt_pk_bf16_f32 v247, v54, v55
    v_add_f32 v26, v26, v52
    v_add_f32 v26, v26, v53
    v_add_f32 v26, v26, v54
    v_add_f32 v26, v26, v55
    v_max3_f32 v29, v24, v25, v26
    v_exp_f32 v48, v156
    v_exp_f32 v49, v157
    v_exp_f32 v50, v158
    v_cvt_pk_bf16_f32 v252, v48, v49
    v_exp_f32 v51, v159
    v_add_f32 v27, v48, v49
    v_cvt_pk_bf16_f32 v253, v50, v51
    v_exp_f32 v52, v188
    v_exp_f32 v53, v189
    v_add_f32 v27, v27, v50
    v_cvt_pk_bf16_f32 v254, v52, v53
    v_exp_f32 v54, v190
    v_exp_f32 v55, v191
    v_add_f32 v27, v27, v51
    v_cvt_pk_bf16_f32 v255, v54, v55
    v_add_f32 v27, v27, v52
    v_add_f32 v27, v27, v53
    v_add_f32 v27, v27, v54
    v_add_f32 v27, v27, v55
    v_max_f32 v29, v29, v27
    v_cmp_nle_f32 vcc, v29, v30
    s_cbranch_vccnz rare_e
rare_e_ret:
    v_mfma_f32_16x16x32_bf16 a[0:3], a[192:195], v[228:231], a[0:3]
    ds_read_b64_tr_b16 a[208:209], v8 offset:13312
    v_add_f32 v20, v20, v24
    v_mfma_f32_16x16x32_bf16 a[16:19], a[196:199], v[228:231], a[16:19]
    ds_read_b64_tr_b16 a[210:211], v8 offset:19456
    v_add_f32 v21, v21, v25
    v_mfma_f32_16x16x32_bf16 a[20:23], a[196:199], v[236:239], a[20:23]
    buffer_load_dwordx4 v5, s[12:15], s38 offen offset:0 lds
    v_mfma_f32_16x16x32_bf16 a[4:7], a[192:195], v[236:239], a[4:7]
    s_add_u32 m0, s49, 77696
    v_add_f32 v22, v22, v26
    v_add_f32 v23, v23, v27
    v_mfma_f32_16x16x32_bf16 a[8:11], a[192:195], v[244:247], a[8:11]
    ds_read_b64_tr_b16 a[212:213], v9 offset:13312
    v_mov_b32 v56, v20
    v_mfma_f32_16x16x32_bf16 a[24:27], a[196:199], v[244:247], a[24:27]
    ds_read_b64_tr_b16 a[214:215], v9 offset:19456
    v_mov_b32 v57, v21
    v_mfma_f32_16x16x32_bf16 a[28:31], a[196:199], v[252:255], a[28:31]
    buffer_load_dwordx4 v5, s[12:15], s38 offen offset:128 lds
    v_mfma_f32_16x16x32_bf16 a[12:15], a[192:195], v[252:255], a[12:15]
    s_waitcnt lgkmcnt(4)
    v_permlane16_swap_b32 v20, v56
    v_mfma_f32_16x16x32_bf16 a[44:47], a[200:203], v[252:255], a[44:47]
    s_add_u32 m0, s49, 78592
    ds_read_b64_tr_b16 a[192:193], v10 offset:13312
    v_add_f32 v20, v20, v56
    v_mfma_f32_16x16x32_bf16 a[60:63], a[204:207], v[252:255], a[60:63]
    ds_read_b64_tr_b16 a[194:195], v10 offset:19456
    v_mov_b32 v56, v20
    v_mfma_f32_16x16x32_bf16 a[56:59], a[204:207], v[244:247], a[56:59]
    buffer_load_dwordx4 v5, s[12:15], s76 offen offset:256 lds
    v_mfma_f32_16x16x32_bf16 a[40:43], a[200:203], v[244:247], a[40:43]
    v_permlane32_swap_b32 v20, v56
    v_mfma_f32_16x16x32_bf16 a[36:39], a[200:203], v[236:239], a[36:39]
    s_waitcnt vmcnt(12)
    ds_read_b64_tr_b16 a[196:197], v11 offset:13312
    v_cmp_ne_u32 vcc, s7, v61
    v_mfma_f32_16x16x32_bf16 a[52:55], a[204:207], v[236:239], a[52:55]
    s_lshl_b32 s11, s54, 16
    ds_read_b64_tr_b16 a[198:199], v11 offset:19456
    v_add_f32 v20, v20, v56
    v_mfma_f32_16x16x32_bf16 a[48:51], a[204:207], v[228:231], a[48:51]
    s_cbranch_vccnz spin_gu
spin_gu_ret:
    v_mul_f32 v20, 0x3c800000, v20
    v_mfma_f32_16x16x32_bf16 a[32:35], a[200:203], v[228:231], a[32:35]
    s_waitcnt lgkmcnt(4)
    v_rcp_f32 v20, v20
    v_mfma_f32_16x16x32_bf16 a[64:67], a[208:211], v[228:231], a[64:67]
    s_nop 0
    ds_read_b64_tr_b16 a[200:201], v8 offset:14336
    v_mov_b32 v58, v22
    v_mfma_f32_16x16x32_bf16 a[80:83], a[212:215], v[228:231], a[80:83]
    s_lshl_b32 s61, s47, 10
    ds_read_b64_tr_b16 a[202:203], v8 offset:20480
    v_mov_b32 v59, v23
    v_mfma_f32_16x16x32_bf16 a[84:87], a[212:215], v[236:239], a[84:87]
    s_add_u32 s61, s61, 3276800
    v_permlane16_swap_b32 v21, v57
    v_mfma_f32_16x16x32_bf16 a[68:71], a[208:211], v[236:239], a[68:71]
    s_add_u32 s56, s3, 0
    v_permlane16_swap_b32 v22, v58
    v_mfma_f32_16x16x32_bf16 a[72:75], a[208:211], v[244:247], a[72:75]
    s_min_u32 s56, s56, 9
    ds_read_b64_tr_b16 a[204:205], v9 offset:14336
    v_add_f32 v21, v21, v57
    v_mfma_f32_16x16x32_bf16 a[88:91], a[212:215], v[244:247], a[88:91]
    s_mul_i32 s57, s56, 24576
    ds_read_b64_tr_b16 a[206:207], v9 offset:20480
    v_mov_b32 v57, v21
    v_mfma_f32_16x16x32_bf16 a[92:95], a[212:215], v[252:255], a[92:95]
    s_add_u32 s57, s57, s61
    v_permlane32_swap_b32 v21, v57
    v_mfma_f32_16x16x32_bf16 a[76:79], a[208:211], v[252:255], a[76:79]
    s_waitcnt lgkmcnt(4)
    v_permlane16_swap_b32 v23, v59
    v_mfma_f32_16x16x32_bf16 a[108:111], a[192:195], v[252:255], a[108:111]
    s_lshl_b32 s56, s56, 10
    ds_read_b64_tr_b16 a[208:209], v10 offset:14336
    v_add_f32 v21, v21, v57
    v_mfma_f32_16x16x32_bf16 a[124:127], a[196:199], v[252:255], a[124:127]
    s_add_u32 m0, s56, 147456
    ds_read_b64_tr_b16 a[210:211], v10 offset:20480
    v_mul_f32 v21, 0x3c800000, v21
    v_mfma_f32_16x16x32_bf16 a[120:123], a[196:199], v[244:247], a[120:123]
    buffer_load_dwordx4 v28, s[24:27], s57 offen sc1 lds
    v_mfma_f32_16x16x32_bf16 a[104:107], a[192:195], v[244:247], a[104:107]
    s_add_u32 s56, s3, 4
    v_rcp_f32 v21, v21
    v_mfma_f32_16x16x32_bf16 a[100:103], a[192:195], v[236:239], a[100:103]
    s_min_u32 s56, s56, 9
    ds_read_b64_tr_b16 a[212:213], v11 offset:14336
    v_add_f32 v22, v22, v58
    v_mfma_f32_16x16x32_bf16 a[116:119], a[196:199], v[236:239], a[116:119]
    s_waitcnt vmcnt(34)
    ds_read_b64_tr_b16 a[214:215], v11 offset:20480
    v_mov_b32 v58, v22
    v_mfma_f32_16x16x32_bf16 a[112:115], a[196:199], v[228:231], a[112:115]
    s_barrier
    v_mfma_f32_16x16x32_bf16 a[96:99], a[192:195], v[228:231], a[96:99]
    s_waitcnt lgkmcnt(4)
    v_permlane32_swap_b32 v22, v58
    v_add_u32 v8, 49152, v12
    v_mfma_f32_16x16x32_bf16 a[128:131], a[200:203], v[228:231], a[128:131]
    s_mul_i32 s57, s56, 24576
    ds_read_b64_tr_b16 a[192:193], v8 offset:0
    v_add_f32 v22, v22, v58
    v_mfma_f32_16x16x32_bf16 a[144:147], a[204:207], v[228:231], a[144:147]
    s_add_u32 s57, s57, s61
    ds_read_b64_tr_b16 a[194:195], v8 offset:6144
    v_mul_f32 v22, 0x3c800000, v22
    v_mfma_f32_16x16x32_bf16 a[148:151], a[204:207], v[236:239], a[148:151]
    s_lshl_b32 s56, s56, 10
    v_rcp_f32 v22, v22
    v_mfma_f32_16x16x32_bf16 a[132:135], a[200:203], v[236:239], a[132:135]
    s_add_u32 m0, s56, 147456
    v_add_f32 v23, v23, v59
    v_mov_b32 v59, v23
    v_add_u32 v9, 49152, v13
    v_mfma_f32_16x16x32_bf16 a[136:139], a[200:203], v[244:247], a[136:139]
    s_and_b32 s72, s3, 1
    ds_read_b64_tr_b16 a[196:197], v9 offset:0
    v_add_u32 v10, 49152, v14
    v_mfma_f32_16x16x32_bf16 a[152:155], a[204:207], v[244:247], a[152:155]
    s_lshl_b32 s72, s72, 14
    ds_read_b64_tr_b16 a[198:199], v9 offset:6144
    v_add_u32 v11, 49152, v15
    v_mfma_f32_16x16x32_bf16 a[156:159], a[204:207], v[252:255], a[156:159]
    buffer_load_dwordx4 v28, s[24:27], s57 offen sc1 lds
    v_mfma_f32_16x16x32_bf16 a[140:143], a[200:203], v[252:255], a[140:143]
    s_waitcnt lgkmcnt(4)
    v_permlane32_swap_b32 v23, v59
    v_mfma_f32_16x16x32_bf16 a[172:175], a[208:211], v[252:255], a[172:175]
    s_add_u32 s56, s3, 8
    ds_read_b64_tr_b16 a[200:201], v10 offset:0
    v_add_f32 v23, v23, v59
    v_mfma_f32_16x16x32_bf16 a[188:191], a[212:215], v[252:255], a[188:191]
    s_min_u32 s56, s56, 9
    ds_read_b64_tr_b16 a[202:203], v10 offset:6144
    v_mul_f32 v23, 0x3c800000, v23
    v_mfma_f32_16x16x32_bf16 a[184:187], a[212:215], v[244:247], a[184:187]
    s_mul_i32 s57, s56, 24576
    v_rcp_f32 v23, v23
    v_mfma_f32_16x16x32_bf16 a[168:171], a[208:211], v[244:247], a[168:171]
    s_add_u32 s57, s57, s61
    v_xor_b32 v18, s39, v8
    v_xor_b32 v19, s39, v9
    v_mfma_f32_16x16x32_bf16 a[164:167], a[208:211], v[236:239], a[164:167]
    s_lshl_b32 s56, s56, 10
    ds_read_b64_tr_b16 a[204:205], v11 offset:0
    v_accvgpr_read_b32 v64, a0
    v_mfma_f32_16x16x32_bf16 a[180:183], a[212:215], v[236:239], a[180:183]
    s_add_u32 m0, s56, 147456
    ds_read_b64_tr_b16 a[206:207], v11 offset:6144
    v_accvgpr_read_b32 v65, a1
    v_accvgpr_read_b32 v24, a18
    v_fma_f32 v24, v24, v20, -v20
    v_accvgpr_read_b32 v25, a19
    v_fma_f32 v25, v25, v20, -v20
    v_accvgpr_read_b32 v66, a2
    v_fma_f32 v66, v66, v20, -v20
    v_accvgpr_read_b32 v67, a3
    v_fma_f32 v67, v67, v20, -v20
    v_fma_f32 v64, v64, v20, -v20
    v_fma_f32 v65, v65, v20, -v20
    v_cvt_pk_bf16_f32 v64, v64, v65
    v_cvt_pk_bf16_f32 v65, v66, v67
    v_accvgpr_read_b32 v66, a16
    v_fma_f32 v66, v66, v20, -v20
    v_accvgpr_read_b32 v67, a17
    v_fma_f32 v67, v67, v20, -v20
    v_cvt_pk_bf16_f32 v66, v66, v67
    v_cvt_pk_bf16_f32 v67, v24, v25
    v_accvgpr_read_b32 v26, a22
    v_fma_f32 v26, v26, v21, -v21
    v_accvgpr_read_b32 v27, a23
    v_fma_f32 v27, v27, v21, -v21
    v_accvgpr_read_b32 v74, a6
    v_fma_f32 v74, v74, v21, -v21
    v_accvgpr_read_b32 v75, a7
    v_fma_f32 v75, v75, v21, -v21
    v_accvgpr_read_b32 v72, a4
    v_fma_f32 v72, v72, v21, -v21
    v_accvgpr_read_b32 v73, a5
    v_fma_f32 v73, v73, v21, -v21
    v_cvt_pk_bf16_f32 v72, v72, v73
    v_cvt_pk_bf16_f32 v73, v74, v75
    v_accvgpr_read_b32 v74, a20
    v_fma_f32 v74, v74, v21, -v21
    v_accvgpr_read_b32 v75, a21
    v_fma_f32 v75, v75, v21, -v21
    v_cvt_pk_bf16_f32 v74, v74, v75
    v_cvt_pk_bf16_f32 v75, v26, v27
    v_accvgpr_read_b32 v30, a26
    v_fma_f32 v30, v30, v22, -v22
    v_accvgpr_read_b32 v31, a27
    v_fma_f32 v31, v31, v22, -v22
    v_accvgpr_read_b32 v82, a10
    v_fma_f32 v82, v82, v22, -v22
    v_accvgpr_read_b32 v83, a11
    v_fma_f32 v83, v83, v22, -v22
    v_accvgpr_read_b32 v80, a8
    v_fma_f32 v80, v80, v22, -v22
    v_accvgpr_read_b32 v81, a9
    v_fma_f32 v81, v81, v22, -v22
    v_cvt_pk_bf16_f32 v80, v80, v81
    v_cvt_pk_bf16_f32 v81, v82, v83
    v_accvgpr_read_b32 v82, a24
    v_fma_f32 v82, v82, v22, -v22
    v_accvgpr_read_b32 v83, a25
    v_fma_f32 v83, v83, v22, -v22
    v_cvt_pk_bf16_f32 v82, v82, v83
    v_cvt_pk_bf16_f32 v83, v30, v31
    v_accvgpr_read_b32 v24, a30
    v_fma_f32 v24, v24, v23, -v23
    v_accvgpr_read_b32 v25, a31
    v_fma_f32 v25, v25, v23, -v23
    v_accvgpr_read_b32 v90, a14
    v_fma_f32 v90, v90, v23, -v23
    v_accvgpr_read_b32 v91, a15
    v_fma_f32 v91, v91, v23, -v23
    v_accvgpr_read_b32 v88, a12
    v_fma_f32 v88, v88, v23, -v23
    v_accvgpr_read_b32 v89, a13
    v_fma_f32 v89, v89, v23, -v23
    v_cvt_pk_bf16_f32 v88, v88, v89
    v_cvt_pk_bf16_f32 v89, v90, v91
    v_accvgpr_read_b32 v90, a28
    v_fma_f32 v90, v90, v23, -v23
    v_accvgpr_read_b32 v91, a29
    v_fma_f32 v91, v91, v23, -v23
    v_cvt_pk_bf16_f32 v90, v90, v91
    v_cvt_pk_bf16_f32 v91, v24, v25
    v_mfma_f32_16x16x32_bf16 a[176:179], a[212:215], v[228:231], a[176:179]
    buffer_load_dwordx4 v28, s[24:27], s57 offen sc1 lds
    v_mfma_f32_16x16x32_bf16 a[160:163], a[208:211], v[228:231], a[160:163]
    s_waitcnt lgkmcnt(4)
    v_accvgpr_read_b32 v96, a32
    v_accvgpr_read_b32 v97, a33
    v_mfma_f32_16x16x32_bf16 a[224:227], a[192:195], v[64:67], 0.5
    s_add_u32 s38, s34, 40960
    ds_read_b64_tr_b16 a[208:209], v8 offset:1024
    v_accvgpr_read_b32 v98, a34
    v_mfma_f32_16x16x32_bf16 a[240:243], a[196:199], v[64:67], 0.5
    s_add_u32 s57, s35, 40960
    ds_read_b64_tr_b16 a[210:211], v8 offset:7168
    v_accvgpr_read_b32 v99, a35
    v_mfma_f32_16x16x32_bf16 a[244:247], a[196:199], v[72:75], 0.5
    buffer_store_dwordx4 v[64:67], v28, s[20:23], s55 offen offset:0 sc1
    v_mfma_f32_16x16x32_bf16 a[228:231], a[192:195], v[72:75], 0.5
    s_cmp_lt_u32 s3, 2
    s_cselect_b32 s38, s38, s57
    v_fma_f32 v96, v96, v20, -v20
    v_mfma_f32_16x16x32_bf16 a[232:235], a[192:195], v[80:83], 0.5
    s_add_u32 s76, s38, s63
    ds_read_b64_tr_b16 a[212:213], v9 offset:1024
    v_fma_f32 v97, v97, v20, -v20
    v_mfma_f32_16x16x32_bf16 a[248:251], a[196:199], v[80:83], 0.5
    s_add_u32 m0, s49, 98304
    ds_read_b64_tr_b16 a[214:215], v9 offset:7168
    v_fma_f32 v98, v98, v20, -v20
    v_mfma_f32_16x16x32_bf16 a[252:255], a[196:199], v[88:91], 0.5
    buffer_store_dwordx4 v[72:75], v28, s[20:23], s55 offen offset:1024 sc1
    v_mfma_f32_16x16x32_bf16 a[236:239], a[192:195], v[88:91], 0.5
    s_waitcnt lgkmcnt(4)
    v_fma_f32 v99, v99, v20, -v20
    v_cvt_pk_bf16_f32 v96, v96, v97
    buffer_store_dwordx4 v[80:83], v28, s[20:23], s55 offen offset:2048 sc1
    buffer_store_dwordx4 v[88:91], v28, s[20:23], s55 offen offset:3072 sc1
    v_accvgpr_read_b32 v26, a50
    v_fma_f32 v26, v26, v20, -v20
    v_accvgpr_read_b32 v27, a51
    v_fma_f32 v27, v27, v20, -v20
    v_cvt_pk_bf16_f32 v97, v98, v99
    v_accvgpr_read_b32 v98, a48
    v_fma_f32 v98, v98, v20, -v20
    v_accvgpr_read_b32 v99, a49
    v_fma_f32 v99, v99, v20, -v20
    v_cvt_pk_bf16_f32 v98, v98, v99
    v_cvt_pk_bf16_f32 v99, v26, v27
    v_mfma_f32_16x16x32_bf16 v[92:95], a[200:203], v[88:91], 0.5
    s_add_u32 s55, s55, 4096
    ds_read_b64_tr_b16 a[192:193], v10 offset:1024
    v_accvgpr_read_b32 v104, a36
    v_mfma_f32_16x16x32_bf16 v[124:127], a[204:207], v[88:91], 0.5
    s_or_b32 s11, s11, s72
    ds_read_b64_tr_b16 a[194:195], v10 offset:7168
    v_accvgpr_read_b32 v105, a37
    v_mfma_f32_16x16x32_bf16 v[116:119], a[204:207], v[80:83], 0.5
    s_lshr_b32 s73, s93, 8
    v_accvgpr_read_b32 v106, a38
    v_accvgpr_read_b32 v107, a39
    v_mfma_f32_16x16x32_bf16 v[84:87], a[200:203], v[80:83], 0.5
    s_add_u32 s8, s51, 1
    v_fma_f32 v104, v104, v21, -v21
    v_fma_f32 v105, v105, v21, -v21
    v_mfma_f32_16x16x32_bf16 v[76:79], a[200:203], v[72:75], 0.5
    s_and_b32 s8, s8, 3
    ds_read_b64_tr_b16 a[196:197], v11 offset:1024
    v_fma_f32 v106, v106, v21, -v21
    v_mfma_f32_16x16x32_bf16 v[108:111], a[204:207], v[72:75], 0.5
    s_lshr_b32 s72, s73, s8
    ds_read_b64_tr_b16 a[198:199], v11 offset:7168
    v_fma_f32 v107, v107, v21, -v21
    v_mfma_f32_16x16x32_bf16 v[100:103], a[204:207], v[64:67], 0.5
    s_and_b32 s72, s72, 0x2000
    v_cvt_pk_bf16_f32 v104, v104, v105
    v_cvt_pk_bf16_f32 v105, v106, v107
    v_mfma_f32_16x16x32_bf16 v[68:71], a[200:203], v[64:67], 0.5
    s_waitcnt lgkmcnt(4)
    v_accvgpr_read_b32 v106, a52
    v_accvgpr_read_b32 v107, a53
    v_mfma_f32_16x16x32_bf16 v[132:135], a[208:211], v[64:67], 0.5
    s_mul_i32 s8, s8, 0x202000
    ds_read_b64_tr_b16 a[200:201], v18 offset:2048
    v_accvgpr_read_b32 v30, a54
    v_mfma_f32_16x16x32_bf16 v[164:167], a[212:215], v[64:67], 0.5
    s_xor_b32 s8, s8, s72
    ds_read_b64_tr_b16 a[202:203], v18 offset:8192
    v_accvgpr_read_b32 v31, a55
    v_fma_f32 v30, v30, v21, -v21
    v_fma_f32 v31, v31, v21, -v21
    v_fma_f32 v106, v106, v21, -v21
    v_fma_f32 v107, v107, v21, -v21
    v_cvt_pk_bf16_f32 v106, v106, v107
    v_cvt_pk_bf16_f32 v107, v30, v31
    v_mfma_f32_16x16x32_bf16 v[172:175], a[212:215], v[72:75], 0.5
    buffer_load_dwordx4 v4, s[12:15], s38 offen offset:0 lds
    v_mfma_f32_16x16x32_bf16 v[140:143], a[208:211], v[72:75], 0.5
    s_add_u32 m0, s49, 99200
    v_accvgpr_read_b32 v112, a40
    v_accvgpr_read_b32 v113, a41
    v_mfma_f32_16x16x32_bf16 v[148:151], a[208:211], v[80:83], 0.5
    s_and_b32 s8, s8, 6299648
    ds_read_b64_tr_b16 a[204:205], v19 offset:2048
    v_accvgpr_read_b32 v114, a42
    v_mfma_f32_16x16x32_bf16 v[180:183], a[212:215], v[80:83], 0.5
    s_xor_b32 s8, s8, s11
    ds_read_b64_tr_b16 a[206:207], v19 offset:8192
    v_accvgpr_read_b32 v115, a43
    v_mfma_f32_16x16x32_bf16 v[188:191], a[212:215], v[88:91], 0.5
    buffer_load_dwordx4 v4, s[12:15], s38 offen offset:128 lds
    v_mfma_f32_16x16x32_bf16 v[156:159], a[208:211], v[88:91], 0.5
    s_waitcnt lgkmcnt(4)
    v_fma_f32 v112, v112, v22, -v22
    v_fma_f32 v113, v113, v22, -v22
    v_mfma_f32_16x16x32_bf16 v[220:223], a[192:195], v[88:91], 0.5
    s_add_u32 m0, s49, 100096
    ds_read_b64_tr_b16 a[208:209], v8 offset:12288
    v_fma_f32 v114, v114, v22, -v22
    v_mfma_f32_16x16x32_bf16 v[252:255], a[196:199], v[88:91], 0.5
    s_add_u32 s9, s51, 2
    ds_read_b64_tr_b16 a[210:211], v8 offset:18432
    v_fma_f32 v115, v115, v22, -v22
    v_mfma_f32_16x16x32_bf16 v[244:247], a[196:199], v[80:83], 0.5
    s_and_b32 s9, s9, 3
    v_cvt_pk_bf16_f32 v112, v112, v113
    v_cvt_pk_bf16_f32 v113, v114, v115
    v_mfma_f32_16x16x32_bf16 v[212:215], a[192:195], v[80:83], 0.5
    buffer_store_dwordx4 v[96:99], v28, s[20:23], s55 offen offset:0 sc1
    v_accvgpr_read_b32 v24, a58
    v_fma_f32 v24, v24, v22, -v22
    v_accvgpr_read_b32 v25, a59
    v_fma_f32 v25, v25, v22, -v22
    v_accvgpr_read_b32 v114, a56
    v_fma_f32 v114, v114, v22, -v22
    v_accvgpr_read_b32 v115, a57
    v_fma_f32 v115, v115, v22, -v22
    v_cvt_pk_bf16_f32 v114, v114, v115
    v_cvt_pk_bf16_f32 v115, v24, v25
    v_mfma_f32_16x16x32_bf16 v[204:207], a[192:195], v[72:75], 0.5
    s_lshr_b32 s72, s73, s9
    ds_read_b64_tr_b16 a[212:213], v9 offset:12288
    v_accvgpr_read_b32 v120, a44
    v_mfma_f32_16x16x32_bf16 v[236:239], a[196:199], v[72:75], 0.5
    s_and_b32 s72, s72, 0x2000
    ds_read_b64_tr_b16 a[214:215], v9 offset:18432
    v_accvgpr_read_b32 v121, a45
    v_mfma_f32_16x16x32_bf16 v[228:231], a[196:199], v[64:67], 0.5
    s_mul_i32 s9, s9, 0x202000
    v_accvgpr_read_b32 v122, a46
    v_accvgpr_read_b32 v123, a47
    v_mfma_f32_16x16x32_bf16 v[196:199], a[192:195], v[64:67], 0.5
    s_waitcnt lgkmcnt(4)
    buffer_load_dwordx4 v4, s[12:15], s76 offen offset:256 lds
    v_mfma_f32_16x16x32_bf16 v[32:35], a[200:203], v[64:67], 0.5
    s_add_u32 m0, s49, 101376
    ds_read_b64_tr_b16 a[192:193], v10 offset:12288
    v_fma_f32 v120, v120, v23, -v23
    v_mfma_f32_16x16x32_bf16 v[48:51], a[204:207], v[64:67], 0.5
    s_xor_b32 s9, s9, s72
    ds_read_b64_tr_b16 a[194:195], v10 offset:18432
    v_fma_f32 v121, v121, v23, -v23
    v_mfma_f32_16x16x32_bf16 v[52:55], a[204:207], v[72:75], 0.5
    s_and_b32 s9, s9, 6299648
    v_fma_f32 v122, v122, v23, -v23
    v_fma_f32 v123, v123, v23, -v23
    v_mfma_f32_16x16x32_bf16 v[36:39], a[200:203], v[72:75], 0.5
    buffer_load_dwordx4 v5, s[12:15], s38 offen offset:0 lds
    v_mfma_f32_16x16x32_bf16 v[40:43], a[200:203], v[80:83], 0.5
    s_add_u32 m0, s49, 102272
    ds_read_b64_tr_b16 a[196:197], v11 offset:12288
    v_cvt_pk_bf16_f32 v120, v120, v121
    v_mfma_f32_16x16x32_bf16 v[56:59], a[204:207], v[80:83], 0.5
    s_xor_b32 s9, s9, s11
    ds_read_b64_tr_b16 a[198:199], v11 offset:18432
    v_cvt_pk_bf16_f32 v121, v122, v123
    v_accvgpr_read_b32 v26, a62
    v_fma_f32 v26, v26, v23, -v23
    v_accvgpr_read_b32 v27, a63
    v_fma_f32 v27, v27, v23, -v23
    v_accvgpr_read_b32 v122, a60
    v_fma_f32 v122, v122, v23, -v23
    v_accvgpr_read_b32 v123, a61
    v_fma_f32 v123, v123, v23, -v23
    v_cvt_pk_bf16_f32 v122, v122, v123
    v_cvt_pk_bf16_f32 v123, v26, v27
    v_mfma_f32_16x16x32_bf16 v[60:63], a[204:207], v[88:91], 0.5
    s_add_u32 s10, s51, 3
    v_accvgpr_read_b32 v128, a64
    v_accvgpr_read_b32 v129, a65
    v_mfma_f32_16x16x32_bf16 v[44:47], a[200:203], v[88:91], 0.5
    s_waitcnt lgkmcnt(4)
    buffer_load_dwordx4 v5, s[12:15], s38 offen offset:128 lds
    v_mfma_f32_16x16x32_bf16 a[236:239], a[208:211], v[120:123], a[236:239]
    s_add_u32 m0, s49, 103168
    ds_read_b64_tr_b16 a[200:201], v8 offset:13312
    v_accvgpr_read_b32 v130, a66
    v_mfma_f32_16x16x32_bf16 a[252:255], a[212:215], v[120:123], a[252:255]
    s_and_b32 s10, s10, 3
    ds_read_b64_tr_b16 a[202:203], v8 offset:19456
    v_accvgpr_read_b32 v131, a67
    v_mfma_f32_16x16x32_bf16 a[248:251], a[212:215], v[112:115], a[248:251]
    s_lshr_b32 s72, s73, s10
    v_fma_f32 v128, v128, v20, -v20
    v_fma_f32 v129, v129, v20, -v20
    v_mfma_f32_16x16x32_bf16 a[232:235], a[208:211], v[112:115], a[232:235]
    s_and_b32 s72, s72, 0x2000
    v_fma_f32 v130, v130, v20, -v20
    v_fma_f32 v131, v131, v20, -v20
    v_mfma_f32_16x16x32_bf16 a[228:231], a[208:211], v[104:107], a[228:231]
    s_mul_i32 s10, s10, 0x202000
    ds_read_b64_tr_b16 a[204:205], v9 offset:13312
    v_cvt_pk_bf16_f32 v128, v128, v129
    v_mfma_f32_16x16x32_bf16 a[244:247], a[212:215], v[104:107], a[244:247]
    s_xor_b32 s10, s10, s72
    ds_read_b64_tr_b16 a[206:207], v9 offset:19456
    v_cvt_pk_bf16_f32 v129, v130, v131
    v_mfma_f32_16x16x32_bf16 a[240:243], a[212:215], v[96:99], a[240:243]
    buffer_store_dwordx4 v[104:107], v28, s[20:23], s55 offen offset:1024 sc1
    v_mfma_f32_16x16x32_bf16 a[224:227], a[208:211], v[96:99], a[224:227]
    s_waitcnt lgkmcnt(4)
    v_accvgpr_read_b32 v130, a80
    v_accvgpr_read_b32 v131, a81
    v_accvgpr_read_b32 v30, a82
    v_fma_f32 v30, v30, v20, -v20
    v_accvgpr_read_b32 v31, a83
    v_fma_f32 v31, v31, v20, -v20
    v_fma_f32 v130, v130, v20, -v20
    v_fma_f32 v131, v131, v20, -v20
    v_cvt_pk_bf16_f32 v130, v130, v131
    v_cvt_pk_bf16_f32 v131, v30, v31
    v_mfma_f32_16x16x32_bf16 v[68:71], a[192:195], v[96:99], v[68:71]
    s_and_b32 s10, s10, 6299648
    ds_read_b64_tr_b16 a[208:209], v10 offset:13312
    v_add_u32 v8, 0, v12
    v_mfma_f32_16x16x32_bf16 v[100:103], a[196:199], v[96:99], v[100:103]
    s_xor_b32 s10, s10, s11
    ds_read_b64_tr_b16 a[210:211], v10 offset:19456
    v_accvgpr_read_b32 v136, a68
    v_mfma_f32_16x16x32_bf16 v[108:111], a[196:199], v[104:107], v[108:111]
    buffer_load_dwordx4 v5, s[12:15], s76 offen offset:256 lds
    v_mfma_f32_16x16x32_bf16 v[76:79], a[192:195], v[104:107], v[76:79]
    s_lshl_b32 s72, 1, s51
    v_mov_b32 v16, s72
    v_accvgpr_read_b32 v17, a223
    v_mfma_f32_16x16x32_bf16 v[84:87], a[192:195], v[112:115], v[84:87]
    s_mov_b32 s72, 0
    ds_read_b64_tr_b16 a[212:213], v11 offset:13312
    v_accvgpr_read_b32 v137, a69
    v_mfma_f32_16x16x32_bf16 v[116:119], a[196:199], v[112:115], v[116:119]
    ds_read_b64_tr_b16 a[214:215], v11 offset:19456
    v_accvgpr_read_b32 v138, a70
    v_mfma_f32_16x16x32_bf16 v[124:127], a[196:199], v[120:123], v[124:127]
    v_accvgpr_read_b32 v139, a71
    v_fma_f32 v136, v136, v21, -v21
    v_mfma_f32_16x16x32_bf16 v[92:95], a[192:195], v[120:123], v[92:95]
    s_waitcnt lgkmcnt(4)
    v_fma_f32 v137, v137, v21, -v21
    v_fma_f32 v138, v138, v21, -v21
    v_mfma_f32_16x16x32_bf16 v[156:159], a[200:203], v[120:123], v[156:159]
pg_8:
    s_cbranch_execz pg_12
    ds_read_b64_tr_b16 a[192:193], v18 offset:14336
    v_fma_f32 v139, v139, v21, -v21
    v_mfma_f32_16x16x32_bf16 v[188:191], a[204:207], v[120:123], v[188:191]
    ds_read_b64_tr_b16 a[194:195], v18 offset:20480
    v_cvt_pk_bf16_f32 v136, v136, v137
    v_accvgpr_read_b32 v24, a86
    v_fma_f32 v24, v24, v21, -v21
    v_accvgpr_read_b32 v25, a87
    v_fma_f32 v25, v25, v21, -v21
    v_cvt_pk_bf16_f32 v137, v138, v139
    v_accvgpr_read_b32 v138, a84
    v_fma_f32 v138, v138, v21, -v21
    v_accvgpr_read_b32 v139, a85
    v_fma_f32 v139, v139, v21, -v21
    v_cvt_pk_bf16_f32 v138, v138, v139
    v_cvt_pk_bf16_f32 v139, v24, v25
    v_mfma_f32_16x16x32_bf16 v[180:183], a[204:207], v[112:115], v[180:183]
    s_add_u32 s38, s33, 81920
    v_add_u32 v9, 0, v13
    v_add_u32 v10, 0, v14
    v_mfma_f32_16x16x32_bf16 v[148:151], a[200:203], v[112:115], v[148:151]
    s_add_u32 s57, s34, 81920
    v_accvgpr_read_b32 v144, a72
    v_accvgpr_read_b32 v145, a73
    v_mfma_f32_16x16x32_bf16 v[140:143], a[200:203], v[104:107], v[140:143]
    s_cmp_lt_u32 s3, 2
    s_cselect_b32 s38, s38, s57
    ds_read_b64_tr_b16 a[196:197], v19 offset:14336
    v_mfma_f32_16x16x32_bf16 v[172:175], a[204:207], v[104:107], v[172:175]
    s_waitcnt vmcnt(35)
    ds_read_b64_tr_b16 a[198:199], v19 offset:20480
    v_accvgpr_read_b32 v146, a74
    v_mfma_f32_16x16x32_bf16 v[164:167], a[204:207], v[96:99], v[164:167]
    s_barrier
    v_mfma_f32_16x16x32_bf16 v[132:135], a[200:203], v[96:99], v[132:135]
    s_waitcnt lgkmcnt(4)
    v_accvgpr_read_b32 v147, a75
    v_fma_f32 v144, v144, v22, -v22
    v_mfma_f32_16x16x32_bf16 v[196:199], a[208:211], v[96:99], v[196:199]
    s_add_u32 s76, s38, s63
    ds_read_b64_tr_b16 a[200:201], v8 offset:0
    v_fma_f32 v145, v145, v22, -v22
    v_mfma_f32_16x16x32_bf16 v[228:231], a[212:215], v[96:99], v[228:231]
    s_add_u32 m0, s49, 49152
    ds_read_b64_tr_b16 a[202:203], v8 offset:6144
    v_fma_f32 v146, v146, v22, -v22
    v_mfma_f32_16x16x32_bf16 v[236:239], a[212:215], v[104:107], v[236:239]
    buffer_store_dwordx4 v[112:115], v28, s[20:23], s55 offen offset:2048 sc1
    v_mfma_f32_16x16x32_bf16 v[204:207], a[208:211], v[104:107], v[204:207]
    s_waitcnt vmcnt(9)
    v_fma_f32 v147, v147, v22, -v22
    v_cvt_pk_bf16_f32 v144, v144, v145
    v_accvgpr_read_b32 v26, a90
    v_fma_f32 v26, v26, v22, -v22
    v_accvgpr_read_b32 v27, a91
    v_fma_f32 v27, v27, v22, -v22
    v_cvt_pk_bf16_f32 v145, v146, v147
    v_accvgpr_read_b32 v146, a88
    v_fma_f32 v146, v146, v22, -v22
    v_accvgpr_read_b32 v147, a89
    v_fma_f32 v147, v147, v22, -v22
    v_cvt_pk_bf16_f32 v146, v146, v147
    v_cvt_pk_bf16_f32 v147, v26, v27
    v_mfma_f32_16x16x32_bf16 v[212:215], a[208:211], v[112:115], v[212:215]
    ds_read_b64_tr_b16 a[204:205], v9 offset:0
    v_add_u32 v11, 0, v15
    v_mfma_f32_16x16x32_bf16 v[244:247], a[212:215], v[112:115], v[244:247]
    ds_read_b64_tr_b16 a[206:207], v9 offset:6144
    v_xor_b32 v18, s39, v8
    v_mfma_f32_16x16x32_bf16 v[252:255], a[212:215], v[120:123], v[252:255]
    buffer_atomic_or v16, v17, s[24:27], 0 offen
    v_mfma_f32_16x16x32_bf16 v[220:223], a[208:211], v[120:123], v[220:223]
    s_waitcnt lgkmcnt(4)
    buffer_load_dwordx4 v4, s[12:15], s38 offen offset:0 lds
    v_mfma_f32_16x16x32_bf16 v[44:47], a[192:195], v[120:123], v[44:47]
    s_add_u32 m0, s49, 50048
    ds_read_b64_tr_b16 a[208:209], v10 offset:0
    v_xor_b32 v19, s39, v9
    v_mfma_f32_16x16x32_bf16 v[60:63], a[196:199], v[120:123], v[60:63]
    ds_read_b64_tr_b16 a[210:211], v10 offset:6144
    v_accvgpr_read_b32 v152, a76
    v_mfma_f32_16x16x32_bf16 v[56:59], a[196:199], v[112:115], v[56:59]
    buffer_load_dwordx4 v4, s[12:15], s38 offen offset:128 lds
    v_mfma_f32_16x16x32_bf16 v[40:43], a[192:195], v[112:115], v[40:43]
    s_add_u32 m0, s49, 50944
    v_accvgpr_read_b32 v153, a77
    v_accvgpr_read_b32 v154, a78
    v_mfma_f32_16x16x32_bf16 v[36:39], a[192:195], v[104:107], v[36:39]
    ds_read_b64_tr_b16 a[212:213], v11 offset:0
    v_accvgpr_read_b32 v155, a79
    v_mfma_f32_16x16x32_bf16 v[52:55], a[196:199], v[104:107], v[52:55]
    ds_read_b64_tr_b16 a[214:215], v11 offset:6144
    v_fma_f32 v152, v152, v23, -v23
    v_accvgpr_read_b32 v30, a94
    v_fma_f32 v30, v30, v23, -v23
    v_accvgpr_read_b32 v31, a95
    v_fma_f32 v31, v31, v23, -v23
    v_fma_f32 v154, v154, v23, -v23
    v_fma_f32 v155, v155, v23, -v23
    v_fma_f32 v153, v153, v23, -v23
    v_cvt_pk_bf16_f32 v152, v152, v153
    v_cvt_pk_bf16_f32 v153, v154, v155
    v_accvgpr_read_b32 v154, a92
    v_fma_f32 v154, v154, v23, -v23
    v_accvgpr_read_b32 v155, a93
    v_fma_f32 v155, v155, v23, -v23
    v_cvt_pk_bf16_f32 v154, v154, v155
    v_cvt_pk_bf16_f32 v155, v30, v31
    v_mfma_f32_16x16x32_bf16 v[48:51], a[196:199], v[96:99], v[48:51]
    buffer_load_dwordx4 v4, s[12:15], s76 offen offset:256 lds
    v_mfma_f32_16x16x32_bf16 v[32:35], a[192:195], v[96:99], v[32:35]
    s_waitcnt lgkmcnt(4)
    v_accvgpr_read_b32 v160, a96
    v_accvgpr_read_b32 v161, a97
    v_mfma_f32_16x16x32_bf16 a[224:227], a[200:203], v[128:131], a[224:227]
    s_add_u32 m0, s49, 52224
    ds_read_b64_tr_b16 a[192:193], v8 offset:1024
    v_accvgpr_read_b32 v162, a98
    v_mfma_f32_16x16x32_bf16 a[240:243], a[204:207], v[128:131], a[240:243]
    ds_read_b64_tr_b16 a[194:195], v8 offset:7168
    v_accvgpr_read_b32 v163, a99
    v_mfma_f32_16x16x32_bf16 a[244:247], a[204:207], v[136:139], a[244:247]
    buffer_load_dwordx4 v5, s[12:15], s38 offen offset:0 lds
    v_mfma_f32_16x16x32_bf16 a[228:231], a[200:203], v[136:139], a[228:231]
    s_add_u32 m0, s49, 53120
    v_fma_f32 v160, v160, v20, -v20
    v_fma_f32 v161, v161, v20, -v20
    v_mfma_f32_16x16x32_bf16 a[232:235], a[200:203], v[144:147], a[232:235]
    ds_read_b64_tr_b16 a[196:197], v9 offset:1024
    v_fma_f32 v162, v162, v20, -v20
    v_mfma_f32_16x16x32_bf16 a[248:251], a[204:207], v[144:147], a[248:251]
    ds_read_b64_tr_b16 a[198:199], v9 offset:7168
    v_fma_f32 v163, v163, v20, -v20
    v_mfma_f32_16x16x32_bf16 a[252:255], a[204:207], v[152:155], a[252:255]
    v_cvt_pk_bf16_f32 v160, v160, v161
    v_cvt_pk_bf16_f32 v161, v162, v163
    v_mfma_f32_16x16x32_bf16 a[236:239], a[200:203], v[152:155], a[236:239]
    s_waitcnt lgkmcnt(4)
    buffer_load_dwordx4 v5, s[12:15], s38 offen offset:128 lds
    v_accvgpr_read_b32 v24, a114
    v_fma_f32 v24, v24, v20, -v20
    v_accvgpr_read_b32 v25, a115
    v_fma_f32 v25, v25, v20, -v20
    v_accvgpr_read_b32 v162, a112
    v_fma_f32 v162, v162, v20, -v20
    v_accvgpr_read_b32 v163, a113
    v_fma_f32 v163, v163, v20, -v20
    v_cvt_pk_bf16_f32 v162, v162, v163
    v_cvt_pk_bf16_f32 v163, v24, v25
    v_mfma_f32_16x16x32_bf16 v[92:95], a[208:211], v[152:155], v[92:95]
    s_add_u32 m0, s49, 54016
    ds_read_b64_tr_b16 a[200:201], v10 offset:1024
    v_accvgpr_read_b32 v168, a100
    v_mfma_f32_16x16x32_bf16 v[124:127], a[212:215], v[152:155], v[124:127]
    ds_read_b64_tr_b16 a[202:203], v10 offset:7168
    v_accvgpr_read_b32 v169, a101
    v_mfma_f32_16x16x32_bf16 v[116:119], a[212:215], v[144:147], v[116:119]
    v_accvgpr_read_b32 v170, a102
    v_accvgpr_read_b32 v171, a103
    v_mfma_f32_16x16x32_bf16 v[84:87], a[208:211], v[144:147], v[84:87]
    buffer_store_dwordx4 v[120:123], v28, s[20:23], s55 offen offset:3072 sc1
    v_mfma_f32_16x16x32_bf16 v[76:79], a[208:211], v[136:139], v[76:79]
    s_add_u32 s55, s55, 12288
    ds_read_b64_tr_b16 a[204:205], v11 offset:1024
    v_fma_f32 v168, v168, v21, -v21
    v_mfma_f32_16x16x32_bf16 v[108:111], a[212:215], v[136:139], v[108:111]
    ds_read_b64_tr_b16 a[206:207], v11 offset:7168
    v_fma_f32 v169, v169, v21, -v21
    v_mfma_f32_16x16x32_bf16 v[100:103], a[212:215], v[128:131], v[100:103]
    v_fma_f32 v170, v170, v21, -v21
    v_fma_f32 v171, v171, v21, -v21
    v_mfma_f32_16x16x32_bf16 v[68:71], a[208:211], v[128:131], v[68:71]
    s_waitcnt lgkmcnt(4)
    buffer_load_dwordx4 v5, s[12:15], s76 offen offset:256 lds
    v_mfma_f32_16x16x32_bf16 v[132:135], a[192:195], v[128:131], v[132:135]
    ds_read_b64_tr_b16 a[208:209], v18 offset:2048
    v_cvt_pk_bf16_f32 v168, v168, v169
    v_mfma_f32_16x16x32_bf16 v[164:167], a[196:199], v[128:131], v[164:167]
    ds_read_b64_tr_b16 a[210:211], v18 offset:8192
    v_cvt_pk_bf16_f32 v169, v170, v171
    v_accvgpr_read_b32 v26, a118
    v_fma_f32 v26, v26, v21, -v21
    v_accvgpr_read_b32 v27, a119
    v_fma_f32 v27, v27, v21, -v21
    v_accvgpr_read_b32 v170, a116
    v_fma_f32 v170, v170, v21, -v21
    v_accvgpr_read_b32 v171, a117
    v_fma_f32 v171, v171, v21, -v21
    v_cvt_pk_bf16_f32 v170, v170, v171
    v_cvt_pk_bf16_f32 v171, v26, v27
    v_mfma_f32_16x16x32_bf16 v[172:175], a[196:199], v[136:139], v[172:175]
    v_accvgpr_read_b32 v176, a104
    v_accvgpr_read_b32 v177, a105
    v_mfma_f32_16x16x32_bf16 v[140:143], a[192:195], v[136:139], v[140:143]
    v_accvgpr_read_b32 v178, a106
    v_accvgpr_read_b32 v179, a107
    v_mfma_f32_16x16x32_bf16 v[148:151], a[192:195], v[144:147], v[148:151]
    ds_read_b64_tr_b16 a[212:213], v19 offset:2048
    v_fma_f32 v176, v176, v22, -v22
    v_mfma_f32_16x16x32_bf16 v[180:183], a[196:199], v[144:147], v[180:183]
    ds_read_b64_tr_b16 a[214:215], v19 offset:8192
    v_fma_f32 v177, v177, v22, -v22
    v_mfma_f32_16x16x32_bf16 v[188:191], a[196:199], v[152:155], v[188:191]
    buffer_store_dwordx4 v[128:131], v28, s[20:23], s55 offen offset:0 sc1
    v_mfma_f32_16x16x32_bf16 v[156:159], a[192:195], v[152:155], v[156:159]
    s_waitcnt lgkmcnt(4)
    v_fma_f32 v178, v178, v22, -v22
    v_fma_f32 v179, v179, v22, -v22
    v_mfma_f32_16x16x32_bf16 v[220:223], a[200:203], v[152:155], v[220:223]
    ds_read_b64_tr_b16 a[192:193], v8 offset:12288
    v_cvt_pk_bf16_f32 v176, v176, v177
    v_mfma_f32_16x16x32_bf16 v[252:255], a[204:207], v[152:155], v[252:255]
    ds_read_b64_tr_b16 a[194:195], v8 offset:18432
    v_cvt_pk_bf16_f32 v177, v178, v179
    v_mfma_f32_16x16x32_bf16 v[244:247], a[204:207], v[144:147], v[244:247]
    v_accvgpr_read_b32 v178, a120
    v_accvgpr_read_b32 v179, a121
    v_mfma_f32_16x16x32_bf16 v[212:215], a[200:203], v[144:147], v[212:215]
    v_accvgpr_read_b32 v30, a122
    v_accvgpr_read_b32 v31, a123
    v_fma_f32 v30, v30, v22, -v22
    v_fma_f32 v31, v31, v22, -v22
    v_fma_f32 v178, v178, v22, -v22
    v_fma_f32 v179, v179, v22, -v22
    v_cvt_pk_bf16_f32 v178, v178, v179
    v_cvt_pk_bf16_f32 v179, v30, v31
    v_mfma_f32_16x16x32_bf16 v[204:207], a[200:203], v[136:139], v[204:207]
    ds_read_b64_tr_b16 a[196:197], v9 offset:12288
    v_accvgpr_read_b32 v184, a108
    v_mfma_f32_16x16x32_bf16 v[236:239], a[204:207], v[136:139], v[236:239]
    ds_read_b64_tr_b16 a[198:199], v9 offset:18432
    v_accvgpr_read_b32 v185, a109
    v_mfma_f32_16x16x32_bf16 v[228:231], a[204:207], v[128:131], v[228:231]
    v_accvgpr_read_b32 v186, a110
    v_accvgpr_read_b32 v187, a111
    v_mfma_f32_16x16x32_bf16 v[196:199], a[200:203], v[128:131], v[196:199]
    s_waitcnt lgkmcnt(4)
    v_fma_f32 v184, v184, v23, -v23
    v_fma_f32 v185, v185, v23, -v23
    v_mfma_f32_16x16x32_bf16 v[32:35], a[208:211], v[128:131], v[32:35]
    ds_read_b64_tr_b16 a[200:201], v10 offset:12288
    v_fma_f32 v186, v186, v23, -v23
    v_mfma_f32_16x16x32_bf16 v[48:51], a[212:215], v[128:131], v[48:51]
    ds_read_b64_tr_b16 a[202:203], v10 offset:18432
    v_fma_f32 v187, v187, v23, -v23
    v_mfma_f32_16x16x32_bf16 v[52:55], a[212:215], v[136:139], v[52:55]
    v_cvt_pk_bf16_f32 v184, v184, v185
    v_cvt_pk_bf16_f32 v185, v186, v187
    v_mfma_f32_16x16x32_bf16 v[36:39], a[208:211], v[136:139], v[36:39]
    buffer_store_dwordx4 v[136:139], v28, s[20:23], s55 offen offset:1024 sc1
    v_mfma_f32_16x16x32_bf16 v[40:43], a[208:211], v[144:147], v[40:43]
    ds_read_b64_tr_b16 a[204:205], v11 offset:12288
    v_accvgpr_read_b32 v186, a124
    v_mfma_f32_16x16x32_bf16 v[56:59], a[212:215], v[144:147], v[56:59]
    ds_read_b64_tr_b16 a[206:207], v11 offset:18432
    v_accvgpr_read_b32 v187, a125
    v_accvgpr_read_b32 v24, a126
    v_fma_f32 v24, v24, v23, -v23
    v_accvgpr_read_b32 v25, a127
    v_fma_f32 v25, v25, v23, -v23
    v_fma_f32 v186, v186, v23, -v23
    v_fma_f32 v187, v187, v23, -v23
    v_cvt_pk_bf16_f32 v186, v186, v187
    v_cvt_pk_bf16_f32 v187, v24, v25
    v_mfma_f32_16x16x32_bf16 v[60:63], a[212:215], v[152:155], v[60:63]
    v_accvgpr_read_b32 v192, a128
    v_accvgpr_read_b32 v193, a129
    v_mfma_f32_16x16x32_bf16 v[44:47], a[208:211], v[152:155], v[44:47]
    s_waitcnt lgkmcnt(4)
    v_accvgpr_read_b32 v194, a130
    v_accvgpr_read_b32 v195, a131
    v_mfma_f32_16x16x32_bf16 a[236:239], a[192:195], v[184:187], a[236:239]
    ds_read_b64_tr_b16 a[208:209], v8 offset:13312
    v_fma_f32 v192, v192, v20, -v20
    v_mfma_f32_16x16x32_bf16 a[252:255], a[196:199], v[184:187], a[252:255]
    ds_read_b64_tr_b16 a[210:211], v8 offset:19456
    v_fma_f32 v193, v193, v20, -v20
    v_mfma_f32_16x16x32_bf16 a[248:251], a[196:199], v[176:179], a[248:251]
    v_fma_f32 v194, v194, v20, -v20
    v_fma_f32 v195, v195, v20, -v20
    v_mfma_f32_16x16x32_bf16 a[232:235], a[192:195], v[176:179], a[232:235]
    v_cvt_pk_bf16_f32 v192, v192, v193
    v_cvt_pk_bf16_f32 v193, v194, v195
    v_mfma_f32_16x16x32_bf16 a[228:231], a[192:195], v[168:171], a[228:231]
    ds_read_b64_tr_b16 a[212:213], v9 offset:13312
    v_accvgpr_read_b32 v194, a144
    v_mfma_f32_16x16x32_bf16 a[244:247], a[196:199], v[168:171], a[244:247]
    ds_read_b64_tr_b16 a[214:215], v9 offset:19456
    v_accvgpr_read_b32 v195, a145
    v_mfma_f32_16x16x32_bf16 a[240:243], a[196:199], v[160:163], a[240:243]
    v_accvgpr_read_b32 v26, a146
    v_accvgpr_read_b32 v27, a147
    v_mfma_f32_16x16x32_bf16 a[224:227], a[192:195], v[160:163], a[224:227]
    s_waitcnt lgkmcnt(4)
    v_fma_f32 v194, v194, v20, -v20
    v_fma_f32 v195, v195, v20, -v20
    v_fma_f32 v26, v26, v20, -v20
    v_fma_f32 v27, v27, v20, -v20
    v_cvt_pk_bf16_f32 v194, v194, v195
    v_cvt_pk_bf16_f32 v195, v26, v27
    v_mfma_f32_16x16x32_bf16 v[68:71], a[200:203], v[160:163], v[68:71]
    ds_read_b64_tr_b16 a[192:193], v10 offset:13312
    v_add_u32 v8, 122880, v12
    v_mfma_f32_16x16x32_bf16 v[100:103], a[204:207], v[160:163], v[100:103]
    ds_read_b64_tr_b16 a[194:195], v10 offset:19456
    v_accvgpr_read_b32 v200, a132
    v_mfma_f32_16x16x32_bf16 v[108:111], a[204:207], v[168:171], v[108:111]
    buffer_store_dwordx4 v[144:147], v28, s[20:23], s55 offen offset:2048 sc1
    v_mfma_f32_16x16x32_bf16 v[76:79], a[200:203], v[168:171], v[76:79]
    v_accvgpr_read_b32 v201, a133
    v_accvgpr_read_b32 v202, a134
    v_mfma_f32_16x16x32_bf16 v[84:87], a[200:203], v[176:179], v[84:87]
    ds_read_b64_tr_b16 a[196:197], v11 offset:13312
    v_accvgpr_read_b32 v203, a135
    v_mfma_f32_16x16x32_bf16 v[116:119], a[204:207], v[176:179], v[116:119]
    ds_read_b64_tr_b16 a[198:199], v11 offset:19456
    v_fma_f32 v200, v200, v21, -v21
    v_mfma_f32_16x16x32_bf16 v[124:127], a[204:207], v[184:187], v[124:127]
    v_fma_f32 v201, v201, v21, -v21
    v_fma_f32 v202, v202, v21, -v21
    v_mfma_f32_16x16x32_bf16 v[92:95], a[200:203], v[184:187], v[92:95]
    s_waitcnt lgkmcnt(4)
    v_fma_f32 v203, v203, v21, -v21
    v_cvt_pk_bf16_f32 v200, v200, v201
    v_mfma_f32_16x16x32_bf16 v[156:159], a[208:211], v[184:187], v[156:159]
    ds_read_b64_tr_b16 a[200:201], v18 offset:14336
    v_cvt_pk_bf16_f32 v201, v202, v203
    v_mfma_f32_16x16x32_bf16 v[188:191], a[212:215], v[184:187], v[188:191]
    ds_read_b64_tr_b16 a[202:203], v18 offset:20480
    v_accvgpr_read_b32 v202, a148
    v_accvgpr_read_b32 v30, a150
    v_fma_f32 v30, v30, v21, -v21
    v_accvgpr_read_b32 v31, a151
    v_fma_f32 v31, v31, v21, -v21
    v_fma_f32 v202, v202, v21, -v21
    v_accvgpr_read_b32 v203, a149
    v_fma_f32 v203, v203, v21, -v21
    v_cvt_pk_bf16_f32 v202, v202, v203
    v_cvt_pk_bf16_f32 v203, v30, v31
    v_mfma_f32_16x16x32_bf16 v[180:183], a[212:215], v[176:179], v[180:183]
    s_add_u32 s38, s35, 81920
    v_add_u32 v9, 122880, v13
    v_add_u32 v10, 122880, v14
    v_mfma_f32_16x16x32_bf16 v[148:151], a[208:211], v[176:179], v[148:151]
    s_add_u32 s57, s33, 122880
    v_accvgpr_read_b32 v208, a136
    v_accvgpr_read_b32 v209, a137
    v_mfma_f32_16x16x32_bf16 v[140:143], a[208:211], v[168:171], v[140:143]
    s_cmp_lt_u32 s3, 2
    s_cselect_b32 s38, s38, s57
    ds_read_b64_tr_b16 a[204:205], v19 offset:14336
    v_mfma_f32_16x16x32_bf16 v[172:175], a[212:215], v[168:171], v[172:175]
    s_waitcnt vmcnt(24)
    ds_read_b64_tr_b16 a[206:207], v19 offset:20480
    v_lshlrev_b32 v16, 4, v16
    v_mfma_f32_16x16x32_bf16 v[164:167], a[212:215], v[160:163], v[164:167]
    s_barrier
    v_mfma_f32_16x16x32_bf16 v[132:135], a[208:211], v[160:163], v[132:135]
    s_waitcnt lgkmcnt(4)
    v_accvgpr_read_b32 v210, a138
    v_accvgpr_read_b32 v211, a139
    v_mfma_f32_16x16x32_bf16 v[196:199], a[192:195], v[160:163], v[196:199]
    s_add_u32 s76, s38, s63
    ds_read_b64_tr_b16 a[208:209], v8 offset:0
    v_fma_f32 v208, v208, v22, -v22
    v_mfma_f32_16x16x32_bf16 v[228:231], a[196:199], v[160:163], v[228:231]
    s_add_u32 m0, s49, 0
    ds_read_b64_tr_b16 a[210:211], v8 offset:6144
    v_fma_f32 v209, v209, v22, -v22
    v_mfma_f32_16x16x32_bf16 v[236:239], a[196:199], v[168:171], v[236:239]
    buffer_store_dwordx4 v[152:155], v28, s[20:23], s55 offen offset:3072 sc1
    v_mfma_f32_16x16x32_bf16 v[204:207], a[192:195], v[168:171], v[204:207]
    s_add_u32 s55, s55, 4096
    v_fma_f32 v210, v210, v22, -v22
    v_fma_f32 v211, v211, v22, -v22
    v_accvgpr_read_b32 v24, a154
    v_fma_f32 v24, v24, v22, -v22
    v_accvgpr_read_b32 v25, a155
    v_fma_f32 v25, v25, v22, -v22
    v_cvt_pk_bf16_f32 v208, v208, v209
    v_cvt_pk_bf16_f32 v209, v210, v211
    v_accvgpr_read_b32 v210, a152
    v_fma_f32 v210, v210, v22, -v22
    v_accvgpr_read_b32 v211, a153
    v_fma_f32 v211, v211, v22, -v22
    v_cvt_pk_bf16_f32 v210, v210, v211
    v_cvt_pk_bf16_f32 v211, v24, v25
    v_mfma_f32_16x16x32_bf16 v[212:215], a[192:195], v[176:179], v[212:215]
    s_load_dword s72, s[86:87], s5 offset:4 glc
    ds_read_b64_tr_b16 a[212:213], v9 offset:0
    v_add_u32 v11, 122880, v15
    v_mfma_f32_16x16x32_bf16 v[244:247], a[196:199], v[176:179], v[244:247]
    s_waitcnt vmcnt(5)
    ds_read_b64_tr_b16 a[214:215], v9 offset:6144
    v_xor_b32 v18, s39, v8
    v_mfma_f32_16x16x32_bf16 v[252:255], a[196:199], v[184:187], v[252:255]
    buffer_atomic_or v16, v17, s[24:27], 0 offen
    v_mfma_f32_16x16x32_bf16 v[220:223], a[192:195], v[184:187], v[220:223]
    s_waitcnt lgkmcnt(4)
    buffer_load_dwordx4 v4, s[12:15], s38 offen offset:0 lds
    v_mfma_f32_16x16x32_bf16 v[44:47], a[200:203], v[184:187], v[44:47]
    s_add_u32 m0, s49, 896
    ds_read_b64_tr_b16 a[192:193], v10 offset:0
    v_xor_b32 v19, s39, v9
    v_mfma_f32_16x16x32_bf16 v[60:63], a[204:207], v[184:187], v[60:63]
    ds_read_b64_tr_b16 a[194:195], v10 offset:6144
    v_accvgpr_read_b32 v216, a140
    v_mfma_f32_16x16x32_bf16 v[56:59], a[204:207], v[176:179], v[56:59]
    buffer_load_dwordx4 v4, s[12:15], s38 offen offset:128 lds
    v_mfma_f32_16x16x32_bf16 v[40:43], a[200:203], v[176:179], v[40:43]
    s_add_u32 m0, s49, 1792
    v_accvgpr_read_b32 v217, a141
    v_accvgpr_read_b32 v218, a142
    v_mfma_f32_16x16x32_bf16 v[36:39], a[200:203], v[168:171], v[36:39]
    s_mov_b32 s28, s82
    ds_read_b64_tr_b16 a[196:197], v11 offset:0
    v_accvgpr_read_b32 v219, a143
    v_mfma_f32_16x16x32_bf16 v[52:55], a[204:207], v[168:171], v[52:55]
    s_and_b32 s29, s83, 0xffff
    ds_read_b64_tr_b16 a[198:199], v11 offset:6144
    v_fma_f32 v216, v216, v23, -v23
    v_accvgpr_read_b32 v26, a158
    v_fma_f32 v26, v26, v23, -v23
    v_accvgpr_read_b32 v27, a159
    v_fma_f32 v27, v27, v23, -v23
    v_fma_f32 v218, v218, v23, -v23
    v_fma_f32 v219, v219, v23, -v23
    v_fma_f32 v217, v217, v23, -v23
    v_cvt_pk_bf16_f32 v216, v216, v217
    v_cvt_pk_bf16_f32 v217, v218, v219
    v_accvgpr_read_b32 v218, a156
    v_fma_f32 v218, v218, v23, -v23
    v_accvgpr_read_b32 v219, a157
    v_fma_f32 v219, v219, v23, -v23
    v_cvt_pk_bf16_f32 v218, v218, v219
    v_cvt_pk_bf16_f32 v219, v26, v27
    v_mfma_f32_16x16x32_bf16 v[48:51], a[204:207], v[160:163], v[48:51]
    buffer_store_dwordx4 v[160:163], v28, s[20:23], s55 offen offset:0 sc1
    v_mfma_f32_16x16x32_bf16 v[32:35], a[200:203], v[160:163], v[32:35]
    s_waitcnt lgkmcnt(4)
    v_accvgpr_read_b32 v224, a160
    v_accvgpr_read_b32 v225, a161
    v_mfma_f32_16x16x32_bf16 a[224:227], a[208:211], v[192:195], a[224:227]
    s_mov_b32 s30, 1966080
    ds_read_b64_tr_b16 a[200:201], v8 offset:1024
    v_accvgpr_read_b32 v226, a162
    v_mfma_f32_16x16x32_bf16 a[240:243], a[212:215], v[192:195], a[240:243]
    s_mov_b32 s31, 0x00020000
    ds_read_b64_tr_b16 a[202:203], v8 offset:7168
    v_accvgpr_read_b32 v227, a163
    v_mfma_f32_16x16x32_bf16 a[244:247], a[212:215], v[200:203], a[244:247]
    buffer_load_dwordx4 v4, s[12:15], s76 offen offset:256 lds
    v_mfma_f32_16x16x32_bf16 a[228:231], a[208:211], v[200:203], a[228:231]
    s_add_u32 m0, s49, 3072
    v_fma_f32 v224, v224, v20, -v20
    v_fma_f32 v225, v225, v20, -v20
    v_mfma_f32_16x16x32_bf16 a[232:235], a[208:211], v[208:211], a[232:235]
    s_mul_i32 s44, s47, 10
    ds_read_b64_tr_b16 a[204:205], v9 offset:1024
    v_fma_f32 v226, v226, v20, -v20
    v_mfma_f32_16x16x32_bf16 a[248:251], a[212:215], v[208:211], a[248:251]
    s_sub_u32 s44, s58, s44
    ds_read_b64_tr_b16 a[206:207], v9 offset:7168
    v_fma_f32 v227, v227, v20, -v20
    v_mfma_f32_16x16x32_bf16 a[252:255], a[212:215], v[216:219], a[252:255]
    s_lshl_b32 s62, s44, 2
    v_cvt_pk_bf16_f32 v224, v224, v225
    v_cvt_pk_bf16_f32 v225, v226, v227
    v_mfma_f32_16x16x32_bf16 a[236:239], a[208:211], v[216:219], a[236:239]
    s_waitcnt lgkmcnt(4)
    buffer_load_dwordx4 v5, s[12:15], s38 offen offset:0 lds
    v_accvgpr_read_b32 v30, a178
    v_fma_f32 v30, v30, v20, -v20
    v_accvgpr_read_b32 v31, a179
    v_fma_f32 v31, v31, v20, -v20
    v_accvgpr_read_b32 v226, a176
    v_fma_f32 v226, v226, v20, -v20
    v_accvgpr_read_b32 v227, a177
    v_fma_f32 v227, v227, v20, -v20
    v_cvt_pk_bf16_f32 v226, v226, v227
    v_cvt_pk_bf16_f32 v227, v30, v31
    v_mfma_f32_16x16x32_bf16 v[92:95], a[192:195], v[216:219], v[92:95]
    s_add_u32 m0, s49, 3968
    ds_read_b64_tr_b16 a[208:209], v10 offset:1024
    v_accvgpr_read_b32 v232, a164
    v_mfma_f32_16x16x32_bf16 v[124:127], a[196:199], v[216:219], v[124:127]
    s_add_u32 s62, s62, s3
    ds_read_b64_tr_b16 a[210:211], v10 offset:7168
    v_accvgpr_read_b32 v233, a165
    v_mfma_f32_16x16x32_bf16 v[116:119], a[196:199], v[208:211], v[116:119]
    s_lshl_b32 s62, s62, 9
    v_accvgpr_read_b32 v234, a166
    v_accvgpr_read_b32 v235, a167
    v_mfma_f32_16x16x32_bf16 v[84:87], a[192:195], v[208:211], v[84:87]
    buffer_load_dwordx4 v5, s[12:15], s38 offen offset:128 lds
    v_mfma_f32_16x16x32_bf16 v[76:79], a[192:195], v[200:203], v[76:79]
    s_add_u32 m0, s49, 4864
    ds_read_b64_tr_b16 a[212:213], v11 offset:1024
    v_fma_f32 v232, v232, v21, -v21
    v_mfma_f32_16x16x32_bf16 v[108:111], a[196:199], v[200:203], v[108:111]
    s_add_u32 s62, s62, 3670016
    ds_read_b64_tr_b16 a[214:215], v11 offset:7168
    v_fma_f32 v233, v233, v21, -v21
    v_mfma_f32_16x16x32_bf16 v[100:103], a[196:199], v[192:195], v[100:103]
    s_cmp_lt_u32 s2, 240
    s_cselect_b32 s62, s62, 0x70000000
    v_fma_f32 v234, v234, v21, -v21
    v_mfma_f32_16x16x32_bf16 v[68:71], a[192:195], v[192:195], v[68:71]
    s_waitcnt lgkmcnt(4)
    buffer_store_dwordx4 v[168:171], v28, s[20:23], s55 offen offset:1024 sc1
    v_mfma_f32_16x16x32_bf16 v[132:135], a[200:203], v[192:195], v[132:135]
    s_lshl_b32 s59, s47, 6
    ds_read_b64_tr_b16 a[192:193], v18 offset:2048
    v_fma_f32 v235, v235, v21, -v21
    v_mfma_f32_16x16x32_bf16 v[164:167], a[204:207], v[192:195], v[164:167]
    s_lshr_b32 s56, s3, 1
    ds_read_b64_tr_b16 a[194:195], v18 offset:8192
    v_cvt_pk_bf16_f32 v232, v232, v233
    v_accvgpr_read_b32 v24, a182
    v_fma_f32 v24, v24, v21, -v21
    v_accvgpr_read_b32 v25, a183
    v_fma_f32 v25, v25, v21, -v21
    v_cvt_pk_bf16_f32 v233, v234, v235
    v_accvgpr_read_b32 v234, a180
    v_fma_f32 v234, v234, v21, -v21
    v_accvgpr_read_b32 v235, a181
    v_fma_f32 v235, v235, v21, -v21
    v_cvt_pk_bf16_f32 v234, v234, v235
    v_cvt_pk_bf16_f32 v235, v24, v25
    v_mfma_f32_16x16x32_bf16 v[172:175], a[204:207], v[200:203], v[172:175]
pg_9:
    s_cbranch_execz pg_13
    s_lshl_b32 s56, s56, 5
    v_accvgpr_read_b32 v240, a168
    v_accvgpr_read_b32 v241, a169
    v_mfma_f32_16x16x32_bf16 v[140:143], a[200:203], v[200:203], v[140:143]
    s_add_u32 s59, s59, s56
    v_accvgpr_read_b32 v242, a170
    v_accvgpr_read_b32 v243, a171
    v_mfma_f32_16x16x32_bf16 v[148:151], a[200:203], v[208:211], v[148:151]
    s_and_b32 s56, s3, 1
    ds_read_b64_tr_b16 a[196:197], v19 offset:2048
    v_fma_f32 v240, v240, v22, -v22
    v_mfma_f32_16x16x32_bf16 v[180:183], a[204:207], v[208:211], v[180:183]
    s_lshl_b32 s56, s56, 2
    ds_read_b64_tr_b16 a[198:199], v19 offset:8192
    v_fma_f32 v241, v241, v22, -v22
    v_mfma_f32_16x16x32_bf16 v[188:191], a[204:207], v[216:219], v[188:191]
    s_bfe_u32 s88, s72, 262144
    s_cmp_lg_u32 s88, 15
    s_cbranch_scc1 spin_o0
spin_o0_ret:
    v_fma_f32 v242, v242, v22, -v22
    v_mfma_f32_16x16x32_bf16 v[156:159], a[200:203], v[216:219], v[156:159]
    s_waitcnt lgkmcnt(4)
    buffer_load_dwordx4 v5, s[12:15], s76 offen offset:256 lds
    v_mfma_f32_16x16x32_bf16 v[220:223], a[208:211], v[216:219], v[220:223]
    s_add_u32 s59, s59, s56
    ds_read_b64_tr_b16 a[200:201], v8 offset:12288
    v_fma_f32 v243, v243, v22, -v22
    v_mfma_f32_16x16x32_bf16 v[252:255], a[212:215], v[216:219], v[252:255]
    s_mul_i32 s59, s59, 1280
    ds_read_b64_tr_b16 a[202:203], v8 offset:18432
    v_cvt_pk_bf16_f32 v240, v240, v241
    v_mfma_f32_16x16x32_bf16 v[244:247], a[212:215], v[208:211], v[244:247]
    buffer_load_dwordx4 a[0:3], v28, s[20:23], s8 offen offset:0 sc1
    v_mfma_f32_16x16x32_bf16 v[212:215], a[208:211], v[208:211], v[212:215]
    s_lshl_b32 s44, s44, 7
    v_cvt_pk_bf16_f32 v241, v242, v243
    v_accvgpr_read_b32 v242, a184
    v_accvgpr_read_b32 v26, a186
    v_fma_f32 v26, v26, v22, -v22
    v_accvgpr_read_b32 v27, a187
    v_fma_f32 v27, v27, v22, -v22
    v_fma_f32 v242, v242, v22, -v22
    v_accvgpr_read_b32 v243, a185
    v_fma_f32 v243, v243, v22, -v22
    v_cvt_pk_bf16_f32 v242, v242, v243
    v_cvt_pk_bf16_f32 v243, v26, v27
    v_mfma_f32_16x16x32_bf16 v[204:207], a[208:211], v[200:203], v[204:207]
    s_add_u32 s59, s59, s44
    ds_read_b64_tr_b16 a[204:205], v9 offset:12288
    v_accvgpr_read_b32 v248, a172
    v_mfma_f32_16x16x32_bf16 v[236:239], a[212:215], v[200:203], v[236:239]
    s_lshl_b32 s44, s3, 11
    ds_read_b64_tr_b16 a[206:207], v9 offset:18432
    v_lshrrev_b32 v29, 5, v1
    v_mfma_f32_16x16x32_bf16 v[228:231], a[212:215], v[192:195], v[228:231]
    buffer_load_dwordx4 a[4:7], v28, s[20:23], s8 offen offset:1024 sc1
    v_mfma_f32_16x16x32_bf16 v[196:199], a[208:211], v[192:195], v[196:199]
    s_waitcnt lgkmcnt(4)
    v_lshlrev_b32 v29, 3, v29
    v_bfe_u32 v6, v1, 3, 2
    v_mfma_f32_16x16x32_bf16 v[32:35], a[192:195], v[192:195], v[32:35]
    ds_read_b64_tr_b16 a[208:209], v10 offset:12288
    v_add_u32 v6, v6, v29
    v_mfma_f32_16x16x32_bf16 v[48:51], a[196:199], v[192:195], v[48:51]
    ds_read_b64_tr_b16 a[210:211], v10 offset:18432
    v_mul_u32_u24 v6, 1280, v6
    v_mfma_f32_16x16x32_bf16 v[52:55], a[196:199], v[200:203], v[52:55]
    buffer_load_dwordx4 a[8:11], v28, s[20:23], s8 offen offset:2048 sc1
    v_mfma_f32_16x16x32_bf16 v[36:39], a[192:195], v[200:203], v[36:39]
    v_lshrrev_b32 v29, 4, v1
    v_lshlrev_b32 v29, 1, v29
    v_mfma_f32_16x16x32_bf16 v[40:43], a[192:195], v[208:211], v[40:43]
    ds_read_b64_tr_b16 a[212:213], v11 offset:12288
    v_and_b32 v7, 7, v1
    v_mfma_f32_16x16x32_bf16 v[56:59], a[196:199], v[208:211], v[56:59]
    ds_read_b64_tr_b16 a[214:215], v11 offset:18432
    v_xor_b32 v7, v7, v29
    buffer_store_dwordx4 v[176:179], v28, s[20:23], s55 offen offset:2048 sc1
    v_accvgpr_read_b32 v30, a190
    v_fma_f32 v30, v30, v23, -v23
    v_accvgpr_read_b32 v31, a191
    v_fma_f32 v31, v31, v23, -v23
    v_accvgpr_read_b32 v250, a174
    v_fma_f32 v250, v250, v23, -v23
    v_accvgpr_read_b32 v251, a175
    v_fma_f32 v251, v251, v23, -v23
    v_fma_f32 v248, v248, v23, -v23
    v_accvgpr_read_b32 v249, a173
    v_fma_f32 v249, v249, v23, -v23
    v_cvt_pk_bf16_f32 v248, v248, v249
    v_cvt_pk_bf16_f32 v249, v250, v251
    v_accvgpr_read_b32 v250, a188
    v_fma_f32 v250, v250, v23, -v23
    v_accvgpr_read_b32 v251, a189
    v_fma_f32 v251, v251, v23, -v23
    v_cvt_pk_bf16_f32 v250, v250, v251
    v_cvt_pk_bf16_f32 v251, v30, v31
    v_mfma_f32_16x16x32_bf16 v[60:63], a[196:199], v[216:219], v[60:63]
    v_lshlrev_b32 v16, 4, v16
    v_lshlrev_b32 v7, 4, v7
    v_mfma_f32_16x16x32_bf16 v[44:47], a[192:195], v[216:219], v[44:47]
    s_waitcnt lgkmcnt(4)
    v_add_u32 v6, v6, v7
    v_add_u32 v7, 20480, v6
    v_mfma_f32_16x16x32_bf16 a[236:239], a[200:203], v[248:251], a[236:239]
    s_waitcnt vmcnt(13)
    ds_read_b64_tr_b16 a[192:193], v8 offset:13312
    v_add_u32 v29, 147456, v28
    v_mfma_f32_16x16x32_bf16 a[252:255], a[204:207], v[248:251], a[252:255]
    ds_read_b64_tr_b16 a[194:195], v8 offset:19456
    v_mfma_f32_16x16x32_bf16 a[248:251], a[204:207], v[240:243], a[248:251]
    buffer_atomic_or v16, v17, s[24:27], 0 offen
    v_mfma_f32_16x16x32_bf16 a[232:235], a[200:203], v[240:243], a[232:235]
    buffer_load_dwordx4 a[12:15], v28, s[20:23], s8 offen offset:3072 sc1
    v_mfma_f32_16x16x32_bf16 a[228:231], a[200:203], v[232:235], a[228:231]
    s_add_u32 s8, s8, 4096
    ds_read_b64_tr_b16 a[196:197], v9 offset:13312
    v_add_u32 v8, 24576, v12
    v_mfma_f32_16x16x32_bf16 a[244:247], a[204:207], v[232:235], a[244:247]
    ds_read_b64_tr_b16 a[198:199], v9 offset:19456
    v_mfma_f32_16x16x32_bf16 a[240:243], a[204:207], v[224:227], a[240:243]
    v_add_u32 v9, 24576, v13
    v_mfma_f32_16x16x32_bf16 a[224:227], a[200:203], v[224:227], a[224:227]
    s_waitcnt lgkmcnt(4)
    buffer_store_dwordx4 v[184:187], v28, s[20:23], s55 offen offset:3072 sc1
    v_mfma_f32_16x16x32_bf16 v[68:71], a[208:211], v[224:227], v[68:71]
    s_add_u32 s55, s55, 12288
    ds_read_b64_tr_b16 a[200:201], v10 offset:13312
    s_mov_b32 s16, s64
    v_mfma_f32_16x16x32_bf16 v[100:103], a[212:215], v[224:227], v[100:103]
    s_and_b32 s17, s65, 0xffff
    ds_read_b64_tr_b16 a[202:203], v10 offset:19456
    s_mov_b32 s18, 2621440
    v_mfma_f32_16x16x32_bf16 v[108:111], a[212:215], v[232:235], v[108:111]
    s_mov_b32 s19, 0x00020000
    v_add_u32 v10, 24576, v14
    s_lshl_b32 s45, s52, 4
    v_mfma_f32_16x16x32_bf16 v[76:79], a[208:211], v[232:235], v[76:79]
    s_lshl_b32 s56, s53, 1
    s_add_u32 s45, s45, s56
    s_and_b32 s56, s3, 1
    v_mfma_f32_16x16x32_bf16 v[84:87], a[208:211], v[240:243], v[84:87]
    s_add_u32 s45, s45, s56
    ds_read_b64_tr_b16 a[204:205], v11 offset:13312
    s_lshl_b32 s56, s45, 4
    v_mfma_f32_16x16x32_bf16 v[116:119], a[212:215], v[240:243], v[116:119]
    ds_read_b64_tr_b16 a[206:207], v11 offset:19456
    v_and_b32 v20, 15, v1
    v_mfma_f32_16x16x32_bf16 v[124:127], a[212:215], v[248:251], v[124:127]
    buffer_load_dwordx4 a[16:19], v28, s[20:23], s9 offen offset:0 sc1
    v_mfma_f32_16x16x32_bf16 v[92:95], a[208:211], v[248:251], v[92:95]
    s_waitcnt lgkmcnt(4)
    v_add_u32 v20, s56, v20
    v_bfe_u32 v21, v1, 4, 1
    v_mfma_f32_16x16x32_bf16 v[156:159], a[192:195], v[248:251], v[156:159]
    ds_read_b64_tr_b16 a[208:209], v18 offset:14336
    v_bfe_u32 v22, v1, 5, 1
    v_mfma_f32_16x16x32_bf16 v[188:191], a[196:199], v[248:251], v[188:191]
    ds_read_b64_tr_b16 a[210:211], v18 offset:20480
    v_lshl_add_u32 v21, v21, 1, v22
    v_mfma_f32_16x16x32_bf16 v[180:183], a[196:199], v[240:243], v[180:183]
    buffer_store_dwordx4 v[192:195], v28, s[20:23], s55 offen offset:0 sc1
    v_mfma_f32_16x16x32_bf16 v[148:151], a[192:195], v[240:243], v[148:151]
    v_mul_u32_u24 v22, 1280, v20
    v_lshl_add_u32 v22, v21, 4, v22
    v_mfma_f32_16x16x32_bf16 v[140:143], a[192:195], v[232:235], v[140:143]
    ds_read_b64_tr_b16 a[212:213], v19 offset:14336
    v_lshlrev_b32 v23, 3, v20
    v_mfma_f32_16x16x32_bf16 v[172:175], a[196:199], v[232:235], v[172:175]
    s_waitcnt vmcnt(52)
    ds_read_b64_tr_b16 a[214:215], v19 offset:20480
    v_add_u32 v11, 24576, v15
    v_mfma_f32_16x16x32_bf16 v[164:167], a[196:199], v[224:227], v[164:167]
    s_barrier
    v_mfma_f32_16x16x32_bf16 v[132:135], a[192:195], v[224:227], v[132:135]
    s_waitcnt lgkmcnt(4)
    buffer_load_dwordx4 a[20:23], v28, s[20:23], s9 offen offset:1024 sc1
    v_mfma_f32_16x16x32_bf16 v[196:199], a[200:203], v[224:227], v[196:199]
    s_mul_i32 s56, s51, 5
    ds_read_b64_tr_b16 a[192:193], v8 offset:0
    v_xor_b32 v18, s39, v8
    v_mfma_f32_16x16x32_bf16 v[228:231], a[204:207], v[224:227], v[228:231]
    s_lshr_b32 s6, s3, 1
    ds_read_b64_tr_b16 a[194:195], v8 offset:6144
    v_xor_b32 v19, s39, v9
    v_mfma_f32_16x16x32_bf16 v[236:239], a[204:207], v[232:235], v[236:239]
    buffer_load_dwordx4 a[24:27], v28, s[20:23], s9 offen offset:2048 sc1
    v_mfma_f32_16x16x32_bf16 v[204:207], a[200:203], v[232:235], v[204:207]
    s_add_u32 s41, s56, s6
    s_add_u32 s42, s56, 2
    s_add_u32 s43, s56, 4
    v_mfma_f32_16x16x32_bf16 v[212:215], a[200:203], v[240:243], v[212:215]
    s_sub_u32 s43, s43, s6
    ds_read_b64_tr_b16 a[196:197], v9 offset:0
    s_lshr_b32 s48, s45, 2
    v_mfma_f32_16x16x32_bf16 v[244:247], a[204:207], v[240:243], v[244:247]
    s_lshr_b32 s56, s48, 1
    ds_read_b64_tr_b16 a[198:199], v9 offset:6144
    s_lshl_b32 s56, s56, 19
    v_mfma_f32_16x16x32_bf16 v[252:255], a[204:207], v[248:251], v[252:255]
    buffer_load_dwordx4 a[28:31], v28, s[20:23], s9 offen offset:3072 sc1
    v_mfma_f32_16x16x32_bf16 v[220:223], a[200:203], v[248:251], v[220:223]
    s_waitcnt lgkmcnt(4)
    s_add_u32 s9, s9, 4096
    s_and_b32 s40, s48, 1
    v_mfma_f32_16x16x32_bf16 v[44:47], a[208:211], v[248:251], v[44:47]
    s_lshl_b32 s40, s40, 12
    ds_read_b64_tr_b16 a[200:201], v10 offset:0
    s_or_b32 s56, s56, s40
    v_mfma_f32_16x16x32_bf16 v[60:63], a[212:215], v[248:251], v[60:63]
    s_lshl_b32 s40, s48, 10
    ds_read_b64_tr_b16 a[202:203], v10 offset:6144
    s_and_b32 s40, s40, 0x2000
    v_mfma_f32_16x16x32_bf16 v[56:59], a[212:215], v[240:243], v[56:59]
    buffer_store_dwordx4 v[200:203], v28, s[20:23], s55 offen offset:1024 sc1
    v_mfma_f32_16x16x32_bf16 v[40:43], a[208:211], v[240:243], v[40:43]
    s_or_b32 s56, s56, s40
    s_or_b32 s56, s56, 134217728
    s_and_b32 s45, s45, 3
    v_mfma_f32_16x16x32_bf16 v[36:39], a[208:211], v[232:235], v[36:39]
    s_lshl_b32 s45, s45, 10
    ds_read_b64_tr_b16 a[204:205], v11 offset:0
    s_add_u32 s45, s45, s56
    v_mfma_f32_16x16x32_bf16 v[52:55], a[212:215], v[232:235], v[52:55]
    s_waitcnt vmcnt(7)
    ds_read_b64_tr_b16 a[206:207], v11 offset:6144
    s_lshl_b32 s47, s41, 14
    v_mfma_f32_16x16x32_bf16 v[48:51], a[212:215], v[224:227], v[48:51]
    s_add_u32 s47, s47, s45
    s_sub_u32 s41, s41, s51
    s_lshl_b32 s48, s42, 14
    v_mfma_f32_16x16x32_bf16 v[32:35], a[208:211], v[224:227], v[32:35]
    s_waitcnt lgkmcnt(4)
    buffer_load_dwordx4 a[32:35], v28, s[20:23], s10 offen offset:0 sc1
    v_mfma_f32_16x16x32_bf16 a[224:227], a[192:195], a[0:3], a[224:227]
    s_load_dword s72, s[86:87], s5 offset:4 glc
    ds_read_b64_tr_b16 a[208:209], v8 offset:1024
    s_add_u32 s48, s48, s45
    v_mfma_f32_16x16x32_bf16 a[240:243], a[196:199], a[0:3], a[240:243]
    s_sub_u32 s42, s42, s51
    ds_read_b64_tr_b16 a[210:211], v8 offset:7168
    s_lshl_b32 s40, s43, 14
    v_mfma_f32_16x16x32_bf16 a[244:247], a[196:199], a[4:7], a[244:247]
    s_add_u32 s40, s40, s45
    ds_read_b128 v[64:67], v29 offset:0
    s_sub_u32 s43, s43, s51
    v_mfma_f32_16x16x32_bf16 a[228:231], a[192:195], a[4:7], a[228:231]
    s_add_u32 s56, s51, 16
    ds_read_b128 v[72:75], v29 offset:1024
    s_cmp_lt_u32 s3, 2
    s_cselect_b32 s43, s56, s43
    v_mfma_f32_16x16x32_bf16 a[232:235], a[192:195], a[8:11], a[232:235]
    s_lshl_b32 s41, s41, 6
    ds_read_b64_tr_b16 a[212:213], v9 offset:1024
    s_lshl_b32 s42, s42, 6
    v_mfma_f32_16x16x32_bf16 a[248:251], a[196:199], a[8:11], a[248:251]
    s_lshl_b32 s43, s43, 6
    ds_read_b64_tr_b16 a[214:215], v9 offset:7168
    s_cmp_lt_u32 s3, 2
    s_cselect_b32 s66, 0x70000000, s42
    v_mfma_f32_16x16x32_bf16 a[252:255], a[196:199], a[12:15], a[252:255]
    ds_read_b128 v[80:83], v29 offset:2048
    v_add_u32 v23, 3211264, v23
    v_mfma_f32_16x16x32_bf16 a[236:239], a[192:195], a[12:15], a[236:239]
    s_waitcnt lgkmcnt(4)
    buffer_store_dwordx4 v[208:211], v28, s[20:23], s55 offen offset:2048 sc1
    v_mfma_f32_16x16x32_bf16 v[92:95], a[200:203], a[12:15], v[92:95]
    ds_read_b64_tr_b16 a[192:193], v10 offset:1024
    v_mfma_f32_16x16x32_bf16 v[124:127], a[204:207], a[12:15], v[124:127]
    ds_read_b64_tr_b16 a[194:195], v10 offset:7168
    v_mfma_f32_16x16x32_bf16 v[116:119], a[204:207], a[8:11], v[116:119]
    ds_read_b128 v[88:91], v29 offset:3072
    v_mfma_f32_16x16x32_bf16 v[84:87], a[200:203], a[8:11], v[84:87]
    ds_read_b128 v[96:99], v29 offset:4096
    v_mfma_f32_16x16x32_bf16 v[76:79], a[200:203], a[4:7], v[76:79]
    ds_read_b64_tr_b16 a[196:197], v11 offset:1024
    v_mfma_f32_16x16x32_bf16 v[108:111], a[204:207], a[4:7], v[108:111]
    ds_read_b64_tr_b16 a[198:199], v11 offset:7168
    v_mfma_f32_16x16x32_bf16 v[100:103], a[204:207], a[0:3], v[100:103]
    ds_read_b128 v[104:107], v29 offset:5120
    v_mfma_f32_16x16x32_bf16 v[68:71], a[200:203], a[0:3], v[68:71]
    s_waitcnt lgkmcnt(4)
    buffer_load_dwordx4 a[36:39], v28, s[20:23], s10 offen offset:1024 sc1
    v_mfma_f32_16x16x32_bf16 v[132:135], a[208:211], a[0:3], v[132:135]
    ds_read_b64_tr_b16 a[200:201], v18 offset:2048
    v_lshlrev_b32 v16, 4, v16
    v_mfma_f32_16x16x32_bf16 v[164:167], a[212:215], a[0:3], v[164:167]
    s_waitcnt vmcnt(9)
    ds_read_b64_tr_b16 a[202:203], v18 offset:8192
    v_mfma_f32_16x16x32_bf16 v[172:175], a[212:215], a[4:7], v[172:175]
    ds_read_b128 v[112:115], v29 offset:6144
    v_mfma_f32_16x16x32_bf16 v[140:143], a[208:211], a[4:7], v[140:143]
    ds_read_b128 v[120:123], v29 offset:7168
    v_mfma_f32_16x16x32_bf16 v[148:151], a[208:211], a[8:11], v[148:151]
    ds_read_b64_tr_b16 a[204:205], v19 offset:2048
    v_mfma_f32_16x16x32_bf16 v[180:183], a[212:215], a[8:11], v[180:183]
    ds_read_b64_tr_b16 a[206:207], v19 offset:8192
    v_mfma_f32_16x16x32_bf16 v[188:191], a[212:215], a[12:15], v[188:191]
    ds_read_b128 v[128:131], v29 offset:8192
    v_mfma_f32_16x16x32_bf16 v[156:159], a[208:211], a[12:15], v[156:159]
    s_waitcnt lgkmcnt(4)
    buffer_atomic_or v16, v17, s[24:27], 0 offen
    v_mfma_f32_16x16x32_bf16 v[220:223], a[192:195], a[12:15], v[220:223]
    ds_read_b64_tr_b16 a[208:209], v8 offset:12288
    v_mfma_f32_16x16x32_bf16 v[252:255], a[196:199], a[12:15], v[252:255]
    ds_read_b64_tr_b16 a[210:211], v8 offset:18432
    v_mfma_f32_16x16x32_bf16 v[244:247], a[196:199], a[8:11], v[244:247]
    ds_read_b128 v[136:139], v29 offset:9216
    v_mfma_f32_16x16x32_bf16 v[212:215], a[192:195], a[8:11], v[212:215]
    buffer_store_dwordx4 v[216:219], v28, s[20:23], s55 offen offset:3072 sc1
    v_mfma_f32_16x16x32_bf16 v[204:207], a[192:195], a[4:7], v[204:207]
    s_add_u32 s55, s55, 4096
    ds_read_b64_tr_b16 a[212:213], v9 offset:12288
    v_mfma_f32_16x16x32_bf16 v[236:239], a[196:199], a[4:7], v[236:239]
    ds_read_b64_tr_b16 a[214:215], v9 offset:18432
    v_mfma_f32_16x16x32_bf16 v[228:231], a[196:199], a[0:3], v[228:231]
    buffer_load_dwordx4 a[40:43], v28, s[20:23], s10 offen offset:2048 sc1
    v_mfma_f32_16x16x32_bf16 v[196:199], a[192:195], a[0:3], v[196:199]
    s_waitcnt lgkmcnt(4)
    v_mfma_f32_16x16x32_bf16 v[32:35], a[200:203], a[0:3], v[32:35]
    ds_read_b64_tr_b16 a[192:193], v10 offset:12288
    v_mfma_f32_16x16x32_bf16 v[48:51], a[204:207], a[0:3], v[48:51]
    ds_read_b64_tr_b16 a[194:195], v10 offset:18432
    v_mfma_f32_16x16x32_bf16 v[52:55], a[204:207], a[4:7], v[52:55]
    s_bfe_u32 s88, s72, 262148
    s_cmp_lg_u32 s88, 15
    s_cbranch_scc1 spin_o1
spin_o1_ret:
    v_mfma_f32_16x16x32_bf16 v[36:39], a[200:203], a[4:7], v[36:39]
    buffer_load_dwordx4 a[44:47], v28, s[20:23], s10 offen offset:3072 sc1
    v_mfma_f32_16x16x32_bf16 v[40:43], a[200:203], a[8:11], v[40:43]
    s_add_u32 s10, s10, 4096
    ds_read_b64_tr_b16 a[196:197], v11 offset:12288
    v_mfma_f32_16x16x32_bf16 v[56:59], a[204:207], a[8:11], v[56:59]
    s_waitcnt vmcnt(8)
    ds_read_b64_tr_b16 a[198:199], v11 offset:18432
    v_mfma_f32_16x16x32_bf16 v[60:63], a[204:207], a[12:15], v[60:63]
    buffer_load_dwordx4 a[48:51], v28, s[20:23], s8 offen offset:0 sc1
    v_mfma_f32_16x16x32_bf16 v[44:47], a[200:203], a[12:15], v[44:47]
    s_waitcnt lgkmcnt(4)
    v_mfma_f32_16x16x32_bf16 a[236:239], a[208:211], a[28:31], a[236:239]
    ds_read_b64_tr_b16 a[200:201], v8 offset:13312
    v_mfma_f32_16x16x32_bf16 a[252:255], a[212:215], a[28:31], a[252:255]
    ds_read_b64_tr_b16 a[202:203], v8 offset:19456
    v_mfma_f32_16x16x32_bf16 a[248:251], a[212:215], a[24:27], a[248:251]
    v_add_u32 v8, 73728, v12
    v_mfma_f32_16x16x32_bf16 a[232:235], a[208:211], a[24:27], a[232:235]
    buffer_load_dwordx4 a[52:55], v28, s[20:23], s8 offen offset:1024 sc1
    v_mfma_f32_16x16x32_bf16 a[228:231], a[208:211], a[20:23], a[228:231]
    ds_read_b64_tr_b16 a[204:205], v9 offset:13312
    v_add_f32 v64, v64, v72
    buffer_store_dwordx4 v[224:227], v28, s[20:23], s55 offen offset:0 sc1
    v_mfma_f32_16x16x32_bf16 a[244:247], a[212:215], a[20:23], a[244:247]
    ds_read_b64_tr_b16 a[206:207], v9 offset:19456
    v_add_f32 v65, v65, v73
    v_mfma_f32_16x16x32_bf16 a[240:243], a[212:215], a[16:19], a[240:243]
    v_add_f32 v66, v66, v74
    v_add_f32 v67, v67, v75
    v_mfma_f32_16x16x32_bf16 a[224:227], a[208:211], a[16:19], a[224:227]
    s_waitcnt lgkmcnt(4)
    v_add_f32 v64, v64, v80
    v_add_f32 v65, v65, v81
    v_mfma_f32_16x16x32_bf16 v[68:71], a[192:195], a[16:19], v[68:71]
    ds_read_b64_tr_b16 a[208:209], v10 offset:13312
    v_add_f32 v66, v66, v82
    v_mfma_f32_16x16x32_bf16 v[100:103], a[196:199], a[16:19], v[100:103]
    ds_read_b64_tr_b16 a[210:211], v10 offset:19456
    v_add_f32 v67, v67, v83
    v_mfma_f32_16x16x32_bf16 v[108:111], a[196:199], a[20:23], v[108:111]
    v_add_f32 v64, v64, v88
    v_add_f32 v65, v65, v89
    v_mfma_f32_16x16x32_bf16 v[76:79], a[192:195], a[20:23], v[76:79]
    buffer_load_dwordx4 a[56:59], v28, s[20:23], s8 offen offset:2048 sc1
    v_mfma_f32_16x16x32_bf16 v[84:87], a[192:195], a[24:27], v[84:87]
    ds_read_b64_tr_b16 a[212:213], v11 offset:13312
    v_add_f32 v66, v66, v90
    v_mfma_f32_16x16x32_bf16 v[116:119], a[196:199], a[24:27], v[116:119]
    ds_read_b64_tr_b16 a[214:215], v11 offset:19456
    v_add_f32 v67, v67, v91
    v_mfma_f32_16x16x32_bf16 v[124:127], a[196:199], a[28:31], v[124:127]
    v_add_f32 v64, v64, v96
    v_add_f32 v65, v65, v97
    v_mfma_f32_16x16x32_bf16 v[92:95], a[192:195], a[28:31], v[92:95]
    s_waitcnt lgkmcnt(4)
    v_add_f32 v66, v66, v98
    v_add_f32 v67, v67, v99
    v_mfma_f32_16x16x32_bf16 v[156:159], a[200:203], a[28:31], v[156:159]
    ds_read_b64_tr_b16 a[192:193], v18 offset:14336
    v_add_f32 v64, v64, v104
    v_mfma_f32_16x16x32_bf16 v[188:191], a[204:207], a[28:31], v[188:191]
    ds_read_b64_tr_b16 a[194:195], v18 offset:20480
    v_add_f32 v65, v65, v105
    v_mfma_f32_16x16x32_bf16 v[180:183], a[204:207], a[24:27], v[180:183]
    buffer_load_dwordx4 a[60:63], v28, s[20:23], s8 offen offset:3072 sc1
    v_mfma_f32_16x16x32_bf16 v[148:151], a[200:203], a[24:27], v[148:151]
    s_add_u32 s8, s8, 12288
    v_add_f32 v66, v66, v106
    v_add_f32 v67, v67, v107
    buffer_store_dwordx4 v[232:235], v28, s[20:23], s55 offen offset:1024 sc1
    v_mfma_f32_16x16x32_bf16 v[140:143], a[200:203], a[20:23], v[140:143]
    ds_read_b64_tr_b16 a[196:197], v19 offset:14336
    v_add_f32 v64, v64, v112
    v_mfma_f32_16x16x32_bf16 v[172:175], a[204:207], a[20:23], v[172:175]
    s_waitcnt vmcnt(63)
    ds_read_b64_tr_b16 a[198:199], v19 offset:20480
    v_add_f32 v65, v65, v113
    v_mfma_f32_16x16x32_bf16 v[164:167], a[204:207], a[16:19], v[164:167]
    s_barrier
    v_mfma_f32_16x16x32_bf16 v[132:135], a[200:203], a[16:19], v[132:135]
    s_waitcnt lgkmcnt(4)
    v_add_f32 v66, v66, v114
    v_add_f32 v67, v67, v115
    v_mfma_f32_16x16x32_bf16 v[196:199], a[208:211], a[16:19], v[196:199]
    ds_read_b64_tr_b16 a[200:201], v8 offset:0
    v_add_f32 v64, v64, v120
    v_mfma_f32_16x16x32_bf16 v[228:231], a[212:215], a[16:19], v[228:231]
    ds_read_b64_tr_b16 a[202:203], v8 offset:6144
    v_add_f32 v65, v65, v121
    v_mfma_f32_16x16x32_bf16 v[236:239], a[212:215], a[20:23], v[236:239]
    buffer_store_dwordx4 v[240:243], v28, s[20:23], s55 offen offset:2048 sc1
    v_mfma_f32_16x16x32_bf16 v[204:207], a[208:211], a[20:23], v[204:207]
    v_add_f32 v66, v66, v122
    v_add_f32 v67, v67, v123
    v_add_u32 v9, 73728, v13
    v_mfma_f32_16x16x32_bf16 v[212:215], a[208:211], a[24:27], v[212:215]
    ds_read_b64_tr_b16 a[204:205], v9 offset:0
    v_add_f32 v64, v64, v128
    v_mfma_f32_16x16x32_bf16 v[244:247], a[212:215], a[24:27], v[244:247]
    ds_read_b64_tr_b16 a[206:207], v9 offset:6144
    v_add_f32 v65, v65, v129
    v_mfma_f32_16x16x32_bf16 v[252:255], a[212:215], a[28:31], v[252:255]
    buffer_load_dwordx4 a[64:67], v28, s[20:23], s9 offen offset:0 sc1
    v_mfma_f32_16x16x32_bf16 v[220:223], a[208:211], a[28:31], v[220:223]
    s_waitcnt lgkmcnt(4)
    v_add_f32 v66, v66, v130
    v_add_f32 v67, v67, v131
    v_add_u32 v10, 73728, v14
    v_mfma_f32_16x16x32_bf16 v[44:47], a[192:195], a[28:31], v[44:47]
    s_load_dword s72, s[86:87], s5 offset:4 glc
    ds_read_b64_tr_b16 a[208:209], v10 offset:0
    v_add_f32 v64, v64, v136
    v_mfma_f32_16x16x32_bf16 v[60:63], a[196:199], a[28:31], v[60:63]
    ds_read_b64_tr_b16 a[210:211], v10 offset:6144
    v_add_f32 v65, v65, v137
    v_mfma_f32_16x16x32_bf16 v[56:59], a[196:199], a[24:27], v[56:59]
    buffer_load_dwordx4 a[68:71], v28, s[20:23], s9 offen offset:1024 sc1
    v_mfma_f32_16x16x32_bf16 v[40:43], a[192:195], a[24:27], v[40:43]
    v_lshlrev_b32 v16, 4, v16
    v_add_f32 v66, v66, v138
    v_add_u32 v11, 73728, v15
    v_mfma_f32_16x16x32_bf16 v[36:39], a[192:195], a[20:23], v[36:39]
    s_waitcnt vmcnt(11)
    ds_read_b64_tr_b16 a[212:213], v11 offset:0
    v_add_f32 v67, v67, v139
    v_mfma_f32_16x16x32_bf16 v[52:55], a[196:199], a[20:23], v[52:55]
    s_waitcnt vmcnt(9)
    ds_read_b64_tr_b16 a[214:215], v11 offset:6144
    v_cvt_pk_bf16_f32 v64, v64, v64
    v_mfma_f32_16x16x32_bf16 v[48:51], a[196:199], a[16:19], v[48:51]
    buffer_atomic_or v16, v17, s[24:27], 0 offen
    v_mfma_f32_16x16x32_bf16 v[32:35], a[192:195], a[16:19], v[32:35]
    s_waitcnt lgkmcnt(4)
    buffer_load_dwordx4 a[72:75], v28, s[20:23], s9 offen offset:2048 sc1
    v_mfma_f32_16x16x32_bf16 a[224:227], a[200:203], a[32:35], a[224:227]
    ds_read_b64_tr_b16 a[192:193], v8 offset:1024
    v_and_b32 v64, 0xffff0000, v64
    v_mfma_f32_16x16x32_bf16 a[240:243], a[204:207], a[32:35], a[240:243]
    ds_read_b64_tr_b16 a[194:195], v8 offset:7168
    v_cvt_pk_bf16_f32 v65, v65, v65
    v_mfma_f32_16x16x32_bf16 a[244:247], a[204:207], a[36:39], a[244:247]
    buffer_store_dwordx4 v[248:251], v28, s[20:23], s55 offen offset:3072 sc1
    v_mfma_f32_16x16x32_bf16 a[228:231], a[200:203], a[36:39], a[228:231]
    s_add_u32 s55, s55, 12288
    v_and_b32 v65, 0xffff0000, v65
    v_cvt_pk_bf16_f32 v66, v66, v66
    v_mfma_f32_16x16x32_bf16 a[232:235], a[200:203], a[40:43], a[232:235]
    ds_read_b64_tr_b16 a[196:197], v9 offset:1024
    v_and_b32 v66, 0xffff0000, v66
    v_mfma_f32_16x16x32_bf16 a[248:251], a[204:207], a[40:43], a[248:251]
    ds_read_b64_tr_b16 a[198:199], v9 offset:7168
    v_cvt_pk_bf16_f32 v67, v67, v67
    v_mfma_f32_16x16x32_bf16 a[252:255], a[204:207], a[44:47], a[252:255]
    v_and_b32 v67, 0xffff0000, v67
    v_mul_f32 v72, s92, v64
    v_mfma_f32_16x16x32_bf16 a[236:239], a[200:203], a[44:47], a[236:239]
    s_waitcnt lgkmcnt(4)
    buffer_load_dwordx4 a[76:79], v28, s[20:23], s9 offen offset:3072 sc1
    v_mfma_f32_16x16x32_bf16 v[92:95], a[208:211], a[44:47], v[92:95]
    s_add_u32 s9, s9, 12288
    ds_read_b64_tr_b16 a[200:201], v10 offset:1024
    v_xor_b32 v18, s39, v8
    v_mfma_f32_16x16x32_bf16 v[124:127], a[212:215], a[44:47], v[124:127]
    ds_read_b64_tr_b16 a[202:203], v10 offset:7168
    v_xor_b32 v19, s39, v9
    v_mfma_f32_16x16x32_bf16 v[116:119], a[212:215], a[40:43], v[116:119]
    v_exp_f32 v72, v72
    v_mfma_f32_16x16x32_bf16 v[84:87], a[208:211], a[40:43], v[84:87]
    buffer_load_dwordx4 a[80:83], v28, s[20:23], s10 offen offset:0 sc1
    v_mfma_f32_16x16x32_bf16 v[76:79], a[208:211], a[36:39], v[76:79]
    ds_read_b64_tr_b16 a[204:205], v11 offset:1024
    v_add_f32 v72, 1.0, v72
    v_mfma_f32_16x16x32_bf16 v[108:111], a[212:215], a[36:39], v[108:111]
    ds_read_b64_tr_b16 a[206:207], v11 offset:7168
    v_mfma_f32_16x16x32_bf16 v[100:103], a[212:215], a[32:35], v[100:103]
    v_rcp_f32 v72, v72
    v_mfma_f32_16x16x32_bf16 v[68:71], a[208:211], a[32:35], v[68:71]
    s_waitcnt lgkmcnt(4)
    buffer_load_dwordx4 a[84:87], v28, s[20:23], s10 offen offset:1024 sc1
    v_mfma_f32_16x16x32_bf16 v[132:135], a[192:195], a[32:35], v[132:135]
    ds_read_b64_tr_b16 a[208:209], v18 offset:2048
    v_mul_f32 v64, v64, v72
    v_mfma_f32_16x16x32_bf16 v[164:167], a[196:199], a[32:35], v[164:167]
    ds_read_b64_tr_b16 a[210:211], v18 offset:8192
    v_cvt_pk_bf16_f32 v64, v64, v64
    v_mfma_f32_16x16x32_bf16 v[172:175], a[196:199], a[36:39], v[172:175]
    v_and_b32 v64, 0xffff0000, v64
    v_mul_f32 v64, v64, v66
    v_mfma_f32_16x16x32_bf16 v[140:143], a[192:195], a[36:39], v[140:143]
    v_mul_f32 v73, s92, v65
    v_mfma_f32_16x16x32_bf16 v[148:151], a[192:195], a[40:43], v[148:151]
    ds_read_b64_tr_b16 a[212:213], v19 offset:2048
    v_mfma_f32_16x16x32_bf16 v[180:183], a[196:199], a[40:43], v[180:183]
    ds_read_b64_tr_b16 a[214:215], v19 offset:8192
    v_mfma_f32_16x16x32_bf16 v[188:191], a[196:199], a[44:47], v[188:191]
    buffer_load_dwordx4 a[88:91], v28, s[20:23], s10 offen offset:2048 sc1
    v_mfma_f32_16x16x32_bf16 v[156:159], a[192:195], a[44:47], v[156:159]
    s_waitcnt lgkmcnt(4)
    v_exp_f32 v73, v73
    v_mfma_f32_16x16x32_bf16 v[220:223], a[200:203], a[44:47], v[220:223]
    ds_read_b64_tr_b16 a[192:193], v8 offset:12288
    v_add_f32 v73, 1.0, v73
    v_mfma_f32_16x16x32_bf16 v[252:255], a[204:207], a[44:47], v[252:255]
    ds_read_b64_tr_b16 a[194:195], v8 offset:18432
    v_cmp_lt_u32 s[78:79], 31, v1
    v_mfma_f32_16x16x32_bf16 v[244:247], a[204:207], a[40:43], v[244:247]
    s_bfe_u32 s88, s72, 262152
    s_cmp_lg_u32 s88, 15
    s_cbranch_scc1 spin_o2
spin_o2_ret:
    v_mov_b32 v195, s70
    v_mfma_f32_16x16x32_bf16 v[212:215], a[200:203], a[40:43], v[212:215]
    buffer_load_dwordx4 a[92:95], v28, s[20:23], s10 offen offset:3072 sc1
    v_mfma_f32_16x16x32_bf16 v[204:207], a[200:203], a[36:39], v[204:207]
    s_add_u32 s10, s10, 12288
    ds_read_b64_tr_b16 a[196:197], v9 offset:12288
    v_mov_b32 v192, s71
    v_mfma_f32_16x16x32_bf16 v[236:239], a[204:207], a[36:39], v[236:239]
    ds_read_b64_tr_b16 a[198:199], v9 offset:18432
    v_cndmask_b32 v195, v195, v192, s[78:79]
    v_mfma_f32_16x16x32_bf16 v[228:231], a[204:207], a[32:35], v[228:231]
    buffer_load_dwordx4 a[96:99], v28, s[20:23], s8 offen offset:0 sc1
    v_mfma_f32_16x16x32_bf16 v[196:199], a[200:203], a[32:35], v[196:199]
    s_waitcnt lgkmcnt(4)
    v_rcp_f32 v73, v73
    v_mfma_f32_16x16x32_bf16 v[32:35], a[208:211], a[32:35], v[32:35]
    ds_read_b64_tr_b16 a[200:201], v10 offset:12288
    v_mul_f32 v65, v65, v73
    v_mfma_f32_16x16x32_bf16 v[48:51], a[212:215], a[32:35], v[48:51]
    ds_read_b64_tr_b16 a[202:203], v10 offset:18432
    v_cvt_pk_bf16_f32 v65, v65, v65
    v_mfma_f32_16x16x32_bf16 v[52:55], a[212:215], a[36:39], v[52:55]
    buffer_load_dwordx4 a[100:103], v28, s[20:23], s8 offen offset:1024 sc1
    v_mfma_f32_16x16x32_bf16 v[36:39], a[208:211], a[36:39], v[36:39]
    v_and_b32 v65, 0xffff0000, v65
    v_mul_f32 v65, v65, v67
    v_mfma_f32_16x16x32_bf16 v[40:43], a[208:211], a[40:43], v[40:43]
    ds_read_b64_tr_b16 a[204:205], v11 offset:12288
    v_cvt_pk_bf16_f32 v64, v64, v65
    v_mfma_f32_16x16x32_bf16 v[56:59], a[212:215], a[40:43], v[56:59]
    s_waitcnt vmcnt(14)
    ds_read_b64_tr_b16 a[206:207], v11 offset:18432
    v_bfe_u32 v194, v1, 3, 2
    v_mfma_f32_16x16x32_bf16 v[60:63], a[212:215], a[44:47], v[60:63]
    buffer_load_dwordx4 a[104:107], v28, s[20:23], s8 offen offset:2048 sc1
    v_mfma_f32_16x16x32_bf16 v[44:47], a[208:211], a[44:47], v[44:47]
    s_waitcnt lgkmcnt(4)
    v_mov_b32 v192, s41
    v_mov_b32 v193, s42
    v_mfma_f32_16x16x32_bf16 a[236:239], a[192:195], a[60:63], a[236:239]
    s_lshl_b32 s61, s3, 8
    ds_read_b64_tr_b16 a[208:209], v8 offset:13312
    v_cmp_eq_u32 s[78:79], 1, v194
    v_mfma_f32_16x16x32_bf16 a[252:255], a[196:199], a[60:63], a[252:255]
    s_add_u32 s61, s61, 157696
    ds_read_b64_tr_b16 a[210:211], v8 offset:19456
    v_lshlrev_b32 v80, 1, v1
    v_mfma_f32_16x16x32_bf16 a[248:251], a[196:199], a[56:59], a[248:251]
    v_add_u32 v80, s61, v80
    v_and_b32 v81, 1, v1
    v_mfma_f32_16x16x32_bf16 a[232:235], a[192:195], a[56:59], a[232:235]
    buffer_load_dwordx4 a[108:111], v28, s[20:23], s8 offen offset:3072 sc1
    v_mfma_f32_16x16x32_bf16 a[228:231], a[192:195], a[52:55], a[228:231]
    s_add_u32 s8, s8, 4096
    ds_read_b64_tr_b16 a[212:213], v9 offset:13312
    v_lshlrev_b32 v81, 7, v81
    v_mfma_f32_16x16x32_bf16 a[244:247], a[196:199], a[52:55], a[244:247]
    s_add_u32 m0, s44, 147456
    ds_read_b64_tr_b16 a[214:215], v9 offset:19456
    v_lshrrev_b32 v83, 4, v1
    v_mfma_f32_16x16x32_bf16 a[240:243], a[196:199], a[48:51], a[240:243]
pg_10:
    s_cbranch_execz pg_ret2
    v_lshl_add_u32 v81, v83, 4, v81
    v_add_u32 v81, s61, v81
    v_mfma_f32_16x16x32_bf16 a[224:227], a[192:195], a[48:51], a[224:227]
    s_waitcnt lgkmcnt(4)
    buffer_load_dwordx4 v6, s[28:31], s59 offen lds
    v_mfma_f32_16x16x32_bf16 v[68:71], a[200:203], a[48:51], v[68:71]
    s_add_u32 m0, s44, 148480
    ds_read_b64_tr_b16 a[192:193], v10 offset:13312
    v_bfe_u32 v83, v1, 2, 3
    v_mfma_f32_16x16x32_bf16 v[100:103], a[204:207], a[48:51], v[100:103]
    ds_read_b64_tr_b16 a[194:195], v10 offset:19456
    v_lshlrev_b32 v82, 7, v83
    v_mfma_f32_16x16x32_bf16 v[108:111], a[204:207], a[52:55], v[108:111]
    v_lshrrev_b32 v83, 1, v83
    v_xor_b32 v83, s3, v83
    v_mfma_f32_16x16x32_bf16 v[76:79], a[200:203], a[52:55], v[76:79]
    buffer_load_dwordx4 v7, s[28:31], s59 offen lds
    v_mfma_f32_16x16x32_bf16 v[84:87], a[200:203], a[56:59], v[84:87]
    ds_read_b64_tr_b16 a[196:197], v11 offset:13312
    v_lshlrev_b32 v16, 4, v16
    v_mfma_f32_16x16x32_bf16 v[116:119], a[204:207], a[56:59], v[116:119]
    s_waitcnt vmcnt(11)
    ds_read_b64_tr_b16 a[198:199], v11 offset:19456
    v_lshl_add_u32 v82, v83, 5, v82
    v_mfma_f32_16x16x32_bf16 v[124:127], a[204:207], a[60:63], v[124:127]
    buffer_atomic_or v16, v17, s[24:27], 0 offen
    v_mfma_f32_16x16x32_bf16 v[92:95], a[200:203], a[60:63], v[92:95]
    s_waitcnt lgkmcnt(4)
    v_and_b32 v83, 3, v1
    v_lshl_add_u32 v82, v83, 3, v82
    v_mfma_f32_16x16x32_bf16 v[156:159], a[208:211], a[60:63], v[156:159]
    ds_read_b64_tr_b16 a[200:201], v18 offset:14336
    v_lshrrev_b32 v83, 5, v1
    v_mfma_f32_16x16x32_bf16 v[188:191], a[212:215], a[60:63], v[188:191]
    ds_read_b64_tr_b16 a[202:203], v18 offset:20480
    v_mul_u32_u24 v83, 1024, v83
    v_mfma_f32_16x16x32_bf16 v[180:183], a[212:215], a[56:59], v[180:183]
    buffer_load_dwordx4 a[112:115], v28, s[20:23], s9 offen offset:0 sc1
    v_mfma_f32_16x16x32_bf16 v[148:151], a[208:211], a[56:59], v[148:151]
    v_add_u32 v82, v82, v83
    v_add_u32 v82, 147456, v82
    v_mfma_f32_16x16x32_bf16 v[140:143], a[208:211], a[52:55], v[140:143]
    ds_read_b64_tr_b16 a[204:205], v19 offset:14336
    v_lshlrev_b32 v74, 2, v1
    v_mfma_f32_16x16x32_bf16 v[172:175], a[212:215], a[52:55], v[172:175]
    s_waitcnt vmcnt(63)
    ds_read_b64_tr_b16 a[206:207], v19 offset:20480
    v_cmp_gt_u32 vcc, 16, v1
    v_mfma_f32_16x16x32_bf16 v[164:167], a[212:215], a[48:51], v[164:167]
    s_barrier
    v_mfma_f32_16x16x32_bf16 v[132:135], a[208:211], a[48:51], v[132:135]
    s_waitcnt lgkmcnt(4)
    buffer_load_dwordx4 a[116:119], v28, s[20:23], s9 offen offset:1024 sc1
    v_add_u32 v8, 98304, v12
    v_mfma_f32_16x16x32_bf16 v[196:199], a[192:195], a[48:51], v[196:199]
    s_load_dword s72, s[86:87], s5 offset:4 glc
    ds_read_b64_tr_b16 a[208:209], v8 offset:0
    v_mov_b32 v83, 0x7ffffff0
    v_mfma_f32_16x16x32_bf16 v[228:231], a[196:199], a[48:51], v[228:231]
    ds_read_b64_tr_b16 a[210:211], v8 offset:6144
    v_cndmask_b32 v74, v83, v74, vcc
    v_mfma_f32_16x16x32_bf16 v[236:239], a[196:199], a[52:55], v[236:239]
    buffer_load_dwordx4 a[120:123], v28, s[20:23], s9 offen offset:2048 sc1
    v_mfma_f32_16x16x32_bf16 v[204:207], a[192:195], a[52:55], v[204:207]
    v_cndmask_b32 v192, v192, v193, s[78:79]
    v_mov_b32 v193, s43
    v_add_u32 v9, 98304, v13
    v_mfma_f32_16x16x32_bf16 v[212:215], a[192:195], a[56:59], v[212:215]
    ds_read_b64_tr_b16 a[212:213], v9 offset:0
    v_cmp_lt_u32 s[78:79], 1, v194
    v_mfma_f32_16x16x32_bf16 v[244:247], a[196:199], a[56:59], v[244:247]
    ds_read_b64_tr_b16 a[214:215], v9 offset:6144
    v_cndmask_b32 v192, v192, v193, s[78:79]
    v_mfma_f32_16x16x32_bf16 v[252:255], a[196:199], a[60:63], v[252:255]
    buffer_load_dwordx4 a[124:127], v28, s[20:23], s9 offen offset:3072 sc1
    v_mfma_f32_16x16x32_bf16 v[220:223], a[192:195], a[60:63], v[220:223]
    s_waitcnt lgkmcnt(4)
    v_and_b32 v193, 7, v1
    v_lshl_add_u32 v192, v193, 3, v192
    v_add_u32 v10, 98304, v14
    v_mfma_f32_16x16x32_bf16 v[44:47], a[200:203], a[60:63], v[44:47]
    s_add_u32 s9, s9, 4096
    ds_read_b64_tr_b16 a[192:193], v10 offset:0
    v_and_b32 v194, 0x7ff, v195
    v_mfma_f32_16x16x32_bf16 v[60:63], a[204:207], a[60:63], v[60:63]
    ds_read_b64_tr_b16 a[194:195], v10 offset:6144
    v_sub_u32 v194, 2047, v194
    v_mfma_f32_16x16x32_bf16 v[56:59], a[204:207], a[56:59], v[56:59]
    buffer_load_dwordx4 a[128:131], v28, s[20:23], s10 offen offset:0 sc1
    v_mfma_f32_16x16x32_bf16 v[40:43], a[200:203], a[56:59], v[40:43]
    v_mul_u32_u24 v193, 1280, v194
    v_add_u32 v193, v193, v192
    v_add_u32 v11, 98304, v15
    v_mfma_f32_16x16x32_bf16 v[36:39], a[200:203], a[52:55], v[36:39]
    ds_read_b64_tr_b16 a[196:197], v11 offset:0
    v_lshlrev_b32 v194, 3, v194
    v_mfma_f32_16x16x32_bf16 v[52:55], a[204:207], a[52:55], v[52:55]
    s_waitcnt vmcnt(16)
    ds_read_b64_tr_b16 a[198:199], v11 offset:6144
    v_add_u32 v194, 3211264, v194
    v_mfma_f32_16x16x32_bf16 v[48:51], a[204:207], a[48:51], v[48:51]
    v_xor_b32 v18, s39, v8
    v_xor_b32 v19, s39, v9
    v_mfma_f32_16x16x32_bf16 v[32:35], a[200:203], a[48:51], v[32:35]
    s_waitcnt lgkmcnt(4)
    buffer_load_dwordx4 a[132:135], v28, s[20:23], s10 offen offset:1024 sc1
    v_mfma_f32_16x16x32_bf16 a[224:227], a[208:211], a[64:67], a[224:227]
    ds_read_b64_tr_b16 a[200:201], v8 offset:1024
    v_mfma_f32_16x16x32_bf16 a[240:243], a[212:215], a[64:67], a[240:243]
    ds_read_b64_tr_b16 a[202:203], v8 offset:7168
    v_mfma_f32_16x16x32_bf16 a[244:247], a[212:215], a[68:71], a[244:247]
    v_mfma_f32_16x16x32_bf16 a[228:231], a[208:211], a[68:71], a[228:231]
    buffer_load_dwordx4 a[136:139], v28, s[20:23], s10 offen offset:2048 sc1
    v_mfma_f32_16x16x32_bf16 a[232:235], a[208:211], a[72:75], a[232:235]
    s_lshr_b32 s55, s54, 1
    ds_read_b64_tr_b16 a[204:205], v9 offset:1024
    v_bfe_u32 v224, v1, 3, 1
    v_mfma_f32_16x16x32_bf16 a[248:251], a[212:215], a[72:75], a[248:251]
    s_lshl_b32 s55, s55, 19
    ds_read_b64_tr_b16 a[206:207], v9 offset:7168
    v_lshlrev_b32 v224, 1, v224
    v_mfma_f32_16x16x32_bf16 a[252:255], a[212:215], a[76:79], a[252:255]
    s_and_b32 s60, s54, 1
    v_lshrrev_b32 v225, 4, v1
    v_sub_u32 v224, v225, v224
    v_mfma_f32_16x16x32_bf16 a[236:239], a[208:211], a[76:79], a[236:239]
    s_waitcnt lgkmcnt(4)
    buffer_load_dwordx4 a[140:143], v28, s[20:23], s10 offen offset:3072 sc1
    v_mfma_f32_16x16x32_bf16 v[92:95], a[192:195], a[76:79], v[92:95]
    s_add_u32 s10, s10, 4096
    ds_read_b64_tr_b16 a[208:209], v10 offset:1024
    v_and_b32 v225, 1, v1
    v_mfma_f32_16x16x32_bf16 v[124:127], a[196:199], a[76:79], v[124:127]
    s_lshl_b32 s60, s60, 12
    ds_read_b64_tr_b16 a[210:211], v10 offset:7168
    v_lshlrev_b32 v225, 4, v225
    v_mfma_f32_16x16x32_bf16 v[116:119], a[196:199], a[72:75], v[116:119]
    s_or_b32 s55, s55, s60
    v_mov_b32 v226, 0x3c80
    v_lshlrev_b32 v225, v225, v226
    v_mfma_f32_16x16x32_bf16 v[84:87], a[192:195], a[72:75], v[84:87]
    s_lshl_b32 s60, s54, 10
    v_bfe_u32 v226, v1, 1, 2
    v_lshl_add_u32 v226, v224, 2, v226
    v_mfma_f32_16x16x32_bf16 v[76:79], a[192:195], a[68:71], v[76:79]
    s_and_b32 s60, s60, 0x2000
    ds_read_b64_tr_b16 a[212:213], v11 offset:1024
    v_cmp_eq_u32 s[74:75], 0, v226
    v_mfma_f32_16x16x32_bf16 v[108:111], a[196:199], a[68:71], v[108:111]
    s_or_b32 s55, s55, s60
    ds_read_b64_tr_b16 a[214:215], v11 offset:7168
    v_cndmask_b32 v208, 0, v225, s[74:75]
    v_mfma_f32_16x16x32_bf16 v[100:103], a[196:199], a[64:67], v[100:103]
    s_or_b32 s55, s55, 134217728
    v_cmp_eq_u32 s[74:75], 1, v226
    s_mul_i32 s60, s51, 81920
    v_mfma_f32_16x16x32_bf16 v[68:71], a[192:195], a[64:67], v[68:71]
    s_waitcnt lgkmcnt(4)
    v_cndmask_b32 v209, 0, v225, s[74:75]
    v_cmp_eq_u32 s[74:75], 2, v226
    v_mfma_f32_16x16x32_bf16 v[132:135], a[200:203], a[64:67], v[132:135]
    s_add_u32 s55, s55, s60
    ds_read_b64_tr_b16 a[192:193], v18 offset:2048
    v_cndmask_b32 v210, 0, v225, s[74:75]
    v_mfma_f32_16x16x32_bf16 v[164:167], a[204:207], a[64:67], v[164:167]
    s_mul_i32 s60, s53, 8389632
    ds_read_b64_tr_b16 a[194:195], v18 offset:8192
    v_cmp_eq_u32 s[74:75], 3, v226
    v_mfma_f32_16x16x32_bf16 v[172:175], a[204:207], a[68:71], v[172:175]
    s_bfe_u32 s88, s72, 262156
    s_cmp_lg_u32 s88, 15
    s_cbranch_scc1 spin_o3
spin_o3_ret:
    v_cndmask_b32 v211, 0, v225, s[74:75]
    v_mfma_f32_16x16x32_bf16 v[140:143], a[200:203], a[68:71], v[140:143]
    s_xor_b32 s55, s55, s60
    v_cmp_eq_u32 s[74:75], 4, v226
    s_add_u32 s60, s51, 8
    v_mfma_f32_16x16x32_bf16 v[148:151], a[200:203], a[72:75], v[148:151]
    s_lshr_b32 s60, s93, s60
    ds_read_b64_tr_b16 a[196:197], v19 offset:2048
    v_cndmask_b32 v216, 0, v225, s[74:75]
    v_mfma_f32_16x16x32_bf16 v[180:183], a[204:207], a[72:75], v[180:183]
    s_and_b32 s60, s60, 0x2000
    ds_read_b64_tr_b16 a[198:199], v19 offset:8192
    v_cmp_eq_u32 s[74:75], 5, v226
    v_mfma_f32_16x16x32_bf16 v[188:191], a[204:207], a[76:79], v[188:191]
    buffer_load_dwordx4 a[144:147], v28, s[20:23], s8 offen offset:0 sc1
    v_mfma_f32_16x16x32_bf16 v[156:159], a[200:203], a[76:79], v[156:159]
    s_waitcnt lgkmcnt(4)
    v_cndmask_b32 v217, 0, v225, s[74:75]
    v_cmp_eq_u32 s[74:75], 6, v226
    v_mfma_f32_16x16x32_bf16 v[220:223], a[208:211], a[76:79], v[220:223]
    s_xor_b32 s55, s55, s60
    ds_read_b64_tr_b16 a[200:201], v8 offset:12288
    v_cndmask_b32 v218, 0, v225, s[74:75]
    v_mfma_f32_16x16x32_bf16 v[252:255], a[212:215], a[76:79], v[252:255]
    ds_read_b64_tr_b16 a[202:203], v8 offset:18432
    v_cmp_eq_u32 s[74:75], 7, v226
    v_mfma_f32_16x16x32_bf16 v[244:247], a[212:215], a[72:75], v[244:247]
    buffer_load_dwordx2 v[24:25], v23, s[24:27], 0 offen sc1
    v_mfma_f32_16x16x32_bf16 v[212:215], a[208:211], a[72:75], v[212:215]
    buffer_load_dwordx4 a[148:151], v28, s[20:23], s8 offen offset:1024 sc1
    v_mfma_f32_16x16x32_bf16 v[204:207], a[208:211], a[68:71], v[204:207]
    ds_read_b64_tr_b16 a[204:205], v9 offset:12288
    v_cndmask_b32 v219, 0, v225, s[74:75]
    v_mfma_f32_16x16x32_bf16 v[236:239], a[212:215], a[68:71], v[236:239]
    ds_read_b64_tr_b16 a[206:207], v9 offset:18432
    v_mfma_f32_16x16x32_bf16 v[228:231], a[212:215], a[64:67], v[228:231]
    buffer_load_dwordx2 v[200:201], v193, s[16:19], 0 offen
    v_mfma_f32_16x16x32_bf16 v[196:199], a[208:211], a[64:67], v[196:199]
    s_waitcnt lgkmcnt(4)
    buffer_load_dwordx4 a[152:155], v28, s[20:23], s8 offen offset:2048 sc1
    v_mfma_f32_16x16x32_bf16 v[32:35], a[192:195], a[64:67], v[32:35]
    ds_read_b64_tr_b16 a[208:209], v10 offset:12288
    v_mfma_f32_16x16x32_bf16 v[48:51], a[196:199], a[64:67], v[48:51]
    ds_read_b64_tr_b16 a[210:211], v10 offset:18432
    v_mfma_f32_16x16x32_bf16 v[52:55], a[196:199], a[68:71], v[52:55]
    buffer_load_dwordx2 v[202:203], v194, s[24:27], 0 offen sc1
    v_mfma_f32_16x16x32_bf16 v[36:39], a[192:195], a[68:71], v[36:39]
    buffer_load_dwordx4 a[156:159], v28, s[20:23], s8 offen offset:3072 sc1
    v_mfma_f32_16x16x32_bf16 v[40:43], a[192:195], a[72:75], v[40:43]
    s_add_u32 s8, s8, 12288
    ds_read_b64_tr_b16 a[212:213], v11 offset:12288
    v_mfma_f32_16x16x32_bf16 v[56:59], a[196:199], a[72:75], v[56:59]
    s_waitcnt vmcnt(22)
    ds_read_b64_tr_b16 a[214:215], v11 offset:18432
    v_mfma_f32_16x16x32_bf16 v[60:63], a[196:199], a[76:79], v[60:63]
    v_mfma_f32_16x16x32_bf16 v[44:47], a[192:195], a[76:79], v[44:47]
    s_waitcnt lgkmcnt(4)
    v_mfma_f32_16x16x32_bf16 a[236:239], a[200:203], a[92:95], a[236:239]
    ds_read_b64_tr_b16 a[192:193], v8 offset:13312
    v_mfma_f32_16x16x32_bf16 a[252:255], a[204:207], a[92:95], a[252:255]
    ds_read_b64_tr_b16 a[194:195], v8 offset:19456
    v_mfma_f32_16x16x32_bf16 a[248:251], a[204:207], a[88:91], a[248:251]
    v_add_u32 v8, 49152, v12
    v_mfma_f32_16x16x32_bf16 a[232:235], a[200:203], a[88:91], a[232:235]
    v_mfma_f32_16x16x32_bf16 a[228:231], a[200:203], a[84:87], a[228:231]
    ds_read_b64_tr_b16 a[196:197], v9 offset:13312
    v_lshrrev_b32 v136, 5, v192
    v_mfma_f32_16x16x32_bf16 a[244:247], a[204:207], a[84:87], a[244:247]
    ds_read_b64_tr_b16 a[198:199], v9 offset:19456
    v_lshlrev_b32 v136, 9, v136
    v_mfma_f32_16x16x32_bf16 a[240:243], a[204:207], a[80:83], a[240:243]
    v_and_b32 v192, 31, v192
    v_lshl_add_u32 v192, v192, 1, v136
    v_mfma_f32_16x16x32_bf16 a[224:227], a[200:203], a[80:83], a[224:227]
    s_waitcnt lgkmcnt(4)
    v_lshrrev_b32 v193, 5, v1
    v_lshl_add_u32 v192, v193, 8, v192
    v_mfma_f32_16x16x32_bf16 v[68:71], a[208:211], a[80:83], v[68:71]
    ds_read_b64_tr_b16 a[200:201], v10 offset:13312
    v_and_b32 v195, 0xffff0000, v195
    v_mfma_f32_16x16x32_bf16 v[100:103], a[212:215], a[80:83], v[100:103]
    ds_read_b64_tr_b16 a[202:203], v10 offset:19456
    v_ashrrev_i32 v193, 31, v195
    v_mfma_f32_16x16x32_bf16 v[108:111], a[212:215], a[84:87], v[108:111]
    buffer_load_dwordx4 a[160:163], v28, s[20:23], s9 offen offset:0 sc1
    v_mfma_f32_16x16x32_bf16 v[76:79], a[208:211], a[84:87], v[76:79]
    v_not_b32 v193, v193
    v_or_b32 v193, 0x80000000, v193
    v_mfma_f32_16x16x32_bf16 v[84:87], a[208:211], a[88:91], v[84:87]
    ds_read_b64_tr_b16 a[204:205], v11 offset:13312
    v_xor_b32 v195, v195, v193
    v_mfma_f32_16x16x32_bf16 v[116:119], a[212:215], a[88:91], v[116:119]
    ds_read_b64_tr_b16 a[206:207], v11 offset:19456
    v_and_b32 v195, 0xffff0000, v195
    v_mfma_f32_16x16x32_bf16 v[124:127], a[212:215], a[92:95], v[124:127]
    buffer_load_dwordx4 a[164:167], v28, s[20:23], s9 offen offset:1024 sc1
    v_mfma_f32_16x16x32_bf16 v[92:95], a[208:211], a[92:95], v[92:95]
    s_waitcnt lgkmcnt(4)
    v_mul_f32 v195, s92, v195
    v_add_u32 v9, 49152, v13
    v_mfma_f32_16x16x32_bf16 v[156:159], a[192:195], a[92:95], v[156:159]
    s_load_dword s72, s[86:87], s5 offset:4 glc
    ds_read_b64_tr_b16 a[208:209], v18 offset:14336
    v_add_u32 v10, 49152, v14
    v_mfma_f32_16x16x32_bf16 v[188:191], a[196:199], a[92:95], v[188:191]
    ds_read_b64_tr_b16 a[210:211], v18 offset:20480
    v_add_u32 v11, 49152, v15
    v_mfma_f32_16x16x32_bf16 v[180:183], a[196:199], a[88:91], v[180:183]
    buffer_load_dwordx4 a[168:171], v28, s[20:23], s9 offen offset:2048 sc1
    v_mfma_f32_16x16x32_bf16 v[148:151], a[192:195], a[88:91], v[148:151]
    v_exp_f32 v195, v195
    v_mfma_f32_16x16x32_bf16 v[140:143], a[192:195], a[84:87], v[140:143]
    ds_read_b64_tr_b16 a[212:213], v19 offset:14336
    v_add_f32 v195, 1.0, v195
    v_mfma_f32_16x16x32_bf16 v[172:175], a[196:199], a[84:87], v[172:175]
    s_waitcnt vmcnt(19)
    ds_read_b64_tr_b16 a[214:215], v19 offset:20480
    v_xor_b32 v18, s39, v8
    v_mfma_f32_16x16x32_bf16 v[164:167], a[196:199], a[80:83], v[164:167]
    s_barrier
    v_mfma_f32_16x16x32_bf16 v[132:135], a[192:195], a[80:83], v[132:135]
    s_waitcnt lgkmcnt(4)
    buffer_load_dwordx4 a[172:175], v28, s[20:23], s9 offen offset:3072 sc1
    v_mfma_f32_16x16x32_bf16 v[196:199], a[200:203], a[80:83], v[196:199]
    s_add_u32 s9, s9, 12288
    ds_read_b64_tr_b16 a[192:193], v8 offset:0
    v_xor_b32 v19, s39, v9
    v_mfma_f32_16x16x32_bf16 v[228:231], a[204:207], a[80:83], v[228:231]
    ds_read_b64_tr_b16 a[194:195], v8 offset:6144
    v_mfma_f32_16x16x32_bf16 v[236:239], a[204:207], a[84:87], v[236:239]
    buffer_load_dwordx4 a[176:179], v28, s[20:23], s10 offen offset:0 sc1
    v_mfma_f32_16x16x32_bf16 v[204:207], a[200:203], a[84:87], v[204:207]
    v_rcp_f32 v195, v195
    v_mfma_f32_16x16x32_bf16 v[212:215], a[200:203], a[88:91], v[212:215]
    ds_read_b64_tr_b16 a[196:197], v9 offset:0
    v_cvt_pk_bf16_f32 v195, v195, v195
    v_mfma_f32_16x16x32_bf16 v[244:247], a[204:207], a[88:91], v[244:247]
    ds_read_b64_tr_b16 a[198:199], v9 offset:6144
    v_and_b32 v195, 0xffff0000, v195
    v_mfma_f32_16x16x32_bf16 v[252:255], a[204:207], a[92:95], v[252:255]
    ds_write_b16 v80, v64
    v_mfma_f32_16x16x32_bf16 v[220:223], a[200:203], a[92:95], v[220:223]
    s_waitcnt lgkmcnt(4)
    ds_write_b16_d16_hi v80, v64 offset:128
    v_mfma_f32_16x16x32_bf16 v[44:47], a[208:211], a[92:95], v[44:47]
    ds_read_b64_tr_b16 a[200:201], v10 offset:0
    v_mfma_f32_16x16x32_bf16 v[60:63], a[212:215], a[92:95], v[60:63]
    ds_read_b64_tr_b16 a[202:203], v10 offset:6144
    v_mfma_f32_16x16x32_bf16 v[56:59], a[212:215], a[88:91], v[56:59]
    ds_read_b128 v[88:91], v81
    v_mfma_f32_16x16x32_bf16 v[40:43], a[208:211], a[88:91], v[40:43]
    buffer_load_dwordx4 a[180:183], v28, s[20:23], s10 offen offset:1024 sc1
    v_mfma_f32_16x16x32_bf16 v[36:39], a[208:211], a[84:87], v[36:39]
    ds_read_b64_tr_b16 a[204:205], v11 offset:0
    v_mfma_f32_16x16x32_bf16 v[52:55], a[212:215], a[84:87], v[52:55]
    s_waitcnt vmcnt(24)
    ds_read_b64_tr_b16 a[206:207], v11 offset:6144
    v_mfma_f32_16x16x32_bf16 v[48:51], a[212:215], a[80:83], v[48:51]
    ds_read_b128 v[96:99], v81 offset:64
    v_mfma_f32_16x16x32_bf16 v[32:35], a[208:211], a[80:83], v[32:35]
    s_waitcnt lgkmcnt(4)
    ds_read_b64_tr_b16 v[104:105], v82
    v_mfma_f32_16x16x32_bf16 a[224:227], a[192:195], a[96:99], a[224:227]
    ds_read_b64_tr_b16 a[208:209], v8 offset:1024
    v_mfma_f32_16x16x32_bf16 a[240:243], a[196:199], a[96:99], a[240:243]
    ds_read_b64_tr_b16 a[210:211], v8 offset:7168
    v_mfma_f32_16x16x32_bf16 a[244:247], a[196:199], a[100:103], a[244:247]
    ds_read_b64_tr_b16 v[106:107], v82 offset:2048
    v_mfma_f32_16x16x32_bf16 a[228:231], a[192:195], a[100:103], a[228:231]
    buffer_load_dwordx4 a[184:187], v28, s[20:23], s10 offen offset:2048 sc1
    v_mfma_f32_16x16x32_bf16 a[232:235], a[192:195], a[104:107], a[232:235]
    s_lshl1_add_u32 m0, s36, 81920
    ds_read_b64_tr_b16 a[212:213], v9 offset:1024
    s_add_u32 s38, s34, 122880
    v_mfma_f32_16x16x32_bf16 a[248:251], a[196:199], a[104:107], a[248:251]
    s_add_u32 s57, s35, 122880
    ds_read_b64_tr_b16 a[214:215], v9 offset:7168
    s_cmp_lt_u32 s3, 2
    s_cselect_b32 s38, s38, s57
    v_mfma_f32_16x16x32_bf16 a[252:255], a[196:199], a[108:111], a[252:255]
    s_waitcnt vmcnt(8)
    ds_read_b64_tr_b16 v[112:113], v82 offset:4096
    v_lshlrev_b32 v248, 16, v200
    v_mfma_f32_16x16x32_bf16 a[236:239], a[192:195], a[108:111], a[236:239]
    s_waitcnt lgkmcnt(4)
    ds_read_b64_tr_b16 v[114:115], v82 offset:6144
    v_and_b32 v249, 0xffff0000, v200
    v_mfma_f32_16x16x32_bf16 v[92:95], a[200:203], a[108:111], v[92:95]
    ds_read_b64_tr_b16 a[192:193], v10 offset:1024
    v_sub_f32 v248, v248, v202
    v_mfma_f32_16x16x32_bf16 v[124:127], a[204:207], a[108:111], v[124:127]
    ds_read_b64_tr_b16 a[194:195], v10 offset:7168
    v_sub_f32 v249, v249, v202
    v_mfma_f32_16x16x32_bf16 v[116:119], a[204:207], a[104:107], v[116:119]
    s_bfe_u32 s88, s72, 262160
    s_cmp_lg_u32 s88, 15
    s_cbranch_scc1 spin_o4
spin_o4_ret:
    v_cvt_pk_bf16_f32 v193, v248, v249
    v_mfma_f32_16x16x32_bf16 v[84:87], a[200:203], a[104:107], v[84:87]
    buffer_load_dwordx4 v4, s[12:15], s38 offen lds
    v_mfma_f32_16x16x32_bf16 v[76:79], a[200:203], a[100:103], v[76:79]
    s_lshl1_add_u32 m0, s36, 82944
    ds_read_b64_tr_b16 a[196:197], v11 offset:1024
    v_lshlrev_b32 v248, 16, v193
    v_mfma_f32_16x16x32_bf16 v[108:111], a[204:207], a[100:103], v[108:111]
    ds_read_b64_tr_b16 a[198:199], v11 offset:7168
    v_and_b32 v249, 0xffff0000, v193
    v_mfma_f32_16x16x32_bf16 v[100:103], a[204:207], a[96:99], v[100:103]
    buffer_load_dwordx4 a[0:3], v28, s[20:23], s8 offen offset:0 sc1
    v_mfma_f32_16x16x32_bf16 v[68:71], a[200:203], a[96:99], v[68:71]
    s_waitcnt lgkmcnt(4)
    v_mul_f32 v248, v248, v203
    v_mul_f32 v249, v249, v203
    v_mfma_f32_16x16x32_bf16 v[132:135], a[208:211], a[96:99], v[132:135]
    ds_read_b64_tr_b16 a[200:201], v18 offset:2048
    v_cvt_pk_bf16_f32 v193, v248, v249
    v_mfma_f32_16x16x32_bf16 v[164:167], a[212:215], a[96:99], v[164:167]
    ds_read_b64_tr_b16 a[202:203], v18 offset:8192
    v_lshlrev_b32 v248, 16, v193
    v_mfma_f32_16x16x32_bf16 v[172:175], a[212:215], a[100:103], v[172:175]
    buffer_load_dwordx4 a[4:7], v28, s[20:23], s8 offen offset:1024 sc1
    v_mfma_f32_16x16x32_bf16 v[140:143], a[208:211], a[100:103], v[140:143]
    v_and_b32 v249, 0xffff0000, v193
    v_lshlrev_b32 v250, 16, v201
    v_mfma_f32_16x16x32_bf16 v[148:151], a[208:211], a[104:107], v[148:151]
    ds_read_b64_tr_b16 a[204:205], v19 offset:2048
    v_and_b32 v251, 0xffff0000, v201
    v_mfma_f32_16x16x32_bf16 v[180:183], a[212:215], a[104:107], v[180:183]
    ds_read_b64_tr_b16 a[206:207], v19 offset:8192
    v_sub_f32 v250, v250, v202
    v_mfma_f32_16x16x32_bf16 v[188:191], a[212:215], a[108:111], v[188:191]
    v_mfma_f32_16x16x32_bf16 v[120:123], v[88:91], v[104:107], 0
    v_mfma_f32_16x16x32_bf16 v[120:123], v[96:99], v[112:115], v[120:123]
    v_mfma_f32_16x16x32_bf16 v[156:159], a[208:211], a[108:111], v[156:159]
    s_waitcnt lgkmcnt(4)
    buffer_load_dwordx4 a[8:11], v28, s[20:23], s8 offen offset:2048 sc1
    v_mfma_f32_16x16x32_bf16 v[220:223], a[192:195], a[108:111], v[220:223]
    ds_read_b64_tr_b16 a[208:209], v8 offset:12288
    v_sub_f32 v251, v251, v202
    v_mfma_f32_16x16x32_bf16 v[252:255], a[196:199], a[108:111], v[252:255]
    ds_read_b64_tr_b16 a[210:211], v8 offset:18432
    v_cvt_pk_bf16_f32 v193, v250, v251
    v_mfma_f32_16x16x32_bf16 v[244:247], a[196:199], a[104:107], v[244:247]
    v_lshlrev_b32 v250, 16, v193
    v_and_b32 v251, 0xffff0000, v193
    v_mfma_f32_16x16x32_bf16 v[212:215], a[192:195], a[104:107], v[212:215]
    buffer_load_dwordx4 a[12:15], v28, s[20:23], s8 offen offset:3072 sc1
    v_mfma_f32_16x16x32_bf16 v[204:207], a[192:195], a[100:103], v[204:207]
    s_add_u32 s8, s8, 4096
    ds_read_b64_tr_b16 a[212:213], v9 offset:12288
    v_mul_f32 v250, v250, v203
    v_mfma_f32_16x16x32_bf16 v[236:239], a[196:199], a[100:103], v[236:239]
    ds_read_b64_tr_b16 a[214:215], v9 offset:18432
    v_mul_f32 v251, v251, v203
    v_mfma_f32_16x16x32_bf16 v[228:231], a[196:199], a[96:99], v[228:231]
    buffer_atomic_add_f32 v120, v74, s[24:27], s62 offen
    v_mfma_f32_16x16x32_bf16 v[196:199], a[192:195], a[96:99], v[196:199]
    s_waitcnt lgkmcnt(4)
    buffer_load_dwordx4 v5, s[12:15], s38 offen lds
    v_mfma_f32_16x16x32_bf16 v[32:35], a[200:203], a[96:99], v[32:35]
    s_lshl1_add_u32 m0, s36, 90112
    ds_read_b64_tr_b16 a[192:193], v10 offset:12288
    v_cvt_pk_bf16_f32 v193, v250, v251
    v_mfma_f32_16x16x32_bf16 v[48:51], a[204:207], a[96:99], v[48:51]
    s_add_u32 s38, s33, 163840
    ds_read_b64_tr_b16 a[194:195], v10 offset:18432
    v_lshlrev_b32 v250, 16, v193
    v_mfma_f32_16x16x32_bf16 v[52:55], a[204:207], a[100:103], v[52:55]
    buffer_atomic_add_f32 v121, v74, s[24:27], s62 offen offset:256
    v_mfma_f32_16x16x32_bf16 v[36:39], a[200:203], a[100:103], v[36:39]
    buffer_load_dwordx4 a[188:191], v28, s[20:23], s10 offen offset:3072 sc1
    v_mfma_f32_16x16x32_bf16 v[40:43], a[200:203], a[104:107], v[40:43]
    s_add_u32 s57, s34, 163840
    ds_read_b64_tr_b16 a[196:197], v11 offset:12288
    v_and_b32 v251, 0xffff0000, v193
    v_mfma_f32_16x16x32_bf16 v[56:59], a[204:207], a[104:107], v[56:59]
    s_waitcnt vmcnt(27)
    ds_read_b64_tr_b16 a[198:199], v11 offset:18432
    v_mul_f32 v24, v24, -v25
    v_mfma_f32_16x16x32_bf16 v[60:63], a[204:207], a[108:111], v[60:63]
    s_cmp_lt_u32 s3, 2
    s_cselect_b32 s38, s38, s57
    v_lshrrev_b32 v233, 5, v1
    v_mfma_f32_16x16x32_bf16 v[44:47], a[200:203], a[108:111], v[44:47]
    s_waitcnt lgkmcnt(4)
    v_lshlrev_b32 v233, 11, v233
    v_sub_u32 v233, 81920, v233
    v_mfma_f32_16x16x32_bf16 a[236:239], a[208:211], a[124:127], a[236:239]
    s_add_u32 s10, s10, 12288
    ds_read_b64_tr_b16 a[200:201], v8 offset:13312
    v_mov_b32 v122, 1
    v_mfma_f32_16x16x32_bf16 a[252:255], a[212:215], a[124:127], a[252:255]
    ds_read_b64_tr_b16 a[202:203], v8 offset:19456
    v_min_u32 v123, 1, v1
    v_mfma_f32_16x16x32_bf16 a[248:251], a[212:215], a[120:123], a[248:251]
    buffer_load_dwordx4 v4, s[12:15], s38 offen lds
    v_mfma_f32_16x16x32_bf16 a[232:235], a[208:211], a[120:123], a[232:235]
    s_lshl1_add_u32 m0, s36, 91136
    v_lshlrev_b32 v123, 30, v123
    v_add_u32 v8, 0, v12
    v_mfma_f32_16x16x32_bf16 a[228:231], a[208:211], a[116:119], a[228:231]
    ds_read_b64_tr_b16 a[204:205], v9 offset:13312
    v_mfma_f32_16x16x32_bf16 a[244:247], a[212:215], a[116:119], a[244:247]
    ds_read_b64_tr_b16 a[206:207], v9 offset:19456
    v_mfma_f32_16x16x32_bf16 a[240:243], a[212:215], a[112:115], a[240:243]
    buffer_load_dwordx4 v5, s[12:15], s38 offen lds
    v_mfma_f32_16x16x32_bf16 a[224:227], a[208:211], a[112:115], a[224:227]
    s_waitcnt lgkmcnt(4)
    v_add_u32 v9, 0, v13
    s_lshl1_add_u32 m0, s36, 98304
    v_mfma_f32_16x16x32_bf16 v[68:71], a[192:195], a[112:115], v[68:71]
    s_add_u32 s38, s35, 163840
    ds_read_b64_tr_b16 a[208:209], v10 offset:13312
    s_add_u32 s57, s33, 204800
    v_mfma_f32_16x16x32_bf16 v[100:103], a[196:199], a[112:115], v[100:103]
    s_cmp_lt_u32 s3, 2
    s_cselect_b32 s38, s38, s57
    ds_read_b64_tr_b16 a[210:211], v10 offset:19456
    v_mfma_f32_16x16x32_bf16 v[108:111], a[196:199], a[116:119], v[108:111]
    buffer_load_dwordx4 v4, s[12:15], s38 offen lds
    v_mfma_f32_16x16x32_bf16 v[76:79], a[192:195], a[116:119], v[76:79]
    s_lshl1_add_u32 m0, s36, 99328
    v_add_u32 v10, 0, v14
    s_load_dword s72, s[86:87], s5 offset:4 glc
    v_mfma_f32_16x16x32_bf16 v[84:87], a[192:195], a[120:123], v[84:87]
    ds_read_b64_tr_b16 a[212:213], v11 offset:13312
    v_mfma_f32_16x16x32_bf16 v[116:119], a[196:199], a[120:123], v[116:119]
    ds_read_b64_tr_b16 a[214:215], v11 offset:19456
    v_mfma_f32_16x16x32_bf16 v[124:127], a[196:199], a[124:127], v[124:127]
    buffer_load_dwordx4 v5, s[12:15], s38 offen lds
    v_mfma_f32_16x16x32_bf16 v[92:95], a[192:195], a[124:127], v[92:95]
    s_waitcnt lgkmcnt(4)
    v_add_u32 v11, 0, v15
    s_lshl1_add_u32 m0, s36, 106496
    v_mfma_f32_16x16x32_bf16 v[156:159], a[200:203], a[124:127], v[156:159]
    s_add_u32 s38, s34, 204800
    ds_read_b64_tr_b16 a[192:193], v18 offset:14336
    s_add_u32 s57, s35, 204800
    v_mfma_f32_16x16x32_bf16 v[188:191], a[204:207], a[124:127], v[188:191]
    s_cmp_lt_u32 s3, 2
    s_cselect_b32 s38, s38, s57
    ds_read_b64_tr_b16 a[194:195], v18 offset:20480
    v_mfma_f32_16x16x32_bf16 v[180:183], a[204:207], a[120:123], v[180:183]
    buffer_load_dwordx4 v4, s[12:15], s38 offen lds
    v_mfma_f32_16x16x32_bf16 v[148:151], a[200:203], a[120:123], v[148:151]
    v_xor_b32 v18, s39, v8
    v_mfma_f32_16x16x32_bf16 v[140:143], a[200:203], a[116:119], v[140:143]
    s_lshl1_add_u32 m0, s36, 107520
    ds_read_b64_tr_b16 a[196:197], v19 offset:14336
    v_add_f32 v68, -0.5, v68
    v_mfma_f32_16x16x32_bf16 v[172:175], a[204:207], a[116:119], v[172:175]
    s_waitcnt vmcnt(63)
    ds_read_b64_tr_b16 a[198:199], v19 offset:20480
    v_add_f32 v69, -0.5, v69
    v_mfma_f32_16x16x32_bf16 v[164:167], a[204:207], a[112:115], v[164:167]
    s_barrier
    v_mfma_f32_16x16x32_bf16 v[132:135], a[200:203], a[112:115], v[132:135]
    s_waitcnt lgkmcnt(4)
    buffer_load_dwordx4 a[16:19], v28, s[20:23], s9 offen offset:0 sc1
    v_mfma_f32_16x16x32_bf16 v[196:199], a[208:211], a[112:115], v[196:199]
    ds_read_b64_tr_b16 a[200:201], v8 offset:0
    v_add_f32 v70, -0.5, v70
    v_mfma_f32_16x16x32_bf16 v[228:231], a[212:215], a[112:115], v[228:231]
    ds_read_b64_tr_b16 a[202:203], v8 offset:6144
    v_add_f32 v71, -0.5, v71
    v_mfma_f32_16x16x32_bf16 v[236:239], a[212:215], a[116:119], v[236:239]
    buffer_load_dwordx4 v5, s[12:15], s38 offen lds
    v_mfma_f32_16x16x32_bf16 v[204:207], a[208:211], a[116:119], v[204:207]
    v_add_f32 v100, -0.5, v100
    v_add_f32 v101, -0.5, v101
    v_mfma_f32_16x16x32_bf16 v[212:215], a[208:211], a[120:123], v[212:215]
    ds_read_b64_tr_b16 a[204:205], v9 offset:0
    v_add_f32 v102, -0.5, v102
    v_mfma_f32_16x16x32_bf16 v[244:247], a[212:215], a[120:123], v[244:247]
    ds_read_b64_tr_b16 a[206:207], v9 offset:6144
    v_add_f32 v103, -0.5, v103
    v_mfma_f32_16x16x32_bf16 v[252:255], a[212:215], a[124:127], v[252:255]
    v_add_f32 v76, -0.5, v76
    v_add_f32 v77, -0.5, v77
    v_mfma_f32_16x16x32_bf16 v[220:223], a[208:211], a[124:127], v[220:223]
    s_waitcnt lgkmcnt(4)
    buffer_load_dwordx4 a[20:23], v28, s[20:23], s9 offen offset:1024 sc1
    v_mfma_f32_16x16x32_bf16 v[44:47], a[192:195], a[124:127], v[44:47]
    ds_read_b64_tr_b16 a[208:209], v10 offset:0
    v_add_f32 v78, -0.5, v78
    v_mfma_f32_16x16x32_bf16 v[60:63], a[196:199], a[124:127], v[60:63]
    ds_read_b64_tr_b16 a[210:211], v10 offset:6144
    v_add_f32 v79, -0.5, v79
    v_mfma_f32_16x16x32_bf16 v[56:59], a[196:199], a[120:123], v[56:59]
    v_add_f32 v108, -0.5, v108
    v_add_f32 v109, -0.5, v109
    v_mfma_f32_16x16x32_bf16 v[40:43], a[192:195], a[120:123], v[40:43]
    buffer_load_dwordx4 a[24:27], v28, s[20:23], s9 offen offset:2048 sc1
    v_mfma_f32_16x16x32_bf16 v[36:39], a[192:195], a[116:119], v[36:39]
    ds_read_b64_tr_b16 a[212:213], v11 offset:0
    v_add_f32 v110, -0.5, v110
    v_mfma_f32_16x16x32_bf16 v[52:55], a[196:199], a[116:119], v[52:55]
    s_waitcnt vmcnt(32)
    ds_read_b64_tr_b16 a[214:215], v11 offset:6144
    v_add_f32 v111, -0.5, v111
    v_mfma_f32_16x16x32_bf16 v[48:51], a[196:199], a[112:115], v[48:51]
    v_add_f32 v84, -0.5, v84
    v_add_f32 v85, -0.5, v85
    v_mfma_f32_16x16x32_bf16 v[32:35], a[192:195], a[112:115], v[32:35]
pg_11:
    s_cbranch_execz pg_ret2
    s_waitcnt lgkmcnt(4)
    buffer_load_dwordx4 a[28:31], v28, s[20:23], s9 offen offset:3072 sc1
    v_mfma_f32_16x16x32_bf16 a[224:227], a[200:203], a[128:131], a[224:227]
    s_add_u32 s9, s9, 4096
    ds_read_b64_tr_b16 a[192:193], v8 offset:1024
    v_add_f32 v86, -0.5, v86
    v_mfma_f32_16x16x32_bf16 a[240:243], a[204:207], a[128:131], a[240:243]
    ds_read_b64_tr_b16 a[194:195], v8 offset:7168
    v_add_f32 v87, -0.5, v87
    v_mfma_f32_16x16x32_bf16 a[244:247], a[204:207], a[132:135], a[244:247]
    s_bfe_u32 s88, s72, 262164
    s_cmp_lg_u32 s88, 15
    s_cbranch_scc1 spin_o5
spin_o5_ret:
    v_add_f32 v116, -0.5, v116
    v_mfma_f32_16x16x32_bf16 a[228:231], a[200:203], a[132:135], a[228:231]
    buffer_load_dwordx4 a[32:35], v28, s[20:23], s10 offen offset:0 sc1
    v_mfma_f32_16x16x32_bf16 a[232:235], a[200:203], a[136:139], a[232:235]
    ds_read_b64_tr_b16 a[196:197], v9 offset:1024
    v_add_f32 v117, -0.5, v117
    v_mfma_f32_16x16x32_bf16 a[248:251], a[204:207], a[136:139], a[248:251]
    ds_read_b64_tr_b16 a[198:199], v9 offset:7168
    v_add_f32 v118, -0.5, v118
    v_add_f32 v119, -0.5, v119
    v_add_f32 v92, -0.5, v92
    v_add_f32 v93, -0.5, v93
    v_add_f32 v94, -0.5, v94
    v_add_f32 v95, -0.5, v95
    v_add_f32 v124, -0.5, v124
    v_add_f32 v125, -0.5, v125
    v_add_f32 v126, -0.5, v126
    v_add_f32 v127, -0.5, v127
    v_mfma_f32_16x16x32_bf16 a[252:255], a[204:207], a[140:143], a[252:255]
    v_xor_b32 v19, s39, v9
    v_mfma_f32_16x16x32_bf16 a[236:239], a[200:203], a[140:143], a[236:239]
    s_waitcnt lgkmcnt(4)
    v_mfma_f32_16x16x32_bf16 v[92:95], a[208:211], a[140:143], v[92:95]
    ds_read_b64_tr_b16 a[200:201], v10 offset:1024
    v_mfma_f32_16x16x32_bf16 v[124:127], a[212:215], a[140:143], v[124:127]
    ds_read_b64_tr_b16 a[202:203], v10 offset:7168
    v_mfma_f32_16x16x32_bf16 v[116:119], a[212:215], a[136:139], v[116:119]
    buffer_load_dwordx4 a[48:51], v28, s[20:23], s8 offen offset:0 sc1
    v_mfma_f32_16x16x32_bf16 v[84:87], a[208:211], a[136:139], v[84:87]
    v_mfma_f32_16x16x32_bf16 v[76:79], a[208:211], a[132:135], v[76:79]
    ds_read_b64_tr_b16 a[204:205], v11 offset:1024
    v_mfma_f32_16x16x32_bf16 v[108:111], a[212:215], a[132:135], v[108:111]
    ds_read_b64_tr_b16 a[206:207], v11 offset:7168
    v_mfma_f32_16x16x32_bf16 v[100:103], a[212:215], a[128:131], v[100:103]
    buffer_load_dwordx4 a[52:55], v28, s[20:23], s8 offen offset:1024 sc1
    v_mfma_f32_16x16x32_bf16 v[68:71], a[208:211], a[128:131], v[68:71]
    s_waitcnt lgkmcnt(4)
    v_mfma_f32_16x16x32_bf16 v[132:135], a[192:195], a[128:131], v[132:135]
    ds_read_b64_tr_b16 a[208:209], v18 offset:2048
    v_mfma_f32_16x16x32_bf16 v[164:167], a[196:199], a[128:131], v[164:167]
    ds_read_b64_tr_b16 a[210:211], v18 offset:8192
    v_mfma_f32_16x16x32_bf16 v[172:175], a[196:199], a[132:135], v[172:175]
    buffer_load_dwordx4 a[56:59], v28, s[20:23], s8 offen offset:2048 sc1
    v_mfma_f32_16x16x32_bf16 v[140:143], a[192:195], a[132:135], v[140:143]
    v_mfma_f32_16x16x32_bf16 v[148:151], a[192:195], a[136:139], v[148:151]
    ds_read_b64_tr_b16 a[212:213], v19 offset:2048
    v_mfma_f32_16x16x32_bf16 v[180:183], a[196:199], a[136:139], v[180:183]
    ds_read_b64_tr_b16 a[214:215], v19 offset:8192
    v_mfma_f32_16x16x32_bf16 v[188:191], a[196:199], a[140:143], v[188:191]
    buffer_load_dwordx4 a[60:63], v28, s[20:23], s8 offen offset:3072 sc1
    v_mfma_f32_16x16x32_bf16 v[156:159], a[192:195], a[140:143], v[156:159]
    s_waitcnt lgkmcnt(4)
    s_add_u32 s8, s8, 12288
    v_mfma_f32_16x16x32_bf16 v[220:223], a[200:203], a[140:143], v[220:223]
    ds_read_b64_tr_b16 a[192:193], v8 offset:12288
    v_mfma_f32_16x16x32_bf16 v[252:255], a[204:207], a[140:143], v[252:255]
    ds_read_b64_tr_b16 a[194:195], v8 offset:18432
    v_mfma_f32_16x16x32_bf16 v[244:247], a[204:207], a[136:139], v[244:247]
    buffer_load_dwordx4 a[36:39], v28, s[20:23], s10 offen offset:1024 sc1
    v_mfma_f32_16x16x32_bf16 v[212:215], a[200:203], a[136:139], v[212:215]
    v_mfma_f32_16x16x32_bf16 v[204:207], a[200:203], a[132:135], v[204:207]
    ds_read_b64_tr_b16 a[196:197], v9 offset:12288
    v_mfma_f32_16x16x32_bf16 v[236:239], a[204:207], a[132:135], v[236:239]
    ds_read_b64_tr_b16 a[198:199], v9 offset:18432
    v_mfma_f32_16x16x32_bf16 v[228:231], a[204:207], a[128:131], v[228:231]
    buffer_load_dwordx4 a[40:43], v28, s[20:23], s10 offen offset:2048 sc1
    v_mfma_f32_16x16x32_bf16 v[196:199], a[200:203], a[128:131], v[196:199]
    s_waitcnt lgkmcnt(4)
    v_mfma_f32_16x16x32_bf16 v[32:35], a[208:211], a[128:131], v[32:35]
    s_waitcnt vmcnt(18)
    ds_read_b64_tr_b16 a[200:201], v10 offset:12288
    v_mfma_f32_16x16x32_bf16 v[48:51], a[212:215], a[128:131], v[48:51]
    ds_read_b64_tr_b16 a[202:203], v10 offset:18432
    v_mfma_f32_16x16x32_bf16 v[52:55], a[212:215], a[132:135], v[52:55]
    buffer_atomic_add v122, v123, s[24:27], s62 offen offset:128
    v_mfma_f32_16x16x32_bf16 v[36:39], a[208:211], a[132:135], v[36:39]
    buffer_load_dwordx4 a[44:47], v28, s[20:23], s10 offen offset:3072 sc1
    v_mfma_f32_16x16x32_bf16 v[40:43], a[208:211], a[136:139], v[40:43]
    s_add_u32 s10, s10, 4096
    ds_read_b64_tr_b16 a[204:205], v11 offset:12288
    v_mfma_f32_16x16x32_bf16 v[56:59], a[212:215], a[136:139], v[56:59]
    s_waitcnt vmcnt(35)
    ds_read_b64_tr_b16 a[206:207], v11 offset:18432
    v_mfma_f32_16x16x32_bf16 v[60:63], a[212:215], a[140:143], v[60:63]
    v_mfma_f32_16x16x32_bf16 v[44:47], a[208:211], a[140:143], v[44:47]
    s_waitcnt lgkmcnt(4)
    buffer_load_dwordx4 a[64:67], v28, s[20:23], s9 offen offset:0 sc1
    v_mfma_f32_16x16x32_bf16 a[236:239], a[192:195], a[156:159], a[236:239]
    ds_read_b64_tr_b16 a[208:209], v8 offset:13312
    v_mfma_f32_16x16x32_bf16 a[252:255], a[196:199], a[156:159], a[252:255]
    ds_read_b64_tr_b16 a[210:211], v8 offset:19456
    v_mfma_f32_16x16x32_bf16 a[248:251], a[196:199], a[152:155], a[248:251]
    v_add_u32 v8, v233, v12
    v_mfma_f32_16x16x32_bf16 a[232:235], a[192:195], a[152:155], a[232:235]
    buffer_load_dwordx4 a[68:71], v28, s[20:23], s9 offen offset:1024 sc1
    v_mfma_f32_16x16x32_bf16 a[228:231], a[192:195], a[148:151], a[228:231]
    s_lshl_b32 s77, s3, 1
    s_add_u32 s77, s77, 0
    s_cmp_eq_u32 s77, s53
    s_cselect_b32 s77, 0x7ffffff0, 0
    ds_read_b64_tr_b16 a[212:213], v9 offset:13312
    v_mfma_f32_16x16x32_bf16 a[244:247], a[196:199], a[148:151], a[244:247]
    ds_read_b64_tr_b16 a[214:215], v9 offset:19456
    v_or_b32 v6, s77, v28
    v_mfma_f32_16x16x32_bf16 a[240:243], a[196:199], a[144:147], a[240:243]
    s_lshl_b32 s77, s3, 1
    s_add_u32 s77, s77, 1
    s_cmp_eq_u32 s77, s53
    s_cselect_b32 s77, 0x7ffffff0, 0
    v_mfma_f32_16x16x32_bf16 a[224:227], a[192:195], a[144:147], a[224:227]
    s_waitcnt lgkmcnt(4)
    buffer_load_dwordx4 a[72:75], v28, s[20:23], s9 offen offset:2048 sc1
    v_mfma_f32_16x16x32_bf16 v[68:71], a[200:203], a[144:147], v[68:71]
    ds_read_b64_tr_b16 a[192:193], v10 offset:13312
    v_or_b32 v7, s77, v28
    v_mfma_f32_16x16x32_bf16 v[100:103], a[204:207], a[144:147], v[100:103]
    ds_read_b64_tr_b16 a[194:195], v10 offset:19456
    v_add_u32 v9, v233, v13
    v_mfma_f32_16x16x32_bf16 v[108:111], a[204:207], a[148:151], v[108:111]
    v_add_u32 v10, v233, v14
    v_mfma_f32_16x16x32_bf16 v[76:79], a[200:203], a[148:151], v[76:79]
    buffer_load_dwordx4 a[76:79], v28, s[20:23], s9 offen offset:3072 sc1
    v_mfma_f32_16x16x32_bf16 v[84:87], a[200:203], a[152:155], v[84:87]
    s_lshl1_add_u32 m0, s36, 114688
    ds_read_b64_tr_b16 a[196:197], v11 offset:13312
    s_add_u32 s38, s34, 123008
    v_mfma_f32_16x16x32_bf16 v[116:119], a[204:207], a[152:155], v[116:119]
    s_add_u32 s57, s35, 123008
    ds_read_b64_tr_b16 a[198:199], v11 offset:19456
    s_cmp_lt_u32 s3, 2
    s_cselect_b32 s38, s38, s57
    v_mfma_f32_16x16x32_bf16 v[124:127], a[204:207], a[156:159], v[124:127]
    s_add_u32 s9, s9, 12288
    v_add_u32 v11, v233, v15
    v_mfma_f32_16x16x32_bf16 v[92:95], a[200:203], a[156:159], v[92:95]
    s_waitcnt lgkmcnt(4)
    v_mfma_f32_16x16x32_bf16 v[156:159], a[208:211], a[156:159], v[156:159]
    ds_read_b64_tr_b16 a[200:201], v18 offset:14336
    v_mfma_f32_16x16x32_bf16 v[188:191], a[212:215], a[156:159], v[188:191]
    ds_read_b64_tr_b16 a[202:203], v18 offset:20480
    v_mfma_f32_16x16x32_bf16 v[180:183], a[212:215], a[152:155], v[180:183]
    buffer_load_dwordx4 a[80:83], v28, s[20:23], s10 offen offset:0 sc1
    v_mfma_f32_16x16x32_bf16 v[148:151], a[208:211], a[152:155], v[148:151]
    v_mfma_f32_16x16x32_bf16 v[140:143], a[208:211], a[148:151], v[140:143]
    ds_read_b64_tr_b16 a[204:205], v19 offset:14336
    v_mfma_f32_16x16x32_bf16 v[172:175], a[212:215], a[148:151], v[172:175]
    s_waitcnt vmcnt(17)
    ds_read_b64_tr_b16 a[206:207], v19 offset:20480
    v_mfma_f32_16x16x32_bf16 v[164:167], a[212:215], a[144:147], v[164:167]
    s_barrier
    v_mfma_f32_16x16x32_bf16 v[132:135], a[208:211], a[144:147], v[132:135]
    s_waitcnt lgkmcnt(4)
    buffer_load_dwordx4 a[84:87], v28, s[20:23], s10 offen offset:1024 sc1
    v_mfma_f32_16x16x32_bf16 v[196:199], a[192:195], a[144:147], v[196:199]
    ds_read_b64_tr_b16 a[208:209], v8 offset:0
    v_lshrrev_b32 v2, 2, v1
    v_mfma_f32_16x16x32_bf16 v[228:231], a[196:199], a[144:147], v[228:231]
    ds_read_b64_tr_b16 a[210:211], v8 offset:2048
    v_lshlrev_b32 v18, 6, v2
    v_mfma_f32_16x16x32_bf16 v[236:239], a[196:199], a[148:151], v[236:239]
    buffer_load_dwordx4 a[88:91], v28, s[20:23], s10 offen offset:2048 sc1
    v_mfma_f32_16x16x32_bf16 v[204:207], a[192:195], a[148:151], v[204:207]
    v_mul_u32_u24 v2, 1280, v2
    v_and_b32 v19, 3, v1
    v_mfma_f32_16x16x32_bf16 v[212:215], a[192:195], a[152:155], v[212:215]
    ds_read_b64_tr_b16 a[212:213], v9 offset:0
    v_lshl_add_u32 v18, v19, 3, v18
    v_mfma_f32_16x16x32_bf16 v[244:247], a[196:199], a[152:155], v[244:247]
    ds_read_b64_tr_b16 a[214:215], v9 offset:2048
    v_lshl_add_u32 v2, v19, 4, v2
    v_mfma_f32_16x16x32_bf16 v[252:255], a[196:199], a[156:159], v[252:255]
    buffer_load_dwordx4 a[92:95], v28, s[20:23], s10 offen offset:3072 sc1
    v_mfma_f32_16x16x32_bf16 v[220:223], a[192:195], a[156:159], v[220:223]
    s_waitcnt lgkmcnt(4)
    v_and_b32 v19, 16, v1
    v_lshlrev_b32 v19, 1, v19
    v_mfma_f32_16x16x32_bf16 v[44:47], a[200:203], a[156:159], v[44:47]
    s_add_u32 s10, s10, 12288
    ds_read_b64_tr_b16 a[192:193], v8 offset:4096
    v_xor_b32 v2, v2, v19
    v_mfma_f32_16x16x32_bf16 v[60:63], a[204:207], a[156:159], v[60:63]
    ds_read_b64_tr_b16 a[194:195], v8 offset:6144
    v_or_b32 v18, v18, v19
    v_mfma_f32_16x16x32_bf16 v[56:59], a[204:207], a[152:155], v[56:59]
    buffer_load_dwordx4 v4, s[12:15], s38 offen lds
    v_mfma_f32_16x16x32_bf16 v[40:43], a[200:203], a[152:155], v[40:43]
    s_lshl1_add_u32 m0, s36, 115712
    v_xor_b32 v19, 32, v18
    v_add_u32 v2, s39, v2
    v_mfma_f32_16x16x32_bf16 v[36:39], a[200:203], a[148:151], v[36:39]
    s_and_b32 s56, s70, 0x7ff
    ds_read_b64_tr_b16 a[196:197], v9 offset:4096
    v_add_u32 v2, s63, v2
    v_mfma_f32_16x16x32_bf16 v[52:55], a[204:207], a[148:151], v[52:55]
    s_waitcnt vmcnt(40)
    ds_read_b64_tr_b16 a[198:199], v9 offset:6144
    v_add_u32 v18, 147456, v18
    v_mfma_f32_16x16x32_bf16 v[48:51], a[204:207], a[144:147], v[48:51]
    s_sub_u32 s56, 2047, s56
    v_add_u32 v19, 147456, v19
    v_cmp_eq_u32 s[78:79], s56, v20
    v_mfma_f32_16x16x32_bf16 v[32:35], a[200:203], a[144:147], v[32:35]
    s_waitcnt lgkmcnt(4)
    buffer_load_dwordx4 v5, s[12:15], s38 offen lds
    v_mfma_f32_16x16x32_bf16 a[224:227], a[208:211], a[160:163], a[224:227]
    s_lshl1_add_u32 m0, s36, 122880
    ds_read_b64_tr_b16 a[200:201], v8 offset:8192
    v_add_f32 v132, -0.5, v132
    v_mfma_f32_16x16x32_bf16 a[240:243], a[212:215], a[160:163], a[240:243]
    s_add_u32 s38, s33, 163968
    ds_read_b64_tr_b16 a[202:203], v8 offset:10240
    v_add_f32 v133, -0.5, v133
    v_mfma_f32_16x16x32_bf16 a[244:247], a[212:215], a[164:167], a[244:247]
    s_add_u32 s57, s34, 163968
    v_add_f32 v134, -0.5, v134
    v_add_f32 v135, -0.5, v135
    v_mfma_f32_16x16x32_bf16 a[228:231], a[208:211], a[164:167], a[228:231]
    s_cmp_lt_u32 s3, 2
    s_cselect_b32 s38, s38, s57
    v_add_f32 v164, -0.5, v164
    v_mfma_f32_16x16x32_bf16 a[232:235], a[208:211], a[168:171], a[232:235]
    s_and_b32 s56, s71, 0x7ff
    ds_read_b64_tr_b16 a[204:205], v9 offset:8192
    v_add_f32 v165, -0.5, v165
    v_mfma_f32_16x16x32_bf16 a[248:251], a[212:215], a[168:171], a[248:251]
    s_waitcnt vmcnt(29)
    ds_read_b64_tr_b16 a[206:207], v9 offset:10240
    v_add_f32 v166, -0.5, v166
    v_mfma_f32_16x16x32_bf16 a[252:255], a[212:215], a[172:175], a[252:255]
    buffer_load_dwordx4 v4, s[12:15], s38 offen lds
    v_mfma_f32_16x16x32_bf16 a[236:239], a[208:211], a[172:175], a[236:239]
    s_waitcnt lgkmcnt(4)
    v_add_f32 v167, -0.5, v167
    v_add_f32 v140, -0.5, v140
    v_mfma_f32_16x16x32_bf16 a[236:239], a[192:195], a[188:191], a[236:239]
    s_lshl1_add_u32 m0, s36, 123904
    ds_read_b64_tr_b16 a[208:209], v8 offset:12288
    v_add_f32 v141, -0.5, v141
    v_mfma_f32_16x16x32_bf16 a[252:255], a[196:199], a[188:191], a[252:255]
    s_sub_u32 s56, 2047, s56
    ds_read_b64_tr_b16 a[210:211], v8 offset:14336
    v_cmp_eq_u32 s[80:81], s56, v20
    v_mfma_f32_16x16x32_bf16 a[248:251], a[196:199], a[184:187], a[248:251]
    buffer_load_dwordx4 v5, s[12:15], s38 offen lds
    v_mfma_f32_16x16x32_bf16 a[232:235], a[192:195], a[184:187], a[232:235]
    s_lshl1_add_u32 m0, s36, 131072
    v_add_f32 v142, -0.5, v142
    v_add_f32 v143, -0.5, v143
    v_mfma_f32_16x16x32_bf16 a[228:231], a[192:195], a[180:183], a[228:231]
    s_add_u32 s38, s35, 163968
    ds_read_b64_tr_b16 a[212:213], v9 offset:12288
    v_add_f32 v172, -0.5, v172
    v_mfma_f32_16x16x32_bf16 a[244:247], a[196:199], a[180:183], a[244:247]
    s_waitcnt vmcnt(35)
    ds_read_b64_tr_b16 a[214:215], v9 offset:14336
    v_add_f32 v173, -0.5, v173
    v_mfma_f32_16x16x32_bf16 a[240:243], a[196:199], a[176:179], a[240:243]
    s_add_u32 s57, s33, 204928
    v_add_f32 v174, -0.5, v174
    v_add_f32 v175, -0.5, v175
    v_mfma_f32_16x16x32_bf16 a[224:227], a[192:195], a[176:179], a[224:227]
    s_waitcnt lgkmcnt(4)
    v_add_f32 v148, -0.5, v148
    v_add_f32 v149, -0.5, v149
    v_mfma_f32_16x16x32_bf16 a[224:227], a[200:203], a[0:3], a[224:227]
    s_cmp_lt_u32 s3, 2
    s_cselect_b32 s38, s38, s57
    ds_read_b64_tr_b16 a[192:193], v8 offset:16384
    v_mfma_f32_16x16x32_bf16 a[240:243], a[204:207], a[0:3], a[240:243]
    s_cmp_ge_u32 s3, 2
    s_cselect_b32 s68, 0, 0xff00
    s_lshl_b32 s69, 0x10101, s53
    s_or_b32 s68, s68, s69
    s_sub_u32 s48, s48, s47
    ds_read_b64_tr_b16 a[194:195], v8 offset:18432
    v_mfma_f32_16x16x32_bf16 a[244:247], a[204:207], a[4:7], a[244:247]
    buffer_load_dwordx4 v4, s[12:15], s38 offen lds
    v_mfma_f32_16x16x32_bf16 a[228:231], a[200:203], a[4:7], a[228:231]
    s_lshl1_add_u32 m0, s36, 132096
    v_bfe_u32 v12, v1, 3, 2
    v_mul_u32_u24 v23, s48, v12
    v_mfma_f32_16x16x32_bf16 a[232:235], a[200:203], a[8:11], a[232:235]
    ds_read_b64_tr_b16 a[196:197], v9 offset:16384
    v_add_u32 v23, s47, v23
    v_mfma_f32_16x16x32_bf16 a[248:251], a[204:207], a[8:11], a[248:251]
    s_waitcnt vmcnt(22)
    ds_read_b64_tr_b16 a[198:199], v9 offset:18432
    v_and_b32 v12, 7, v1
    v_mfma_f32_16x16x32_bf16 a[252:255], a[204:207], a[12:15], a[252:255]
    buffer_load_dwordx4 v5, s[12:15], s38 offen lds
    v_mfma_f32_16x16x32_bf16 a[236:239], a[200:203], a[12:15], a[236:239]
    s_waitcnt lgkmcnt(4)
    v_mul_u32_u24 v13, 8389632, v12
    v_xor_b32 v23, v23, v13
    v_mfma_f32_16x16x32_bf16 a[236:239], a[208:211], a[28:31], a[236:239]
    s_lshl1_add_u32 m0, s36, 139264
    ds_read_b64_tr_b16 a[200:201], v8 offset:20480
    v_lshrrev_b32 v13, v12, s93
    v_mfma_f32_16x16x32_bf16 a[252:255], a[212:215], a[28:31], a[252:255]
    s_add_u32 s38, s34, 204928
    ds_read_b64_tr_b16 a[202:203], v8 offset:22528
    v_and_b32 v13, 0x2000, v13
    v_mfma_f32_16x16x32_bf16 a[248:251], a[212:215], a[24:27], a[248:251]
    s_add_u32 s57, s35, 204928
    v_xor_b32 v23, v23, v13
    v_add_f32 v150, -0.5, v150
    v_mfma_f32_16x16x32_bf16 a[232:235], a[208:211], a[24:27], a[232:235]
    s_cmp_lt_u32 s3, 2
    s_cselect_b32 s38, s38, s57
    v_add_f32 v151, -0.5, v151
    v_mfma_f32_16x16x32_bf16 a[228:231], a[208:211], a[20:23], a[228:231]
    s_lshr_b32 s56, s2, 4
    ds_read_b64_tr_b16 a[204:205], v9 offset:20480
    v_add_f32 v180, -0.5, v180
    v_mfma_f32_16x16x32_bf16 a[244:247], a[212:215], a[20:23], a[244:247]
    s_waitcnt vmcnt(14)
    ds_read_b64_tr_b16 a[206:207], v9 offset:22528
    v_add_f32 v181, -0.5, v181
    v_mfma_f32_16x16x32_bf16 a[240:243], a[212:215], a[16:19], a[240:243]
    buffer_load_dwordx4 v4, s[12:15], s38 offen lds
    v_mfma_f32_16x16x32_bf16 a[224:227], a[208:211], a[16:19], a[224:227]
    s_waitcnt lgkmcnt(4)
    v_add_f32 v182, -0.5, v182
    v_add_f32 v183, -0.5, v183
    v_mfma_f32_16x16x32_bf16 a[224:227], a[192:195], a[32:35], a[224:227]
    s_lshl1_add_u32 m0, s36, 140288
    ds_read_b64_tr_b16 a[208:209], v8 offset:24576
    v_add_f32 v156, -0.5, v156
    v_mfma_f32_16x16x32_bf16 a[240:243], a[196:199], a[32:35], a[240:243]
    s_lshl_b32 s56, s56, 14
    ds_read_b64_tr_b16 a[210:211], v8 offset:26624
    v_add_f32 v157, -0.5, v157
    v_mfma_f32_16x16x32_bf16 a[244:247], a[196:199], a[36:39], a[244:247]
    buffer_load_dwordx4 v5, s[12:15], s38 offen lds
    v_mfma_f32_16x16x32_bf16 a[228:231], a[192:195], a[36:39], a[228:231]
    s_and_b32 s46, s2, 8
    v_add_f32 v158, -0.5, v158
    v_add_f32 v159, -0.5, v159
    v_mfma_f32_16x16x32_bf16 a[232:235], a[192:195], a[40:43], a[232:235]
    s_lshl_b32 s46, s46, 9
    ds_read_b64_tr_b16 a[212:213], v9 offset:24576
    v_add_f32 v188, -0.5, v188
    v_mfma_f32_16x16x32_bf16 a[248:251], a[196:199], a[40:43], a[248:251]
    s_waitcnt vmcnt(20)
    ds_read_b64_tr_b16 a[214:215], v9 offset:26624
    v_add_f32 v189, -0.5, v189
    v_mfma_f32_16x16x32_bf16 a[252:255], a[196:199], a[44:47], a[252:255]
    buffer_load_dwordx4 v[144:147], v22, s[16:19], s41 offen
    v_mfma_f32_16x16x32_bf16 a[236:239], a[192:195], a[44:47], a[236:239]
    s_waitcnt lgkmcnt(4)
    v_add_f32 v190, -0.5, v190
    v_add_f32 v191, -0.5, v191
    v_mfma_f32_16x16x32_bf16 a[236:239], a[200:203], a[60:63], a[236:239]
    s_add_u32 s56, s56, s46
    ds_read_b64_tr_b16 a[192:193], v8 offset:28672
    v_add_f32 v196, -0.5, v196
    v_mfma_f32_16x16x32_bf16 a[252:255], a[204:207], a[60:63], a[252:255]
    s_add_u32 s56, s56, 4456448
    ds_read_b64_tr_b16 a[194:195], v8 offset:30720
    v_add_f32 v197, -0.5, v197
    v_mfma_f32_16x16x32_bf16 a[248:251], a[204:207], a[56:59], a[248:251]
    buffer_load_dwordx4 v[152:155], v22, s[16:19], s66 offen
    v_mfma_f32_16x16x32_bf16 a[232:235], a[200:203], a[56:59], a[232:235]
    s_lshl_b32 s46, s3, 1
    v_bfe_u32 v12, v1, 1, 1
    v_add_u32 v12, s46, v12
    v_mfma_f32_16x16x32_bf16 a[228:231], a[200:203], a[52:55], a[228:231]
    ds_read_b64_tr_b16 a[196:197], v9 offset:28672
    v_lshrrev_b32 v3, v12, s93
    v_mfma_f32_16x16x32_bf16 a[244:247], a[204:207], a[52:55], a[244:247]
    s_waitcnt vmcnt(14)
    ds_read_b64_tr_b16 a[198:199], v9 offset:30720
    v_and_b32 v3, 0x2000, v3
    v_mfma_f32_16x16x32_bf16 a[240:243], a[204:207], a[48:51], a[240:243]
    buffer_load_dwordx4 v[160:163], v22, s[16:19], s43 offen
    v_mfma_f32_16x16x32_bf16 a[224:227], a[200:203], a[48:51], a[224:227]
    s_waitcnt lgkmcnt(4)
    v_lshl_add_u32 v3, v12, 9, v3
    v_add_u32 v3, s56, v3
    v_mfma_f32_16x16x32_bf16 a[224:227], a[208:211], a[64:67], a[224:227]
    ds_read_b64_tr_b16 a[200:201], v10 offset:0
    v_and_b32 v12, 1, v1
    v_mfma_f32_16x16x32_bf16 a[240:243], a[212:215], a[64:67], a[240:243]
    ds_read_b64_tr_b16 a[202:203], v10 offset:2048
    v_lshl_add_u32 v3, v12, 7, v3
    v_mfma_f32_16x16x32_bf16 a[244:247], a[212:215], a[68:71], a[244:247]
    v_lshrrev_b32 v12, 2, v1
    v_min_u32 v12, 1, v12
    v_mfma_f32_16x16x32_bf16 a[228:231], a[208:211], a[68:71], a[228:231]
    v_lshl_or_b32 v3, v12, 30, v3
    v_add_f32 v198, -0.5, v198
    v_mfma_f32_16x16x32_bf16 a[232:235], a[208:211], a[72:75], a[232:235]
    s_lshl_b32 s56, 1, s53
    ds_read_b64_tr_b16 a[204:205], v11 offset:0
    v_mov_b32 v128, s56
    v_mfma_f32_16x16x32_bf16 a[248:251], a[212:215], a[72:75], a[248:251]
    s_waitcnt vmcnt(11)
    ds_read_b64_tr_b16 a[206:207], v11 offset:2048
    v_lshlrev_b32 v129, 8, v128
    v_mfma_f32_16x16x32_bf16 a[252:255], a[212:215], a[76:79], a[252:255]
    v_lshlrev_b32 v130, 16, v128
    v_or_b32 v131, v129, v130
    v_mfma_f32_16x16x32_bf16 a[236:239], a[208:211], a[76:79], a[236:239]
    s_waitcnt lgkmcnt(4)
    v_add_f32 v199, -0.5, v199
    v_add_f32 v228, -0.5, v228
    v_mfma_f32_16x16x32_bf16 a[236:239], a[192:195], a[92:95], a[236:239]
    s_mov_b32 s67, 0
    ds_read_b64_tr_b16 a[208:209], v10 offset:4096
    v_add_f32 v229, -0.5, v229
    v_mfma_f32_16x16x32_bf16 a[252:255], a[196:199], a[92:95], a[252:255]
    s_lshl_b32 s37, s3, 2
    ds_read_b64_tr_b16 a[210:211], v10 offset:6144
    v_add_f32 v230, -0.5, v230
    v_mfma_f32_16x16x32_bf16 a[248:251], a[196:199], a[88:91], a[248:251]
    s_lshr_b32 s37, 0x7410, s37
    v_add_f32 v231, -0.5, v231
    v_add_f32 v204, -0.5, v204
    v_mfma_f32_16x16x32_bf16 a[232:235], a[192:195], a[88:91], a[232:235]
    s_and_b32 s37, s37, 7
    v_add_f32 v205, -0.5, v205
    v_add_f32 v206, -0.5, v206
    v_mfma_f32_16x16x32_bf16 a[228:231], a[192:195], a[84:87], a[228:231]
    s_lshl_b32 s37, s37, 13
    ds_read_b64_tr_b16 a[212:213], v11 offset:4096
    v_add_f32 v207, -0.5, v207
    v_mfma_f32_16x16x32_bf16 a[244:247], a[196:199], a[84:87], a[244:247]
    s_lshl_b32 s56, s3, 9
    ds_read_b64_tr_b16 a[214:215], v11 offset:6144
    v_add_f32 v236, -0.5, v236
    v_mfma_f32_16x16x32_bf16 a[240:243], a[196:199], a[80:83], a[240:243]
    s_add_u32 s56, s56, 159744
    v_lshlrev_b32 v138, 3, v1
    v_add_u32 v138, s56, v138
    v_mfma_f32_16x16x32_bf16 a[224:227], a[192:195], a[80:83], a[224:227]
    s_waitcnt lgkmcnt(4)
    v_mov_b32 v139, 256
    v_cndmask_b32 v139, 0, v139, s[80:81]
    v_mfma_f32_16x16x32_bf16 v[68:71], a[200:203], a[160:163], v[68:71]
    ds_read_b64_tr_b16 a[192:193], v10 offset:8192
    v_lshl_add_u32 v139, v21, 4, v139
    v_mfma_f32_16x16x32_bf16 v[100:103], a[204:207], a[160:163], v[100:103]
    ds_read_b64_tr_b16 a[194:195], v10 offset:10240
    v_add_u32 v139, s56, v139
    v_mfma_f32_16x16x32_bf16 v[108:111], a[204:207], a[164:167], v[108:111]
    s_mov_b32 s59, 3670016
    v_and_b32 v14, 15, v1
    v_lshl_add_u32 v14, s3, 4, v14
    v_mfma_f32_16x16x32_bf16 v[76:79], a[200:203], a[164:167], v[76:79]
    s_or_b64 s[88:89], s[78:79], s[80:81]
    s_cselect_b32 s59, s59, 0x70000000
    v_lshlrev_b32 v14, 6, v14
    v_mfma_f32_16x16x32_bf16 v[84:87], a[200:203], a[168:171], v[84:87]
    ds_read_b64_tr_b16 a[196:197], v11 offset:8192
    v_add_f32 v237, -0.5, v237
    v_mfma_f32_16x16x32_bf16 v[116:119], a[204:207], a[168:171], v[116:119]
    ds_read_b64_tr_b16 a[198:199], v11 offset:10240
    v_add_f32 v238, -0.5, v238
    v_mfma_f32_16x16x32_bf16 v[124:127], a[204:207], a[172:175], v[124:127]
    v_accvgpr_read_b32 v64, a224
    v_accvgpr_read_b32 v65, a225
    v_mfma_f32_16x16x32_bf16 v[92:95], a[200:203], a[172:175], v[92:95]
    s_waitcnt lgkmcnt(4)
    v_accvgpr_read_b32 v66, a226
    v_accvgpr_read_b32 v67, a227
    v_mfma_f32_16x16x32_bf16 v[92:95], a[208:211], a[188:191], v[92:95]
    ds_read_b64_tr_b16 a[200:201], v10 offset:12288
    v_accvgpr_read_b32 v72, a240
    v_mfma_f32_16x16x32_bf16 v[124:127], a[212:215], a[188:191], v[124:127]
    ds_read_b64_tr_b16 a[202:203], v10 offset:14336
    v_accvgpr_read_b32 v73, a241
    v_mfma_f32_16x16x32_bf16 v[116:119], a[212:215], a[184:187], v[116:119]
    v_accvgpr_read_b32 v74, a242
    v_accvgpr_read_b32 v75, a243
    v_mfma_f32_16x16x32_bf16 v[84:87], a[208:211], a[184:187], v[84:87]
    v_add_f32 v64, -0.5, v64
    v_add_f32 v65, -0.5, v65
    v_mfma_f32_16x16x32_bf16 v[76:79], a[208:211], a[180:183], v[76:79]
    ds_read_b64_tr_b16 a[204:205], v11 offset:12288
    v_add_f32 v66, -0.5, v66
    v_mfma_f32_16x16x32_bf16 v[108:111], a[212:215], a[180:183], v[108:111]
    ds_read_b64_tr_b16 a[206:207], v11 offset:14336
    v_add_f32 v67, -0.5, v67
    v_mfma_f32_16x16x32_bf16 v[100:103], a[212:215], a[176:179], v[100:103]
    v_add_f32 v72, -0.5, v72
    v_add_f32 v73, -0.5, v73
    v_mfma_f32_16x16x32_bf16 v[68:71], a[208:211], a[176:179], v[68:71]
    s_waitcnt lgkmcnt(4)
    v_add_f32 v74, -0.5, v74
    v_add_f32 v75, -0.5, v75
    v_mfma_f32_16x16x32_bf16 v[68:71], a[192:195], a[0:3], v[68:71]
    ds_read_b64_tr_b16 a[208:209], v10 offset:16384
    v_cvt_pk_bf16_f32 v64, v64, v65
    v_mfma_f32_16x16x32_bf16 v[100:103], a[196:199], a[0:3], v[100:103]
    ds_read_b64_tr_b16 a[210:211], v10 offset:18432
    v_cvt_pk_bf16_f32 v65, v66, v67
    v_mfma_f32_16x16x32_bf16 v[108:111], a[196:199], a[4:7], v[108:111]
    v_cvt_pk_bf16_f32 v66, v72, v73
    v_cvt_pk_bf16_f32 v67, v74, v75
    v_mfma_f32_16x16x32_bf16 v[76:79], a[192:195], a[4:7], v[76:79]
    buffer_store_dwordx4 v[64:67], v6, s[24:27], s55 offen sc1
    v_mfma_f32_16x16x32_bf16 v[84:87], a[192:195], a[8:11], v[84:87]
    s_xor_b32 s55, s55, 1024
    ds_read_b64_tr_b16 a[212:213], v11 offset:16384
    v_accvgpr_read_b32 v80, a228
    v_mfma_f32_16x16x32_bf16 v[116:119], a[196:199], a[8:11], v[116:119]
    s_waitcnt vmcnt(3)
    ds_read_b64_tr_b16 a[214:215], v11 offset:18432
    v_accvgpr_read_b32 v81, a229
    v_mfma_f32_16x16x32_bf16 v[124:127], a[196:199], a[12:15], v[124:127]
    v_accvgpr_read_b32 v82, a230
    v_accvgpr_read_b32 v83, a231
    v_mfma_f32_16x16x32_bf16 v[92:95], a[192:195], a[12:15], v[92:95]
    s_waitcnt lgkmcnt(4)
    v_accvgpr_read_b32 v88, a244
    v_accvgpr_read_b32 v89, a245
    v_mfma_f32_16x16x32_bf16 v[92:95], a[200:203], a[28:31], v[92:95]
    ds_read_b64_tr_b16 a[192:193], v10 offset:20480
    v_accvgpr_read_b32 v90, a246
    v_mfma_f32_16x16x32_bf16 v[124:127], a[204:207], a[28:31], v[124:127]
    ds_read_b64_tr_b16 a[194:195], v10 offset:22528
    v_accvgpr_read_b32 v91, a247
    v_mfma_f32_16x16x32_bf16 v[116:119], a[204:207], a[24:27], v[116:119]
    v_add_f32 v80, -0.5, v80
    v_add_f32 v81, -0.5, v81
    v_mfma_f32_16x16x32_bf16 v[84:87], a[200:203], a[24:27], v[84:87]
    v_add_f32 v82, -0.5, v82
    v_add_f32 v83, -0.5, v83
    v_mfma_f32_16x16x32_bf16 v[76:79], a[200:203], a[20:23], v[76:79]
    ds_read_b64_tr_b16 a[196:197], v11 offset:20480
    v_add_f32 v88, -0.5, v88
    v_mfma_f32_16x16x32_bf16 v[108:111], a[204:207], a[20:23], v[108:111]
    ds_read_b64_tr_b16 a[198:199], v11 offset:22528
    v_add_f32 v89, -0.5, v89
    v_mfma_f32_16x16x32_bf16 v[100:103], a[204:207], a[16:19], v[100:103]
    v_add_f32 v90, -0.5, v90
    v_add_f32 v91, -0.5, v91
    v_mfma_f32_16x16x32_bf16 v[68:71], a[200:203], a[16:19], v[68:71]
    s_waitcnt lgkmcnt(4)
    v_cvt_pk_bf16_f32 v80, v80, v81
    v_cvt_pk_bf16_f32 v81, v82, v83
    v_mfma_f32_16x16x32_bf16 v[68:71], a[208:211], a[32:35], v[68:71]
    ds_read_b64_tr_b16 a[200:201], v10 offset:24576
    v_cvt_pk_bf16_f32 v82, v88, v89
    v_mfma_f32_16x16x32_bf16 v[100:103], a[212:215], a[32:35], v[100:103]
    ds_read_b64_tr_b16 a[202:203], v10 offset:26624
    v_cvt_pk_bf16_f32 v83, v90, v91
    v_mfma_f32_16x16x32_bf16 v[108:111], a[212:215], a[36:39], v[108:111]
    buffer_store_dwordx4 v[80:83], v6, s[24:27], s55 offen sc1
    v_mfma_f32_16x16x32_bf16 v[76:79], a[208:211], a[36:39], v[76:79]
    s_xor_b32 s55, s55, 3072
    v_accvgpr_read_b32 v96, a232
    v_accvgpr_read_b32 v97, a233
    v_mfma_f32_16x16x32_bf16 v[84:87], a[208:211], a[40:43], v[84:87]
    s_add_u32 m0, s36, 147456
    ds_read_b64_tr_b16 a[204:205], v11 offset:24576
    v_accvgpr_read_b32 v98, a234
    v_mfma_f32_16x16x32_bf16 v[116:119], a[212:215], a[40:43], v[116:119]
    s_add_u32 s38, s34, 123136
    ds_read_b64_tr_b16 a[206:207], v11 offset:26624
    v_accvgpr_read_b32 v99, a235
    v_mfma_f32_16x16x32_bf16 v[124:127], a[212:215], a[44:47], v[124:127]
    s_add_u32 s57, s35, 123136
    v_accvgpr_read_b32 v104, a248
    v_accvgpr_read_b32 v105, a249
    v_mfma_f32_16x16x32_bf16 v[92:95], a[208:211], a[44:47], v[92:95]
    s_waitcnt lgkmcnt(4)
    v_accvgpr_read_b32 v106, a250
    v_accvgpr_read_b32 v107, a251
    v_mfma_f32_16x16x32_bf16 v[92:95], a[192:195], a[60:63], v[92:95]
    s_cmp_lt_u32 s3, 2
    s_cselect_b32 s38, s38, s57
    ds_read_b64_tr_b16 a[208:209], v10 offset:28672
    v_mfma_f32_16x16x32_bf16 v[124:127], a[196:199], a[60:63], v[124:127]
    ds_read_b64_tr_b16 a[210:211], v10 offset:30720
    v_add_f32 v96, -0.5, v96
    v_mfma_f32_16x16x32_bf16 v[116:119], a[196:199], a[56:59], v[116:119]
    buffer_load_dwordx4 v2, s[12:15], s38 offen lds
    v_mfma_f32_16x16x32_bf16 v[84:87], a[192:195], a[56:59], v[84:87]
    s_add_u32 m0, s36, 151552
    v_add_f32 v97, -0.5, v97
    v_add_f32 v98, -0.5, v98
    v_mfma_f32_16x16x32_bf16 v[76:79], a[192:195], a[52:55], v[76:79]
    s_add_u32 s38, s33, 164096
    ds_read_b64_tr_b16 a[212:213], v11 offset:28672
    v_add_f32 v99, -0.5, v99
    v_mfma_f32_16x16x32_bf16 v[108:111], a[196:199], a[52:55], v[108:111]
    s_waitcnt vmcnt(6)
    ds_read_b64_tr_b16 a[214:215], v11 offset:30720
    v_add_f32 v104, -0.5, v104
    v_mfma_f32_16x16x32_bf16 v[100:103], a[196:199], a[48:51], v[100:103]
    s_barrier
    v_mfma_f32_16x16x32_bf16 v[68:71], a[192:195], a[48:51], v[68:71]
pg_12:
    s_cbranch_execz pg_ret2
    s_waitcnt lgkmcnt(4)
    v_add_f32 v105, -0.5, v105
    v_add_f32 v106, -0.5, v106
    v_mfma_f32_16x16x32_bf16 v[68:71], a[200:203], a[64:67], v[68:71]
    s_add_u32 s57, s34, 164096
    ds_read_b64_tr_b16 a[192:193], v8 offset:32768
    v_add_f32 v107, -0.5, v107
    v_mfma_f32_16x16x32_bf16 v[100:103], a[204:207], a[64:67], v[100:103]
    s_cmp_lt_u32 s3, 2
    s_cselect_b32 s38, s38, s57
    ds_read_b64_tr_b16 a[194:195], v8 offset:34816
    v_mfma_f32_16x16x32_bf16 v[108:111], a[204:207], a[68:71], v[108:111]
    buffer_load_dwordx4 v2, s[12:15], s38 offen lds
    v_mfma_f32_16x16x32_bf16 v[76:79], a[200:203], a[68:71], v[76:79]
    s_add_u32 m0, s36, 155648
    v_cvt_pk_bf16_f32 v96, v96, v97
    v_cvt_pk_bf16_f32 v97, v98, v99
    v_mfma_f32_16x16x32_bf16 v[84:87], a[200:203], a[72:75], v[84:87]
    s_add_u32 s38, s35, 164096
    ds_read_b64_tr_b16 a[196:197], v9 offset:32768
    v_cvt_pk_bf16_f32 v98, v104, v105
    v_mfma_f32_16x16x32_bf16 v[116:119], a[204:207], a[72:75], v[116:119]
    s_add_u32 s57, s33, 205056
    ds_read_b64_tr_b16 a[198:199], v9 offset:34816
    v_cvt_pk_bf16_f32 v99, v106, v107
    v_mfma_f32_16x16x32_bf16 v[124:127], a[204:207], a[76:79], v[124:127]
    buffer_store_dwordx4 v[96:99], v7, s[24:27], s55 offen sc1
    v_mfma_f32_16x16x32_bf16 v[92:95], a[200:203], a[76:79], v[92:95]
    s_waitcnt lgkmcnt(4)
    v_accvgpr_read_b32 v112, a236
    v_accvgpr_read_b32 v113, a237
    v_mfma_f32_16x16x32_bf16 v[92:95], a[208:211], a[92:95], v[92:95]
    s_cmp_lt_u32 s3, 2
    s_cselect_b32 s38, s38, s57
    ds_read_b64_tr_b16 a[200:201], v8 offset:36864
    v_mfma_f32_16x16x32_bf16 v[124:127], a[212:215], a[92:95], v[124:127]
    s_xor_b32 s55, s55, 1024
    ds_read_b64_tr_b16 a[202:203], v8 offset:38912
    v_accvgpr_read_b32 v114, a238
    v_mfma_f32_16x16x32_bf16 v[116:119], a[212:215], a[88:91], v[116:119]
    buffer_load_dwordx4 v2, s[12:15], s38 offen lds
    v_mfma_f32_16x16x32_bf16 v[84:87], a[208:211], a[88:91], v[84:87]
    s_add_u32 m0, s36, 159744
    v_accvgpr_read_b32 v115, a239
    v_accvgpr_read_b32 v120, a252
    v_mfma_f32_16x16x32_bf16 v[76:79], a[208:211], a[84:87], v[76:79]
    s_add_u32 s38, s34, 205056
    ds_read_b64_tr_b16 a[204:205], v9 offset:36864
    v_accvgpr_read_b32 v121, a253
    v_mfma_f32_16x16x32_bf16 v[108:111], a[212:215], a[84:87], v[108:111]
    s_add_u32 s57, s35, 205056
    ds_read_b64_tr_b16 a[206:207], v9 offset:38912
    v_accvgpr_read_b32 v122, a254
    v_mfma_f32_16x16x32_bf16 v[100:103], a[212:215], a[80:83], v[100:103]
    s_cmp_lt_u32 s3, 2
    s_cselect_b32 s38, s38, s57
    v_accvgpr_read_b32 v123, a255
    v_mfma_f32_16x16x32_bf16 v[68:71], a[208:211], a[80:83], v[68:71]
    s_waitcnt lgkmcnt(4)
    buffer_load_dwordx4 v2, s[12:15], s38 offen lds
    v_mfma_f32_16x16x32_bf16 v[132:135], a[192:195], a[160:163], v[132:135]
    ds_read_b64_tr_b16 a[208:209], v8 offset:40960
    v_add_f32 v112, -0.5, v112
    v_mfma_f32_16x16x32_bf16 v[164:167], a[196:199], a[160:163], v[164:167]
    ds_read_b64_tr_b16 a[210:211], v8 offset:43008
    v_add_f32 v113, -0.5, v113
    v_mfma_f32_16x16x32_bf16 v[172:175], a[196:199], a[164:167], v[172:175]
    v_add_f32 v114, -0.5, v114
    v_add_f32 v115, -0.5, v115
    v_mfma_f32_16x16x32_bf16 v[140:143], a[192:195], a[164:167], v[140:143]
    v_add_f32 v120, -0.5, v120
    v_add_f32 v121, -0.5, v121
    v_mfma_f32_16x16x32_bf16 v[148:151], a[192:195], a[168:171], v[148:151]
    ds_read_b64_tr_b16 a[212:213], v9 offset:40960
    v_add_f32 v122, -0.5, v122
    v_mfma_f32_16x16x32_bf16 v[180:183], a[196:199], a[168:171], v[180:183]
    ds_read_b64_tr_b16 a[214:215], v9 offset:43008
    v_add_f32 v123, -0.5, v123
    v_mfma_f32_16x16x32_bf16 v[188:191], a[196:199], a[172:175], v[188:191]
    v_cvt_pk_bf16_f32 v112, v112, v113
    v_cvt_pk_bf16_f32 v113, v114, v115
    v_mfma_f32_16x16x32_bf16 v[156:159], a[192:195], a[172:175], v[156:159]
    s_waitcnt lgkmcnt(4)
    v_cvt_pk_bf16_f32 v114, v120, v121
    v_cvt_pk_bf16_f32 v115, v122, v123
    v_mfma_f32_16x16x32_bf16 v[156:159], a[200:203], a[188:191], v[156:159]
    ds_read_b64_tr_b16 a[192:193], v8 offset:45056
    v_cvt_pk_bf16_f32 v68, v68, v69
    v_mfma_f32_16x16x32_bf16 v[188:191], a[204:207], a[188:191], v[188:191]
    ds_read_b64_tr_b16 a[194:195], v8 offset:47104
    v_cvt_pk_bf16_f32 v69, v70, v71
    v_mfma_f32_16x16x32_bf16 v[180:183], a[204:207], a[184:187], v[180:183]
    buffer_store_dwordx4 v[112:115], v7, s[24:27], s55 offen sc1
    v_mfma_f32_16x16x32_bf16 v[148:151], a[200:203], a[184:187], v[148:151]
    s_xor_b32 s55, s55, 3072
    v_cvt_pk_bf16_f32 v70, v100, v101
    v_cvt_pk_bf16_f32 v71, v102, v103
    v_mfma_f32_16x16x32_bf16 v[140:143], a[200:203], a[180:183], v[140:143]
    s_add_u32 s55, s55, 16384
    ds_read_b64_tr_b16 a[196:197], v9 offset:45056
    v_cvt_pk_bf16_f32 v76, v76, v77
    v_mfma_f32_16x16x32_bf16 v[172:175], a[204:207], a[180:183], v[172:175]
    ds_read_b64_tr_b16 a[198:199], v9 offset:47104
    v_cvt_pk_bf16_f32 v77, v78, v79
    v_mfma_f32_16x16x32_bf16 v[164:167], a[204:207], a[176:179], v[164:167]
    buffer_store_dwordx4 v[68:71], v6, s[24:27], s55 offen sc1
    v_mfma_f32_16x16x32_bf16 v[132:135], a[200:203], a[176:179], v[132:135]
    s_waitcnt lgkmcnt(4)
    v_cvt_pk_bf16_f32 v78, v108, v109
    v_cvt_pk_bf16_f32 v79, v110, v111
    v_mfma_f32_16x16x32_bf16 v[132:135], a[208:211], a[0:3], v[132:135]
    s_xor_b32 s55, s55, 1024
    ds_read_b64_tr_b16 a[200:201], v8 offset:49152
    v_cvt_pk_bf16_f32 v84, v84, v85
    v_mfma_f32_16x16x32_bf16 v[164:167], a[212:215], a[0:3], v[164:167]
    ds_read_b64_tr_b16 a[202:203], v8 offset:51200
    v_cvt_pk_bf16_f32 v85, v86, v87
    v_mfma_f32_16x16x32_bf16 v[172:175], a[212:215], a[4:7], v[172:175]
    buffer_store_dwordx4 v[76:79], v6, s[24:27], s55 offen sc1
    v_mfma_f32_16x16x32_bf16 v[140:143], a[208:211], a[4:7], v[140:143]
    s_xor_b32 s55, s55, 3072
    v_cvt_pk_bf16_f32 v86, v116, v117
    v_cvt_pk_bf16_f32 v87, v118, v119
    v_mfma_f32_16x16x32_bf16 v[148:151], a[208:211], a[8:11], v[148:151]
    ds_read_b64_tr_b16 a[204:205], v9 offset:49152
    v_cvt_pk_bf16_f32 v92, v92, v93
    v_mfma_f32_16x16x32_bf16 v[180:183], a[212:215], a[8:11], v[180:183]
    ds_read_b64_tr_b16 a[206:207], v9 offset:51200
    v_cvt_pk_bf16_f32 v93, v94, v95
    v_mfma_f32_16x16x32_bf16 v[188:191], a[212:215], a[12:15], v[188:191]
    v_cvt_pk_bf16_f32 v94, v124, v125
    v_cvt_pk_bf16_f32 v95, v126, v127
    v_mfma_f32_16x16x32_bf16 v[156:159], a[208:211], a[12:15], v[156:159]
    s_waitcnt lgkmcnt(4)
    v_lshlrev_b32 v26, 16, v144
    v_and_b32 v27, 0xffff0000, v144
    v_mfma_f32_16x16x32_bf16 v[156:159], a[192:195], a[28:31], v[156:159]
    ds_read_b64_tr_b16 a[208:209], v8 offset:53248
    v_fma_f32 v26, v26, v25, v24
    v_mfma_f32_16x16x32_bf16 v[188:191], a[196:199], a[28:31], v[188:191]
    ds_read_b64_tr_b16 a[210:211], v8 offset:55296
    v_fma_f32 v27, v27, v25, v24
    v_mfma_f32_16x16x32_bf16 v[180:183], a[196:199], a[24:27], v[180:183]
    v_mul_f32 v30, s92, v26
    v_mul_f32 v31, s92, v27
    v_mfma_f32_16x16x32_bf16 v[148:151], a[192:195], a[24:27], v[148:151]
    v_exp_f32 v30, v30
    v_mfma_f32_16x16x32_bf16 v[140:143], a[192:195], a[20:23], v[140:143]
    ds_read_b64_tr_b16 a[212:213], v9 offset:53248
    v_add_f32 v239, -0.5, v239
    v_mfma_f32_16x16x32_bf16 v[172:175], a[196:199], a[20:23], v[172:175]
    ds_read_b64_tr_b16 a[214:215], v9 offset:55296
    v_add_f32 v212, -0.5, v212
    v_mfma_f32_16x16x32_bf16 v[164:167], a[196:199], a[16:19], v[164:167]
    buffer_store_dwordx4 v[84:87], v7, s[24:27], s55 offen sc1
    v_mfma_f32_16x16x32_bf16 v[132:135], a[192:195], a[16:19], v[132:135]
    s_waitcnt lgkmcnt(4)
    v_exp_f32 v31, v31
    v_mfma_f32_16x16x32_bf16 v[132:135], a[200:203], a[32:35], v[132:135]
    s_xor_b32 s55, s55, 1024
    ds_read_b64_tr_b16 a[192:193], v8 offset:57344
    v_add_f32 v30, 1.0, v30
    v_mfma_f32_16x16x32_bf16 v[164:167], a[204:207], a[32:35], v[164:167]
    ds_read_b64_tr_b16 a[194:195], v8 offset:59392
    v_add_f32 v31, 1.0, v31
    v_mfma_f32_16x16x32_bf16 v[172:175], a[204:207], a[36:39], v[172:175]
    v_rcp_f32 v30, v30
    v_mfma_f32_16x16x32_bf16 v[140:143], a[200:203], a[36:39], v[140:143]
    v_rcp_f32 v31, v31
    v_mfma_f32_16x16x32_bf16 v[148:151], a[200:203], a[40:43], v[148:151]
    s_mov_b32 s32, s84
    ds_read_b64_tr_b16 a[196:197], v9 offset:57344
    v_mul_f32 v26, v26, v30
    v_mfma_f32_16x16x32_bf16 v[180:183], a[204:207], a[40:43], v[180:183]
    s_and_b32 s33, s85, 0xffff
    ds_read_b64_tr_b16 a[198:199], v9 offset:59392
    v_mul_f32 v27, v27, v31
    v_mfma_f32_16x16x32_bf16 v[188:191], a[204:207], a[44:47], v[188:191]
    s_mov_b32 s34, 2621440
    v_cvt_pk_bf16_f32 v168, v26, v27
    v_lshlrev_b32 v26, 16, v145
    v_mfma_f32_16x16x32_bf16 v[156:159], a[200:203], a[44:47], v[156:159]
    s_waitcnt lgkmcnt(4)
    v_and_b32 v27, 0xffff0000, v145
    v_fma_f32 v26, v26, v25, v24
    v_mfma_f32_16x16x32_bf16 v[156:159], a[208:211], a[60:63], v[156:159]
    s_mov_b32 s35, 0x00020000
    ds_read_b64_tr_b16 a[200:201], v8 offset:61440
    v_fma_f32 v27, v27, v25, v24
    v_mfma_f32_16x16x32_bf16 v[188:191], a[212:215], a[60:63], v[188:191]
    ds_read_b64_tr_b16 a[202:203], v8 offset:63488
    v_mul_f32 v30, s92, v26
    v_mfma_f32_16x16x32_bf16 v[180:183], a[212:215], a[56:59], v[180:183]
    buffer_load_dword v137, v136, s[24:27], s59 offen offset:128 sc1
    v_mfma_f32_16x16x32_bf16 v[148:151], a[208:211], a[56:59], v[148:151]
    buffer_store_dwordx4 v[92:95], v7, s[24:27], s55 offen sc1
    v_mfma_f32_16x16x32_bf16 v[140:143], a[208:211], a[52:55], v[140:143]
    s_xor_b32 s55, s55, 3072
    ds_read_b64_tr_b16 a[204:205], v9 offset:61440
    v_mul_f32 v31, s92, v27
    v_mfma_f32_16x16x32_bf16 v[172:175], a[212:215], a[52:55], v[172:175]
    s_add_u32 s55, s55, 16384
    ds_read_b64_tr_b16 a[206:207], v9 offset:63488
    v_add_f32 v213, -0.5, v213
    v_mfma_f32_16x16x32_bf16 v[164:167], a[212:215], a[48:51], v[164:167]
    v_exp_f32 v30, v30
    v_mfma_f32_16x16x32_bf16 v[132:135], a[208:211], a[48:51], v[132:135]
    s_waitcnt lgkmcnt(4)
    v_exp_f32 v31, v31
    v_mfma_f32_16x16x32_bf16 v[132:135], a[192:195], a[64:67], v[132:135]
    ds_read_b64_tr_b16 a[208:209], v10 offset:32768
    v_add_f32 v30, 1.0, v30
    v_mfma_f32_16x16x32_bf16 v[164:167], a[196:199], a[64:67], v[164:167]
    ds_read_b64_tr_b16 a[210:211], v10 offset:34816
    v_add_f32 v31, 1.0, v31
    v_mfma_f32_16x16x32_bf16 v[172:175], a[196:199], a[68:71], v[172:175]
    s_load_dword s67, s[86:87], s5 glc
    v_rcp_f32 v30, v30
    v_mfma_f32_16x16x32_bf16 v[140:143], a[192:195], a[68:71], v[140:143]
    v_rcp_f32 v31, v31
    v_mfma_f32_16x16x32_bf16 v[148:151], a[192:195], a[72:75], v[148:151]
    ds_read_b64_tr_b16 a[212:213], v11 offset:32768
    v_mul_f32 v26, v26, v30
    v_mfma_f32_16x16x32_bf16 v[180:183], a[196:199], a[72:75], v[180:183]
    ds_read_b64_tr_b16 a[214:215], v11 offset:34816
    v_mul_f32 v27, v27, v31
    v_mfma_f32_16x16x32_bf16 v[188:191], a[196:199], a[76:79], v[188:191]
    v_cvt_pk_bf16_f32 v169, v26, v27
    v_lshlrev_b32 v26, 16, v146
    v_mfma_f32_16x16x32_bf16 v[156:159], a[192:195], a[76:79], v[156:159]
    s_waitcnt lgkmcnt(4)
    v_and_b32 v27, 0xffff0000, v146
    v_fma_f32 v26, v26, v25, v24
    v_mfma_f32_16x16x32_bf16 v[156:159], a[200:203], a[92:95], v[156:159]
    ds_read_b64_tr_b16 a[192:193], v10 offset:36864
    v_fma_f32 v27, v27, v25, v24
    v_mfma_f32_16x16x32_bf16 v[188:191], a[204:207], a[92:95], v[188:191]
    ds_read_b64_tr_b16 a[194:195], v10 offset:38912
    v_mul_f32 v30, s92, v26
    v_mfma_f32_16x16x32_bf16 v[180:183], a[204:207], a[88:91], v[180:183]
    v_mul_f32 v31, s92, v27
    v_add_f32 v214, -0.5, v214
    v_mfma_f32_16x16x32_bf16 v[148:151], a[200:203], a[88:91], v[148:151]
    v_exp_f32 v30, v30
    v_mfma_f32_16x16x32_bf16 v[140:143], a[200:203], a[84:87], v[140:143]
    ds_read_b64_tr_b16 a[196:197], v11 offset:36864
    v_add_f32 v215, -0.5, v215
    v_mfma_f32_16x16x32_bf16 v[172:175], a[204:207], a[84:87], v[172:175]
    ds_read_b64_tr_b16 a[198:199], v11 offset:38912
    v_add_f32 v244, -0.5, v244
    v_add_f32 v245, -0.5, v245
    v_add_f32 v246, -0.5, v246
    v_add_f32 v247, -0.5, v247
    v_add_f32 v220, -0.5, v220
    v_add_f32 v221, -0.5, v221
    v_add_f32 v222, -0.5, v222
    v_add_f32 v223, -0.5, v223
    v_add_f32 v252, -0.5, v252
    v_add_f32 v253, -0.5, v253
    v_add_f32 v254, -0.5, v254
    v_add_f32 v255, -0.5, v255
    v_mfma_f32_16x16x32_bf16 v[164:167], a[204:207], a[80:83], v[164:167]
    s_waitcnt vmcnt(5)
    v_exp_f32 v31, v31
    v_mfma_f32_16x16x32_bf16 v[132:135], a[200:203], a[80:83], v[132:135]
    s_waitcnt lgkmcnt(4)
    v_add_f32 v30, 1.0, v30
    v_add_f32 v31, 1.0, v31
    v_mfma_f32_16x16x32_bf16 v[196:199], a[208:211], a[160:163], v[196:199]
    ds_read_b64_tr_b16 a[200:201], v10 offset:40960
    v_add_f32 v32, -0.5, v32
    v_mfma_f32_16x16x32_bf16 v[228:231], a[212:215], a[160:163], v[228:231]
    ds_read_b64_tr_b16 a[202:203], v10 offset:43008
    v_add_f32 v33, -0.5, v33
    v_mfma_f32_16x16x32_bf16 v[236:239], a[212:215], a[164:167], v[236:239]
    buffer_atomic_or v128, v3, s[24:27], 0 offen offset:0
    v_mfma_f32_16x16x32_bf16 v[204:207], a[208:211], a[164:167], v[204:207]
    v_rcp_f32 v30, v30
    v_mfma_f32_16x16x32_bf16 v[212:215], a[208:211], a[168:171], v[212:215]
    ds_read_b64_tr_b16 a[204:205], v11 offset:40960
    v_add_f32 v34, -0.5, v34
    v_mfma_f32_16x16x32_bf16 v[244:247], a[212:215], a[168:171], v[244:247]
    ds_read_b64_tr_b16 a[206:207], v11 offset:43008
    v_add_f32 v35, -0.5, v35
    v_mfma_f32_16x16x32_bf16 v[252:255], a[212:215], a[172:175], v[252:255]
    v_cvt_pk_bf16_f32 v132, v132, v133
    v_cvt_pk_bf16_f32 v133, v134, v135
    v_mfma_f32_16x16x32_bf16 v[220:223], a[208:211], a[172:175], v[220:223]
    s_waitcnt lgkmcnt(4)
    v_cvt_pk_bf16_f32 v134, v164, v165
    v_cvt_pk_bf16_f32 v135, v166, v167
    v_mfma_f32_16x16x32_bf16 v[220:223], a[192:195], a[188:191], v[220:223]
    ds_read_b64_tr_b16 a[208:209], v10 offset:45056
    v_cvt_pk_bf16_f32 v140, v140, v141
    v_mfma_f32_16x16x32_bf16 v[252:255], a[196:199], a[188:191], v[252:255]
    ds_read_b64_tr_b16 a[210:211], v10 offset:47104
    v_cvt_pk_bf16_f32 v141, v142, v143
    v_mfma_f32_16x16x32_bf16 v[244:247], a[196:199], a[184:187], v[244:247]
    buffer_store_dwordx4 v[132:135], v6, s[24:27], s55 offen sc1
    v_mfma_f32_16x16x32_bf16 v[212:215], a[192:195], a[184:187], v[212:215]
    s_xor_b32 s55, s55, 1024
    v_cvt_pk_bf16_f32 v142, v172, v173
    v_cvt_pk_bf16_f32 v143, v174, v175
    v_mfma_f32_16x16x32_bf16 v[204:207], a[192:195], a[180:183], v[204:207]
    ds_read_b64_tr_b16 a[212:213], v11 offset:45056
    v_cvt_pk_bf16_f32 v148, v148, v149
    v_mfma_f32_16x16x32_bf16 v[236:239], a[196:199], a[180:183], v[236:239]
    ds_read_b64_tr_b16 a[214:215], v11 offset:47104
    v_cvt_pk_bf16_f32 v149, v150, v151
    v_mfma_f32_16x16x32_bf16 v[228:231], a[196:199], a[176:179], v[228:231]
    v_cvt_pk_bf16_f32 v150, v180, v181
    v_cvt_pk_bf16_f32 v151, v182, v183
    v_mfma_f32_16x16x32_bf16 v[196:199], a[192:195], a[176:179], v[196:199]
    s_waitcnt lgkmcnt(4)
    v_cvt_pk_bf16_f32 v156, v156, v157
    v_cvt_pk_bf16_f32 v157, v158, v159
    v_mfma_f32_16x16x32_bf16 v[196:199], a[200:203], a[0:3], v[196:199]
    ds_read_b64_tr_b16 a[192:193], v10 offset:49152
    v_cvt_pk_bf16_f32 v158, v188, v189
    v_mfma_f32_16x16x32_bf16 v[228:231], a[204:207], a[0:3], v[228:231]
    ds_read_b64_tr_b16 a[194:195], v10 offset:51200
    v_cvt_pk_bf16_f32 v159, v190, v191
    v_mfma_f32_16x16x32_bf16 v[236:239], a[204:207], a[4:7], v[236:239]
    buffer_store_dwordx4 v[140:143], v6, s[24:27], s55 offen sc1
    v_mfma_f32_16x16x32_bf16 v[204:207], a[200:203], a[4:7], v[204:207]
    s_xor_b32 s55, s55, 3072
    v_rcp_f32 v31, v31
    v_mfma_f32_16x16x32_bf16 v[212:215], a[200:203], a[8:11], v[212:215]
    ds_read_b64_tr_b16 a[196:197], v11 offset:49152
    v_mul_f32 v26, v26, v30
    v_mfma_f32_16x16x32_bf16 v[244:247], a[204:207], a[8:11], v[244:247]
    ds_read_b64_tr_b16 a[198:199], v11 offset:51200
    v_mul_f32 v27, v27, v31
    v_mfma_f32_16x16x32_bf16 v[252:255], a[204:207], a[12:15], v[252:255]
    s_andn2_b32 s69, s67, s68
    s_and_b32 s69, s69, 255
    s_or_b32 s68, s68, s69
    v_mfma_f32_16x16x32_bf16 v[220:223], a[200:203], a[12:15], v[220:223]
    s_waitcnt lgkmcnt(4)
    v_readlane_b32 s56, v23, 0
    v_cvt_pk_bf16_f32 v170, v26, v27
    v_mfma_f32_16x16x32_bf16 v[220:223], a[208:211], a[28:31], v[220:223]
    s_add_u32 m0, s37, 0
    ds_read_b64_tr_b16 a[200:201], v10 offset:53248
    v_lshlrev_b32 v26, 16, v147
    v_mfma_f32_16x16x32_bf16 v[252:255], a[212:215], a[28:31], v[252:255]
    s_bitcmp1_b32 s69, 0
    s_cselect_b32 s56, s56, 0x70000000
    s_cselect_b32 m0, m0, 0x30000
    ds_read_b64_tr_b16 a[202:203], v10 offset:55296
    v_mfma_f32_16x16x32_bf16 v[244:247], a[212:215], a[24:27], v[244:247]
    buffer_load_dwordx4 v28, s[24:27], s56 offen sc1 lds
    v_mfma_f32_16x16x32_bf16 v[212:215], a[208:211], a[24:27], v[212:215]
    v_readlane_b32 s56, v23, 1
    v_and_b32 v27, 0xffff0000, v147
    v_mfma_f32_16x16x32_bf16 v[204:207], a[208:211], a[20:23], v[204:207]
    s_waitcnt vmcnt(5)
    ds_read_b64_tr_b16 a[204:205], v11 offset:53248
    v_cmp_ne_u32 s[78:79], 24, v137
    v_mfma_f32_16x16x32_bf16 v[236:239], a[212:215], a[20:23], v[236:239]
    s_cmp_eq_u64 s[78:79], 0
    s_cselect_b32 s44, s59, 0x70000000
    ds_read_b64_tr_b16 a[206:207], v11 offset:55296
    v_mfma_f32_16x16x32_bf16 v[228:231], a[212:215], a[16:19], v[228:231]
    buffer_load_dwordx4 v[240:243], v192, s[24:27], s44 offen sc1
    v_mfma_f32_16x16x32_bf16 v[196:199], a[208:211], a[16:19], v[196:199]
    s_waitcnt lgkmcnt(4)
    v_fma_f32 v26, v26, v25, v24
    v_fma_f32 v27, v27, v25, v24
    v_mfma_f32_16x16x32_bf16 v[196:199], a[192:195], a[32:35], v[196:199]
    s_add_u32 m0, s37, 1024
    ds_read_b64_tr_b16 a[208:209], v10 offset:57344
    v_mul_f32 v30, s92, v26
    v_mfma_f32_16x16x32_bf16 v[228:231], a[196:199], a[32:35], v[228:231]
    s_bitcmp1_b32 s69, 1
    s_cselect_b32 s56, s56, 0x70000000
    s_cselect_b32 m0, m0, 0x30000
    ds_read_b64_tr_b16 a[210:211], v10 offset:59392
    v_mfma_f32_16x16x32_bf16 v[236:239], a[196:199], a[36:39], v[236:239]
    buffer_load_dwordx4 v28, s[24:27], s56 offen sc1 lds
    v_mfma_f32_16x16x32_bf16 v[204:207], a[192:195], a[36:39], v[204:207]
    v_readlane_b32 s56, v23, 2
    v_mul_f32 v31, s92, v27
    v_mfma_f32_16x16x32_bf16 v[212:215], a[192:195], a[40:43], v[212:215]
    s_add_u32 m0, s37, 2048
    ds_read_b64_tr_b16 a[212:213], v11 offset:57344
    v_add_f32 v48, -0.5, v48
    v_mfma_f32_16x16x32_bf16 v[244:247], a[196:199], a[40:43], v[244:247]
    s_bitcmp1_b32 s69, 2
    s_cselect_b32 s56, s56, 0x70000000
    s_cselect_b32 m0, m0, 0x30000
    ds_read_b64_tr_b16 a[214:215], v11 offset:59392
    v_mfma_f32_16x16x32_bf16 v[252:255], a[196:199], a[44:47], v[252:255]
    buffer_load_dwordx4 v28, s[24:27], s56 offen sc1 lds
    v_mfma_f32_16x16x32_bf16 v[220:223], a[192:195], a[44:47], v[220:223]
    s_waitcnt lgkmcnt(4)
    v_readlane_b32 s56, v23, 3
    v_add_f32 v49, -0.5, v49
    v_mfma_f32_16x16x32_bf16 v[220:223], a[200:203], a[60:63], v[220:223]
    s_add_u32 m0, s37, 3072
    ds_read_b64_tr_b16 a[192:193], v10 offset:61440
    v_add_f32 v50, -0.5, v50
    v_mfma_f32_16x16x32_bf16 v[252:255], a[204:207], a[60:63], v[252:255]
    s_bitcmp1_b32 s69, 3
    s_cselect_b32 s56, s56, 0x70000000
    s_cselect_b32 m0, m0, 0x30000
    ds_read_b64_tr_b16 a[194:195], v10 offset:63488
    v_mfma_f32_16x16x32_bf16 v[244:247], a[204:207], a[56:59], v[244:247]
    buffer_store_dwordx4 v[148:151], v7, s[24:27], s55 offen sc1
    v_mfma_f32_16x16x32_bf16 v[212:215], a[200:203], a[56:59], v[212:215]
    s_xor_b32 s55, s55, 1024
    v_exp_f32 v30, v30
    v_mfma_f32_16x16x32_bf16 v[204:207], a[200:203], a[52:55], v[204:207]
    ds_read_b64_tr_b16 a[196:197], v11 offset:61440
    v_add_f32 v51, -0.5, v51
    v_mfma_f32_16x16x32_bf16 v[236:239], a[204:207], a[52:55], v[236:239]
    s_waitcnt vmcnt(14)
    ds_read_b64_tr_b16 a[198:199], v11 offset:63488
    v_add_f32 v36, -0.5, v36
    v_mfma_f32_16x16x32_bf16 v[228:231], a[204:207], a[48:51], v[228:231]
    s_barrier
    v_mfma_f32_16x16x32_bf16 v[196:199], a[200:203], a[48:51], v[196:199]
    s_waitcnt lgkmcnt(4)
    buffer_load_dwordx4 v28, s[24:27], s56 offen sc1 lds
    v_mfma_f32_16x16x32_bf16 v[196:199], a[208:211], a[64:67], v[196:199]
    ds_read_b64_tr_b16 a[200:201], v18 offset:0
    v_readlane_b32 s56, v23, 4
    v_mfma_f32_16x16x32_bf16 v[228:231], a[212:215], a[64:67], v[228:231]
    s_add_u32 m0, s37, 4096
    ds_read_b64_tr_b16 a[202:203], v18 offset:1024
    v_add_f32 v37, -0.5, v37
    v_mfma_f32_16x16x32_bf16 v[236:239], a[212:215], a[68:71], v[236:239]
    buffer_store_dwordx4 v[156:159], v7, s[24:27], s55 offen sc1
    v_mfma_f32_16x16x32_bf16 v[204:207], a[208:211], a[68:71], v[204:207]
    s_bitcmp1_b32 s69, 4
    s_cselect_b32 s56, s56, 0x70000000
    s_cselect_b32 m0, m0, 0x30000
    v_mfma_f32_16x16x32_bf16 v[212:215], a[208:211], a[72:75], v[212:215]
    s_xor_b32 s55, s55, 3072
    ds_read_b64_tr_b16 a[204:205], v19 offset:0
    v_add_f32 v38, -0.5, v38
    v_mfma_f32_16x16x32_bf16 v[244:247], a[212:215], a[72:75], v[244:247]
    s_add_u32 s55, s55, 16384
    ds_read_b64_tr_b16 a[206:207], v19 offset:1024
    v_add_f32 v39, -0.5, v39
    v_mfma_f32_16x16x32_bf16 v[252:255], a[212:215], a[76:79], v[252:255]
    v_exp_f32 v31, v31
    v_mfma_f32_16x16x32_bf16 v[220:223], a[208:211], a[76:79], v[220:223]
    s_waitcnt lgkmcnt(4)
    buffer_load_dwordx4 v28, s[24:27], s56 offen sc1 lds
    v_mfma_f32_16x16x32_bf16 v[220:223], a[192:195], a[92:95], v[220:223]
    ds_read_b64_tr_b16 a[208:209], v18 offset:2048
    v_readlane_b32 s56, v23, 5
    v_mfma_f32_16x16x32_bf16 v[252:255], a[196:199], a[92:95], v[252:255]
    s_add_u32 m0, s37, 5120
    ds_read_b64_tr_b16 a[210:211], v18 offset:3072
    v_add_f32 v30, 1.0, v30
    v_mfma_f32_16x16x32_bf16 v[244:247], a[196:199], a[88:91], v[244:247]
    s_bitcmp1_b32 s69, 5
    s_cselect_b32 s56, s56, 0x70000000
    s_cselect_b32 m0, m0, 0x30000
    v_mfma_f32_16x16x32_bf16 v[212:215], a[192:195], a[88:91], v[212:215]
    buffer_load_dwordx4 v28, s[24:27], s56 offen sc1 lds
    v_mfma_f32_16x16x32_bf16 v[204:207], a[192:195], a[84:87], v[204:207]
    ds_read_b64_tr_b16 a[212:213], v19 offset:2048
    v_readlane_b32 s56, v23, 6
    v_mfma_f32_16x16x32_bf16 v[236:239], a[196:199], a[84:87], v[236:239]
    s_add_u32 m0, s37, 6144
    ds_read_b64_tr_b16 a[214:215], v19 offset:3072
    v_add_f32 v31, 1.0, v31
    v_add_f32 v52, -0.5, v52
    v_add_f32 v53, -0.5, v53
    v_add_f32 v54, -0.5, v54
    v_add_f32 v55, -0.5, v55
    v_add_f32 v40, -0.5, v40
    v_add_f32 v41, -0.5, v41
    v_add_f32 v42, -0.5, v42
    v_add_f32 v43, -0.5, v43
    v_add_f32 v56, -0.5, v56
    v_add_f32 v57, -0.5, v57
    v_add_f32 v58, -0.5, v58
    v_add_f32 v59, -0.5, v59
    v_add_f32 v44, -0.5, v44
    v_add_f32 v45, -0.5, v45
    v_add_f32 v46, -0.5, v46
    v_add_f32 v47, -0.5, v47
    v_add_f32 v60, -0.5, v60
    v_add_f32 v61, -0.5, v61
    v_add_f32 v62, -0.5, v62
    v_add_f32 v63, -0.5, v63
    v_mfma_f32_16x16x32_bf16 v[228:231], a[196:199], a[80:83], v[228:231]
    s_waitcnt vmcnt(12)
    v_rcp_f32 v30, v30
    v_mfma_f32_16x16x32_bf16 v[196:199], a[192:195], a[80:83], v[196:199]
    s_waitcnt lgkmcnt(4)
    v_rcp_f32 v31, v31
    v_mfma_f32_16x16x32_bf16 v[32:35], a[200:203], a[160:163], v[32:35]
    s_bitcmp1_b32 s69, 6
    s_cselect_b32 s56, s56, 0x70000000
    s_cselect_b32 m0, m0, 0x30000
    ds_read_b64_tr_b16 a[192:193], v18 offset:4096
    v_mfma_f32_16x16x32_bf16 v[48:51], a[204:207], a[160:163], v[48:51]
    ds_read_b64_tr_b16 a[194:195], v18 offset:5120
    v_mul_f32 v26, v26, v30
    v_mfma_f32_16x16x32_bf16 v[52:55], a[204:207], a[164:167], v[52:55]
    buffer_atomic_or v128, v3, s[24:27], 0 offen offset:256
    v_mfma_f32_16x16x32_bf16 v[36:39], a[200:203], a[164:167], v[36:39]
    buffer_load_dwordx4 v28, s[24:27], s56 offen sc1 lds
    v_mfma_f32_16x16x32_bf16 v[40:43], a[200:203], a[168:171], v[40:43]
    ds_read_b64_tr_b16 a[196:197], v19 offset:4096
    v_readlane_b32 s56, v23, 7
    v_mfma_f32_16x16x32_bf16 v[56:59], a[204:207], a[168:171], v[56:59]
    s_add_u32 m0, s37, 7168
    ds_read_b64_tr_b16 a[198:199], v19 offset:5120
    v_mul_f32 v27, v27, v31
    v_mfma_f32_16x16x32_bf16 v[60:63], a[204:207], a[172:175], v[60:63]
    s_bitcmp1_b32 s69, 7
    s_cselect_b32 s56, s56, 0x70000000
    s_cselect_b32 m0, m0, 0x30000
    v_mfma_f32_16x16x32_bf16 v[44:47], a[200:203], a[172:175], v[44:47]
    s_waitcnt lgkmcnt(4)
    buffer_load_dwordx4 v28, s[24:27], s56 offen sc1 lds
    v_mfma_f32_16x16x32_bf16 v[44:47], a[208:211], a[188:191], v[44:47]
    ds_read_b64_tr_b16 a[200:201], v18 offset:6144
    v_cvt_pk_bf16_f32 v196, v196, v197
    v_mfma_f32_16x16x32_bf16 v[60:63], a[212:215], a[188:191], v[60:63]
    ds_read_b64_tr_b16 a[202:203], v18 offset:7168
    v_cvt_pk_bf16_f32 v197, v198, v199
    v_mfma_f32_16x16x32_bf16 v[56:59], a[212:215], a[184:187], v[56:59]
    v_cvt_pk_bf16_f32 v198, v228, v229
    v_cvt_pk_bf16_f32 v199, v230, v231
    v_mfma_f32_16x16x32_bf16 v[40:43], a[208:211], a[184:187], v[40:43]
    buffer_store_dwordx4 v[196:199], v6, s[24:27], s55 offen sc1
    v_mfma_f32_16x16x32_bf16 v[36:39], a[208:211], a[180:183], v[36:39]
    s_xor_b32 s55, s55, 1024
    ds_read_b64_tr_b16 a[204:205], v19 offset:6144
    v_cvt_pk_bf16_f32 v204, v204, v205
    v_mfma_f32_16x16x32_bf16 v[52:55], a[212:215], a[180:183], v[52:55]
    ds_read_b64_tr_b16 a[206:207], v19 offset:7168
    v_cvt_pk_bf16_f32 v205, v206, v207
    v_mfma_f32_16x16x32_bf16 v[48:51], a[212:215], a[176:179], v[48:51]
    v_cvt_pk_bf16_f32 v206, v236, v237
    v_cvt_pk_bf16_f32 v207, v238, v239
    v_mfma_f32_16x16x32_bf16 v[32:35], a[208:211], a[176:179], v[32:35]
    s_waitcnt lgkmcnt(4)
    v_cvt_pk_bf16_f32 v212, v212, v213
    v_cvt_pk_bf16_f32 v213, v214, v215
    v_mfma_f32_16x16x32_bf16 v[32:35], a[192:195], a[0:3], v[32:35]
    ds_read_b64_tr_b16 a[208:209], v18 offset:8192
    v_cvt_pk_bf16_f32 v214, v244, v245
    v_mfma_f32_16x16x32_bf16 v[48:51], a[196:199], a[0:3], v[48:51]
    ds_read_b64_tr_b16 a[210:211], v18 offset:9216
    v_cvt_pk_bf16_f32 v215, v246, v247
    v_mfma_f32_16x16x32_bf16 v[52:55], a[196:199], a[4:7], v[52:55]
    buffer_store_dwordx4 v[204:207], v6, s[24:27], s55 offen sc1
    v_mfma_f32_16x16x32_bf16 v[36:39], a[192:195], a[4:7], v[36:39]
    s_xor_b32 s55, s55, 3072
    v_cvt_pk_bf16_f32 v220, v220, v221
    v_cvt_pk_bf16_f32 v221, v222, v223
    v_mfma_f32_16x16x32_bf16 v[40:43], a[192:195], a[8:11], v[40:43]
    ds_read_b64_tr_b16 a[212:213], v19 offset:8192
    v_cvt_pk_bf16_f32 v222, v252, v253
    v_mfma_f32_16x16x32_bf16 v[56:59], a[196:199], a[8:11], v[56:59]
    ds_read_b64_tr_b16 a[214:215], v19 offset:9216
    v_cvt_pk_bf16_f32 v223, v254, v255
    v_mfma_f32_16x16x32_bf16 v[60:63], a[196:199], a[12:15], v[60:63]
    v_cvt_pk_bf16_f32 v171, v26, v27
    v_add_u32 v4, s37, v28
    v_mfma_f32_16x16x32_bf16 v[44:47], a[192:195], a[12:15], v[44:47]
    s_waitcnt lgkmcnt(4)
    s_waitcnt vmcnt(31)
    v_lshlrev_b32 v26, 16, v152
    v_mfma_f32_16x16x32_bf16 v[44:47], a[200:203], a[28:31], v[44:47]
    ds_read_b64_tr_b16 a[192:193], v18 offset:10240
    v_and_b32 v27, 0xffff0000, v152
    v_mfma_f32_16x16x32_bf16 v[60:63], a[204:207], a[28:31], v[60:63]
    ds_read_b64_tr_b16 a[194:195], v18 offset:11264
    v_fma_f32 v26, v26, v25, v24
    v_mfma_f32_16x16x32_bf16 v[56:59], a[204:207], a[24:27], v[56:59]
    v_fma_f32 v27, v27, v25, v24
    v_mul_f32 v30, s92, v26
    v_mfma_f32_16x16x32_bf16 v[40:43], a[200:203], a[24:27], v[40:43]
    v_mul_f32 v31, s92, v27
    v_mfma_f32_16x16x32_bf16 v[36:39], a[200:203], a[20:23], v[36:39]
    ds_read_b64_tr_b16 a[196:197], v19 offset:10240
    v_mfma_f32_16x16x32_bf16 v[52:55], a[204:207], a[20:23], v[52:55]
    ds_read_b64_tr_b16 a[198:199], v19 offset:11264
    v_mfma_f32_16x16x32_bf16 v[48:51], a[204:207], a[16:19], v[48:51]
    buffer_store_dwordx4 v[212:215], v7, s[24:27], s55 offen sc1
    v_mfma_f32_16x16x32_bf16 v[32:35], a[200:203], a[16:19], v[32:35]
    s_waitcnt lgkmcnt(4)
    v_exp_f32 v30, v30
    v_mfma_f32_16x16x32_bf16 v[32:35], a[208:211], a[32:35], v[32:35]
    s_xor_b32 s55, s55, 1024
    ds_read_b64_tr_b16 a[200:201], v18 offset:12288
    v_mfma_f32_16x16x32_bf16 v[48:51], a[212:215], a[32:35], v[48:51]
pg_13:
    s_cbranch_execz pg_ret2
    ds_read_b64_tr_b16 a[202:203], v18 offset:13312
    v_mfma_f32_16x16x32_bf16 v[52:55], a[212:215], a[36:39], v[52:55]
    v_exp_f32 v31, v31
    v_mfma_f32_16x16x32_bf16 v[36:39], a[208:211], a[36:39], v[36:39]
    v_add_f32 v30, 1.0, v30
    v_add_f32 v31, 1.0, v31
    v_mfma_f32_16x16x32_bf16 v[40:43], a[208:211], a[40:43], v[40:43]
    ds_read_b64_tr_b16 a[204:205], v19 offset:12288
    v_mfma_f32_16x16x32_bf16 v[56:59], a[212:215], a[40:43], v[56:59]
    ds_read_b64_tr_b16 a[206:207], v19 offset:13312
    v_mfma_f32_16x16x32_bf16 v[60:63], a[212:215], a[44:47], v[60:63]
    s_waitcnt vmcnt(8)
    v_rcp_f32 v30, v30
    v_mfma_f32_16x16x32_bf16 v[44:47], a[208:211], a[44:47], v[44:47]
    s_waitcnt lgkmcnt(4)
    v_rcp_f32 v31, v31
    v_mfma_f32_16x16x32_bf16 v[44:47], a[192:195], a[60:63], v[44:47]
    ds_read_b64_tr_b16 a[208:209], v18 offset:14336
    v_mul_f32 v26, v26, v30
    v_mfma_f32_16x16x32_bf16 v[60:63], a[196:199], a[60:63], v[60:63]
    ds_read_b64_tr_b16 a[210:211], v18 offset:15360
    v_mul_f32 v27, v27, v31
    v_mfma_f32_16x16x32_bf16 v[56:59], a[196:199], a[56:59], v[56:59]
    buffer_atomic_or v129, v3, s[24:27], 0 offen offset:256
    v_mfma_f32_16x16x32_bf16 v[40:43], a[192:195], a[56:59], v[40:43]
    buffer_store_dwordx4 v[220:223], v7, s[24:27], s55 offen sc1
    v_mfma_f32_16x16x32_bf16 v[36:39], a[192:195], a[52:55], v[36:39]
    s_xor_b32 s55, s55, 3072
    ds_read_b64_tr_b16 a[212:213], v19 offset:14336
    v_cvt_pk_bf16_f32 v176, v26, v27
    v_mfma_f32_16x16x32_bf16 v[52:55], a[196:199], a[52:55], v[52:55]
    s_add_u32 s55, s55, 16384
    ds_read_b64_tr_b16 a[214:215], v19 offset:15360
    v_lshlrev_b32 v26, 16, v153
    v_mfma_f32_16x16x32_bf16 v[48:51], a[196:199], a[48:51], v[48:51]
    v_and_b32 v27, 0xffff0000, v153
    v_fma_f32 v26, v26, v25, v24
    v_mfma_f32_16x16x32_bf16 v[32:35], a[192:195], a[48:51], v[32:35]
    s_waitcnt lgkmcnt(4)
    v_fma_f32 v27, v27, v25, v24
    v_mul_f32 v30, s92, v26
    v_mfma_f32_16x16x32_bf16 v[32:35], a[200:203], a[64:67], v[32:35]
    s_load_dword s67, s[86:87], s5 glc
    v_mul_f32 v31, s92, v27
    v_mfma_f32_16x16x32_bf16 v[48:51], a[204:207], a[64:67], v[48:51]
    v_exp_f32 v30, v30
    v_mfma_f32_16x16x32_bf16 v[52:55], a[204:207], a[68:71], v[52:55]
    v_exp_f32 v31, v31
    v_mfma_f32_16x16x32_bf16 v[36:39], a[200:203], a[68:71], v[36:39]
    v_add_f32 v30, 1.0, v30
    v_add_f32 v31, 1.0, v31
    v_mfma_f32_16x16x32_bf16 v[40:43], a[200:203], a[72:75], v[40:43]
    v_rcp_f32 v30, v30
    v_mfma_f32_16x16x32_bf16 v[56:59], a[204:207], a[72:75], v[56:59]
    v_rcp_f32 v31, v31
    v_mfma_f32_16x16x32_bf16 v[60:63], a[204:207], a[76:79], v[60:63]
    v_mul_f32 v26, v26, v30
    v_mul_f32 v27, v27, v31
    v_mfma_f32_16x16x32_bf16 v[44:47], a[200:203], a[76:79], v[44:47]
    s_waitcnt lgkmcnt(0)
    v_cvt_pk_bf16_f32 v177, v26, v27
    v_lshlrev_b32 v26, 16, v154
    v_mfma_f32_16x16x32_bf16 v[44:47], a[208:211], a[92:95], v[44:47]
    v_and_b32 v27, 0xffff0000, v154
    v_fma_f32 v26, v26, v25, v24
    v_mfma_f32_16x16x32_bf16 v[60:63], a[212:215], a[92:95], v[60:63]
    v_fma_f32 v27, v27, v25, v24
    v_mul_f32 v30, s92, v26
    v_mfma_f32_16x16x32_bf16 v[56:59], a[212:215], a[88:91], v[56:59]
    v_mul_f32 v31, s92, v27
    v_mfma_f32_16x16x32_bf16 v[40:43], a[208:211], a[88:91], v[40:43]
    v_exp_f32 v30, v30
    v_mfma_f32_16x16x32_bf16 v[36:39], a[208:211], a[84:87], v[36:39]
    v_exp_f32 v31, v31
    v_mfma_f32_16x16x32_bf16 v[52:55], a[212:215], a[84:87], v[52:55]
    v_add_f32 v30, 1.0, v30
    v_add_f32 v31, 1.0, v31
    v_mfma_f32_16x16x32_bf16 v[48:51], a[212:215], a[80:83], v[48:51]
    v_rcp_f32 v30, v30
    v_mfma_f32_16x16x32_bf16 v[32:35], a[208:211], a[80:83], v[32:35]
    v_rcp_f32 v31, v31
    s_nop 7
    v_cvt_pk_bf16_f32 v32, v32, v33
    v_cvt_pk_bf16_f32 v33, v34, v35
    v_cvt_pk_bf16_f32 v34, v48, v49
    v_cvt_pk_bf16_f32 v35, v50, v51
    buffer_store_dwordx4 v[32:35], v6, s[24:27], s55 offen sc1
    s_xor_b32 s55, s55, 1024
    v_cvt_pk_bf16_f32 v36, v36, v37
    v_cvt_pk_bf16_f32 v37, v38, v39
    v_cvt_pk_bf16_f32 v38, v52, v53
    v_cvt_pk_bf16_f32 v39, v54, v55
    buffer_store_dwordx4 v[36:39], v6, s[24:27], s55 offen sc1
    s_xor_b32 s55, s55, 3072
    v_cvt_pk_bf16_f32 v40, v40, v41
    v_cvt_pk_bf16_f32 v41, v42, v43
    v_cvt_pk_bf16_f32 v42, v56, v57
    v_cvt_pk_bf16_f32 v43, v58, v59
    buffer_store_dwordx4 v[40:43], v7, s[24:27], s55 offen sc1
    s_xor_b32 s55, s55, 1024
    v_cvt_pk_bf16_f32 v44, v44, v45
    v_cvt_pk_bf16_f32 v45, v46, v47
    v_cvt_pk_bf16_f32 v46, v60, v61
    v_cvt_pk_bf16_f32 v47, v62, v63
    buffer_store_dwordx4 v[44:47], v7, s[24:27], s55 offen sc1
    s_xor_b32 s55, s55, 3072
    s_add_u32 s55, s55, 16384
    v_mul_f32 v26, v26, v30
    v_mul_f32 v27, v27, v31
    v_cvt_pk_bf16_f32 v178, v26, v27
    v_lshlrev_b32 v26, 16, v155
    v_and_b32 v27, 0xffff0000, v155
    v_fma_f32 v26, v26, v25, v24
    v_fma_f32 v27, v27, v25, v24
    v_mul_f32 v30, s92, v26
    v_mul_f32 v31, s92, v27
    v_exp_f32 v30, v30
    v_exp_f32 v31, v31
    s_nop 0
    v_add_f32 v30, 1.0, v30
    v_add_f32 v31, 1.0, v31
    v_rcp_f32 v30, v30
    v_rcp_f32 v31, v31
    s_nop 0
    v_mul_f32 v26, v26, v30
    v_mul_f32 v27, v27, v31
    v_cvt_pk_bf16_f32 v179, v26, v27
    s_waitcnt vmcnt(37)
    v_lshlrev_b32 v26, 16, v160
    v_and_b32 v27, 0xffff0000, v160
    v_fma_f32 v26, v26, v25, v24
    v_fma_f32 v27, v27, v25, v24
    v_mul_f32 v30, s92, v26
    v_mul_f32 v31, s92, v27
    v_exp_f32 v30, v30
    v_exp_f32 v31, v31
    s_nop 0
    v_add_f32 v30, 1.0, v30
    v_add_f32 v31, 1.0, v31
    v_rcp_f32 v30, v30
    v_rcp_f32 v31, v31
    s_nop 0
    v_mul_f32 v26, v26, v30
    v_mul_f32 v27, v27, v31
    v_cvt_pk_bf16_f32 v184, v26, v27
    v_lshlrev_b32 v26, 16, v161
    v_and_b32 v27, 0xffff0000, v161
    v_fma_f32 v26, v26, v25, v24
    v_fma_f32 v27, v27, v25, v24
    v_mul_f32 v30, s92, v26
    v_mul_f32 v31, s92, v27
    v_exp_f32 v30, v30
    v_exp_f32 v31, v31
    s_nop 0
    v_add_f32 v30, 1.0, v30
    v_add_f32 v31, 1.0, v31
    v_rcp_f32 v30, v30
    v_rcp_f32 v31, v31
    s_nop 0
    v_mul_f32 v26, v26, v30
    v_mul_f32 v27, v27, v31
    v_cvt_pk_bf16_f32 v185, v26, v27
    v_lshlrev_b32 v26, 16, v162
    v_and_b32 v27, 0xffff0000, v162
    v_fma_f32 v26, v26, v25, v24
    v_fma_f32 v27, v27, v25, v24
    v_mul_f32 v30, s92, v26
    v_mul_f32 v31, s92, v27
    v_exp_f32 v30, v30
    v_exp_f32 v31, v31
    s_nop 0
    v_add_f32 v30, 1.0, v30
    v_add_f32 v31, 1.0, v31
    v_rcp_f32 v30, v30
    v_rcp_f32 v31, v31
    s_nop 0
    v_mul_f32 v26, v26, v30
    v_mul_f32 v27, v27, v31
    v_cvt_pk_bf16_f32 v186, v26, v27
    v_lshlrev_b32 v26, 16, v163
    v_and_b32 v27, 0xffff0000, v163
    v_fma_f32 v26, v26, v25, v24
    v_fma_f32 v27, v27, v25, v24
    v_mul_f32 v30, s92, v26
    v_mul_f32 v31, s92, v27
    v_exp_f32 v30, v30
    v_exp_f32 v31, v31
    s_nop 0
    v_add_f32 v30, 1.0, v30
    v_add_f32 v31, 1.0, v31
    v_rcp_f32 v30, v30
    v_rcp_f32 v31, v31
    s_nop 0
    v_mul_f32 v26, v26, v30
    v_mul_f32 v27, v27, v31
    v_cvt_pk_bf16_f32 v187, v26, v27
post_code:
    s_cmp_ge_u32 s3, 2
    s_cselect_b32 s60, 0, 0xff00
    s_mov_b32 s9, 1
    s_mov_b32 s55, s68
    s_waitcnt vmcnt(4) lgkmcnt(0)
    buffer_atomic_or v130, v3, s[24:27], 0 offen offset:256
    s_andn2_b32 s69, s67, s68
    s_load_dword s67, s[86:87], s5 glc
    s_or_b32 s68, s68, s69
    s_and_b32 s8, s69, 0xff00ff
    s_andn2_b32 s69, s69, s8
    s_cmp_lg_u32 s8, 0
    s_cbranch_scc0 e0_issued
e0_iss:
    s_ff1_i32_b32 s56, s8
    v_readlane_b32 s57, v23, s56
    s_lshl_b32 s39, s56, 10
    s_add_u32 m0, s37, s39
    s_bitset0_b32 s8, s56
    s_add_u32 s9, s9, 1
    s_cmp_lg_u32 s8, 0
    buffer_load_dwordx4 v28, s[24:27], s57 offen sc1 lds
    s_cbranch_scc1 e0_iss
e0_issued:
w4:
    s_getreg_b32 s56, hwreg(HW_REG_IB_STS)
    s_bfe_u32 s57, s56, 0x20016
    s_and_b32 s56, s56, 15
    s_lshl4_add_u32 s56, s57, s56
    s_cmp_gt_u32 s56, s9
    s_cbranch_scc1 w4
    buffer_atomic_or v130, v3, s[24:27], 0 offen offset:0
    s_lshr_b32 s56, s53, 1
    s_cmp_eq_u32 s56, s3
    s_cbranch_scc0 own_share_ret
    s_lshl_b32 s56, s53, 10
    v_add_u32 v8, s56, v28
    v_add_u32 v11, 57344, v8
    v_add_u32 v10, 32768, v8
    v_add_u32 v9, 8192, v8
    v_add_u32 v8, 0, v8
    s_bitcmp1_b32 s53, 0
    s_cbranch_scc1 own_odd
    ds_write_b128 v8, v[32:35] offset:16384
    ds_write_b128 v9, v[36:39] offset:16384
    ds_write_b128 v10, v[196:199] offset:16384
    ds_write_b128 v11, v[204:207] offset:16384
    ds_write_b128 v10, v[132:135] offset:8192
    ds_write_b128 v11, v[140:143] offset:8192
    ds_write_b128 v10, v[68:71] offset:0
    ds_write_b128 v11, v[76:79] offset:0
    ds_write_b128 v8, v[64:67] offset:0
    ds_write_b128 v9, v[80:83] offset:0
    s_branch own_share_ret
own_odd:
    ds_write_b128 v8, v[40:43] offset:16384
    ds_write_b128 v9, v[44:47] offset:16384
    ds_write_b128 v10, v[212:215] offset:16384
    ds_write_b128 v11, v[220:223] offset:16384
    ds_write_b128 v10, v[148:151] offset:8192
    ds_write_b128 v11, v[156:159] offset:8192
    ds_write_b128 v10, v[84:87] offset:0
    ds_write_b128 v11, v[92:95] offset:0
    ds_write_b128 v8, v[96:99] offset:0
    ds_write_b128 v9, v[112:115] offset:0
own_share_ret:
    s_cmp_lg_u32 s69, 0
    s_cbranch_scc0 e1_issued
e1_iss:
    s_ff1_i32_b32 s56, s69
    v_readlane_b32 s57, v23, s56
    s_lshl_b32 s39, s56, 10
    s_add_u32 m0, s37, s39
    s_bitset0_b32 s69, s56
    s_add_u32 s9, s9, 1
    s_cmp_lg_u32 s69, 0
    buffer_load_dwordx4 v28, s[24:27], s57 offen sc1 lds
    s_cbranch_scc1 e1_iss
e1_issued:
    s_waitcnt lgkmcnt(0)
    s_barrier
    s_cmp_lg_u64 s[88:89], 0
    s_cbranch_scc1 routed
routed_ret:
ev_loop:
    s_waitcnt lgkmcnt(0)
    s_getreg_b32 s56, hwreg(HW_REG_IB_STS)
    s_and_b32 s56, s56, 0xc0000f
    s_cselect_b32 s55, s55, s68
    s_andn2_b32 s69, s67, s68
    s_or_b32 s68, s68, s69
    s_cmp_eq_u32 s68, 0xffffff
    s_cbranch_scc1 ev_nopoll
    s_load_dword s67, s[86:87], s5 glc
ev_nopoll:
    s_cmp_lg_u32 s69, 0
    s_cbranch_scc0 ev_issued
ev_iss:
    s_ff1_i32_b32 s56, s69
    v_readlane_b32 s57, v23, s56
    s_lshl_b32 s39, s56, 10
    s_add_u32 m0, s37, s39
    s_bitset0_b32 s69, s56
    s_add_u32 s9, s9, 1
    s_cmp_lg_u32 s69, 0
    buffer_load_dwordx4 v28, s[24:27], s57 offen sc1 lds
    s_cbranch_scc1 ev_iss
ev_issued:
ev_sel:
    s_andn2_b32 s8, s55, s60
    s_bfe_u32 s56, s8, 524288
    s_cmp_eq_u32 s56, 0xff
    s_cbranch_scc0 ev_r0
    s_or_b32 s60, s60, 255
    s_mov_b32 s38, s41
    ds_read_b128 v[132:135], v4 offset:0
    ds_read_b128 v[140:143], v4 offset:1024
    ds_read_b128 v[148:151], v4 offset:2048
    ds_read_b128 v[156:159], v4 offset:3072
    ds_read_b128 v[164:167], v4 offset:4096
    ds_read_b128 v[172:175], v4 offset:5120
    ds_read_b128 v[180:183], v4 offset:6144
    ds_read_b128 v[188:191], v4 offset:7168
    v_lshlrev_b32 v84, 16, v168
    v_and_b32 v85, 0xffff0000, v168
    v_lshlrev_b32 v100, 16, v144
    v_and_b32 v101, 0xffff0000, v144
    v_lshlrev_b32 v86, 16, v169
    v_and_b32 v87, 0xffff0000, v169
    v_lshlrev_b32 v102, 16, v145
    v_and_b32 v103, 0xffff0000, v145
    v_lshlrev_b32 v92, 16, v170
    v_and_b32 v93, 0xffff0000, v170
    v_lshlrev_b32 v108, 16, v146
    v_and_b32 v109, 0xffff0000, v146
    v_lshlrev_b32 v94, 16, v171
    v_and_b32 v95, 0xffff0000, v171
    v_lshlrev_b32 v110, 16, v147
    v_and_b32 v111, 0xffff0000, v147
    s_branch ev_go
ev_r0:
    s_bfe_u32 s56, s8, 524296
    s_cmp_eq_u32 s56, 0xff
    s_cbranch_scc0 ev_r1
    s_or_b32 s60, s60, 65280
    s_mov_b32 s38, s42
    ds_read_b128 v[132:135], v4 offset:8192
    ds_read_b128 v[140:143], v4 offset:9216
    ds_read_b128 v[148:151], v4 offset:10240
    ds_read_b128 v[156:159], v4 offset:11264
    ds_read_b128 v[164:167], v4 offset:12288
    ds_read_b128 v[172:175], v4 offset:13312
    ds_read_b128 v[180:183], v4 offset:14336
    ds_read_b128 v[188:191], v4 offset:15360
    v_lshlrev_b32 v84, 16, v176
    v_and_b32 v85, 0xffff0000, v176
    v_lshlrev_b32 v100, 16, v152
    v_and_b32 v101, 0xffff0000, v152
    v_lshlrev_b32 v86, 16, v177
    v_and_b32 v87, 0xffff0000, v177
    v_lshlrev_b32 v102, 16, v153
    v_and_b32 v103, 0xffff0000, v153
    v_lshlrev_b32 v92, 16, v178
    v_and_b32 v93, 0xffff0000, v178
    v_lshlrev_b32 v108, 16, v154
    v_and_b32 v109, 0xffff0000, v154
    v_lshlrev_b32 v94, 16, v179
    v_and_b32 v95, 0xffff0000, v179
    v_lshlrev_b32 v110, 16, v155
    v_and_b32 v111, 0xffff0000, v155
    s_branch ev_go
ev_r1:
    s_bfe_u32 s56, s8, 524304
    s_cmp_eq_u32 s56, 0xff
    s_cbranch_scc0 ev_r2
    s_or_b32 s60, s60, 16711680
    s_mov_b32 s38, s43
    ds_read_b128 v[132:135], v4 offset:16384
    ds_read_b128 v[140:143], v4 offset:17408
    ds_read_b128 v[148:151], v4 offset:18432
    ds_read_b128 v[156:159], v4 offset:19456
    ds_read_b128 v[164:167], v4 offset:20480
    ds_read_b128 v[172:175], v4 offset:21504
    ds_read_b128 v[180:183], v4 offset:22528
    ds_read_b128 v[188:191], v4 offset:23552
    v_lshlrev_b32 v84, 16, v184
    v_and_b32 v85, 0xffff0000, v184
    v_lshlrev_b32 v100, 16, v160
    v_and_b32 v101, 0xffff0000, v160
    v_lshlrev_b32 v86, 16, v185
    v_and_b32 v87, 0xffff0000, v185
    v_lshlrev_b32 v102, 16, v161
    v_and_b32 v103, 0xffff0000, v161
    v_lshlrev_b32 v92, 16, v186
    v_and_b32 v93, 0xffff0000, v186
    v_lshlrev_b32 v108, 16, v162
    v_and_b32 v109, 0xffff0000, v162
    v_lshlrev_b32 v94, 16, v187
    v_and_b32 v95, 0xffff0000, v187
    v_lshlrev_b32 v110, 16, v163
    v_and_b32 v111, 0xffff0000, v163
    s_branch ev_go
ev_r2:
    s_cmp_eq_u32 s68, 0xffffff
    s_cbranch_scc0 ev_more
    s_waitcnt vmcnt(0)
    s_mov_b32 s55, s68
    s_branch ev_sel
ev_more:
    s_add_u32 s101, s101, 1
    s_cmp_gt_u32 s101, 0x2000000
    s_cbranch_scc0 ev_loop
    s_branch ev_done
ev_go:
    s_waitcnt lgkmcnt(7)
    v_mfma_f32_16x16x32_bf16 v[68:71], v[208:211], v[132:135], 0
    v_mfma_f32_16x16x32_bf16 v[76:79], v[216:219], v[132:135], 0
    s_waitcnt lgkmcnt(6)
    v_mfma_f32_16x16x32_bf16 v[68:71], v[208:211], v[140:143], v[68:71]
    v_mfma_f32_16x16x32_bf16 v[76:79], v[216:219], v[140:143], v[76:79]
    s_waitcnt lgkmcnt(5)
    v_mfma_f32_16x16x32_bf16 v[68:71], v[208:211], v[148:151], v[68:71]
    v_mfma_f32_16x16x32_bf16 v[76:79], v[216:219], v[148:151], v[76:79]
    s_waitcnt lgkmcnt(4)
    v_mfma_f32_16x16x32_bf16 v[68:71], v[208:211], v[156:159], v[68:71]
    v_mfma_f32_16x16x32_bf16 v[76:79], v[216:219], v[156:159], v[76:79]
    s_waitcnt lgkmcnt(3)
    v_mfma_f32_16x16x32_bf16 v[68:71], v[208:211], v[164:167], v[68:71]
    v_mfma_f32_16x16x32_bf16 v[76:79], v[216:219], v[164:167], v[76:79]
    s_waitcnt lgkmcnt(2)
    v_mfma_f32_16x16x32_bf16 v[68:71], v[208:211], v[172:175], v[68:71]
    v_mfma_f32_16x16x32_bf16 v[76:79], v[216:219], v[172:175], v[76:79]
    s_waitcnt lgkmcnt(1)
    v_mfma_f32_16x16x32_bf16 v[68:71], v[208:211], v[180:183], v[68:71]
    v_mfma_f32_16x16x32_bf16 v[76:79], v[216:219], v[180:183], v[76:79]
    s_waitcnt lgkmcnt(0)
    v_mfma_f32_16x16x32_bf16 v[68:71], v[208:211], v[188:191], v[68:71]
    v_mfma_f32_16x16x32_bf16 v[76:79], v[216:219], v[188:191], v[76:79]
    s_nop 6
    v_pk_fma_f32 v[68:69], v[68:69], v[84:85], v[100:101]
    v_pk_fma_f32 v[70:71], v[70:71], v[86:87], v[102:103]
    v_pk_fma_f32 v[76:77], v[76:77], v[92:93], v[108:109]
    v_pk_fma_f32 v[78:79], v[78:79], v[94:95], v[110:111]
    v_cvt_pk_bf16_f32 v124, v68, v69
    v_cvt_pk_bf16_f32 v125, v70, v71
    v_cvt_pk_bf16_f32 v126, v76, v77
    v_cvt_pk_bf16_f32 v127, v78, v79
    buffer_store_dwordx4 v[124:127], v22, s[32:35], s38 offen sc1
    s_cmp_lg_u32 s60, 0xffffff
    s_cbranch_scc1 ev_sel
ev_done:
    s_or_b32 s56, s2, s3
    s_cbranch_scc1 main_fin
    v_mov_b32 v8, s7
    v_mov_b32 v9, 3203072
    s_mov_b64 exec, 1
    buffer_store_dword v8, v9, s[24:27], 0 offen
main_fin:
main_end:
    s_endpgm
spin_o0:
    s_load_dword s72, s[86:87], s5 offset:4 glc
    s_add_u32 s101, s101, 1
    s_cmp_gt_u32 s101, 0x2000000
    s_waitcnt lgkmcnt(0)
    s_cbranch_scc1 spin_o0_ret
    s_bfe_u32 s88, s72, 262144
    s_cmp_lg_u32 s88, 15
    s_cbranch_scc1 spin_o0
    s_branch spin_o0_ret
spin_o1:
    s_load_dword s72, s[86:87], s5 offset:4 glc
    s_add_u32 s101, s101, 1
    s_cmp_gt_u32 s101, 0x2000000
    s_waitcnt lgkmcnt(0)
    s_cbranch_scc1 spin_o1_ret
    s_bfe_u32 s88, s72, 262148
    s_cmp_lg_u32 s88, 15
    s_cbranch_scc1 spin_o1
    s_branch spin_o1_ret
spin_o2:
    s_load_dword s72, s[86:87], s5 offset:4 glc
    s_add_u32 s101, s101, 1
    s_cmp_gt_u32 s101, 0x2000000
    s_waitcnt lgkmcnt(0)
    s_cbranch_scc1 spin_o2_ret
    s_bfe_u32 s88, s72, 262152
    s_cmp_lg_u32 s88, 15
    s_cbranch_scc1 spin_o2
    s_branch spin_o2_ret
spin_o3:
    s_load_dword s72, s[86:87], s5 offset:4 glc
    s_add_u32 s101, s101, 1
    s_cmp_gt_u32 s101, 0x2000000
    s_waitcnt lgkmcnt(0)
    s_cbranch_scc1 spin_o3_ret
    s_bfe_u32 s88, s72, 262156
    s_cmp_lg_u32 s88, 15
    s_cbranch_scc1 spin_o3
    s_branch spin_o3_ret
spin_o4:
    s_load_dword s72, s[86:87], s5 offset:4 glc
    s_add_u32 s101, s101, 1
    s_cmp_gt_u32 s101, 0x2000000
    s_waitcnt lgkmcnt(0)
    s_cbranch_scc1 spin_o4_ret
    s_bfe_u32 s88, s72, 262160
    s_cmp_lg_u32 s88, 15
    s_cbranch_scc1 spin_o4
    s_branch spin_o4_ret
spin_o5:
    s_load_dword s72, s[86:87], s5 offset:4 glc
    s_add_u32 s101, s101, 1
    s_cmp_gt_u32 s101, 0x2000000
    s_waitcnt lgkmcnt(0)
    s_cbranch_scc1 spin_o5_ret
    s_bfe_u32 s88, s72, 262164
    s_cmp_lg_u32 s88, 15
    s_cbranch_scc1 spin_o5
    s_branch spin_o5_ret
routed:
    s_cmp_eq_u32 s44, s59
    s_cbranch_scc0 spin_y
spin_y_ret:
    v_cvt_pk_bf16_f32 v200, v240, v241
    v_cvt_pk_bf16_f32 v201, v242, v243
    v_lshlrev_b32 v240, 16, v200
    v_and_b32 v241, 0xffff0000, v200
    v_lshlrev_b32 v242, 16, v201
    v_and_b32 v243, 0xffff0000, v201
    v_mul_f32 v240, v240, v195
    v_mul_f32 v241, v241, v195
    v_mul_f32 v242, v242, v195
    v_mul_f32 v243, v243, v195
    v_cvt_pk_bf16_f32 v200, v240, v241
    v_cvt_pk_bf16_f32 v201, v242, v243
    v_lshlrev_b32 v240, 16, v200
    v_and_b32 v241, 0xffff0000, v200
    v_lshlrev_b32 v242, 16, v201
    v_and_b32 v243, 0xffff0000, v201
    v_add_f32 v240, v240, v248
    v_add_f32 v241, v241, v249
    v_add_f32 v242, v242, v250
    v_add_f32 v243, v243, v251
    v_cvt_pk_bf16_f32 v200, v240, v241
    v_cvt_pk_bf16_f32 v201, v242, v243
    v_lshlrev_b32 v240, 16, v200
    v_and_b32 v241, 0xffff0000, v200
    v_lshlrev_b32 v242, 16, v201
    v_and_b32 v243, 0xffff0000, v201
    v_mul_f32 v200, s92, v240
    v_mul_f32 v201, s92, v241
    v_mul_f32 v202, s92, v242
    v_mul_f32 v203, s92, v243
    v_exp_f32 v200, v200
    v_exp_f32 v201, v201
    v_exp_f32 v202, v202
    v_exp_f32 v203, v203
    v_add_f32 v200, 1.0, v200
    v_add_f32 v201, 1.0, v201
    v_add_f32 v202, 1.0, v202
    v_add_f32 v203, 1.0, v203
    v_rcp_f32 v200, v200
    v_rcp_f32 v201, v201
    v_rcp_f32 v202, v202
    v_rcp_f32 v203, v203
    v_mul_f32 v240, v240, v200
    v_mul_f32 v241, v241, v201
    v_mul_f32 v242, v242, v202
    v_mul_f32 v243, v243, v203
    v_cvt_pk_bf16_f32 v240, v240, v241
    v_cvt_pk_bf16_f32 v241, v242, v243
    ds_write_b64 v138, v[240:241]
    s_mov_b64 exec, s[88:89]
    ds_read_b128 v[168:171], v139 offset:0
    ds_read_b128 v[176:179], v139 offset:64
    ds_read_b128 v[184:187], v139 offset:128
    s_waitcnt lgkmcnt(0)
    s_mov_b64 exec, -1
    s_branch routed_ret
spin_y:
    s_add_u32 s101, s101, 1
    s_cmp_gt_u32 s101, 0x2000000
    s_cbranch_scc1 spin_y_x
    buffer_load_dword v137, v136, s[24:27], s59 offen offset:128 sc1
    s_waitcnt vmcnt(0)
    v_cmp_ne_u32 vcc, 24, v137
    s_cbranch_vccnz spin_y
spin_y_x:
    buffer_load_dwordx4 v[240:243], v192, s[24:27], s59 offen sc1
    s_waitcnt vmcnt(0)
    s_branch spin_y_ret
spin_rec:
    s_add_u32 s101, s101, 1
    s_cmp_gt_u32 s101, 0x2000000
    s_cbranch_scc1 spin_rec_x
    buffer_load_dwordx4 v[32:35], v17, s[24:27], s47 offen offset:0 sc1
    buffer_load_dwordx4 v[36:39], v17, s[24:27], s47 offen offset:1024 sc1
    buffer_load_dwordx4 v[40:43], v17, s[24:27], s47 offen offset:2048 sc1
    buffer_load_dwordx4 v[44:47], v17, s[24:27], s47 offen offset:3072 sc1
    s_waitcnt vmcnt(0)
    v_xor_b32 v34, s7, v34
    v_xor_b32 v38, s7, v38
    v_xor_b32 v42, s7, v42
    v_xor_b32 v46, s7, v46
    v_or3_b32 v34, v34, v38, v42
    v_or_b32 v34, v34, v46
    v_cmp_ne_u32 vcc, 0, v34
    s_cbranch_vccnz spin_rec
spin_rec_x:
    s_branch spin_rec_ret
spin_gu:
    s_add_u32 s101, s101, 1
    s_cmp_gt_u32 s101, 0x2000000
    s_cbranch_scc1 spin_gu_x
    buffer_load_dword v61, v60, s[24:27], s37 offen sc1
    s_waitcnt vmcnt(0)
    v_cmp_ne_u32 vcc, s7, v61
    s_cbranch_vccnz spin_gu
spin_gu_x:
    s_branch spin_gu_ret
rare_p:
    s_nop 7
    s_nop 7
    v_max3_f32 v56, v68, v69, v70
    v_max3_f32 v56, v56, v71, v100
    v_max3_f32 v56, v56, v101, v102
    v_max3_f32 v56, v56, v103, v56
    v_mov_b32 v58, v56
    s_nop 1
    v_permlane16_swap_b32 v56, v58
    s_nop 1
    v_max_f32 v56, v56, v58
    v_mov_b32 v58, v56
    s_nop 1
    v_permlane32_swap_b32 v56, v58
    s_nop 1
    v_max_f32 v56, v56, v58
    v_add_f32 v56, 2.0, v56
    v_sub_f32 v32, v32, v56
    v_sub_f32 v33, v33, v56
    v_sub_f32 v34, v34, v56
    v_sub_f32 v35, v35, v56
    v_sub_f32 v68, v68, v56
    v_sub_f32 v69, v69, v56
    v_sub_f32 v70, v70, v56
    v_sub_f32 v71, v71, v56
    v_sub_f32 v100, v100, v56
    v_sub_f32 v101, v101, v56
    v_sub_f32 v102, v102, v56
    v_sub_f32 v103, v103, v56
    v_sub_f32 v132, v132, v56
    v_sub_f32 v133, v133, v56
    v_sub_f32 v134, v134, v56
    v_sub_f32 v135, v135, v56
    v_sub_f32 v164, v164, v56
    v_sub_f32 v165, v165, v56
    v_sub_f32 v166, v166, v56
    v_sub_f32 v167, v167, v56
    v_exp_f32 v48, v68
    v_exp_f32 v49, v69
    v_exp_f32 v50, v70
    v_exp_f32 v51, v71
    v_exp_f32 v52, v100
    v_exp_f32 v53, v101
    v_exp_f32 v54, v102
    v_exp_f32 v55, v103
    s_nop 0
    v_cvt_pk_bf16_f32 v196, v48, v49
    v_cvt_pk_bf16_f32 v197, v50, v51
    v_cvt_pk_bf16_f32 v198, v52, v53
    v_cvt_pk_bf16_f32 v199, v54, v55
    v_add_f32 v24, v48, v49
    v_add_f32 v24, v24, v50
    v_add_f32 v24, v24, v51
    v_add_f32 v24, v24, v52
    v_add_f32 v24, v24, v53
    v_add_f32 v24, v24, v54
    v_add_f32 v24, v24, v55
    v_max3_f32 v56, v76, v77, v78
    v_max3_f32 v56, v56, v79, v108
    v_max3_f32 v56, v56, v109, v110
    v_max3_f32 v56, v56, v111, v56
    v_mov_b32 v58, v56
    s_nop 1
    v_permlane16_swap_b32 v56, v58
    s_nop 1
    v_max_f32 v56, v56, v58
    v_mov_b32 v58, v56
    s_nop 1
    v_permlane32_swap_b32 v56, v58
    s_nop 1
    v_max_f32 v56, v56, v58
    v_add_f32 v56, 2.0, v56
    v_sub_f32 v36, v36, v56
    v_sub_f32 v37, v37, v56
    v_sub_f32 v38, v38, v56
    v_sub_f32 v39, v39, v56
    v_sub_f32 v76, v76, v56
    v_sub_f32 v77, v77, v56
    v_sub_f32 v78, v78, v56
    v_sub_f32 v79, v79, v56
    v_sub_f32 v108, v108, v56
    v_sub_f32 v109, v109, v56
    v_sub_f32 v110, v110, v56
    v_sub_f32 v111, v111, v56
    v_sub_f32 v140, v140, v56
    v_sub_f32 v141, v141, v56
    v_sub_f32 v142, v142, v56
    v_sub_f32 v143, v143, v56
    v_sub_f32 v172, v172, v56
    v_sub_f32 v173, v173, v56
    v_sub_f32 v174, v174, v56
    v_sub_f32 v175, v175, v56
    v_exp_f32 v48, v76
    v_exp_f32 v49, v77
    v_exp_f32 v50, v78
    v_exp_f32 v51, v79
    v_exp_f32 v52, v108
    v_exp_f32 v53, v109
    v_exp_f32 v54, v110
    v_exp_f32 v55, v111
    s_nop 0
    v_cvt_pk_bf16_f32 v204, v48, v49
    v_cvt_pk_bf16_f32 v205, v50, v51
    v_cvt_pk_bf16_f32 v206, v52, v53
    v_cvt_pk_bf16_f32 v207, v54, v55
    v_add_f32 v25, v48, v49
    v_add_f32 v25, v25, v50
    v_add_f32 v25, v25, v51
    v_add_f32 v25, v25, v52
    v_add_f32 v25, v25, v53
    v_add_f32 v25, v25, v54
    v_add_f32 v25, v25, v55
    v_max3_f32 v56, v84, v85, v86
    v_max3_f32 v56, v56, v87, v116
    v_max3_f32 v56, v56, v117, v118
    v_max3_f32 v56, v56, v119, v56
    v_mov_b32 v58, v56
    s_nop 1
    v_permlane16_swap_b32 v56, v58
    s_nop 1
    v_max_f32 v56, v56, v58
    v_mov_b32 v58, v56
    s_nop 1
    v_permlane32_swap_b32 v56, v58
    s_nop 1
    v_max_f32 v56, v56, v58
    v_add_f32 v56, 2.0, v56
    v_sub_f32 v40, v40, v56
    v_sub_f32 v41, v41, v56
    v_sub_f32 v42, v42, v56
    v_sub_f32 v43, v43, v56
    v_sub_f32 v84, v84, v56
    v_sub_f32 v85, v85, v56
    v_sub_f32 v86, v86, v56
    v_sub_f32 v87, v87, v56
    v_sub_f32 v116, v116, v56
    v_sub_f32 v117, v117, v56
    v_sub_f32 v118, v118, v56
    v_sub_f32 v119, v119, v56
    v_sub_f32 v148, v148, v56
    v_sub_f32 v149, v149, v56
    v_sub_f32 v150, v150, v56
    v_sub_f32 v151, v151, v56
    v_sub_f32 v180, v180, v56
    v_sub_f32 v181, v181, v56
    v_sub_f32 v182, v182, v56
    v_sub_f32 v183, v183, v56
    v_exp_f32 v48, v84
    v_exp_f32 v49, v85
    v_exp_f32 v50, v86
    v_exp_f32 v51, v87
    v_exp_f32 v52, v116
    v_exp_f32 v53, v117
    v_exp_f32 v54, v118
    v_exp_f32 v55, v119
    s_nop 0
    v_cvt_pk_bf16_f32 v212, v48, v49
    v_cvt_pk_bf16_f32 v213, v50, v51
    v_cvt_pk_bf16_f32 v214, v52, v53
    v_cvt_pk_bf16_f32 v215, v54, v55
    v_add_f32 v26, v48, v49
    v_add_f32 v26, v26, v50
    v_add_f32 v26, v26, v51
    v_add_f32 v26, v26, v52
    v_add_f32 v26, v26, v53
    v_add_f32 v26, v26, v54
    v_add_f32 v26, v26, v55
    v_max3_f32 v56, v92, v93, v94
    v_max3_f32 v56, v56, v95, v124
    v_max3_f32 v56, v56, v125, v126
    v_max3_f32 v56, v56, v127, v56
    v_mov_b32 v58, v56
    s_nop 1
    v_permlane16_swap_b32 v56, v58
    s_nop 1
    v_max_f32 v56, v56, v58
    v_mov_b32 v58, v56
    s_nop 1
    v_permlane32_swap_b32 v56, v58
    s_nop 1
    v_max_f32 v56, v56, v58
    v_add_f32 v56, 2.0, v56
    v_sub_f32 v44, v44, v56
    v_sub_f32 v45, v45, v56
    v_sub_f32 v46, v46, v56
    v_sub_f32 v47, v47, v56
    v_sub_f32 v92, v92, v56
    v_sub_f32 v93, v93, v56
    v_sub_f32 v94, v94, v56
    v_sub_f32 v95, v95, v56
    v_sub_f32 v124, v124, v56
    v_sub_f32 v125, v125, v56
    v_sub_f32 v126, v126, v56
    v_sub_f32 v127, v127, v56
    v_sub_f32 v156, v156, v56
    v_sub_f32 v157, v157, v56
    v_sub_f32 v158, v158, v56
    v_sub_f32 v159, v159, v56
    v_sub_f32 v188, v188, v56
    v_sub_f32 v189, v189, v56
    v_sub_f32 v190, v190, v56
    v_sub_f32 v191, v191, v56
    v_exp_f32 v48, v92
    v_exp_f32 v49, v93
    v_exp_f32 v50, v94
    v_exp_f32 v51, v95
    v_exp_f32 v52, v124
    v_exp_f32 v53, v125
    v_exp_f32 v54, v126
    v_exp_f32 v55, v127
    s_nop 0
    v_cvt_pk_bf16_f32 v220, v48, v49
    v_cvt_pk_bf16_f32 v221, v50, v51
    v_cvt_pk_bf16_f32 v222, v52, v53
    v_cvt_pk_bf16_f32 v223, v54, v55
    v_add_f32 v27, v48, v49
    v_add_f32 v27, v27, v50
    v_add_f32 v27, v27, v51
    v_add_f32 v27, v27, v52
    v_add_f32 v27, v27, v53
    v_add_f32 v27, v27, v54
    v_add_f32 v27, v27, v55
    s_nop 1
    s_branch rare_p_ret
rare_a:
    s_nop 7
    s_nop 7
    v_max3_f32 v56, v132, v133, v134
    v_max3_f32 v56, v56, v135, v164
    v_max3_f32 v56, v56, v165, v166
    v_max3_f32 v56, v56, v167, 0
    v_mov_b32 v58, v56
    s_nop 1
    v_permlane16_swap_b32 v56, v58
    s_nop 1
    v_max_f32 v56, v56, v58
    v_mov_b32 v58, v56
    s_nop 1
    v_permlane32_swap_b32 v56, v58
    s_nop 1
    v_max_f32 v56, v56, v58
    v_exp_f32 v57, -v56
    v_sub_f32 v32, v32, v56
    v_sub_f32 v33, v33, v56
    v_sub_f32 v34, v34, v56
    v_sub_f32 v35, v35, v56
    v_mul_f32 v20, v20, v57
    v_sub_f32 v58, 1.0, v57
    v_sub_f32 v132, v132, v56
    v_sub_f32 v133, v133, v56
    v_sub_f32 v134, v134, v56
    v_sub_f32 v135, v135, v56
    v_sub_f32 v164, v164, v56
    v_sub_f32 v165, v165, v56
    v_sub_f32 v166, v166, v56
    v_sub_f32 v167, v167, v56
    v_sub_f32 v68, v68, v56
    v_sub_f32 v69, v69, v56
    v_sub_f32 v70, v70, v56
    v_sub_f32 v71, v71, v56
    v_sub_f32 v100, v100, v56
    v_sub_f32 v101, v101, v56
    v_sub_f32 v102, v102, v56
    v_sub_f32 v103, v103, v56
    v_accvgpr_read_b32 v48, a0
    v_accvgpr_read_b32 v49, a1
    v_accvgpr_read_b32 v50, a2
    v_accvgpr_read_b32 v51, a3
    v_fma_f32 v48, v48, v57, v58
    v_fma_f32 v49, v49, v57, v58
    v_fma_f32 v50, v50, v57, v58
    v_fma_f32 v51, v51, v57, v58
    v_accvgpr_write_b32 a0, v48
    v_accvgpr_write_b32 a1, v49
    v_accvgpr_write_b32 a2, v50
    v_accvgpr_write_b32 a3, v51
    v_accvgpr_read_b32 v48, a16
    v_accvgpr_read_b32 v49, a17
    v_accvgpr_read_b32 v50, a18
    v_accvgpr_read_b32 v51, a19
    v_fma_f32 v48, v48, v57, v58
    v_fma_f32 v49, v49, v57, v58
    v_fma_f32 v50, v50, v57, v58
    v_fma_f32 v51, v51, v57, v58
    v_accvgpr_write_b32 a16, v48
    v_accvgpr_write_b32 a17, v49
    v_accvgpr_write_b32 a18, v50
    v_accvgpr_write_b32 a19, v51
    v_accvgpr_read_b32 v48, a32
    v_accvgpr_read_b32 v49, a33
    v_accvgpr_read_b32 v50, a34
    v_accvgpr_read_b32 v51, a35
    v_fma_f32 v48, v48, v57, v58
    v_fma_f32 v49, v49, v57, v58
    v_fma_f32 v50, v50, v57, v58
    v_fma_f32 v51, v51, v57, v58
    v_accvgpr_write_b32 a32, v48
    v_accvgpr_write_b32 a33, v49
    v_accvgpr_write_b32 a34, v50
    v_accvgpr_write_b32 a35, v51
    v_accvgpr_read_b32 v48, a48
    v_accvgpr_read_b32 v49, a49
    v_accvgpr_read_b32 v50, a50
    v_accvgpr_read_b32 v51, a51
    v_fma_f32 v48, v48, v57, v58
    v_fma_f32 v49, v49, v57, v58
    v_fma_f32 v50, v50, v57, v58
    v_fma_f32 v51, v51, v57, v58
    v_accvgpr_write_b32 a48, v48
    v_accvgpr_write_b32 a49, v49
    v_accvgpr_write_b32 a50, v50
    v_accvgpr_write_b32 a51, v51
    v_accvgpr_read_b32 v48, a64
    v_accvgpr_read_b32 v49, a65
    v_accvgpr_read_b32 v50, a66
    v_accvgpr_read_b32 v51, a67
    v_fma_f32 v48, v48, v57, v58
    v_fma_f32 v49, v49, v57, v58
    v_fma_f32 v50, v50, v57, v58
    v_fma_f32 v51, v51, v57, v58
    v_accvgpr_write_b32 a64, v48
    v_accvgpr_write_b32 a65, v49
    v_accvgpr_write_b32 a66, v50
    v_accvgpr_write_b32 a67, v51
    v_accvgpr_read_b32 v48, a80
    v_accvgpr_read_b32 v49, a81
    v_accvgpr_read_b32 v50, a82
    v_accvgpr_read_b32 v51, a83
    v_fma_f32 v48, v48, v57, v58
    v_fma_f32 v49, v49, v57, v58
    v_fma_f32 v50, v50, v57, v58
    v_fma_f32 v51, v51, v57, v58
    v_accvgpr_write_b32 a80, v48
    v_accvgpr_write_b32 a81, v49
    v_accvgpr_write_b32 a82, v50
    v_accvgpr_write_b32 a83, v51
    v_accvgpr_read_b32 v48, a96
    v_accvgpr_read_b32 v49, a97
    v_accvgpr_read_b32 v50, a98
    v_accvgpr_read_b32 v51, a99
    v_fma_f32 v48, v48, v57, v58
    v_fma_f32 v49, v49, v57, v58
    v_fma_f32 v50, v50, v57, v58
    v_fma_f32 v51, v51, v57, v58
    v_accvgpr_write_b32 a96, v48
    v_accvgpr_write_b32 a97, v49
    v_accvgpr_write_b32 a98, v50
    v_accvgpr_write_b32 a99, v51
    v_accvgpr_read_b32 v48, a112
    v_accvgpr_read_b32 v49, a113
    v_accvgpr_read_b32 v50, a114
    v_accvgpr_read_b32 v51, a115
    v_fma_f32 v48, v48, v57, v58
    v_fma_f32 v49, v49, v57, v58
    v_fma_f32 v50, v50, v57, v58
    v_fma_f32 v51, v51, v57, v58
    v_accvgpr_write_b32 a112, v48
    v_accvgpr_write_b32 a113, v49
    v_accvgpr_write_b32 a114, v50
    v_accvgpr_write_b32 a115, v51
    v_accvgpr_read_b32 v48, a128
    v_accvgpr_read_b32 v49, a129
    v_accvgpr_read_b32 v50, a130
    v_accvgpr_read_b32 v51, a131
    v_fma_f32 v48, v48, v57, v58
    v_fma_f32 v49, v49, v57, v58
    v_fma_f32 v50, v50, v57, v58
    v_fma_f32 v51, v51, v57, v58
    v_accvgpr_write_b32 a128, v48
    v_accvgpr_write_b32 a129, v49
    v_accvgpr_write_b32 a130, v50
    v_accvgpr_write_b32 a131, v51
    v_accvgpr_read_b32 v48, a144
    v_accvgpr_read_b32 v49, a145
    v_accvgpr_read_b32 v50, a146
    v_accvgpr_read_b32 v51, a147
    v_fma_f32 v48, v48, v57, v58
    v_fma_f32 v49, v49, v57, v58
    v_fma_f32 v50, v50, v57, v58
    v_fma_f32 v51, v51, v57, v58
    v_accvgpr_write_b32 a144, v48
    v_accvgpr_write_b32 a145, v49
    v_accvgpr_write_b32 a146, v50
    v_accvgpr_write_b32 a147, v51
    v_accvgpr_read_b32 v48, a160
    v_accvgpr_read_b32 v49, a161
    v_accvgpr_read_b32 v50, a162
    v_accvgpr_read_b32 v51, a163
    v_fma_f32 v48, v48, v57, v58
    v_fma_f32 v49, v49, v57, v58
    v_fma_f32 v50, v50, v57, v58
    v_fma_f32 v51, v51, v57, v58
    v_accvgpr_write_b32 a160, v48
    v_accvgpr_write_b32 a161, v49
    v_accvgpr_write_b32 a162, v50
    v_accvgpr_write_b32 a163, v51
    v_accvgpr_read_b32 v48, a176
    v_accvgpr_read_b32 v49, a177
    v_accvgpr_read_b32 v50, a178
    v_accvgpr_read_b32 v51, a179
    v_fma_f32 v48, v48, v57, v58
    v_fma_f32 v49, v49, v57, v58
    v_fma_f32 v50, v50, v57, v58
    v_fma_f32 v51, v51, v57, v58
    v_accvgpr_write_b32 a176, v48
    v_accvgpr_write_b32 a177, v49
    v_accvgpr_write_b32 a178, v50
    v_accvgpr_write_b32 a179, v51
    v_exp_f32 v48, v132
    v_exp_f32 v49, v133
    v_exp_f32 v50, v134
    v_exp_f32 v51, v135
    v_exp_f32 v52, v164
    v_exp_f32 v53, v165
    v_exp_f32 v54, v166
    v_exp_f32 v55, v167
    s_nop 0
    v_cvt_pk_bf16_f32 v228, v48, v49
    v_cvt_pk_bf16_f32 v229, v50, v51
    v_cvt_pk_bf16_f32 v230, v52, v53
    v_cvt_pk_bf16_f32 v231, v54, v55
    v_add_f32 v24, v48, v49
    v_add_f32 v24, v24, v50
    v_add_f32 v24, v24, v51
    v_add_f32 v24, v24, v52
    v_add_f32 v24, v24, v53
    v_add_f32 v24, v24, v54
    v_add_f32 v24, v24, v55
    v_max3_f32 v56, v140, v141, v142
    v_max3_f32 v56, v56, v143, v172
    v_max3_f32 v56, v56, v173, v174
    v_max3_f32 v56, v56, v175, 0
    v_mov_b32 v58, v56
    s_nop 1
    v_permlane16_swap_b32 v56, v58
    s_nop 1
    v_max_f32 v56, v56, v58
    v_mov_b32 v58, v56
    s_nop 1
    v_permlane32_swap_b32 v56, v58
    s_nop 1
    v_max_f32 v56, v56, v58
    v_exp_f32 v57, -v56
    v_sub_f32 v36, v36, v56
    v_sub_f32 v37, v37, v56
    v_sub_f32 v38, v38, v56
    v_sub_f32 v39, v39, v56
    v_mul_f32 v21, v21, v57
    v_sub_f32 v58, 1.0, v57
    v_sub_f32 v140, v140, v56
    v_sub_f32 v141, v141, v56
    v_sub_f32 v142, v142, v56
    v_sub_f32 v143, v143, v56
    v_sub_f32 v172, v172, v56
    v_sub_f32 v173, v173, v56
    v_sub_f32 v174, v174, v56
    v_sub_f32 v175, v175, v56
    v_sub_f32 v76, v76, v56
    v_sub_f32 v77, v77, v56
    v_sub_f32 v78, v78, v56
    v_sub_f32 v79, v79, v56
    v_sub_f32 v108, v108, v56
    v_sub_f32 v109, v109, v56
    v_sub_f32 v110, v110, v56
    v_sub_f32 v111, v111, v56
    v_accvgpr_read_b32 v48, a4
    v_accvgpr_read_b32 v49, a5
    v_accvgpr_read_b32 v50, a6
    v_accvgpr_read_b32 v51, a7
    v_fma_f32 v48, v48, v57, v58
    v_fma_f32 v49, v49, v57, v58
    v_fma_f32 v50, v50, v57, v58
    v_fma_f32 v51, v51, v57, v58
    v_accvgpr_write_b32 a4, v48
    v_accvgpr_write_b32 a5, v49
    v_accvgpr_write_b32 a6, v50
    v_accvgpr_write_b32 a7, v51
    v_accvgpr_read_b32 v48, a20
    v_accvgpr_read_b32 v49, a21
    v_accvgpr_read_b32 v50, a22
    v_accvgpr_read_b32 v51, a23
    v_fma_f32 v48, v48, v57, v58
    v_fma_f32 v49, v49, v57, v58
    v_fma_f32 v50, v50, v57, v58
    v_fma_f32 v51, v51, v57, v58
    v_accvgpr_write_b32 a20, v48
    v_accvgpr_write_b32 a21, v49
    v_accvgpr_write_b32 a22, v50
    v_accvgpr_write_b32 a23, v51
    v_accvgpr_read_b32 v48, a36
    v_accvgpr_read_b32 v49, a37
    v_accvgpr_read_b32 v50, a38
    v_accvgpr_read_b32 v51, a39
    v_fma_f32 v48, v48, v57, v58
    v_fma_f32 v49, v49, v57, v58
    v_fma_f32 v50, v50, v57, v58
    v_fma_f32 v51, v51, v57, v58
    v_accvgpr_write_b32 a36, v48
    v_accvgpr_write_b32 a37, v49
    v_accvgpr_write_b32 a38, v50
    v_accvgpr_write_b32 a39, v51
    v_accvgpr_read_b32 v48, a52
    v_accvgpr_read_b32 v49, a53
    v_accvgpr_read_b32 v50, a54
    v_accvgpr_read_b32 v51, a55
    v_fma_f32 v48, v48, v57, v58
    v_fma_f32 v49, v49, v57, v58
    v_fma_f32 v50, v50, v57, v58
    v_fma_f32 v51, v51, v57, v58
    v_accvgpr_write_b32 a52, v48
    v_accvgpr_write_b32 a53, v49
    v_accvgpr_write_b32 a54, v50
    v_accvgpr_write_b32 a55, v51
    v_accvgpr_read_b32 v48, a68
    v_accvgpr_read_b32 v49, a69
    v_accvgpr_read_b32 v50, a70
    v_accvgpr_read_b32 v51, a71
    v_fma_f32 v48, v48, v57, v58
    v_fma_f32 v49, v49, v57, v58
    v_fma_f32 v50, v50, v57, v58
    v_fma_f32 v51, v51, v57, v58
    v_accvgpr_write_b32 a68, v48
    v_accvgpr_write_b32 a69, v49
    v_accvgpr_write_b32 a70, v50
    v_accvgpr_write_b32 a71, v51
    v_accvgpr_read_b32 v48, a84
    v_accvgpr_read_b32 v49, a85
    v_accvgpr_read_b32 v50, a86
    v_accvgpr_read_b32 v51, a87
    v_fma_f32 v48, v48, v57, v58
    v_fma_f32 v49, v49, v57, v58
    v_fma_f32 v50, v50, v57, v58
    v_fma_f32 v51, v51, v57, v58
    v_accvgpr_write_b32 a84, v48
    v_accvgpr_write_b32 a85, v49
    v_accvgpr_write_b32 a86, v50
    v_accvgpr_write_b32 a87, v51
    v_accvgpr_read_b32 v48, a100
    v_accvgpr_read_b32 v49, a101
    v_accvgpr_read_b32 v50, a102
    v_accvgpr_read_b32 v51, a103
    v_fma_f32 v48, v48, v57, v58
    v_fma_f32 v49, v49, v57, v58
    v_fma_f32 v50, v50, v57, v58
    v_fma_f32 v51, v51, v57, v58
    v_accvgpr_write_b32 a100, v48
    v_accvgpr_write_b32 a101, v49
    v_accvgpr_write_b32 a102, v50
    v_accvgpr_write_b32 a103, v51
    v_accvgpr_read_b32 v48, a116
    v_accvgpr_read_b32 v49, a117
    v_accvgpr_read_b32 v50, a118
    v_accvgpr_read_b32 v51, a119
    v_fma_f32 v48, v48, v57, v58
    v_fma_f32 v49, v49, v57, v58
    v_fma_f32 v50, v50, v57, v58
    v_fma_f32 v51, v51, v57, v58
    v_accvgpr_write_b32 a116, v48
    v_accvgpr_write_b32 a117, v49
    v_accvgpr_write_b32 a118, v50
    v_accvgpr_write_b32 a119, v51
    v_accvgpr_read_b32 v48, a132
    v_accvgpr_read_b32 v49, a133
    v_accvgpr_read_b32 v50, a134
    v_accvgpr_read_b32 v51, a135
    v_fma_f32 v48, v48, v57, v58
    v_fma_f32 v49, v49, v57, v58
    v_fma_f32 v50, v50, v57, v58
    v_fma_f32 v51, v51, v57, v58
    v_accvgpr_write_b32 a132, v48
    v_accvgpr_write_b32 a133, v49
    v_accvgpr_write_b32 a134, v50
    v_accvgpr_write_b32 a135, v51
    v_accvgpr_read_b32 v48, a148
    v_accvgpr_read_b32 v49, a149
    v_accvgpr_read_b32 v50, a150
    v_accvgpr_read_b32 v51, a151
    v_fma_f32 v48, v48, v57, v58
    v_fma_f32 v49, v49, v57, v58
    v_fma_f32 v50, v50, v57, v58
    v_fma_f32 v51, v51, v57, v58
    v_accvgpr_write_b32 a148, v48
    v_accvgpr_write_b32 a149, v49
    v_accvgpr_write_b32 a150, v50
    v_accvgpr_write_b32 a151, v51
    v_accvgpr_read_b32 v48, a164
    v_accvgpr_read_b32 v49, a165
    v_accvgpr_read_b32 v50, a166
    v_accvgpr_read_b32 v51, a167
    v_fma_f32 v48, v48, v57, v58
    v_fma_f32 v49, v49, v57, v58
    v_fma_f32 v50, v50, v57, v58
    v_fma_f32 v51, v51, v57, v58
    v_accvgpr_write_b32 a164, v48
    v_accvgpr_write_b32 a165, v49
    v_accvgpr_write_b32 a166, v50
    v_accvgpr_write_b32 a167, v51
    v_accvgpr_read_b32 v48, a180
    v_accvgpr_read_b32 v49, a181
    v_accvgpr_read_b32 v50, a182
    v_accvgpr_read_b32 v51, a183
    v_fma_f32 v48, v48, v57, v58
    v_fma_f32 v49, v49, v57, v58
    v_fma_f32 v50, v50, v57, v58
    v_fma_f32 v51, v51, v57, v58
    v_accvgpr_write_b32 a180, v48
    v_accvgpr_write_b32 a181, v49
    v_accvgpr_write_b32 a182, v50
    v_accvgpr_write_b32 a183, v51
    v_exp_f32 v48, v140
    v_exp_f32 v49, v141
    v_exp_f32 v50, v142
    v_exp_f32 v51, v143
    v_exp_f32 v52, v172
    v_exp_f32 v53, v173
    v_exp_f32 v54, v174
    v_exp_f32 v55, v175
    s_nop 0
    v_cvt_pk_bf16_f32 v236, v48, v49
    v_cvt_pk_bf16_f32 v237, v50, v51
    v_cvt_pk_bf16_f32 v238, v52, v53
    v_cvt_pk_bf16_f32 v239, v54, v55
    v_add_f32 v25, v48, v49
    v_add_f32 v25, v25, v50
    v_add_f32 v25, v25, v51
    v_add_f32 v25, v25, v52
    v_add_f32 v25, v25, v53
    v_add_f32 v25, v25, v54
    v_add_f32 v25, v25, v55
    v_max3_f32 v56, v148, v149, v150
    v_max3_f32 v56, v56, v151, v180
    v_max3_f32 v56, v56, v181, v182
    v_max3_f32 v56, v56, v183, 0
    v_mov_b32 v58, v56
    s_nop 1
    v_permlane16_swap_b32 v56, v58
    s_nop 1
    v_max_f32 v56, v56, v58
    v_mov_b32 v58, v56
    s_nop 1
    v_permlane32_swap_b32 v56, v58
    s_nop 1
    v_max_f32 v56, v56, v58
    v_exp_f32 v57, -v56
    v_sub_f32 v40, v40, v56
    v_sub_f32 v41, v41, v56
    v_sub_f32 v42, v42, v56
    v_sub_f32 v43, v43, v56
    v_mul_f32 v22, v22, v57
    v_sub_f32 v58, 1.0, v57
    v_sub_f32 v148, v148, v56
    v_sub_f32 v149, v149, v56
    v_sub_f32 v150, v150, v56
    v_sub_f32 v151, v151, v56
    v_sub_f32 v180, v180, v56
    v_sub_f32 v181, v181, v56
    v_sub_f32 v182, v182, v56
    v_sub_f32 v183, v183, v56
    v_sub_f32 v84, v84, v56
    v_sub_f32 v85, v85, v56
    v_sub_f32 v86, v86, v56
    v_sub_f32 v87, v87, v56
    v_sub_f32 v116, v116, v56
    v_sub_f32 v117, v117, v56
    v_sub_f32 v118, v118, v56
    v_sub_f32 v119, v119, v56
    v_accvgpr_read_b32 v48, a8
    v_accvgpr_read_b32 v49, a9
    v_accvgpr_read_b32 v50, a10
    v_accvgpr_read_b32 v51, a11
    v_fma_f32 v48, v48, v57, v58
    v_fma_f32 v49, v49, v57, v58
    v_fma_f32 v50, v50, v57, v58
    v_fma_f32 v51, v51, v57, v58
    v_accvgpr_write_b32 a8, v48
    v_accvgpr_write_b32 a9, v49
    v_accvgpr_write_b32 a10, v50
    v_accvgpr_write_b32 a11, v51
    v_accvgpr_read_b32 v48, a24
    v_accvgpr_read_b32 v49, a25
    v_accvgpr_read_b32 v50, a26
    v_accvgpr_read_b32 v51, a27
    v_fma_f32 v48, v48, v57, v58
    v_fma_f32 v49, v49, v57, v58
    v_fma_f32 v50, v50, v57, v58
    v_fma_f32 v51, v51, v57, v58
    v_accvgpr_write_b32 a24, v48
    v_accvgpr_write_b32 a25, v49
    v_accvgpr_write_b32 a26, v50
    v_accvgpr_write_b32 a27, v51
    v_accvgpr_read_b32 v48, a40
    v_accvgpr_read_b32 v49, a41
    v_accvgpr_read_b32 v50, a42
    v_accvgpr_read_b32 v51, a43
    v_fma_f32 v48, v48, v57, v58
    v_fma_f32 v49, v49, v57, v58
    v_fma_f32 v50, v50, v57, v58
    v_fma_f32 v51, v51, v57, v58
    v_accvgpr_write_b32 a40, v48
    v_accvgpr_write_b32 a41, v49
    v_accvgpr_write_b32 a42, v50
    v_accvgpr_write_b32 a43, v51
    v_accvgpr_read_b32 v48, a56
    v_accvgpr_read_b32 v49, a57
    v_accvgpr_read_b32 v50, a58
    v_accvgpr_read_b32 v51, a59
    v_fma_f32 v48, v48, v57, v58
    v_fma_f32 v49, v49, v57, v58
    v_fma_f32 v50, v50, v57, v58
    v_fma_f32 v51, v51, v57, v58
    v_accvgpr_write_b32 a56, v48
    v_accvgpr_write_b32 a57, v49
    v_accvgpr_write_b32 a58, v50
    v_accvgpr_write_b32 a59, v51
    v_accvgpr_read_b32 v48, a72
    v_accvgpr_read_b32 v49, a73
    v_accvgpr_read_b32 v50, a74
    v_accvgpr_read_b32 v51, a75
    v_fma_f32 v48, v48, v57, v58
    v_fma_f32 v49, v49, v57, v58
    v_fma_f32 v50, v50, v57, v58
    v_fma_f32 v51, v51, v57, v58
    v_accvgpr_write_b32 a72, v48
    v_accvgpr_write_b32 a73, v49
    v_accvgpr_write_b32 a74, v50
    v_accvgpr_write_b32 a75, v51
    v_accvgpr_read_b32 v48, a88
    v_accvgpr_read_b32 v49, a89
    v_accvgpr_read_b32 v50, a90
    v_accvgpr_read_b32 v51, a91
    v_fma_f32 v48, v48, v57, v58
    v_fma_f32 v49, v49, v57, v58
    v_fma_f32 v50, v50, v57, v58
    v_fma_f32 v51, v51, v57, v58
    v_accvgpr_write_b32 a88, v48
    v_accvgpr_write_b32 a89, v49
    v_accvgpr_write_b32 a90, v50
    v_accvgpr_write_b32 a91, v51
    v_accvgpr_read_b32 v48, a104
    v_accvgpr_read_b32 v49, a105
    v_accvgpr_read_b32 v50, a106
    v_accvgpr_read_b32 v51, a107
    v_fma_f32 v48, v48, v57, v58
    v_fma_f32 v49, v49, v57, v58
    v_fma_f32 v50, v50, v57, v58
    v_fma_f32 v51, v51, v57, v58
    v_accvgpr_write_b32 a104, v48
    v_accvgpr_write_b32 a105, v49
    v_accvgpr_write_b32 a106, v50
    v_accvgpr_write_b32 a107, v51
    v_accvgpr_read_b32 v48, a120
    v_accvgpr_read_b32 v49, a121
    v_accvgpr_read_b32 v50, a122
    v_accvgpr_read_b32 v51, a123
    v_fma_f32 v48, v48, v57, v58
    v_fma_f32 v49, v49, v57, v58
    v_fma_f32 v50, v50, v57, v58
    v_fma_f32 v51, v51, v57, v58
    v_accvgpr_write_b32 a120, v48
    v_accvgpr_write_b32 a121, v49
    v_accvgpr_write_b32 a122, v50
    v_accvgpr_write_b32 a123, v51
    v_accvgpr_read_b32 v48, a136
    v_accvgpr_read_b32 v49, a137
    v_accvgpr_read_b32 v50, a138
    v_accvgpr_read_b32 v51, a139
    v_fma_f32 v48, v48, v57, v58
    v_fma_f32 v49, v49, v57, v58
    v_fma_f32 v50, v50, v57, v58
    v_fma_f32 v51, v51, v57, v58
    v_accvgpr_write_b32 a136, v48
    v_accvgpr_write_b32 a137, v49
    v_accvgpr_write_b32 a138, v50
    v_accvgpr_write_b32 a139, v51
    v_accvgpr_read_b32 v48, a152
    v_accvgpr_read_b32 v49, a153
    v_accvgpr_read_b32 v50, a154
    v_accvgpr_read_b32 v51, a155
    v_fma_f32 v48, v48, v57, v58
    v_fma_f32 v49, v49, v57, v58
    v_fma_f32 v50, v50, v57, v58
    v_fma_f32 v51, v51, v57, v58
    v_accvgpr_write_b32 a152, v48
    v_accvgpr_write_b32 a153, v49
    v_accvgpr_write_b32 a154, v50
    v_accvgpr_write_b32 a155, v51
    v_accvgpr_read_b32 v48, a168
    v_accvgpr_read_b32 v49, a169
    v_accvgpr_read_b32 v50, a170
    v_accvgpr_read_b32 v51, a171
    v_fma_f32 v48, v48, v57, v58
    v_fma_f32 v49, v49, v57, v58
    v_fma_f32 v50, v50, v57, v58
    v_fma_f32 v51, v51, v57, v58
    v_accvgpr_write_b32 a168, v48
    v_accvgpr_write_b32 a169, v49
    v_accvgpr_write_b32 a170, v50
    v_accvgpr_write_b32 a171, v51
    v_accvgpr_read_b32 v48, a184
    v_accvgpr_read_b32 v49, a185
    v_accvgpr_read_b32 v50, a186
    v_accvgpr_read_b32 v51, a187
    v_fma_f32 v48, v48, v57, v58
    v_fma_f32 v49, v49, v57, v58
    v_fma_f32 v50, v50, v57, v58
    v_fma_f32 v51, v51, v57, v58
    v_accvgpr_write_b32 a184, v48
    v_accvgpr_write_b32 a185, v49
    v_accvgpr_write_b32 a186, v50
    v_accvgpr_write_b32 a187, v51
    v_exp_f32 v48, v148
    v_exp_f32 v49, v149
    v_exp_f32 v50, v150
    v_exp_f32 v51, v151
    v_exp_f32 v52, v180
    v_exp_f32 v53, v181
    v_exp_f32 v54, v182
    v_exp_f32 v55, v183
    s_nop 0
    v_cvt_pk_bf16_f32 v244, v48, v49
    v_cvt_pk_bf16_f32 v245, v50, v51
    v_cvt_pk_bf16_f32 v246, v52, v53
    v_cvt_pk_bf16_f32 v247, v54, v55
    v_add_f32 v26, v48, v49
    v_add_f32 v26, v26, v50
    v_add_f32 v26, v26, v51
    v_add_f32 v26, v26, v52
    v_add_f32 v26, v26, v53
    v_add_f32 v26, v26, v54
    v_add_f32 v26, v26, v55
    v_max3_f32 v56, v156, v157, v158
    v_max3_f32 v56, v56, v159, v188
    v_max3_f32 v56, v56, v189, v190
    v_max3_f32 v56, v56, v191, 0
    v_mov_b32 v58, v56
    s_nop 1
    v_permlane16_swap_b32 v56, v58
    s_nop 1
    v_max_f32 v56, v56, v58
    v_mov_b32 v58, v56
    s_nop 1
    v_permlane32_swap_b32 v56, v58
    s_nop 1
    v_max_f32 v56, v56, v58
    v_exp_f32 v57, -v56
    v_sub_f32 v44, v44, v56
    v_sub_f32 v45, v45, v56
    v_sub_f32 v46, v46, v56
    v_sub_f32 v47, v47, v56
    v_mul_f32 v23, v23, v57
    v_sub_f32 v58, 1.0, v57
    v_sub_f32 v156, v156, v56
    v_sub_f32 v157, v157, v56
    v_sub_f32 v158, v158, v56
    v_sub_f32 v159, v159, v56
    v_sub_f32 v188, v188, v56
    v_sub_f32 v189, v189, v56
    v_sub_f32 v190, v190, v56
    v_sub_f32 v191, v191, v56
    v_sub_f32 v92, v92, v56
    v_sub_f32 v93, v93, v56
    v_sub_f32 v94, v94, v56
    v_sub_f32 v95, v95, v56
    v_sub_f32 v124, v124, v56
    v_sub_f32 v125, v125, v56
    v_sub_f32 v126, v126, v56
    v_sub_f32 v127, v127, v56
    v_accvgpr_read_b32 v48, a12
    v_accvgpr_read_b32 v49, a13
    v_accvgpr_read_b32 v50, a14
    v_accvgpr_read_b32 v51, a15
    v_fma_f32 v48, v48, v57, v58
    v_fma_f32 v49, v49, v57, v58
    v_fma_f32 v50, v50, v57, v58
    v_fma_f32 v51, v51, v57, v58
    v_accvgpr_write_b32 a12, v48
    v_accvgpr_write_b32 a13, v49
    v_accvgpr_write_b32 a14, v50
    v_accvgpr_write_b32 a15, v51
    v_accvgpr_read_b32 v48, a28
    v_accvgpr_read_b32 v49, a29
    v_accvgpr_read_b32 v50, a30
    v_accvgpr_read_b32 v51, a31
    v_fma_f32 v48, v48, v57, v58
    v_fma_f32 v49, v49, v57, v58
    v_fma_f32 v50, v50, v57, v58
    v_fma_f32 v51, v51, v57, v58
    v_accvgpr_write_b32 a28, v48
    v_accvgpr_write_b32 a29, v49
    v_accvgpr_write_b32 a30, v50
    v_accvgpr_write_b32 a31, v51
    v_accvgpr_read_b32 v48, a44
    v_accvgpr_read_b32 v49, a45
    v_accvgpr_read_b32 v50, a46
    v_accvgpr_read_b32 v51, a47
    v_fma_f32 v48, v48, v57, v58
    v_fma_f32 v49, v49, v57, v58
    v_fma_f32 v50, v50, v57, v58
    v_fma_f32 v51, v51, v57, v58
    v_accvgpr_write_b32 a44, v48
    v_accvgpr_write_b32 a45, v49
    v_accvgpr_write_b32 a46, v50
    v_accvgpr_write_b32 a47, v51
    v_accvgpr_read_b32 v48, a60
    v_accvgpr_read_b32 v49, a61
    v_accvgpr_read_b32 v50, a62
    v_accvgpr_read_b32 v51, a63
    v_fma_f32 v48, v48, v57, v58
    v_fma_f32 v49, v49, v57, v58
    v_fma_f32 v50, v50, v57, v58
    v_fma_f32 v51, v51, v57, v58
    v_accvgpr_write_b32 a60, v48
    v_accvgpr_write_b32 a61, v49
    v_accvgpr_write_b32 a62, v50
    v_accvgpr_write_b32 a63, v51
    v_accvgpr_read_b32 v48, a76
    v_accvgpr_read_b32 v49, a77
    v_accvgpr_read_b32 v50, a78
    v_accvgpr_read_b32 v51, a79
    v_fma_f32 v48, v48, v57, v58
    v_fma_f32 v49, v49, v57, v58
    v_fma_f32 v50, v50, v57, v58
    v_fma_f32 v51, v51, v57, v58
    v_accvgpr_write_b32 a76, v48
    v_accvgpr_write_b32 a77, v49
    v_accvgpr_write_b32 a78, v50
    v_accvgpr_write_b32 a79, v51
    v_accvgpr_read_b32 v48, a92
    v_accvgpr_read_b32 v49, a93
    v_accvgpr_read_b32 v50, a94
    v_accvgpr_read_b32 v51, a95
    v_fma_f32 v48, v48, v57, v58
    v_fma_f32 v49, v49, v57, v58
    v_fma_f32 v50, v50, v57, v58
    v_fma_f32 v51, v51, v57, v58
    v_accvgpr_write_b32 a92, v48
    v_accvgpr_write_b32 a93, v49
    v_accvgpr_write_b32 a94, v50
    v_accvgpr_write_b32 a95, v51
    v_accvgpr_read_b32 v48, a108
    v_accvgpr_read_b32 v49, a109
    v_accvgpr_read_b32 v50, a110
    v_accvgpr_read_b32 v51, a111
    v_fma_f32 v48, v48, v57, v58
    v_fma_f32 v49, v49, v57, v58
    v_fma_f32 v50, v50, v57, v58
    v_fma_f32 v51, v51, v57, v58
    v_accvgpr_write_b32 a108, v48
    v_accvgpr_write_b32 a109, v49
    v_accvgpr_write_b32 a110, v50
    v_accvgpr_write_b32 a111, v51
    v_accvgpr_read_b32 v48, a124
    v_accvgpr_read_b32 v49, a125
    v_accvgpr_read_b32 v50, a126
    v_accvgpr_read_b32 v51, a127
    v_fma_f32 v48, v48, v57, v58
    v_fma_f32 v49, v49, v57, v58
    v_fma_f32 v50, v50, v57, v58
    v_fma_f32 v51, v51, v57, v58
    v_accvgpr_write_b32 a124, v48
    v_accvgpr_write_b32 a125, v49
    v_accvgpr_write_b32 a126, v50
    v_accvgpr_write_b32 a127, v51
    v_accvgpr_read_b32 v48, a140
    v_accvgpr_read_b32 v49, a141
    v_accvgpr_read_b32 v50, a142
    v_accvgpr_read_b32 v51, a143
    v_fma_f32 v48, v48, v57, v58
    v_fma_f32 v49, v49, v57, v58
    v_fma_f32 v50, v50, v57, v58
    v_fma_f32 v51, v51, v57, v58
    v_accvgpr_write_b32 a140, v48
    v_accvgpr_write_b32 a141, v49
    v_accvgpr_write_b32 a142, v50
    v_accvgpr_write_b32 a143, v51
    v_accvgpr_read_b32 v48, a156
    v_accvgpr_read_b32 v49, a157
    v_accvgpr_read_b32 v50, a158
    v_accvgpr_read_b32 v51, a159
    v_fma_f32 v48, v48, v57, v58
    v_fma_f32 v49, v49, v57, v58
    v_fma_f32 v50, v50, v57, v58
    v_fma_f32 v51, v51, v57, v58
    v_accvgpr_write_b32 a156, v48
    v_accvgpr_write_b32 a157, v49
    v_accvgpr_write_b32 a158, v50
    v_accvgpr_write_b32 a159, v51
    v_accvgpr_read_b32 v48, a172
    v_accvgpr_read_b32 v49, a173
    v_accvgpr_read_b32 v50, a174
    v_accvgpr_read_b32 v51, a175
    v_fma_f32 v48, v48, v57, v58
    v_fma_f32 v49, v49, v57, v58
    v_fma_f32 v50, v50, v57, v58
    v_fma_f32 v51, v51, v57, v58
    v_accvgpr_write_b32 a172, v48
    v_accvgpr_write_b32 a173, v49
    v_accvgpr_write_b32 a174, v50
    v_accvgpr_write_b32 a175, v51
    v_accvgpr_read_b32 v48, a188
    v_accvgpr_read_b32 v49, a189
    v_accvgpr_read_b32 v50, a190
    v_accvgpr_read_b32 v51, a191
    v_fma_f32 v48, v48, v57, v58
    v_fma_f32 v49, v49, v57, v58
    v_fma_f32 v50, v50, v57, v58
    v_fma_f32 v51, v51, v57, v58
    v_accvgpr_write_b32 a188, v48
    v_accvgpr_write_b32 a189, v49
    v_accvgpr_write_b32 a190, v50
    v_accvgpr_write_b32 a191, v51
    v_exp_f32 v48, v156
    v_exp_f32 v49, v157
    v_exp_f32 v50, v158
    v_exp_f32 v51, v159
    v_exp_f32 v52, v188
    v_exp_f32 v53, v189
    v_exp_f32 v54, v190
    v_exp_f32 v55, v191
    s_nop 0
    v_cvt_pk_bf16_f32 v252, v48, v49
    v_cvt_pk_bf16_f32 v253, v50, v51
    v_cvt_pk_bf16_f32 v254, v52, v53
    v_cvt_pk_bf16_f32 v255, v54, v55
    v_add_f32 v27, v48, v49
    v_add_f32 v27, v27, v50
    v_add_f32 v27, v27, v51
    v_add_f32 v27, v27, v52
    v_add_f32 v27, v27, v53
    v_add_f32 v27, v27, v54
    v_add_f32 v27, v27, v55
    s_nop 1
    s_branch rare_a_ret
rare_b:
    s_nop 7
    s_nop 7
    v_max3_f32 v56, v68, v69, v70
    v_max3_f32 v56, v56, v71, v100
    v_max3_f32 v56, v56, v101, v102
    v_max3_f32 v56, v56, v103, 0
    v_mov_b32 v58, v56
    s_nop 1
    v_permlane16_swap_b32 v56, v58
    s_nop 1
    v_max_f32 v56, v56, v58
    v_mov_b32 v58, v56
    s_nop 1
    v_permlane32_swap_b32 v56, v58
    s_nop 1
    v_max_f32 v56, v56, v58
    v_exp_f32 v57, -v56
    v_sub_f32 v32, v32, v56
    v_sub_f32 v33, v33, v56
    v_sub_f32 v34, v34, v56
    v_sub_f32 v35, v35, v56
    v_mul_f32 v20, v20, v57
    v_sub_f32 v58, 1.0, v57
    v_sub_f32 v68, v68, v56
    v_sub_f32 v69, v69, v56
    v_sub_f32 v70, v70, v56
    v_sub_f32 v71, v71, v56
    v_sub_f32 v100, v100, v56
    v_sub_f32 v101, v101, v56
    v_sub_f32 v102, v102, v56
    v_sub_f32 v103, v103, v56
    v_sub_f32 v132, v132, v56
    v_sub_f32 v133, v133, v56
    v_sub_f32 v134, v134, v56
    v_sub_f32 v135, v135, v56
    v_sub_f32 v164, v164, v56
    v_sub_f32 v165, v165, v56
    v_sub_f32 v166, v166, v56
    v_sub_f32 v167, v167, v56
    v_accvgpr_read_b32 v48, a0
    v_accvgpr_read_b32 v49, a1
    v_accvgpr_read_b32 v50, a2
    v_accvgpr_read_b32 v51, a3
    v_fma_f32 v48, v48, v57, v58
    v_fma_f32 v49, v49, v57, v58
    v_fma_f32 v50, v50, v57, v58
    v_fma_f32 v51, v51, v57, v58
    v_accvgpr_write_b32 a0, v48
    v_accvgpr_write_b32 a1, v49
    v_accvgpr_write_b32 a2, v50
    v_accvgpr_write_b32 a3, v51
    v_accvgpr_read_b32 v48, a16
    v_accvgpr_read_b32 v49, a17
    v_accvgpr_read_b32 v50, a18
    v_accvgpr_read_b32 v51, a19
    v_fma_f32 v48, v48, v57, v58
    v_fma_f32 v49, v49, v57, v58
    v_fma_f32 v50, v50, v57, v58
    v_fma_f32 v51, v51, v57, v58
    v_accvgpr_write_b32 a16, v48
    v_accvgpr_write_b32 a17, v49
    v_accvgpr_write_b32 a18, v50
    v_accvgpr_write_b32 a19, v51
    v_accvgpr_read_b32 v48, a32
    v_accvgpr_read_b32 v49, a33
    v_accvgpr_read_b32 v50, a34
    v_accvgpr_read_b32 v51, a35
    v_fma_f32 v48, v48, v57, v58
    v_fma_f32 v49, v49, v57, v58
    v_fma_f32 v50, v50, v57, v58
    v_fma_f32 v51, v51, v57, v58
    v_accvgpr_write_b32 a32, v48
    v_accvgpr_write_b32 a33, v49
    v_accvgpr_write_b32 a34, v50
    v_accvgpr_write_b32 a35, v51
    v_accvgpr_read_b32 v48, a48
    v_accvgpr_read_b32 v49, a49
    v_accvgpr_read_b32 v50, a50
    v_accvgpr_read_b32 v51, a51
    v_fma_f32 v48, v48, v57, v58
    v_fma_f32 v49, v49, v57, v58
    v_fma_f32 v50, v50, v57, v58
    v_fma_f32 v51, v51, v57, v58
    v_accvgpr_write_b32 a48, v48
    v_accvgpr_write_b32 a49, v49
    v_accvgpr_write_b32 a50, v50
    v_accvgpr_write_b32 a51, v51
    v_accvgpr_read_b32 v48, a64
    v_accvgpr_read_b32 v49, a65
    v_accvgpr_read_b32 v50, a66
    v_accvgpr_read_b32 v51, a67
    v_fma_f32 v48, v48, v57, v58
    v_fma_f32 v49, v49, v57, v58
    v_fma_f32 v50, v50, v57, v58
    v_fma_f32 v51, v51, v57, v58
    v_accvgpr_write_b32 a64, v48
    v_accvgpr_write_b32 a65, v49
    v_accvgpr_write_b32 a66, v50
    v_accvgpr_write_b32 a67, v51
    v_accvgpr_read_b32 v48, a80
    v_accvgpr_read_b32 v49, a81
    v_accvgpr_read_b32 v50, a82
    v_accvgpr_read_b32 v51, a83
    v_fma_f32 v48, v48, v57, v58
    v_fma_f32 v49, v49, v57, v58
    v_fma_f32 v50, v50, v57, v58
    v_fma_f32 v51, v51, v57, v58
    v_accvgpr_write_b32 a80, v48
    v_accvgpr_write_b32 a81, v49
    v_accvgpr_write_b32 a82, v50
    v_accvgpr_write_b32 a83, v51
    v_accvgpr_read_b32 v48, a96
    v_accvgpr_read_b32 v49, a97
    v_accvgpr_read_b32 v50, a98
    v_accvgpr_read_b32 v51, a99
    v_fma_f32 v48, v48, v57, v58
    v_fma_f32 v49, v49, v57, v58
    v_fma_f32 v50, v50, v57, v58
    v_fma_f32 v51, v51, v57, v58
    v_accvgpr_write_b32 a96, v48
    v_accvgpr_write_b32 a97, v49
    v_accvgpr_write_b32 a98, v50
    v_accvgpr_write_b32 a99, v51
    v_accvgpr_read_b32 v48, a112
    v_accvgpr_read_b32 v49, a113
    v_accvgpr_read_b32 v50, a114
    v_accvgpr_read_b32 v51, a115
    v_fma_f32 v48, v48, v57, v58
    v_fma_f32 v49, v49, v57, v58
    v_fma_f32 v50, v50, v57, v58
    v_fma_f32 v51, v51, v57, v58
    v_accvgpr_write_b32 a112, v48
    v_accvgpr_write_b32 a113, v49
    v_accvgpr_write_b32 a114, v50
    v_accvgpr_write_b32 a115, v51
    v_accvgpr_read_b32 v48, a128
    v_accvgpr_read_b32 v49, a129
    v_accvgpr_read_b32 v50, a130
    v_accvgpr_read_b32 v51, a131
    v_fma_f32 v48, v48, v57, v58
    v_fma_f32 v49, v49, v57, v58
    v_fma_f32 v50, v50, v57, v58
    v_fma_f32 v51, v51, v57, v58
    v_accvgpr_write_b32 a128, v48
    v_accvgpr_write_b32 a129, v49
    v_accvgpr_write_b32 a130, v50
    v_accvgpr_write_b32 a131, v51
    v_accvgpr_read_b32 v48, a144
    v_accvgpr_read_b32 v49, a145
    v_accvgpr_read_b32 v50, a146
    v_accvgpr_read_b32 v51, a147
    v_fma_f32 v48, v48, v57, v58
    v_fma_f32 v49, v49, v57, v58
    v_fma_f32 v50, v50, v57, v58
    v_fma_f32 v51, v51, v57, v58
    v_accvgpr_write_b32 a144, v48
    v_accvgpr_write_b32 a145, v49
    v_accvgpr_write_b32 a146, v50
    v_accvgpr_write_b32 a147, v51
    v_accvgpr_read_b32 v48, a160
    v_accvgpr_read_b32 v49, a161
    v_accvgpr_read_b32 v50, a162
    v_accvgpr_read_b32 v51, a163
    v_fma_f32 v48, v48, v57, v58
    v_fma_f32 v49, v49, v57, v58
    v_fma_f32 v50, v50, v57, v58
    v_fma_f32 v51, v51, v57, v58
    v_accvgpr_write_b32 a160, v48
    v_accvgpr_write_b32 a161, v49
    v_accvgpr_write_b32 a162, v50
    v_accvgpr_write_b32 a163, v51
    v_accvgpr_read_b32 v48, a176
    v_accvgpr_read_b32 v49, a177
    v_accvgpr_read_b32 v50, a178
    v_accvgpr_read_b32 v51, a179
    v_fma_f32 v48, v48, v57, v58
    v_fma_f32 v49, v49, v57, v58
    v_fma_f32 v50, v50, v57, v58
    v_fma_f32 v51, v51, v57, v58
    v_accvgpr_write_b32 a176, v48
    v_accvgpr_write_b32 a177, v49
    v_accvgpr_write_b32 a178, v50
    v_accvgpr_write_b32 a179, v51
    v_exp_f32 v48, v68
    v_exp_f32 v49, v69
    v_exp_f32 v50, v70
    v_exp_f32 v51, v71
    v_exp_f32 v52, v100
    v_exp_f32 v53, v101
    v_exp_f32 v54, v102
    v_exp_f32 v55, v103
    s_nop 0
    v_cvt_pk_bf16_f32 v196, v48, v49
    v_cvt_pk_bf16_f32 v197, v50, v51
    v_cvt_pk_bf16_f32 v198, v52, v53
    v_cvt_pk_bf16_f32 v199, v54, v55
    v_add_f32 v24, v48, v49
    v_add_f32 v24, v24, v50
    v_add_f32 v24, v24, v51
    v_add_f32 v24, v24, v52
    v_add_f32 v24, v24, v53
    v_add_f32 v24, v24, v54
    v_add_f32 v24, v24, v55
    v_max3_f32 v56, v76, v77, v78
    v_max3_f32 v56, v56, v79, v108
    v_max3_f32 v56, v56, v109, v110
    v_max3_f32 v56, v56, v111, 0
    v_mov_b32 v58, v56
    s_nop 1
    v_permlane16_swap_b32 v56, v58
    s_nop 1
    v_max_f32 v56, v56, v58
    v_mov_b32 v58, v56
    s_nop 1
    v_permlane32_swap_b32 v56, v58
    s_nop 1
    v_max_f32 v56, v56, v58
    v_exp_f32 v57, -v56
    v_sub_f32 v36, v36, v56
    v_sub_f32 v37, v37, v56
    v_sub_f32 v38, v38, v56
    v_sub_f32 v39, v39, v56
    v_mul_f32 v21, v21, v57
    v_sub_f32 v58, 1.0, v57
    v_sub_f32 v76, v76, v56
    v_sub_f32 v77, v77, v56
    v_sub_f32 v78, v78, v56
    v_sub_f32 v79, v79, v56
    v_sub_f32 v108, v108, v56
    v_sub_f32 v109, v109, v56
    v_sub_f32 v110, v110, v56
    v_sub_f32 v111, v111, v56
    v_sub_f32 v140, v140, v56
    v_sub_f32 v141, v141, v56
    v_sub_f32 v142, v142, v56
    v_sub_f32 v143, v143, v56
    v_sub_f32 v172, v172, v56
    v_sub_f32 v173, v173, v56
    v_sub_f32 v174, v174, v56
    v_sub_f32 v175, v175, v56
    v_accvgpr_read_b32 v48, a4
    v_accvgpr_read_b32 v49, a5
    v_accvgpr_read_b32 v50, a6
    v_accvgpr_read_b32 v51, a7
    v_fma_f32 v48, v48, v57, v58
    v_fma_f32 v49, v49, v57, v58
    v_fma_f32 v50, v50, v57, v58
    v_fma_f32 v51, v51, v57, v58
    v_accvgpr_write_b32 a4, v48
    v_accvgpr_write_b32 a5, v49
    v_accvgpr_write_b32 a6, v50
    v_accvgpr_write_b32 a7, v51
    v_accvgpr_read_b32 v48, a20
    v_accvgpr_read_b32 v49, a21
    v_accvgpr_read_b32 v50, a22
    v_accvgpr_read_b32 v51, a23
    v_fma_f32 v48, v48, v57, v58
    v_fma_f32 v49, v49, v57, v58
    v_fma_f32 v50, v50, v57, v58
    v_fma_f32 v51, v51, v57, v58
    v_accvgpr_write_b32 a20, v48
    v_accvgpr_write_b32 a21, v49
    v_accvgpr_write_b32 a22, v50
    v_accvgpr_write_b32 a23, v51
    v_accvgpr_read_b32 v48, a36
    v_accvgpr_read_b32 v49, a37
    v_accvgpr_read_b32 v50, a38
    v_accvgpr_read_b32 v51, a39
    v_fma_f32 v48, v48, v57, v58
    v_fma_f32 v49, v49, v57, v58
    v_fma_f32 v50, v50, v57, v58
    v_fma_f32 v51, v51, v57, v58
    v_accvgpr_write_b32 a36, v48
    v_accvgpr_write_b32 a37, v49
    v_accvgpr_write_b32 a38, v50
    v_accvgpr_write_b32 a39, v51
    v_accvgpr_read_b32 v48, a52
    v_accvgpr_read_b32 v49, a53
    v_accvgpr_read_b32 v50, a54
    v_accvgpr_read_b32 v51, a55
    v_fma_f32 v48, v48, v57, v58
    v_fma_f32 v49, v49, v57, v58
    v_fma_f32 v50, v50, v57, v58
    v_fma_f32 v51, v51, v57, v58
    v_accvgpr_write_b32 a52, v48
    v_accvgpr_write_b32 a53, v49
    v_accvgpr_write_b32 a54, v50
    v_accvgpr_write_b32 a55, v51
    v_accvgpr_read_b32 v48, a68
    v_accvgpr_read_b32 v49, a69
    v_accvgpr_read_b32 v50, a70
    v_accvgpr_read_b32 v51, a71
    v_fma_f32 v48, v48, v57, v58
    v_fma_f32 v49, v49, v57, v58
    v_fma_f32 v50, v50, v57, v58
    v_fma_f32 v51, v51, v57, v58
    v_accvgpr_write_b32 a68, v48
    v_accvgpr_write_b32 a69, v49
    v_accvgpr_write_b32 a70, v50
    v_accvgpr_write_b32 a71, v51
    v_accvgpr_read_b32 v48, a84
    v_accvgpr_read_b32 v49, a85
    v_accvgpr_read_b32 v50, a86
    v_accvgpr_read_b32 v51, a87
    v_fma_f32 v48, v48, v57, v58
    v_fma_f32 v49, v49, v57, v58
    v_fma_f32 v50, v50, v57, v58
    v_fma_f32 v51, v51, v57, v58
    v_accvgpr_write_b32 a84, v48
    v_accvgpr_write_b32 a85, v49
    v_accvgpr_write_b32 a86, v50
    v_accvgpr_write_b32 a87, v51
    v_accvgpr_read_b32 v48, a100
    v_accvgpr_read_b32 v49, a101
    v_accvgpr_read_b32 v50, a102
    v_accvgpr_read_b32 v51, a103
    v_fma_f32 v48, v48, v57, v58
    v_fma_f32 v49, v49, v57, v58
    v_fma_f32 v50, v50, v57, v58
    v_fma_f32 v51, v51, v57, v58
    v_accvgpr_write_b32 a100, v48
    v_accvgpr_write_b32 a101, v49
    v_accvgpr_write_b32 a102, v50
    v_accvgpr_write_b32 a103, v51
    v_accvgpr_read_b32 v48, a116
    v_accvgpr_read_b32 v49, a117
    v_accvgpr_read_b32 v50, a118
    v_accvgpr_read_b32 v51, a119
    v_fma_f32 v48, v48, v57, v58
    v_fma_f32 v49, v49, v57, v58
    v_fma_f32 v50, v50, v57, v58
    v_fma_f32 v51, v51, v57, v58
    v_accvgpr_write_b32 a116, v48
    v_accvgpr_write_b32 a117, v49
    v_accvgpr_write_b32 a118, v50
    v_accvgpr_write_b32 a119, v51
    v_accvgpr_read_b32 v48, a132
    v_accvgpr_read_b32 v49, a133
    v_accvgpr_read_b32 v50, a134
    v_accvgpr_read_b32 v51, a135
    v_fma_f32 v48, v48, v57, v58
    v_fma_f32 v49, v49, v57, v58
    v_fma_f32 v50, v50, v57, v58
    v_fma_f32 v51, v51, v57, v58
    v_accvgpr_write_b32 a132, v48
    v_accvgpr_write_b32 a133, v49
    v_accvgpr_write_b32 a134, v50
    v_accvgpr_write_b32 a135, v51
    v_accvgpr_read_b32 v48, a148
    v_accvgpr_read_b32 v49, a149
    v_accvgpr_read_b32 v50, a150
    v_accvgpr_read_b32 v51, a151
    v_fma_f32 v48, v48, v57, v58
    v_fma_f32 v49, v49, v57, v58
    v_fma_f32 v50, v50, v57, v58
    v_fma_f32 v51, v51, v57, v58
    v_accvgpr_write_b32 a148, v48
    v_accvgpr_write_b32 a149, v49
    v_accvgpr_write_b32 a150, v50
    v_accvgpr_write_b32 a151, v51
    v_accvgpr_read_b32 v48, a164
    v_accvgpr_read_b32 v49, a165
    v_accvgpr_read_b32 v50, a166
    v_accvgpr_read_b32 v51, a167
    v_fma_f32 v48, v48, v57, v58
    v_fma_f32 v49, v49, v57, v58
    v_fma_f32 v50, v50, v57, v58
    v_fma_f32 v51, v51, v57, v58
    v_accvgpr_write_b32 a164, v48
    v_accvgpr_write_b32 a165, v49
    v_accvgpr_write_b32 a166, v50
    v_accvgpr_write_b32 a167, v51
    v_accvgpr_read_b32 v48, a180
    v_accvgpr_read_b32 v49, a181
    v_accvgpr_read_b32 v50, a182
    v_accvgpr_read_b32 v51, a183
    v_fma_f32 v48, v48, v57, v58
    v_fma_f32 v49, v49, v57, v58
    v_fma_f32 v50, v50, v57, v58
    v_fma_f32 v51, v51, v57, v58
    v_accvgpr_write_b32 a180, v48
    v_accvgpr_write_b32 a181, v49
    v_accvgpr_write_b32 a182, v50
    v_accvgpr_write_b32 a183, v51
    v_exp_f32 v48, v76
    v_exp_f32 v49, v77
    v_exp_f32 v50, v78
    v_exp_f32 v51, v79
    v_exp_f32 v52, v108
    v_exp_f32 v53, v109
    v_exp_f32 v54, v110
    v_exp_f32 v55, v111
    s_nop 0
    v_cvt_pk_bf16_f32 v204, v48, v49
    v_cvt_pk_bf16_f32 v205, v50, v51
    v_cvt_pk_bf16_f32 v206, v52, v53
    v_cvt_pk_bf16_f32 v207, v54, v55
    v_add_f32 v25, v48, v49
    v_add_f32 v25, v25, v50
    v_add_f32 v25, v25, v51
    v_add_f32 v25, v25, v52
    v_add_f32 v25, v25, v53
    v_add_f32 v25, v25, v54
    v_add_f32 v25, v25, v55
    v_max3_f32 v56, v84, v85, v86
    v_max3_f32 v56, v56, v87, v116
    v_max3_f32 v56, v56, v117, v118
    v_max3_f32 v56, v56, v119, 0
    v_mov_b32 v58, v56
    s_nop 1
    v_permlane16_swap_b32 v56, v58
    s_nop 1
    v_max_f32 v56, v56, v58
    v_mov_b32 v58, v56
    s_nop 1
    v_permlane32_swap_b32 v56, v58
    s_nop 1
    v_max_f32 v56, v56, v58
    v_exp_f32 v57, -v56
    v_sub_f32 v40, v40, v56
    v_sub_f32 v41, v41, v56
    v_sub_f32 v42, v42, v56
    v_sub_f32 v43, v43, v56
    v_mul_f32 v22, v22, v57
    v_sub_f32 v58, 1.0, v57
    v_sub_f32 v84, v84, v56
    v_sub_f32 v85, v85, v56
    v_sub_f32 v86, v86, v56
    v_sub_f32 v87, v87, v56
    v_sub_f32 v116, v116, v56
    v_sub_f32 v117, v117, v56
    v_sub_f32 v118, v118, v56
    v_sub_f32 v119, v119, v56
    v_sub_f32 v148, v148, v56
    v_sub_f32 v149, v149, v56
    v_sub_f32 v150, v150, v56
    v_sub_f32 v151, v151, v56
    v_sub_f32 v180, v180, v56
    v_sub_f32 v181, v181, v56
    v_sub_f32 v182, v182, v56
    v_sub_f32 v183, v183, v56
    v_accvgpr_read_b32 v48, a8
    v_accvgpr_read_b32 v49, a9
    v_accvgpr_read_b32 v50, a10
    v_accvgpr_read_b32 v51, a11
    v_fma_f32 v48, v48, v57, v58
    v_fma_f32 v49, v49, v57, v58
    v_fma_f32 v50, v50, v57, v58
    v_fma_f32 v51, v51, v57, v58
    v_accvgpr_write_b32 a8, v48
    v_accvgpr_write_b32 a9, v49
    v_accvgpr_write_b32 a10, v50
    v_accvgpr_write_b32 a11, v51
    v_accvgpr_read_b32 v48, a24
    v_accvgpr_read_b32 v49, a25
    v_accvgpr_read_b32 v50, a26
    v_accvgpr_read_b32 v51, a27
    v_fma_f32 v48, v48, v57, v58
    v_fma_f32 v49, v49, v57, v58
    v_fma_f32 v50, v50, v57, v58
    v_fma_f32 v51, v51, v57, v58
    v_accvgpr_write_b32 a24, v48
    v_accvgpr_write_b32 a25, v49
    v_accvgpr_write_b32 a26, v50
    v_accvgpr_write_b32 a27, v51
    v_accvgpr_read_b32 v48, a40
    v_accvgpr_read_b32 v49, a41
    v_accvgpr_read_b32 v50, a42
    v_accvgpr_read_b32 v51, a43
    v_fma_f32 v48, v48, v57, v58
    v_fma_f32 v49, v49, v57, v58
    v_fma_f32 v50, v50, v57, v58
    v_fma_f32 v51, v51, v57, v58
    v_accvgpr_write_b32 a40, v48
    v_accvgpr_write_b32 a41, v49
    v_accvgpr_write_b32 a42, v50
    v_accvgpr_write_b32 a43, v51
    v_accvgpr_read_b32 v48, a56
    v_accvgpr_read_b32 v49, a57
    v_accvgpr_read_b32 v50, a58
    v_accvgpr_read_b32 v51, a59
    v_fma_f32 v48, v48, v57, v58
    v_fma_f32 v49, v49, v57, v58
    v_fma_f32 v50, v50, v57, v58
    v_fma_f32 v51, v51, v57, v58
    v_accvgpr_write_b32 a56, v48
    v_accvgpr_write_b32 a57, v49
    v_accvgpr_write_b32 a58, v50
    v_accvgpr_write_b32 a59, v51
    v_accvgpr_read_b32 v48, a72
    v_accvgpr_read_b32 v49, a73
    v_accvgpr_read_b32 v50, a74
    v_accvgpr_read_b32 v51, a75
    v_fma_f32 v48, v48, v57, v58
    v_fma_f32 v49, v49, v57, v58
    v_fma_f32 v50, v50, v57, v58
    v_fma_f32 v51, v51, v57, v58
    v_accvgpr_write_b32 a72, v48
    v_accvgpr_write_b32 a73, v49
    v_accvgpr_write_b32 a74, v50
    v_accvgpr_write_b32 a75, v51
    v_accvgpr_read_b32 v48, a88
    v_accvgpr_read_b32 v49, a89
    v_accvgpr_read_b32 v50, a90
    v_accvgpr_read_b32 v51, a91
    v_fma_f32 v48, v48, v57, v58
    v_fma_f32 v49, v49, v57, v58
    v_fma_f32 v50, v50, v57, v58
    v_fma_f32 v51, v51, v57, v58
    v_accvgpr_write_b32 a88, v48
    v_accvgpr_write_b32 a89, v49
    v_accvgpr_write_b32 a90, v50
    v_accvgpr_write_b32 a91, v51
    v_accvgpr_read_b32 v48, a104
    v_accvgpr_read_b32 v49, a105
    v_accvgpr_read_b32 v50, a106
    v_accvgpr_read_b32 v51, a107
    v_fma_f32 v48, v48, v57, v58
    v_fma_f32 v49, v49, v57, v58
    v_fma_f32 v50, v50, v57, v58
    v_fma_f32 v51, v51, v57, v58
    v_accvgpr_write_b32 a104, v48
    v_accvgpr_write_b32 a105, v49
    v_accvgpr_write_b32 a106, v50
    v_accvgpr_write_b32 a107, v51
    v_accvgpr_read_b32 v48, a120
    v_accvgpr_read_b32 v49, a121
    v_accvgpr_read_b32 v50, a122
    v_accvgpr_read_b32 v51, a123
    v_fma_f32 v48, v48, v57, v58
    v_fma_f32 v49, v49, v57, v58
    v_fma_f32 v50, v50, v57, v58
    v_fma_f32 v51, v51, v57, v58
    v_accvgpr_write_b32 a120, v48
    v_accvgpr_write_b32 a121, v49
    v_accvgpr_write_b32 a122, v50
    v_accvgpr_write_b32 a123, v51
    v_accvgpr_read_b32 v48, a136
    v_accvgpr_read_b32 v49, a137
    v_accvgpr_read_b32 v50, a138
    v_accvgpr_read_b32 v51, a139
    v_fma_f32 v48, v48, v57, v58
    v_fma_f32 v49, v49, v57, v58
    v_fma_f32 v50, v50, v57, v58
    v_fma_f32 v51, v51, v57, v58
    v_accvgpr_write_b32 a136, v48
    v_accvgpr_write_b32 a137, v49
    v_accvgpr_write_b32 a138, v50
    v_accvgpr_write_b32 a139, v51
    v_accvgpr_read_b32 v48, a152
    v_accvgpr_read_b32 v49, a153
    v_accvgpr_read_b32 v50, a154
    v_accvgpr_read_b32 v51, a155
    v_fma_f32 v48, v48, v57, v58
    v_fma_f32 v49, v49, v57, v58
    v_fma_f32 v50, v50, v57, v58
    v_fma_f32 v51, v51, v57, v58
    v_accvgpr_write_b32 a152, v48
    v_accvgpr_write_b32 a153, v49
    v_accvgpr_write_b32 a154, v50
    v_accvgpr_write_b32 a155, v51
    v_accvgpr_read_b32 v48, a168
    v_accvgpr_read_b32 v49, a169
    v_accvgpr_read_b32 v50, a170
    v_accvgpr_read_b32 v51, a171
    v_fma_f32 v48, v48, v57, v58
    v_fma_f32 v49, v49, v57, v58
    v_fma_f32 v50, v50, v57, v58
    v_fma_f32 v51, v51, v57, v58
    v_accvgpr_write_b32 a168, v48
    v_accvgpr_write_b32 a169, v49
    v_accvgpr_write_b32 a170, v50
    v_accvgpr_write_b32 a171, v51
    v_accvgpr_read_b32 v48, a184
    v_accvgpr_read_b32 v49, a185
    v_accvgpr_read_b32 v50, a186
    v_accvgpr_read_b32 v51, a187
    v_fma_f32 v48, v48, v57, v58
    v_fma_f32 v49, v49, v57, v58
    v_fma_f32 v50, v50, v57, v58
    v_fma_f32 v51, v51, v57, v58
    v_accvgpr_write_b32 a184, v48
    v_accvgpr_write_b32 a185, v49
    v_accvgpr_write_b32 a186, v50
    v_accvgpr_write_b32 a187, v51
    v_exp_f32 v48, v84
    v_exp_f32 v49, v85
    v_exp_f32 v50, v86
    v_exp_f32 v51, v87
    v_exp_f32 v52, v116
    v_exp_f32 v53, v117
    v_exp_f32 v54, v118
    v_exp_f32 v55, v119
    s_nop 0
    v_cvt_pk_bf16_f32 v212, v48, v49
    v_cvt_pk_bf16_f32 v213, v50, v51
    v_cvt_pk_bf16_f32 v214, v52, v53
    v_cvt_pk_bf16_f32 v215, v54, v55
    v_add_f32 v26, v48, v49
    v_add_f32 v26, v26, v50
    v_add_f32 v26, v26, v51
    v_add_f32 v26, v26, v52
    v_add_f32 v26, v26, v53
    v_add_f32 v26, v26, v54
    v_add_f32 v26, v26, v55
    v_max3_f32 v56, v92, v93, v94
    v_max3_f32 v56, v56, v95, v124
    v_max3_f32 v56, v56, v125, v126
    v_max3_f32 v56, v56, v127, 0
    v_mov_b32 v58, v56
    s_nop 1
    v_permlane16_swap_b32 v56, v58
    s_nop 1
    v_max_f32 v56, v56, v58
    v_mov_b32 v58, v56
    s_nop 1
    v_permlane32_swap_b32 v56, v58
    s_nop 1
    v_max_f32 v56, v56, v58
    v_exp_f32 v57, -v56
    v_sub_f32 v44, v44, v56
    v_sub_f32 v45, v45, v56
    v_sub_f32 v46, v46, v56
    v_sub_f32 v47, v47, v56
    v_mul_f32 v23, v23, v57
    v_sub_f32 v58, 1.0, v57
    v_sub_f32 v92, v92, v56
    v_sub_f32 v93, v93, v56
    v_sub_f32 v94, v94, v56
    v_sub_f32 v95, v95, v56
    v_sub_f32 v124, v124, v56
    v_sub_f32 v125, v125, v56
    v_sub_f32 v126, v126, v56
    v_sub_f32 v127, v127, v56
    v_sub_f32 v156, v156, v56
    v_sub_f32 v157, v157, v56
    v_sub_f32 v158, v158, v56
    v_sub_f32 v159, v159, v56
    v_sub_f32 v188, v188, v56
    v_sub_f32 v189, v189, v56
    v_sub_f32 v190, v190, v56
    v_sub_f32 v191, v191, v56
    v_accvgpr_read_b32 v48, a12
    v_accvgpr_read_b32 v49, a13
    v_accvgpr_read_b32 v50, a14
    v_accvgpr_read_b32 v51, a15
    v_fma_f32 v48, v48, v57, v58
    v_fma_f32 v49, v49, v57, v58
    v_fma_f32 v50, v50, v57, v58
    v_fma_f32 v51, v51, v57, v58
    v_accvgpr_write_b32 a12, v48
    v_accvgpr_write_b32 a13, v49
    v_accvgpr_write_b32 a14, v50
    v_accvgpr_write_b32 a15, v51
    v_accvgpr_read_b32 v48, a28
    v_accvgpr_read_b32 v49, a29
    v_accvgpr_read_b32 v50, a30
    v_accvgpr_read_b32 v51, a31
    v_fma_f32 v48, v48, v57, v58
    v_fma_f32 v49, v49, v57, v58
    v_fma_f32 v50, v50, v57, v58
    v_fma_f32 v51, v51, v57, v58
    v_accvgpr_write_b32 a28, v48
    v_accvgpr_write_b32 a29, v49
    v_accvgpr_write_b32 a30, v50
    v_accvgpr_write_b32 a31, v51
    v_accvgpr_read_b32 v48, a44
    v_accvgpr_read_b32 v49, a45
    v_accvgpr_read_b32 v50, a46
    v_accvgpr_read_b32 v51, a47
    v_fma_f32 v48, v48, v57, v58
    v_fma_f32 v49, v49, v57, v58
    v_fma_f32 v50, v50, v57, v58
    v_fma_f32 v51, v51, v57, v58
    v_accvgpr_write_b32 a44, v48
    v_accvgpr_write_b32 a45, v49
    v_accvgpr_write_b32 a46, v50
    v_accvgpr_write_b32 a47, v51
    v_accvgpr_read_b32 v48, a60
    v_accvgpr_read_b32 v49, a61
    v_accvgpr_read_b32 v50, a62
    v_accvgpr_read_b32 v51, a63
    v_fma_f32 v48, v48, v57, v58
    v_fma_f32 v49, v49, v57, v58
    v_fma_f32 v50, v50, v57, v58
    v_fma_f32 v51, v51, v57, v58
    v_accvgpr_write_b32 a60, v48
    v_accvgpr_write_b32 a61, v49
    v_accvgpr_write_b32 a62, v50
    v_accvgpr_write_b32 a63, v51
    v_accvgpr_read_b32 v48, a76
    v_accvgpr_read_b32 v49, a77
    v_accvgpr_read_b32 v50, a78
    v_accvgpr_read_b32 v51, a79
    v_fma_f32 v48, v48, v57, v58
    v_fma_f32 v49, v49, v57, v58
    v_fma_f32 v50, v50, v57, v58
    v_fma_f32 v51, v51, v57, v58
    v_accvgpr_write_b32 a76, v48
    v_accvgpr_write_b32 a77, v49
    v_accvgpr_write_b32 a78, v50
    v_accvgpr_write_b32 a79, v51
    v_accvgpr_read_b32 v48, a92
    v_accvgpr_read_b32 v49, a93
    v_accvgpr_read_b32 v50, a94
    v_accvgpr_read_b32 v51, a95
    v_fma_f32 v48, v48, v57, v58
    v_fma_f32 v49, v49, v57, v58
    v_fma_f32 v50, v50, v57, v58
    v_fma_f32 v51, v51, v57, v58
    v_accvgpr_write_b32 a92, v48
    v_accvgpr_write_b32 a93, v49
    v_accvgpr_write_b32 a94, v50
    v_accvgpr_write_b32 a95, v51
    v_accvgpr_read_b32 v48, a108
    v_accvgpr_read_b32 v49, a109
    v_accvgpr_read_b32 v50, a110
    v_accvgpr_read_b32 v51, a111
    v_fma_f32 v48, v48, v57, v58
    v_fma_f32 v49, v49, v57, v58
    v_fma_f32 v50, v50, v57, v58
    v_fma_f32 v51, v51, v57, v58
    v_accvgpr_write_b32 a108, v48
    v_accvgpr_write_b32 a109, v49
    v_accvgpr_write_b32 a110, v50
    v_accvgpr_write_b32 a111, v51
    v_accvgpr_read_b32 v48, a124
    v_accvgpr_read_b32 v49, a125
    v_accvgpr_read_b32 v50, a126
    v_accvgpr_read_b32 v51, a127
    v_fma_f32 v48, v48, v57, v58
    v_fma_f32 v49, v49, v57, v58
    v_fma_f32 v50, v50, v57, v58
    v_fma_f32 v51, v51, v57, v58
    v_accvgpr_write_b32 a124, v48
    v_accvgpr_write_b32 a125, v49
    v_accvgpr_write_b32 a126, v50
    v_accvgpr_write_b32 a127, v51
    v_accvgpr_read_b32 v48, a140
    v_accvgpr_read_b32 v49, a141
    v_accvgpr_read_b32 v50, a142
    v_accvgpr_read_b32 v51, a143
    v_fma_f32 v48, v48, v57, v58
    v_fma_f32 v49, v49, v57, v58
    v_fma_f32 v50, v50, v57, v58
    v_fma_f32 v51, v51, v57, v58
    v_accvgpr_write_b32 a140, v48
    v_accvgpr_write_b32 a141, v49
    v_accvgpr_write_b32 a142, v50
    v_accvgpr_write_b32 a143, v51
    v_accvgpr_read_b32 v48, a156
    v_accvgpr_read_b32 v49, a157
    v_accvgpr_read_b32 v50, a158
    v_accvgpr_read_b32 v51, a159
    v_fma_f32 v48, v48, v57, v58
    v_fma_f32 v49, v49, v57, v58
    v_fma_f32 v50, v50, v57, v58
    v_fma_f32 v51, v51, v57, v58
    v_accvgpr_write_b32 a156, v48
    v_accvgpr_write_b32 a157, v49
    v_accvgpr_write_b32 a158, v50
    v_accvgpr_write_b32 a159, v51
    v_accvgpr_read_b32 v48, a172
    v_accvgpr_read_b32 v49, a173
    v_accvgpr_read_b32 v50, a174
    v_accvgpr_read_b32 v51, a175
    v_fma_f32 v48, v48, v57, v58
    v_fma_f32 v49, v49, v57, v58
    v_fma_f32 v50, v50, v57, v58
    v_fma_f32 v51, v51, v57, v58
    v_accvgpr_write_b32 a172, v48
    v_accvgpr_write_b32 a173, v49
    v_accvgpr_write_b32 a174, v50
    v_accvgpr_write_b32 a175, v51
    v_accvgpr_read_b32 v48, a188
    v_accvgpr_read_b32 v49, a189
    v_accvgpr_read_b32 v50, a190
    v_accvgpr_read_b32 v51, a191
    v_fma_f32 v48, v48, v57, v58
    v_fma_f32 v49, v49, v57, v58
    v_fma_f32 v50, v50, v57, v58
    v_fma_f32 v51, v51, v57, v58
    v_accvgpr_write_b32 a188, v48
    v_accvgpr_write_b32 a189, v49
    v_accvgpr_write_b32 a190, v50
    v_accvgpr_write_b32 a191, v51
    v_exp_f32 v48, v92
    v_exp_f32 v49, v93
    v_exp_f32 v50, v94
    v_exp_f32 v51, v95
    v_exp_f32 v52, v124
    v_exp_f32 v53, v125
    v_exp_f32 v54, v126
    v_exp_f32 v55, v127
    s_nop 0
    v_cvt_pk_bf16_f32 v220, v48, v49
    v_cvt_pk_bf16_f32 v221, v50, v51
    v_cvt_pk_bf16_f32 v222, v52, v53
    v_cvt_pk_bf16_f32 v223, v54, v55
    v_add_f32 v27, v48, v49
    v_add_f32 v27, v27, v50
    v_add_f32 v27, v27, v51
    v_add_f32 v27, v27, v52
    v_add_f32 v27, v27, v53
    v_add_f32 v27, v27, v54
    v_add_f32 v27, v27, v55
    s_nop 1
    s_branch rare_b_ret
rare_e:
    s_nop 7
    s_nop 7
    v_max3_f32 v56, v132, v133, v134
    v_max3_f32 v56, v56, v135, v164
    v_max3_f32 v56, v56, v165, v166
    v_max3_f32 v56, v56, v167, 0
    v_mov_b32 v58, v56
    s_nop 1
    v_permlane16_swap_b32 v56, v58
    s_nop 1
    v_max_f32 v56, v56, v58
    v_mov_b32 v58, v56
    s_nop 1
    v_permlane32_swap_b32 v56, v58
    s_nop 1
    v_max_f32 v56, v56, v58
    v_exp_f32 v57, -v56
    v_sub_f32 v32, v32, v56
    v_sub_f32 v33, v33, v56
    v_sub_f32 v34, v34, v56
    v_sub_f32 v35, v35, v56
    v_mul_f32 v20, v20, v57
    v_sub_f32 v58, 1.0, v57
    v_sub_f32 v132, v132, v56
    v_sub_f32 v133, v133, v56
    v_sub_f32 v134, v134, v56
    v_sub_f32 v135, v135, v56
    v_sub_f32 v164, v164, v56
    v_sub_f32 v165, v165, v56
    v_sub_f32 v166, v166, v56
    v_sub_f32 v167, v167, v56
    v_accvgpr_read_b32 v48, a0
    v_accvgpr_read_b32 v49, a1
    v_accvgpr_read_b32 v50, a2
    v_accvgpr_read_b32 v51, a3
    v_fma_f32 v48, v48, v57, v58
    v_fma_f32 v49, v49, v57, v58
    v_fma_f32 v50, v50, v57, v58
    v_fma_f32 v51, v51, v57, v58
    v_accvgpr_write_b32 a0, v48
    v_accvgpr_write_b32 a1, v49
    v_accvgpr_write_b32 a2, v50
    v_accvgpr_write_b32 a3, v51
    v_accvgpr_read_b32 v48, a16
    v_accvgpr_read_b32 v49, a17
    v_accvgpr_read_b32 v50, a18
    v_accvgpr_read_b32 v51, a19
    v_fma_f32 v48, v48, v57, v58
    v_fma_f32 v49, v49, v57, v58
    v_fma_f32 v50, v50, v57, v58
    v_fma_f32 v51, v51, v57, v58
    v_accvgpr_write_b32 a16, v48
    v_accvgpr_write_b32 a17, v49
    v_accvgpr_write_b32 a18, v50
    v_accvgpr_write_b32 a19, v51
    v_accvgpr_read_b32 v48, a32
    v_accvgpr_read_b32 v49, a33
    v_accvgpr_read_b32 v50, a34
    v_accvgpr_read_b32 v51, a35
    v_fma_f32 v48, v48, v57, v58
    v_fma_f32 v49, v49, v57, v58
    v_fma_f32 v50, v50, v57, v58
    v_fma_f32 v51, v51, v57, v58
    v_accvgpr_write_b32 a32, v48
    v_accvgpr_write_b32 a33, v49
    v_accvgpr_write_b32 a34, v50
    v_accvgpr_write_b32 a35, v51
    v_accvgpr_read_b32 v48, a48
    v_accvgpr_read_b32 v49, a49
    v_accvgpr_read_b32 v50, a50
    v_accvgpr_read_b32 v51, a51
    v_fma_f32 v48, v48, v57, v58
    v_fma_f32 v49, v49, v57, v58
    v_fma_f32 v50, v50, v57, v58
    v_fma_f32 v51, v51, v57, v58
    v_accvgpr_write_b32 a48, v48
    v_accvgpr_write_b32 a49, v49
    v_accvgpr_write_b32 a50, v50
    v_accvgpr_write_b32 a51, v51
    v_accvgpr_read_b32 v48, a64
    v_accvgpr_read_b32 v49, a65
    v_accvgpr_read_b32 v50, a66
    v_accvgpr_read_b32 v51, a67
    v_fma_f32 v48, v48, v57, v58
    v_fma_f32 v49, v49, v57, v58
    v_fma_f32 v50, v50, v57, v58
    v_fma_f32 v51, v51, v57, v58
    v_accvgpr_write_b32 a64, v48
    v_accvgpr_write_b32 a65, v49
    v_accvgpr_write_b32 a66, v50
    v_accvgpr_write_b32 a67, v51
    v_accvgpr_read_b32 v48, a80
    v_accvgpr_read_b32 v49, a81
    v_accvgpr_read_b32 v50, a82
    v_accvgpr_read_b32 v51, a83
    v_fma_f32 v48, v48, v57, v58
    v_fma_f32 v49, v49, v57, v58
    v_fma_f32 v50, v50, v57, v58
    v_fma_f32 v51, v51, v57, v58
    v_accvgpr_write_b32 a80, v48
    v_accvgpr_write_b32 a81, v49
    v_accvgpr_write_b32 a82, v50
    v_accvgpr_write_b32 a83, v51
    v_accvgpr_read_b32 v48, a96
    v_accvgpr_read_b32 v49, a97
    v_accvgpr_read_b32 v50, a98
    v_accvgpr_read_b32 v51, a99
    v_fma_f32 v48, v48, v57, v58
    v_fma_f32 v49, v49, v57, v58
    v_fma_f32 v50, v50, v57, v58
    v_fma_f32 v51, v51, v57, v58
    v_accvgpr_write_b32 a96, v48
    v_accvgpr_write_b32 a97, v49
    v_accvgpr_write_b32 a98, v50
    v_accvgpr_write_b32 a99, v51
    v_accvgpr_read_b32 v48, a112
    v_accvgpr_read_b32 v49, a113
    v_accvgpr_read_b32 v50, a114
    v_accvgpr_read_b32 v51, a115
    v_fma_f32 v48, v48, v57, v58
    v_fma_f32 v49, v49, v57, v58
    v_fma_f32 v50, v50, v57, v58
    v_fma_f32 v51, v51, v57, v58
    v_accvgpr_write_b32 a112, v48
    v_accvgpr_write_b32 a113, v49
    v_accvgpr_write_b32 a114, v50
    v_accvgpr_write_b32 a115, v51
    v_accvgpr_read_b32 v48, a128
    v_accvgpr_read_b32 v49, a129
    v_accvgpr_read_b32 v50, a130
    v_accvgpr_read_b32 v51, a131
    v_fma_f32 v48, v48, v57, v58
    v_fma_f32 v49, v49, v57, v58
    v_fma_f32 v50, v50, v57, v58
    v_fma_f32 v51, v51, v57, v58
    v_accvgpr_write_b32 a128, v48
    v_accvgpr_write_b32 a129, v49
    v_accvgpr_write_b32 a130, v50
    v_accvgpr_write_b32 a131, v51
    v_accvgpr_read_b32 v48, a144
    v_accvgpr_read_b32 v49, a145
    v_accvgpr_read_b32 v50, a146
    v_accvgpr_read_b32 v51, a147
    v_fma_f32 v48, v48, v57, v58
    v_fma_f32 v49, v49, v57, v58
    v_fma_f32 v50, v50, v57, v58
    v_fma_f32 v51, v51, v57, v58
    v_accvgpr_write_b32 a144, v48
    v_accvgpr_write_b32 a145, v49
    v_accvgpr_write_b32 a146, v50
    v_accvgpr_write_b32 a147, v51
    v_accvgpr_read_b32 v48, a160
    v_accvgpr_read_b32 v49, a161
    v_accvgpr_read_b32 v50, a162
    v_accvgpr_read_b32 v51, a163
    v_fma_f32 v48, v48, v57, v58
    v_fma_f32 v49, v49, v57, v58
    v_fma_f32 v50, v50, v57, v58
    v_fma_f32 v51, v51, v57, v58
    v_accvgpr_write_b32 a160, v48
    v_accvgpr_write_b32 a161, v49
    v_accvgpr_write_b32 a162, v50
    v_accvgpr_write_b32 a163, v51
    v_accvgpr_read_b32 v48, a176
    v_accvgpr_read_b32 v49, a177
    v_accvgpr_read_b32 v50, a178
    v_accvgpr_read_b32 v51, a179
    v_fma_f32 v48, v48, v57, v58
    v_fma_f32 v49, v49, v57, v58
    v_fma_f32 v50, v50, v57, v58
    v_fma_f32 v51, v51, v57, v58
    v_accvgpr_write_b32 a176, v48
    v_accvgpr_write_b32 a177, v49
    v_accvgpr_write_b32 a178, v50
    v_accvgpr_write_b32 a179, v51
    v_exp_f32 v48, v132
    v_exp_f32 v49, v133
    v_exp_f32 v50, v134
    v_exp_f32 v51, v135
    v_exp_f32 v52, v164
    v_exp_f32 v53, v165
    v_exp_f32 v54, v166
    v_exp_f32 v55, v167
    s_nop 0
    v_cvt_pk_bf16_f32 v228, v48, v49
    v_cvt_pk_bf16_f32 v229, v50, v51
    v_cvt_pk_bf16_f32 v230, v52, v53
    v_cvt_pk_bf16_f32 v231, v54, v55
    v_add_f32 v24, v48, v49
    v_add_f32 v24, v24, v50
    v_add_f32 v24, v24, v51
    v_add_f32 v24, v24, v52
    v_add_f32 v24, v24, v53
    v_add_f32 v24, v24, v54
    v_add_f32 v24, v24, v55
    v_max3_f32 v56, v140, v141, v142
    v_max3_f32 v56, v56, v143, v172
    v_max3_f32 v56, v56, v173, v174
    v_max3_f32 v56, v56, v175, 0
    v_mov_b32 v58, v56
    s_nop 1
    v_permlane16_swap_b32 v56, v58
    s_nop 1
    v_max_f32 v56, v56, v58
    v_mov_b32 v58, v56
    s_nop 1
    v_permlane32_swap_b32 v56, v58
    s_nop 1
    v_max_f32 v56, v56, v58
    v_exp_f32 v57, -v56
    v_sub_f32 v36, v36, v56
    v_sub_f32 v37, v37, v56
    v_sub_f32 v38, v38, v56
    v_sub_f32 v39, v39, v56
    v_mul_f32 v21, v21, v57
    v_sub_f32 v58, 1.0, v57
    v_sub_f32 v140, v140, v56
    v_sub_f32 v141, v141, v56
    v_sub_f32 v142, v142, v56
    v_sub_f32 v143, v143, v56
    v_sub_f32 v172, v172, v56
    v_sub_f32 v173, v173, v56
    v_sub_f32 v174, v174, v56
    v_sub_f32 v175, v175, v56
    v_accvgpr_read_b32 v48, a4
    v_accvgpr_read_b32 v49, a5
    v_accvgpr_read_b32 v50, a6
    v_accvgpr_read_b32 v51, a7
    v_fma_f32 v48, v48, v57, v58
    v_fma_f32 v49, v49, v57, v58
    v_fma_f32 v50, v50, v57, v58
    v_fma_f32 v51, v51, v57, v58
    v_accvgpr_write_b32 a4, v48
    v_accvgpr_write_b32 a5, v49
    v_accvgpr_write_b32 a6, v50
    v_accvgpr_write_b32 a7, v51
    v_accvgpr_read_b32 v48, a20
    v_accvgpr_read_b32 v49, a21
    v_accvgpr_read_b32 v50, a22
    v_accvgpr_read_b32 v51, a23
    v_fma_f32 v48, v48, v57, v58
    v_fma_f32 v49, v49, v57, v58
    v_fma_f32 v50, v50, v57, v58
    v_fma_f32 v51, v51, v57, v58
    v_accvgpr_write_b32 a20, v48
    v_accvgpr_write_b32 a21, v49
    v_accvgpr_write_b32 a22, v50
    v_accvgpr_write_b32 a23, v51
    v_accvgpr_read_b32 v48, a36
    v_accvgpr_read_b32 v49, a37
    v_accvgpr_read_b32 v50, a38
    v_accvgpr_read_b32 v51, a39
    v_fma_f32 v48, v48, v57, v58
    v_fma_f32 v49, v49, v57, v58
    v_fma_f32 v50, v50, v57, v58
    v_fma_f32 v51, v51, v57, v58
    v_accvgpr_write_b32 a36, v48
    v_accvgpr_write_b32 a37, v49
    v_accvgpr_write_b32 a38, v50
    v_accvgpr_write_b32 a39, v51
    v_accvgpr_read_b32 v48, a52
    v_accvgpr_read_b32 v49, a53
    v_accvgpr_read_b32 v50, a54
    v_accvgpr_read_b32 v51, a55
    v_fma_f32 v48, v48, v57, v58
    v_fma_f32 v49, v49, v57, v58
    v_fma_f32 v50, v50, v57, v58
    v_fma_f32 v51, v51, v57, v58
    v_accvgpr_write_b32 a52, v48
    v_accvgpr_write_b32 a53, v49
    v_accvgpr_write_b32 a54, v50
    v_accvgpr_write_b32 a55, v51
    v_accvgpr_read_b32 v48, a68
    v_accvgpr_read_b32 v49, a69
    v_accvgpr_read_b32 v50, a70
    v_accvgpr_read_b32 v51, a71
    v_fma_f32 v48, v48, v57, v58
    v_fma_f32 v49, v49, v57, v58
    v_fma_f32 v50, v50, v57, v58
    v_fma_f32 v51, v51, v57, v58
    v_accvgpr_write_b32 a68, v48
    v_accvgpr_write_b32 a69, v49
    v_accvgpr_write_b32 a70, v50
    v_accvgpr_write_b32 a71, v51
    v_accvgpr_read_b32 v48, a84
    v_accvgpr_read_b32 v49, a85
    v_accvgpr_read_b32 v50, a86
    v_accvgpr_read_b32 v51, a87
    v_fma_f32 v48, v48, v57, v58
    v_fma_f32 v49, v49, v57, v58
    v_fma_f32 v50, v50, v57, v58
    v_fma_f32 v51, v51, v57, v58
    v_accvgpr_write_b32 a84, v48
    v_accvgpr_write_b32 a85, v49
    v_accvgpr_write_b32 a86, v50
    v_accvgpr_write_b32 a87, v51
    v_accvgpr_read_b32 v48, a100
    v_accvgpr_read_b32 v49, a101
    v_accvgpr_read_b32 v50, a102
    v_accvgpr_read_b32 v51, a103
    v_fma_f32 v48, v48, v57, v58
    v_fma_f32 v49, v49, v57, v58
    v_fma_f32 v50, v50, v57, v58
    v_fma_f32 v51, v51, v57, v58
    v_accvgpr_write_b32 a100, v48
    v_accvgpr_write_b32 a101, v49
    v_accvgpr_write_b32 a102, v50
    v_accvgpr_write_b32 a103, v51
    v_accvgpr_read_b32 v48, a116
    v_accvgpr_read_b32 v49, a117
    v_accvgpr_read_b32 v50, a118
    v_accvgpr_read_b32 v51, a119
    v_fma_f32 v48, v48, v57, v58
    v_fma_f32 v49, v49, v57, v58
    v_fma_f32 v50, v50, v57, v58
    v_fma_f32 v51, v51, v57, v58
    v_accvgpr_write_b32 a116, v48
    v_accvgpr_write_b32 a117, v49
    v_accvgpr_write_b32 a118, v50
    v_accvgpr_write_b32 a119, v51
    v_accvgpr_read_b32 v48, a132
    v_accvgpr_read_b32 v49, a133
    v_accvgpr_read_b32 v50, a134
    v_accvgpr_read_b32 v51, a135
    v_fma_f32 v48, v48, v57, v58
    v_fma_f32 v49, v49, v57, v58
    v_fma_f32 v50, v50, v57, v58
    v_fma_f32 v51, v51, v57, v58
    v_accvgpr_write_b32 a132, v48
    v_accvgpr_write_b32 a133, v49
    v_accvgpr_write_b32 a134, v50
    v_accvgpr_write_b32 a135, v51
    v_accvgpr_read_b32 v48, a148
    v_accvgpr_read_b32 v49, a149
    v_accvgpr_read_b32 v50, a150
    v_accvgpr_read_b32 v51, a151
    v_fma_f32 v48, v48, v57, v58
    v_fma_f32 v49, v49, v57, v58
    v_fma_f32 v50, v50, v57, v58
    v_fma_f32 v51, v51, v57, v58
    v_accvgpr_write_b32 a148, v48
    v_accvgpr_write_b32 a149, v49
    v_accvgpr_write_b32 a150, v50
    v_accvgpr_write_b32 a151, v51
    v_accvgpr_read_b32 v48, a164
    v_accvgpr_read_b32 v49, a165
    v_accvgpr_read_b32 v50, a166
    v_accvgpr_read_b32 v51, a167
    v_fma_f32 v48, v48, v57, v58
    v_fma_f32 v49, v49, v57, v58
    v_fma_f32 v50, v50, v57, v58
    v_fma_f32 v51, v51, v57, v58
    v_accvgpr_write_b32 a164, v48
    v_accvgpr_write_b32 a165, v49
    v_accvgpr_write_b32 a166, v50
    v_accvgpr_write_b32 a167, v51
    v_accvgpr_read_b32 v48, a180
    v_accvgpr_read_b32 v49, a181
    v_accvgpr_read_b32 v50, a182
    v_accvgpr_read_b32 v51, a183
    v_fma_f32 v48, v48, v57, v58
    v_fma_f32 v49, v49, v57, v58
    v_fma_f32 v50, v50, v57, v58
    v_fma_f32 v51, v51, v57, v58
    v_accvgpr_write_b32 a180, v48
    v_accvgpr_write_b32 a181, v49
    v_accvgpr_write_b32 a182, v50
    v_accvgpr_write_b32 a183, v51
    v_exp_f32 v48, v140
    v_exp_f32 v49, v141
    v_exp_f32 v50, v142
    v_exp_f32 v51, v143
    v_exp_f32 v52, v172
    v_exp_f32 v53, v173
    v_exp_f32 v54, v174
    v_exp_f32 v55, v175
    s_nop 0
    v_cvt_pk_bf16_f32 v236, v48, v49
    v_cvt_pk_bf16_f32 v237, v50, v51
    v_cvt_pk_bf16_f32 v238, v52, v53
    v_cvt_pk_bf16_f32 v239, v54, v55
    v_add_f32 v25, v48, v49
    v_add_f32 v25, v25, v50
    v_add_f32 v25, v25, v51
    v_add_f32 v25, v25, v52
    v_add_f32 v25, v25, v53
    v_add_f32 v25, v25, v54
    v_add_f32 v25, v25, v55
    v_max3_f32 v56, v148, v149, v150
    v_max3_f32 v56, v56, v151, v180
    v_max3_f32 v56, v56, v181, v182
    v_max3_f32 v56, v56, v183, 0
    v_mov_b32 v58, v56
    s_nop 1
    v_permlane16_swap_b32 v56, v58
    s_nop 1
    v_max_f32 v56, v56, v58
    v_mov_b32 v58, v56
    s_nop 1
    v_permlane32_swap_b32 v56, v58
    s_nop 1
    v_max_f32 v56, v56, v58
    v_exp_f32 v57, -v56
    v_sub_f32 v40, v40, v56
    v_sub_f32 v41, v41, v56
    v_sub_f32 v42, v42, v56
    v_sub_f32 v43, v43, v56
    v_mul_f32 v22, v22, v57
    v_sub_f32 v58, 1.0, v57
    v_sub_f32 v148, v148, v56
    v_sub_f32 v149, v149, v56
    v_sub_f32 v150, v150, v56
    v_sub_f32 v151, v151, v56
    v_sub_f32 v180, v180, v56
    v_sub_f32 v181, v181, v56
    v_sub_f32 v182, v182, v56
    v_sub_f32 v183, v183, v56
    v_accvgpr_read_b32 v48, a8
    v_accvgpr_read_b32 v49, a9
    v_accvgpr_read_b32 v50, a10
    v_accvgpr_read_b32 v51, a11
    v_fma_f32 v48, v48, v57, v58
    v_fma_f32 v49, v49, v57, v58
    v_fma_f32 v50, v50, v57, v58
    v_fma_f32 v51, v51, v57, v58
    v_accvgpr_write_b32 a8, v48
    v_accvgpr_write_b32 a9, v49
    v_accvgpr_write_b32 a10, v50
    v_accvgpr_write_b32 a11, v51
    v_accvgpr_read_b32 v48, a24
    v_accvgpr_read_b32 v49, a25
    v_accvgpr_read_b32 v50, a26
    v_accvgpr_read_b32 v51, a27
    v_fma_f32 v48, v48, v57, v58
    v_fma_f32 v49, v49, v57, v58
    v_fma_f32 v50, v50, v57, v58
    v_fma_f32 v51, v51, v57, v58
    v_accvgpr_write_b32 a24, v48
    v_accvgpr_write_b32 a25, v49
    v_accvgpr_write_b32 a26, v50
    v_accvgpr_write_b32 a27, v51
    v_accvgpr_read_b32 v48, a40
    v_accvgpr_read_b32 v49, a41
    v_accvgpr_read_b32 v50, a42
    v_accvgpr_read_b32 v51, a43
    v_fma_f32 v48, v48, v57, v58
    v_fma_f32 v49, v49, v57, v58
    v_fma_f32 v50, v50, v57, v58
    v_fma_f32 v51, v51, v57, v58
    v_accvgpr_write_b32 a40, v48
    v_accvgpr_write_b32 a41, v49
    v_accvgpr_write_b32 a42, v50
    v_accvgpr_write_b32 a43, v51
    v_accvgpr_read_b32 v48, a56
    v_accvgpr_read_b32 v49, a57
    v_accvgpr_read_b32 v50, a58
    v_accvgpr_read_b32 v51, a59
    v_fma_f32 v48, v48, v57, v58
    v_fma_f32 v49, v49, v57, v58
    v_fma_f32 v50, v50, v57, v58
    v_fma_f32 v51, v51, v57, v58
    v_accvgpr_write_b32 a56, v48
    v_accvgpr_write_b32 a57, v49
    v_accvgpr_write_b32 a58, v50
    v_accvgpr_write_b32 a59, v51
    v_accvgpr_read_b32 v48, a72
    v_accvgpr_read_b32 v49, a73
    v_accvgpr_read_b32 v50, a74
    v_accvgpr_read_b32 v51, a75
    v_fma_f32 v48, v48, v57, v58
    v_fma_f32 v49, v49, v57, v58
    v_fma_f32 v50, v50, v57, v58
    v_fma_f32 v51, v51, v57, v58
    v_accvgpr_write_b32 a72, v48
    v_accvgpr_write_b32 a73, v49
    v_accvgpr_write_b32 a74, v50
    v_accvgpr_write_b32 a75, v51
    v_accvgpr_read_b32 v48, a88
    v_accvgpr_read_b32 v49, a89
    v_accvgpr_read_b32 v50, a90
    v_accvgpr_read_b32 v51, a91
    v_fma_f32 v48, v48, v57, v58
    v_fma_f32 v49, v49, v57, v58
    v_fma_f32 v50, v50, v57, v58
    v_fma_f32 v51, v51, v57, v58
    v_accvgpr_write_b32 a88, v48
    v_accvgpr_write_b32 a89, v49
    v_accvgpr_write_b32 a90, v50
    v_accvgpr_write_b32 a91, v51
    v_accvgpr_read_b32 v48, a104
    v_accvgpr_read_b32 v49, a105
    v_accvgpr_read_b32 v50, a106
    v_accvgpr_read_b32 v51, a107
    v_fma_f32 v48, v48, v57, v58
    v_fma_f32 v49, v49, v57, v58
    v_fma_f32 v50, v50, v57, v58
    v_fma_f32 v51, v51, v57, v58
    v_accvgpr_write_b32 a104, v48
    v_accvgpr_write_b32 a105, v49
    v_accvgpr_write_b32 a106, v50
    v_accvgpr_write_b32 a107, v51
    v_accvgpr_read_b32 v48, a120
    v_accvgpr_read_b32 v49, a121
    v_accvgpr_read_b32 v50, a122
    v_accvgpr_read_b32 v51, a123
    v_fma_f32 v48, v48, v57, v58
    v_fma_f32 v49, v49, v57, v58
    v_fma_f32 v50, v50, v57, v58
    v_fma_f32 v51, v51, v57, v58
    v_accvgpr_write_b32 a120, v48
    v_accvgpr_write_b32 a121, v49
    v_accvgpr_write_b32 a122, v50
    v_accvgpr_write_b32 a123, v51
    v_accvgpr_read_b32 v48, a136
    v_accvgpr_read_b32 v49, a137
    v_accvgpr_read_b32 v50, a138
    v_accvgpr_read_b32 v51, a139
    v_fma_f32 v48, v48, v57, v58
    v_fma_f32 v49, v49, v57, v58
    v_fma_f32 v50, v50, v57, v58
    v_fma_f32 v51, v51, v57, v58
    v_accvgpr_write_b32 a136, v48
    v_accvgpr_write_b32 a137, v49
    v_accvgpr_write_b32 a138, v50
    v_accvgpr_write_b32 a139, v51
    v_accvgpr_read_b32 v48, a152
    v_accvgpr_read_b32 v49, a153
    v_accvgpr_read_b32 v50, a154
    v_accvgpr_read_b32 v51, a155
    v_fma_f32 v48, v48, v57, v58
    v_fma_f32 v49, v49, v57, v58
    v_fma_f32 v50, v50, v57, v58
    v_fma_f32 v51, v51, v57, v58
    v_accvgpr_write_b32 a152, v48
    v_accvgpr_write_b32 a153, v49
    v_accvgpr_write_b32 a154, v50
    v_accvgpr_write_b32 a155, v51
    v_accvgpr_read_b32 v48, a168
    v_accvgpr_read_b32 v49, a169
    v_accvgpr_read_b32 v50, a170
    v_accvgpr_read_b32 v51, a171
    v_fma_f32 v48, v48, v57, v58
    v_fma_f32 v49, v49, v57, v58
    v_fma_f32 v50, v50, v57, v58
    v_fma_f32 v51, v51, v57, v58
    v_accvgpr_write_b32 a168, v48
    v_accvgpr_write_b32 a169, v49
    v_accvgpr_write_b32 a170, v50
    v_accvgpr_write_b32 a171, v51
    v_accvgpr_read_b32 v48, a184
    v_accvgpr_read_b32 v49, a185
    v_accvgpr_read_b32 v50, a186
    v_accvgpr_read_b32 v51, a187
    v_fma_f32 v48, v48, v57, v58
    v_fma_f32 v49, v49, v57, v58
    v_fma_f32 v50, v50, v57, v58
    v_fma_f32 v51, v51, v57, v58
    v_accvgpr_write_b32 a184, v48
    v_accvgpr_write_b32 a185, v49
    v_accvgpr_write_b32 a186, v50
    v_accvgpr_write_b32 a187, v51
    v_exp_f32 v48, v148
    v_exp_f32 v49, v149
    v_exp_f32 v50, v150
    v_exp_f32 v51, v151
    v_exp_f32 v52, v180
    v_exp_f32 v53, v181
    v_exp_f32 v54, v182
    v_exp_f32 v55, v183
    s_nop 0
    v_cvt_pk_bf16_f32 v244, v48, v49
    v_cvt_pk_bf16_f32 v245, v50, v51
    v_cvt_pk_bf16_f32 v246, v52, v53
    v_cvt_pk_bf16_f32 v247, v54, v55
    v_add_f32 v26, v48, v49
    v_add_f32 v26, v26, v50
    v_add_f32 v26, v26, v51
    v_add_f32 v26, v26, v52
    v_add_f32 v26, v26, v53
    v_add_f32 v26, v26, v54
    v_add_f32 v26, v26, v55
    v_max3_f32 v56, v156, v157, v158
    v_max3_f32 v56, v56, v159, v188
    v_max3_f32 v56, v56, v189, v190
    v_max3_f32 v56, v56, v191, 0
    v_mov_b32 v58, v56
    s_nop 1
    v_permlane16_swap_b32 v56, v58
    s_nop 1
    v_max_f32 v56, v56, v58
    v_mov_b32 v58, v56
    s_nop 1
    v_permlane32_swap_b32 v56, v58
    s_nop 1
    v_max_f32 v56, v56, v58
    v_exp_f32 v57, -v56
    v_sub_f32 v44, v44, v56
    v_sub_f32 v45, v45, v56
    v_sub_f32 v46, v46, v56
    v_sub_f32 v47, v47, v56
    v_mul_f32 v23, v23, v57
    v_sub_f32 v58, 1.0, v57
    v_sub_f32 v156, v156, v56
    v_sub_f32 v157, v157, v56
    v_sub_f32 v158, v158, v56
    v_sub_f32 v159, v159, v56
    v_sub_f32 v188, v188, v56
    v_sub_f32 v189, v189, v56
    v_sub_f32 v190, v190, v56
    v_sub_f32 v191, v191, v56
    v_accvgpr_read_b32 v48, a12
    v_accvgpr_read_b32 v49, a13
    v_accvgpr_read_b32 v50, a14
    v_accvgpr_read_b32 v51, a15
    v_fma_f32 v48, v48, v57, v58
    v_fma_f32 v49, v49, v57, v58
    v_fma_f32 v50, v50, v57, v58
    v_fma_f32 v51, v51, v57, v58
    v_accvgpr_write_b32 a12, v48
    v_accvgpr_write_b32 a13, v49
    v_accvgpr_write_b32 a14, v50
    v_accvgpr_write_b32 a15, v51
    v_accvgpr_read_b32 v48, a28
    v_accvgpr_read_b32 v49, a29
    v_accvgpr_read_b32 v50, a30
    v_accvgpr_read_b32 v51, a31
    v_fma_f32 v48, v48, v57, v58
    v_fma_f32 v49, v49, v57, v58
    v_fma_f32 v50, v50, v57, v58
    v_fma_f32 v51, v51, v57, v58
    v_accvgpr_write_b32 a28, v48
    v_accvgpr_write_b32 a29, v49
    v_accvgpr_write_b32 a30, v50
    v_accvgpr_write_b32 a31, v51
    v_accvgpr_read_b32 v48, a44
    v_accvgpr_read_b32 v49, a45
    v_accvgpr_read_b32 v50, a46
    v_accvgpr_read_b32 v51, a47
    v_fma_f32 v48, v48, v57, v58
    v_fma_f32 v49, v49, v57, v58
    v_fma_f32 v50, v50, v57, v58
    v_fma_f32 v51, v51, v57, v58
    v_accvgpr_write_b32 a44, v48
    v_accvgpr_write_b32 a45, v49
    v_accvgpr_write_b32 a46, v50
    v_accvgpr_write_b32 a47, v51
    v_accvgpr_read_b32 v48, a60
    v_accvgpr_read_b32 v49, a61
    v_accvgpr_read_b32 v50, a62
    v_accvgpr_read_b32 v51, a63
    v_fma_f32 v48, v48, v57, v58
    v_fma_f32 v49, v49, v57, v58
    v_fma_f32 v50, v50, v57, v58
    v_fma_f32 v51, v51, v57, v58
    v_accvgpr_write_b32 a60, v48
    v_accvgpr_write_b32 a61, v49
    v_accvgpr_write_b32 a62, v50
    v_accvgpr_write_b32 a63, v51
    v_accvgpr_read_b32 v48, a76
    v_accvgpr_read_b32 v49, a77
    v_accvgpr_read_b32 v50, a78
    v_accvgpr_read_b32 v51, a79
    v_fma_f32 v48, v48, v57, v58
    v_fma_f32 v49, v49, v57, v58
    v_fma_f32 v50, v50, v57, v58
    v_fma_f32 v51, v51, v57, v58
    v_accvgpr_write_b32 a76, v48
    v_accvgpr_write_b32 a77, v49
    v_accvgpr_write_b32 a78, v50
    v_accvgpr_write_b32 a79, v51
    v_accvgpr_read_b32 v48, a92
    v_accvgpr_read_b32 v49, a93
    v_accvgpr_read_b32 v50, a94
    v_accvgpr_read_b32 v51, a95
    v_fma_f32 v48, v48, v57, v58
    v_fma_f32 v49, v49, v57, v58
    v_fma_f32 v50, v50, v57, v58
    v_fma_f32 v51, v51, v57, v58
    v_accvgpr_write_b32 a92, v48
    v_accvgpr_write_b32 a93, v49
    v_accvgpr_write_b32 a94, v50
    v_accvgpr_write_b32 a95, v51
    v_accvgpr_read_b32 v48, a108
    v_accvgpr_read_b32 v49, a109
    v_accvgpr_read_b32 v50, a110
    v_accvgpr_read_b32 v51, a111
    v_fma_f32 v48, v48, v57, v58
    v_fma_f32 v49, v49, v57, v58
    v_fma_f32 v50, v50, v57, v58
    v_fma_f32 v51, v51, v57, v58
    v_accvgpr_write_b32 a108, v48
    v_accvgpr_write_b32 a109, v49
    v_accvgpr_write_b32 a110, v50
    v_accvgpr_write_b32 a111, v51
    v_accvgpr_read_b32 v48, a124
    v_accvgpr_read_b32 v49, a125
    v_accvgpr_read_b32 v50, a126
    v_accvgpr_read_b32 v51, a127
    v_fma_f32 v48, v48, v57, v58
    v_fma_f32 v49, v49, v57, v58
    v_fma_f32 v50, v50, v57, v58
    v_fma_f32 v51, v51, v57, v58
    v_accvgpr_write_b32 a124, v48
    v_accvgpr_write_b32 a125, v49
    v_accvgpr_write_b32 a126, v50
    v_accvgpr_write_b32 a127, v51
    v_accvgpr_read_b32 v48, a140
    v_accvgpr_read_b32 v49, a141
    v_accvgpr_read_b32 v50, a142
    v_accvgpr_read_b32 v51, a143
    v_fma_f32 v48, v48, v57, v58
    v_fma_f32 v49, v49, v57, v58
    v_fma_f32 v50, v50, v57, v58
    v_fma_f32 v51, v51, v57, v58
    v_accvgpr_write_b32 a140, v48
    v_accvgpr_write_b32 a141, v49
    v_accvgpr_write_b32 a142, v50
    v_accvgpr_write_b32 a143, v51
    v_accvgpr_read_b32 v48, a156
    v_accvgpr_read_b32 v49, a157
    v_accvgpr_read_b32 v50, a158
    v_accvgpr_read_b32 v51, a159
    v_fma_f32 v48, v48, v57, v58
    v_fma_f32 v49, v49, v57, v58
    v_fma_f32 v50, v50, v57, v58
    v_fma_f32 v51, v51, v57, v58
    v_accvgpr_write_b32 a156, v48
    v_accvgpr_write_b32 a157, v49
    v_accvgpr_write_b32 a158, v50
    v_accvgpr_write_b32 a159, v51
    v_accvgpr_read_b32 v48, a172
    v_accvgpr_read_b32 v49, a173
    v_accvgpr_read_b32 v50, a174
    v_accvgpr_read_b32 v51, a175
    v_fma_f32 v48, v48, v57, v58
    v_fma_f32 v49, v49, v57, v58
    v_fma_f32 v50, v50, v57, v58
    v_fma_f32 v51, v51, v57, v58
    v_accvgpr_write_b32 a172, v48
    v_accvgpr_write_b32 a173, v49
    v_accvgpr_write_b32 a174, v50
    v_accvgpr_write_b32 a175, v51
    v_accvgpr_read_b32 v48, a188
    v_accvgpr_read_b32 v49, a189
    v_accvgpr_read_b32 v50, a190
    v_accvgpr_read_b32 v51, a191
    v_fma_f32 v48, v48, v57, v58
    v_fma_f32 v49, v49, v57, v58
    v_fma_f32 v50, v50, v57, v58
    v_fma_f32 v51, v51, v57, v58
    v_accvgpr_write_b32 a188, v48
    v_accvgpr_write_b32 a189, v49
    v_accvgpr_write_b32 a190, v50
    v_accvgpr_write_b32 a191, v51
    v_exp_f32 v48, v156
    v_exp_f32 v49, v157
    v_exp_f32 v50, v158
    v_exp_f32 v51, v159
    v_exp_f32 v52, v188
    v_exp_f32 v53, v189
    v_exp_f32 v54, v190
    v_exp_f32 v55, v191
    s_nop 0
    v_cvt_pk_bf16_f32 v252, v48, v49
    v_cvt_pk_bf16_f32 v253, v50, v51
    v_cvt_pk_bf16_f32 v254, v52, v53
    v_cvt_pk_bf16_f32 v255, v54, v55
    v_add_f32 v27, v48, v49
    v_add_f32 v27, v27, v50
    v_add_f32 v27, v27, v51
    v_add_f32 v27, v27, v52
    v_add_f32 v27, v27, v53
    v_add_f32 v27, v27, v54
    v_add_f32 v27, v27, v55
    s_nop 1
    s_branch rare_e_ret
.section .rodata,"a"
.p2align 6
.amdhsa_kernel recurrent_scan__sliding_block_cached__moe_arch_mod__prompt_kernel
  .amdhsa_next_free_vgpr 512
  .amdhsa_next_free_sgpr 102
  .amdhsa_accum_offset 256
  .amdhsa_group_segment_fixed_size 0
  .amdhsa_kernarg_size 104
  .amdhsa_user_sgpr_count 2
  .amdhsa_user_sgpr_kernarg_segment_ptr 1
  .amdhsa_system_sgpr_workgroup_id_x 1
  .amdhsa_float_denorm_mode_32 3
.end_amdhsa_kernel
```

```asm
; @launch grid=(256,1,1) block=(256,1,1) lds=163840
.amdgcn_target "amdgcn-amd-amdhsa--gfx950"
.text
.globl recurrent_scan__sliding_block_cached__moe_arch_mod__prompt_kernel
.p2align 8
.type recurrent_scan__sliding_block_cached__moe_arch_mod__prompt_kernel,@function
recurrent_scan__sliding_block_cached__moe_arch_mod__prompt_kernel:
    s_cmp_ge_u32 s2, 256
    s_cbranch_scc1 main_end
    s_load_dwordx16 s[64:79], s[0:1], 0
    s_load_dwordx4 s[80:83], s[0:1], 64
    s_load_dwordx2 s[84:85], s[0:1], 80
    s_load_dwordx2 s[86:87], s[0:1], 96
    s_bfe_u32 s30, s2, 0x20003
    s_lshl_b32 s30, s30, 3
    s_lshr_b32 s30, 0x18183060, s30
    s_and_b32 s30, s30, 0xff
    s_load_dwordx2 s[28:29], s[0:1], s30
    s_bfe_u32 s30, s2, 0x10003
    s_bfe_u32 s31, s2, 0x10005
    s_lshl1_add_u32 s30, s30, s31
    s_lshl_b32 s30, s30, 21
    s_bitcmp1_b32 s2, 3
    s_cselect_b32 s31, 0, 0x300000
    s_bitcmp1_b32 s2, 4
    s_cselect_b32 s30, s30, s31
    s_lshr_b32 s56, s2, 3
    s_lshl_b32 s56, s56, 11
    v_lshrrev_b32 v17, 4, v0
    v_lshlrev_b32 v17, 7, v17
    v_add_u32 v17, s56, v17
    s_getpc_b64 s[88:89]
    global_load_dword a220, v17, s[88:89]
    v_lshrrev_b32 v17, 6, v0
    v_lshlrev_b32 v17, 12, v17
    v_and_b32 v1, 63, v0
    v_lshl_add_u32 v17, v1, 4, v17
    v_and_b32 v1, 63, v0
    v_lshrrev_b32 v29, 6, v0
    v_mov_b32 v16, v0
    v_readfirstlane_b32 s3, v29
    s_and_b32 s53, s2, 7
    s_lshr_b32 s52, s2, 5
    s_bfe_u32 s51, s2, 0x20003
    s_lshl_b32 s50, s53, 2
    s_add_u32 s50, s50, s51
    s_lshl_b32 s60, s2, 3
    s_lshl_b32 s56, s3, 1
    s_add_u32 s60, s60, s56
    v_bfe_u32 v240, v1, 2, 1
    v_add_u32 v240, s60, v240
    v_lshrrev_b32 v241, 3, v1
    v_lshlrev_b32 v241, 6, v241
    v_and_b32 v29, 3, v1
    v_lshl_add_u32 v241, v29, 4, v241
    v_mul_u32_u24 v242, 1280, v240
    v_add_u32 v242, v242, v241
    v_lshrrev_b32 v29, 4, v1
    v_lshlrev_b32 v29, 1, v29
    v_and_b32 v7, 7, v1
    v_xor_b32 v7, v7, v29
    v_lshlrev_b32 v7, 4, v7
    v_lshrrev_b32 v29, 5, v1
    v_lshlrev_b32 v29, 3, v29
    v_bfe_u32 v5, v1, 3, 2
    v_add_u32 v5, v5, v29
    v_mul_u32_u24 v2, 12288, v5
    v_add_u32 v2, v2, v7
    v_add_u32 v3, 196608, v2
    s_lshl_b32 s54, s52, 2
    s_add_u32 s54, s54, s3
    s_mul_i32 s49, s3, 6144
    s_lshr_b32 s59, s3, 1
    s_lshl_b32 s59, s59, 5
    s_and_b32 s56, s3, 1
    s_lshl_b32 s56, s56, 2
    s_add_u32 s59, s59, s56
    s_mul_i32 s36, s59, 12288
    s_mov_b32 s37, 786432
    s_add_u32 s45, s51, s52
    s_and_b32 s45, s45, 3
    s_lshl_b32 s45, s45, 2
    s_lshr_b32 s45, 0x5050, s45
    s_and_b32 s45, s45, 15
    s_mul_i32 s56, s45, 786432
    s_add_u32 s36, s36, s56
    s_lshl_b32 s45, s45, 13
    s_lshr_b32 s56, s2, 3
    s_lshl_b32 s56, s56, 8
    v_add_u32 v22, s56, v16
    s_mov_b32 s56, 357913942
    v_mul_hi_u32 v23, s56, v22
    v_mul_u32_u24 v24, 12, v23
    v_sub_u32 v24, v22, v24
    v_mul_u32_u24 v23, 12288, v23
    v_lshl_add_u32 v23, v24, 7, v23
    s_mul_i32 s40, s51, 384
    s_sub_u32 s40, 1572864, s40
    v_lshlrev_b32 v24, 7, v1
    s_mul_i32 s47, s50, 786432
    s_add_u32 s47, s47, 589824
    s_lshl_b32 s48, s52, 13
    s_mul_i32 s56, s50, 384
    s_sub_u32 s57, 7864320, s56
    s_waitcnt lgkmcnt(0)
k_in:
    s_load_dword s4, s[28:29], s30 offset:1024
    s_mov_b32 s12, s64
    s_and_b32 s13, s65, 0xffff
    s_mov_b32 s14, 2621440
    s_mov_b32 s15, 0x00020000
    s_mov_b32 s16, s76
    s_and_b32 s17, s77, 0xffff
    s_mov_b32 s18, 1280
    s_mov_b32 s19, 0x00020000
    buffer_load_dwordx4 v[64:67], v242, s[12:15], 0 offen
    buffer_load_dwordx4 v[68:71], v242, s[12:15], 0 offen offset:512
    buffer_load_dwordx4 v[72:75], v242, s[12:15], 0 offen offset:1024
    v_mov_b32 v25, 3203072
    global_load_dword v26, v25, s[86:87] sc1
    s_lshr_b32 s44, s2, 3
    s_lshl_b32 s44, s44, 7
    s_add_u32 s44, s44, 4784128
    s_load_dword s92, s[86:87], s44 glc
    s_lshr_b32 s58, s2, 4
    s_lshl_b32 s58, s58, 14
    s_and_b32 s44, s2, 15
    s_lshl_b32 s44, s44, 2
    s_add_u32 s44, s44, s3
    s_lshl_b32 s44, s44, 7
    s_add_u32 s58, s58, s44
    s_add_u32 s58, s58, 4456448
    v_and_b32 v27, 31, v1
    v_lshlrev_b32 v27, 2, v27
    v_lshrrev_b32 v25, 5, v1
    v_lshl_add_u32 v27, v25, 13, v27
    v_add_u32 v27, s58, v27
    v_mov_b32 v25, 0
    global_store_dword v27, v25, s[86:87] sc1
    buffer_load_dwordx4 v[76:79], v241, s[16:19], 0 offen offset:0
    buffer_load_dwordx4 v[80:83], v241, s[16:19], 0 offen offset:512
    buffer_load_dwordx4 v[84:87], v241, s[16:19], 0 offen offset:1024
    s_add_u32 s8, s70, s56
    s_addc_u32 s9, s71, 0
    s_and_b32 s9, s9, 0xffff
    s_mov_b32 s10, s57
    s_mov_b32 s11, 0x00020000
    s_add_u32 m0, s49, 49152
    s_nop 0
    buffer_load_dwordx4 v2, s[8:11], s36 offen offset:0 lds
    s_add_u32 m0, s49, 50048
    s_nop 0
    buffer_load_dwordx4 v2, s[8:11], s36 offen offset:128 lds
    s_add_u32 m0, s49, 50944
    s_nop 0
    buffer_load_dwordx4 v2, s[8:11], s36 offen offset:256 lds
    s_add_u32 m0, s49, 52224
    s_nop 0
    buffer_load_dwordx4 v3, s[8:11], s36 offen offset:0 lds
    s_add_u32 m0, s49, 53120
    s_nop 0
    buffer_load_dwordx4 v3, s[8:11], s36 offen offset:128 lds
    s_add_u32 m0, s49, 54016
    s_nop 0
    buffer_load_dwordx4 v3, s[8:11], s36 offen offset:256 lds
    s_add_u32 s36, s36, s37
    s_sub_u32 s55, s36, 7864320
    s_min_u32 s36, s36, s55
    s_mov_b32 s24, s86
    s_and_b32 s25, s87, 0xffff
    s_mov_b32 s26, 268435456
    s_mov_b32 s27, 0x00020000
    s_lshl_b32 s56, s2, 2
    s_add_u32 s56, s56, s3
    s_cmp_lt_u32 s56, 20
    s_cselect_b32 s57, 0, 0x70000000
    s_add_u32 s57, s57, 3670016
    s_lshl_b32 s56, s56, 10
    s_add_u32 s56, s56, s57
    v_mov_b32 v160, 0
    v_mov_b32 v161, 0
    v_mov_b32 v162, 0
    v_mov_b32 v163, 0
    v_lshlrev_b32 v164, 4, v1
    buffer_store_dwordx4 v[160:163], v164, s[24:27], s56 offen sc1
    v_lshrrev_b32 v243, 6, v240
    v_mul_u32_u24 v243, 81920, v243
    v_bfe_u32 v29, v240, 4, 2
    v_lshl_add_u32 v243, v29, 10, v243
    v_and_b32 v29, 15, v240
    v_lshl_add_u32 v243, v29, 6, v243
    v_lshrrev_b32 v29, 3, v1
    v_lshl_add_u32 v243, v29, 12, v243
    v_and_b32 v29, 3, v1
    v_lshl_add_u32 v243, v29, 4, v243
    s_mov_b32 s38, 0x3acccccd
    s_mov_b32 s39, 0x3727c5ac
    s_mov_b32 s41, 0
    s_mov_b32 s42, 32768
    s_mov_b32 s43, 65536
    v_bfe_u32 v29, v1, 2, 3
    v_lshlrev_b32 v12, 7, v29
    v_lshrrev_b32 v29, 1, v29
    v_xor_b32 v29, 0, v29
    v_lshl_add_u32 v12, v29, 5, v12
    v_and_b32 v29, 3, v1
    v_lshl_add_u32 v12, v29, 3, v12
    v_lshrrev_b32 v29, 5, v1
    v_mul_u32_u24 v29, 3072, v29
    v_add_u32 v12, v12, v29
    v_xor_b32 v13, 32, v12
    v_xor_b32 v14, 64, v12
    v_xor_b32 v15, 96, v12
    v_add_u32 v8, 49152, v12
    v_add_u32 v9, 49152, v13
    v_add_u32 v10, 49152, v14
    v_add_u32 v11, 49152, v15
    v_and_b32 v28, 15, v1
    v_lshlrev_b32 v28, 6, v28
    v_lshrrev_b32 v29, 4, v1
    v_lshl_add_u32 v28, v29, 4, v28
    s_mul_i32 s56, s54, 81920
    s_add_u32 s56, s56, 0
    s_add_u32 s20, s86, s56
    s_addc_u32 s21, s87, 0
    s_and_b32 s21, s21, 0xffff
    s_mov_b32 s22, 81920
    s_mov_b32 s23, 0x00020000
    s_lshl_b32 s46, s54, 7
    s_add_u32 s46, s46, 4784128
    s_mov_b32 s101, 0
    s_lshl_b32 s56, s53, 12
    s_add_u32 s46, s46, s56
    s_load_dword s47, s[86:87], s46 glc
    s_lshr_b32 s6, s2, 3
    s_lshl_b32 s6, s6, 7
    s_lshl_b32 s56, s53, 2
    s_add_u32 s6, s6, s56
    s_add_u32 s6, s6, 4784128
    s_cmp_eq_u32 s3, 0
    s_cselect_b32 s6, s6, 0x70000000
    v_lshlrev_b32 v20, 12, v1
    s_mov_b64 exec, 0
pg_ret:
    s_mov_b64 exec, -1
    s_waitcnt vmcnt(12)
x_in:
    v_lshlrev_b32 v96, 16, v64
    v_and_b32 v97, 0xffff0000, v64
    v_lshlrev_b32 v98, 16, v65
    v_and_b32 v99, 0xffff0000, v65
    v_lshlrev_b32 v100, 16, v66
    v_and_b32 v101, 0xffff0000, v66
    v_lshlrev_b32 v102, 16, v67
    v_and_b32 v103, 0xffff0000, v67
    v_lshlrev_b32 v104, 16, v68
    v_and_b32 v105, 0xffff0000, v68
    v_lshlrev_b32 v106, 16, v69
    v_and_b32 v107, 0xffff0000, v69
    v_lshlrev_b32 v108, 16, v70
    v_and_b32 v109, 0xffff0000, v70
    v_lshlrev_b32 v110, 16, v71
    v_and_b32 v111, 0xffff0000, v71
    v_lshlrev_b32 v112, 16, v72
    v_and_b32 v113, 0xffff0000, v72
    v_lshlrev_b32 v114, 16, v73
    v_and_b32 v115, 0xffff0000, v73
    v_lshlrev_b32 v116, 16, v74
    v_and_b32 v117, 0xffff0000, v74
    v_lshlrev_b32 v118, 16, v75
    v_and_b32 v119, 0xffff0000, v75
    v_pk_add_f32 v[120:121], v[96:97], v[98:99]
    v_pk_add_f32 v[122:123], v[100:101], v[102:103]
    v_pk_add_f32 v[120:121], v[120:121], v[104:105]
    v_pk_add_f32 v[122:123], v[122:123], v[106:107]
    v_pk_add_f32 v[120:121], v[120:121], v[108:109]
    v_pk_add_f32 v[122:123], v[122:123], v[110:111]
    s_mov_b32 exec_hi, 0
    v_pk_add_f32 v[120:121], v[120:121], v[112:113]
    v_pk_add_f32 v[122:123], v[122:123], v[114:115]
    v_pk_add_f32 v[120:121], v[120:121], v[116:117]
    v_pk_add_f32 v[122:123], v[122:123], v[118:119]
    s_mov_b64 exec, -1
    v_pk_add_f32 v[120:121], v[120:121], v[122:123]
    v_add_f32 v120, v120, v121
    s_nop 1
    v_add_f32_dpp v120, v120, v120 quad_perm:[1,0,3,2] row_mask:0xf bank_mask:0xf
    s_nop 1
    v_add_f32_dpp v120, v120, v120 quad_perm:[2,3,0,1] row_mask:0xf bank_mask:0xf
    s_nop 1
    v_add_f32_dpp v120, v120, v120 row_ror:8 row_mask:0xf bank_mask:0xf
    v_mov_b32 v124, v120
    s_nop 1
    v_permlane16_swap_b32 v120, v124
    s_nop 1
    v_add_f32 v120, v120, v124
    v_mov_b32 v124, v120
    s_nop 1
    v_permlane32_swap_b32 v120, v124
    s_nop 1
    v_add_f32 v120, v120, v124
    v_mul_f32 v126, s38, v120
    v_mul_f32 v128, s38, -v120
    v_mul_f32 v129, s38, -v120
    v_pk_add_f32 v[132:133], v[96:97], v[128:129]
    v_pk_mul_f32 v[120:121], v[132:133], v[132:133]
    v_pk_add_f32 v[134:135], v[98:99], v[128:129]
    v_pk_mul_f32 v[122:123], v[134:135], v[134:135]
    v_pk_add_f32 v[136:137], v[100:101], v[128:129]
    v_pk_fma_f32 v[120:121], v[136:137], v[136:137], v[120:121]
    v_pk_add_f32 v[138:139], v[102:103], v[128:129]
    v_pk_fma_f32 v[122:123], v[138:139], v[138:139], v[122:123]
    v_pk_add_f32 v[132:133], v[104:105], v[128:129]
    v_pk_fma_f32 v[120:121], v[132:133], v[132:133], v[120:121]
    v_pk_add_f32 v[134:135], v[106:107], v[128:129]
    v_pk_fma_f32 v[122:123], v[134:135], v[134:135], v[122:123]
    v_pk_add_f32 v[136:137], v[108:109], v[128:129]
    v_pk_fma_f32 v[120:121], v[136:137], v[136:137], v[120:121]
    v_pk_add_f32 v[138:139], v[110:111], v[128:129]
    v_pk_fma_f32 v[122:123], v[138:139], v[138:139], v[122:123]
    s_mov_b32 exec_hi, 0
    v_pk_add_f32 v[132:133], v[112:113], v[128:129]
    v_pk_fma_f32 v[120:121], v[132:133], v[132:133], v[120:121]
    v_pk_add_f32 v[134:135], v[114:115], v[128:129]
    v_pk_fma_f32 v[122:123], v[134:135], v[134:135], v[122:123]
    v_pk_add_f32 v[136:137], v[116:117], v[128:129]
    v_pk_fma_f32 v[120:121], v[136:137], v[136:137], v[120:121]
    v_pk_add_f32 v[138:139], v[118:119], v[128:129]
    v_pk_fma_f32 v[122:123], v[138:139], v[138:139], v[122:123]
    s_mov_b64 exec, -1
    v_pk_add_f32 v[120:121], v[120:121], v[122:123]
    v_add_f32 v120, v120, v121
    s_nop 1
    v_add_f32_dpp v120, v120, v120 quad_perm:[1,0,3,2] row_mask:0xf bank_mask:0xf
    s_nop 1
    v_add_f32_dpp v120, v120, v120 quad_perm:[2,3,0,1] row_mask:0xf bank_mask:0xf
    s_nop 1
    v_add_f32_dpp v120, v120, v120 row_ror:8 row_mask:0xf bank_mask:0xf
    v_mov_b32 v124, v120
    s_nop 1
    v_permlane16_swap_b32 v120, v124
    s_nop 1
    v_add_f32 v120, v120, v124
    v_mov_b32 v124, v120
    s_nop 1
    v_permlane32_swap_b32 v120, v124
    s_nop 1
    v_add_f32 v120, v120, v124
    v_mul_f32 v130, s38, v120
    v_cvt_pk_bf16_f32 v126, v126, v126
    v_and_b32 v126, 0xffff0000, v126
    v_cvt_pk_bf16_f32 v130, v130, v130
    v_and_b32 v130, 0xffff0000, v130
    v_add_f32 v130, s39, v130
    v_cvt_pk_bf16_f32 v130, v130, v130
    v_and_b32 v130, 0xffff0000, v130
    v_sqrt_f32 v130, v130
    v_sub_f32 v128, 0, v126
    v_cvt_pk_bf16_f32 v130, v130, v130
    v_and_b32 v130, 0xffff0000, v130
    v_rcp_f32 v127, v130
    v_sub_f32 v129, 0, v126
    v_mul_f32 v120, 0x3dd53b95, v127
    v_mul_f32 v121, 0x3dd53b95, v127
    v_mov_b32 v130, v127
    v_mov_b32 v131, v127
    v_pk_add_f32 v[96:97], v[96:97], v[128:129]
    v_pk_mul_f32 v[132:133], v[96:97], v[120:121]
    v_cvt_pk_bf16_f32 v144, v132, v133
    v_pk_add_f32 v[98:99], v[98:99], v[128:129]
    v_pk_mul_f32 v[134:135], v[98:99], v[120:121]
    v_cvt_pk_bf16_f32 v145, v134, v135
    v_pk_add_f32 v[100:101], v[100:101], v[128:129]
    v_pk_mul_f32 v[136:137], v[100:101], v[120:121]
    v_cvt_pk_bf16_f32 v146, v136, v137
    v_pk_add_f32 v[102:103], v[102:103], v[128:129]
    v_pk_mul_f32 v[138:139], v[102:103], v[120:121]
    v_cvt_pk_bf16_f32 v147, v138, v139
    buffer_store_dwordx4 v[144:147], v243, s[24:27], s41 offen sc1
    v_pk_add_f32 v[104:105], v[104:105], v[128:129]
    v_pk_mul_f32 v[132:133], v[104:105], v[120:121]
    v_cvt_pk_bf16_f32 v148, v132, v133
    v_pk_add_f32 v[106:107], v[106:107], v[128:129]
    v_pk_mul_f32 v[134:135], v[106:107], v[120:121]
    v_cvt_pk_bf16_f32 v149, v134, v135
    v_pk_add_f32 v[108:109], v[108:109], v[128:129]
    v_pk_mul_f32 v[136:137], v[108:109], v[120:121]
    v_cvt_pk_bf16_f32 v150, v136, v137
    v_pk_add_f32 v[110:111], v[110:111], v[128:129]
    v_pk_mul_f32 v[138:139], v[110:111], v[120:121]
    v_cvt_pk_bf16_f32 v151, v138, v139
    buffer_store_dwordx4 v[148:151], v243, s[24:27], s42 offen sc1
    v_pk_add_f32 v[112:113], v[112:113], v[128:129]
    v_pk_mul_f32 v[132:133], v[112:113], v[120:121]
    v_cvt_pk_bf16_f32 v152, v132, v133
    v_pk_add_f32 v[114:115], v[114:115], v[128:129]
    v_pk_mul_f32 v[134:135], v[114:115], v[120:121]
    v_cvt_pk_bf16_f32 v153, v134, v135
    v_pk_add_f32 v[116:117], v[116:117], v[128:129]
    v_pk_mul_f32 v[136:137], v[116:117], v[120:121]
    v_cvt_pk_bf16_f32 v154, v136, v137
    v_pk_add_f32 v[118:119], v[118:119], v[128:129]
    v_pk_mul_f32 v[138:139], v[118:119], v[120:121]
    v_cvt_pk_bf16_f32 v155, v138, v139
    s_mov_b32 exec_hi, 0
    buffer_store_dwordx4 v[152:155], v243, s[24:27], s43 offen sc1
    s_mov_b64 exec, -1
    s_branch pg_start
    .p2align 12
pg_0:
    s_cbranch_execz pg_4
pg_start:
    s_waitcnt vmcnt(10)
    v_readfirstlane_b32 s7, v26
    v_cvt_pk_bf16_f32 v64, v96, v97
    v_lshlrev_b32 v96, 16, v64
    v_and_b32 v97, 0xffff0000, v64
    v_pk_mul_f32 v[96:97], v[96:97], v[130:131]
    v_cvt_pk_bf16_f32 v64, v96, v97
    v_lshlrev_b32 v96, 16, v64
    v_and_b32 v97, 0xffff0000, v64
    v_lshlrev_b32 v132, 16, v76
    v_and_b32 v133, 0xffff0000, v76
    v_pk_mul_f32 v[120:121], v[96:97], v[132:133]
    s_add_u32 m0, s49, 73728
    s_nop 0
    buffer_load_dwordx4 v2, s[8:11], s36 offen offset:0 lds
    s_add_u32 m0, s49, 74624
    s_nop 0
    buffer_load_dwordx4 v2, s[8:11], s36 offen offset:128 lds
    v_cvt_pk_bf16_f32 v65, v98, v99
    v_lshlrev_b32 v98, 16, v65
    v_and_b32 v99, 0xffff0000, v65
    v_pk_mul_f32 v[98:99], v[98:99], v[130:131]
    v_cvt_pk_bf16_f32 v65, v98, v99
    v_lshlrev_b32 v98, 16, v65
    v_and_b32 v99, 0xffff0000, v65
    v_lshlrev_b32 v134, 16, v77
    v_and_b32 v135, 0xffff0000, v77
    v_pk_mul_f32 v[122:123], v[98:99], v[134:135]
    s_add_u32 m0, s49, 75520
    s_nop 0
    buffer_load_dwordx4 v2, s[8:11], s36 offen offset:256 lds
    s_add_u32 m0, s49, 76800
    s_nop 0
    buffer_load_dwordx4 v3, s[8:11], s36 offen offset:0 lds
    v_cvt_pk_bf16_f32 v66, v100, v101
    v_lshlrev_b32 v100, 16, v66
    v_and_b32 v101, 0xffff0000, v66
    v_pk_mul_f32 v[100:101], v[100:101], v[130:131]
    v_cvt_pk_bf16_f32 v66, v100, v101
    v_lshlrev_b32 v100, 16, v66
    v_and_b32 v101, 0xffff0000, v66
    v_lshlrev_b32 v136, 16, v78
    v_and_b32 v137, 0xffff0000, v78
    v_pk_fma_f32 v[120:121], v[100:101], v[136:137], v[120:121]
    s_add_u32 m0, s49, 77696
    s_nop 0
    buffer_load_dwordx4 v3, s[8:11], s36 offen offset:128 lds
    s_add_u32 m0, s49, 78592
    s_nop 0
    buffer_load_dwordx4 v3, s[8:11], s36 offen offset:256 lds
    s_add_u32 s36, s36, s37
    s_sub_u32 s55, s36, 7864320
    s_min_u32 s36, s36, s55
    v_cvt_pk_bf16_f32 v67, v102, v103
    v_lshlrev_b32 v102, 16, v67
    v_and_b32 v103, 0xffff0000, v67
    v_pk_mul_f32 v[102:103], v[102:103], v[130:131]
    v_cvt_pk_bf16_f32 v67, v102, v103
    v_lshlrev_b32 v102, 16, v67
    v_and_b32 v103, 0xffff0000, v67
    v_lshlrev_b32 v138, 16, v79
    v_and_b32 v139, 0xffff0000, v79
    v_pk_fma_f32 v[122:123], v[102:103], v[138:139], v[122:123]
    s_add_u32 m0, s49, 98304
    s_nop 0
    buffer_load_dwordx4 v2, s[8:11], s36 offen offset:0 lds
    s_add_u32 m0, s49, 99200
    s_nop 0
    buffer_load_dwordx4 v2, s[8:11], s36 offen offset:128 lds
    s_waitcnt vmcnt(8) lgkmcnt(0)
    s_lshr_b32 s7, s7, 4
    s_mul_i32 s7, s7, 0x2c9277b5
    s_add_u32 s7, s7, 0x6c564b05
    s_lshl_b32 s7, s7, 4
    s_barrier
    v_mov_b32 v21, s7
    s_mov_b64 exec, 255
    buffer_store_dword v21, v20, s[24:27], s6 offen sc1
    s_mov_b64 exec, 0x11
    v_lshlrev_b32 v29, 3, v240
    s_mov_b32 s56, 3211264
    buffer_store_dwordx2 v[126:127], v29, s[24:27], s56 offen sc1
    s_mov_b64 exec, -1
    v_cvt_pk_bf16_f32 v68, v104, v105
    v_lshlrev_b32 v104, 16, v68
    v_and_b32 v105, 0xffff0000, v68
    v_pk_mul_f32 v[104:105], v[104:105], v[130:131]
    v_cvt_pk_bf16_f32 v68, v104, v105
    v_lshlrev_b32 v104, 16, v68
    v_and_b32 v105, 0xffff0000, v68
    v_lshlrev_b32 v132, 16, v80
    v_and_b32 v133, 0xffff0000, v80
    v_pk_fma_f32 v[120:121], v[104:105], v[132:133], v[120:121]
    s_add_u32 m0, s49, 100096
    s_nop 0
    buffer_load_dwordx4 v2, s[8:11], s36 offen offset:256 lds
    s_add_u32 m0, s49, 101376
    s_nop 0
    buffer_load_dwordx4 v3, s[8:11], s36 offen offset:0 lds
    s_mov_b32 s63, -1
    s_lshr_b32 s61, s2, 6
    s_or_b32 s61, s61, s3
    s_cbranch_scc1 race_skip
    s_waitcnt lgkmcnt(0)
    s_mov_b32 s63, -1
    s_load_dword s4, s[86:87], s58 offset:0x2000 glc
    s_load_dword s63, s[86:87], s58 glc
    s_waitcnt lgkmcnt(1)
race_skip:
    v_cvt_pk_bf16_f32 v69, v106, v107
    v_lshlrev_b32 v106, 16, v69
    v_and_b32 v107, 0xffff0000, v69
    v_pk_mul_f32 v[106:107], v[106:107], v[130:131]
    v_cvt_pk_bf16_f32 v69, v106, v107
    v_lshlrev_b32 v106, 16, v69
    v_and_b32 v107, 0xffff0000, v69
    v_lshlrev_b32 v134, 16, v81
    v_and_b32 v135, 0xffff0000, v81
    v_pk_fma_f32 v[122:123], v[106:107], v[134:135], v[122:123]
    s_and_b32 s93, s63, 0x2000
    s_getreg_b32 s61, hwreg(HW_REG_XCC_ID, 2, 1)
    s_mul_i32 s61, s61, 0x6000
    s_lshl_b32 s93, s93, 1
    s_xor_b32 s93, s93, s61
    s_add_u32 m0, s49, 102272
    s_nop 0
    buffer_load_dwordx4 v3, s[8:11], s36 offen offset:128 lds
    s_add_u32 m0, s49, 103168
    s_nop 0
    buffer_load_dwordx4 v3, s[8:11], s36 offen offset:256 lds
    s_add_u32 s36, s36, s37
    s_sub_u32 s55, s36, 7864320
    s_min_u32 s36, s36, s55
    s_mov_b64 exec, -1
    s_add_u32 m0, s49, 122880
    s_nop 0
    buffer_load_dwordx4 v2, s[8:11], s36 offen offset:0 lds
    s_add_u32 m0, s49, 123776
    s_nop 0
    buffer_load_dwordx4 v2, s[8:11], s36 offen offset:128 lds
    s_add_u32 m0, s49, 124672
    s_nop 0
    buffer_load_dwordx4 v2, s[8:11], s36 offen offset:256 lds
    s_add_u32 m0, s49, 125952
    s_nop 0
    buffer_load_dwordx4 v3, s[8:11], s36 offen offset:0 lds
    s_add_u32 m0, s49, 126848
    s_nop 0
    buffer_load_dwordx4 v3, s[8:11], s36 offen offset:128 lds
    s_add_u32 m0, s49, 127744
    s_nop 0
    buffer_load_dwordx4 v3, s[8:11], s36 offen offset:256 lds
    s_add_u32 s36, s36, s37
    s_sub_u32 s55, s36, 7864320
    s_min_u32 s36, s36, s55
    s_mov_b64 exec, 0
    s_cmp_eq_u32 s3, 0
    s_cbranch_scc1 pg_0
    s_cmp_eq_u32 s3, 1
    s_cbranch_scc1 pg_1
    s_cmp_eq_u32 s3, 2
    s_cbranch_scc1 pg_2
    s_cmp_eq_u32 s3, 3
    s_cbranch_scc1 pg_3
pg_ret2:
    s_mov_b64 exec, -1
    ds_read_b64_tr_b16 a[192:193], v8 offset:0
    ds_read_b64_tr_b16 a[194:195], v8 offset:6144
    ds_read_b64_tr_b16 a[196:197], v9 offset:0
    ds_read_b64_tr_b16 a[198:199], v9 offset:6144
    ds_read_b64_tr_b16 a[200:201], v10 offset:0
    ds_read_b64_tr_b16 a[202:203], v10 offset:6144
    ds_read_b64_tr_b16 a[204:205], v11 offset:0
    ds_read_b64_tr_b16 a[206:207], v11 offset:6144
spin_ln:
    s_load_dwordx8 s[28:35], s[86:87], s46 glc
    s_add_u32 s101, s101, 1
    s_cmp_gt_u32 s101, 0x2000000
    s_cselect_b32 s57, 0, -1
    s_waitcnt lgkmcnt(0)
    s_xor_b32 s56, s28, s7
    s_xor_b32 s29, s29, s7
    s_or_b32 s56, s56, s29
    s_xor_b32 s30, s30, s7
    s_or_b32 s56, s56, s30
    s_xor_b32 s31, s31, s7
    s_or_b32 s56, s56, s31
    s_xor_b32 s32, s32, s7
    s_or_b32 s56, s56, s32
    s_xor_b32 s33, s33, s7
    s_or_b32 s56, s56, s33
    s_xor_b32 s34, s34, s7
    s_or_b32 s56, s56, s34
    s_xor_b32 s35, s35, s7
    s_or_b32 s56, s56, s35
    s_and_b32 s56, s56, s57
    s_cbranch_scc1 spin_ln
z_skip:
    s_add_u32 s46, s45, 0
    s_sub_u32 s5, s46, 81920
    s_min_u32 s46, s46, s5
    buffer_load_dwordx4 a[0:3], v28, s[20:23], s46 offen offset:0 sc1
    buffer_load_dwordx4 a[4:7], v28, s[20:23], s46 offen offset:1024 sc1
    buffer_load_dwordx4 a[8:11], v28, s[20:23], s46 offen offset:2048 sc1
    buffer_load_dwordx4 a[12:15], v28, s[20:23], s46 offen offset:3072 sc1
    s_add_u32 s46, s45, 4096
    s_sub_u32 s5, s46, 81920
    s_min_u32 s46, s46, s5
    buffer_load_dwordx4 a[16:19], v28, s[20:23], s46 offen offset:0 sc1
    buffer_load_dwordx4 a[20:23], v28, s[20:23], s46 offen offset:1024 sc1
    buffer_load_dwordx4 a[24:27], v28, s[20:23], s46 offen offset:2048 sc1
    buffer_load_dwordx4 a[28:31], v28, s[20:23], s46 offen offset:3072 sc1
    v_cvt_pk_bf16_f32 v70, v108, v109
    v_lshlrev_b32 v108, 16, v70
    v_and_b32 v109, 0xffff0000, v70
    v_pk_mul_f32 v[108:109], v[108:109], v[130:131]
    v_cvt_pk_bf16_f32 v70, v108, v109
    v_lshlrev_b32 v108, 16, v70
    v_and_b32 v109, 0xffff0000, v70
    v_lshlrev_b32 v136, 16, v82
    v_and_b32 v137, 0xffff0000, v82
    v_pk_fma_f32 v[120:121], v[108:109], v[136:137], v[120:121]
    v_cvt_pk_bf16_f32 v71, v110, v111
    v_lshlrev_b32 v110, 16, v71
    v_and_b32 v111, 0xffff0000, v71
    v_pk_mul_f32 v[110:111], v[110:111], v[130:131]
    v_cvt_pk_bf16_f32 v71, v110, v111
    v_lshlrev_b32 v110, 16, v71
    v_and_b32 v111, 0xffff0000, v71
    v_lshlrev_b32 v138, 16, v83
    v_and_b32 v139, 0xffff0000, v83
    v_pk_fma_f32 v[122:123], v[110:111], v[138:139], v[122:123]
    s_mov_b32 exec_hi, 0
    v_cvt_pk_bf16_f32 v72, v112, v113
    v_lshlrev_b32 v112, 16, v72
    v_and_b32 v113, 0xffff0000, v72
    v_pk_mul_f32 v[112:113], v[112:113], v[130:131]
    v_cvt_pk_bf16_f32 v72, v112, v113
    v_lshlrev_b32 v112, 16, v72
    v_and_b32 v113, 0xffff0000, v72
    v_lshlrev_b32 v132, 16, v84
    v_and_b32 v133, 0xffff0000, v84
    v_pk_fma_f32 v[120:121], v[112:113], v[132:133], v[120:121]
    v_cvt_pk_bf16_f32 v73, v114, v115
    v_lshlrev_b32 v114, 16, v73
    v_and_b32 v115, 0xffff0000, v73
    v_pk_mul_f32 v[114:115], v[114:115], v[130:131]
    v_cvt_pk_bf16_f32 v73, v114, v115
    v_lshlrev_b32 v114, 16, v73
    v_and_b32 v115, 0xffff0000, v73
    v_lshlrev_b32 v134, 16, v85
    v_and_b32 v135, 0xffff0000, v85
    v_pk_fma_f32 v[122:123], v[114:115], v[134:135], v[122:123]
    v_cvt_pk_bf16_f32 v74, v116, v117
    v_lshlrev_b32 v116, 16, v74
    v_and_b32 v117, 0xffff0000, v74
    v_pk_mul_f32 v[116:117], v[116:117], v[130:131]
    v_cvt_pk_bf16_f32 v74, v116, v117
    v_lshlrev_b32 v116, 16, v74
    v_and_b32 v117, 0xffff0000, v74
    v_lshlrev_b32 v136, 16, v86
    v_and_b32 v137, 0xffff0000, v86
    v_pk_fma_f32 v[120:121], v[116:117], v[136:137], v[120:121]
    v_cvt_pk_bf16_f32 v75, v118, v119
    v_lshlrev_b32 v118, 16, v75
    v_and_b32 v119, 0xffff0000, v75
    v_pk_mul_f32 v[118:119], v[118:119], v[130:131]
    v_cvt_pk_bf16_f32 v75, v118, v119
    v_lshlrev_b32 v118, 16, v75
    v_and_b32 v119, 0xffff0000, v75
    v_lshlrev_b32 v138, 16, v87
    v_and_b32 v139, 0xffff0000, v87
    v_pk_fma_f32 v[122:123], v[118:119], v[138:139], v[122:123]
    s_mov_b64 exec, -1
    v_pk_add_f32 v[120:121], v[120:121], v[122:123]
    v_add_f32 v120, v120, v121
    s_nop 1
    v_add_f32_dpp v120, v120, v120 quad_perm:[1,0,3,2] row_mask:0xf bank_mask:0xf
    s_nop 1
    v_add_f32_dpp v120, v120, v120 quad_perm:[2,3,0,1] row_mask:0xf bank_mask:0xf
    s_nop 1
    v_add_f32_dpp v120, v120, v120 row_ror:8 row_mask:0xf bank_mask:0xf
    v_mov_b32 v124, v120
    s_nop 1
    v_permlane16_swap_b32 v120, v124
    s_nop 1
    v_add_f32 v120, v120, v124
    v_mov_b32 v124, v120
    s_nop 1
    v_permlane32_swap_b32 v120, v124
    s_nop 1
    v_add_f32 v120, v120, v124
    v_cvt_pk_bf16_f32 v120, v120, v120
    v_and_b32 v120, 0xffff0000, v120
    v_ashrrev_i32 v122, 31, v120
    v_or_b32 v122, 0x80000000, v122
    v_xor_b32 v120, v120, v122
    v_and_b32 v120, 0xffff0000, v120
    v_sub_u32 v122, 2047, v240
    v_or_b32 v120, v120, v122
    s_nop 1
    v_mov_b32_dpp v121, v120 row_ror:4 row_mask:0xf bank_mask:0xf
    v_mov_b32 v122, s7
    v_mov_b32 v123, s93
    s_lshl_b32 s56, s2, 2
    s_add_u32 s56, s56, s3
    s_lshl_b32 s56, s56, 4
    s_add_u32 s56, s56, 3162112
    v_mov_b32 v29, 0
    s_mov_b64 s[74:75], s[66:67]
    s_mul_i32 s57, s50, 786432
    s_add_u32 s57, s57, 688128
    s_cmp_eq_u32 s3, 1
    s_cselect_b64 s[74:75], s[68:69], s[74:75]
    s_cmp_eq_u32 s3, 2
    s_cselect_b64 s[74:75], s[78:79], s[74:75]
    s_cselect_b32 s57, 0, s57
    s_cmp_eq_u32 s3, 3
    s_cselect_b64 s[74:75], s[80:81], s[74:75]
    s_cselect_b32 s57, 0, s57
    s_load_dword s76, s[74:75], s57
    s_mov_b64 s[74:75], s[72:73]
    s_mul_i32 s57, s50, 245760
    s_cmp_eq_u32 s3, 1
    s_cselect_b64 s[74:75], s[82:83], s[74:75]
    s_cselect_b32 s57, 0, s57
    s_mul_i32 s77, s2, 10240
    s_cmp_eq_u32 s3, 2
    s_cselect_b64 s[74:75], s[84:85], s[74:75]
    s_cselect_b32 s57, s77, s57
    s_lshr_b32 s77, s2, 3
    s_lshl_b32 s77, s77, 22
    s_add_u32 s77, s77, 67563520
    s_cmp_eq_u32 s3, 3
    s_cselect_b64 s[74:75], s[86:87], s[74:75]
    s_cselect_b32 s57, s77, s57
    s_load_dword s76, s[74:75], s57
    s_waitcnt vmcnt(4)
    s_mov_b64 exec, 1
    s_waitcnt vmcnt(18)
    buffer_store_dwordx4 v[120:123], v29, s[24:27], s56 offen sc1
    s_mov_b64 exec, -1
head_code:
    v_mfma_f32_16x16x32_bf16 v[64:67], a[192:195], a[0:3], 0
    s_add_u32 s46, s45, 8192
    ds_read_b64_tr_b16 a[208:209], v8 offset:1024
    s_sub_u32 s77, s46, 81920
    v_mfma_f32_16x16x32_bf16 v[68:71], a[196:199], a[0:3], 0
    s_min_u32 s46, s46, s77
    ds_read_b64_tr_b16 a[210:211], v8 offset:7168
    v_mfma_f32_16x16x32_bf16 v[76:79], a[196:199], a[4:7], 0
    buffer_load_dwordx4 a[32:35], v28, s[20:23], s46 offen offset:0 sc1
    v_mfma_f32_16x16x32_bf16 v[72:75], a[192:195], a[4:7], 0
    v_mfma_f32_16x16x32_bf16 v[80:83], a[192:195], a[8:11], 0
    ds_read_b64_tr_b16 a[212:213], v9 offset:1024
    v_mfma_f32_16x16x32_bf16 v[84:87], a[196:199], a[8:11], 0
    ds_read_b64_tr_b16 a[214:215], v9 offset:7168
    v_mfma_f32_16x16x32_bf16 v[92:95], a[196:199], a[12:15], 0
    v_mfma_f32_16x16x32_bf16 v[88:91], a[192:195], a[12:15], 0
    s_waitcnt lgkmcnt(4)
    v_mfma_f32_16x16x32_bf16 v[120:123], a[200:203], a[12:15], 0
    ds_read_b64_tr_b16 a[192:193], v10 offset:1024
    v_mul_u32_u24 v56, 3072, v5
    v_mfma_f32_16x16x32_bf16 v[124:127], a[204:207], a[12:15], 0
    ds_read_b64_tr_b16 a[194:195], v10 offset:7168
    v_add_u32 v56, v56, v7
    v_mfma_f32_16x16x32_bf16 v[116:119], a[204:207], a[8:11], 0
    buffer_load_dwordx4 a[36:39], v28, s[20:23], s46 offen offset:1024 sc1
    v_mfma_f32_16x16x32_bf16 v[112:115], a[200:203], a[8:11], 0
    v_add_u32 v57, 49152, v56
    v_lshrrev_b32 v29, 3, v1
    v_mfma_f32_16x16x32_bf16 v[104:107], a[200:203], a[4:7], 0
    ds_read_b64_tr_b16 a[196:197], v11 offset:1024
    v_mul_u32_u24 v62, 1280, v29
    v_mfma_f32_16x16x32_bf16 v[108:111], a[204:207], a[4:7], 0
    ds_read_b64_tr_b16 a[198:199], v11 offset:7168
    v_add_u32 v62, v62, v7
    v_mfma_f32_16x16x32_bf16 v[100:103], a[204:207], a[0:3], 0
    v_add_u32 v63, 10240, v62
    v_mul_u32_u24 v31, 384, v29
    v_mfma_f32_16x16x32_bf16 v[96:99], a[200:203], a[0:3], 0
    s_waitcnt lgkmcnt(4)
    v_add_u32 v6, v31, v7
    v_add_u32 v7, 3072, v6
    v_mfma_f32_16x16x32_bf16 v[128:131], a[208:211], a[0:3], 0
    ds_read_b64_tr_b16 a[200:201], v8 offset:2048
    v_bfe_u32 v29, v1, 4, 1
    v_mfma_f32_16x16x32_bf16 v[132:135], a[212:215], a[0:3], 0
    ds_read_b64_tr_b16 a[202:203], v8 offset:8192
    v_bfe_u32 v30, v1, 5, 1
    v_mfma_f32_16x16x32_bf16 v[140:143], a[212:215], a[4:7], 0
    buffer_load_dwordx4 a[40:43], v28, s[20:23], s46 offen offset:2048 sc1
    v_mfma_f32_16x16x32_bf16 v[136:139], a[208:211], a[4:7], 0
    v_lshl_add_u32 v29, v29, 1, v30
    v_and_b32 v30, 7, v1
    v_mfma_f32_16x16x32_bf16 v[144:147], a[208:211], a[8:11], 0
    ds_read_b64_tr_b16 a[204:205], v9 offset:2048
    v_xor_b32 v30, v30, v29
    v_mfma_f32_16x16x32_bf16 v[148:151], a[212:215], a[8:11], 0
    ds_read_b64_tr_b16 a[206:207], v9 offset:8192
    v_lshl_add_u32 v4, v30, 4, v31
    v_mfma_f32_16x16x32_bf16 v[156:159], a[212:215], a[12:15], 0
    buffer_load_dwordx4 a[44:47], v28, s[20:23], s46 offen offset:3072 sc1
    v_mfma_f32_16x16x32_bf16 v[152:155], a[208:211], a[12:15], 0
    s_waitcnt lgkmcnt(4)
    v_xor_b32 v30, 4, v30
    v_lshl_add_u32 v5, v30, 4, v31
    v_mfma_f32_16x16x32_bf16 v[184:187], a[192:195], a[12:15], 0
    s_add_u32 s46, s45, 12288
    ds_read_b64_tr_b16 a[208:209], v10 offset:2048
    v_add_u32 v5, 3072, v5
    v_mfma_f32_16x16x32_bf16 v[188:191], a[196:199], a[12:15], 0
    s_sub_u32 s77, s46, 81920
    ds_read_b64_tr_b16 a[210:211], v10 offset:8192
    v_bfe_u32 v30, v1, 1, 1
    v_mfma_f32_16x16x32_bf16 v[180:183], a[196:199], a[8:11], 0
    s_min_u32 s46, s46, s77
    v_bfe_u32 v31, v1, 2, 1
    v_lshl_add_u32 v30, v30, 1, v31
    v_mfma_f32_16x16x32_bf16 v[176:179], a[192:195], a[8:11], 0
    v_bfe_u32 v31, v1, 3, 1
    v_lshl_add_u32 v30, v31, 2, v30
    v_mfma_f32_16x16x32_bf16 v[168:171], a[192:195], a[4:7], 0
    ds_read_b64_tr_b16 a[212:213], v11 offset:2048
    v_xor_b32 v30, v30, v29
    v_mfma_f32_16x16x32_bf16 v[172:175], a[196:199], a[4:7], 0
    ds_read_b64_tr_b16 a[214:215], v11 offset:8192
    v_lshlrev_b32 v30, 4, v30
    v_mfma_f32_16x16x32_bf16 v[164:167], a[196:199], a[0:3], 0
    buffer_load_dwordx4 a[48:51], v28, s[20:23], s46 offen offset:0 sc1
    v_mfma_f32_16x16x32_bf16 v[160:163], a[192:195], a[0:3], 0
    s_waitcnt lgkmcnt(4)
    v_mul_u32_u24 v31, 3072, v31
    v_and_b32 v29, 7, v1
    v_mfma_f32_16x16x32_bf16 v[192:195], a[200:203], a[0:3], 0
    ds_read_b64_tr_b16 a[192:193], v8 offset:12288
    v_lshl_add_u32 v31, v29, 7, v31
    v_mfma_f32_16x16x32_bf16 v[196:199], a[204:207], a[0:3], 0
    ds_read_b64_tr_b16 a[194:195], v8 offset:18432
    v_subrev_u32 v31, s49, v31
    v_mfma_f32_16x16x32_bf16 v[204:207], a[204:207], a[4:7], 0
    buffer_load_dwordx4 a[52:55], v28, s[20:23], s46 offen offset:1024 sc1
    v_mfma_f32_16x16x32_bf16 v[200:203], a[200:203], a[4:7], 0
    v_add_u32 v18, v31, v30
    v_xor_b32 v30, 64, v30
    v_mfma_f32_16x16x32_bf16 v[208:211], a[200:203], a[8:11], 0
    ds_read_b64_tr_b16 a[196:197], v9 offset:12288
    v_add_u32 v19, v31, v30
    v_mfma_f32_16x16x32_bf16 v[212:215], a[204:207], a[8:11], 0
    s_mul_i32 s56, s50, 786432
    ds_read_b64_tr_b16 a[198:199], v9 offset:18432
    s_add_u32 s56, s56, 589824
    v_mfma_f32_16x16x32_bf16 v[220:223], a[204:207], a[12:15], 0
    s_add_u32 s12, s66, s56
    s_addc_u32 s13, s67, 0
    s_and_b32 s13, s13, 0xffff
    v_mfma_f32_16x16x32_bf16 v[216:219], a[200:203], a[12:15], 0
    s_waitcnt lgkmcnt(4)
    s_mov_b32 s14, 196608
    s_mov_b32 s15, 0x00020000
    v_mfma_f32_16x16x32_bf16 v[248:251], a[208:211], a[12:15], 0
    s_add_u32 s16, s68, s56
    s_addc_u32 s17, s69, 0
    ds_read_b64_tr_b16 a[200:201], v10 offset:12288
    v_mfma_f32_16x16x32_bf16 v[252:255], a[212:215], a[12:15], 0
    s_and_b32 s17, s17, 0xffff
    ds_read_b64_tr_b16 a[202:203], v10 offset:18432
    s_mov_b32 s18, 196608
    v_mfma_f32_16x16x32_bf16 v[244:247], a[212:215], a[8:11], 0
    buffer_load_dwordx4 a[56:59], v28, s[20:23], s46 offen offset:2048 sc1
    v_mfma_f32_16x16x32_bf16 v[240:243], a[208:211], a[8:11], 0
    s_mov_b32 s19, 0x00020000
    s_mov_b32 s28, s78
    s_and_b32 s29, s79, 0xffff
    v_mfma_f32_16x16x32_bf16 v[232:235], a[208:211], a[4:7], 0
    s_mov_b32 s30, 1966080
    ds_read_b64_tr_b16 a[204:205], v11 offset:12288
    s_mov_b32 s31, 0x00020000
    v_mfma_f32_16x16x32_bf16 v[236:239], a[212:215], a[4:7], 0
    s_waitcnt vmcnt(8)
    ds_read_b64_tr_b16 a[206:207], v11 offset:18432
    s_mov_b32 s32, s80
    v_mfma_f32_16x16x32_bf16 v[228:231], a[212:215], a[0:3], 0
    s_and_b32 s33, s81, 0xffff
    s_mov_b32 s34, 1966080
    s_mov_b32 s35, 0x00020000
    v_mfma_f32_16x16x32_bf16 v[224:227], a[208:211], a[0:3], 0
    s_waitcnt lgkmcnt(4)
    s_mov_b32 s5, s58
    s_min_u32 s58, s2, 239
    v_mfma_f32_16x16x32_bf16 v[64:67], a[192:195], a[16:19], v[64:67]
    s_mul_hi_u32 s56, s58, 178956971
    ds_read_b64_tr_b16 a[208:209], v8 offset:13312
    s_mul_i32 s57, s56, 24
    v_mfma_f32_16x16x32_bf16 v[68:71], a[196:199], a[16:19], v[68:71]
    s_sub_u32 s57, s58, s57
    ds_read_b64_tr_b16 a[210:211], v8 offset:19456
    s_lshl_b32 s60, s56, 6
    v_mfma_f32_16x16x32_bf16 v[76:79], a[196:199], a[20:23], v[76:79]
    buffer_load_dwordx4 a[60:63], v28, s[20:23], s46 offen offset:3072 sc1
    v_mfma_f32_16x16x32_bf16 v[72:75], a[192:195], a[20:23], v[72:75]
    s_add_u32 s46, s45, 16384
    s_sub_u32 s77, s46, 81920
    s_min_u32 s46, s46, s77
    v_mfma_f32_16x16x32_bf16 v[80:83], a[192:195], a[24:27], v[80:83]
    s_add_u32 s60, s60, s59
    ds_read_b64_tr_b16 a[212:213], v9 offset:13312
    s_mul_i32 s60, s60, 3072
    v_mfma_f32_16x16x32_bf16 v[84:87], a[196:199], a[24:27], v[84:87]
    s_lshl_b32 s44, s57, 7
    ds_read_b64_tr_b16 a[214:215], v9 offset:19456
    s_add_u32 s60, s60, s44
    v_mfma_f32_16x16x32_bf16 v[92:95], a[196:199], a[28:31], v[92:95]
    buffer_load_dwordx4 a[64:67], v28, s[20:23], s46 offen offset:0 sc1
    v_mfma_f32_16x16x32_bf16 v[88:91], a[192:195], a[28:31], v[88:91]
    s_waitcnt lgkmcnt(4)
    s_lshl_b32 s61, s56, 7
    s_mul_i32 s62, s56, 1536
    v_mfma_f32_16x16x32_bf16 v[120:123], a[200:203], a[28:31], v[120:123]
    s_lshl_b32 s44, s57, 6
    ds_read_b64_tr_b16 a[192:193], v10 offset:13312
    s_add_u32 s62, s62, s44
    v_mfma_f32_16x16x32_bf16 v[124:127], a[204:207], a[28:31], v[124:127]
    s_lshl_b32 s44, s3, 4
    ds_read_b64_tr_b16 a[194:195], v10 offset:19456
    s_add_u32 s62, s62, s44
    v_mfma_f32_16x16x32_bf16 v[116:119], a[204:207], a[24:27], v[116:119]
    s_lshl_b32 s62, s62, 4
    s_add_u32 s62, s62, 3276800
    s_lshl_b32 s4, s2, 8
    v_mfma_f32_16x16x32_bf16 v[112:115], a[200:203], a[24:27], v[112:115]
    s_lshl_b32 s44, s3, 2
    s_add_u32 s4, s4, s44
    s_add_u32 s4, s4, 4718592
    v_mfma_f32_16x16x32_bf16 v[104:107], a[200:203], a[20:23], v[104:107]
    s_mov_b32 s92, 0xbfb8aa3b
    ds_read_b64_tr_b16 a[196:197], v11 offset:13312
    s_lshl_b32 s44, s3, 12
    v_mfma_f32_16x16x32_bf16 v[108:111], a[204:207], a[20:23], v[108:111]
    s_mov_b32 s38, s49
    ds_read_b64_tr_b16 a[198:199], v11 offset:19456
    s_mov_b32 s40, s49
    v_mfma_f32_16x16x32_bf16 v[100:103], a[204:207], a[16:19], v[100:103]
    buffer_load_dwordx4 a[68:71], v28, s[20:23], s46 offen offset:1024 sc1
    v_mfma_f32_16x16x32_bf16 v[96:99], a[200:203], a[16:19], v[96:99]
    s_waitcnt lgkmcnt(4)
    s_mov_b32 s39, 24576
    s_mov_b32 s47, 3162112
    v_mfma_f32_16x16x32_bf16 v[128:131], a[208:211], a[16:19], v[128:131]
    s_mov_b32 s88, 0xaaaaaaaa
    ds_read_b64_tr_b16 a[200:201], v8 offset:14336
    s_mov_b32 s89, 0xaaaaaaaa
    v_mfma_f32_16x16x32_bf16 v[132:135], a[212:215], a[16:19], v[132:135]
    ds_read_b64_tr_b16 a[202:203], v8 offset:20480
    v_mfma_f32_16x16x32_bf16 v[140:143], a[212:215], a[20:23], v[140:143]
    v_add_u32 v8, 73728, v12
    v_mfma_f32_16x16x32_bf16 v[136:139], a[208:211], a[20:23], v[136:139]
    buffer_load_dwordx4 a[72:75], v28, s[20:23], s46 offen offset:2048 sc1
    v_mfma_f32_16x16x32_bf16 v[144:147], a[208:211], a[24:27], v[144:147]
    ds_read_b64_tr_b16 a[204:205], v9 offset:14336
    v_mfma_f32_16x16x32_bf16 v[148:151], a[212:215], a[24:27], v[148:151]
    ds_read_b64_tr_b16 a[206:207], v9 offset:20480
    v_mfma_f32_16x16x32_bf16 v[156:159], a[212:215], a[28:31], v[156:159]
    v_add_u32 v9, 73728, v13
    v_mfma_f32_16x16x32_bf16 v[152:155], a[208:211], a[28:31], v[152:155]
    s_waitcnt lgkmcnt(4)
    v_mfma_f32_16x16x32_bf16 v[184:187], a[192:195], a[28:31], v[184:187]
    ds_read_b64_tr_b16 a[208:209], v10 offset:14336
    v_mfma_f32_16x16x32_bf16 v[188:191], a[196:199], a[28:31], v[188:191]
    ds_read_b64_tr_b16 a[210:211], v10 offset:20480
    v_mfma_f32_16x16x32_bf16 v[180:183], a[196:199], a[24:27], v[180:183]
    buffer_load_dwordx4 a[76:79], v28, s[20:23], s46 offen offset:3072 sc1
    v_mfma_f32_16x16x32_bf16 v[176:179], a[192:195], a[24:27], v[176:179]
    v_add_u32 v10, 73728, v14
    v_mfma_f32_16x16x32_bf16 v[168:171], a[192:195], a[20:23], v[168:171]
    s_add_u32 s46, s45, 20480
    ds_read_b64_tr_b16 a[212:213], v11 offset:14336
    s_sub_u32 s77, s46, 81920
    v_mfma_f32_16x16x32_bf16 v[172:175], a[196:199], a[20:23], v[172:175]
    s_waitcnt vmcnt(35)
    ds_read_b64_tr_b16 a[214:215], v11 offset:20480
    s_min_u32 s46, s46, s77
    v_mfma_f32_16x16x32_bf16 v[164:167], a[196:199], a[16:19], v[164:167]
    s_barrier
    v_mfma_f32_16x16x32_bf16 v[160:163], a[192:195], a[16:19], v[160:163]
    s_waitcnt lgkmcnt(4)
    v_add_u32 v11, 73728, v15
    v_mfma_f32_16x16x32_bf16 v[192:195], a[200:203], a[16:19], v[192:195]
    ds_read_b64_tr_b16 a[192:193], v8 offset:0
    v_mfma_f32_16x16x32_bf16 v[196:199], a[204:207], a[16:19], v[196:199]
    ds_read_b64_tr_b16 a[194:195], v8 offset:6144
    v_mfma_f32_16x16x32_bf16 v[204:207], a[204:207], a[20:23], v[204:207]
    buffer_load_dwordx4 a[80:83], v28, s[20:23], s46 offen offset:0 sc1
    v_mfma_f32_16x16x32_bf16 v[200:203], a[200:203], a[20:23], v[200:203]
    v_mfma_f32_16x16x32_bf16 v[208:211], a[200:203], a[24:27], v[208:211]
    ds_read_b64_tr_b16 a[196:197], v8 offset:12288
    v_mfma_f32_16x16x32_bf16 v[212:215], a[204:207], a[24:27], v[212:215]
    ds_read_b64_tr_b16 a[198:199], v8 offset:18432
    v_mfma_f32_16x16x32_bf16 v[220:223], a[204:207], a[28:31], v[220:223]
    buffer_load_dwordx4 a[84:87], v28, s[20:23], s46 offen offset:1024 sc1
    v_mfma_f32_16x16x32_bf16 v[216:219], a[200:203], a[28:31], v[216:219]
    s_waitcnt lgkmcnt(4)
    v_mfma_f32_16x16x32_bf16 v[248:251], a[208:211], a[28:31], v[248:251]
    ds_read_b64_tr_b16 a[200:201], v9 offset:0
    v_mfma_f32_16x16x32_bf16 v[252:255], a[212:215], a[28:31], v[252:255]
    ds_read_b64_tr_b16 a[202:203], v9 offset:6144
    v_mfma_f32_16x16x32_bf16 v[244:247], a[212:215], a[24:27], v[244:247]
    v_mfma_f32_16x16x32_bf16 v[240:243], a[208:211], a[24:27], v[240:243]
    v_mfma_f32_16x16x32_bf16 v[232:235], a[208:211], a[20:23], v[232:235]
    ds_read_b64_tr_b16 a[204:205], v9 offset:12288
    v_mfma_f32_16x16x32_bf16 v[236:239], a[212:215], a[20:23], v[236:239]
    s_waitcnt vmcnt(10)
    s_waitcnt vmcnt(6)
    ds_read_b64_tr_b16 a[206:207], v9 offset:18432
    v_mfma_f32_16x16x32_bf16 v[228:231], a[212:215], a[16:19], v[228:231]
    buffer_load_dwordx4 a[88:91], v28, s[20:23], s46 offen offset:2048 sc1
    v_mfma_f32_16x16x32_bf16 v[224:227], a[208:211], a[16:19], v[224:227]
    s_waitcnt lgkmcnt(4)
    v_mfma_f32_16x16x32_bf16 v[64:67], a[192:195], a[32:35], v[64:67]
    ds_read_b64_tr_b16 a[208:209], v10 offset:0
    v_mfma_f32_16x16x32_bf16 v[64:67], a[196:199], a[48:51], v[64:67]
    ds_read_b64_tr_b16 a[210:211], v10 offset:6144
    v_mfma_f32_16x16x32_bf16 v[72:75], a[196:199], a[52:55], v[72:75]
    v_mfma_f32_16x16x32_bf16 v[72:75], a[192:195], a[36:39], v[72:75]
    buffer_load_dwordx4 a[92:95], v28, s[20:23], s46 offen offset:3072 sc1
    v_mfma_f32_16x16x32_bf16 v[80:83], a[192:195], a[40:43], v[80:83]
    ds_read_b64_tr_b16 a[212:213], v10 offset:12288
    v_mfma_f32_16x16x32_bf16 v[80:83], a[196:199], a[56:59], v[80:83]
    ds_read_b64_tr_b16 a[214:215], v10 offset:18432
    v_mfma_f32_16x16x32_bf16 v[88:91], a[196:199], a[60:63], v[88:91]
    s_add_u32 s46, s45, 24576
    s_sub_u32 s77, s46, 81920
    s_min_u32 s46, s46, s77
    v_mfma_f32_16x16x32_bf16 v[88:91], a[192:195], a[44:47], v[88:91]
pg_1:
    s_cbranch_execz pg_5
    s_waitcnt lgkmcnt(4)
    v_mfma_f32_16x16x32_bf16 v[92:95], a[200:203], a[44:47], v[92:95]
    ds_read_b64_tr_b16 a[192:193], v11 offset:0
    v_mfma_f32_16x16x32_bf16 v[92:95], a[204:207], a[60:63], v[92:95]
    ds_read_b64_tr_b16 a[194:195], v11 offset:6144
    v_mfma_f32_16x16x32_bf16 v[84:87], a[204:207], a[56:59], v[84:87]
    buffer_load_dwordx4 a[96:99], v28, s[20:23], s46 offen offset:0 sc1
    v_mfma_f32_16x16x32_bf16 v[84:87], a[200:203], a[40:43], v[84:87]
    v_mfma_f32_16x16x32_bf16 v[76:79], a[200:203], a[36:39], v[76:79]
    ds_read_b64_tr_b16 a[196:197], v11 offset:12288
    v_mfma_f32_16x16x32_bf16 v[76:79], a[204:207], a[52:55], v[76:79]
    ds_read_b64_tr_b16 a[198:199], v11 offset:18432
    v_mfma_f32_16x16x32_bf16 v[68:71], a[204:207], a[48:51], v[68:71]
    v_mfma_f32_16x16x32_bf16 v[68:71], a[200:203], a[32:35], v[68:71]
    s_waitcnt lgkmcnt(4)
    v_mfma_f32_16x16x32_bf16 v[96:99], a[208:211], a[32:35], v[96:99]
    ds_read_b64_tr_b16 a[200:201], v8 offset:1024
    v_mfma_f32_16x16x32_bf16 v[96:99], a[212:215], a[48:51], v[96:99]
    ds_read_b64_tr_b16 a[202:203], v8 offset:7168
    v_mfma_f32_16x16x32_bf16 v[104:107], a[212:215], a[52:55], v[104:107]
    buffer_load_dwordx4 a[100:103], v28, s[20:23], s46 offen offset:1024 sc1
    v_mfma_f32_16x16x32_bf16 v[104:107], a[208:211], a[36:39], v[104:107]
    v_mfma_f32_16x16x32_bf16 v[112:115], a[208:211], a[40:43], v[112:115]
    ds_read_b64_tr_b16 a[204:205], v8 offset:13312
    v_mfma_f32_16x16x32_bf16 v[112:115], a[212:215], a[56:59], v[112:115]
    ds_read_b64_tr_b16 a[206:207], v8 offset:19456
    v_mfma_f32_16x16x32_bf16 v[120:123], a[212:215], a[60:63], v[120:123]
    v_mfma_f32_16x16x32_bf16 v[120:123], a[208:211], a[44:47], v[120:123]
    s_waitcnt lgkmcnt(4)
    v_mfma_f32_16x16x32_bf16 v[124:127], a[192:195], a[44:47], v[124:127]
    ds_read_b64_tr_b16 a[208:209], v9 offset:1024
    v_mfma_f32_16x16x32_bf16 v[124:127], a[196:199], a[60:63], v[124:127]
    ds_read_b64_tr_b16 a[210:211], v9 offset:7168
    v_mfma_f32_16x16x32_bf16 v[116:119], a[196:199], a[56:59], v[116:119]
    buffer_load_dwordx4 a[104:107], v28, s[20:23], s46 offen offset:2048 sc1
    v_mfma_f32_16x16x32_bf16 v[116:119], a[192:195], a[40:43], v[116:119]
    v_mfma_f32_16x16x32_bf16 v[108:111], a[192:195], a[36:39], v[108:111]
    ds_read_b64_tr_b16 a[212:213], v9 offset:13312
    v_mfma_f32_16x16x32_bf16 v[108:111], a[196:199], a[52:55], v[108:111]
    ds_read_b64_tr_b16 a[214:215], v9 offset:19456
    v_mfma_f32_16x16x32_bf16 v[100:103], a[196:199], a[48:51], v[100:103]
    buffer_load_dwordx4 a[108:111], v28, s[20:23], s46 offen offset:3072 sc1
    v_mfma_f32_16x16x32_bf16 v[100:103], a[192:195], a[32:35], v[100:103]
    s_waitcnt lgkmcnt(4)
    v_mfma_f32_16x16x32_bf16 v[128:131], a[200:203], a[32:35], v[128:131]
    ds_read_b64_tr_b16 a[192:193], v10 offset:1024
    v_mfma_f32_16x16x32_bf16 v[128:131], a[204:207], a[48:51], v[128:131]
    ds_read_b64_tr_b16 a[194:195], v10 offset:7168
    v_mfma_f32_16x16x32_bf16 v[136:139], a[204:207], a[52:55], v[136:139]
    v_mfma_f32_16x16x32_bf16 v[136:139], a[200:203], a[36:39], v[136:139]
    s_add_u32 m0, s49, 0
    v_mfma_f32_16x16x32_bf16 v[144:147], a[200:203], a[40:43], v[144:147]
    ds_read_b64_tr_b16 a[196:197], v10 offset:13312
    v_mfma_f32_16x16x32_bf16 v[144:147], a[204:207], a[56:59], v[144:147]
    ds_read_b64_tr_b16 a[198:199], v10 offset:19456
    v_mfma_f32_16x16x32_bf16 v[152:155], a[204:207], a[60:63], v[152:155]
    buffer_load_dwordx4 v2, s[8:11], s36 offen offset:0 lds
    v_mfma_f32_16x16x32_bf16 v[152:155], a[200:203], a[44:47], v[152:155]
    s_waitcnt lgkmcnt(4)
    v_mfma_f32_16x16x32_bf16 v[156:159], a[208:211], a[44:47], v[156:159]
    ds_read_b64_tr_b16 a[200:201], v11 offset:1024
    v_mfma_f32_16x16x32_bf16 v[156:159], a[212:215], a[60:63], v[156:159]
    s_add_u32 m0, s49, 896
    ds_read_b64_tr_b16 a[202:203], v11 offset:7168
    v_mfma_f32_16x16x32_bf16 v[148:151], a[212:215], a[56:59], v[148:151]
    buffer_load_dwordx4 v2, s[8:11], s36 offen offset:128 lds
    v_mfma_f32_16x16x32_bf16 v[148:151], a[208:211], a[40:43], v[148:151]
    v_mfma_f32_16x16x32_bf16 v[140:143], a[208:211], a[36:39], v[140:143]
    ds_read_b64_tr_b16 a[204:205], v11 offset:13312
    v_mfma_f32_16x16x32_bf16 v[140:143], a[212:215], a[52:55], v[140:143]
    ds_read_b64_tr_b16 a[206:207], v11 offset:19456
    v_mfma_f32_16x16x32_bf16 v[132:135], a[212:215], a[48:51], v[132:135]
    v_mfma_f32_16x16x32_bf16 v[132:135], a[208:211], a[32:35], v[132:135]
    s_waitcnt lgkmcnt(4)
    v_mfma_f32_16x16x32_bf16 v[160:163], a[192:195], a[32:35], v[160:163]
    s_add_u32 m0, s49, 1792
    ds_read_b64_tr_b16 a[208:209], v8 offset:2048
    v_mfma_f32_16x16x32_bf16 v[160:163], a[196:199], a[48:51], v[160:163]
    ds_read_b64_tr_b16 a[210:211], v8 offset:8192
    v_mfma_f32_16x16x32_bf16 v[168:171], a[196:199], a[52:55], v[168:171]
    buffer_load_dwordx4 v2, s[8:11], s36 offen offset:256 lds
    v_mfma_f32_16x16x32_bf16 v[168:171], a[192:195], a[36:39], v[168:171]
    v_mfma_f32_16x16x32_bf16 v[176:179], a[192:195], a[40:43], v[176:179]
    ds_read_b64_tr_b16 a[212:213], v8 offset:14336
    v_mfma_f32_16x16x32_bf16 v[176:179], a[196:199], a[56:59], v[176:179]
    ds_read_b64_tr_b16 a[214:215], v8 offset:20480
    v_mfma_f32_16x16x32_bf16 v[184:187], a[196:199], a[60:63], v[184:187]
    s_add_u32 m0, s49, 3072
    v_add_u32 v8, 98304, v12
    v_mfma_f32_16x16x32_bf16 v[184:187], a[192:195], a[44:47], v[184:187]
    s_waitcnt lgkmcnt(4)
    v_mfma_f32_16x16x32_bf16 v[188:191], a[200:203], a[44:47], v[188:191]
    ds_read_b64_tr_b16 a[192:193], v9 offset:2048
    v_mfma_f32_16x16x32_bf16 v[188:191], a[204:207], a[60:63], v[188:191]
    ds_read_b64_tr_b16 a[194:195], v9 offset:8192
    v_mfma_f32_16x16x32_bf16 v[180:183], a[204:207], a[56:59], v[180:183]
    buffer_load_dwordx4 v3, s[8:11], s36 offen offset:0 lds
    v_mfma_f32_16x16x32_bf16 v[180:183], a[200:203], a[40:43], v[180:183]
    v_mfma_f32_16x16x32_bf16 v[172:175], a[200:203], a[36:39], v[172:175]
    ds_read_b64_tr_b16 a[196:197], v9 offset:14336
    v_mfma_f32_16x16x32_bf16 v[172:175], a[204:207], a[52:55], v[172:175]
    s_add_u32 m0, s49, 3968
    ds_read_b64_tr_b16 a[198:199], v9 offset:20480
    v_mfma_f32_16x16x32_bf16 v[164:167], a[204:207], a[48:51], v[164:167]
    buffer_load_dwordx4 v3, s[8:11], s36 offen offset:128 lds
    v_mfma_f32_16x16x32_bf16 v[164:167], a[200:203], a[32:35], v[164:167]
    s_waitcnt lgkmcnt(4)
    v_add_u32 v9, 98304, v13
    v_mfma_f32_16x16x32_bf16 v[192:195], a[208:211], a[32:35], v[192:195]
    ds_read_b64_tr_b16 a[200:201], v10 offset:2048
    v_mfma_f32_16x16x32_bf16 v[192:195], a[212:215], a[48:51], v[192:195]
    ds_read_b64_tr_b16 a[202:203], v10 offset:8192
    v_mfma_f32_16x16x32_bf16 v[200:203], a[212:215], a[52:55], v[200:203]
    v_mfma_f32_16x16x32_bf16 v[200:203], a[208:211], a[36:39], v[200:203]
    s_add_u32 m0, s49, 4864
    v_mfma_f32_16x16x32_bf16 v[208:211], a[208:211], a[40:43], v[208:211]
    ds_read_b64_tr_b16 a[204:205], v10 offset:14336
    v_mfma_f32_16x16x32_bf16 v[208:211], a[212:215], a[56:59], v[208:211]
    ds_read_b64_tr_b16 a[206:207], v10 offset:20480
    v_mfma_f32_16x16x32_bf16 v[216:219], a[212:215], a[60:63], v[216:219]
    buffer_load_dwordx4 v3, s[8:11], s36 offen offset:256 lds
    v_mfma_f32_16x16x32_bf16 v[216:219], a[208:211], a[44:47], v[216:219]
    s_waitcnt lgkmcnt(4)
    v_add_u32 v10, 98304, v14
    s_add_u32 s36, s36, s37
    v_mfma_f32_16x16x32_bf16 v[220:223], a[192:195], a[44:47], v[220:223]
    s_sub_u32 s55, s36, 7864320
    ds_read_b64_tr_b16 a[208:209], v11 offset:2048
    s_min_u32 s36, s36, s55
    v_mfma_f32_16x16x32_bf16 v[220:223], a[196:199], a[60:63], v[220:223]
    s_add_u32 s46, s45, 28672
    ds_read_b64_tr_b16 a[210:211], v11 offset:8192
    s_sub_u32 s77, s46, 81920
    v_mfma_f32_16x16x32_bf16 v[212:215], a[196:199], a[56:59], v[212:215]
    s_min_u32 s46, s46, s77
    v_mfma_f32_16x16x32_bf16 v[212:215], a[192:195], a[40:43], v[212:215]
    buffer_load_dwordx4 a[112:115], v28, s[20:23], s46 offen offset:0 sc1
    v_mfma_f32_16x16x32_bf16 v[204:207], a[192:195], a[36:39], v[204:207]
    ds_read_b64_tr_b16 a[212:213], v11 offset:14336
    v_mfma_f32_16x16x32_bf16 v[204:207], a[196:199], a[52:55], v[204:207]
    s_waitcnt vmcnt(42)
    ds_read_b64_tr_b16 a[214:215], v11 offset:20480
    v_mfma_f32_16x16x32_bf16 v[196:199], a[196:199], a[48:51], v[196:199]
    s_barrier
    v_mfma_f32_16x16x32_bf16 v[196:199], a[192:195], a[32:35], v[196:199]
    s_waitcnt lgkmcnt(4)
    v_add_u32 v11, 98304, v15
    v_mfma_f32_16x16x32_bf16 v[224:227], a[200:203], a[32:35], v[224:227]
    ds_read_b64_tr_b16 a[192:193], v8 offset:0
    v_mfma_f32_16x16x32_bf16 v[224:227], a[204:207], a[48:51], v[224:227]
    ds_read_b64_tr_b16 a[194:195], v8 offset:6144
    v_mfma_f32_16x16x32_bf16 v[232:235], a[204:207], a[52:55], v[232:235]
    buffer_load_dwordx4 a[116:119], v28, s[20:23], s46 offen offset:1024 sc1
    v_mfma_f32_16x16x32_bf16 v[232:235], a[200:203], a[36:39], v[232:235]
    v_mfma_f32_16x16x32_bf16 v[240:243], a[200:203], a[40:43], v[240:243]
    ds_read_b64_tr_b16 a[196:197], v8 offset:12288
    v_mov_b32 v23, 0
    v_mfma_f32_16x16x32_bf16 v[240:243], a[204:207], a[56:59], v[240:243]
    ds_read_b64_tr_b16 a[198:199], v8 offset:18432
    v_mfma_f32_16x16x32_bf16 v[248:251], a[204:207], a[60:63], v[248:251]
    buffer_load_dword a218, v23, s[24:27], s4 offen offset:128 sc1
    v_mfma_f32_16x16x32_bf16 v[248:251], a[200:203], a[44:47], v[248:251]
    s_waitcnt lgkmcnt(4)
    v_mfma_f32_16x16x32_bf16 v[252:255], a[208:211], a[44:47], v[252:255]
    ds_read_b64_tr_b16 a[200:201], v9 offset:0
    v_mfma_f32_16x16x32_bf16 v[252:255], a[212:215], a[60:63], v[252:255]
    ds_read_b64_tr_b16 a[202:203], v9 offset:6144
    v_mfma_f32_16x16x32_bf16 v[244:247], a[212:215], a[56:59], v[244:247]
    buffer_load_dwordx4 a[120:123], v28, s[20:23], s46 offen offset:2048 sc1
    v_mfma_f32_16x16x32_bf16 v[244:247], a[208:211], a[40:43], v[244:247]
    v_mfma_f32_16x16x32_bf16 v[236:239], a[208:211], a[36:39], v[236:239]
    ds_read_b64_tr_b16 a[204:205], v9 offset:12288
    v_mfma_f32_16x16x32_bf16 v[236:239], a[212:215], a[52:55], v[236:239]
    s_waitcnt vmcnt(18)
    s_waitcnt vmcnt(14)
    ds_read_b64_tr_b16 a[206:207], v9 offset:18432
    v_mfma_f32_16x16x32_bf16 v[228:231], a[212:215], a[48:51], v[228:231]
    buffer_load_dwordx4 a[124:127], v28, s[20:23], s46 offen offset:3072 sc1
    v_mfma_f32_16x16x32_bf16 v[228:231], a[208:211], a[32:35], v[228:231]
    s_waitcnt lgkmcnt(4)
    v_mfma_f32_16x16x32_bf16 v[64:67], a[192:195], a[64:67], v[64:67]
    ds_read_b64_tr_b16 a[208:209], v10 offset:0
    v_mfma_f32_16x16x32_bf16 v[64:67], a[196:199], a[80:83], v[64:67]
    s_add_u32 s46, s45, 32768
    ds_read_b64_tr_b16 a[210:211], v10 offset:6144
    s_sub_u32 s77, s46, 81920
    v_mfma_f32_16x16x32_bf16 v[72:75], a[196:199], a[84:87], v[72:75]
    s_min_u32 s46, s46, s77
    v_mfma_f32_16x16x32_bf16 v[72:75], a[192:195], a[68:71], v[72:75]
    v_mfma_f32_16x16x32_bf16 v[80:83], a[192:195], a[72:75], v[80:83]
    ds_read_b64_tr_b16 a[212:213], v10 offset:12288
    v_mfma_f32_16x16x32_bf16 v[80:83], a[196:199], a[88:91], v[80:83]
    ds_read_b64_tr_b16 a[214:215], v10 offset:18432
    v_mfma_f32_16x16x32_bf16 v[88:91], a[196:199], a[92:95], v[88:91]
    buffer_load_dwordx4 a[128:131], v28, s[20:23], s46 offen offset:0 sc1
    v_mfma_f32_16x16x32_bf16 v[88:91], a[192:195], a[76:79], v[88:91]
    s_waitcnt lgkmcnt(4)
    v_mfma_f32_16x16x32_bf16 v[92:95], a[200:203], a[76:79], v[92:95]
    ds_read_b64_tr_b16 a[192:193], v11 offset:0
    v_mfma_f32_16x16x32_bf16 v[92:95], a[204:207], a[92:95], v[92:95]
    ds_read_b64_tr_b16 a[194:195], v11 offset:6144
    v_mfma_f32_16x16x32_bf16 v[84:87], a[204:207], a[88:91], v[84:87]
    v_mfma_f32_16x16x32_bf16 v[84:87], a[200:203], a[72:75], v[84:87]
    buffer_load_dwordx4 a[132:135], v28, s[20:23], s46 offen offset:1024 sc1
    v_mfma_f32_16x16x32_bf16 v[76:79], a[200:203], a[68:71], v[76:79]
    ds_read_b64_tr_b16 a[196:197], v11 offset:12288
    v_mfma_f32_16x16x32_bf16 v[76:79], a[204:207], a[84:87], v[76:79]
    ds_read_b64_tr_b16 a[198:199], v11 offset:18432
    v_mfma_f32_16x16x32_bf16 v[68:71], a[204:207], a[80:83], v[68:71]
    v_mfma_f32_16x16x32_bf16 v[68:71], a[200:203], a[64:67], v[68:71]
    s_waitcnt lgkmcnt(4)
    v_mfma_f32_16x16x32_bf16 v[96:99], a[208:211], a[64:67], v[96:99]
    ds_read_b64_tr_b16 a[200:201], v8 offset:1024
    v_mfma_f32_16x16x32_bf16 v[96:99], a[212:215], a[80:83], v[96:99]
    ds_read_b64_tr_b16 a[202:203], v8 offset:7168
    v_mfma_f32_16x16x32_bf16 v[104:107], a[212:215], a[84:87], v[104:107]
    buffer_load_dwordx4 a[136:139], v28, s[20:23], s46 offen offset:2048 sc1
    v_mfma_f32_16x16x32_bf16 v[104:107], a[208:211], a[68:71], v[104:107]
    v_mfma_f32_16x16x32_bf16 v[112:115], a[208:211], a[72:75], v[112:115]
    ds_read_b64_tr_b16 a[204:205], v8 offset:13312
    v_mfma_f32_16x16x32_bf16 v[112:115], a[212:215], a[88:91], v[112:115]
    ds_read_b64_tr_b16 a[206:207], v8 offset:19456
    v_mfma_f32_16x16x32_bf16 v[120:123], a[212:215], a[92:95], v[120:123]
    v_mfma_f32_16x16x32_bf16 v[120:123], a[208:211], a[76:79], v[120:123]
    s_waitcnt lgkmcnt(4)
    v_mfma_f32_16x16x32_bf16 v[124:127], a[192:195], a[76:79], v[124:127]
    ds_read_b64_tr_b16 a[208:209], v9 offset:1024
    v_mfma_f32_16x16x32_bf16 v[124:127], a[196:199], a[92:95], v[124:127]
    ds_read_b64_tr_b16 a[210:211], v9 offset:7168
    v_mfma_f32_16x16x32_bf16 v[116:119], a[196:199], a[88:91], v[116:119]
    buffer_load_dwordx4 a[140:143], v28, s[20:23], s46 offen offset:3072 sc1
    v_mfma_f32_16x16x32_bf16 v[116:119], a[192:195], a[72:75], v[116:119]
    v_mfma_f32_16x16x32_bf16 v[108:111], a[192:195], a[68:71], v[108:111]
    ds_read_b64_tr_b16 a[212:213], v9 offset:13312
    v_mfma_f32_16x16x32_bf16 v[108:111], a[196:199], a[84:87], v[108:111]
    ds_read_b64_tr_b16 a[214:215], v9 offset:19456
    v_mfma_f32_16x16x32_bf16 v[100:103], a[196:199], a[80:83], v[100:103]
    s_add_u32 m0, s49, 24576
    v_mfma_f32_16x16x32_bf16 v[100:103], a[192:195], a[64:67], v[100:103]
    s_waitcnt lgkmcnt(4)
    v_mfma_f32_16x16x32_bf16 v[128:131], a[200:203], a[64:67], v[128:131]
    ds_read_b64_tr_b16 a[192:193], v10 offset:1024
    v_mfma_f32_16x16x32_bf16 v[128:131], a[204:207], a[80:83], v[128:131]
    ds_read_b64_tr_b16 a[194:195], v10 offset:7168
    v_mfma_f32_16x16x32_bf16 v[136:139], a[204:207], a[84:87], v[136:139]
    buffer_load_dwordx4 v2, s[8:11], s36 offen offset:0 lds
    v_mfma_f32_16x16x32_bf16 v[136:139], a[200:203], a[68:71], v[136:139]
    v_mfma_f32_16x16x32_bf16 v[144:147], a[200:203], a[72:75], v[144:147]
    s_add_u32 m0, s49, 25472
    ds_read_b64_tr_b16 a[196:197], v10 offset:13312
    v_mfma_f32_16x16x32_bf16 v[144:147], a[204:207], a[88:91], v[144:147]
    ds_read_b64_tr_b16 a[198:199], v10 offset:19456
    v_mfma_f32_16x16x32_bf16 v[152:155], a[204:207], a[92:95], v[152:155]
    buffer_load_dwordx4 v2, s[8:11], s36 offen offset:128 lds
    v_mfma_f32_16x16x32_bf16 v[152:155], a[200:203], a[76:79], v[152:155]
    s_waitcnt lgkmcnt(4)
    v_mfma_f32_16x16x32_bf16 v[156:159], a[208:211], a[76:79], v[156:159]
    ds_read_b64_tr_b16 a[200:201], v11 offset:1024
    v_mfma_f32_16x16x32_bf16 v[156:159], a[212:215], a[92:95], v[156:159]
    ds_read_b64_tr_b16 a[202:203], v11 offset:7168
    v_mfma_f32_16x16x32_bf16 v[148:151], a[212:215], a[88:91], v[148:151]
    buffer_load_dwordx4 v[32:35], v17, s[24:27], s47 offen offset:0 sc1
    v_mfma_f32_16x16x32_bf16 v[148:151], a[208:211], a[72:75], v[148:151]
    s_add_u32 m0, s49, 26368
    v_mfma_f32_16x16x32_bf16 v[140:143], a[208:211], a[68:71], v[140:143]
    ds_read_b64_tr_b16 a[204:205], v11 offset:13312
    v_mfma_f32_16x16x32_bf16 v[140:143], a[212:215], a[84:87], v[140:143]
    ds_read_b64_tr_b16 a[206:207], v11 offset:19456
    v_mfma_f32_16x16x32_bf16 v[132:135], a[212:215], a[80:83], v[132:135]
    buffer_load_dwordx4 v2, s[8:11], s36 offen offset:256 lds
    v_mfma_f32_16x16x32_bf16 v[132:135], a[208:211], a[64:67], v[132:135]
    s_waitcnt lgkmcnt(4)
    v_mfma_f32_16x16x32_bf16 v[160:163], a[192:195], a[64:67], v[160:163]
    ds_read_b64_tr_b16 a[208:209], v8 offset:2048
    v_mfma_f32_16x16x32_bf16 v[160:163], a[196:199], a[80:83], v[160:163]
    s_add_u32 m0, s49, 27648
    ds_read_b64_tr_b16 a[210:211], v8 offset:8192
    v_mfma_f32_16x16x32_bf16 v[168:171], a[196:199], a[84:87], v[168:171]
    buffer_load_dwordx4 v3, s[8:11], s36 offen offset:0 lds
    v_mfma_f32_16x16x32_bf16 v[168:171], a[192:195], a[68:71], v[168:171]
    v_mfma_f32_16x16x32_bf16 v[176:179], a[192:195], a[72:75], v[176:179]
    ds_read_b64_tr_b16 a[212:213], v8 offset:14336
    v_mfma_f32_16x16x32_bf16 v[176:179], a[196:199], a[88:91], v[176:179]
    ds_read_b64_tr_b16 a[214:215], v8 offset:20480
    v_mfma_f32_16x16x32_bf16 v[184:187], a[196:199], a[92:95], v[184:187]
    buffer_load_dwordx4 v[36:39], v17, s[24:27], s47 offen offset:1024 sc1
    v_mfma_f32_16x16x32_bf16 v[184:187], a[192:195], a[76:79], v[184:187]
    s_waitcnt lgkmcnt(4)
    v_add_u32 v8, 122880, v12
    v_mfma_f32_16x16x32_bf16 v[188:191], a[200:203], a[76:79], v[188:191]
    s_add_u32 m0, s49, 28544
    ds_read_b64_tr_b16 a[192:193], v9 offset:2048
    v_mfma_f32_16x16x32_bf16 v[188:191], a[204:207], a[92:95], v[188:191]
    ds_read_b64_tr_b16 a[194:195], v9 offset:8192
    v_mfma_f32_16x16x32_bf16 v[180:183], a[204:207], a[88:91], v[180:183]
    buffer_load_dwordx4 v3, s[8:11], s36 offen offset:128 lds
    v_mfma_f32_16x16x32_bf16 v[180:183], a[200:203], a[72:75], v[180:183]
    v_mfma_f32_16x16x32_bf16 v[172:175], a[200:203], a[68:71], v[172:175]
    ds_read_b64_tr_b16 a[196:197], v9 offset:14336
    v_mfma_f32_16x16x32_bf16 v[172:175], a[204:207], a[84:87], v[172:175]
    ds_read_b64_tr_b16 a[198:199], v9 offset:20480
    v_mfma_f32_16x16x32_bf16 v[164:167], a[204:207], a[80:83], v[164:167]
    s_add_u32 m0, s49, 29440
    v_add_u32 v9, 122880, v13
    v_mfma_f32_16x16x32_bf16 v[164:167], a[200:203], a[64:67], v[164:167]
    s_waitcnt lgkmcnt(4)
    v_mfma_f32_16x16x32_bf16 v[192:195], a[208:211], a[64:67], v[192:195]
    ds_read_b64_tr_b16 a[200:201], v10 offset:2048
    v_mfma_f32_16x16x32_bf16 v[192:195], a[212:215], a[80:83], v[192:195]
    ds_read_b64_tr_b16 a[202:203], v10 offset:8192
    v_mfma_f32_16x16x32_bf16 v[200:203], a[212:215], a[84:87], v[200:203]
    buffer_load_dwordx4 v3, s[8:11], s36 offen offset:256 lds
    v_mfma_f32_16x16x32_bf16 v[200:203], a[208:211], a[68:71], v[200:203]
    buffer_load_dwordx4 v[40:43], v17, s[24:27], s47 offen offset:2048 sc1
    v_mfma_f32_16x16x32_bf16 v[208:211], a[208:211], a[72:75], v[208:211]
    s_add_u32 s36, s36, s37
    ds_read_b64_tr_b16 a[204:205], v10 offset:14336
    s_sub_u32 s55, s36, 7864320
    v_mfma_f32_16x16x32_bf16 v[208:211], a[212:215], a[88:91], v[208:211]
    s_min_u32 s36, s36, s55
    ds_read_b64_tr_b16 a[206:207], v10 offset:20480
    s_add_u32 s46, s45, 36864
    v_mfma_f32_16x16x32_bf16 v[216:219], a[212:215], a[92:95], v[216:219]
    s_sub_u32 s77, s46, 81920
    v_add_u32 v10, 122880, v14
    s_min_u32 s46, s46, s77
    v_mfma_f32_16x16x32_bf16 v[216:219], a[208:211], a[76:79], v[216:219]
    s_waitcnt lgkmcnt(4)
    v_mfma_f32_16x16x32_bf16 v[220:223], a[192:195], a[76:79], v[220:223]
    ds_read_b64_tr_b16 a[208:209], v11 offset:2048
    v_mfma_f32_16x16x32_bf16 v[220:223], a[196:199], a[92:95], v[220:223]
    ds_read_b64_tr_b16 a[210:211], v11 offset:8192
    v_mfma_f32_16x16x32_bf16 v[212:215], a[196:199], a[88:91], v[212:215]
    buffer_load_dwordx4 a[144:147], v28, s[20:23], s46 offen offset:0 sc1
    v_mfma_f32_16x16x32_bf16 v[212:215], a[192:195], a[72:75], v[212:215]
    v_mfma_f32_16x16x32_bf16 v[204:207], a[192:195], a[68:71], v[204:207]
    ds_read_b64_tr_b16 a[212:213], v11 offset:14336
    v_mfma_f32_16x16x32_bf16 v[204:207], a[196:199], a[84:87], v[204:207]
    s_waitcnt vmcnt(54)
    ds_read_b64_tr_b16 a[214:215], v11 offset:20480
    v_mfma_f32_16x16x32_bf16 v[196:199], a[196:199], a[80:83], v[196:199]
    s_barrier
    v_mfma_f32_16x16x32_bf16 v[196:199], a[192:195], a[64:67], v[196:199]
    s_waitcnt lgkmcnt(4)
    buffer_load_dwordx4 a[148:151], v28, s[20:23], s46 offen offset:1024 sc1
    v_mfma_f32_16x16x32_bf16 v[224:227], a[200:203], a[64:67], v[224:227]
    ds_read_b64_tr_b16 a[192:193], v8 offset:0
    v_add_u32 v11, 122880, v15
    v_mfma_f32_16x16x32_bf16 v[224:227], a[204:207], a[80:83], v[224:227]
    ds_read_b64_tr_b16 a[194:195], v8 offset:6144
    v_mfma_f32_16x16x32_bf16 v[232:235], a[204:207], a[84:87], v[232:235]
    buffer_load_dwordx4 v[44:47], v17, s[24:27], s47 offen offset:3072 sc1
    v_mfma_f32_16x16x32_bf16 v[232:235], a[200:203], a[68:71], v[232:235]
    buffer_load_dwordx4 a[152:155], v28, s[20:23], s46 offen offset:2048 sc1
    v_mfma_f32_16x16x32_bf16 v[240:243], a[200:203], a[72:75], v[240:243]
    ds_read_b64_tr_b16 a[196:197], v8 offset:12288
    v_mfma_f32_16x16x32_bf16 v[240:243], a[204:207], a[88:91], v[240:243]
    ds_read_b64_tr_b16 a[198:199], v8 offset:18432
    v_mfma_f32_16x16x32_bf16 v[248:251], a[204:207], a[92:95], v[248:251]
    v_mfma_f32_16x16x32_bf16 v[248:251], a[200:203], a[76:79], v[248:251]
    s_waitcnt lgkmcnt(4)
    v_mfma_f32_16x16x32_bf16 v[252:255], a[208:211], a[76:79], v[252:255]
    ds_read_b64_tr_b16 a[200:201], v9 offset:0
    v_mfma_f32_16x16x32_bf16 v[252:255], a[212:215], a[92:95], v[252:255]
    ds_read_b64_tr_b16 a[202:203], v9 offset:6144
    v_mfma_f32_16x16x32_bf16 v[244:247], a[212:215], a[88:91], v[244:247]
    buffer_load_dwordx4 a[156:159], v28, s[20:23], s46 offen offset:3072 sc1
    v_mfma_f32_16x16x32_bf16 v[244:247], a[208:211], a[72:75], v[244:247]
    v_mfma_f32_16x16x32_bf16 v[236:239], a[208:211], a[68:71], v[236:239]
    s_add_u32 s46, s45, 40960
    ds_read_b64_tr_b16 a[204:205], v9 offset:12288
    s_sub_u32 s77, s46, 81920
    v_mfma_f32_16x16x32_bf16 v[236:239], a[212:215], a[84:87], v[236:239]
    s_waitcnt vmcnt(29)
    s_waitcnt vmcnt(18)
    ds_read_b64_tr_b16 a[206:207], v9 offset:18432
    v_mfma_f32_16x16x32_bf16 v[228:231], a[212:215], a[80:83], v[228:231]
    s_min_u32 s46, s46, s77
    v_mfma_f32_16x16x32_bf16 v[228:231], a[208:211], a[64:67], v[228:231]
    s_waitcnt lgkmcnt(4)
    v_mfma_f32_16x16x32_bf16 v[64:67], a[192:195], a[96:99], v[64:67]
    ds_read_b64_tr_b16 a[208:209], v10 offset:0
    v_mfma_f32_16x16x32_bf16 v[64:67], a[196:199], a[112:115], v[64:67]
    ds_read_b64_tr_b16 a[210:211], v10 offset:6144
    v_mfma_f32_16x16x32_bf16 v[72:75], a[196:199], a[116:119], v[72:75]
    buffer_load_dwordx4 a[160:163], v28, s[20:23], s46 offen offset:0 sc1
    v_mfma_f32_16x16x32_bf16 v[72:75], a[192:195], a[100:103], v[72:75]
    v_mfma_f32_16x16x32_bf16 v[80:83], a[192:195], a[104:107], v[80:83]
    ds_read_b64_tr_b16 a[212:213], v10 offset:12288
    v_mfma_f32_16x16x32_bf16 v[80:83], a[196:199], a[120:123], v[80:83]
    ds_read_b64_tr_b16 a[214:215], v10 offset:18432
    v_mfma_f32_16x16x32_bf16 v[88:91], a[196:199], a[124:127], v[88:91]
    buffer_load_dwordx4 a[164:167], v28, s[20:23], s46 offen offset:1024 sc1
    v_mfma_f32_16x16x32_bf16 v[88:91], a[192:195], a[108:111], v[88:91]
    s_waitcnt lgkmcnt(4)
    v_mfma_f32_16x16x32_bf16 v[92:95], a[200:203], a[108:111], v[92:95]
    ds_read_b64_tr_b16 a[192:193], v11 offset:0
    v_mfma_f32_16x16x32_bf16 v[92:95], a[204:207], a[124:127], v[92:95]
    ds_read_b64_tr_b16 a[194:195], v11 offset:6144
    v_mfma_f32_16x16x32_bf16 v[84:87], a[204:207], a[120:123], v[84:87]
    v_mfma_f32_16x16x32_bf16 v[84:87], a[200:203], a[104:107], v[84:87]
    v_mfma_f32_16x16x32_bf16 v[76:79], a[200:203], a[100:103], v[76:79]
    ds_read_b64_tr_b16 a[196:197], v11 offset:12288
    v_mfma_f32_16x16x32_bf16 v[76:79], a[204:207], a[116:119], v[76:79]
    ds_read_b64_tr_b16 a[198:199], v11 offset:18432
    v_mfma_f32_16x16x32_bf16 v[68:71], a[204:207], a[112:115], v[68:71]
    buffer_load_dwordx4 a[168:171], v28, s[20:23], s46 offen offset:2048 sc1
    v_mfma_f32_16x16x32_bf16 v[68:71], a[200:203], a[96:99], v[68:71]
    s_waitcnt lgkmcnt(4)
    v_mfma_f32_16x16x32_bf16 v[96:99], a[208:211], a[96:99], v[96:99]
    ds_read_b64_tr_b16 a[200:201], v8 offset:1024
    v_mfma_f32_16x16x32_bf16 v[96:99], a[212:215], a[112:115], v[96:99]
    ds_read_b64_tr_b16 a[202:203], v8 offset:7168
    v_mfma_f32_16x16x32_bf16 v[104:107], a[212:215], a[116:119], v[104:107]
    v_mfma_f32_16x16x32_bf16 v[104:107], a[208:211], a[100:103], v[104:107]
    buffer_load_dwordx4 a[172:175], v28, s[20:23], s46 offen offset:3072 sc1
    v_mfma_f32_16x16x32_bf16 v[112:115], a[208:211], a[104:107], v[112:115]
    ds_read_b64_tr_b16 a[204:205], v8 offset:13312
    v_mfma_f32_16x16x32_bf16 v[112:115], a[212:215], a[120:123], v[112:115]
    ds_read_b64_tr_b16 a[206:207], v8 offset:19456
    v_mfma_f32_16x16x32_bf16 v[120:123], a[212:215], a[124:127], v[120:123]
    v_mfma_f32_16x16x32_bf16 v[120:123], a[208:211], a[108:111], v[120:123]
    s_waitcnt lgkmcnt(4)
    v_mfma_f32_16x16x32_bf16 v[124:127], a[192:195], a[108:111], v[124:127]
    ds_read_b64_tr_b16 a[208:209], v9 offset:1024
    v_mfma_f32_16x16x32_bf16 v[124:127], a[196:199], a[124:127], v[124:127]
    s_add_u32 m0, s49, 49152
    ds_read_b64_tr_b16 a[210:211], v9 offset:7168
    v_mfma_f32_16x16x32_bf16 v[116:119], a[196:199], a[120:123], v[116:119]
    buffer_load_dwordx4 v2, s[8:11], s36 offen offset:0 lds
    v_mfma_f32_16x16x32_bf16 v[116:119], a[192:195], a[104:107], v[116:119]
    v_mfma_f32_16x16x32_bf16 v[108:111], a[192:195], a[100:103], v[108:111]
    ds_read_b64_tr_b16 a[212:213], v9 offset:13312
    v_mfma_f32_16x16x32_bf16 v[108:111], a[196:199], a[116:119], v[108:111]
    ds_read_b64_tr_b16 a[214:215], v9 offset:19456
    v_mfma_f32_16x16x32_bf16 v[100:103], a[196:199], a[112:115], v[100:103]
    v_mfma_f32_16x16x32_bf16 v[100:103], a[192:195], a[96:99], v[100:103]
    s_waitcnt lgkmcnt(4)
    s_add_u32 m0, s49, 50048
    v_mfma_f32_16x16x32_bf16 v[128:131], a[200:203], a[96:99], v[128:131]
    ds_read_b64_tr_b16 a[192:193], v10 offset:1024
    v_mfma_f32_16x16x32_bf16 v[128:131], a[204:207], a[112:115], v[128:131]
    ds_read_b64_tr_b16 a[194:195], v10 offset:7168
    v_mfma_f32_16x16x32_bf16 v[136:139], a[204:207], a[116:119], v[136:139]
    buffer_load_dwordx4 v2, s[8:11], s36 offen offset:128 lds
    v_mfma_f32_16x16x32_bf16 v[136:139], a[200:203], a[100:103], v[136:139]
    v_mfma_f32_16x16x32_bf16 v[144:147], a[200:203], a[104:107], v[144:147]
    ds_read_b64_tr_b16 a[196:197], v10 offset:13312
    v_mfma_f32_16x16x32_bf16 v[144:147], a[204:207], a[120:123], v[144:147]
    ds_read_b64_tr_b16 a[198:199], v10 offset:19456
    v_mfma_f32_16x16x32_bf16 v[152:155], a[204:207], a[124:127], v[152:155]
    s_add_u32 m0, s49, 50944
    v_mfma_f32_16x16x32_bf16 v[152:155], a[200:203], a[108:111], v[152:155]
    s_waitcnt lgkmcnt(4)
    v_mfma_f32_16x16x32_bf16 v[156:159], a[208:211], a[108:111], v[156:159]
    ds_read_b64_tr_b16 a[200:201], v11 offset:1024
    v_mfma_f32_16x16x32_bf16 v[156:159], a[212:215], a[124:127], v[156:159]
    ds_read_b64_tr_b16 a[202:203], v11 offset:7168
    v_mfma_f32_16x16x32_bf16 v[148:151], a[212:215], a[120:123], v[148:151]
    buffer_load_dwordx4 v2, s[8:11], s36 offen offset:256 lds
    v_mfma_f32_16x16x32_bf16 v[148:151], a[208:211], a[104:107], v[148:151]
    v_mfma_f32_16x16x32_bf16 v[140:143], a[208:211], a[100:103], v[140:143]
    s_add_u32 m0, s49, 52224
    ds_read_b64_tr_b16 a[204:205], v11 offset:13312
    v_mfma_f32_16x16x32_bf16 v[140:143], a[212:215], a[116:119], v[140:143]
    ds_read_b64_tr_b16 a[206:207], v11 offset:19456
    v_mfma_f32_16x16x32_bf16 v[132:135], a[212:215], a[112:115], v[132:135]
    buffer_load_dwordx4 v3, s[8:11], s36 offen offset:0 lds
    v_mfma_f32_16x16x32_bf16 v[132:135], a[208:211], a[96:99], v[132:135]
    s_waitcnt lgkmcnt(4)
    v_mfma_f32_16x16x32_bf16 v[160:163], a[192:195], a[96:99], v[160:163]
    ds_read_b64_tr_b16 a[208:209], v8 offset:2048
    v_mfma_f32_16x16x32_bf16 v[160:163], a[196:199], a[112:115], v[160:163]
    ds_read_b64_tr_b16 a[210:211], v8 offset:8192
    v_mfma_f32_16x16x32_bf16 v[168:171], a[196:199], a[116:119], v[168:171]
    v_mfma_f32_16x16x32_bf16 v[168:171], a[192:195], a[100:103], v[168:171]
    s_add_u32 m0, s49, 53120
    v_mfma_f32_16x16x32_bf16 v[176:179], a[192:195], a[104:107], v[176:179]
    ds_read_b64_tr_b16 a[212:213], v8 offset:14336
    v_mfma_f32_16x16x32_bf16 v[176:179], a[196:199], a[120:123], v[176:179]
    ds_read_b64_tr_b16 a[214:215], v8 offset:20480
    v_mfma_f32_16x16x32_bf16 v[184:187], a[196:199], a[124:127], v[184:187]
    buffer_load_dwordx4 v3, s[8:11], s36 offen offset:128 lds
    v_mfma_f32_16x16x32_bf16 v[184:187], a[192:195], a[108:111], v[184:187]
    s_waitcnt lgkmcnt(4)
    v_add_u32 v8, 0, v12
    v_mfma_f32_16x16x32_bf16 v[188:191], a[200:203], a[108:111], v[188:191]
    ds_read_b64_tr_b16 a[192:193], v9 offset:2048
    v_mfma_f32_16x16x32_bf16 v[188:191], a[204:207], a[124:127], v[188:191]
    s_add_u32 m0, s49, 54016
    ds_read_b64_tr_b16 a[194:195], v9 offset:8192
    v_mfma_f32_16x16x32_bf16 v[180:183], a[204:207], a[120:123], v[180:183]
    buffer_load_dwordx4 v3, s[8:11], s36 offen offset:256 lds
    v_mfma_f32_16x16x32_bf16 v[180:183], a[200:203], a[104:107], v[180:183]
    s_add_u32 s36, s36, s37
    s_sub_u32 s55, s36, 7864320
    s_min_u32 s36, s36, s55
    v_mfma_f32_16x16x32_bf16 v[172:175], a[200:203], a[100:103], v[172:175]
    ds_read_b64_tr_b16 a[196:197], v9 offset:14336
    v_mfma_f32_16x16x32_bf16 v[172:175], a[204:207], a[116:119], v[172:175]
    s_add_u32 s46, s45, 45056
    ds_read_b64_tr_b16 a[198:199], v9 offset:20480
    s_sub_u32 s77, s46, 81920
    v_mfma_f32_16x16x32_bf16 v[164:167], a[204:207], a[112:115], v[164:167]
    s_min_u32 s46, s46, s77
    v_add_u32 v9, 0, v13
    v_mfma_f32_16x16x32_bf16 v[164:167], a[200:203], a[96:99], v[164:167]
    s_waitcnt lgkmcnt(4)
    v_mfma_f32_16x16x32_bf16 v[192:195], a[208:211], a[96:99], v[192:195]
    ds_read_b64_tr_b16 a[200:201], v10 offset:2048
    v_mfma_f32_16x16x32_bf16 v[192:195], a[212:215], a[112:115], v[192:195]
    ds_read_b64_tr_b16 a[202:203], v10 offset:8192
    v_mfma_f32_16x16x32_bf16 v[200:203], a[212:215], a[116:119], v[200:203]
    buffer_load_dwordx4 a[176:179], v28, s[20:23], s46 offen offset:0 sc1
    v_mfma_f32_16x16x32_bf16 v[200:203], a[208:211], a[100:103], v[200:203]
    v_mfma_f32_16x16x32_bf16 v[208:211], a[208:211], a[104:107], v[208:211]
    ds_read_b64_tr_b16 a[204:205], v10 offset:14336
    v_mfma_f32_16x16x32_bf16 v[208:211], a[212:215], a[120:123], v[208:211]
    ds_read_b64_tr_b16 a[206:207], v10 offset:20480
    v_mfma_f32_16x16x32_bf16 v[216:219], a[212:215], a[124:127], v[216:219]
    v_add_u32 v10, 0, v14
    v_mfma_f32_16x16x32_bf16 v[216:219], a[208:211], a[108:111], v[216:219]
    s_waitcnt lgkmcnt(4)
    v_mfma_f32_16x16x32_bf16 v[220:223], a[192:195], a[108:111], v[220:223]
    s_waitcnt vmcnt(13)
    ds_read_b64_tr_b16 a[208:209], v11 offset:2048
    v_xor_b32 v34, s7, v34
    v_mfma_f32_16x16x32_bf16 v[220:223], a[196:199], a[124:127], v[220:223]
    ds_read_b64_tr_b16 a[210:211], v11 offset:8192
    v_xor_b32 v38, s7, v38
    v_mfma_f32_16x16x32_bf16 v[212:215], a[196:199], a[120:123], v[212:215]
    buffer_load_dwordx4 a[180:183], v28, s[20:23], s46 offen offset:1024 sc1
    v_mfma_f32_16x16x32_bf16 v[212:215], a[192:195], a[104:107], v[212:215]
    v_xor_b32 v42, s7, v42
    v_xor_b32 v46, s7, v46
    v_mfma_f32_16x16x32_bf16 v[204:207], a[192:195], a[100:103], v[204:207]
    ds_read_b64_tr_b16 a[212:213], v11 offset:14336
    v_or3_b32 v34, v34, v38, v42
    v_mfma_f32_16x16x32_bf16 v[204:207], a[196:199], a[116:119], v[204:207]
    s_waitcnt vmcnt(35)
    ds_read_b64_tr_b16 a[214:215], v11 offset:20480
    v_or_b32 v34, v34, v46
    v_mfma_f32_16x16x32_bf16 v[196:199], a[196:199], a[112:115], v[196:199]
pg_2:
    s_cbranch_execz pg_6
    s_barrier
    v_mfma_f32_16x16x32_bf16 v[196:199], a[192:195], a[96:99], v[196:199]
    s_waitcnt lgkmcnt(4)
    v_cmp_ne_u32 vcc, 0, v34
    v_add_u32 v11, 0, v15
    v_mfma_f32_16x16x32_bf16 v[224:227], a[200:203], a[96:99], v[224:227]
    ds_read_b64_tr_b16 a[192:193], v8 offset:0
    v_mfma_f32_16x16x32_bf16 v[224:227], a[204:207], a[112:115], v[224:227]
    ds_read_b64_tr_b16 a[194:195], v8 offset:6144
    v_mfma_f32_16x16x32_bf16 v[232:235], a[204:207], a[116:119], v[232:235]
    s_cbranch_vccnz spin_rec
spin_rec_ret:
    v_max_u32 v20, v32, v33
    v_mfma_f32_16x16x32_bf16 v[232:235], a[200:203], a[100:103], v[232:235]
    buffer_load_dwordx4 a[184:187], v28, s[20:23], s46 offen offset:2048 sc1
    v_mfma_f32_16x16x32_bf16 v[240:243], a[200:203], a[104:107], v[240:243]
    ds_read_b64_tr_b16 a[196:197], v8 offset:12288
    v_min_u32 v21, v32, v33
    v_mfma_f32_16x16x32_bf16 v[240:243], a[204:207], a[120:123], v[240:243]
    ds_read_b64_tr_b16 a[198:199], v8 offset:18432
    v_med3_u32 v21, v20, v21, v36
    v_mfma_f32_16x16x32_bf16 v[248:251], a[204:207], a[124:127], v[248:251]
    buffer_load_dwordx4 a[188:191], v28, s[20:23], s46 offen offset:3072 sc1
    v_mfma_f32_16x16x32_bf16 v[248:251], a[200:203], a[108:111], v[248:251]
    s_waitcnt lgkmcnt(4)
    v_max_u32 v20, v20, v36
    v_med3_u32 v21, v20, v21, v37
    v_mfma_f32_16x16x32_bf16 v[252:255], a[208:211], a[108:111], v[252:255]
    s_add_u32 s46, s45, 49152
    ds_read_b64_tr_b16 a[200:201], v9 offset:0
    v_max_u32 v20, v20, v37
    v_mfma_f32_16x16x32_bf16 v[252:255], a[212:215], a[124:127], v[252:255]
    s_sub_u32 s77, s46, 81920
    ds_read_b64_tr_b16 a[202:203], v9 offset:6144
    v_med3_u32 v21, v20, v21, v40
    v_mfma_f32_16x16x32_bf16 v[244:247], a[212:215], a[120:123], v[244:247]
    s_min_u32 s46, s46, s77
    v_max_u32 v20, v20, v40
    v_med3_u32 v21, v20, v21, v41
    v_mfma_f32_16x16x32_bf16 v[244:247], a[208:211], a[104:107], v[244:247]
    buffer_load_dwordx4 a[0:3], v28, s[20:23], s46 offen offset:0 sc1
    v_mfma_f32_16x16x32_bf16 v[236:239], a[208:211], a[100:103], v[236:239]
    ds_read_b64_tr_b16 a[204:205], v9 offset:12288
    v_max_u32 v20, v20, v41
    v_mfma_f32_16x16x32_bf16 v[236:239], a[212:215], a[116:119], v[236:239]
    s_waitcnt vmcnt(29)
    s_waitcnt vmcnt(15)
    ds_read_b64_tr_b16 a[206:207], v9 offset:18432
    v_mfma_f32_16x16x32_bf16 v[228:231], a[212:215], a[112:115], v[228:231]
    v_med3_u32 v21, v20, v21, v44
    v_max_u32 v20, v20, v44
    v_mfma_f32_16x16x32_bf16 v[228:231], a[208:211], a[96:99], v[228:231]
    s_waitcnt lgkmcnt(4)
    v_med3_u32 v21, v20, v21, v45
    v_max_u32 v20, v20, v45
    v_mfma_f32_16x16x32_bf16 v[64:67], a[192:195], a[128:131], v[64:67]
    ds_read_b64_tr_b16 a[208:209], v10 offset:0
    v_mov_b32_dpp v22, v20 row_ror:8 row_mask:0xf bank_mask:0xf
    v_mfma_f32_16x16x32_bf16 v[64:67], a[196:199], a[144:147], v[64:67]
    ds_read_b64_tr_b16 a[210:211], v10 offset:6144
    v_mov_b32_dpp v23, v21 row_ror:8 row_mask:0xf bank_mask:0xf
    v_mfma_f32_16x16x32_bf16 v[72:75], a[196:199], a[148:151], v[72:75]
    buffer_load_dwordx4 a[4:7], v28, s[20:23], s46 offen offset:1024 sc1
    v_mfma_f32_16x16x32_bf16 v[72:75], a[192:195], a[132:135], v[72:75]
    v_min_u32 v24, v20, v22
    v_max_u32 v20, v20, v22
    v_mfma_f32_16x16x32_bf16 v[80:83], a[192:195], a[136:139], v[80:83]
    ds_read_b64_tr_b16 a[212:213], v10 offset:12288
    v_max3_u32 v21, v24, v21, v23
    v_mfma_f32_16x16x32_bf16 v[80:83], a[196:199], a[152:155], v[80:83]
    ds_read_b64_tr_b16 a[214:215], v10 offset:18432
    v_mov_b32_dpp v22, v20 row_ror:4 row_mask:0xf bank_mask:0xf
    v_mfma_f32_16x16x32_bf16 v[88:91], a[196:199], a[156:159], v[88:91]
    v_mov_b32_dpp v23, v21 row_ror:4 row_mask:0xf bank_mask:0xf
    v_min_u32 v24, v20, v22
    v_mfma_f32_16x16x32_bf16 v[88:91], a[192:195], a[140:143], v[88:91]
    s_waitcnt lgkmcnt(4)
    v_max_u32 v20, v20, v22
    v_max3_u32 v21, v24, v21, v23
    v_mfma_f32_16x16x32_bf16 v[92:95], a[200:203], a[140:143], v[92:95]
    ds_read_b64_tr_b16 a[192:193], v11 offset:0
    v_mov_b32_dpp v22, v20 row_ror:2 row_mask:0xf bank_mask:0xf
    v_mfma_f32_16x16x32_bf16 v[92:95], a[204:207], a[156:159], v[92:95]
    ds_read_b64_tr_b16 a[194:195], v11 offset:6144
    v_mov_b32_dpp v23, v21 row_ror:2 row_mask:0xf bank_mask:0xf
    v_mfma_f32_16x16x32_bf16 v[84:87], a[204:207], a[152:155], v[84:87]
    buffer_load_dwordx4 a[8:11], v28, s[20:23], s46 offen offset:2048 sc1
    v_mfma_f32_16x16x32_bf16 v[84:87], a[200:203], a[136:139], v[84:87]
    v_min_u32 v24, v20, v22
    v_max_u32 v20, v20, v22
    v_mfma_f32_16x16x32_bf16 v[76:79], a[200:203], a[132:135], v[76:79]
    ds_read_b64_tr_b16 a[196:197], v11 offset:12288
    v_max3_u32 v21, v24, v21, v23
    v_mfma_f32_16x16x32_bf16 v[76:79], a[204:207], a[148:151], v[76:79]
    ds_read_b64_tr_b16 a[198:199], v11 offset:18432
    v_mov_b32_dpp v22, v20 row_ror:1 row_mask:0xf bank_mask:0xf
    v_mfma_f32_16x16x32_bf16 v[68:71], a[204:207], a[144:147], v[68:71]
    buffer_load_dwordx4 a[12:15], v28, s[20:23], s46 offen offset:3072 sc1
    v_mfma_f32_16x16x32_bf16 v[68:71], a[200:203], a[128:131], v[68:71]
    s_waitcnt lgkmcnt(4)
    v_mov_b32_dpp v23, v21 row_ror:1 row_mask:0xf bank_mask:0xf
    v_min_u32 v24, v20, v22
    v_mfma_f32_16x16x32_bf16 v[96:99], a[208:211], a[128:131], v[96:99]
    s_andn2_b32 s88, s2, 7
    ds_read_b64_tr_b16 a[200:201], v8 offset:1024
    v_max_u32 v20, v20, v22
    v_mfma_f32_16x16x32_bf16 v[96:99], a[212:215], a[144:147], v[96:99]
    s_lshl_b32 s88, s88, 2
    ds_read_b64_tr_b16 a[202:203], v8 offset:7168
    v_max3_u32 v21, v24, v21, v23
    v_mfma_f32_16x16x32_bf16 v[104:107], a[212:215], a[148:151], v[104:107]
    s_lshr_b32 s89, s53, 1
    v_mov_b32 v22, v20
    v_mov_b32 v23, v21
    v_mfma_f32_16x16x32_bf16 v[104:107], a[208:211], a[132:135], v[104:107]
    s_add_u32 s88, s88, s89
    v_permlane16_swap_b32 v20, v22
    v_mfma_f32_16x16x32_bf16 v[112:115], a[208:211], a[136:139], v[112:115]
    s_add_u32 m0, s49, 73728
    ds_read_b64_tr_b16 a[204:205], v8 offset:13312
    v_lshl_add_u32 v60, v1, 2, s88
    v_mfma_f32_16x16x32_bf16 v[112:115], a[212:215], a[152:155], v[112:115]
    s_andn2_b32 s88, s2, 0x18
    ds_read_b64_tr_b16 a[206:207], v8 offset:19456
    v_accvgpr_write_b32 a96, 1.0
    v_mfma_f32_16x16x32_bf16 v[120:123], a[212:215], a[156:159], v[120:123]
    buffer_load_dwordx4 v2, s[8:11], s36 offen offset:0 lds
    v_mfma_f32_16x16x32_bf16 v[120:123], a[208:211], a[140:143], v[120:123]
    s_waitcnt lgkmcnt(4)
    v_permlane16_swap_b32 v21, v23
    v_mfma_f32_16x16x32_bf16 v[124:127], a[192:195], a[140:143], v[124:127]
    s_lshl_b32 s88, s88, 2
    ds_read_b64_tr_b16 a[208:209], v9 offset:1024
    v_min_u32 v24, v20, v22
    v_mfma_f32_16x16x32_bf16 v[124:127], a[196:199], a[156:159], v[124:127]
    s_add_u32 s88, s88, s3
    ds_read_b64_tr_b16 a[210:211], v9 offset:7168
    v_max_u32 v20, v20, v22
    v_mfma_f32_16x16x32_bf16 v[116:119], a[196:199], a[152:155], v[116:119]
    s_add_u32 m0, s49, 74624
    v_max3_u32 v21, v24, v21, v23
    v_mov_b32 v22, v20
    v_mfma_f32_16x16x32_bf16 v[116:119], a[192:195], a[136:139], v[116:119]
    buffer_load_dwordx4 v2, s[8:11], s36 offen offset:128 lds
    v_mfma_f32_16x16x32_bf16 v[108:111], a[192:195], a[132:135], v[108:111]
    ds_read_b64_tr_b16 a[212:213], v9 offset:13312
    v_mov_b32 v23, v21
    v_mfma_f32_16x16x32_bf16 v[108:111], a[196:199], a[148:151], v[108:111]
    ds_read_b64_tr_b16 a[214:215], v9 offset:19456
    v_and_b32 v61, 3, v1
    v_mfma_f32_16x16x32_bf16 v[100:103], a[196:199], a[144:147], v[100:103]
    v_permlane32_swap_b32 v20, v22
    v_mfma_f32_16x16x32_bf16 v[100:103], a[192:195], a[128:131], v[100:103]
    s_waitcnt lgkmcnt(4)
    v_permlane32_swap_b32 v21, v23
    v_mfma_f32_16x16x32_bf16 v[128:131], a[200:203], a[128:131], v[128:131]
    ds_read_b64_tr_b16 a[192:193], v10 offset:1024
    v_min_u32 v24, v20, v22
    v_mfma_f32_16x16x32_bf16 v[128:131], a[204:207], a[144:147], v[128:131]
    s_add_u32 m0, s49, 75520
    ds_read_b64_tr_b16 a[194:195], v10 offset:7168
    v_max_u32 v20, v20, v22
    v_mfma_f32_16x16x32_bf16 v[136:139], a[204:207], a[148:151], v[136:139]
    buffer_load_dwordx4 v2, s[8:11], s36 offen offset:256 lds
    v_mfma_f32_16x16x32_bf16 v[136:139], a[200:203], a[132:135], v[136:139]
    v_max3_u32 v21, v24, v21, v23
    v_lshl_add_u32 v61, v61, 5, s88
    v_mfma_f32_16x16x32_bf16 v[144:147], a[200:203], a[136:139], v[144:147]
    s_lshl_b32 s56, s3, 3
    ds_read_b64_tr_b16 a[196:197], v10 offset:13312
    v_cmp_gt_u32 s[88:89], 8, v1
    v_mfma_f32_16x16x32_bf16 v[144:147], a[204:207], a[152:155], v[144:147]
    s_add_u32 s56, s56, 147456
    ds_read_b64_tr_b16 a[198:199], v10 offset:19456
    v_mov_b32 v22, s56
    v_mfma_f32_16x16x32_bf16 v[152:155], a[204:207], a[156:159], v[152:155]
    v_mov_b32 v23, 147456
    v_cndmask_b32 v60, v61, v60, s[88:89]
    v_mfma_f32_16x16x32_bf16 v[152:155], a[200:203], a[140:143], v[152:155]
    s_waitcnt lgkmcnt(4)
    v_lshlrev_b32 v61, 2, v1
    v_cmp_gt_u32 s[88:89], 12, v1
    v_mfma_f32_16x16x32_bf16 v[156:159], a[208:211], a[140:143], v[156:159]
    s_add_u32 m0, s49, 76800
    ds_read_b64_tr_b16 a[200:201], v11 offset:1024
    v_cndmask_b32 v60, v61, v60, s[88:89]
    v_mfma_f32_16x16x32_bf16 v[156:159], a[212:215], a[156:159], v[156:159]
    ds_read_b64_tr_b16 a[202:203], v11 offset:7168
    v_lshlrev_b32 v60, 4, v60
    v_mfma_f32_16x16x32_bf16 v[148:151], a[212:215], a[152:155], v[148:151]
    buffer_load_dwordx4 v3, s[8:11], s36 offen offset:0 lds
    v_mfma_f32_16x16x32_bf16 v[148:151], a[208:211], a[136:139], v[148:151]
    v_accvgpr_write_b32 a97, 1.0
    v_accvgpr_write_b32 a98, 1.0
    v_mfma_f32_16x16x32_bf16 v[140:143], a[208:211], a[132:135], v[140:143]
    ds_read_b64_tr_b16 a[204:205], v11 offset:13312
    v_accvgpr_write_b32 a99, 1.0
    v_mfma_f32_16x16x32_bf16 v[140:143], a[212:215], a[148:151], v[140:143]
    ds_read_b64_tr_b16 a[206:207], v11 offset:19456
    v_accvgpr_write_b32 a100, 1.0
    v_mfma_f32_16x16x32_bf16 v[132:135], a[212:215], a[144:147], v[132:135]
    s_add_u32 m0, s49, 77696
    v_accvgpr_write_b32 a101, 1.0
    v_accvgpr_write_b32 a102, 1.0
    v_mfma_f32_16x16x32_bf16 v[132:135], a[208:211], a[128:131], v[132:135]
    s_waitcnt lgkmcnt(4)
    v_accvgpr_write_b32 a103, 1.0
    v_accvgpr_write_b32 a104, 1.0
    v_mfma_f32_16x16x32_bf16 v[160:163], a[192:195], a[128:131], v[160:163]
    ds_read_b64_tr_b16 a[208:209], v8 offset:2048
    v_accvgpr_write_b32 a105, 1.0
    v_mfma_f32_16x16x32_bf16 v[160:163], a[196:199], a[144:147], v[160:163]
    ds_read_b64_tr_b16 a[210:211], v8 offset:8192
    v_accvgpr_write_b32 a106, 1.0
    v_mfma_f32_16x16x32_bf16 v[168:171], a[196:199], a[148:151], v[168:171]
    buffer_load_dwordx4 v3, s[8:11], s36 offen offset:128 lds
    v_mfma_f32_16x16x32_bf16 v[168:171], a[192:195], a[132:135], v[168:171]
    v_accvgpr_write_b32 a107, 1.0
    v_accvgpr_write_b32 a108, 1.0
    v_mfma_f32_16x16x32_bf16 v[176:179], a[192:195], a[136:139], v[176:179]
    s_add_u32 m0, s49, 78592
    ds_read_b64_tr_b16 a[212:213], v8 offset:14336
    v_accvgpr_write_b32 a109, 1.0
    v_mfma_f32_16x16x32_bf16 v[176:179], a[196:199], a[152:155], v[176:179]
    ds_read_b64_tr_b16 a[214:215], v8 offset:20480
    v_accvgpr_write_b32 a110, 1.0
    v_mfma_f32_16x16x32_bf16 v[184:187], a[196:199], a[156:159], v[184:187]
    buffer_load_dwordx4 v3, s[8:11], s36 offen offset:256 lds
    v_mfma_f32_16x16x32_bf16 v[184:187], a[192:195], a[140:143], v[184:187]
    s_waitcnt lgkmcnt(4)
    v_accvgpr_write_b32 a111, 1.0
    v_accvgpr_write_b32 a112, 1.0
    v_mfma_f32_16x16x32_bf16 v[188:191], a[200:203], a[140:143], v[188:191]
    s_add_u32 s36, s36, s37
    ds_read_b64_tr_b16 a[192:193], v9 offset:2048
    v_accvgpr_write_b32 a113, 1.0
    v_mfma_f32_16x16x32_bf16 v[188:191], a[204:207], a[156:159], v[188:191]
    s_sub_u32 s55, s36, 7864320
    ds_read_b64_tr_b16 a[194:195], v9 offset:8192
    v_accvgpr_write_b32 a114, 1.0
    v_mfma_f32_16x16x32_bf16 v[180:183], a[204:207], a[152:155], v[180:183]
    s_min_u32 s36, s36, s55
    ds_write_b64 v22, v[20:21]
    v_accvgpr_write_b32 a115, 1.0
    v_mfma_f32_16x16x32_bf16 v[180:183], a[200:203], a[136:139], v[180:183]
    s_add_u32 s46, s45, 53248
    v_accvgpr_write_b32 a116, 1.0
    v_accvgpr_write_b32 a117, 1.0
    v_mfma_f32_16x16x32_bf16 v[172:175], a[200:203], a[132:135], v[172:175]
    s_sub_u32 s77, s46, 81920
    ds_read_b64_tr_b16 a[196:197], v9 offset:14336
    v_accvgpr_write_b32 a118, 1.0
    v_mfma_f32_16x16x32_bf16 v[172:175], a[204:207], a[148:151], v[172:175]
    s_min_u32 s46, s46, s77
    ds_read_b64_tr_b16 a[198:199], v9 offset:20480
    v_accvgpr_write_b32 a119, 1.0
    v_mfma_f32_16x16x32_bf16 v[164:167], a[204:207], a[144:147], v[164:167]
    buffer_load_dwordx4 a[16:19], v28, s[20:23], s46 offen offset:0 sc1
    v_mfma_f32_16x16x32_bf16 v[164:167], a[200:203], a[128:131], v[164:167]
    s_waitcnt lgkmcnt(4)
    v_accvgpr_write_b32 a120, 1.0
    v_accvgpr_write_b32 a121, 1.0
    v_mfma_f32_16x16x32_bf16 v[192:195], a[208:211], a[128:131], v[192:195]
    ds_read_b64_tr_b16 a[200:201], v10 offset:2048
    v_accvgpr_write_b32 a122, 1.0
    v_mfma_f32_16x16x32_bf16 v[192:195], a[212:215], a[144:147], v[192:195]
    ds_read_b64_tr_b16 a[202:203], v10 offset:8192
    v_accvgpr_write_b32 a123, 1.0
    v_mfma_f32_16x16x32_bf16 v[200:203], a[212:215], a[148:151], v[200:203]
    buffer_load_dwordx4 a[20:23], v28, s[20:23], s46 offen offset:1024 sc1
    v_mfma_f32_16x16x32_bf16 v[200:203], a[208:211], a[132:135], v[200:203]
    v_accvgpr_write_b32 a124, 1.0
    v_accvgpr_write_b32 a125, 1.0
    v_mfma_f32_16x16x32_bf16 v[208:211], a[208:211], a[136:139], v[208:211]
    ds_read_b64_tr_b16 a[204:205], v10 offset:14336
    v_accvgpr_write_b32 a126, 1.0
    v_mfma_f32_16x16x32_bf16 v[208:211], a[212:215], a[152:155], v[208:211]
    ds_read_b64_tr_b16 a[206:207], v10 offset:20480
    v_accvgpr_write_b32 a127, 1.0
    v_mfma_f32_16x16x32_bf16 v[216:219], a[212:215], a[156:159], v[216:219]
    v_add_u32 v8, 24576, v12
    v_add_u32 v9, 24576, v13
    v_mfma_f32_16x16x32_bf16 v[216:219], a[208:211], a[140:143], v[216:219]
    s_waitcnt lgkmcnt(4)
    v_add_u32 v10, 24576, v14
    v_mfma_f32_16x16x32_bf16 v[220:223], a[192:195], a[140:143], v[220:223]
    ds_read_b64_tr_b16 a[208:209], v11 offset:2048
    v_mfma_f32_16x16x32_bf16 v[220:223], a[196:199], a[156:159], v[220:223]
    ds_read_b64_tr_b16 a[210:211], v11 offset:8192
    v_mfma_f32_16x16x32_bf16 v[212:215], a[196:199], a[152:155], v[212:215]
    buffer_load_dwordx4 a[24:27], v28, s[20:23], s46 offen offset:2048 sc1
    v_mfma_f32_16x16x32_bf16 v[212:215], a[192:195], a[136:139], v[212:215]
    v_mfma_f32_16x16x32_bf16 v[204:207], a[192:195], a[132:135], v[204:207]
    ds_read_b64_tr_b16 a[212:213], v11 offset:14336
    v_mfma_f32_16x16x32_bf16 v[204:207], a[196:199], a[148:151], v[204:207]
    s_waitcnt vmcnt(33)
    ds_read_b64_tr_b16 a[214:215], v11 offset:20480
    v_mfma_f32_16x16x32_bf16 v[196:199], a[196:199], a[144:147], v[196:199]
    s_barrier
    v_mfma_f32_16x16x32_bf16 v[196:199], a[192:195], a[128:131], v[196:199]
    s_waitcnt lgkmcnt(4)
    v_add_u32 v11, 24576, v15
    v_mfma_f32_16x16x32_bf16 v[224:227], a[200:203], a[128:131], v[224:227]
    ds_read_b64_tr_b16 a[192:193], v8 offset:0
    v_mfma_f32_16x16x32_bf16 v[224:227], a[204:207], a[144:147], v[224:227]
    ds_read_b64_tr_b16 a[194:195], v8 offset:6144
    v_mfma_f32_16x16x32_bf16 v[232:235], a[204:207], a[148:151], v[232:235]
    ds_read_b128 v[32:35], v23
    v_mfma_f32_16x16x32_bf16 v[232:235], a[200:203], a[132:135], v[232:235]
    ds_read_b128 v[36:39], v23 offset:16
    v_mfma_f32_16x16x32_bf16 v[240:243], a[200:203], a[136:139], v[240:243]
    ds_read_b64_tr_b16 a[196:197], v8 offset:12288
    v_mfma_f32_16x16x32_bf16 v[240:243], a[204:207], a[152:155], v[240:243]
    ds_read_b64_tr_b16 a[198:199], v8 offset:18432
    v_mfma_f32_16x16x32_bf16 v[248:251], a[204:207], a[156:159], v[248:251]
    buffer_load_dwordx4 a[28:31], v28, s[20:23], s46 offen offset:3072 sc1
    v_mfma_f32_16x16x32_bf16 v[248:251], a[200:203], a[140:143], v[248:251]
    s_waitcnt lgkmcnt(4)
    s_add_u32 s46, s45, 57344
    s_sub_u32 s77, s46, 81920
    v_mfma_f32_16x16x32_bf16 v[252:255], a[208:211], a[140:143], v[252:255]
    s_min_u32 s46, s46, s77
    ds_read_b64_tr_b16 a[200:201], v9 offset:0
    v_mfma_f32_16x16x32_bf16 v[252:255], a[212:215], a[156:159], v[252:255]
    ds_read_b64_tr_b16 a[202:203], v9 offset:6144
    v_mfma_f32_16x16x32_bf16 v[244:247], a[212:215], a[152:155], v[244:247]
    buffer_load_dwordx4 a[32:35], v28, s[20:23], s46 offen offset:0 sc1
    v_mfma_f32_16x16x32_bf16 v[244:247], a[208:211], a[136:139], v[244:247]
    v_mfma_f32_16x16x32_bf16 v[236:239], a[208:211], a[132:135], v[236:239]
    ds_read_b64_tr_b16 a[204:205], v9 offset:12288
    v_mfma_f32_16x16x32_bf16 v[236:239], a[212:215], a[148:151], v[236:239]
    s_waitcnt vmcnt(25)
    s_waitcnt vmcnt(15)
    ds_read_b64_tr_b16 a[206:207], v9 offset:18432
    v_mfma_f32_16x16x32_bf16 v[228:231], a[212:215], a[144:147], v[228:231]
    buffer_load_dwordx4 a[36:39], v28, s[20:23], s46 offen offset:1024 sc1
    v_mfma_f32_16x16x32_bf16 v[228:231], a[208:211], a[128:131], v[228:231]
    s_waitcnt lgkmcnt(4)
    v_mfma_f32_16x16x32_bf16 v[64:67], a[192:195], a[160:163], v[64:67]
    ds_read_b64_tr_b16 a[208:209], v10 offset:0
    v_mfma_f32_16x16x32_bf16 v[64:67], a[196:199], a[176:179], v[64:67]
    ds_read_b64_tr_b16 a[210:211], v10 offset:6144
    v_accvgpr_write_b32 a128, 1.0
    v_mfma_f32_16x16x32_bf16 v[72:75], a[196:199], a[180:183], v[72:75]
    v_accvgpr_write_b32 a129, 1.0
    v_mfma_f32_16x16x32_bf16 v[72:75], a[192:195], a[164:167], v[72:75]
    buffer_load_dwordx4 a[40:43], v28, s[20:23], s46 offen offset:2048 sc1
    v_mfma_f32_16x16x32_bf16 v[80:83], a[192:195], a[168:171], v[80:83]
    ds_read_b64_tr_b16 a[212:213], v10 offset:12288
    v_max_u32 v20, v32, v33
    v_mfma_f32_16x16x32_bf16 v[80:83], a[196:199], a[184:187], v[80:83]
    ds_read_b64_tr_b16 a[214:215], v10 offset:18432
    v_min_u32 v21, v32, v33
    v_mfma_f32_16x16x32_bf16 v[88:91], a[196:199], a[188:191], v[88:91]
    v_med3_u32 v21, v20, v21, v34
    v_max_u32 v20, v20, v34
    v_mfma_f32_16x16x32_bf16 v[88:91], a[192:195], a[172:175], v[88:91]
    s_waitcnt lgkmcnt(4)
    v_med3_u32 v21, v20, v21, v35
    v_max_u32 v20, v20, v35
    v_mfma_f32_16x16x32_bf16 v[92:95], a[200:203], a[172:175], v[92:95]
    ds_read_b64_tr_b16 a[192:193], v11 offset:0
    v_med3_u32 v21, v20, v21, v36
    v_mfma_f32_16x16x32_bf16 v[92:95], a[204:207], a[188:191], v[92:95]
    ds_read_b64_tr_b16 a[194:195], v11 offset:6144
    v_max_u32 v20, v20, v36
    v_mfma_f32_16x16x32_bf16 v[84:87], a[204:207], a[184:187], v[84:87]
    buffer_load_dwordx4 a[44:47], v28, s[20:23], s46 offen offset:3072 sc1
    v_mfma_f32_16x16x32_bf16 v[84:87], a[200:203], a[168:171], v[84:87]
    v_med3_u32 v21, v20, v21, v37
    v_max_u32 v20, v20, v37
    v_mfma_f32_16x16x32_bf16 v[76:79], a[200:203], a[164:167], v[76:79]
    ds_read_b64_tr_b16 a[196:197], v11 offset:12288
    v_med3_u32 v21, v20, v21, v38
    v_mfma_f32_16x16x32_bf16 v[76:79], a[204:207], a[180:183], v[76:79]
    ds_read_b64_tr_b16 a[198:199], v11 offset:18432
    v_max_u32 v20, v20, v38
    v_mfma_f32_16x16x32_bf16 v[68:71], a[204:207], a[176:179], v[68:71]
    v_med3_u32 v21, v20, v21, v39
    v_max_u32 v20, v20, v39
    v_mfma_f32_16x16x32_bf16 v[68:71], a[200:203], a[160:163], v[68:71]
    s_waitcnt lgkmcnt(4)
    v_and_b32 v22, 1, v1
    v_cmp_eq_u32 vcc, 1, v22
    v_mfma_f32_16x16x32_bf16 v[96:99], a[208:211], a[160:163], v[96:99]
    s_add_u32 m0, s49, 98304
    ds_read_b64_tr_b16 a[200:201], v8 offset:1024
    v_readfirstlane_b32 s70, v20
    v_mfma_f32_16x16x32_bf16 v[96:99], a[212:215], a[176:179], v[96:99]
    ds_read_b64_tr_b16 a[202:203], v8 offset:7168
    v_readfirstlane_b32 s71, v21
    v_mfma_f32_16x16x32_bf16 v[104:107], a[212:215], a[180:183], v[104:107]
    buffer_load_dwordx4 v2, s[8:11], s36 offen offset:0 lds
    v_mfma_f32_16x16x32_bf16 v[104:107], a[208:211], a[164:167], v[104:107]
    v_cndmask_b32 v22, v20, v21, vcc
    v_and_b32 v22, 0x7ff, v22
    v_mfma_f32_16x16x32_bf16 v[112:115], a[208:211], a[168:171], v[112:115]
    ds_read_b64_tr_b16 a[204:205], v8 offset:13312
    v_sub_u32 v22, 2047, v22
    v_mfma_f32_16x16x32_bf16 v[112:115], a[212:215], a[184:187], v[112:115]
    s_add_u32 m0, s49, 99200
    ds_read_b64_tr_b16 a[206:207], v8 offset:19456
    v_mul_u32_u24 v23, 1280, v22
    v_mfma_f32_16x16x32_bf16 v[120:123], a[212:215], a[188:191], v[120:123]
    buffer_load_dwordx4 v2, s[8:11], s36 offen offset:128 lds
    v_mfma_f32_16x16x32_bf16 v[120:123], a[208:211], a[172:175], v[120:123]
    s_waitcnt lgkmcnt(4)
    v_lshrrev_b32 v24, 4, v1
    v_lshl_add_u32 v23, v24, 4, v23
    v_mfma_f32_16x16x32_bf16 v[124:127], a[192:195], a[172:175], v[124:127]
    ds_read_b64_tr_b16 a[208:209], v9 offset:1024
    v_add_u32 v23, s61, v23
    v_mfma_f32_16x16x32_bf16 v[124:127], a[196:199], a[188:191], v[124:127]
    ds_read_b64_tr_b16 a[210:211], v9 offset:7168
    v_lshlrev_b32 v24, 3, v22
    v_mfma_f32_16x16x32_bf16 v[116:119], a[196:199], a[184:187], v[116:119]
    s_mov_b32 s56, 3211264
    v_accvgpr_write_b32 a130, 1.0
    v_accvgpr_write_b32 a131, 1.0
    v_mfma_f32_16x16x32_bf16 v[116:119], a[192:195], a[168:171], v[116:119]
    v_accvgpr_write_b32 a132, 1.0
    v_accvgpr_write_b32 a133, 1.0
    v_mfma_f32_16x16x32_bf16 v[108:111], a[192:195], a[164:167], v[108:111]
    s_add_u32 m0, s49, 100096
    ds_read_b64_tr_b16 a[212:213], v9 offset:13312
    v_accvgpr_write_b32 a134, 1.0
    v_mfma_f32_16x16x32_bf16 v[108:111], a[196:199], a[180:183], v[108:111]
    ds_read_b64_tr_b16 a[214:215], v9 offset:19456
    v_accvgpr_write_b32 a135, 1.0
    v_mfma_f32_16x16x32_bf16 v[100:103], a[196:199], a[176:179], v[100:103]
    buffer_load_dwordx4 v2, s[8:11], s36 offen offset:256 lds
    v_mfma_f32_16x16x32_bf16 v[100:103], a[192:195], a[160:163], v[100:103]
    s_waitcnt lgkmcnt(4)
    v_accvgpr_write_b32 a136, 1.0
    v_accvgpr_write_b32 a137, 1.0
    v_mfma_f32_16x16x32_bf16 v[128:131], a[200:203], a[160:163], v[128:131]
    ds_read_b64_tr_b16 a[192:193], v10 offset:1024
    v_accvgpr_write_b32 a138, 1.0
    v_mfma_f32_16x16x32_bf16 v[128:131], a[204:207], a[176:179], v[128:131]
    ds_read_b64_tr_b16 a[194:195], v10 offset:7168
    v_accvgpr_write_b32 a139, 1.0
    v_mfma_f32_16x16x32_bf16 v[136:139], a[204:207], a[180:183], v[136:139]
    s_add_u32 m0, s49, 101376
    v_accvgpr_write_b32 a140, 1.0
    v_accvgpr_write_b32 a141, 1.0
    v_mfma_f32_16x16x32_bf16 v[136:139], a[200:203], a[164:167], v[136:139]
    buffer_load_dwordx4 v3, s[8:11], s36 offen offset:0 lds
    v_mfma_f32_16x16x32_bf16 v[144:147], a[200:203], a[168:171], v[144:147]
    ds_read_b64_tr_b16 a[196:197], v10 offset:13312
    v_accvgpr_write_b32 a142, 1.0
    v_mfma_f32_16x16x32_bf16 v[144:147], a[204:207], a[184:187], v[144:147]
    ds_read_b64_tr_b16 a[198:199], v10 offset:19456
    v_accvgpr_write_b32 a143, 1.0
    v_mfma_f32_16x16x32_bf16 v[152:155], a[204:207], a[188:191], v[152:155]
    v_accvgpr_write_b32 a144, 1.0
    v_accvgpr_write_b32 a145, 1.0
    v_mfma_f32_16x16x32_bf16 v[152:155], a[200:203], a[172:175], v[152:155]
    s_waitcnt lgkmcnt(4)
    v_accvgpr_write_b32 a146, 1.0
    v_accvgpr_write_b32 a147, 1.0
    v_mfma_f32_16x16x32_bf16 v[156:159], a[208:211], a[172:175], v[156:159]
    ds_read_b64_tr_b16 a[200:201], v11 offset:1024
    v_accvgpr_write_b32 a148, 1.0
    v_mfma_f32_16x16x32_bf16 v[156:159], a[212:215], a[188:191], v[156:159]
    s_add_u32 m0, s49, 102272
    ds_read_b64_tr_b16 a[202:203], v11 offset:7168
    v_accvgpr_write_b32 a149, 1.0
    v_mfma_f32_16x16x32_bf16 v[148:151], a[212:215], a[184:187], v[148:151]
    buffer_load_dwordx4 v3, s[8:11], s36 offen offset:128 lds
    v_mfma_f32_16x16x32_bf16 v[148:151], a[208:211], a[168:171], v[148:151]
    v_accvgpr_write_b32 a150, 1.0
    v_accvgpr_write_b32 a151, 1.0
    v_mfma_f32_16x16x32_bf16 v[140:143], a[208:211], a[164:167], v[140:143]
    ds_read_b64_tr_b16 a[204:205], v11 offset:13312
    v_accvgpr_write_b32 a152, 1.0
    v_mfma_f32_16x16x32_bf16 v[140:143], a[212:215], a[180:183], v[140:143]
    ds_read_b64_tr_b16 a[206:207], v11 offset:19456
    v_accvgpr_write_b32 a153, 1.0
    v_mfma_f32_16x16x32_bf16 v[132:135], a[212:215], a[176:179], v[132:135]
    v_accvgpr_write_b32 a154, 1.0
    v_accvgpr_write_b32 a155, 1.0
    v_mfma_f32_16x16x32_bf16 v[132:135], a[208:211], a[160:163], v[132:135]
    s_waitcnt lgkmcnt(4)
    v_accvgpr_write_b32 a156, 1.0
    v_accvgpr_write_b32 a157, 1.0
    v_mfma_f32_16x16x32_bf16 v[160:163], a[192:195], a[160:163], v[160:163]
    s_add_u32 m0, s49, 103168
    ds_read_b64_tr_b16 a[208:209], v8 offset:2048
    v_accvgpr_write_b32 a158, 1.0
    v_mfma_f32_16x16x32_bf16 v[160:163], a[196:199], a[176:179], v[160:163]
    ds_read_b64_tr_b16 a[210:211], v8 offset:8192
    v_accvgpr_write_b32 a159, 1.0
    v_mfma_f32_16x16x32_bf16 v[168:171], a[196:199], a[180:183], v[168:171]
    buffer_load_dwordx4 v3, s[8:11], s36 offen offset:256 lds
    v_mfma_f32_16x16x32_bf16 v[168:171], a[192:195], a[164:167], v[168:171]
    s_add_u32 s36, s36, s37
    s_sub_u32 s55, s36, 7864320
    s_min_u32 s36, s36, s55
    v_mfma_f32_16x16x32_bf16 v[176:179], a[192:195], a[168:171], v[176:179]
    s_add_u32 s46, s45, 61440
    ds_read_b64_tr_b16 a[212:213], v8 offset:14336
    s_sub_u32 s77, s46, 81920
    v_mfma_f32_16x16x32_bf16 v[176:179], a[196:199], a[184:187], v[176:179]
    s_min_u32 s46, s46, s77
    ds_read_b64_tr_b16 a[214:215], v8 offset:20480
    v_mfma_f32_16x16x32_bf16 v[184:187], a[196:199], a[188:191], v[184:187]
    v_add_u32 v8, 49152, v12
    v_mfma_f32_16x16x32_bf16 v[184:187], a[192:195], a[172:175], v[184:187]
    s_waitcnt lgkmcnt(4)
    v_mfma_f32_16x16x32_bf16 v[188:191], a[200:203], a[172:175], v[188:191]
    ds_read_b64_tr_b16 a[192:193], v9 offset:2048
    v_mfma_f32_16x16x32_bf16 v[188:191], a[204:207], a[188:191], v[188:191]
    ds_read_b64_tr_b16 a[194:195], v9 offset:8192
    v_mfma_f32_16x16x32_bf16 v[180:183], a[204:207], a[184:187], v[180:183]
    buffer_load_dwordx4 a[48:51], v28, s[20:23], s46 offen offset:0 sc1
    v_mfma_f32_16x16x32_bf16 v[180:183], a[200:203], a[168:171], v[180:183]
    v_mfma_f32_16x16x32_bf16 v[172:175], a[200:203], a[164:167], v[172:175]
    ds_read_b64_tr_b16 a[196:197], v9 offset:14336
    v_mfma_f32_16x16x32_bf16 v[172:175], a[204:207], a[180:183], v[172:175]
    ds_read_b64_tr_b16 a[198:199], v9 offset:20480
    v_mfma_f32_16x16x32_bf16 v[164:167], a[204:207], a[176:179], v[164:167]
    buffer_load_dwordx4 a[52:55], v28, s[20:23], s46 offen offset:1024 sc1
    v_mfma_f32_16x16x32_bf16 v[164:167], a[200:203], a[160:163], v[164:167]
    s_waitcnt lgkmcnt(4)
    v_add_u32 v9, 49152, v13
    v_mfma_f32_16x16x32_bf16 v[192:195], a[208:211], a[160:163], v[192:195]
    ds_read_b64_tr_b16 a[200:201], v10 offset:2048
    v_mfma_f32_16x16x32_bf16 v[192:195], a[212:215], a[176:179], v[192:195]
    ds_read_b64_tr_b16 a[202:203], v10 offset:8192
    v_mfma_f32_16x16x32_bf16 v[200:203], a[212:215], a[180:183], v[200:203]
    v_mfma_f32_16x16x32_bf16 v[200:203], a[208:211], a[164:167], v[200:203]
    v_mfma_f32_16x16x32_bf16 v[208:211], a[208:211], a[168:171], v[208:211]
    ds_read_b64_tr_b16 a[204:205], v10 offset:14336
    v_mfma_f32_16x16x32_bf16 v[208:211], a[212:215], a[184:187], v[208:211]
    ds_read_b64_tr_b16 a[206:207], v10 offset:20480
    v_mfma_f32_16x16x32_bf16 v[216:219], a[212:215], a[188:191], v[216:219]
    buffer_load_dwordx4 a[56:59], v28, s[20:23], s46 offen offset:2048 sc1
    v_mfma_f32_16x16x32_bf16 v[216:219], a[208:211], a[172:175], v[216:219]
    s_waitcnt lgkmcnt(4)
    v_add_u32 v10, 49152, v14
    v_mfma_f32_16x16x32_bf16 v[220:223], a[192:195], a[172:175], v[220:223]
    ds_read_b64_tr_b16 a[208:209], v11 offset:2048
    v_mfma_f32_16x16x32_bf16 v[220:223], a[196:199], a[188:191], v[220:223]
    ds_read_b64_tr_b16 a[210:211], v11 offset:8192
    v_mfma_f32_16x16x32_bf16 v[212:215], a[196:199], a[184:187], v[212:215]
    buffer_load_dwordx4 a[60:63], v28, s[20:23], s46 offen offset:3072 sc1
    v_mfma_f32_16x16x32_bf16 v[212:215], a[192:195], a[168:171], v[212:215]
    v_mfma_f32_16x16x32_bf16 v[204:207], a[192:195], a[164:167], v[204:207]
    ds_read_b64_tr_b16 a[212:213], v11 offset:14336
    v_mfma_f32_16x16x32_bf16 v[204:207], a[196:199], a[180:183], v[204:207]
    s_waitcnt vmcnt(32)
    ds_read_b64_tr_b16 a[214:215], v11 offset:20480
    v_mfma_f32_16x16x32_bf16 v[196:199], a[196:199], a[176:179], v[196:199]
    s_barrier
    v_mfma_f32_16x16x32_bf16 v[196:199], a[192:195], a[160:163], v[196:199]
    s_waitcnt lgkmcnt(4)
    global_load_dwordx4 v[48:51], v23, s[64:65]
    v_mfma_f32_16x16x32_bf16 v[224:227], a[200:203], a[160:163], v[224:227]
    ds_read_b64_tr_b16 a[192:193], v8 offset:0
    v_add_u32 v11, 49152, v15
    v_mfma_f32_16x16x32_bf16 v[224:227], a[204:207], a[176:179], v[224:227]
    s_add_u32 m0, s44, 147456
    ds_read_b64_tr_b16 a[194:195], v8 offset:6144
    v_mfma_f32_16x16x32_bf16 v[232:235], a[204:207], a[180:183], v[232:235]
pg_3:
    s_cbranch_execz pg_7
    global_load_dwordx4 v[52:55], v23, s[64:65] offset:64
    v_mfma_f32_16x16x32_bf16 v[232:235], a[200:203], a[164:167], v[232:235]
    buffer_load_dwordx2 v[40:41], v24, s[24:27], s56 offen sc1
    v_mfma_f32_16x16x32_bf16 v[240:243], a[200:203], a[168:171], v[240:243]
    ds_read_b64_tr_b16 a[196:197], v8 offset:12288
    v_bfe_u32 v26, v1, 2, 3
    v_mfma_f32_16x16x32_bf16 v[240:243], a[204:207], a[184:187], v[240:243]
    ds_read_b64_tr_b16 a[198:199], v8 offset:18432
    v_lshlrev_b32 v25, 7, v26
    v_mfma_f32_16x16x32_bf16 v[248:251], a[204:207], a[188:191], v[248:251]
    buffer_load_dword v61, v60, s[24:27], s47 offen offset:12 sc1
    v_mfma_f32_16x16x32_bf16 v[248:251], a[200:203], a[172:175], v[248:251]
    s_waitcnt lgkmcnt(4)
    buffer_load_dwordx4 v56, s[28:31], s60 offen lds
    v_mfma_f32_16x16x32_bf16 v[252:255], a[208:211], a[172:175], v[252:255]
    s_add_u32 m0, s44, 148480
    ds_read_b64_tr_b16 a[200:201], v9 offset:0
    v_lshrrev_b32 v26, 1, v26
    v_mfma_f32_16x16x32_bf16 v[252:255], a[212:215], a[188:191], v[252:255]
    ds_read_b64_tr_b16 a[202:203], v9 offset:6144
    v_xor_b32 v26, s3, v26
    v_mfma_f32_16x16x32_bf16 v[244:247], a[212:215], a[184:187], v[244:247]
    buffer_load_dwordx4 v56, s[32:35], s60 offen lds
    v_mfma_f32_16x16x32_bf16 v[244:247], a[208:211], a[168:171], v[244:247]
    s_add_u32 m0, s44, 149504
    v_lshl_add_u32 v25, v26, 5, v25
    v_and_b32 v26, 3, v1
    v_mfma_f32_16x16x32_bf16 v[236:239], a[208:211], a[164:167], v[236:239]
    ds_read_b64_tr_b16 a[204:205], v9 offset:12288
    v_lshl_add_u32 v25, v26, 3, v25
    v_mfma_f32_16x16x32_bf16 v[236:239], a[212:215], a[180:183], v[236:239]
    s_waitcnt vmcnt(30)
    s_waitcnt vmcnt(20)
    ds_read_b64_tr_b16 a[206:207], v9 offset:18432
    v_mfma_f32_16x16x32_bf16 v[228:231], a[212:215], a[176:179], v[228:231]
    buffer_load_dwordx4 v57, s[28:31], s60 offen lds
    v_mfma_f32_16x16x32_bf16 v[228:231], a[208:211], a[160:163], v[228:231]
    s_waitcnt lgkmcnt(4)
    v_lshrrev_b32 v26, 5, v1
    v_mul_u32_u24 v26, 2048, v26
    v_mfma_f32_16x16x32_bf16 v[64:67], a[192:195], a[0:3], v[64:67]
    s_add_u32 m0, s44, 150528
    ds_read_b64_tr_b16 a[208:209], v10 offset:0
    v_add_u32 v25, v25, v26
    v_mfma_f32_16x16x32_bf16 v[64:67], a[196:199], a[16:19], v[64:67]
    ds_read_b64_tr_b16 a[210:211], v10 offset:6144
    v_add_u32 v25, 147456, v25
    v_mfma_f32_16x16x32_bf16 v[72:75], a[196:199], a[20:23], v[72:75]
    buffer_load_dwordx4 v57, s[32:35], s60 offen lds
    v_mfma_f32_16x16x32_bf16 v[72:75], a[192:195], a[4:7], v[72:75]
    v_lshlrev_b32 v26, 4, v1
    v_cmp_gt_u32 vcc, 16, v1
    v_mfma_f32_16x16x32_bf16 v[80:83], a[192:195], a[8:11], v[80:83]
    ds_read_b64_tr_b16 a[212:213], v10 offset:12288
    v_mov_b32 v27, 0x7ffffff0
    v_mfma_f32_16x16x32_bf16 v[80:83], a[196:199], a[24:27], v[80:83]
    ds_read_b64_tr_b16 a[214:215], v10 offset:18432
    v_cndmask_b32 v26, v27, v26, vcc
    v_mfma_f32_16x16x32_bf16 v[88:91], a[196:199], a[28:31], v[88:91]
    v_accvgpr_write_b32 a160, 1.0
    v_mfma_f32_16x16x32_bf16 v[88:91], a[192:195], a[12:15], v[88:91]
    s_waitcnt lgkmcnt(4)
    v_accvgpr_write_b32 a161, 1.0
    v_mfma_f32_16x16x32_bf16 v[92:95], a[200:203], a[12:15], v[92:95]
    s_add_u32 s46, s45, 65536
    ds_read_b64_tr_b16 a[192:193], v11 offset:0
    v_accvgpr_write_b32 a162, 1.0
    v_mfma_f32_16x16x32_bf16 v[92:95], a[204:207], a[28:31], v[92:95]
    s_sub_u32 s77, s46, 81920
    ds_read_b64_tr_b16 a[194:195], v11 offset:6144
    v_accvgpr_write_b32 a163, 1.0
    v_mfma_f32_16x16x32_bf16 v[84:87], a[204:207], a[24:27], v[84:87]
    s_min_u32 s46, s46, s77
    v_accvgpr_write_b32 a164, 1.0
    v_mfma_f32_16x16x32_bf16 v[84:87], a[200:203], a[8:11], v[84:87]
    buffer_load_dwordx4 a[64:67], v28, s[20:23], s46 offen offset:0 sc1
    v_mfma_f32_16x16x32_bf16 v[76:79], a[200:203], a[4:7], v[76:79]
    ds_read_b64_tr_b16 a[196:197], v11 offset:12288
    v_accvgpr_write_b32 a165, 1.0
    v_mfma_f32_16x16x32_bf16 v[76:79], a[204:207], a[20:23], v[76:79]
    ds_read_b64_tr_b16 a[198:199], v11 offset:18432
    v_accvgpr_write_b32 a166, 1.0
    v_mfma_f32_16x16x32_bf16 v[68:71], a[204:207], a[16:19], v[68:71]
    v_accvgpr_write_b32 a167, 1.0
    v_mfma_f32_16x16x32_bf16 v[68:71], a[200:203], a[0:3], v[68:71]
    s_waitcnt lgkmcnt(4)
    v_accvgpr_write_b32 a168, 1.0
    v_mfma_f32_16x16x32_bf16 v[96:99], a[208:211], a[0:3], v[96:99]
    ds_read_b64_tr_b16 a[200:201], v8 offset:1024
    v_accvgpr_write_b32 a169, 1.0
    v_mfma_f32_16x16x32_bf16 v[96:99], a[212:215], a[16:19], v[96:99]
    ds_read_b64_tr_b16 a[202:203], v8 offset:7168
    v_accvgpr_write_b32 a170, 1.0
    v_mfma_f32_16x16x32_bf16 v[104:107], a[212:215], a[20:23], v[104:107]
    buffer_load_dwordx4 a[68:71], v28, s[20:23], s46 offen offset:1024 sc1
    v_mfma_f32_16x16x32_bf16 v[104:107], a[208:211], a[4:7], v[104:107]
    v_accvgpr_write_b32 a171, 1.0
    v_accvgpr_write_b32 a172, 1.0
    v_mfma_f32_16x16x32_bf16 v[112:115], a[208:211], a[8:11], v[112:115]
    ds_read_b64_tr_b16 a[204:205], v8 offset:13312
    v_accvgpr_write_b32 a173, 1.0
    v_mfma_f32_16x16x32_bf16 v[112:115], a[212:215], a[24:27], v[112:115]
    ds_read_b64_tr_b16 a[206:207], v8 offset:19456
    v_accvgpr_write_b32 a174, 1.0
    v_mfma_f32_16x16x32_bf16 v[120:123], a[212:215], a[28:31], v[120:123]
    v_accvgpr_write_b32 a175, 1.0
    v_accvgpr_write_b32 a176, 1.0
    v_mfma_f32_16x16x32_bf16 v[120:123], a[208:211], a[12:15], v[120:123]
    s_waitcnt lgkmcnt(4)
    v_accvgpr_write_b32 a177, 1.0
    v_accvgpr_write_b32 a178, 1.0
    v_mfma_f32_16x16x32_bf16 v[124:127], a[192:195], a[12:15], v[124:127]
    ds_read_b64_tr_b16 a[208:209], v9 offset:1024
    v_accvgpr_write_b32 a179, 1.0
    v_mfma_f32_16x16x32_bf16 v[124:127], a[196:199], a[28:31], v[124:127]
    ds_read_b64_tr_b16 a[210:211], v9 offset:7168
    v_accvgpr_write_b32 a180, 1.0
    v_mfma_f32_16x16x32_bf16 v[116:119], a[196:199], a[24:27], v[116:119]
    buffer_load_dwordx4 a[72:75], v28, s[20:23], s46 offen offset:2048 sc1
    v_mfma_f32_16x16x32_bf16 v[116:119], a[192:195], a[8:11], v[116:119]
    v_accvgpr_write_b32 a181, 1.0
    v_accvgpr_write_b32 a182, 1.0
    v_mfma_f32_16x16x32_bf16 v[108:111], a[192:195], a[4:7], v[108:111]
    ds_read_b64_tr_b16 a[212:213], v9 offset:13312
    v_accvgpr_write_b32 a183, 1.0
    v_mfma_f32_16x16x32_bf16 v[108:111], a[196:199], a[20:23], v[108:111]
    ds_read_b64_tr_b16 a[214:215], v9 offset:19456
    v_accvgpr_write_b32 a184, 1.0
    v_mfma_f32_16x16x32_bf16 v[100:103], a[196:199], a[16:19], v[100:103]
    buffer_load_dwordx4 a[76:79], v28, s[20:23], s46 offen offset:3072 sc1
    v_mfma_f32_16x16x32_bf16 v[100:103], a[192:195], a[0:3], v[100:103]
    s_waitcnt lgkmcnt(4)
    v_accvgpr_write_b32 a185, 1.0
    v_accvgpr_write_b32 a186, 1.0
    v_mfma_f32_16x16x32_bf16 v[128:131], a[200:203], a[0:3], v[128:131]
    ds_read_b64_tr_b16 a[192:193], v10 offset:1024
    v_accvgpr_write_b32 a187, 1.0
    v_mfma_f32_16x16x32_bf16 v[128:131], a[204:207], a[16:19], v[128:131]
    ds_read_b64_tr_b16 a[194:195], v10 offset:7168
    v_accvgpr_write_b32 a188, 1.0
    v_mfma_f32_16x16x32_bf16 v[136:139], a[204:207], a[20:23], v[136:139]
    v_accvgpr_write_b32 a189, 1.0
    v_accvgpr_write_b32 a190, 1.0
    v_mfma_f32_16x16x32_bf16 v[136:139], a[200:203], a[4:7], v[136:139]
    v_accvgpr_write_b32 a191, 1.0
    v_mfma_f32_16x16x32_bf16 v[144:147], a[200:203], a[8:11], v[144:147]
    s_add_u32 m0, s49, 122880
    ds_read_b64_tr_b16 a[196:197], v10 offset:13312
    v_mfma_f32_16x16x32_bf16 v[144:147], a[204:207], a[24:27], v[144:147]
    ds_read_b64_tr_b16 a[198:199], v10 offset:19456
    v_mfma_f32_16x16x32_bf16 v[152:155], a[204:207], a[28:31], v[152:155]
    buffer_load_dwordx4 v2, s[8:11], s36 offen offset:0 lds
    v_mfma_f32_16x16x32_bf16 v[152:155], a[200:203], a[12:15], v[152:155]
    s_waitcnt lgkmcnt(4)
    v_mfma_f32_16x16x32_bf16 v[156:159], a[208:211], a[12:15], v[156:159]
    ds_read_b64_tr_b16 a[200:201], v11 offset:1024
    v_mfma_f32_16x16x32_bf16 v[156:159], a[212:215], a[28:31], v[156:159]
    ds_read_b64_tr_b16 a[202:203], v11 offset:7168
    v_mfma_f32_16x16x32_bf16 v[148:151], a[212:215], a[24:27], v[148:151]
    s_add_u32 m0, s49, 123776
    v_mfma_f32_16x16x32_bf16 v[148:151], a[208:211], a[8:11], v[148:151]
    buffer_load_dwordx4 v2, s[8:11], s36 offen offset:128 lds
    v_mfma_f32_16x16x32_bf16 v[140:143], a[208:211], a[4:7], v[140:143]
    ds_read_b64_tr_b16 a[204:205], v11 offset:13312
    v_mfma_f32_16x16x32_bf16 v[140:143], a[212:215], a[20:23], v[140:143]
    ds_read_b64_tr_b16 a[206:207], v11 offset:19456
    v_mfma_f32_16x16x32_bf16 v[132:135], a[212:215], a[16:19], v[132:135]
    v_mfma_f32_16x16x32_bf16 v[132:135], a[208:211], a[0:3], v[132:135]
    s_waitcnt lgkmcnt(4)
    v_mfma_f32_16x16x32_bf16 v[160:163], a[192:195], a[0:3], v[160:163]
    ds_read_b64_tr_b16 a[208:209], v8 offset:2048
    v_mfma_f32_16x16x32_bf16 v[160:163], a[196:199], a[16:19], v[160:163]
    s_add_u32 m0, s49, 124672
    ds_read_b64_tr_b16 a[210:211], v8 offset:8192
    v_mfma_f32_16x16x32_bf16 v[168:171], a[196:199], a[20:23], v[168:171]
    buffer_load_dwordx4 v2, s[8:11], s36 offen offset:256 lds
    v_mfma_f32_16x16x32_bf16 v[168:171], a[192:195], a[4:7], v[168:171]
    v_mfma_f32_16x16x32_bf16 v[176:179], a[192:195], a[8:11], v[176:179]
    ds_read_b64_tr_b16 a[212:213], v8 offset:14336
    v_mfma_f32_16x16x32_bf16 v[176:179], a[196:199], a[24:27], v[176:179]
    ds_read_b64_tr_b16 a[214:215], v8 offset:20480
    v_mfma_f32_16x16x32_bf16 v[184:187], a[196:199], a[28:31], v[184:187]
    v_add_u32 v8, 73728, v12
    v_mfma_f32_16x16x32_bf16 v[184:187], a[192:195], a[12:15], v[184:187]
    s_waitcnt lgkmcnt(4)
    s_add_u32 m0, s49, 125952
    v_mfma_f32_16x16x32_bf16 v[188:191], a[200:203], a[12:15], v[188:191]
    ds_read_b64_tr_b16 a[192:193], v9 offset:2048
    v_mfma_f32_16x16x32_bf16 v[188:191], a[204:207], a[28:31], v[188:191]
    ds_read_b64_tr_b16 a[194:195], v9 offset:8192
    v_mfma_f32_16x16x32_bf16 v[180:183], a[204:207], a[24:27], v[180:183]
    buffer_load_dwordx4 v3, s[8:11], s36 offen offset:0 lds
    v_mfma_f32_16x16x32_bf16 v[180:183], a[200:203], a[8:11], v[180:183]
    v_mfma_f32_16x16x32_bf16 v[172:175], a[200:203], a[4:7], v[172:175]
    ds_read_b64_tr_b16 a[196:197], v9 offset:14336
    v_mfma_f32_16x16x32_bf16 v[172:175], a[204:207], a[20:23], v[172:175]
    ds_read_b64_tr_b16 a[198:199], v9 offset:20480
    v_mfma_f32_16x16x32_bf16 v[164:167], a[204:207], a[16:19], v[164:167]
    s_add_u32 m0, s49, 126848
    v_add_u32 v9, 73728, v13
    v_mfma_f32_16x16x32_bf16 v[164:167], a[200:203], a[0:3], v[164:167]
    s_waitcnt lgkmcnt(4)
    v_mfma_f32_16x16x32_bf16 v[192:195], a[208:211], a[0:3], v[192:195]
    ds_read_b64_tr_b16 a[200:201], v10 offset:2048
    v_mfma_f32_16x16x32_bf16 v[192:195], a[212:215], a[16:19], v[192:195]
    ds_read_b64_tr_b16 a[202:203], v10 offset:8192
    v_mfma_f32_16x16x32_bf16 v[200:203], a[212:215], a[20:23], v[200:203]
    buffer_load_dwordx4 v3, s[8:11], s36 offen offset:128 lds
    v_mfma_f32_16x16x32_bf16 v[200:203], a[208:211], a[4:7], v[200:203]
    v_mfma_f32_16x16x32_bf16 v[208:211], a[208:211], a[8:11], v[208:211]
    s_add_u32 m0, s49, 127744
    ds_read_b64_tr_b16 a[204:205], v10 offset:14336
    v_mfma_f32_16x16x32_bf16 v[208:211], a[212:215], a[24:27], v[208:211]
    ds_read_b64_tr_b16 a[206:207], v10 offset:20480
    v_mfma_f32_16x16x32_bf16 v[216:219], a[212:215], a[28:31], v[216:219]
    buffer_load_dwordx4 v3, s[8:11], s36 offen offset:256 lds
    v_mfma_f32_16x16x32_bf16 v[216:219], a[208:211], a[12:15], v[216:219]
    s_waitcnt lgkmcnt(4)
    v_add_u32 v10, 73728, v14
    s_add_u32 s36, s36, s37
    v_mfma_f32_16x16x32_bf16 v[220:223], a[192:195], a[12:15], v[220:223]
    s_sub_u32 s55, s36, 7864320
    ds_read_b64_tr_b16 a[208:209], v11 offset:2048
    s_min_u32 s36, s36, s55
    v_mfma_f32_16x16x32_bf16 v[220:223], a[196:199], a[28:31], v[220:223]
    s_add_u32 s46, s45, 69632
    ds_read_b64_tr_b16 a[210:211], v11 offset:8192
    s_sub_u32 s77, s46, 81920
    v_mfma_f32_16x16x32_bf16 v[212:215], a[196:199], a[24:27], v[212:215]
    s_min_u32 s46, s46, s77
    v_mfma_f32_16x16x32_bf16 v[212:215], a[192:195], a[8:11], v[212:215]
    v_mfma_f32_16x16x32_bf16 v[204:207], a[192:195], a[4:7], v[204:207]
    ds_read_b64_tr_b16 a[212:213], v11 offset:14336
    v_mfma_f32_16x16x32_bf16 v[204:207], a[196:199], a[20:23], v[204:207]
    s_waitcnt vmcnt(36)
    ds_read_b64_tr_b16 a[214:215], v11 offset:20480
    v_mfma_f32_16x16x32_bf16 v[196:199], a[196:199], a[16:19], v[196:199]
    s_barrier
    v_mfma_f32_16x16x32_bf16 v[196:199], a[192:195], a[0:3], v[196:199]
    s_waitcnt lgkmcnt(4)
    buffer_load_dwordx4 a[80:83], v28, s[20:23], s46 offen offset:0 sc1
    v_mfma_f32_16x16x32_bf16 v[224:227], a[200:203], a[0:3], v[224:227]
    ds_read_b64_tr_b16 a[192:193], v8 offset:0
    v_add_u32 v11, 73728, v15
    v_mfma_f32_16x16x32_bf16 v[224:227], a[204:207], a[16:19], v[224:227]
    ds_read_b64_tr_b16 a[194:195], v8 offset:6144
    v_mfma_f32_16x16x32_bf16 v[232:235], a[204:207], a[20:23], v[232:235]
    buffer_load_dwordx4 a[84:87], v28, s[20:23], s46 offen offset:1024 sc1
    v_mfma_f32_16x16x32_bf16 v[232:235], a[200:203], a[4:7], v[232:235]
    v_mfma_f32_16x16x32_bf16 v[240:243], a[200:203], a[8:11], v[240:243]
    ds_read_b64_tr_b16 a[196:197], v8 offset:12288
    v_mfma_f32_16x16x32_bf16 v[240:243], a[204:207], a[24:27], v[240:243]
    ds_read_b64_tr_b16 a[198:199], v8 offset:18432
    v_mfma_f32_16x16x32_bf16 v[248:251], a[204:207], a[28:31], v[248:251]
    v_mfma_f32_16x16x32_bf16 v[248:251], a[200:203], a[12:15], v[248:251]
    s_waitcnt lgkmcnt(4)
    v_mfma_f32_16x16x32_bf16 v[252:255], a[208:211], a[12:15], v[252:255]
    ds_read_b64_tr_b16 a[200:201], v9 offset:0
    v_mfma_f32_16x16x32_bf16 v[252:255], a[212:215], a[28:31], v[252:255]
    ds_read_b64_tr_b16 a[202:203], v9 offset:6144
    v_mfma_f32_16x16x32_bf16 v[244:247], a[212:215], a[24:27], v[244:247]
    buffer_load_dwordx4 a[88:91], v28, s[20:23], s46 offen offset:2048 sc1
    v_mfma_f32_16x16x32_bf16 v[244:247], a[208:211], a[8:11], v[244:247]
    v_mfma_f32_16x16x32_bf16 v[236:239], a[208:211], a[4:7], v[236:239]
    ds_read_b64_tr_b16 a[204:205], v9 offset:12288
    v_mfma_f32_16x16x32_bf16 v[236:239], a[212:215], a[20:23], v[236:239]
    s_waitcnt vmcnt(31)
    s_waitcnt vmcnt(21)
    ds_read_b64_tr_b16 a[206:207], v9 offset:18432
    v_mfma_f32_16x16x32_bf16 v[228:231], a[212:215], a[16:19], v[228:231]
    v_mfma_f32_16x16x32_bf16 v[228:231], a[208:211], a[0:3], v[228:231]
    s_waitcnt lgkmcnt(4)
    v_mfma_f32_16x16x32_bf16 v[64:67], a[192:195], a[32:35], v[64:67]
    ds_read_b64_tr_b16 a[208:209], v10 offset:0
    v_mfma_f32_16x16x32_bf16 v[64:67], a[196:199], a[48:51], v[64:67]
    ds_read_b64_tr_b16 a[210:211], v10 offset:6144
    v_accvgpr_write_b32 a0, 1.0
    v_mfma_f32_16x16x32_bf16 v[72:75], a[196:199], a[52:55], v[72:75]
    buffer_load_dwordx4 a[92:95], v28, s[20:23], s46 offen offset:3072 sc1
    v_mfma_f32_16x16x32_bf16 v[72:75], a[192:195], a[36:39], v[72:75]
    s_add_u32 s46, s45, 73728
    v_accvgpr_write_b32 a1, 1.0
    v_mfma_f32_16x16x32_bf16 v[80:83], a[192:195], a[40:43], v[80:83]
    s_sub_u32 s77, s46, 81920
    ds_read_b64_tr_b16 a[212:213], v10 offset:12288
    v_accvgpr_write_b32 a2, 1.0
    v_mfma_f32_16x16x32_bf16 v[80:83], a[196:199], a[56:59], v[80:83]
    s_min_u32 s46, s46, s77
    ds_read_b64_tr_b16 a[214:215], v10 offset:18432
    v_accvgpr_write_b32 a3, 1.0
    v_mfma_f32_16x16x32_bf16 v[88:91], a[196:199], a[60:63], v[88:91]
    buffer_load_dwordx4 a[224:227], v28, s[20:23], s46 offen offset:0 sc1
    v_mfma_f32_16x16x32_bf16 v[88:91], a[192:195], a[44:47], v[88:91]
    s_waitcnt lgkmcnt(4)
    v_accvgpr_write_b32 a4, 1.0
    v_mfma_f32_16x16x32_bf16 v[92:95], a[200:203], a[44:47], v[92:95]
    s_waitcnt vmcnt(20)
    ds_read_b64_tr_b16 a[192:193], v11 offset:0
    v_lshlrev_b32 v42, 16, v48
    v_mfma_f32_16x16x32_bf16 v[92:95], a[204:207], a[60:63], v[92:95]
    ds_read_b64_tr_b16 a[194:195], v11 offset:6144
    v_and_b32 v43, 0xffff0000, v48
    v_mfma_f32_16x16x32_bf16 v[84:87], a[204:207], a[56:59], v[84:87]
    v_sub_f32 v42, v42, v40
    v_sub_f32 v43, v43, v40
    v_mfma_f32_16x16x32_bf16 v[84:87], a[200:203], a[40:43], v[84:87]
    v_cvt_pk_bf16_f32 v44, v42, v43
    v_lshlrev_b32 v42, 16, v44
    v_mfma_f32_16x16x32_bf16 v[76:79], a[200:203], a[36:39], v[76:79]
    ds_read_b64_tr_b16 a[196:197], v11 offset:12288
    v_and_b32 v43, 0xffff0000, v44
    v_mfma_f32_16x16x32_bf16 v[76:79], a[204:207], a[52:55], v[76:79]
    ds_read_b64_tr_b16 a[198:199], v11 offset:18432
    v_mul_f32 v42, v42, v41
    v_mfma_f32_16x16x32_bf16 v[68:71], a[204:207], a[48:51], v[68:71]
    buffer_load_dwordx4 a[228:231], v28, s[20:23], s46 offen offset:1024 sc1
    v_mfma_f32_16x16x32_bf16 v[68:71], a[200:203], a[32:35], v[68:71]
    s_waitcnt lgkmcnt(4)
    v_mul_f32 v43, v43, v41
    v_cvt_pk_bf16_f32 v48, v42, v43
    v_mfma_f32_16x16x32_bf16 v[96:99], a[208:211], a[32:35], v[96:99]
    ds_read_b64_tr_b16 a[200:201], v8 offset:1024
    v_lshlrev_b32 v42, 16, v49
    v_mfma_f32_16x16x32_bf16 v[96:99], a[212:215], a[48:51], v[96:99]
    ds_read_b64_tr_b16 a[202:203], v8 offset:7168
    v_and_b32 v43, 0xffff0000, v49
    v_mfma_f32_16x16x32_bf16 v[104:107], a[212:215], a[52:55], v[104:107]
    s_waitcnt vmcnt(20)
    v_sub_f32 v42, v42, v40
    v_sub_f32 v43, v43, v40
    v_mfma_f32_16x16x32_bf16 v[104:107], a[208:211], a[36:39], v[104:107]
    buffer_load_dwordx4 a[232:235], v28, s[20:23], s46 offen offset:2048 sc1
    v_mfma_f32_16x16x32_bf16 v[112:115], a[208:211], a[40:43], v[112:115]
    ds_read_b64_tr_b16 a[204:205], v8 offset:13312
    v_cvt_pk_bf16_f32 v44, v42, v43
    v_mfma_f32_16x16x32_bf16 v[112:115], a[212:215], a[56:59], v[112:115]
    ds_read_b64_tr_b16 a[206:207], v8 offset:19456
    v_lshlrev_b32 v42, 16, v44
    v_mfma_f32_16x16x32_bf16 v[120:123], a[212:215], a[60:63], v[120:123]
    v_and_b32 v43, 0xffff0000, v44
    v_mul_f32 v42, v42, v41
    v_mfma_f32_16x16x32_bf16 v[120:123], a[208:211], a[44:47], v[120:123]
    s_waitcnt lgkmcnt(4)
    v_mul_f32 v43, v43, v41
    v_cvt_pk_bf16_f32 v49, v42, v43
    v_mfma_f32_16x16x32_bf16 v[124:127], a[192:195], a[44:47], v[124:127]
    ds_read_b64_tr_b16 a[208:209], v9 offset:1024
    v_lshlrev_b32 v42, 16, v50
    v_mfma_f32_16x16x32_bf16 v[124:127], a[196:199], a[60:63], v[124:127]
    ds_read_b64_tr_b16 a[210:211], v9 offset:7168
    v_and_b32 v43, 0xffff0000, v50
    v_mfma_f32_16x16x32_bf16 v[116:119], a[196:199], a[56:59], v[116:119]
    buffer_load_dwordx4 a[236:239], v28, s[20:23], s46 offen offset:3072 sc1
    v_mfma_f32_16x16x32_bf16 v[116:119], a[192:195], a[40:43], v[116:119]
    v_sub_f32 v42, v42, v40
    v_sub_f32 v43, v43, v40
    v_mfma_f32_16x16x32_bf16 v[108:111], a[192:195], a[36:39], v[108:111]
    s_add_u32 s46, s45, 77824
    ds_read_b64_tr_b16 a[212:213], v9 offset:13312
    v_cvt_pk_bf16_f32 v44, v42, v43
    v_mfma_f32_16x16x32_bf16 v[108:111], a[196:199], a[52:55], v[108:111]
    s_sub_u32 s77, s46, 81920
    ds_read_b64_tr_b16 a[214:215], v9 offset:19456
    v_lshlrev_b32 v42, 16, v44
    v_mfma_f32_16x16x32_bf16 v[100:103], a[196:199], a[48:51], v[100:103]
    s_min_u32 s46, s46, s77
    v_and_b32 v43, 0xffff0000, v44
    v_mul_f32 v42, v42, v41
    v_mfma_f32_16x16x32_bf16 v[100:103], a[192:195], a[32:35], v[100:103]
    s_waitcnt lgkmcnt(4)
    v_mul_f32 v43, v43, v41
    v_cvt_pk_bf16_f32 v50, v42, v43
    v_mfma_f32_16x16x32_bf16 v[128:131], a[200:203], a[32:35], v[128:131]
    ds_read_b64_tr_b16 a[192:193], v10 offset:1024
    v_lshlrev_b32 v42, 16, v51
    v_mfma_f32_16x16x32_bf16 v[128:131], a[204:207], a[48:51], v[128:131]
    ds_read_b64_tr_b16 a[194:195], v10 offset:7168
    v_and_b32 v43, 0xffff0000, v51
    v_mfma_f32_16x16x32_bf16 v[136:139], a[204:207], a[52:55], v[136:139]
    buffer_load_dwordx4 a[240:243], v28, s[20:23], s46 offen offset:0 sc1
    v_mfma_f32_16x16x32_bf16 v[136:139], a[200:203], a[36:39], v[136:139]
    v_sub_f32 v42, v42, v40
    v_sub_f32 v43, v43, v40
    v_mfma_f32_16x16x32_bf16 v[144:147], a[200:203], a[40:43], v[144:147]
    ds_read_b64_tr_b16 a[196:197], v10 offset:13312
    v_cvt_pk_bf16_f32 v44, v42, v43
    v_mfma_f32_16x16x32_bf16 v[144:147], a[204:207], a[56:59], v[144:147]
    ds_read_b64_tr_b16 a[198:199], v10 offset:19456
    v_lshlrev_b32 v42, 16, v44
    v_mfma_f32_16x16x32_bf16 v[152:155], a[204:207], a[60:63], v[152:155]
    buffer_load_dwordx4 a[244:247], v28, s[20:23], s46 offen offset:1024 sc1
    v_mfma_f32_16x16x32_bf16 v[152:155], a[200:203], a[44:47], v[152:155]
    s_waitcnt lgkmcnt(4)
    v_and_b32 v43, 0xffff0000, v44
    v_mul_f32 v42, v42, v41
    v_mfma_f32_16x16x32_bf16 v[156:159], a[208:211], a[44:47], v[156:159]
    ds_read_b64_tr_b16 a[200:201], v11 offset:1024
    v_mul_f32 v43, v43, v41
    v_mfma_f32_16x16x32_bf16 v[156:159], a[212:215], a[60:63], v[156:159]
    ds_read_b64_tr_b16 a[202:203], v11 offset:7168
    v_cvt_pk_bf16_f32 v51, v42, v43
    v_mfma_f32_16x16x32_bf16 v[148:151], a[212:215], a[56:59], v[148:151]
    v_lshlrev_b32 v42, 16, v52
    v_and_b32 v43, 0xffff0000, v52
    v_mfma_f32_16x16x32_bf16 v[148:151], a[208:211], a[40:43], v[148:151]
    v_sub_f32 v42, v42, v40
    v_sub_f32 v43, v43, v40
    v_mfma_f32_16x16x32_bf16 v[140:143], a[208:211], a[36:39], v[140:143]
    ds_read_b64_tr_b16 a[204:205], v11 offset:13312
    v_cvt_pk_bf16_f32 v44, v42, v43
    v_mfma_f32_16x16x32_bf16 v[140:143], a[212:215], a[52:55], v[140:143]
    ds_read_b64_tr_b16 a[206:207], v11 offset:19456
    v_lshlrev_b32 v42, 16, v44
    v_mfma_f32_16x16x32_bf16 v[132:135], a[212:215], a[48:51], v[132:135]
    buffer_load_dwordx4 a[248:251], v28, s[20:23], s46 offen offset:2048 sc1
    v_mfma_f32_16x16x32_bf16 v[132:135], a[208:211], a[32:35], v[132:135]
    s_waitcnt lgkmcnt(4)
    v_and_b32 v43, 0xffff0000, v44
    v_mul_f32 v42, v42, v41
    v_mfma_f32_16x16x32_bf16 v[160:163], a[192:195], a[32:35], v[160:163]
    ds_read_b64_tr_b16 a[208:209], v8 offset:2048
    v_mul_f32 v43, v43, v41
    v_mfma_f32_16x16x32_bf16 v[160:163], a[196:199], a[48:51], v[160:163]
    ds_read_b64_tr_b16 a[210:211], v8 offset:8192
    v_cvt_pk_bf16_f32 v52, v42, v43
    v_mfma_f32_16x16x32_bf16 v[168:171], a[196:199], a[52:55], v[168:171]
    v_lshlrev_b32 v42, 16, v53
    v_and_b32 v43, 0xffff0000, v53
    v_mfma_f32_16x16x32_bf16 v[168:171], a[192:195], a[36:39], v[168:171]
    buffer_load_dwordx4 a[252:255], v28, s[20:23], s46 offen offset:3072 sc1
    v_mfma_f32_16x16x32_bf16 v[176:179], a[192:195], a[40:43], v[176:179]
    ds_read_b64_tr_b16 a[212:213], v8 offset:14336
    v_sub_f32 v42, v42, v40
    v_mfma_f32_16x16x32_bf16 v[176:179], a[196:199], a[56:59], v[176:179]
    ds_read_b64_tr_b16 a[214:215], v8 offset:20480
    v_sub_f32 v43, v43, v40
    v_mfma_f32_16x16x32_bf16 v[184:187], a[196:199], a[60:63], v[184:187]
    v_cvt_pk_bf16_f32 v44, v42, v43
    v_lshlrev_b32 v42, 16, v44
    v_mfma_f32_16x16x32_bf16 v[184:187], a[192:195], a[44:47], v[184:187]
    s_waitcnt lgkmcnt(4)
    v_and_b32 v43, 0xffff0000, v44
    v_mul_f32 v42, v42, v41
    v_mfma_f32_16x16x32_bf16 v[188:191], a[200:203], a[44:47], v[188:191]
    ds_read_b64_tr_b16 a[192:193], v9 offset:2048
    v_mul_f32 v43, v43, v41
    v_mfma_f32_16x16x32_bf16 v[188:191], a[204:207], a[60:63], v[188:191]
    s_add_u32 m0, s49, 0
    ds_read_b64_tr_b16 a[194:195], v9 offset:8192
    v_cvt_pk_bf16_f32 v53, v42, v43
    v_mfma_f32_16x16x32_bf16 v[180:183], a[204:207], a[56:59], v[180:183]
    buffer_load_dwordx4 v4, s[12:15], s38 offen offset:0 lds
    v_mfma_f32_16x16x32_bf16 v[180:183], a[200:203], a[40:43], v[180:183]
    v_lshlrev_b32 v42, 16, v54
    v_and_b32 v43, 0xffff0000, v54
    v_mfma_f32_16x16x32_bf16 v[172:175], a[200:203], a[36:39], v[172:175]
    ds_read_b64_tr_b16 a[196:197], v9 offset:14336
    v_sub_f32 v42, v42, v40
    v_mfma_f32_16x16x32_bf16 v[172:175], a[204:207], a[52:55], v[172:175]
    ds_read_b64_tr_b16 a[198:199], v9 offset:20480
    v_sub_f32 v43, v43, v40
    v_mfma_f32_16x16x32_bf16 v[164:167], a[204:207], a[48:51], v[164:167]
    v_cvt_pk_bf16_f32 v44, v42, v43
    v_lshlrev_b32 v42, 16, v44
    v_mfma_f32_16x16x32_bf16 v[164:167], a[200:203], a[32:35], v[164:167]
    s_waitcnt lgkmcnt(4)
    v_and_b32 v43, 0xffff0000, v44
    v_mul_f32 v42, v42, v41
    v_mfma_f32_16x16x32_bf16 v[192:195], a[208:211], a[32:35], v[192:195]
    s_add_u32 m0, s49, 896
    ds_read_b64_tr_b16 a[200:201], v10 offset:2048
    v_mul_f32 v43, v43, v41
    v_mfma_f32_16x16x32_bf16 v[192:195], a[212:215], a[48:51], v[192:195]
    ds_read_b64_tr_b16 a[202:203], v10 offset:8192
    v_cvt_pk_bf16_f32 v54, v42, v43
    v_mfma_f32_16x16x32_bf16 v[200:203], a[212:215], a[52:55], v[200:203]
    buffer_load_dwordx4 v4, s[12:15], s38 offen offset:128 lds
    v_mfma_f32_16x16x32_bf16 v[200:203], a[208:211], a[36:39], v[200:203]
    v_lshlrev_b32 v42, 16, v55
    v_and_b32 v43, 0xffff0000, v55
    v_mfma_f32_16x16x32_bf16 v[208:211], a[208:211], a[40:43], v[208:211]
    ds_read_b64_tr_b16 a[204:205], v10 offset:14336
    v_sub_f32 v42, v42, v40
    v_mfma_f32_16x16x32_bf16 v[208:211], a[212:215], a[56:59], v[208:211]
    ds_read_b64_tr_b16 a[206:207], v10 offset:20480
    v_sub_f32 v43, v43, v40
    v_mfma_f32_16x16x32_bf16 v[216:219], a[212:215], a[60:63], v[216:219]
    s_add_u32 m0, s49, 1792
    v_cvt_pk_bf16_f32 v44, v42, v43
    v_lshlrev_b32 v42, 16, v44
    v_mfma_f32_16x16x32_bf16 v[216:219], a[208:211], a[44:47], v[216:219]
    s_waitcnt lgkmcnt(4)
    v_and_b32 v43, 0xffff0000, v44
    v_mul_f32 v42, v42, v41
    v_mfma_f32_16x16x32_bf16 v[220:223], a[192:195], a[44:47], v[220:223]
    ds_read_b64_tr_b16 a[208:209], v11 offset:2048
    v_mul_f32 v43, v43, v41
    v_mfma_f32_16x16x32_bf16 v[220:223], a[196:199], a[60:63], v[220:223]
    ds_read_b64_tr_b16 a[210:211], v11 offset:8192
    v_cvt_pk_bf16_f32 v55, v42, v43
    v_mfma_f32_16x16x32_bf16 v[212:215], a[196:199], a[56:59], v[212:215]
    buffer_load_dwordx4 v4, s[12:15], s38 offen offset:256 lds
    v_mfma_f32_16x16x32_bf16 v[212:215], a[192:195], a[40:43], v[212:215]
    v_lshrrev_b32 v60, 14, v61
    v_and_b32 v61, 0x2000, v61
    v_mfma_f32_16x16x32_bf16 v[204:207], a[192:195], a[36:39], v[204:207]
    s_add_u32 m0, s49, 3072
    ds_read_b64_tr_b16 a[212:213], v11 offset:14336
    v_cmp_ne_u32 s[88:89], 0, v60
    v_mfma_f32_16x16x32_bf16 v[204:207], a[196:199], a[52:55], v[204:207]
    s_waitcnt vmcnt(25)
    ds_read_b64_tr_b16 a[214:215], v11 offset:20480
    v_accvgpr_write_b32 a5, 1.0
    v_mfma_f32_16x16x32_bf16 v[196:199], a[196:199], a[48:51], v[196:199]
    s_barrier
    v_mfma_f32_16x16x32_bf16 v[196:199], a[192:195], a[32:35], v[196:199]
    s_waitcnt lgkmcnt(4)
    buffer_load_dwordx4 v5, s[12:15], s38 offen offset:0 lds
    v_add_u32 v8, 98304, v12
    v_mfma_f32_16x16x32_bf16 v[224:227], a[200:203], a[32:35], v[224:227]
    s_lshr_b64 s[88:89], s[88:89], 12
    ds_read_b64_tr_b16 a[192:193], v8 offset:0
    v_accvgpr_write_b32 a6, 1.0
    v_mfma_f32_16x16x32_bf16 v[224:227], a[204:207], a[48:51], v[224:227]
    s_bcnt1_i32_b64 s93, s[88:89]
    ds_read_b64_tr_b16 a[194:195], v8 offset:6144
    v_cmp_ne_u32 s[88:89], 0, v61
    v_mfma_f32_16x16x32_bf16 v[232:235], a[204:207], a[52:55], v[232:235]
    s_cmp_gt_u32 s93, 26
    s_cselect_b32 s93, -1, 0
    v_accvgpr_write_b32 a7, 1.0
    v_mfma_f32_16x16x32_bf16 v[232:235], a[200:203], a[36:39], v[232:235]
    s_add_u32 m0, s49, 3968
    v_accvgpr_write_b32 a8, 1.0
    v_accvgpr_write_b32 a9, 1.0
    v_mfma_f32_16x16x32_bf16 v[240:243], a[200:203], a[40:43], v[240:243]
    s_xor_b32 s88, s88, s93
    ds_read_b64_tr_b16 a[196:197], v8 offset:12288
    v_accvgpr_write_b32 a10, 1.0
    v_mfma_f32_16x16x32_bf16 v[240:243], a[204:207], a[56:59], v[240:243]
    s_and_b32 s88, s88, 0xfff
    ds_read_b64_tr_b16 a[198:199], v8 offset:18432
    v_accvgpr_write_b32 a11, 1.0
    v_mfma_f32_16x16x32_bf16 v[248:251], a[204:207], a[60:63], v[248:251]
    buffer_load_dwordx4 v5, s[12:15], s38 offen offset:128 lds
    v_mfma_f32_16x16x32_bf16 v[248:251], a[200:203], a[44:47], v[248:251]
    s_waitcnt lgkmcnt(4)
    v_accvgpr_write_b32 a12, 1.0
    v_accvgpr_write_b32 a13, 1.0
    v_add_u32 v9, 98304, v13
    v_mfma_f32_16x16x32_bf16 v[252:255], a[208:211], a[44:47], v[252:255]
    s_lshl_b32 s93, s88, 13
    ds_read_b64_tr_b16 a[200:201], v9 offset:0
    v_accvgpr_write_b32 a14, 1.0
    v_mfma_f32_16x16x32_bf16 v[252:255], a[212:215], a[60:63], v[252:255]
    s_add_u32 m0, s49, 4864
    ds_read_b64_tr_b16 a[202:203], v9 offset:6144
    v_accvgpr_write_b32 a15, 1.0
    v_mfma_f32_16x16x32_bf16 v[244:247], a[212:215], a[56:59], v[244:247]
    buffer_load_dwordx4 v5, s[12:15], s38 offen offset:256 lds
    v_mfma_f32_16x16x32_bf16 v[244:247], a[208:211], a[40:43], v[244:247]
pg_4:
    s_cbranch_execz pg_8
    s_add_u32 s38, s38, 24576
    v_accvgpr_write_b32 a16, 1.0
    v_accvgpr_write_b32 a17, 1.0
    v_mfma_f32_16x16x32_bf16 v[236:239], a[208:211], a[36:39], v[236:239]
    s_add_u32 s88, s51, 8
    ds_read_b64_tr_b16 a[204:205], v9 offset:12288
    v_accvgpr_write_b32 a18, 1.0
    v_mfma_f32_16x16x32_bf16 v[236:239], a[212:215], a[52:55], v[236:239]
    s_waitcnt vmcnt(24)
    s_waitcnt vmcnt(14)
    ds_read_b64_tr_b16 a[206:207], v9 offset:18432
    v_mfma_f32_16x16x32_bf16 v[228:231], a[212:215], a[48:51], v[228:231]
    s_lshr_b32 s88, s93, s88
    v_accvgpr_write_b32 a19, 1.0
    v_accvgpr_write_b32 a20, 1.0
    v_mfma_f32_16x16x32_bf16 v[228:231], a[208:211], a[32:35], v[228:231]
    s_waitcnt lgkmcnt(4)
    v_accvgpr_write_b32 a21, 1.0
    v_accvgpr_write_b32 a22, 1.0
    v_add_u32 v10, 98304, v14
    v_mfma_f32_16x16x32_bf16 v[64:67], a[192:195], a[64:67], v[64:67]
    s_add_u32 m0, s49, 24576
    ds_read_b64_tr_b16 a[208:209], v10 offset:0
    v_accvgpr_write_b32 a23, 1.0
    v_mfma_f32_16x16x32_bf16 v[64:67], a[196:199], a[80:83], v[64:67]
    s_and_b32 s88, s88, 0x2000
    ds_read_b64_tr_b16 a[210:211], v10 offset:6144
    v_accvgpr_write_b32 a24, 1.0
    v_mfma_f32_16x16x32_bf16 v[72:75], a[196:199], a[84:87], v[72:75]
    s_add_u32 s5, s5, s88
    ds_read_b64_tr_b16 v[32:33], v25 offset:0
    v_accvgpr_write_b32 a25, 1.0
    v_mfma_f32_16x16x32_bf16 v[72:75], a[192:195], a[68:71], v[72:75]
    s_lshl_b32 s88, s52, 15
    ds_read_b64_tr_b16 v[34:35], v25 offset:4096
    v_accvgpr_write_b32 a26, 1.0
    v_mfma_f32_16x16x32_bf16 v[80:83], a[192:195], a[72:75], v[80:83]
    s_lshl_b32 s89, s53, 9
    ds_read_b64_tr_b16 a[212:213], v10 offset:12288
    v_accvgpr_write_b32 a27, 1.0
    v_mfma_f32_16x16x32_bf16 v[80:83], a[196:199], a[88:91], v[80:83]
    s_add_u32 s88, s88, s89
    ds_read_b64_tr_b16 a[214:215], v10 offset:18432
    v_accvgpr_write_b32 a28, 1.0
    v_mfma_f32_16x16x32_bf16 v[88:91], a[196:199], a[92:95], v[88:91]
    s_lshl_b32 s89, s3, 7
    ds_read_b64_tr_b16 v[36:37], v25 offset:1024
    v_accvgpr_write_b32 a29, 1.0
    v_mfma_f32_16x16x32_bf16 v[88:91], a[192:195], a[76:79], v[88:91]
    s_waitcnt lgkmcnt(4)
    buffer_load_dwordx4 v4, s[12:15], s38 offen offset:0 lds
    v_add_u32 v11, 98304, v15
    v_mfma_f32_16x16x32_bf16 v[92:95], a[200:203], a[76:79], v[92:95]
    s_add_u32 m0, s49, 25472
    ds_read_b64_tr_b16 a[192:193], v11 offset:0
    v_accvgpr_write_b32 a30, 1.0
    v_mfma_f32_16x16x32_bf16 v[92:95], a[204:207], a[92:95], v[92:95]
    s_add_u32 s88, s88, s89
    ds_read_b64_tr_b16 a[194:195], v11 offset:6144
    v_accvgpr_write_b32 a31, 1.0
    v_mfma_f32_16x16x32_bf16 v[84:87], a[204:207], a[88:91], v[84:87]
    s_add_u32 s88, s88, 4456452
    ds_read_b64_tr_b16 v[38:39], v25 offset:5120
    v_accvgpr_write_b32 a32, 1.0
    v_mfma_f32_16x16x32_bf16 v[84:87], a[200:203], a[72:75], v[84:87]
    s_lshr_b32 s89, s93, 8
    ds_read_b64_tr_b16 v[40:41], v25 offset:8192
    v_lshrrev_b32 v60, v1, s89
    v_mfma_f32_16x16x32_bf16 v[76:79], a[200:203], a[68:71], v[76:79]
    ds_read_b64_tr_b16 a[196:197], v11 offset:12288
    v_and_b32 v60, 0x2000, v60
    v_mfma_f32_16x16x32_bf16 v[76:79], a[204:207], a[84:87], v[76:79]
    ds_read_b64_tr_b16 a[198:199], v11 offset:18432
    v_add_u32 v60, s88, v60
    v_mfma_f32_16x16x32_bf16 v[68:71], a[204:207], a[80:83], v[68:71]
    ds_read_b64_tr_b16 v[42:43], v25 offset:12288
    v_bfe_u32 v61, v1, 1, 1
    v_mfma_f32_16x16x32_bf16 v[68:71], a[200:203], a[64:67], v[68:71]
    s_waitcnt lgkmcnt(4)
    buffer_load_dwordx4 v4, s[12:15], s38 offen offset:128 lds
    v_mfma_f32_16x16x32_bf16 v[96:99], a[208:211], a[64:67], v[96:99]
    s_add_u32 m0, s49, 26368
    ds_read_b64_tr_b16 a[200:201], v8 offset:1024
    v_lshl_add_u32 v60, v61, 14, v60
    v_mfma_f32_16x16x32_bf16 v[96:99], a[212:215], a[80:83], v[96:99]
    ds_read_b64_tr_b16 a[202:203], v8 offset:7168
    v_and_b32 v61, 1, v1
    v_mfma_f32_16x16x32_bf16 v[104:107], a[212:215], a[84:87], v[104:107]
    ds_read_b64_tr_b16 v[44:45], v25 offset:9216
    v_lshl_add_u32 v60, v61, 12, v60
    v_mfma_f32_16x16x32_bf16 v[104:107], a[208:211], a[68:71], v[104:107]
    ds_read_b64_tr_b16 v[46:47], v25 offset:13312
    v_lshrrev_b32 v61, 2, v1
    v_mfma_f32_16x16x32_bf16 v[112:115], a[208:211], a[72:75], v[112:115]
    ds_read_b64_tr_b16 a[204:205], v8 offset:13312
    v_min_u32 v61, 1, v61
    v_mfma_f32_16x16x32_bf16 v[112:115], a[212:215], a[88:91], v[112:115]
    ds_read_b64_tr_b16 a[206:207], v8 offset:19456
    v_lshl_or_b32 v60, v61, 30, v60
    v_mfma_f32_16x16x32_bf16 v[120:123], a[212:215], a[92:95], v[120:123]
    buffer_load_dwordx4 v4, s[12:15], s38 offen offset:256 lds
    v_accvgpr_write_b32 a223, v60
    v_mfma_f32_16x16x32_bf16 v[120:123], a[208:211], a[76:79], v[120:123]
    s_waitcnt lgkmcnt(4)
    v_accvgpr_write_b32 a33, 1.0
    v_accvgpr_write_b32 a34, 1.0
    v_mfma_f32_16x16x32_bf16 v[124:127], a[192:195], a[76:79], v[124:127]
    s_add_u32 m0, s49, 27648
    ds_read_b64_tr_b16 a[208:209], v9 offset:1024
    v_accvgpr_write_b32 a35, 1.0
    v_mfma_f32_16x16x32_bf16 v[124:127], a[196:199], a[92:95], v[124:127]
    s_mul_hi_u32 s47, s58, 429496730
    ds_read_b64_tr_b16 a[210:211], v9 offset:7168
    v_accvgpr_write_b32 a36, 1.0
    v_mfma_f32_16x16x32_bf16 v[116:119], a[196:199], a[88:91], v[116:119]
    buffer_load_dwordx4 v5, s[12:15], s38 offen offset:0 lds
    v_mfma_f32_16x16x32_bf16 v[116:119], a[192:195], a[72:75], v[116:119]
    s_add_u32 m0, s49, 28544
    v_accvgpr_write_b32 a37, 1.0
    v_accvgpr_write_b32 a38, 1.0
    v_mfma_f32_16x16x32_bf16 v[108:111], a[192:195], a[68:71], v[108:111]
    s_lshl_b32 s37, s47, 8
    ds_read_b64_tr_b16 a[212:213], v9 offset:13312
    v_accvgpr_write_b32 a39, 1.0
    v_mfma_f32_16x16x32_bf16 v[108:111], a[196:199], a[84:87], v[108:111]
    s_add_u32 s37, s37, 4718736
    ds_read_b64_tr_b16 a[214:215], v9 offset:19456
    v_accvgpr_write_b32 a40, 1.0
    v_mfma_f32_16x16x32_bf16 v[100:103], a[196:199], a[80:83], v[100:103]
    buffer_load_dwordx4 v5, s[12:15], s38 offen offset:128 lds
    v_mfma_f32_16x16x32_bf16 v[100:103], a[192:195], a[64:67], v[100:103]
    s_waitcnt lgkmcnt(4)
    v_accvgpr_write_b32 a41, 1.0
    v_accvgpr_write_b32 a42, 1.0
    v_mfma_f32_16x16x32_bf16 v[128:131], a[200:203], a[64:67], v[128:131]
    s_add_u32 m0, s49, 29440
    ds_read_b64_tr_b16 a[192:193], v10 offset:1024
    v_accvgpr_write_b32 a43, 1.0
    v_mfma_f32_16x16x32_bf16 v[128:131], a[204:207], a[80:83], v[128:131]
    s_mov_b32 s32, s82
    ds_read_b64_tr_b16 a[194:195], v10 offset:7168
    v_accvgpr_write_b32 a44, 1.0
    v_mfma_f32_16x16x32_bf16 v[136:139], a[204:207], a[84:87], v[136:139]
    v_mfma_f32_16x16x32_bf16 v[20:23], v[48:51], v[32:35], 0
    v_mfma_f32_16x16x32_bf16 v[58:61], v[48:51], v[36:39], 0
    v_mfma_f32_16x16x32_bf16 v[20:23], v[52:55], v[40:43], v[20:23]
    v_mfma_f32_16x16x32_bf16 v[58:61], v[52:55], v[44:47], v[58:61]
    v_mfma_f32_16x16x32_bf16 v[136:139], a[200:203], a[68:71], v[136:139]
    buffer_load_dwordx4 v5, s[12:15], s38 offen offset:256 lds
    v_mfma_f32_16x16x32_bf16 v[144:147], a[200:203], a[72:75], v[144:147]
    s_add_u32 s38, s38, 24576
    ds_read_b64_tr_b16 a[196:197], v10 offset:13312
    v_accvgpr_write_b32 a45, 1.0
    v_mfma_f32_16x16x32_bf16 v[144:147], a[204:207], a[88:91], v[144:147]
    s_and_b32 s33, s83, 0xffff
    ds_read_b64_tr_b16 a[198:199], v10 offset:19456
    v_accvgpr_write_b32 a46, 1.0
    v_mfma_f32_16x16x32_bf16 v[152:155], a[204:207], a[92:95], v[152:155]
    s_mov_b32 s34, 1966080
    v_accvgpr_write_b32 a47, 1.0
    v_accvgpr_write_b32 a48, 1.0
    v_mfma_f32_16x16x32_bf16 v[152:155], a[200:203], a[76:79], v[152:155]
    s_waitcnt lgkmcnt(4)
    v_accvgpr_write_b32 a49, 1.0
    v_accvgpr_write_b32 a50, 1.0
    v_mfma_f32_16x16x32_bf16 v[156:159], a[208:211], a[76:79], v[156:159]
    s_add_u32 m0, s49, 73728
    ds_read_b64_tr_b16 a[200:201], v11 offset:1024
    v_accvgpr_write_b32 a51, 1.0
    v_mfma_f32_16x16x32_bf16 v[156:159], a[212:215], a[92:95], v[156:159]
    s_mov_b32 s35, 0x00020000
    ds_read_b64_tr_b16 a[202:203], v11 offset:7168
    v_accvgpr_write_b32 a52, 1.0
    v_mfma_f32_16x16x32_bf16 v[148:151], a[212:215], a[88:91], v[148:151]
    buffer_load_dwordx4 v6, s[16:19], s40 offen offset:0 lds
    v_mfma_f32_16x16x32_bf16 v[148:151], a[208:211], a[72:75], v[148:151]
    s_mul_i32 s60, s47, 80640
    v_accvgpr_write_b32 a53, 1.0
    v_accvgpr_write_b32 a54, 1.0
    v_mfma_f32_16x16x32_bf16 v[140:143], a[208:211], a[68:71], v[140:143]
    s_lshl_b32 s56, s58, 7
    ds_read_b64_tr_b16 a[204:205], v11 offset:13312
    v_accvgpr_write_b32 a55, 1.0
    v_mfma_f32_16x16x32_bf16 v[140:143], a[212:215], a[84:87], v[140:143]
    s_add_u32 m0, s49, 74624
    ds_read_b64_tr_b16 a[206:207], v11 offset:19456
    v_accvgpr_write_b32 a56, 1.0
    v_mfma_f32_16x16x32_bf16 v[132:135], a[212:215], a[80:83], v[132:135]
    buffer_load_dwordx4 v6, s[16:19], s40 offen offset:128 lds
    v_mfma_f32_16x16x32_bf16 v[132:135], a[208:211], a[64:67], v[132:135]
    s_waitcnt lgkmcnt(4)
    v_accvgpr_write_b32 a57, 1.0
    v_accvgpr_write_b32 a58, 1.0
    v_mfma_f32_16x16x32_bf16 v[160:163], a[192:195], a[64:67], v[160:163]
    s_add_u32 s60, s60, s56
    ds_read_b64_tr_b16 a[208:209], v8 offset:2048
    v_accvgpr_write_b32 a59, 1.0
    v_mfma_f32_16x16x32_bf16 v[160:163], a[196:199], a[80:83], v[160:163]
    s_mul_i32 s56, s53, 983040
    ds_read_b64_tr_b16 a[210:211], v8 offset:8192
    v_accvgpr_write_b32 a60, 1.0
    v_mfma_f32_16x16x32_bf16 v[168:171], a[196:199], a[84:87], v[168:171]
    s_add_u32 s28, s72, s56
    s_addc_u32 s29, s73, 0
    v_accvgpr_write_b32 a61, 1.0
    v_mfma_f32_16x16x32_bf16 v[168:171], a[192:195], a[68:71], v[168:171]
    s_and_b32 s29, s29, 0xffff
    v_accvgpr_write_b32 a62, 1.0
    v_accvgpr_write_b32 a63, 1.0
    v_mfma_f32_16x16x32_bf16 v[176:179], a[192:195], a[72:75], v[176:179]
    s_add_u32 m0, s49, 75520
    ds_read_b64_tr_b16 a[212:213], v8 offset:14336
    v_mov_b32 v22, v58
    v_mfma_f32_16x16x32_bf16 v[176:179], a[196:199], a[88:91], v[176:179]
    s_mov_b32 s30, 983040
    ds_read_b64_tr_b16 a[214:215], v8 offset:20480
    v_mov_b32 v23, v59
    v_mfma_f32_16x16x32_bf16 v[184:187], a[196:199], a[92:95], v[184:187]
    buffer_store_dwordx4 v[20:23], v26, s[24:27], s62 offen sc1
    v_mfma_f32_16x16x32_bf16 v[184:187], a[192:195], a[76:79], v[184:187]
    s_waitcnt lgkmcnt(4)
    buffer_load_dwordx4 v6, s[16:19], s40 offen offset:256 lds
    v_mfma_f32_16x16x32_bf16 v[188:191], a[200:203], a[76:79], v[188:191]
    s_mov_b32 s31, 0x00020000
    ds_read_b64_tr_b16 a[192:193], v9 offset:2048
    v_mov_b32 v32, 0xc0933333
    v_mfma_f32_16x16x32_bf16 v[188:191], a[204:207], a[92:95], v[188:191]
    s_lshr_b32 s48, s2, 3
    ds_read_b64_tr_b16 a[194:195], v9 offset:8192
    v_mov_b32 v33, 0xc0933333
    v_mfma_f32_16x16x32_bf16 v[180:183], a[204:207], a[88:91], v[180:183]
    s_add_u32 m0, s49, 76800
    v_mov_b32 v34, 0xc0933333
    v_mov_b32 v35, 0xc0933333
    v_mfma_f32_16x16x32_bf16 v[180:183], a[200:203], a[72:75], v[180:183]
    buffer_load_dwordx4 v7, s[16:19], s40 offen offset:0 lds
    v_mfma_f32_16x16x32_bf16 v[172:175], a[200:203], a[68:71], v[172:175]
    s_lshl_b32 s48, s48, 2
    ds_read_b64_tr_b16 a[196:197], v9 offset:14336
    v_mov_b32 v36, 0xc0933333
    v_mfma_f32_16x16x32_bf16 v[172:175], a[204:207], a[84:87], v[172:175]
    s_add_u32 s48, s48, s3
    ds_read_b64_tr_b16 a[198:199], v9 offset:20480
    v_mov_b32 v37, 0xc0933333
    v_mfma_f32_16x16x32_bf16 v[164:167], a[204:207], a[80:83], v[164:167]
    s_mul_i32 s6, s48, 7680
    v_lshlrev_b32 v16, 7, v16
    v_mov_b32 v38, 0xc0933333
    v_mfma_f32_16x16x32_bf16 v[164:167], a[200:203], a[64:67], v[164:167]
    s_waitcnt lgkmcnt(4)
    v_mov_b32 v39, 0xc0933333
    v_mov_b32 v40, 0xc0933333
    v_mfma_f32_16x16x32_bf16 v[192:195], a[208:211], a[64:67], v[192:195]
    s_lshl_b32 s57, s51, 8
    ds_read_b64_tr_b16 a[200:201], v10 offset:2048
    v_mov_b32 v41, 0xc0933333
    v_mfma_f32_16x16x32_bf16 v[192:195], a[212:215], a[80:83], v[192:195]
    s_add_u32 m0, s49, 77696
    ds_read_b64_tr_b16 a[202:203], v10 offset:8192
    v_mov_b32 v42, 0xc0933333
    v_mfma_f32_16x16x32_bf16 v[200:203], a[212:215], a[84:87], v[200:203]
    buffer_load_dwordx4 v7, s[16:19], s40 offen offset:128 lds
    v_mfma_f32_16x16x32_bf16 v[200:203], a[208:211], a[68:71], v[200:203]
    s_add_u32 s56, s56, s57
    v_mov_b32 v43, 0xc0933333
    v_mov_b32 v44, 0xc0933333
    v_mfma_f32_16x16x32_bf16 v[208:211], a[208:211], a[72:75], v[208:211]
    s_lshr_b32 s63, s51, 1
    ds_read_b64_tr_b16 a[204:205], v10 offset:14336
    v_mov_b32 v45, 0xc0933333
    v_mfma_f32_16x16x32_bf16 v[208:211], a[212:215], a[88:91], v[208:211]
    s_lshl_b32 s63, s63, 7
    ds_read_b64_tr_b16 a[206:207], v10 offset:20480
    v_mov_b32 v46, 0xc0933333
    v_mfma_f32_16x16x32_bf16 v[216:219], a[212:215], a[92:95], v[216:219]
    s_add_u32 s63, s63, 768
    v_mov_b32 v47, 0xc0933333
    v_add_u32 v8, 122880, v12
    v_mfma_f32_16x16x32_bf16 v[216:219], a[208:211], a[76:79], v[216:219]
    s_waitcnt lgkmcnt(4)
    v_add_u32 v9, 122880, v13
    v_lshrrev_b32 v60, 2, v1
    v_mfma_f32_16x16x32_bf16 v[220:223], a[192:195], a[76:79], v[220:223]
    s_add_u32 m0, s49, 78592
    ds_read_b64_tr_b16 a[208:209], v11 offset:2048
    v_min_u32 v60, 9, v60
    v_mfma_f32_16x16x32_bf16 v[220:223], a[196:199], a[92:95], v[220:223]
    s_sub_u32 s63, s63, s57
    ds_read_b64_tr_b16 a[210:211], v11 offset:8192
    v_mul_u32_u24 v60, 6144, v60
    v_mfma_f32_16x16x32_bf16 v[212:215], a[196:199], a[88:91], v[212:215]
    buffer_load_dwordx4 v7, s[16:19], s40 offen offset:256 lds
    v_mfma_f32_16x16x32_bf16 v[212:215], a[192:195], a[72:75], v[212:215]
    s_add_u32 s40, s40, 24576
    v_and_b32 v61, 3, v1
    v_lshl_add_u32 v60, v61, 2, v60
    v_mfma_f32_16x16x32_bf16 v[204:207], a[192:195], a[68:71], v[204:207]
    s_mov_b32 s66, 0
    ds_read_b64_tr_b16 a[212:213], v11 offset:14336
    v_add_u32 v10, 122880, v14
    v_mfma_f32_16x16x32_bf16 v[204:207], a[196:199], a[84:87], v[204:207]
    s_waitcnt vmcnt(31)
    ds_read_b64_tr_b16 a[214:215], v11 offset:20480
    s_sub_u32 s57, 7864320, s56
    v_mfma_f32_16x16x32_bf16 v[196:199], a[196:199], a[80:83], v[196:199]
    s_barrier
    v_mfma_f32_16x16x32_bf16 v[196:199], a[192:195], a[64:67], v[196:199]
    s_waitcnt lgkmcnt(4)
    v_add_u32 v11, 122880, v15
    s_add_u32 s8, s72, s56
    s_addc_u32 s9, s73, 0
    v_mfma_f32_16x16x32_bf16 v[224:227], a[200:203], a[64:67], v[224:227]
    s_and_b32 s9, s9, 0xffff
    ds_read_b64_tr_b16 a[192:193], v8 offset:0
    s_mov_b32 s10, s57
    v_mfma_f32_16x16x32_bf16 v[224:227], a[204:207], a[80:83], v[224:227]
    s_mov_b32 s11, 0x00020000
    ds_read_b64_tr_b16 a[194:195], v8 offset:6144
    s_mul_i32 s36, s51, 245760
    v_mfma_f32_16x16x32_bf16 v[232:235], a[204:207], a[84:87], v[232:235]
    s_mul_i32 s56, s3, 20480
    s_add_u32 s36, s36, s56
    s_lshl_b32 s59, s53, 23
    v_mfma_f32_16x16x32_bf16 v[232:235], a[200:203], a[68:71], v[232:235]
    s_add_u32 s59, s59, 67108864
    s_add_u32 s20, s86, s59
    s_addc_u32 s21, s87, 0
    v_mfma_f32_16x16x32_bf16 v[240:243], a[200:203], a[72:75], v[240:243]
    s_and_b32 s21, s21, 0xffff
    ds_read_b64_tr_b16 a[196:197], v8 offset:12288
    s_mov_b32 s22, 8388608
    v_mfma_f32_16x16x32_bf16 v[240:243], a[204:207], a[88:91], v[240:243]
    s_mov_b32 s23, 0x00020000
    ds_read_b64_tr_b16 a[198:199], v8 offset:18432
    s_add_u32 s55, s51, 8
    v_mfma_f32_16x16x32_bf16 v[248:251], a[204:207], a[92:95], v[248:251]
    s_lshr_b32 s55, s93, s55
    s_and_b32 s55, s55, 0x2000
    s_lshl_b32 s59, s54, 16
    v_mfma_f32_16x16x32_bf16 v[248:251], a[200:203], a[76:79], v[248:251]
    s_waitcnt lgkmcnt(4)
    s_or_b32 s55, s55, s59
    s_and_b32 s59, s3, 1
    v_mfma_f32_16x16x32_bf16 v[252:255], a[208:211], a[76:79], v[252:255]
    s_lshl_b32 s59, s59, 14
    ds_read_b64_tr_b16 a[200:201], v9 offset:0
    s_or_b32 s55, s55, s59
    v_mfma_f32_16x16x32_bf16 v[252:255], a[212:215], a[92:95], v[252:255]
    s_mul_i32 s59, s51, 0x202000
    ds_read_b64_tr_b16 a[202:203], v9 offset:6144
    s_and_b32 s59, s59, 6299648
    v_mfma_f32_16x16x32_bf16 v[244:247], a[212:215], a[88:91], v[244:247]
    s_xor_b32 s55, s55, s59
    v_lshlrev_b32 v2, 7, v1
    v_and_b32 v3, 3, v1
    v_mfma_f32_16x16x32_bf16 v[244:247], a[208:211], a[72:75], v[244:247]
    v_lshlrev_b32 v3, 11, v3
    v_lshlrev_b32 v28, 4, v1
    v_mfma_f32_16x16x32_bf16 v[236:239], a[208:211], a[68:71], v[236:239]
    ds_read_b64_tr_b16 a[204:205], v9 offset:12288
    v_mov_b32 v31, v16
    v_mfma_f32_16x16x32_bf16 v[236:239], a[212:215], a[84:87], v[236:239]
    s_waitcnt vmcnt(23)
    s_waitcnt vmcnt(19)
    ds_read_b64_tr_b16 a[206:207], v9 offset:18432
    v_mfma_f32_16x16x32_bf16 v[228:231], a[212:215], a[80:83], v[228:231]
    s_mov_b32 s41, s49
    s_add_u32 s42, s49, 24576
    s_add_u32 s43, s49, 49152
    v_mfma_f32_16x16x32_bf16 v[228:231], a[208:211], a[64:67], v[228:231]
    s_waitcnt lgkmcnt(4)
    s_mov_b32 s45, 6
    s_sub_u32 s56, 73728, s49
    v_mfma_f32_16x16x32_bf16 v[64:67], a[192:195], a[224:227], v[64:67]
    ds_read_b64_tr_b16 a[208:209], v10 offset:0
    v_add_u32 v16, s49, v18
    v_mfma_f32_16x16x32_bf16 v[64:67], a[196:199], a[240:243], v[64:67]
    ds_read_b64_tr_b16 a[210:211], v10 offset:6144
    v_add_u32 v17, s49, v19
    v_mfma_f32_16x16x32_bf16 v[72:75], a[196:199], a[244:247], v[72:75]
    v_add_u32 v12, s56, v12
    v_add_u32 v13, s56, v13
    v_mfma_f32_16x16x32_bf16 v[72:75], a[192:195], a[228:231], v[72:75]
    v_add_u32 v14, s56, v14
    v_add_u32 v15, s56, v15
    v_mfma_f32_16x16x32_bf16 v[80:83], a[192:195], a[232:235], v[80:83]
    ds_read_b64_tr_b16 a[212:213], v10 offset:12288
    v_mov_b32 v30, 0x47800000
    v_mfma_f32_16x16x32_bf16 v[80:83], a[196:199], a[248:251], v[80:83]
    ds_read_b64_tr_b16 a[214:215], v10 offset:18432
    v_mov_b32 v20, 0
    v_mfma_f32_16x16x32_bf16 v[88:91], a[196:199], a[252:255], v[88:91]
    v_mov_b32 v21, 0
    v_mov_b32 v22, 0
    v_mfma_f32_16x16x32_bf16 v[88:91], a[192:195], a[236:239], v[88:91]
    s_waitcnt lgkmcnt(4)
    v_mov_b32 v23, 0
    v_mov_b32 v56, 0x3c000000
    v_mfma_f32_16x16x32_bf16 v[92:95], a[200:203], a[236:239], v[92:95]
    ds_read_b64_tr_b16 a[192:193], v11 offset:0
    v_accvgpr_write_b32 a64, 1.0
    v_mfma_f32_16x16x32_bf16 v[92:95], a[204:207], a[252:255], v[92:95]
    ds_read_b64_tr_b16 a[194:195], v11 offset:6144
    v_accvgpr_write_b32 a65, 1.0
    v_mfma_f32_16x16x32_bf16 v[84:87], a[204:207], a[248:251], v[84:87]
    s_getpc_b64 s[74:75]
ct3:
    s_add_u32 s74, s74, at_switch-ct3
    s_addc_u32 s75, s75, 0
    global_load_dword a222, v2, s[74:75]
    v_mfma_f32_16x16x32_bf16 v[84:87], a[200:203], a[232:235], v[84:87]
    v_min_u32 v2, 15, v1
    v_mfma_f32_16x16x32_bf16 v[76:79], a[200:203], a[228:231], v[76:79]
    s_lshl_b32 s59, s3, 4
    ds_read_b64_tr_b16 a[196:197], v11 offset:12288
    v_add_u32 v2, s59, v2
    v_mfma_f32_16x16x32_bf16 v[76:79], a[204:207], a[244:247], v[76:79]
    ds_read_b64_tr_b16 a[198:199], v11 offset:18432
    v_mul_u32_u24 v2, 1280, v2
    v_mfma_f32_16x16x32_bf16 v[68:71], a[204:207], a[240:243], v[68:71]
    buffer_load_dword a217, v2, s[32:35], s60 offen
    v_mfma_f32_16x16x32_bf16 v[68:71], a[200:203], a[224:227], v[68:71]
    s_waitcnt lgkmcnt(4)
    v_and_b32 v2, 1, v1
    v_lshlrev_b32 v2, 7, v2
    v_mfma_f32_16x16x32_bf16 v[96:99], a[208:211], a[224:227], v[96:99]
    s_lshl_b32 s59, s48, 8
    ds_read_b64_tr_b16 a[200:201], v8 offset:1024
    v_add_u32 v2, s59, v2
    v_mfma_f32_16x16x32_bf16 v[96:99], a[212:215], a[240:243], v[96:99]
    ds_read_b64_tr_b16 a[202:203], v8 offset:7168
    v_accvgpr_write_b32 a66, 1.0
    v_mfma_f32_16x16x32_bf16 v[104:107], a[212:215], a[244:247], v[104:107]
    v_accvgpr_write_b32 a67, 1.0
    v_mfma_f32_16x16x32_bf16 v[104:107], a[208:211], a[228:231], v[104:107]
    v_accvgpr_write_b32 a68, 1.0
    v_mfma_f32_16x16x32_bf16 v[112:115], a[208:211], a[232:235], v[112:115]
    ds_read_b64_tr_b16 a[204:205], v8 offset:13312
    v_accvgpr_write_b32 a69, 1.0
    v_mfma_f32_16x16x32_bf16 v[112:115], a[212:215], a[248:251], v[112:115]
    ds_read_b64_tr_b16 a[206:207], v8 offset:19456
    v_cvt_pk_bf16_f32 v64, v64, v65
    v_mfma_f32_16x16x32_bf16 v[120:123], a[212:215], a[252:255], v[120:123]
    s_getpc_b64 s[74:75]
ct4:
    s_add_u32 s74, s74, tail_code-ct4
    s_addc_u32 s75, s75, 0
    global_load_dword a218, v2, s[74:75]
    v_mfma_f32_16x16x32_bf16 v[120:123], a[208:211], a[236:239], v[120:123]
    s_waitcnt lgkmcnt(4)
    v_and_b32 v31, 3, v1
    v_lshlrev_b32 v31, 7, v31
    v_mfma_f32_16x16x32_bf16 v[124:127], a[192:195], a[236:239], v[124:127]
    s_lshl_b32 s59, s48, 9
    ds_read_b64_tr_b16 a[208:209], v9 offset:1024
    v_cvt_pk_bf16_f32 v65, v66, v67
    v_mfma_f32_16x16x32_bf16 v[124:127], a[196:199], a[252:255], v[124:127]
    s_and_b32 s59, s59, 0x7fff
    ds_read_b64_tr_b16 a[210:211], v9 offset:7168
    v_add_u32 v31, s59, v31
    v_mfma_f32_16x16x32_bf16 v[116:119], a[196:199], a[248:251], v[116:119]
    v_min_u32 v2, 11, v1
    v_lshlrev_b32 v2, 7, v2
    v_mfma_f32_16x16x32_bf16 v[116:119], a[192:195], a[232:235], v[116:119]
    v_cvt_pk_bf16_f32 v66, v68, v69
    v_cvt_pk_bf16_f32 v67, v70, v71
    v_mfma_f32_16x16x32_bf16 v[108:111], a[192:195], a[228:231], v[108:111]
    ds_read_b64_tr_b16 a[212:213], v9 offset:13312
    v_cvt_pk_bf16_f32 v72, v72, v73
    v_mfma_f32_16x16x32_bf16 v[108:111], a[196:199], a[244:247], v[108:111]
    ds_read_b64_tr_b16 a[214:215], v9 offset:19456
    v_cvt_pk_bf16_f32 v73, v74, v75
    v_mfma_f32_16x16x32_bf16 v[100:103], a[196:199], a[240:243], v[100:103]
    s_and_b32 s88, s3, 1
    v_permlane16_swap_b32 v64, v66
    v_mfma_f32_16x16x32_bf16 v[100:103], a[192:195], a[224:227], v[100:103]
    s_waitcnt lgkmcnt(4)
    v_permlane16_swap_b32 v65, v67
    v_mfma_f32_16x16x32_bf16 v[128:131], a[200:203], a[224:227], v[128:131]
    s_mul_i32 s88, s88, 20480
    ds_read_b64_tr_b16 a[192:193], v10 offset:1024
    v_cvt_pk_bf16_f32 v74, v76, v77
    v_mfma_f32_16x16x32_bf16 v[128:131], a[204:207], a[240:243], v[128:131]
    s_add_u32 s89, s51, 0
    ds_read_b64_tr_b16 a[194:195], v10 offset:7168
    v_cvt_pk_bf16_f32 v75, v78, v79
    v_mfma_f32_16x16x32_bf16 v[136:139], a[204:207], a[244:247], v[136:139]
    s_and_b32 s89, s89, 3
    v_permlane16_swap_b32 v72, v74
    v_mfma_f32_16x16x32_bf16 v[136:139], a[200:203], a[228:231], v[136:139]
    s_mul_i32 s89, s89, 245760
    v_permlane16_swap_b32 v73, v75
    v_mfma_f32_16x16x32_bf16 v[144:147], a[200:203], a[232:235], v[144:147]
    s_add_u32 s32, s89, s88
    ds_read_b64_tr_b16 a[196:197], v10 offset:13312
    v_cvt_pk_bf16_f32 v80, v80, v81
    v_mfma_f32_16x16x32_bf16 v[144:147], a[204:207], a[248:251], v[144:147]
    s_add_u32 s89, s51, 1
    ds_read_b64_tr_b16 a[198:199], v10 offset:19456
    v_cvt_pk_bf16_f32 v81, v82, v83
    v_mfma_f32_16x16x32_bf16 v[152:155], a[204:207], a[252:255], v[152:155]
    s_and_b32 s89, s89, 3
    v_cvt_pk_bf16_f32 v82, v84, v85
    v_cvt_pk_bf16_f32 v83, v86, v87
    v_mfma_f32_16x16x32_bf16 v[152:155], a[200:203], a[236:239], v[152:155]
    s_waitcnt lgkmcnt(4)
    v_permlane16_swap_b32 v80, v82
    v_mfma_f32_16x16x32_bf16 v[156:159], a[208:211], a[236:239], v[156:159]
    s_mul_i32 s89, s89, 245760
    ds_read_b64_tr_b16 a[200:201], v11 offset:1024
    v_cvt_pk_bf16_f32 v88, v88, v89
    v_mfma_f32_16x16x32_bf16 v[156:159], a[212:215], a[252:255], v[156:159]
    s_add_u32 s33, s89, s88
    ds_read_b64_tr_b16 a[202:203], v11 offset:7168
    v_cvt_pk_bf16_f32 v89, v90, v91
    v_mfma_f32_16x16x32_bf16 v[148:151], a[212:215], a[248:251], v[148:151]
    s_add_u32 s89, s51, 2
    v_permlane16_swap_b32 v81, v83
    v_mfma_f32_16x16x32_bf16 v[148:151], a[208:211], a[232:235], v[148:151]
    s_and_b32 s89, s89, 3
    v_cvt_pk_bf16_f32 v90, v92, v93
    v_cvt_pk_bf16_f32 v91, v94, v95
    v_mfma_f32_16x16x32_bf16 v[140:143], a[208:211], a[228:231], v[140:143]
    s_mul_i32 s89, s89, 245760
    ds_read_b64_tr_b16 a[204:205], v11 offset:13312
    v_cvt_pk_bf16_f32 v96, v96, v97
    v_mfma_f32_16x16x32_bf16 v[140:143], a[212:215], a[244:247], v[140:143]
    s_add_u32 s34, s89, s88
    ds_read_b64_tr_b16 a[206:207], v11 offset:19456
    v_cvt_pk_bf16_f32 v97, v98, v99
    v_mfma_f32_16x16x32_bf16 v[132:135], a[212:215], a[240:243], v[132:135]
    s_add_u32 s89, s51, 3
    v_permlane16_swap_b32 v88, v90
    v_mfma_f32_16x16x32_bf16 v[132:135], a[208:211], a[224:227], v[132:135]
    s_waitcnt lgkmcnt(4)
    v_permlane16_swap_b32 v89, v91
    v_mfma_f32_16x16x32_bf16 v[160:163], a[192:195], a[224:227], v[160:163]
    s_and_b32 s89, s89, 3
    ds_read_b64_tr_b16 a[208:209], v8 offset:2048
    v_cvt_pk_bf16_f32 v98, v100, v101
    v_mfma_f32_16x16x32_bf16 v[160:163], a[196:199], a[240:243], v[160:163]
    s_mul_i32 s89, s89, 245760
    ds_read_b64_tr_b16 a[210:211], v8 offset:8192
    v_cvt_pk_bf16_f32 v99, v102, v103
    v_mfma_f32_16x16x32_bf16 v[168:171], a[196:199], a[244:247], v[168:171]
    s_add_u32 s35, s89, s88
    v_permlane16_swap_b32 v96, v98
    v_mfma_f32_16x16x32_bf16 v[168:171], a[192:195], a[228:231], v[168:171]
    v_permlane16_swap_b32 v97, v99
    v_mfma_f32_16x16x32_bf16 v[176:179], a[192:195], a[232:235], v[176:179]
    ds_read_b64_tr_b16 a[212:213], v8 offset:14336
    v_cvt_pk_bf16_f32 v104, v104, v105
    v_mfma_f32_16x16x32_bf16 v[176:179], a[196:199], a[248:251], v[176:179]
    ds_read_b64_tr_b16 a[214:215], v8 offset:20480
    v_cvt_pk_bf16_f32 v105, v106, v107
    v_mfma_f32_16x16x32_bf16 v[184:187], a[196:199], a[252:255], v[184:187]
    v_cvt_pk_bf16_f32 v106, v108, v109
    v_cvt_pk_bf16_f32 v107, v110, v111
    v_mfma_f32_16x16x32_bf16 v[184:187], a[192:195], a[236:239], v[184:187]
    s_waitcnt lgkmcnt(4)
    v_permlane16_swap_b32 v104, v106
    v_mfma_f32_16x16x32_bf16 v[188:191], a[200:203], a[236:239], v[188:191]
    ds_read_b64_tr_b16 a[192:193], v9 offset:2048
    v_cvt_pk_bf16_f32 v112, v112, v113
    v_mfma_f32_16x16x32_bf16 v[188:191], a[204:207], a[252:255], v[188:191]
    ds_read_b64_tr_b16 a[194:195], v9 offset:8192
    v_cvt_pk_bf16_f32 v113, v114, v115
    v_mfma_f32_16x16x32_bf16 v[180:183], a[204:207], a[248:251], v[180:183]
    v_permlane16_swap_b32 v105, v107
    v_mfma_f32_16x16x32_bf16 v[180:183], a[200:203], a[232:235], v[180:183]
    v_cvt_pk_bf16_f32 v114, v116, v117
    v_cvt_pk_bf16_f32 v115, v118, v119
    v_mfma_f32_16x16x32_bf16 v[172:175], a[200:203], a[228:231], v[172:175]
    ds_read_b64_tr_b16 a[196:197], v9 offset:14336
    v_cvt_pk_bf16_f32 v120, v120, v121
    v_mfma_f32_16x16x32_bf16 v[172:175], a[204:207], a[244:247], v[172:175]
    ds_read_b64_tr_b16 a[198:199], v9 offset:20480
    v_cvt_pk_bf16_f32 v121, v122, v123
    v_mfma_f32_16x16x32_bf16 v[164:167], a[204:207], a[240:243], v[164:167]
pg_5:
    s_cbranch_execz pg_9
    v_permlane16_swap_b32 v112, v114
    v_mfma_f32_16x16x32_bf16 v[164:167], a[200:203], a[224:227], v[164:167]
    s_waitcnt lgkmcnt(4)
    v_permlane16_swap_b32 v113, v115
    v_mfma_f32_16x16x32_bf16 v[192:195], a[208:211], a[224:227], v[192:195]
    ds_read_b64_tr_b16 a[200:201], v10 offset:2048
    v_cvt_pk_bf16_f32 v122, v124, v125
    v_mfma_f32_16x16x32_bf16 v[192:195], a[212:215], a[240:243], v[192:195]
    ds_read_b64_tr_b16 a[202:203], v10 offset:8192
    v_cvt_pk_bf16_f32 v123, v126, v127
    v_mfma_f32_16x16x32_bf16 v[200:203], a[212:215], a[244:247], v[200:203]
    v_permlane16_swap_b32 v120, v122
    v_mfma_f32_16x16x32_bf16 v[200:203], a[208:211], a[228:231], v[200:203]
    v_permlane16_swap_b32 v121, v123
    v_mfma_f32_16x16x32_bf16 v[208:211], a[208:211], a[232:235], v[208:211]
    ds_read_b64_tr_b16 a[204:205], v10 offset:14336
    v_cvt_pk_bf16_f32 v128, v128, v129
    v_mfma_f32_16x16x32_bf16 v[208:211], a[212:215], a[248:251], v[208:211]
    ds_read_b64_tr_b16 a[206:207], v10 offset:20480
    v_cvt_pk_bf16_f32 v129, v130, v131
    v_mfma_f32_16x16x32_bf16 v[216:219], a[212:215], a[252:255], v[216:219]
    v_cvt_pk_bf16_f32 v130, v132, v133
    v_cvt_pk_bf16_f32 v131, v134, v135
    v_mfma_f32_16x16x32_bf16 v[216:219], a[208:211], a[236:239], v[216:219]
    s_waitcnt lgkmcnt(4)
    v_permlane16_swap_b32 v128, v130
    v_mfma_f32_16x16x32_bf16 v[220:223], a[192:195], a[236:239], v[220:223]
    ds_read_b64_tr_b16 a[208:209], v11 offset:2048
    v_cvt_pk_bf16_f32 v136, v136, v137
    v_mfma_f32_16x16x32_bf16 v[220:223], a[196:199], a[252:255], v[220:223]
    ds_read_b64_tr_b16 a[210:211], v11 offset:8192
    v_cvt_pk_bf16_f32 v137, v138, v139
    v_mfma_f32_16x16x32_bf16 v[212:215], a[196:199], a[248:251], v[212:215]
    v_permlane16_swap_b32 v129, v131
    v_mfma_f32_16x16x32_bf16 v[212:215], a[192:195], a[232:235], v[212:215]
    v_cvt_pk_bf16_f32 v138, v140, v141
    v_cvt_pk_bf16_f32 v139, v142, v143
    v_mfma_f32_16x16x32_bf16 v[204:207], a[192:195], a[228:231], v[204:207]
    ds_read_b64_tr_b16 a[212:213], v11 offset:14336
    v_cvt_pk_bf16_f32 v144, v144, v145
    v_mfma_f32_16x16x32_bf16 v[204:207], a[196:199], a[244:247], v[204:207]
    s_waitcnt vmcnt(16)
    ds_read_b64_tr_b16 a[214:215], v11 offset:20480
    v_cvt_pk_bf16_f32 v145, v146, v147
    v_mfma_f32_16x16x32_bf16 v[196:199], a[196:199], a[240:243], v[196:199]
    s_barrier
    v_mfma_f32_16x16x32_bf16 v[196:199], a[192:195], a[224:227], v[196:199]
    s_waitcnt lgkmcnt(4)
    v_permlane16_swap_b32 v136, v138
    v_mfma_f32_16x16x32_bf16 v[224:227], a[200:203], a[224:227], v[224:227]
    ds_read_b128 a[192:195], v16 offset:0
    v_cvt_pk_bf16_f32 v146, v148, v149
    v_mfma_f32_16x16x32_bf16 v[224:227], a[204:207], a[240:243], v[224:227]
    v_permlane16_swap_b32 v137, v139
    v_mfma_f32_16x16x32_bf16 v[232:235], a[204:207], a[244:247], v[232:235]
    v_permlane16_swap_b32 v144, v146
    v_mfma_f32_16x16x32_bf16 v[232:235], a[200:203], a[228:231], v[232:235]
    v_cvt_pk_bf16_f32 v147, v150, v151
    v_cvt_pk_bf16_f32 v152, v152, v153
    v_mfma_f32_16x16x32_bf16 v[240:243], a[200:203], a[232:235], v[240:243]
    ds_read_b128 a[196:199], v17 offset:0
    v_cvt_pk_bf16_f32 v153, v154, v155
    v_mfma_f32_16x16x32_bf16 v[240:243], a[204:207], a[248:251], v[240:243]
    v_permlane16_swap_b32 v145, v147
    v_mfma_f32_16x16x32_bf16 v[248:251], a[204:207], a[252:255], v[248:251]
    v_cvt_pk_bf16_f32 v154, v156, v157
    v_cvt_pk_bf16_f32 v155, v158, v159
    v_mfma_f32_16x16x32_bf16 v[248:251], a[200:203], a[236:239], v[248:251]
    s_waitcnt lgkmcnt(2)
    v_permlane16_swap_b32 v152, v154
    v_mfma_f32_16x16x32_bf16 v[252:255], a[208:211], a[236:239], v[252:255]
    ds_read_b128 a[200:203], v16 offset:1024
    v_mov_b32 v26, s7
    v_mfma_f32_16x16x32_bf16 v[252:255], a[212:215], a[252:255], v[252:255]
    v_permlane16_swap_b32 v153, v155
    v_mfma_f32_16x16x32_bf16 v[244:247], a[212:215], a[248:251], v[244:247]
    v_min_u32 v27, 1, v1
    v_lshlrev_b32 v27, 30, v27
    v_mfma_f32_16x16x32_bf16 v[244:247], a[208:211], a[232:235], v[244:247]
    s_waitcnt vmcnt(7)
    v_cvt_pk_bf16_f32 v160, v160, v161
    v_cvt_pk_bf16_f32 v161, v162, v163
    v_mfma_f32_16x16x32_bf16 v[236:239], a[208:211], a[228:231], v[236:239]
    ds_read_b128 a[204:207], v17 offset:1024
    v_cvt_pk_bf16_f32 v162, v164, v165
    v_mfma_f32_16x16x32_bf16 v[236:239], a[212:215], a[244:247], v[236:239]
    buffer_store_dword v26, v27, s[24:27], s4 offen offset:144 sc1
    v_mfma_f32_16x16x32_bf16 v[228:231], a[212:215], a[240:243], v[228:231]
    v_permlane16_swap_b32 v160, v162
    v_mfma_f32_16x16x32_bf16 v[228:231], a[208:211], a[224:227], v[228:231]
    s_waitcnt lgkmcnt(2)
    v_cvt_pk_bf16_f32 v163, v166, v167
    v_cvt_pk_bf16_f32 v168, v168, v169
    v_mfma_f32_16x16x32_bf16 v[68:71], a[192:195], v[64:67], v[32:35]
    ds_read_b128 a[208:211], v16 offset:2048
    v_cvt_pk_bf16_f32 v169, v170, v171
    v_mfma_f32_16x16x32_bf16 v[68:71], a[196:199], v[96:99], v[68:71]
    v_permlane16_swap_b32 v161, v163
    v_mfma_f32_16x16x32_bf16 v[76:79], a[196:199], v[104:107], v[36:39]
    v_cvt_pk_bf16_f32 v170, v172, v173
    v_cvt_pk_bf16_f32 v171, v174, v175
    v_mfma_f32_16x16x32_bf16 v[76:79], a[192:195], v[72:75], v[76:79]
    v_permlane16_swap_b32 v168, v170
    v_mfma_f32_16x16x32_bf16 v[84:87], a[192:195], v[80:83], v[40:43]
    ds_read_b128 a[212:215], v17 offset:2048
    v_cvt_pk_bf16_f32 v176, v176, v177
    v_mfma_f32_16x16x32_bf16 v[84:87], a[196:199], v[112:115], v[84:87]
    v_permlane16_swap_b32 v169, v171
    v_cvt_pk_bf16_f32 v177, v178, v179
    v_cvt_pk_bf16_f32 v178, v180, v181
    v_cvt_pk_bf16_f32 v179, v182, v183
    v_cvt_pk_bf16_f32 v184, v184, v185
    v_permlane16_swap_b32 v176, v178
    v_permlane16_swap_b32 v177, v179
    v_cvt_pk_bf16_f32 v185, v186, v187
    v_cvt_pk_bf16_f32 v186, v188, v189
    v_cvt_pk_bf16_f32 v187, v190, v191
    v_cvt_pk_bf16_f32 v192, v192, v193
    v_permlane16_swap_b32 v184, v186
    v_permlane16_swap_b32 v185, v187
    v_mfma_f32_16x16x32_bf16 v[92:95], a[196:199], v[120:123], v[44:47]
    v_cvt_pk_bf16_f32 v193, v194, v195
    v_cvt_pk_bf16_f32 v194, v196, v197
    v_mfma_f32_16x16x32_bf16 v[92:95], a[192:195], v[88:91], v[92:95]
    s_waitcnt lgkmcnt(2)
    v_permlane16_swap_b32 v192, v194
    v_mfma_f32_16x16x32_bf16 v[92:95], a[200:203], v[152:155], v[92:95]
    ds_read_b128 a[192:195], v16 offset:6144
    v_cvt_pk_bf16_f32 v195, v198, v199
    v_mfma_f32_16x16x32_bf16 v[92:95], a[204:207], v[184:187], v[92:95]
    v_cvt_pk_bf16_f32 v200, v200, v201
    v_cvt_pk_bf16_f32 v201, v202, v203
    v_mfma_f32_16x16x32_bf16 v[84:87], a[204:207], v[176:179], v[84:87]
    v_permlane16_swap_b32 v193, v195
    v_mfma_f32_16x16x32_bf16 v[84:87], a[200:203], v[144:147], v[84:87]
    v_cvt_pk_bf16_f32 v202, v204, v205
    v_cvt_pk_bf16_f32 v203, v206, v207
    v_mfma_f32_16x16x32_bf16 v[76:79], a[200:203], v[136:139], v[76:79]
    ds_read_b128 a[196:199], v17 offset:6144
    v_cvt_pk_bf16_f32 v208, v208, v209
    v_mfma_f32_16x16x32_bf16 v[76:79], a[204:207], v[168:171], v[76:79]
    s_add_u32 m0, s49, 49152
    v_permlane16_swap_b32 v200, v202
    v_permlane16_swap_b32 v201, v203
    v_cvt_pk_bf16_f32 v209, v210, v211
    v_cvt_pk_bf16_f32 v210, v212, v213
    v_cvt_pk_bf16_f32 v211, v214, v215
    v_cvt_pk_bf16_f32 v216, v216, v217
    v_permlane16_swap_b32 v208, v210
    v_permlane16_swap_b32 v209, v211
    v_cvt_pk_bf16_f32 v217, v218, v219
    v_cvt_pk_bf16_f32 v218, v220, v221
    v_cvt_pk_bf16_f32 v219, v222, v223
    v_cvt_pk_bf16_f32 v224, v224, v225
    v_permlane16_swap_b32 v216, v218
    v_permlane16_swap_b32 v217, v219
    v_cvt_pk_bf16_f32 v225, v226, v227
    v_cvt_pk_bf16_f32 v226, v228, v229
    v_cvt_pk_bf16_f32 v227, v230, v231
    v_cvt_pk_bf16_f32 v232, v232, v233
    v_permlane16_swap_b32 v224, v226
    v_permlane16_swap_b32 v225, v227
    v_cvt_pk_bf16_f32 v233, v234, v235
    v_cvt_pk_bf16_f32 v234, v236, v237
    v_cvt_pk_bf16_f32 v235, v238, v239
    v_cvt_pk_bf16_f32 v240, v240, v241
    v_permlane16_swap_b32 v232, v234
    v_permlane16_swap_b32 v233, v235
    v_cvt_pk_bf16_f32 v241, v242, v243
    v_cvt_pk_bf16_f32 v242, v244, v245
    v_cvt_pk_bf16_f32 v243, v246, v247
    v_cvt_pk_bf16_f32 v248, v248, v249
    v_permlane16_swap_b32 v240, v242
    v_permlane16_swap_b32 v241, v243
    v_cvt_pk_bf16_f32 v249, v250, v251
    v_cvt_pk_bf16_f32 v250, v252, v253
    v_cvt_pk_bf16_f32 v251, v254, v255
    v_accvgpr_write_b32 a70, 1.0
    v_permlane16_swap_b32 v248, v250
    v_permlane16_swap_b32 v249, v251
    v_mfma_f32_16x16x32_bf16 v[68:71], a[204:207], v[160:163], v[68:71]
    buffer_load_dwordx4 v4, s[12:15], s38 offen offset:0 lds
    v_mfma_f32_16x16x32_bf16 v[68:71], a[200:203], v[128:131], v[68:71]
    s_waitcnt lgkmcnt(2)
    v_accvgpr_write_b32 a71, 1.0
    v_accvgpr_write_b32 a72, 1.0
    v_mfma_f32_16x16x32_bf16 v[68:71], a[208:211], v[192:195], v[68:71]
    ds_read_b128 a[200:203], v16 offset:7168
    v_accvgpr_write_b32 a73, 1.0
    v_mfma_f32_16x16x32_bf16 v[68:71], a[212:215], v[224:227], v[68:71]
    v_accvgpr_write_b32 a74, 1.0
    v_accvgpr_write_b32 a75, 1.0
    v_mfma_f32_16x16x32_bf16 v[76:79], a[212:215], v[232:235], v[76:79]
    v_accvgpr_write_b32 a76, 1.0
    v_accvgpr_write_b32 a77, 1.0
    v_mfma_f32_16x16x32_bf16 v[76:79], a[208:211], v[200:203], v[76:79]
    s_add_u32 m0, s49, 50048
    v_accvgpr_write_b32 a78, 1.0
    v_accvgpr_write_b32 a79, 1.0
    v_mfma_f32_16x16x32_bf16 v[84:87], a[208:211], v[208:211], v[84:87]
    ds_read_b128 a[204:207], v17 offset:7168
    v_accvgpr_write_b32 a80, 1.0
    v_mfma_f32_16x16x32_bf16 v[84:87], a[212:215], v[240:243], v[84:87]
    buffer_load_dwordx4 v4, s[12:15], s38 offen offset:128 lds
    v_mfma_f32_16x16x32_bf16 v[92:95], a[212:215], v[248:251], v[92:95]
    v_accvgpr_write_b32 a81, 1.0
    v_accvgpr_write_b32 a82, 1.0
    v_mfma_f32_16x16x32_bf16 v[92:95], a[208:211], v[216:219], v[92:95]
    s_waitcnt lgkmcnt(2)
    v_accvgpr_write_b32 a83, 1.0
    v_accvgpr_write_b32 a84, 1.0
    v_mfma_f32_16x16x32_bf16 v[124:127], a[192:195], v[88:91], v[44:47]
    ds_read_b128 a[208:211], v16 offset:8192
    v_accvgpr_write_b32 a85, 1.0
    v_mfma_f32_16x16x32_bf16 v[124:127], a[196:199], v[120:123], v[124:127]
    v_accvgpr_write_b32 a86, 1.0
    v_accvgpr_write_b32 a87, 1.0
    v_mfma_f32_16x16x32_bf16 v[116:119], a[196:199], v[112:115], v[40:43]
    s_add_u32 m0, s49, 50944
    v_accvgpr_write_b32 a88, 1.0
    v_accvgpr_write_b32 a89, 1.0
    v_mfma_f32_16x16x32_bf16 v[116:119], a[192:195], v[80:83], v[116:119]
    buffer_load_dwordx4 v4, s[12:15], s38 offen offset:256 lds
    v_mfma_f32_16x16x32_bf16 v[108:111], a[192:195], v[72:75], v[36:39]
    ds_read_b128 a[212:215], v17 offset:8192
    v_accvgpr_write_b32 a90, 1.0
    v_mfma_f32_16x16x32_bf16 v[108:111], a[196:199], v[104:107], v[108:111]
    v_accvgpr_write_b32 a91, 1.0
    v_accvgpr_write_b32 a92, 1.0
    v_mfma_f32_16x16x32_bf16 v[100:103], a[196:199], v[96:99], v[32:35]
    v_accvgpr_write_b32 a93, 1.0
    v_accvgpr_write_b32 a94, 1.0
    v_mfma_f32_16x16x32_bf16 v[100:103], a[192:195], v[64:67], v[100:103]
    s_waitcnt lgkmcnt(2)
    v_accvgpr_write_b32 a95, 1.0
    v_mfma_f32_16x16x32_bf16 v[100:103], a[200:203], v[128:131], v[100:103]
    s_add_u32 m0, s49, 52224
    ds_read_b128 a[192:195], v16 offset:12288
    v_mfma_f32_16x16x32_bf16 v[100:103], a[204:207], v[160:163], v[100:103]
    buffer_load_dwordx4 v5, s[12:15], s38 offen offset:0 lds
    v_mfma_f32_16x16x32_bf16 v[108:111], a[204:207], v[168:171], v[108:111]
    v_exp_f32 v48, v68
    v_mfma_f32_16x16x32_bf16 v[108:111], a[200:203], v[136:139], v[108:111]
    v_exp_f32 v49, v69
    v_mfma_f32_16x16x32_bf16 v[116:119], a[200:203], v[144:147], v[116:119]
    ds_read_b128 a[196:199], v17 offset:12288
    v_cvt_pk_bf16_f32 v196, v48, v49
    v_mfma_f32_16x16x32_bf16 v[116:119], a[204:207], v[176:179], v[116:119]
    v_exp_f32 v50, v70
    v_mfma_f32_16x16x32_bf16 v[124:127], a[204:207], v[184:187], v[124:127]
    v_exp_f32 v51, v71
    v_mfma_f32_16x16x32_bf16 v[124:127], a[200:203], v[152:155], v[124:127]
    s_waitcnt lgkmcnt(2)
    v_add_f32 v24, v48, v49
    v_add_f32 v24, v24, v50
    v_mfma_f32_16x16x32_bf16 v[124:127], a[208:211], v[216:219], v[124:127]
    s_add_u32 m0, s49, 53120
    ds_read_b128 a[200:203], v16 offset:13312
    v_cvt_pk_bf16_f32 v197, v50, v51
    v_mfma_f32_16x16x32_bf16 v[124:127], a[212:215], v[248:251], v[124:127]
    buffer_load_dwordx4 v5, s[12:15], s38 offen offset:128 lds
    v_mfma_f32_16x16x32_bf16 v[116:119], a[212:215], v[240:243], v[116:119]
    v_exp_f32 v48, v76
    v_mfma_f32_16x16x32_bf16 v[116:119], a[208:211], v[208:211], v[116:119]
    v_add_f32 v24, v24, v51
    v_mfma_f32_16x16x32_bf16 v[108:111], a[208:211], v[200:203], v[108:111]
    ds_read_b128 a[204:207], v17 offset:13312
    v_mfma_f32_16x16x32_bf16 v[108:111], a[212:215], v[232:235], v[108:111]
    s_add_u32 m0, s49, 54016
    v_exp_f32 v49, v77
    v_mfma_f32_16x16x32_bf16 v[100:103], a[212:215], v[224:227], v[100:103]
    buffer_load_dwordx4 v5, s[12:15], s38 offen offset:256 lds
    v_mfma_f32_16x16x32_bf16 v[100:103], a[208:211], v[192:195], v[100:103]
    s_waitcnt lgkmcnt(2)
    v_exp_f32 v50, v78
    v_mfma_f32_16x16x32_bf16 v[132:135], a[192:195], v[64:67], v[32:35]
    s_add_u32 s38, s38, 24576
    ds_read_b128 a[208:211], v16 offset:14336
    v_cvt_pk_bf16_f32 v204, v48, v49
    v_mfma_f32_16x16x32_bf16 v[132:135], a[196:199], v[96:99], v[132:135]
    v_exp_f32 v51, v79
    v_mfma_f32_16x16x32_bf16 v[140:143], a[196:199], v[104:107], v[36:39]
    v_add_f32 v25, v48, v49
    v_add_f32 v25, v25, v50
    v_mfma_f32_16x16x32_bf16 v[140:143], a[192:195], v[72:75], v[140:143]
    v_exp_f32 v48, v84
    v_mfma_f32_16x16x32_bf16 v[148:151], a[192:195], v[80:83], v[40:43]
    s_add_u32 m0, s49, 98304
    ds_read_b128 a[212:215], v17 offset:14336
    v_cvt_pk_bf16_f32 v205, v50, v51
    v_mfma_f32_16x16x32_bf16 v[148:151], a[196:199], v[112:115], v[148:151]
    buffer_load_dwordx4 v6, s[16:19], s40 offen offset:0 lds
    v_mfma_f32_16x16x32_bf16 v[156:159], a[196:199], v[120:123], v[44:47]
    v_exp_f32 v52, v100
    v_mfma_f32_16x16x32_bf16 v[156:159], a[192:195], v[88:91], v[156:159]
    s_waitcnt lgkmcnt(2)
    v_exp_f32 v53, v101
    v_mfma_f32_16x16x32_bf16 v[156:159], a[200:203], v[152:155], v[156:159]
    ds_read_b128 a[192:195], v16 offset:18432
    v_add_f32 v24, v24, v52
    v_mfma_f32_16x16x32_bf16 v[156:159], a[204:207], v[184:187], v[156:159]
    v_exp_f32 v54, v102
    v_mfma_f32_16x16x32_bf16 v[148:151], a[204:207], v[176:179], v[148:151]
    s_add_u32 m0, s49, 99200
    v_exp_f32 v55, v103
    v_mfma_f32_16x16x32_bf16 v[148:151], a[200:203], v[144:147], v[148:151]
    buffer_load_dwordx4 v6, s[16:19], s40 offen offset:128 lds
    v_mfma_f32_16x16x32_bf16 v[140:143], a[200:203], v[136:139], v[140:143]
    ds_read_b128 a[196:199], v17 offset:18432
    v_cvt_pk_bf16_f32 v198, v52, v53
    v_mfma_f32_16x16x32_bf16 v[140:143], a[204:207], v[168:171], v[140:143]
    v_add_f32 v24, v24, v53
    v_add_f32 v24, v24, v54
    v_mfma_f32_16x16x32_bf16 v[132:135], a[204:207], v[160:163], v[132:135]
    v_exp_f32 v52, v108
    v_mfma_f32_16x16x32_bf16 v[132:135], a[200:203], v[128:131], v[132:135]
    s_waitcnt lgkmcnt(2)
    v_cvt_pk_bf16_f32 v199, v54, v55
    v_add_f32 v24, v24, v55
    v_mfma_f32_16x16x32_bf16 v[132:135], a[208:211], v[192:195], v[132:135]
    ds_read_b128 a[200:203], v16 offset:19456
    v_add_f32 v25, v25, v51
    v_mfma_f32_16x16x32_bf16 v[132:135], a[212:215], v[224:227], v[132:135]
    s_add_u32 m0, s49, 100096
    v_exp_f32 v53, v109
    v_mfma_f32_16x16x32_bf16 v[140:143], a[212:215], v[232:235], v[140:143]
    buffer_load_dwordx4 v6, s[16:19], s40 offen offset:256 lds
    v_mfma_f32_16x16x32_bf16 v[140:143], a[208:211], v[200:203], v[140:143]
    v_exp_f32 v54, v110
    v_mfma_f32_16x16x32_bf16 v[148:151], a[208:211], v[208:211], v[148:151]
    ds_read_b128 a[204:207], v17 offset:19456
    v_add_f32 v25, v25, v52
    v_mfma_f32_16x16x32_bf16 v[148:151], a[212:215], v[240:243], v[148:151]
    v_exp_f32 v55, v111
    v_mfma_f32_16x16x32_bf16 v[156:159], a[212:215], v[248:251], v[156:159]
    v_exp_f32 v49, v85
    v_mfma_f32_16x16x32_bf16 v[156:159], a[208:211], v[216:219], v[156:159]
    s_waitcnt lgkmcnt(2)
    v_exp_f32 v50, v86
    v_mfma_f32_16x16x32_bf16 v[188:191], a[192:195], v[88:91], v[44:47]
    s_add_u32 m0, s49, 101376
    ds_read_b128 a[208:211], v16 offset:20480
    v_cvt_pk_bf16_f32 v206, v52, v53
    v_mfma_f32_16x16x32_bf16 v[188:191], a[196:199], v[120:123], v[188:191]
    buffer_load_dwordx4 v7, s[16:19], s40 offen offset:0 lds
    v_mfma_f32_16x16x32_bf16 v[180:183], a[196:199], v[112:115], v[40:43]
    v_add_f32 v25, v25, v53
    v_add_f32 v25, v25, v54
    v_mfma_f32_16x16x32_bf16 v[180:183], a[192:195], v[80:83], v[180:183]
    v_exp_f32 v51, v87
    v_mfma_f32_16x16x32_bf16 v[172:175], a[192:195], v[72:75], v[36:39]
    ds_read_b128 a[212:215], v17 offset:20480
    v_cvt_pk_bf16_f32 v207, v54, v55
    v_mfma_f32_16x16x32_bf16 v[172:175], a[196:199], v[104:107], v[172:175]
    s_waitcnt vmcnt(14)
    v_exp_f32 v52, v116
    v_mfma_f32_16x16x32_bf16 v[164:167], a[196:199], v[96:99], v[32:35]
    s_barrier
    v_mfma_f32_16x16x32_bf16 v[164:167], a[192:195], v[64:67], v[164:167]
    s_waitcnt lgkmcnt(2)
    v_add_f32 v25, v25, v55
    v_cvt_pk_bf16_f32 v212, v48, v49
    v_add_u32 v16, s42, v18
    v_mfma_f32_16x16x32_bf16 v[164:167], a[200:203], v[128:131], v[164:167]
    s_add_u32 m0, s49, 102272
    ds_read_b128 a[224:227], v16 offset:0
    v_add_f32 v26, v48, v49
    v_mfma_f32_16x16x32_bf16 v[164:167], a[204:207], v[160:163], v[164:167]
    buffer_load_dwordx4 v7, s[16:19], s40 offen offset:128 lds
    v_add_u32 v17, s42, v19
    v_mfma_f32_16x16x32_bf16 v[172:175], a[204:207], v[168:171], v[172:175]
    ds_read_b128 a[228:231], v17 offset:0
    v_add_f32 v26, v26, v50
    v_mfma_f32_16x16x32_bf16 v[172:175], a[200:203], v[136:139], v[172:175]
    v_exp_f32 v53, v117
    v_mfma_f32_16x16x32_bf16 v[180:183], a[200:203], v[144:147], v[180:183]
    s_add_u32 m0, s49, 103168
    ds_read_b128 a[232:235], v16 offset:1024
    v_cvt_pk_bf16_f32 v213, v50, v51
    v_mfma_f32_16x16x32_bf16 v[180:183], a[204:207], v[176:179], v[180:183]
    buffer_load_dwordx4 v7, s[16:19], s40 offen offset:256 lds
    v_mfma_f32_16x16x32_bf16 v[188:191], a[204:207], v[184:187], v[188:191]
    s_add_u32 s40, s40, 24576
    ds_read_b128 a[236:239], v17 offset:1024
    v_add_f32 v26, v26, v51
    v_mfma_f32_16x16x32_bf16 v[188:191], a[200:203], v[152:155], v[188:191]
    s_waitcnt lgkmcnt(4)
    v_exp_f32 v54, v118
    v_mfma_f32_16x16x32_bf16 v[188:191], a[208:211], v[216:219], v[188:191]
    ds_read_b128 a[240:243], v16 offset:2048
    v_add_f32 v26, v26, v52
    v_mfma_f32_16x16x32_bf16 v[188:191], a[212:215], v[248:251], v[188:191]
    v_exp_f32 v55, v119
    v_mfma_f32_16x16x32_bf16 v[180:183], a[212:215], v[240:243], v[180:183]
    ds_read_b128 a[244:247], v17 offset:2048
    v_cvt_pk_bf16_f32 v214, v52, v53
    v_mfma_f32_16x16x32_bf16 v[180:183], a[208:211], v[208:211], v[180:183]
    v_exp_f32 v48, v92
    v_mfma_f32_16x16x32_bf16 v[172:175], a[208:211], v[200:203], v[172:175]
    v_exp_f32 v49, v93
    v_mfma_f32_16x16x32_bf16 v[172:175], a[212:215], v[232:235], v[172:175]
    v_exp_f32 v50, v94
    v_mfma_f32_16x16x32_bf16 v[164:167], a[212:215], v[224:227], v[164:167]
    v_add_f32 v26, v26, v53
    v_add_f32 v26, v26, v54
    v_mfma_f32_16x16x32_bf16 v[164:167], a[208:211], v[192:195], v[164:167]
    v_cvt_pk_bf16_f32 v215, v54, v55
    v_add_f32 v26, v26, v55
    v_max3_f32 v29, v24, v25, v26
    v_cvt_pk_bf16_f32 v220, v48, v49
    v_exp_f32 v51, v95
    v_add_f32 v27, v48, v49
    v_cvt_pk_bf16_f32 v221, v50, v51
    v_exp_f32 v52, v124
    v_exp_f32 v53, v125
    v_add_f32 v27, v27, v50
    v_cvt_pk_bf16_f32 v222, v52, v53
    v_exp_f32 v54, v126
    v_exp_f32 v55, v127
    v_add_f32 v27, v27, v51
    v_cvt_pk_bf16_f32 v223, v54, v55
    v_add_f32 v27, v27, v52
    v_add_f32 v27, v27, v53
    v_add_f32 v27, v27, v54
    v_add_f32 v27, v27, v55
    v_max_f32 v29, v29, v27
    v_cmp_nle_f32 vcc, v29, v30
    v_min3_f32 v29, v24, v25, v26
    v_min_f32 v29, v29, v27
    v_cmp_gt_f32 s[88:89], v56, v29
    s_or_b64 vcc, vcc, s[88:89]
    s_cbranch_vccnz rare_p
rare_p_ret:
    s_waitcnt lgkmcnt(0)
at_switch:
at_dry:
    s_mov_b32 s76, 0
    s_branch at_loop
    .p2align 12
pg_6:
    s_cbranch_execz pg_10
at_loop:
    v_mfma_f32_16x16x32_bf16 v[68:71], a[224:227], v[64:67], v[32:35]
    ds_read_b128 a[192:195], v16 offset:6144
    v_add_f32 v20, v20, v24
    v_mfma_f32_16x16x32_bf16 v[68:71], a[228:231], v[96:99], v[68:71]
    s_add_u32 s77, s38, s76
    v_add_f32 v21, v21, v25
    v_add_f32 v22, v22, v26
    v_mfma_f32_16x16x32_bf16 v[68:71], a[232:235], v[128:131], v[68:71]
    v_add_f32 v23, v23, v27
    v_add_u32 v8, s41, v12
    v_mfma_f32_16x16x32_bf16 v[68:71], a[236:239], v[160:163], v[68:71]
    ds_read_b128 a[196:199], v17 offset:6144
    v_add_u32 v9, s41, v13
    v_mfma_f32_16x16x32_bf16 v[68:71], a[240:243], v[192:195], v[68:71]
    v_exp_f32 v48, v132
    v_mfma_f32_16x16x32_bf16 v[68:71], a[244:247], v[224:227], v[68:71]
    s_add_u32 m0, s41, 0
    v_exp_f32 v49, v133
    v_mfma_f32_16x16x32_bf16 v[76:79], a[244:247], v[232:235], v[36:39]
    ds_read_b128 a[200:203], v16 offset:7168
    v_cvt_pk_bf16_f32 v228, v48, v49
    v_mfma_f32_16x16x32_bf16 v[76:79], a[240:243], v[200:203], v[76:79]
    buffer_load_dwordx4 v4, s[12:15], s38 offen offset:0 lds
    v_mfma_f32_16x16x32_bf16 v[76:79], a[236:239], v[168:171], v[76:79]
    v_exp_f32 v50, v134
    v_mfma_f32_16x16x32_bf16 v[76:79], a[232:235], v[136:139], v[76:79]
    ds_read_b128 a[204:207], v17 offset:7168
    v_add_f32 v24, v48, v49
    v_mfma_f32_16x16x32_bf16 v[76:79], a[228:231], v[104:107], v[76:79]
    v_exp_f32 v51, v135
    v_mfma_f32_16x16x32_bf16 v[76:79], a[224:227], v[72:75], v[76:79]
    v_exp_f32 v52, v164
    v_mfma_f32_16x16x32_bf16 v[84:87], a[224:227], v[80:83], v[40:43]
    ds_read_b128 a[208:211], v16 offset:8192
    v_add_f32 v24, v24, v50
    v_mfma_f32_16x16x32_bf16 v[84:87], a[228:231], v[112:115], v[84:87]
    v_exp_f32 v53, v165
    v_mfma_f32_16x16x32_bf16 v[84:87], a[232:235], v[144:147], v[84:87]
    v_exp_f32 v54, v166
    v_mfma_f32_16x16x32_bf16 v[84:87], a[236:239], v[176:179], v[84:87]
    ds_read_b128 a[212:215], v17 offset:8192
    v_add_u32 v10, s41, v14
    v_mfma_f32_16x16x32_bf16 v[84:87], a[240:243], v[208:211], v[84:87]
    v_exp_f32 v55, v167
    v_mfma_f32_16x16x32_bf16 v[84:87], a[244:247], v[240:243], v[84:87]
    s_add_u32 m0, s41, 896
    v_cvt_pk_bf16_f32 v229, v50, v51
    v_add_f32 v24, v24, v51
    v_mfma_f32_16x16x32_bf16 v[92:95], a[244:247], v[248:251], v[44:47]
    buffer_load_dwordx4 v4, s[12:15], s38 offen offset:128 lds
    v_mfma_f32_16x16x32_bf16 v[92:95], a[240:243], v[216:219], v[92:95]
    v_exp_f32 v48, v140
    v_mfma_f32_16x16x32_bf16 v[92:95], a[236:239], v[184:187], v[92:95]
    v_add_u32 v11, s41, v15
    v_add_f32 v24, v24, v52
    v_mfma_f32_16x16x32_bf16 v[92:95], a[232:235], v[152:155], v[92:95]
    v_exp_f32 v49, v141
    v_mfma_f32_16x16x32_bf16 v[92:95], a[228:231], v[120:123], v[92:95]
    v_cvt_pk_bf16_f32 v230, v52, v53
    v_add_f32 v24, v24, v53
    v_mfma_f32_16x16x32_bf16 v[92:95], a[224:227], v[88:91], v[92:95]
    s_waitcnt lgkmcnt(0)
    v_exp_f32 v50, v142
    v_mfma_f32_16x16x32_bf16 v[124:127], a[192:195], v[88:91], v[44:47]
    ds_read_b64_tr_b16 a[224:225], v8 offset:0
    v_add_f32 v24, v24, v54
    v_mfma_f32_16x16x32_bf16 v[124:127], a[196:199], v[120:123], v[124:127]
    ds_read_b64_tr_b16 a[226:227], v8 offset:6144
    v_cvt_pk_bf16_f32 v231, v54, v55
    v_mfma_f32_16x16x32_bf16 v[124:127], a[200:203], v[152:155], v[124:127]
    v_exp_f32 v51, v143
    v_mfma_f32_16x16x32_bf16 v[124:127], a[204:207], v[184:187], v[124:127]
    ds_read_b64_tr_b16 a[228:229], v9 offset:0
    v_add_f32 v24, v24, v55
    v_mfma_f32_16x16x32_bf16 v[124:127], a[208:211], v[216:219], v[124:127]
    ds_read_b64_tr_b16 a[230:231], v9 offset:6144
    v_cvt_pk_bf16_f32 v236, v48, v49
    v_mfma_f32_16x16x32_bf16 v[124:127], a[212:215], v[248:251], v[124:127]
    v_exp_f32 v52, v172
    v_mfma_f32_16x16x32_bf16 v[116:119], a[212:215], v[240:243], v[40:43]
    ds_read_b64_tr_b16 a[232:233], v10 offset:0
    v_add_f32 v25, v48, v49
    v_mfma_f32_16x16x32_bf16 v[116:119], a[208:211], v[208:211], v[116:119]
    s_add_u32 m0, s41, 1792
    ds_read_b64_tr_b16 a[234:235], v10 offset:6144
    v_add_f32 v25, v25, v50
    v_mfma_f32_16x16x32_bf16 v[116:119], a[204:207], v[176:179], v[116:119]
    buffer_load_dwordx4 v4, s[12:15], s77 offen offset:256 lds
    v_mfma_f32_16x16x32_bf16 v[116:119], a[200:203], v[144:147], v[116:119]
    ds_read_b64_tr_b16 a[236:237], v11 offset:0
    v_cvt_pk_bf16_f32 v237, v50, v51
    v_mfma_f32_16x16x32_bf16 v[116:119], a[196:199], v[112:115], v[116:119]
    ds_read_b64_tr_b16 a[238:239], v11 offset:6144
    v_add_f32 v25, v25, v51
    v_mfma_f32_16x16x32_bf16 v[116:119], a[192:195], v[80:83], v[116:119]
    v_exp_f32 v53, v173
    v_mfma_f32_16x16x32_bf16 v[108:111], a[192:195], v[72:75], v[36:39]
    ds_read_b64_tr_b16 a[240:241], v8 offset:1024
    v_add_f32 v25, v25, v52
    v_mfma_f32_16x16x32_bf16 v[108:111], a[196:199], v[104:107], v[108:111]
    ds_read_b64_tr_b16 a[242:243], v8 offset:7168
    v_cvt_pk_bf16_f32 v238, v52, v53
    v_mfma_f32_16x16x32_bf16 v[108:111], a[200:203], v[136:139], v[108:111]
    v_exp_f32 v54, v174
    v_mfma_f32_16x16x32_bf16 v[108:111], a[204:207], v[168:171], v[108:111]
    ds_read_b64_tr_b16 a[244:245], v9 offset:1024
    v_add_f32 v25, v25, v53
    v_mfma_f32_16x16x32_bf16 v[108:111], a[208:211], v[200:203], v[108:111]
    ds_read_b64_tr_b16 a[246:247], v9 offset:7168
    v_add_f32 v25, v25, v54
    v_mfma_f32_16x16x32_bf16 v[108:111], a[212:215], v[232:235], v[108:111]
    v_exp_f32 v55, v175
    v_mfma_f32_16x16x32_bf16 v[100:103], a[212:215], v[224:227], v[32:35]
    v_exp_f32 v48, v148
    v_mfma_f32_16x16x32_bf16 v[100:103], a[208:211], v[192:195], v[100:103]
    v_exp_f32 v49, v149
    v_mfma_f32_16x16x32_bf16 v[100:103], a[204:207], v[160:163], v[100:103]
    v_exp_f32 v50, v150
    v_mfma_f32_16x16x32_bf16 v[100:103], a[200:203], v[128:131], v[100:103]
    s_add_u32 m0, s41, 3072
    v_exp_f32 v51, v151
    v_mfma_f32_16x16x32_bf16 v[100:103], a[196:199], v[96:99], v[100:103]
    buffer_load_dwordx4 v5, s[12:15], s38 offen offset:0 lds
    v_mfma_f32_16x16x32_bf16 v[100:103], a[192:195], v[64:67], v[100:103]
    s_waitcnt lgkmcnt(0)
    v_cvt_pk_bf16_f32 v239, v54, v55
    v_add_f32 v25, v25, v55
    v_mfma_f32_16x16x32_bf16 a[0:3], a[224:227], v[196:199], a[0:3]
    ds_read_b64_tr_b16 a[192:193], v10 offset:1024
    v_cvt_pk_bf16_f32 v244, v48, v49
    v_mfma_f32_16x16x32_bf16 a[16:19], a[228:231], v[196:199], a[16:19]
    ds_read_b64_tr_b16 a[194:195], v10 offset:7168
    v_add_f32 v26, v48, v49
    v_mfma_f32_16x16x32_bf16 a[32:35], a[232:235], v[196:199], a[32:35]
    v_exp_f32 v52, v180
    v_mfma_f32_16x16x32_bf16 a[48:51], a[236:239], v[196:199], a[48:51]
    ds_read_b64_tr_b16 a[196:197], v11 offset:1024
    v_add_f32 v26, v26, v50
    v_mfma_f32_16x16x32_bf16 a[64:67], a[240:243], v[196:199], a[64:67]
    ds_read_b64_tr_b16 a[198:199], v11 offset:7168
    v_cvt_pk_bf16_f32 v245, v50, v51
    v_mfma_f32_16x16x32_bf16 a[80:83], a[244:247], v[196:199], a[80:83]
    v_exp_f32 v53, v181
    v_mfma_f32_16x16x32_bf16 a[84:87], a[244:247], v[204:207], a[84:87]
    ds_read_b64_tr_b16 a[200:201], v8 offset:2048
    v_add_f32 v26, v26, v51
    v_mfma_f32_16x16x32_bf16 a[68:71], a[240:243], v[204:207], a[68:71]
    ds_read_b64_tr_b16 a[202:203], v8 offset:8192
    v_add_f32 v26, v26, v52
    v_mfma_f32_16x16x32_bf16 a[52:55], a[236:239], v[204:207], a[52:55]
    v_exp_f32 v54, v182
    v_mfma_f32_16x16x32_bf16 a[36:39], a[232:235], v[204:207], a[36:39]
    ds_read_b64_tr_b16 a[204:205], v9 offset:2048
    v_cvt_pk_bf16_f32 v246, v52, v53
    v_mfma_f32_16x16x32_bf16 a[20:23], a[228:231], v[204:207], a[20:23]
    ds_read_b64_tr_b16 a[206:207], v9 offset:8192
    v_add_f32 v26, v26, v53
    v_mfma_f32_16x16x32_bf16 a[4:7], a[224:227], v[204:207], a[4:7]
    s_add_u32 m0, s41, 3968
    v_exp_f32 v55, v183
    v_mfma_f32_16x16x32_bf16 a[8:11], a[224:227], v[212:215], a[8:11]
    ds_read_b64_tr_b16 a[208:209], v10 offset:2048
    v_add_f32 v26, v26, v54
    v_mfma_f32_16x16x32_bf16 a[24:27], a[228:231], v[212:215], a[24:27]
    ds_read_b64_tr_b16 a[210:211], v10 offset:8192
    v_cvt_pk_bf16_f32 v247, v54, v55
    v_mfma_f32_16x16x32_bf16 a[40:43], a[232:235], v[212:215], a[40:43]
    buffer_load_dwordx4 v5, s[12:15], s38 offen offset:128 lds
    v_mfma_f32_16x16x32_bf16 a[56:59], a[236:239], v[212:215], a[56:59]
    ds_read_b64_tr_b16 a[212:213], v11 offset:2048
    v_add_f32 v26, v26, v55
    v_mfma_f32_16x16x32_bf16 a[72:75], a[240:243], v[212:215], a[72:75]
    ds_read_b64_tr_b16 a[214:215], v11 offset:8192
    v_max3_f32 v29, v24, v25, v26
    v_mfma_f32_16x16x32_bf16 a[88:91], a[244:247], v[212:215], a[88:91]
    v_exp_f32 v48, v156
    v_mfma_f32_16x16x32_bf16 a[92:95], a[244:247], v[220:223], a[92:95]
    v_exp_f32 v49, v157
    v_mfma_f32_16x16x32_bf16 a[76:79], a[240:243], v[220:223], a[76:79]
    v_exp_f32 v50, v158
    v_mfma_f32_16x16x32_bf16 a[60:63], a[236:239], v[220:223], a[60:63]
    v_exp_f32 v51, v159
    v_mfma_f32_16x16x32_bf16 a[44:47], a[232:235], v[220:223], a[44:47]
    v_exp_f32 v52, v188
    v_mfma_f32_16x16x32_bf16 a[28:31], a[228:231], v[220:223], a[28:31]
    v_exp_f32 v53, v189
    v_mfma_f32_16x16x32_bf16 a[12:15], a[224:227], v[220:223], a[12:15]
    s_waitcnt lgkmcnt(0)
    v_cvt_pk_bf16_f32 v252, v48, v49
    v_add_f32 v27, v48, v49
    v_mfma_f32_16x16x32_bf16 a[108:111], a[192:195], v[220:223], a[108:111]
    ds_read_b128 a[224:227], v16 offset:12288
    v_add_f32 v27, v27, v50
    v_mfma_f32_16x16x32_bf16 a[124:127], a[196:199], v[220:223], a[124:127]
    s_add_u32 m0, s41, 4864
    v_exp_f32 v54, v190
    v_mfma_f32_16x16x32_bf16 a[140:143], a[200:203], v[220:223], a[140:143]
    buffer_load_dwordx4 v5, s[12:15], s77 offen offset:256 lds
    v_mfma_f32_16x16x32_bf16 a[156:159], a[204:207], v[220:223], a[156:159]
    ds_read_b128 a[228:231], v17 offset:12288
    v_cvt_pk_bf16_f32 v253, v50, v51
    v_mfma_f32_16x16x32_bf16 a[172:175], a[208:211], v[220:223], a[172:175]
    s_add_u32 s38, s38, s39
    v_exp_f32 v55, v191
    v_mfma_f32_16x16x32_bf16 a[188:191], a[212:215], v[220:223], a[188:191]
    s_add_u32 s77, s40, s66
    v_add_f32 v27, v27, v51
    v_mfma_f32_16x16x32_bf16 a[184:187], a[212:215], v[212:215], a[184:187]
    ds_read_b128 a[232:235], v16 offset:13312
    v_add_f32 v27, v27, v52
    v_mfma_f32_16x16x32_bf16 a[168:171], a[208:211], v[212:215], a[168:171]
    v_cvt_pk_bf16_f32 v254, v52, v53
    v_mfma_f32_16x16x32_bf16 a[152:155], a[204:207], v[212:215], a[152:155]
    v_add_f32 v27, v27, v53
    v_mfma_f32_16x16x32_bf16 a[136:139], a[200:203], v[212:215], a[136:139]
    ds_read_b128 a[236:239], v17 offset:13312
    v_add_f32 v27, v27, v54
    v_mfma_f32_16x16x32_bf16 a[120:123], a[196:199], v[212:215], a[120:123]
    v_cvt_pk_bf16_f32 v255, v54, v55
    v_mfma_f32_16x16x32_bf16 a[104:107], a[192:195], v[212:215], a[104:107]
    v_add_f32 v27, v27, v55
    v_mfma_f32_16x16x32_bf16 a[100:103], a[192:195], v[204:207], a[100:103]
    ds_read_b128 a[240:243], v16 offset:14336
    v_max_f32 v29, v29, v27
    v_mfma_f32_16x16x32_bf16 a[116:119], a[196:199], v[204:207], a[116:119]
    v_cmp_nle_f32 vcc, v29, v30
    v_mfma_f32_16x16x32_bf16 a[132:135], a[200:203], v[204:207], a[132:135]
    v_mfma_f32_16x16x32_bf16 a[148:151], a[204:207], v[204:207], a[148:151]
    s_add_u32 m0, s43, 73728
    ds_read_b128 a[244:247], v17 offset:14336
    v_mfma_f32_16x16x32_bf16 a[164:167], a[208:211], v[204:207], a[164:167]
    buffer_load_dwordx4 v6, s[16:19], s40 offen offset:0 lds
    v_mfma_f32_16x16x32_bf16 a[180:183], a[212:215], v[204:207], a[180:183]
    v_mfma_f32_16x16x32_bf16 a[176:179], a[212:215], v[196:199], a[176:179]
    s_cmp_eq_u32 s45, 2
    s_cselect_b64 s[88:89], -1, 0
    s_cselect_b64 s[12:13], s[8:9], s[12:13]
    v_mfma_f32_16x16x32_bf16 a[160:163], a[208:211], v[196:199], a[160:163]
    s_cmp_eq_u32 s45, 2
    s_cselect_b32 s14, s10, s14
    s_cselect_b32 s38, s36, s38
    v_mfma_f32_16x16x32_bf16 a[144:147], a[204:207], v[196:199], a[144:147]
    s_cmp_eq_u32 s45, 2
    s_cselect_b32 s39, 81920, s39
    s_cselect_b32 s76, s63, s76
    v_mfma_f32_16x16x32_bf16 a[128:131], a[200:203], v[196:199], a[128:131]
    v_cndmask_b32 v4, v4, v62, s[88:89]
    v_cndmask_b32 v5, v5, v63, s[88:89]
    v_mfma_f32_16x16x32_bf16 a[112:115], a[196:199], v[196:199], a[112:115]
    v_mfma_f32_16x16x32_bf16 a[96:99], a[192:195], v[196:199], a[96:99]
    s_waitcnt lgkmcnt(0)
    s_cbranch_vccnz rare_a
rare_a_ret:
    v_mfma_f32_16x16x32_bf16 v[132:135], a[224:227], v[64:67], v[32:35]
    ds_read_b128 a[192:195], v16 offset:18432
    v_add_f32 v20, v20, v24
    v_mfma_f32_16x16x32_bf16 v[132:135], a[228:231], v[96:99], v[132:135]
    v_add_f32 v21, v21, v25
    v_add_f32 v22, v22, v26
    v_mfma_f32_16x16x32_bf16 v[132:135], a[232:235], v[128:131], v[132:135]
    v_add_f32 v23, v23, v27
    v_mfma_f32_16x16x32_bf16 v[132:135], a[236:239], v[160:163], v[132:135]
    ds_read_b128 a[196:199], v17 offset:18432
    v_mfma_f32_16x16x32_bf16 v[132:135], a[240:243], v[192:195], v[132:135]
    v_exp_f32 v48, v68
    v_mfma_f32_16x16x32_bf16 v[132:135], a[244:247], v[224:227], v[132:135]
    s_add_u32 m0, s43, 74624
    v_exp_f32 v49, v69
    v_mfma_f32_16x16x32_bf16 v[140:143], a[244:247], v[232:235], v[36:39]
    ds_read_b128 a[200:203], v16 offset:19456
    v_cvt_pk_bf16_f32 v196, v48, v49
    v_mfma_f32_16x16x32_bf16 v[140:143], a[240:243], v[200:203], v[140:143]
    buffer_load_dwordx4 v6, s[16:19], s40 offen offset:128 lds
    v_mfma_f32_16x16x32_bf16 v[140:143], a[236:239], v[168:171], v[140:143]
    v_exp_f32 v50, v70
    v_mfma_f32_16x16x32_bf16 v[140:143], a[232:235], v[136:139], v[140:143]
    ds_read_b128 a[204:207], v17 offset:19456
    v_add_f32 v24, v48, v49
    v_mfma_f32_16x16x32_bf16 v[140:143], a[228:231], v[104:107], v[140:143]
    v_exp_f32 v51, v71
    v_mfma_f32_16x16x32_bf16 v[140:143], a[224:227], v[72:75], v[140:143]
    v_exp_f32 v52, v100
    v_mfma_f32_16x16x32_bf16 v[148:151], a[224:227], v[80:83], v[40:43]
    ds_read_b128 a[208:211], v16 offset:20480
    v_add_f32 v24, v24, v50
    v_mfma_f32_16x16x32_bf16 v[148:151], a[228:231], v[112:115], v[148:151]
    v_exp_f32 v53, v101
    v_mfma_f32_16x16x32_bf16 v[148:151], a[232:235], v[144:147], v[148:151]
    v_exp_f32 v54, v102
    v_mfma_f32_16x16x32_bf16 v[148:151], a[236:239], v[176:179], v[148:151]
    ds_read_b128 a[212:215], v17 offset:20480
    v_cvt_pk_bf16_f32 v197, v50, v51
    v_mfma_f32_16x16x32_bf16 v[148:151], a[240:243], v[208:211], v[148:151]
    v_exp_f32 v55, v103
    v_mfma_f32_16x16x32_bf16 v[148:151], a[244:247], v[240:243], v[148:151]
    v_add_f32 v24, v24, v51
    v_add_f32 v24, v24, v52
    v_mfma_f32_16x16x32_bf16 v[156:159], a[244:247], v[248:251], v[44:47]
    v_exp_f32 v48, v76
    v_mfma_f32_16x16x32_bf16 v[156:159], a[240:243], v[216:219], v[156:159]
    s_add_u32 m0, s43, 75520
    v_exp_f32 v49, v77
    v_mfma_f32_16x16x32_bf16 v[156:159], a[236:239], v[184:187], v[156:159]
    buffer_load_dwordx4 v6, s[16:19], s77 offen offset:256 lds
    v_mfma_f32_16x16x32_bf16 v[156:159], a[232:235], v[152:155], v[156:159]
    v_cvt_pk_bf16_f32 v198, v52, v53
    v_add_f32 v24, v24, v53
    v_mfma_f32_16x16x32_bf16 v[156:159], a[228:231], v[120:123], v[156:159]
    v_exp_f32 v50, v78
    v_mfma_f32_16x16x32_bf16 v[156:159], a[224:227], v[88:91], v[156:159]
    s_waitcnt lgkmcnt(0)
    v_add_f32 v24, v24, v54
    v_cvt_pk_bf16_f32 v199, v54, v55
    v_mfma_f32_16x16x32_bf16 v[188:191], a[192:195], v[88:91], v[44:47]
    ds_read_b64_tr_b16 a[224:225], v8 offset:12288
    v_add_f32 v24, v24, v55
    v_mfma_f32_16x16x32_bf16 v[188:191], a[196:199], v[120:123], v[188:191]
    ds_read_b64_tr_b16 a[226:227], v8 offset:18432
    v_cvt_pk_bf16_f32 v204, v48, v49
    v_mfma_f32_16x16x32_bf16 v[188:191], a[200:203], v[152:155], v[188:191]
    v_exp_f32 v51, v79
    v_mfma_f32_16x16x32_bf16 v[188:191], a[204:207], v[184:187], v[188:191]
    ds_read_b64_tr_b16 a[228:229], v9 offset:12288
    v_add_f32 v25, v48, v49
    v_mfma_f32_16x16x32_bf16 v[188:191], a[208:211], v[216:219], v[188:191]
    ds_read_b64_tr_b16 a[230:231], v9 offset:18432
    v_add_f32 v25, v25, v50
    v_mfma_f32_16x16x32_bf16 v[188:191], a[212:215], v[248:251], v[188:191]
    v_exp_f32 v52, v108
    v_mfma_f32_16x16x32_bf16 v[180:183], a[212:215], v[240:243], v[40:43]
    ds_read_b64_tr_b16 a[232:233], v10 offset:12288
    v_cvt_pk_bf16_f32 v205, v50, v51
    v_mfma_f32_16x16x32_bf16 v[180:183], a[208:211], v[208:211], v[180:183]
    ds_read_b64_tr_b16 a[234:235], v10 offset:18432
    v_add_f32 v25, v25, v51
    v_mfma_f32_16x16x32_bf16 v[180:183], a[204:207], v[176:179], v[180:183]
    v_exp_f32 v53, v109
    v_mfma_f32_16x16x32_bf16 v[180:183], a[200:203], v[144:147], v[180:183]
    s_add_u32 m0, s43, 76800
    ds_read_b64_tr_b16 a[236:237], v11 offset:12288
    v_add_f32 v25, v25, v52
    v_mfma_f32_16x16x32_bf16 v[180:183], a[196:199], v[112:115], v[180:183]
    ds_read_b64_tr_b16 a[238:239], v11 offset:18432
    v_cvt_pk_bf16_f32 v206, v52, v53
    v_mfma_f32_16x16x32_bf16 v[180:183], a[192:195], v[80:83], v[180:183]
    buffer_load_dwordx4 v7, s[16:19], s40 offen offset:0 lds
    v_mfma_f32_16x16x32_bf16 v[172:175], a[192:195], v[72:75], v[36:39]
    ds_read_b64_tr_b16 a[240:241], v8 offset:13312
    v_add_f32 v25, v25, v53
    v_mfma_f32_16x16x32_bf16 v[172:175], a[196:199], v[104:107], v[172:175]
    ds_read_b64_tr_b16 a[242:243], v8 offset:19456
    v_add_u32 v16, s43, v18
    v_mfma_f32_16x16x32_bf16 v[172:175], a[200:203], v[136:139], v[172:175]
    v_exp_f32 v54, v110
    v_mfma_f32_16x16x32_bf16 v[172:175], a[204:207], v[168:171], v[172:175]
    ds_read_b64_tr_b16 a[244:245], v9 offset:13312
    v_add_f32 v25, v25, v54
    v_mfma_f32_16x16x32_bf16 v[172:175], a[208:211], v[200:203], v[172:175]
    ds_read_b64_tr_b16 a[246:247], v9 offset:19456
    v_add_u32 v17, s43, v19
    v_mfma_f32_16x16x32_bf16 v[172:175], a[212:215], v[232:235], v[172:175]
    v_exp_f32 v55, v111
    v_mfma_f32_16x16x32_bf16 v[164:167], a[212:215], v[224:227], v[32:35]
    v_exp_f32 v48, v84
    v_mfma_f32_16x16x32_bf16 v[164:167], a[208:211], v[192:195], v[164:167]
    v_exp_f32 v49, v85
    v_mfma_f32_16x16x32_bf16 v[164:167], a[204:207], v[160:163], v[164:167]
    v_exp_f32 v50, v86
    v_mfma_f32_16x16x32_bf16 v[164:167], a[200:203], v[128:131], v[164:167]
    v_exp_f32 v51, v87
    v_mfma_f32_16x16x32_bf16 v[164:167], a[196:199], v[96:99], v[164:167]
    v_cvt_pk_bf16_f32 v207, v54, v55
    v_add_f32 v25, v25, v55
    v_mfma_f32_16x16x32_bf16 v[164:167], a[192:195], v[64:67], v[164:167]
    s_waitcnt lgkmcnt(0)
    v_exp_f32 v52, v116
    v_mfma_f32_16x16x32_bf16 a[0:3], a[224:227], v[228:231], a[0:3]
    s_add_u32 m0, s43, 77696
    ds_read_b64_tr_b16 a[192:193], v10 offset:13312
    v_cvt_pk_bf16_f32 v212, v48, v49
    v_mfma_f32_16x16x32_bf16 a[16:19], a[228:231], v[228:231], a[16:19]
    ds_read_b64_tr_b16 a[194:195], v10 offset:19456
    v_add_f32 v26, v48, v49
    v_mfma_f32_16x16x32_bf16 a[32:35], a[232:235], v[228:231], a[32:35]
    buffer_load_dwordx4 v7, s[16:19], s40 offen offset:128 lds
    v_mfma_f32_16x16x32_bf16 a[48:51], a[236:239], v[228:231], a[48:51]
    ds_read_b64_tr_b16 a[196:197], v11 offset:13312
    v_add_f32 v26, v26, v50
    v_mfma_f32_16x16x32_bf16 a[64:67], a[240:243], v[228:231], a[64:67]
    ds_read_b64_tr_b16 a[198:199], v11 offset:19456
    v_cvt_pk_bf16_f32 v213, v50, v51
    v_mfma_f32_16x16x32_bf16 a[80:83], a[244:247], v[228:231], a[80:83]
    v_exp_f32 v53, v117
    v_mfma_f32_16x16x32_bf16 a[84:87], a[244:247], v[236:239], a[84:87]
    ds_read_b64_tr_b16 a[200:201], v8 offset:14336
    v_add_f32 v26, v26, v51
    v_mfma_f32_16x16x32_bf16 a[68:71], a[240:243], v[236:239], a[68:71]
    ds_read_b64_tr_b16 a[202:203], v8 offset:20480
    v_add_f32 v26, v26, v52
    v_mfma_f32_16x16x32_bf16 a[52:55], a[236:239], v[236:239], a[52:55]
    v_exp_f32 v54, v118
    v_mfma_f32_16x16x32_bf16 a[36:39], a[232:235], v[236:239], a[36:39]
    ds_read_b64_tr_b16 a[204:205], v9 offset:14336
    v_cvt_pk_bf16_f32 v214, v52, v53
    v_mfma_f32_16x16x32_bf16 a[20:23], a[228:231], v[236:239], a[20:23]
    ds_read_b64_tr_b16 a[206:207], v9 offset:20480
    v_add_f32 v26, v26, v53
    v_mfma_f32_16x16x32_bf16 a[4:7], a[224:227], v[236:239], a[4:7]
    v_exp_f32 v55, v119
    v_mfma_f32_16x16x32_bf16 a[8:11], a[224:227], v[244:247], a[8:11]
    ds_read_b64_tr_b16 a[208:209], v10 offset:14336
    v_add_f32 v26, v26, v54
    v_mfma_f32_16x16x32_bf16 a[24:27], a[228:231], v[244:247], a[24:27]
    s_add_u32 m0, s43, 78592
    ds_read_b64_tr_b16 a[210:211], v10 offset:20480
    v_cvt_pk_bf16_f32 v215, v54, v55
    v_mfma_f32_16x16x32_bf16 a[40:43], a[232:235], v[244:247], a[40:43]
    buffer_load_dwordx4 v7, s[16:19], s77 offen offset:256 lds
    v_mfma_f32_16x16x32_bf16 a[56:59], a[236:239], v[244:247], a[56:59]
    ds_read_b64_tr_b16 a[212:213], v11 offset:14336
    v_add_f32 v26, v26, v55
    v_mfma_f32_16x16x32_bf16 a[72:75], a[240:243], v[244:247], a[72:75]
    s_add_u32 s40, s40, 24576
    ds_read_b64_tr_b16 a[214:215], v11 offset:20480
    v_max3_f32 v29, v24, v25, v26
    v_mfma_f32_16x16x32_bf16 a[88:91], a[244:247], v[244:247], a[88:91]
    s_add_u32 s77, s38, s39
    v_exp_f32 v48, v92
    v_mfma_f32_16x16x32_bf16 a[92:95], a[244:247], v[252:255], a[92:95]
    v_exp_f32 v49, v93
    v_mfma_f32_16x16x32_bf16 a[76:79], a[240:243], v[252:255], a[76:79]
    v_exp_f32 v50, v94
    v_mfma_f32_16x16x32_bf16 a[60:63], a[236:239], v[252:255], a[60:63]
    v_exp_f32 v51, v95
    v_mfma_f32_16x16x32_bf16 a[44:47], a[232:235], v[252:255], a[44:47]
    s_waitcnt vmcnt(12)
    v_exp_f32 v52, v124
    v_mfma_f32_16x16x32_bf16 a[28:31], a[228:231], v[252:255], a[28:31]
    s_barrier
    v_mfma_f32_16x16x32_bf16 a[12:15], a[224:227], v[252:255], a[12:15]
    s_waitcnt lgkmcnt(0)
    v_exp_f32 v53, v125
    v_mfma_f32_16x16x32_bf16 a[108:111], a[192:195], v[252:255], a[108:111]
    ds_read_b128 a[224:227], v16 offset:0
    v_cvt_pk_bf16_f32 v220, v48, v49
    v_mfma_f32_16x16x32_bf16 a[124:127], a[196:199], v[252:255], a[124:127]
    v_add_f32 v27, v48, v49
    v_mfma_f32_16x16x32_bf16 a[140:143], a[200:203], v[252:255], a[140:143]
    v_exp_f32 v54, v126
    v_mfma_f32_16x16x32_bf16 a[156:159], a[204:207], v[252:255], a[156:159]
    ds_read_b128 a[228:231], v17 offset:0
    v_add_f32 v27, v27, v50
    v_mfma_f32_16x16x32_bf16 a[172:175], a[208:211], v[252:255], a[172:175]
    v_exp_f32 v55, v127
    v_mfma_f32_16x16x32_bf16 a[188:191], a[212:215], v[252:255], a[188:191]
    v_cvt_pk_bf16_f32 v221, v50, v51
    v_add_f32 v27, v27, v51
    v_mfma_f32_16x16x32_bf16 a[184:187], a[212:215], v[244:247], a[184:187]
    ds_read_b128 a[232:235], v16 offset:1024
    v_add_f32 v27, v27, v52
    v_mfma_f32_16x16x32_bf16 a[168:171], a[208:211], v[244:247], a[168:171]
    v_cvt_pk_bf16_f32 v222, v52, v53
    v_mfma_f32_16x16x32_bf16 a[152:155], a[204:207], v[244:247], a[152:155]
    v_add_f32 v27, v27, v53
    v_mfma_f32_16x16x32_bf16 a[136:139], a[200:203], v[244:247], a[136:139]
    ds_read_b128 a[236:239], v17 offset:1024
    v_add_f32 v27, v27, v54
    v_mfma_f32_16x16x32_bf16 a[120:123], a[196:199], v[244:247], a[120:123]
    buffer_load_dword a216, v2, s[28:31], s6 offen
    v_mfma_f32_16x16x32_bf16 a[104:107], a[192:195], v[244:247], a[104:107]
    s_add_u32 s6, s6, 1536
    v_cvt_pk_bf16_f32 v223, v54, v55
    v_mfma_f32_16x16x32_bf16 a[100:103], a[192:195], v[236:239], a[100:103]
    s_mov_b32 s44, s41
    ds_read_b128 a[240:243], v16 offset:2048
    v_add_f32 v27, v27, v55
    v_mfma_f32_16x16x32_bf16 a[116:119], a[196:199], v[236:239], a[116:119]
    s_mov_b32 s41, s42
    v_max_f32 v29, v29, v27
    v_mfma_f32_16x16x32_bf16 a[132:135], a[200:203], v[236:239], a[132:135]
    s_mov_b32 s42, s43
    v_cmp_nle_f32 vcc, v29, v30
    s_mov_b32 s43, s44
    v_mfma_f32_16x16x32_bf16 a[148:151], a[204:207], v[236:239], a[148:151]
    ds_read_b128 a[244:247], v17 offset:2048
    v_mfma_f32_16x16x32_bf16 a[164:167], a[208:211], v[236:239], a[164:167]
    s_cmp_eq_u32 s45, 1
    s_cselect_b64 s[88:89], -1, 0
    s_cselect_b64 s[16:17], s[8:9], s[16:17]
    v_mfma_f32_16x16x32_bf16 a[180:183], a[212:215], v[236:239], a[180:183]
    s_cmp_eq_u32 s45, 1
    s_cselect_b32 s18, s10, s18
    s_cselect_b32 s40, s77, s40
    v_mfma_f32_16x16x32_bf16 a[176:179], a[212:215], v[228:231], a[176:179]
    s_cmp_eq_u32 s45, 1
    s_cselect_b32 s66, s63, s66
    v_mfma_f32_16x16x32_bf16 a[160:163], a[208:211], v[228:231], a[160:163]
    v_cndmask_b32 v6, v6, v62, s[88:89]
    v_cndmask_b32 v7, v7, v63, s[88:89]
    v_mfma_f32_16x16x32_bf16 a[144:147], a[204:207], v[228:231], a[144:147]
    s_sub_u32 s45, s45, 1
    v_mfma_f32_16x16x32_bf16 a[128:131], a[200:203], v[228:231], a[128:131]
    v_mfma_f32_16x16x32_bf16 a[112:115], a[196:199], v[228:231], a[112:115]
    s_waitcnt lgkmcnt(0)
    v_mfma_f32_16x16x32_bf16 a[96:99], a[192:195], v[228:231], a[96:99]
    s_cbranch_vccnz rare_b
rare_b_ret:
    s_cbranch_scc0 at_loop
tail_code:
    v_add_u32 v8, s41, v12
    v_add_u32 v9, s41, v13
    v_add_u32 v10, s41, v14
    v_add_u32 v11, s41, v15
    s_waitcnt lgkmcnt(0)
    ds_read_b64_tr_b16 a[192:193], v8 offset:0
    ds_read_b64_tr_b16 a[194:195], v8 offset:6144
    ds_read_b64_tr_b16 a[196:197], v9 offset:0
    ds_read_b64_tr_b16 a[198:199], v9 offset:6144
    ds_read_b64_tr_b16 a[200:201], v10 offset:0
    ds_read_b64_tr_b16 a[202:203], v10 offset:6144
    ds_read_b64_tr_b16 a[204:205], v11 offset:0
    ds_read_b64_tr_b16 a[206:207], v11 offset:6144
    s_waitcnt lgkmcnt(4)
    v_mfma_f32_16x16x32_bf16 a[0:3], a[192:195], v[196:199], a[0:3]
    s_add_u32 s38, s33, 0
    ds_read_b64_tr_b16 a[208:209], v8 offset:1024
    v_add_f32 v20, v20, v24
    v_mfma_f32_16x16x32_bf16 a[16:19], a[196:199], v[196:199], a[16:19]
    s_add_u32 s57, s34, 0
    ds_read_b64_tr_b16 a[210:211], v8 offset:7168
    v_add_f32 v21, v21, v25
    v_mfma_f32_16x16x32_bf16 a[20:23], a[196:199], v[204:207], a[20:23]
    buffer_load_dword v61, v60, s[24:27], s37 offen sc1
    v_mfma_f32_16x16x32_bf16 a[4:7], a[192:195], v[204:207], a[4:7]
    s_cmp_lt_u32 s3, 2
    s_cselect_b32 s38, s38, s57
    v_add_f32 v22, v22, v26
    v_mfma_f32_16x16x32_bf16 a[8:11], a[192:195], v[212:215], a[8:11]
    s_add_u32 s76, s38, s63
    ds_read_b64_tr_b16 a[212:213], v9 offset:1024
    v_add_f32 v23, v23, v27
    v_mfma_f32_16x16x32_bf16 a[24:27], a[196:199], v[212:215], a[24:27]
    s_add_u32 m0, s49, 24576
    ds_read_b64_tr_b16 a[214:215], v9 offset:7168
    s_and_b32 s59, s51, 1
    v_mfma_f32_16x16x32_bf16 a[28:31], a[196:199], v[220:223], a[28:31]
    buffer_load_dwordx4 v4, s[12:15], s38 offen offset:0 lds
    v_mfma_f32_16x16x32_bf16 a[12:15], a[192:195], v[220:223], a[12:15]
    s_waitcnt lgkmcnt(4)
    v_exp_f32 v48, v132
    v_mfma_f32_16x16x32_bf16 a[44:47], a[200:203], v[220:223], a[44:47]
    s_lshl_b32 s59, s59, 6
    ds_read_b64_tr_b16 a[192:193], v10 offset:1024
    s_sub_u32 s44, s49, 73728
    v_mfma_f32_16x16x32_bf16 a[60:63], a[204:207], v[220:223], a[60:63]
    s_add_u32 m0, s49, 25472
    ds_read_b64_tr_b16 a[194:195], v10 offset:7168
    v_add_u32 v12, s44, v12
    v_mfma_f32_16x16x32_bf16 a[56:59], a[204:207], v[212:215], a[56:59]
    buffer_load_dwordx4 v4, s[12:15], s38 offen offset:128 lds
    v_mfma_f32_16x16x32_bf16 a[40:43], a[200:203], v[212:215], a[40:43]
    v_add_u32 v13, s44, v13
    v_add_u32 v14, s44, v14
    v_mfma_f32_16x16x32_bf16 a[36:39], a[200:203], v[204:207], a[36:39]
    ds_read_b64_tr_b16 a[196:197], v11 offset:1024
    v_add_u32 v15, s44, v15
    v_mfma_f32_16x16x32_bf16 a[52:55], a[204:207], v[204:207], a[52:55]
    s_add_u32 m0, s49, 26368
    ds_read_b64_tr_b16 a[198:199], v11 offset:7168
    s_mov_b32 s39, s59
    v_mfma_f32_16x16x32_bf16 a[48:51], a[204:207], v[196:199], a[48:51]
    buffer_load_dwordx4 v4, s[12:15], s76 offen offset:256 lds
    v_mfma_f32_16x16x32_bf16 a[32:35], a[200:203], v[196:199], a[32:35]
    s_waitcnt lgkmcnt(4)
    v_exp_f32 v49, v133
    v_mfma_f32_16x16x32_bf16 a[64:67], a[208:211], v[196:199], a[64:67]
    s_lshl_b32 s36, s3, 10
    ds_read_b64_tr_b16 a[200:201], v8 offset:2048
    v_cvt_pk_bf16_f32 v228, v48, v49
    v_mfma_f32_16x16x32_bf16 a[80:83], a[212:215], v[196:199], a[80:83]
    s_add_u32 m0, s49, 27648
    ds_read_b64_tr_b16 a[202:203], v8 offset:8192
    v_add_f32 v24, v48, v49
    v_mfma_f32_16x16x32_bf16 a[84:87], a[212:215], v[204:207], a[84:87]
    buffer_load_dwordx4 v5, s[12:15], s38 offen offset:0 lds
    v_mfma_f32_16x16x32_bf16 a[68:71], a[208:211], v[204:207], a[68:71]
    v_exp_f32 v50, v134
    v_mfma_f32_16x16x32_bf16 a[72:75], a[208:211], v[212:215], a[72:75]
    ds_read_b64_tr_b16 a[204:205], v9 offset:2048
    v_add_f32 v24, v24, v50
    v_mfma_f32_16x16x32_bf16 a[88:91], a[212:215], v[212:215], a[88:91]
    s_add_u32 m0, s49, 28544
    ds_read_b64_tr_b16 a[206:207], v9 offset:8192
    v_mfma_f32_16x16x32_bf16 a[92:95], a[212:215], v[220:223], a[92:95]
    buffer_load_dwordx4 v5, s[12:15], s38 offen offset:128 lds
    v_mfma_f32_16x16x32_bf16 a[76:79], a[208:211], v[220:223], a[76:79]
    s_waitcnt lgkmcnt(4)
    v_exp_f32 v51, v135
    v_mfma_f32_16x16x32_bf16 a[108:111], a[192:195], v[220:223], a[108:111]
    ds_read_b64_tr_b16 a[208:209], v10 offset:2048
    v_cvt_pk_bf16_f32 v229, v50, v51
    v_mfma_f32_16x16x32_bf16 a[124:127], a[196:199], v[220:223], a[124:127]
    s_add_u32 m0, s49, 29440
    ds_read_b64_tr_b16 a[210:211], v10 offset:8192
    v_add_f32 v24, v24, v51
    v_mfma_f32_16x16x32_bf16 a[120:123], a[196:199], v[212:215], a[120:123]
    buffer_load_dwordx4 v5, s[12:15], s76 offen offset:256 lds
    v_mfma_f32_16x16x32_bf16 a[104:107], a[192:195], v[212:215], a[104:107]
    s_add_u32 s38, s35, 0
    v_exp_f32 v52, v164
    v_mfma_f32_16x16x32_bf16 a[100:103], a[192:195], v[204:207], a[100:103]
    s_add_u32 s57, s33, 40960
    ds_read_b64_tr_b16 a[212:213], v11 offset:2048
    v_add_f32 v24, v24, v52
    v_mfma_f32_16x16x32_bf16 a[116:119], a[196:199], v[204:207], a[116:119]
    s_cmp_lt_u32 s3, 2
    s_cselect_b32 s38, s38, s57
    ds_read_b64_tr_b16 a[214:215], v11 offset:8192
    v_mfma_f32_16x16x32_bf16 a[112:115], a[196:199], v[196:199], a[112:115]
    s_add_u32 s76, s38, s63
    v_exp_f32 v53, v165
    v_mfma_f32_16x16x32_bf16 a[96:99], a[192:195], v[196:199], a[96:99]
    s_waitcnt lgkmcnt(4)
    v_exp_f32 v54, v166
    v_mfma_f32_16x16x32_bf16 a[128:131], a[200:203], v[196:199], a[128:131]
    s_add_u32 m0, s49, 73728
    ds_read_b64_tr_b16 a[192:193], v8 offset:12288
    v_cvt_pk_bf16_f32 v230, v52, v53
    v_mfma_f32_16x16x32_bf16 a[144:147], a[204:207], v[196:199], a[144:147]
pg_7:
    s_cbranch_execz pg_11
    ds_read_b64_tr_b16 a[194:195], v8 offset:18432
    v_add_f32 v24, v24, v53
    v_mfma_f32_16x16x32_bf16 a[148:151], a[204:207], v[204:207], a[148:151]
    buffer_load_dwordx4 v4, s[12:15], s38 offen offset:0 lds
    v_mfma_f32_16x16x32_bf16 a[132:135], a[200:203], v[204:207], a[132:135]
    v_exp_f32 v55, v167
    v_mfma_f32_16x16x32_bf16 a[136:139], a[200:203], v[212:215], a[136:139]
    s_add_u32 m0, s49, 74624
    ds_read_b64_tr_b16 a[196:197], v9 offset:12288
    v_add_f32 v24, v24, v54
    v_mfma_f32_16x16x32_bf16 a[152:155], a[204:207], v[212:215], a[152:155]
    ds_read_b64_tr_b16 a[198:199], v9 offset:18432
    v_cvt_pk_bf16_f32 v231, v54, v55
    v_mfma_f32_16x16x32_bf16 a[156:159], a[204:207], v[220:223], a[156:159]
    buffer_load_dwordx4 v4, s[12:15], s38 offen offset:128 lds
    v_mfma_f32_16x16x32_bf16 a[140:143], a[200:203], v[220:223], a[140:143]
    s_waitcnt lgkmcnt(4)
    v_exp_f32 v48, v140
    v_mfma_f32_16x16x32_bf16 a[172:175], a[208:211], v[220:223], a[172:175]
    ds_read_b64_tr_b16 a[200:201], v10 offset:12288
    v_add_f32 v24, v24, v55
    v_mfma_f32_16x16x32_bf16 a[188:191], a[212:215], v[220:223], a[188:191]
    s_add_u32 m0, s49, 75520
    ds_read_b64_tr_b16 a[202:203], v10 offset:18432
    v_mfma_f32_16x16x32_bf16 a[184:187], a[212:215], v[212:215], a[184:187]
    buffer_load_dwordx4 v4, s[12:15], s76 offen offset:256 lds
    v_mfma_f32_16x16x32_bf16 a[168:171], a[208:211], v[212:215], a[168:171]
    v_exp_f32 v49, v141
    v_mfma_f32_16x16x32_bf16 a[164:167], a[208:211], v[204:207], a[164:167]
    ds_read_b64_tr_b16 a[204:205], v11 offset:12288
    v_cvt_pk_bf16_f32 v236, v48, v49
    v_mfma_f32_16x16x32_bf16 a[180:183], a[212:215], v[204:207], a[180:183]
    ds_read_b64_tr_b16 a[206:207], v11 offset:18432
    v_add_f32 v25, v48, v49
    v_mfma_f32_16x16x32_bf16 a[176:179], a[212:215], v[196:199], a[176:179]
    s_add_u32 m0, s49, 76800
    v_exp_f32 v50, v142
    v_mfma_f32_16x16x32_bf16 a[160:163], a[208:211], v[196:199], a[160:163]
    s_waitcnt lgkmcnt(4)
    v_exp_f32 v51, v143
    v_add_f32 v25, v25, v50
    v_cvt_pk_bf16_f32 v237, v50, v51
    v_exp_f32 v52, v172
    v_exp_f32 v53, v173
    v_add_f32 v25, v25, v51
    v_cvt_pk_bf16_f32 v238, v52, v53
    v_exp_f32 v54, v174
    v_exp_f32 v55, v175
    v_add_f32 v25, v25, v52
    v_cvt_pk_bf16_f32 v239, v54, v55
    v_add_f32 v25, v25, v53
    v_add_f32 v25, v25, v54
    v_add_f32 v25, v25, v55
    v_exp_f32 v48, v148
    v_exp_f32 v49, v149
    v_exp_f32 v50, v150
    v_cvt_pk_bf16_f32 v244, v48, v49
    v_exp_f32 v51, v151
    v_add_f32 v26, v48, v49
    v_cvt_pk_bf16_f32 v245, v50, v51
    v_exp_f32 v52, v180
    v_exp_f32 v53, v181
    v_add_f32 v26, v26, v50
    v_cvt_pk_bf16_f32 v246, v52, v53
    v_exp_f32 v54, v182
    v_exp_f32 v55, v183
    v_add_f32 v26, v26, v51
    v_cvt_pk_bf16_f32 v247, v54, v55
    v_add_f32 v26, v26, v52
    v_add_f32 v26, v26, v53
    v_add_f32 v26, v26, v54
    v_add_f32 v26, v26, v55
    v_max3_f32 v29, v24, v25, v26
    v_exp_f32 v48, v156
    v_exp_f32 v49, v157
    v_exp_f32 v50, v158
    v_cvt_pk_bf16_f32 v252, v48, v49
    v_exp_f32 v51, v159
    v_add_f32 v27, v48, v49
    v_cvt_pk_bf16_f32 v253, v50, v51
    v_exp_f32 v52, v188
    v_exp_f32 v53, v189
    v_add_f32 v27, v27, v50
    v_cvt_pk_bf16_f32 v254, v52, v53
    v_exp_f32 v54, v190
    v_exp_f32 v55, v191
    v_add_f32 v27, v27, v51
    v_cvt_pk_bf16_f32 v255, v54, v55
    v_add_f32 v27, v27, v52
    v_add_f32 v27, v27, v53
    v_add_f32 v27, v27, v54
    v_add_f32 v27, v27, v55
    v_max_f32 v29, v29, v27
    v_cmp_nle_f32 vcc, v29, v30
    s_cbranch_vccnz rare_e
rare_e_ret:
    v_mfma_f32_16x16x32_bf16 a[0:3], a[192:195], v[228:231], a[0:3]
    ds_read_b64_tr_b16 a[208:209], v8 offset:13312
    v_add_f32 v20, v20, v24
    v_mfma_f32_16x16x32_bf16 a[16:19], a[196:199], v[228:231], a[16:19]
    ds_read_b64_tr_b16 a[210:211], v8 offset:19456
    v_add_f32 v21, v21, v25
    v_mfma_f32_16x16x32_bf16 a[20:23], a[196:199], v[236:239], a[20:23]
    buffer_load_dwordx4 v5, s[12:15], s38 offen offset:0 lds
    v_mfma_f32_16x16x32_bf16 a[4:7], a[192:195], v[236:239], a[4:7]
    s_add_u32 m0, s49, 77696
    v_add_f32 v22, v22, v26
    v_add_f32 v23, v23, v27
    v_mfma_f32_16x16x32_bf16 a[8:11], a[192:195], v[244:247], a[8:11]
    ds_read_b64_tr_b16 a[212:213], v9 offset:13312
    v_mov_b32 v56, v20
    v_mfma_f32_16x16x32_bf16 a[24:27], a[196:199], v[244:247], a[24:27]
    ds_read_b64_tr_b16 a[214:215], v9 offset:19456
    v_mov_b32 v57, v21
    v_mfma_f32_16x16x32_bf16 a[28:31], a[196:199], v[252:255], a[28:31]
    buffer_load_dwordx4 v5, s[12:15], s38 offen offset:128 lds
    v_mfma_f32_16x16x32_bf16 a[12:15], a[192:195], v[252:255], a[12:15]
    s_waitcnt lgkmcnt(4)
    v_permlane16_swap_b32 v20, v56
    v_mfma_f32_16x16x32_bf16 a[44:47], a[200:203], v[252:255], a[44:47]
    s_add_u32 m0, s49, 78592
    ds_read_b64_tr_b16 a[192:193], v10 offset:13312
    v_add_f32 v20, v20, v56
    v_mfma_f32_16x16x32_bf16 a[60:63], a[204:207], v[252:255], a[60:63]
    ds_read_b64_tr_b16 a[194:195], v10 offset:19456
    v_mov_b32 v56, v20
    v_mfma_f32_16x16x32_bf16 a[56:59], a[204:207], v[244:247], a[56:59]
    buffer_load_dwordx4 v5, s[12:15], s76 offen offset:256 lds
    v_mfma_f32_16x16x32_bf16 a[40:43], a[200:203], v[244:247], a[40:43]
    v_permlane32_swap_b32 v20, v56
    v_mfma_f32_16x16x32_bf16 a[36:39], a[200:203], v[236:239], a[36:39]
    s_waitcnt vmcnt(12)
    ds_read_b64_tr_b16 a[196:197], v11 offset:13312
    v_cmp_ne_u32 vcc, s7, v61
    v_mfma_f32_16x16x32_bf16 a[52:55], a[204:207], v[236:239], a[52:55]
    s_lshl_b32 s11, s54, 16
    ds_read_b64_tr_b16 a[198:199], v11 offset:19456
    v_add_f32 v20, v20, v56
    v_mfma_f32_16x16x32_bf16 a[48:51], a[204:207], v[228:231], a[48:51]
    s_cbranch_vccnz spin_gu
spin_gu_ret:
    v_mul_f32 v20, 0x3c800000, v20
    v_mfma_f32_16x16x32_bf16 a[32:35], a[200:203], v[228:231], a[32:35]
    s_waitcnt lgkmcnt(4)
    v_rcp_f32 v20, v20
    v_mfma_f32_16x16x32_bf16 a[64:67], a[208:211], v[228:231], a[64:67]
    s_nop 0
    ds_read_b64_tr_b16 a[200:201], v8 offset:14336
    v_mov_b32 v58, v22
    v_mfma_f32_16x16x32_bf16 a[80:83], a[212:215], v[228:231], a[80:83]
    s_lshl_b32 s61, s47, 10
    ds_read_b64_tr_b16 a[202:203], v8 offset:20480
    v_mov_b32 v59, v23
    v_mfma_f32_16x16x32_bf16 a[84:87], a[212:215], v[236:239], a[84:87]
    s_add_u32 s61, s61, 3276800
    v_permlane16_swap_b32 v21, v57
    v_mfma_f32_16x16x32_bf16 a[68:71], a[208:211], v[236:239], a[68:71]
    s_add_u32 s56, s3, 0
    v_permlane16_swap_b32 v22, v58
    v_mfma_f32_16x16x32_bf16 a[72:75], a[208:211], v[244:247], a[72:75]
    s_min_u32 s56, s56, 9
    ds_read_b64_tr_b16 a[204:205], v9 offset:14336
    v_add_f32 v21, v21, v57
    v_mfma_f32_16x16x32_bf16 a[88:91], a[212:215], v[244:247], a[88:91]
    s_mul_i32 s57, s56, 24576
    ds_read_b64_tr_b16 a[206:207], v9 offset:20480
    v_mov_b32 v57, v21
    v_mfma_f32_16x16x32_bf16 a[92:95], a[212:215], v[252:255], a[92:95]
    s_add_u32 s57, s57, s61
    v_permlane32_swap_b32 v21, v57
    v_mfma_f32_16x16x32_bf16 a[76:79], a[208:211], v[252:255], a[76:79]
    s_waitcnt lgkmcnt(4)
    v_permlane16_swap_b32 v23, v59
    v_mfma_f32_16x16x32_bf16 a[108:111], a[192:195], v[252:255], a[108:111]
    s_lshl_b32 s56, s56, 10
    ds_read_b64_tr_b16 a[208:209], v10 offset:14336
    v_add_f32 v21, v21, v57
    v_mfma_f32_16x16x32_bf16 a[124:127], a[196:199], v[252:255], a[124:127]
    s_add_u32 m0, s56, 147456
    ds_read_b64_tr_b16 a[210:211], v10 offset:20480
    v_mul_f32 v21, 0x3c800000, v21
    v_mfma_f32_16x16x32_bf16 a[120:123], a[196:199], v[244:247], a[120:123]
    buffer_load_dwordx4 v28, s[24:27], s57 offen sc1 lds
    v_mfma_f32_16x16x32_bf16 a[104:107], a[192:195], v[244:247], a[104:107]
    s_add_u32 s56, s3, 4
    v_rcp_f32 v21, v21
    v_mfma_f32_16x16x32_bf16 a[100:103], a[192:195], v[236:239], a[100:103]
    s_min_u32 s56, s56, 9
    ds_read_b64_tr_b16 a[212:213], v11 offset:14336
    v_add_f32 v22, v22, v58
    v_mfma_f32_16x16x32_bf16 a[116:119], a[196:199], v[236:239], a[116:119]
    s_waitcnt vmcnt(34)
    ds_read_b64_tr_b16 a[214:215], v11 offset:20480
    v_mov_b32 v58, v22
    v_mfma_f32_16x16x32_bf16 a[112:115], a[196:199], v[228:231], a[112:115]
    s_barrier
    v_mfma_f32_16x16x32_bf16 a[96:99], a[192:195], v[228:231], a[96:99]
    s_waitcnt lgkmcnt(4)
    v_permlane32_swap_b32 v22, v58
    v_add_u32 v8, 49152, v12
    v_mfma_f32_16x16x32_bf16 a[128:131], a[200:203], v[228:231], a[128:131]
    s_mul_i32 s57, s56, 24576
    ds_read_b64_tr_b16 a[192:193], v8 offset:0
    v_add_f32 v22, v22, v58
    v_mfma_f32_16x16x32_bf16 a[144:147], a[204:207], v[228:231], a[144:147]
    s_add_u32 s57, s57, s61
    ds_read_b64_tr_b16 a[194:195], v8 offset:6144
    v_mul_f32 v22, 0x3c800000, v22
    v_mfma_f32_16x16x32_bf16 a[148:151], a[204:207], v[236:239], a[148:151]
    s_lshl_b32 s56, s56, 10
    v_rcp_f32 v22, v22
    v_mfma_f32_16x16x32_bf16 a[132:135], a[200:203], v[236:239], a[132:135]
    s_add_u32 m0, s56, 147456
    v_add_f32 v23, v23, v59
    v_mov_b32 v59, v23
    v_add_u32 v9, 49152, v13
    v_mfma_f32_16x16x32_bf16 a[136:139], a[200:203], v[244:247], a[136:139]
    s_and_b32 s72, s3, 1
    ds_read_b64_tr_b16 a[196:197], v9 offset:0
    v_add_u32 v10, 49152, v14
    v_mfma_f32_16x16x32_bf16 a[152:155], a[204:207], v[244:247], a[152:155]
    s_lshl_b32 s72, s72, 14
    ds_read_b64_tr_b16 a[198:199], v9 offset:6144
    v_add_u32 v11, 49152, v15
    v_mfma_f32_16x16x32_bf16 a[156:159], a[204:207], v[252:255], a[156:159]
    buffer_load_dwordx4 v28, s[24:27], s57 offen sc1 lds
    v_mfma_f32_16x16x32_bf16 a[140:143], a[200:203], v[252:255], a[140:143]
    s_waitcnt lgkmcnt(4)
    v_permlane32_swap_b32 v23, v59
    v_mfma_f32_16x16x32_bf16 a[172:175], a[208:211], v[252:255], a[172:175]
    s_add_u32 s56, s3, 8
    ds_read_b64_tr_b16 a[200:201], v10 offset:0
    v_add_f32 v23, v23, v59
    v_mfma_f32_16x16x32_bf16 a[188:191], a[212:215], v[252:255], a[188:191]
    s_min_u32 s56, s56, 9
    ds_read_b64_tr_b16 a[202:203], v10 offset:6144
    v_mul_f32 v23, 0x3c800000, v23
    v_mfma_f32_16x16x32_bf16 a[184:187], a[212:215], v[244:247], a[184:187]
    s_mul_i32 s57, s56, 24576
    v_rcp_f32 v23, v23
    v_mfma_f32_16x16x32_bf16 a[168:171], a[208:211], v[244:247], a[168:171]
    s_add_u32 s57, s57, s61
    v_xor_b32 v18, s39, v8
    v_xor_b32 v19, s39, v9
    v_mfma_f32_16x16x32_bf16 a[164:167], a[208:211], v[236:239], a[164:167]
    s_lshl_b32 s56, s56, 10
    ds_read_b64_tr_b16 a[204:205], v11 offset:0
    v_accvgpr_read_b32 v64, a0
    v_mfma_f32_16x16x32_bf16 a[180:183], a[212:215], v[236:239], a[180:183]
    s_add_u32 m0, s56, 147456
    ds_read_b64_tr_b16 a[206:207], v11 offset:6144
    v_accvgpr_read_b32 v65, a1
    v_accvgpr_read_b32 v24, a18
    v_fma_f32 v24, v24, v20, -v20
    v_accvgpr_read_b32 v25, a19
    v_fma_f32 v25, v25, v20, -v20
    v_accvgpr_read_b32 v66, a2
    v_fma_f32 v66, v66, v20, -v20
    v_accvgpr_read_b32 v67, a3
    v_fma_f32 v67, v67, v20, -v20
    v_fma_f32 v64, v64, v20, -v20
    v_fma_f32 v65, v65, v20, -v20
    v_cvt_pk_bf16_f32 v64, v64, v65
    v_cvt_pk_bf16_f32 v65, v66, v67
    v_accvgpr_read_b32 v66, a16
    v_fma_f32 v66, v66, v20, -v20
    v_accvgpr_read_b32 v67, a17
    v_fma_f32 v67, v67, v20, -v20
    v_cvt_pk_bf16_f32 v66, v66, v67
    v_cvt_pk_bf16_f32 v67, v24, v25
    v_accvgpr_read_b32 v26, a22
    v_fma_f32 v26, v26, v21, -v21
    v_accvgpr_read_b32 v27, a23
    v_fma_f32 v27, v27, v21, -v21
    v_accvgpr_read_b32 v74, a6
    v_fma_f32 v74, v74, v21, -v21
    v_accvgpr_read_b32 v75, a7
    v_fma_f32 v75, v75, v21, -v21
    v_accvgpr_read_b32 v72, a4
    v_fma_f32 v72, v72, v21, -v21
    v_accvgpr_read_b32 v73, a5
    v_fma_f32 v73, v73, v21, -v21
    v_cvt_pk_bf16_f32 v72, v72, v73
    v_cvt_pk_bf16_f32 v73, v74, v75
    v_accvgpr_read_b32 v74, a20
    v_fma_f32 v74, v74, v21, -v21
    v_accvgpr_read_b32 v75, a21
    v_fma_f32 v75, v75, v21, -v21
    v_cvt_pk_bf16_f32 v74, v74, v75
    v_cvt_pk_bf16_f32 v75, v26, v27
    v_accvgpr_read_b32 v30, a26
    v_fma_f32 v30, v30, v22, -v22
    v_accvgpr_read_b32 v31, a27
    v_fma_f32 v31, v31, v22, -v22
    v_accvgpr_read_b32 v82, a10
    v_fma_f32 v82, v82, v22, -v22
    v_accvgpr_read_b32 v83, a11
    v_fma_f32 v83, v83, v22, -v22
    v_accvgpr_read_b32 v80, a8
    v_fma_f32 v80, v80, v22, -v22
    v_accvgpr_read_b32 v81, a9
    v_fma_f32 v81, v81, v22, -v22
    v_cvt_pk_bf16_f32 v80, v80, v81
    v_cvt_pk_bf16_f32 v81, v82, v83
    v_accvgpr_read_b32 v82, a24
    v_fma_f32 v82, v82, v22, -v22
    v_accvgpr_read_b32 v83, a25
    v_fma_f32 v83, v83, v22, -v22
    v_cvt_pk_bf16_f32 v82, v82, v83
    v_cvt_pk_bf16_f32 v83, v30, v31
    v_accvgpr_read_b32 v24, a30
    v_fma_f32 v24, v24, v23, -v23
    v_accvgpr_read_b32 v25, a31
    v_fma_f32 v25, v25, v23, -v23
    v_accvgpr_read_b32 v90, a14
    v_fma_f32 v90, v90, v23, -v23
    v_accvgpr_read_b32 v91, a15
    v_fma_f32 v91, v91, v23, -v23
    v_accvgpr_read_b32 v88, a12
    v_fma_f32 v88, v88, v23, -v23
    v_accvgpr_read_b32 v89, a13
    v_fma_f32 v89, v89, v23, -v23
    v_cvt_pk_bf16_f32 v88, v88, v89
    v_cvt_pk_bf16_f32 v89, v90, v91
    v_accvgpr_read_b32 v90, a28
    v_fma_f32 v90, v90, v23, -v23
    v_accvgpr_read_b32 v91, a29
    v_fma_f32 v91, v91, v23, -v23
    v_cvt_pk_bf16_f32 v90, v90, v91
    v_cvt_pk_bf16_f32 v91, v24, v25
    v_mfma_f32_16x16x32_bf16 a[176:179], a[212:215], v[228:231], a[176:179]
    buffer_load_dwordx4 v28, s[24:27], s57 offen sc1 lds
    v_mfma_f32_16x16x32_bf16 a[160:163], a[208:211], v[228:231], a[160:163]
    s_waitcnt lgkmcnt(4)
    v_accvgpr_read_b32 v96, a32
    v_accvgpr_read_b32 v97, a33
    v_mfma_f32_16x16x32_bf16 a[224:227], a[192:195], v[64:67], 0.5
    s_add_u32 s38, s34, 40960
    ds_read_b64_tr_b16 a[208:209], v8 offset:1024
    v_accvgpr_read_b32 v98, a34
    v_mfma_f32_16x16x32_bf16 a[240:243], a[196:199], v[64:67], 0.5
    s_add_u32 s57, s35, 40960
    ds_read_b64_tr_b16 a[210:211], v8 offset:7168
    v_accvgpr_read_b32 v99, a35
    v_mfma_f32_16x16x32_bf16 a[244:247], a[196:199], v[72:75], 0.5
    buffer_store_dwordx4 v[64:67], v28, s[20:23], s55 offen offset:0 sc1
    v_mfma_f32_16x16x32_bf16 a[228:231], a[192:195], v[72:75], 0.5
    s_cmp_lt_u32 s3, 2
    s_cselect_b32 s38, s38, s57
    v_fma_f32 v96, v96, v20, -v20
    v_mfma_f32_16x16x32_bf16 a[232:235], a[192:195], v[80:83], 0.5
    s_add_u32 s76, s38, s63
    ds_read_b64_tr_b16 a[212:213], v9 offset:1024
    v_fma_f32 v97, v97, v20, -v20
    v_mfma_f32_16x16x32_bf16 a[248:251], a[196:199], v[80:83], 0.5
    s_add_u32 m0, s49, 98304
    ds_read_b64_tr_b16 a[214:215], v9 offset:7168
    v_fma_f32 v98, v98, v20, -v20
    v_mfma_f32_16x16x32_bf16 a[252:255], a[196:199], v[88:91], 0.5
    buffer_store_dwordx4 v[72:75], v28, s[20:23], s55 offen offset:1024 sc1
    v_mfma_f32_16x16x32_bf16 a[236:239], a[192:195], v[88:91], 0.5
    s_waitcnt lgkmcnt(4)
    v_fma_f32 v99, v99, v20, -v20
    v_cvt_pk_bf16_f32 v96, v96, v97
    buffer_store_dwordx4 v[80:83], v28, s[20:23], s55 offen offset:2048 sc1
    buffer_store_dwordx4 v[88:91], v28, s[20:23], s55 offen offset:3072 sc1
    v_accvgpr_read_b32 v26, a50
    v_fma_f32 v26, v26, v20, -v20
    v_accvgpr_read_b32 v27, a51
    v_fma_f32 v27, v27, v20, -v20
    v_cvt_pk_bf16_f32 v97, v98, v99
    v_accvgpr_read_b32 v98, a48
    v_fma_f32 v98, v98, v20, -v20
    v_accvgpr_read_b32 v99, a49
    v_fma_f32 v99, v99, v20, -v20
    v_cvt_pk_bf16_f32 v98, v98, v99
    v_cvt_pk_bf16_f32 v99, v26, v27
    v_mfma_f32_16x16x32_bf16 v[92:95], a[200:203], v[88:91], 0.5
    s_add_u32 s55, s55, 4096
    ds_read_b64_tr_b16 a[192:193], v10 offset:1024
    v_accvgpr_read_b32 v104, a36
    v_mfma_f32_16x16x32_bf16 v[124:127], a[204:207], v[88:91], 0.5
    s_or_b32 s11, s11, s72
    ds_read_b64_tr_b16 a[194:195], v10 offset:7168
    v_accvgpr_read_b32 v105, a37
    v_mfma_f32_16x16x32_bf16 v[116:119], a[204:207], v[80:83], 0.5
    s_lshr_b32 s73, s93, 8
    v_accvgpr_read_b32 v106, a38
    v_accvgpr_read_b32 v107, a39
    v_mfma_f32_16x16x32_bf16 v[84:87], a[200:203], v[80:83], 0.5
    s_add_u32 s8, s51, 1
    v_fma_f32 v104, v104, v21, -v21
    v_fma_f32 v105, v105, v21, -v21
    v_mfma_f32_16x16x32_bf16 v[76:79], a[200:203], v[72:75], 0.5
    s_and_b32 s8, s8, 3
    ds_read_b64_tr_b16 a[196:197], v11 offset:1024
    v_fma_f32 v106, v106, v21, -v21
    v_mfma_f32_16x16x32_bf16 v[108:111], a[204:207], v[72:75], 0.5
    s_lshr_b32 s72, s73, s8
    ds_read_b64_tr_b16 a[198:199], v11 offset:7168
    v_fma_f32 v107, v107, v21, -v21
    v_mfma_f32_16x16x32_bf16 v[100:103], a[204:207], v[64:67], 0.5
    s_and_b32 s72, s72, 0x2000
    v_cvt_pk_bf16_f32 v104, v104, v105
    v_cvt_pk_bf16_f32 v105, v106, v107
    v_mfma_f32_16x16x32_bf16 v[68:71], a[200:203], v[64:67], 0.5
    s_waitcnt lgkmcnt(4)
    v_accvgpr_read_b32 v106, a52
    v_accvgpr_read_b32 v107, a53
    v_mfma_f32_16x16x32_bf16 v[132:135], a[208:211], v[64:67], 0.5
    s_mul_i32 s8, s8, 0x202000
    ds_read_b64_tr_b16 a[200:201], v18 offset:2048
    v_accvgpr_read_b32 v30, a54
    v_mfma_f32_16x16x32_bf16 v[164:167], a[212:215], v[64:67], 0.5
    s_xor_b32 s8, s8, s72
    ds_read_b64_tr_b16 a[202:203], v18 offset:8192
    v_accvgpr_read_b32 v31, a55
    v_fma_f32 v30, v30, v21, -v21
    v_fma_f32 v31, v31, v21, -v21
    v_fma_f32 v106, v106, v21, -v21
    v_fma_f32 v107, v107, v21, -v21
    v_cvt_pk_bf16_f32 v106, v106, v107
    v_cvt_pk_bf16_f32 v107, v30, v31
    v_mfma_f32_16x16x32_bf16 v[172:175], a[212:215], v[72:75], 0.5
    buffer_load_dwordx4 v4, s[12:15], s38 offen offset:0 lds
    v_mfma_f32_16x16x32_bf16 v[140:143], a[208:211], v[72:75], 0.5
    s_add_u32 m0, s49, 99200
    v_accvgpr_read_b32 v112, a40
    v_accvgpr_read_b32 v113, a41
    v_mfma_f32_16x16x32_bf16 v[148:151], a[208:211], v[80:83], 0.5
    s_and_b32 s8, s8, 6299648
    ds_read_b64_tr_b16 a[204:205], v19 offset:2048
    v_accvgpr_read_b32 v114, a42
    v_mfma_f32_16x16x32_bf16 v[180:183], a[212:215], v[80:83], 0.5
    s_xor_b32 s8, s8, s11
    ds_read_b64_tr_b16 a[206:207], v19 offset:8192
    v_accvgpr_read_b32 v115, a43
    v_mfma_f32_16x16x32_bf16 v[188:191], a[212:215], v[88:91], 0.5
    buffer_load_dwordx4 v4, s[12:15], s38 offen offset:128 lds
    v_mfma_f32_16x16x32_bf16 v[156:159], a[208:211], v[88:91], 0.5
    s_waitcnt lgkmcnt(4)
    v_fma_f32 v112, v112, v22, -v22
    v_fma_f32 v113, v113, v22, -v22
    v_mfma_f32_16x16x32_bf16 v[220:223], a[192:195], v[88:91], 0.5
    s_add_u32 m0, s49, 100096
    ds_read_b64_tr_b16 a[208:209], v8 offset:12288
    v_fma_f32 v114, v114, v22, -v22
    v_mfma_f32_16x16x32_bf16 v[252:255], a[196:199], v[88:91], 0.5
    s_add_u32 s9, s51, 2
    ds_read_b64_tr_b16 a[210:211], v8 offset:18432
    v_fma_f32 v115, v115, v22, -v22
    v_mfma_f32_16x16x32_bf16 v[244:247], a[196:199], v[80:83], 0.5
    s_and_b32 s9, s9, 3
    v_cvt_pk_bf16_f32 v112, v112, v113
    v_cvt_pk_bf16_f32 v113, v114, v115
    v_mfma_f32_16x16x32_bf16 v[212:215], a[192:195], v[80:83], 0.5
    buffer_store_dwordx4 v[96:99], v28, s[20:23], s55 offen offset:0 sc1
    v_accvgpr_read_b32 v24, a58
    v_fma_f32 v24, v24, v22, -v22
    v_accvgpr_read_b32 v25, a59
    v_fma_f32 v25, v25, v22, -v22
    v_accvgpr_read_b32 v114, a56
    v_fma_f32 v114, v114, v22, -v22
    v_accvgpr_read_b32 v115, a57
    v_fma_f32 v115, v115, v22, -v22
    v_cvt_pk_bf16_f32 v114, v114, v115
    v_cvt_pk_bf16_f32 v115, v24, v25
    v_mfma_f32_16x16x32_bf16 v[204:207], a[192:195], v[72:75], 0.5
    s_lshr_b32 s72, s73, s9
    ds_read_b64_tr_b16 a[212:213], v9 offset:12288
    v_accvgpr_read_b32 v120, a44
    v_mfma_f32_16x16x32_bf16 v[236:239], a[196:199], v[72:75], 0.5
    s_and_b32 s72, s72, 0x2000
    ds_read_b64_tr_b16 a[214:215], v9 offset:18432
    v_accvgpr_read_b32 v121, a45
    v_mfma_f32_16x16x32_bf16 v[228:231], a[196:199], v[64:67], 0.5
    s_mul_i32 s9, s9, 0x202000
    v_accvgpr_read_b32 v122, a46
    v_accvgpr_read_b32 v123, a47
    v_mfma_f32_16x16x32_bf16 v[196:199], a[192:195], v[64:67], 0.5
    s_waitcnt lgkmcnt(4)
    buffer_load_dwordx4 v4, s[12:15], s76 offen offset:256 lds
    v_mfma_f32_16x16x32_bf16 v[32:35], a[200:203], v[64:67], 0.5
    s_add_u32 m0, s49, 101376
    ds_read_b64_tr_b16 a[192:193], v10 offset:12288
    v_fma_f32 v120, v120, v23, -v23
    v_mfma_f32_16x16x32_bf16 v[48:51], a[204:207], v[64:67], 0.5
    s_xor_b32 s9, s9, s72
    ds_read_b64_tr_b16 a[194:195], v10 offset:18432
    v_fma_f32 v121, v121, v23, -v23
    v_mfma_f32_16x16x32_bf16 v[52:55], a[204:207], v[72:75], 0.5
    s_and_b32 s9, s9, 6299648
    v_fma_f32 v122, v122, v23, -v23
    v_fma_f32 v123, v123, v23, -v23
    v_mfma_f32_16x16x32_bf16 v[36:39], a[200:203], v[72:75], 0.5
    buffer_load_dwordx4 v5, s[12:15], s38 offen offset:0 lds
    v_mfma_f32_16x16x32_bf16 v[40:43], a[200:203], v[80:83], 0.5
    s_add_u32 m0, s49, 102272
    ds_read_b64_tr_b16 a[196:197], v11 offset:12288
    v_cvt_pk_bf16_f32 v120, v120, v121
    v_mfma_f32_16x16x32_bf16 v[56:59], a[204:207], v[80:83], 0.5
    s_xor_b32 s9, s9, s11
    ds_read_b64_tr_b16 a[198:199], v11 offset:18432
    v_cvt_pk_bf16_f32 v121, v122, v123
    v_accvgpr_read_b32 v26, a62
    v_fma_f32 v26, v26, v23, -v23
    v_accvgpr_read_b32 v27, a63
    v_fma_f32 v27, v27, v23, -v23
    v_accvgpr_read_b32 v122, a60
    v_fma_f32 v122, v122, v23, -v23
    v_accvgpr_read_b32 v123, a61
    v_fma_f32 v123, v123, v23, -v23
    v_cvt_pk_bf16_f32 v122, v122, v123
    v_cvt_pk_bf16_f32 v123, v26, v27
    v_mfma_f32_16x16x32_bf16 v[60:63], a[204:207], v[88:91], 0.5
    s_add_u32 s10, s51, 3
    v_accvgpr_read_b32 v128, a64
    v_accvgpr_read_b32 v129, a65
    v_mfma_f32_16x16x32_bf16 v[44:47], a[200:203], v[88:91], 0.5
    s_waitcnt lgkmcnt(4)
    buffer_load_dwordx4 v5, s[12:15], s38 offen offset:128 lds
    v_mfma_f32_16x16x32_bf16 a[236:239], a[208:211], v[120:123], a[236:239]
    s_add_u32 m0, s49, 103168
    ds_read_b64_tr_b16 a[200:201], v8 offset:13312
    v_accvgpr_read_b32 v130, a66
    v_mfma_f32_16x16x32_bf16 a[252:255], a[212:215], v[120:123], a[252:255]
    s_and_b32 s10, s10, 3
    ds_read_b64_tr_b16 a[202:203], v8 offset:19456
    v_accvgpr_read_b32 v131, a67
    v_mfma_f32_16x16x32_bf16 a[248:251], a[212:215], v[112:115], a[248:251]
    s_lshr_b32 s72, s73, s10
    v_fma_f32 v128, v128, v20, -v20
    v_fma_f32 v129, v129, v20, -v20
    v_mfma_f32_16x16x32_bf16 a[232:235], a[208:211], v[112:115], a[232:235]
    s_and_b32 s72, s72, 0x2000
    v_fma_f32 v130, v130, v20, -v20
    v_fma_f32 v131, v131, v20, -v20
    v_mfma_f32_16x16x32_bf16 a[228:231], a[208:211], v[104:107], a[228:231]
    s_mul_i32 s10, s10, 0x202000
    ds_read_b64_tr_b16 a[204:205], v9 offset:13312
    v_cvt_pk_bf16_f32 v128, v128, v129
    v_mfma_f32_16x16x32_bf16 a[244:247], a[212:215], v[104:107], a[244:247]
    s_xor_b32 s10, s10, s72
    ds_read_b64_tr_b16 a[206:207], v9 offset:19456
    v_cvt_pk_bf16_f32 v129, v130, v131
    v_mfma_f32_16x16x32_bf16 a[240:243], a[212:215], v[96:99], a[240:243]
    buffer_store_dwordx4 v[104:107], v28, s[20:23], s55 offen offset:1024 sc1
    v_mfma_f32_16x16x32_bf16 a[224:227], a[208:211], v[96:99], a[224:227]
    s_waitcnt lgkmcnt(4)
    v_accvgpr_read_b32 v130, a80
    v_accvgpr_read_b32 v131, a81
    v_accvgpr_read_b32 v30, a82
    v_fma_f32 v30, v30, v20, -v20
    v_accvgpr_read_b32 v31, a83
    v_fma_f32 v31, v31, v20, -v20
    v_fma_f32 v130, v130, v20, -v20
    v_fma_f32 v131, v131, v20, -v20
    v_cvt_pk_bf16_f32 v130, v130, v131
    v_cvt_pk_bf16_f32 v131, v30, v31
    v_mfma_f32_16x16x32_bf16 v[68:71], a[192:195], v[96:99], v[68:71]
    s_and_b32 s10, s10, 6299648
    ds_read_b64_tr_b16 a[208:209], v10 offset:13312
    v_add_u32 v8, 0, v12
    v_mfma_f32_16x16x32_bf16 v[100:103], a[196:199], v[96:99], v[100:103]
    s_xor_b32 s10, s10, s11
    ds_read_b64_tr_b16 a[210:211], v10 offset:19456
    v_accvgpr_read_b32 v136, a68
    v_mfma_f32_16x16x32_bf16 v[108:111], a[196:199], v[104:107], v[108:111]
    buffer_load_dwordx4 v5, s[12:15], s76 offen offset:256 lds
    v_mfma_f32_16x16x32_bf16 v[76:79], a[192:195], v[104:107], v[76:79]
    s_lshl_b32 s72, 1, s51
    v_mov_b32 v16, s72
    v_accvgpr_read_b32 v17, a223
    v_mfma_f32_16x16x32_bf16 v[84:87], a[192:195], v[112:115], v[84:87]
    s_mov_b32 s72, 0
    ds_read_b64_tr_b16 a[212:213], v11 offset:13312
    v_accvgpr_read_b32 v137, a69
    v_mfma_f32_16x16x32_bf16 v[116:119], a[196:199], v[112:115], v[116:119]
    ds_read_b64_tr_b16 a[214:215], v11 offset:19456
    v_accvgpr_read_b32 v138, a70
    v_mfma_f32_16x16x32_bf16 v[124:127], a[196:199], v[120:123], v[124:127]
    v_accvgpr_read_b32 v139, a71
    v_fma_f32 v136, v136, v21, -v21
    v_mfma_f32_16x16x32_bf16 v[92:95], a[192:195], v[120:123], v[92:95]
    s_waitcnt lgkmcnt(4)
    v_fma_f32 v137, v137, v21, -v21
    v_fma_f32 v138, v138, v21, -v21
    v_mfma_f32_16x16x32_bf16 v[156:159], a[200:203], v[120:123], v[156:159]
pg_8:
    s_cbranch_execz pg_12
    ds_read_b64_tr_b16 a[192:193], v18 offset:14336
    v_fma_f32 v139, v139, v21, -v21
    v_mfma_f32_16x16x32_bf16 v[188:191], a[204:207], v[120:123], v[188:191]
    ds_read_b64_tr_b16 a[194:195], v18 offset:20480
    v_cvt_pk_bf16_f32 v136, v136, v137
    v_accvgpr_read_b32 v24, a86
    v_fma_f32 v24, v24, v21, -v21
    v_accvgpr_read_b32 v25, a87
    v_fma_f32 v25, v25, v21, -v21
    v_cvt_pk_bf16_f32 v137, v138, v139
    v_accvgpr_read_b32 v138, a84
    v_fma_f32 v138, v138, v21, -v21
    v_accvgpr_read_b32 v139, a85
    v_fma_f32 v139, v139, v21, -v21
    v_cvt_pk_bf16_f32 v138, v138, v139
    v_cvt_pk_bf16_f32 v139, v24, v25
    v_mfma_f32_16x16x32_bf16 v[180:183], a[204:207], v[112:115], v[180:183]
    s_add_u32 s38, s33, 81920
    v_add_u32 v9, 0, v13
    v_add_u32 v10, 0, v14
    v_mfma_f32_16x16x32_bf16 v[148:151], a[200:203], v[112:115], v[148:151]
    s_add_u32 s57, s34, 81920
    v_accvgpr_read_b32 v144, a72
    v_accvgpr_read_b32 v145, a73
    v_mfma_f32_16x16x32_bf16 v[140:143], a[200:203], v[104:107], v[140:143]
    s_cmp_lt_u32 s3, 2
    s_cselect_b32 s38, s38, s57
    ds_read_b64_tr_b16 a[196:197], v19 offset:14336
    v_mfma_f32_16x16x32_bf16 v[172:175], a[204:207], v[104:107], v[172:175]
    s_waitcnt vmcnt(35)
    ds_read_b64_tr_b16 a[198:199], v19 offset:20480
    v_accvgpr_read_b32 v146, a74
    v_mfma_f32_16x16x32_bf16 v[164:167], a[204:207], v[96:99], v[164:167]
    s_barrier
    v_mfma_f32_16x16x32_bf16 v[132:135], a[200:203], v[96:99], v[132:135]
    s_waitcnt lgkmcnt(4)
    v_accvgpr_read_b32 v147, a75
    v_fma_f32 v144, v144, v22, -v22
    v_mfma_f32_16x16x32_bf16 v[196:199], a[208:211], v[96:99], v[196:199]
    s_add_u32 s76, s38, s63
    ds_read_b64_tr_b16 a[200:201], v8 offset:0
    v_fma_f32 v145, v145, v22, -v22
    v_mfma_f32_16x16x32_bf16 v[228:231], a[212:215], v[96:99], v[228:231]
    s_add_u32 m0, s49, 49152
    ds_read_b64_tr_b16 a[202:203], v8 offset:6144
    v_fma_f32 v146, v146, v22, -v22
    v_mfma_f32_16x16x32_bf16 v[236:239], a[212:215], v[104:107], v[236:239]
    buffer_store_dwordx4 v[112:115], v28, s[20:23], s55 offen offset:2048 sc1
    v_mfma_f32_16x16x32_bf16 v[204:207], a[208:211], v[104:107], v[204:207]
    s_waitcnt vmcnt(9)
    v_fma_f32 v147, v147, v22, -v22
    v_cvt_pk_bf16_f32 v144, v144, v145
    v_accvgpr_read_b32 v26, a90
    v_fma_f32 v26, v26, v22, -v22
    v_accvgpr_read_b32 v27, a91
    v_fma_f32 v27, v27, v22, -v22
    v_cvt_pk_bf16_f32 v145, v146, v147
    v_accvgpr_read_b32 v146, a88
    v_fma_f32 v146, v146, v22, -v22
    v_accvgpr_read_b32 v147, a89
    v_fma_f32 v147, v147, v22, -v22
    v_cvt_pk_bf16_f32 v146, v146, v147
    v_cvt_pk_bf16_f32 v147, v26, v27
    v_mfma_f32_16x16x32_bf16 v[212:215], a[208:211], v[112:115], v[212:215]
    ds_read_b64_tr_b16 a[204:205], v9 offset:0
    v_add_u32 v11, 0, v15
    v_mfma_f32_16x16x32_bf16 v[244:247], a[212:215], v[112:115], v[244:247]
    ds_read_b64_tr_b16 a[206:207], v9 offset:6144
    v_xor_b32 v18, s39, v8
    v_mfma_f32_16x16x32_bf16 v[252:255], a[212:215], v[120:123], v[252:255]
    buffer_atomic_or v16, v17, s[24:27], 0 offen
    v_mfma_f32_16x16x32_bf16 v[220:223], a[208:211], v[120:123], v[220:223]
    s_waitcnt lgkmcnt(4)
    buffer_load_dwordx4 v4, s[12:15], s38 offen offset:0 lds
    v_mfma_f32_16x16x32_bf16 v[44:47], a[192:195], v[120:123], v[44:47]
    s_add_u32 m0, s49, 50048
    ds_read_b64_tr_b16 a[208:209], v10 offset:0
    v_xor_b32 v19, s39, v9
    v_mfma_f32_16x16x32_bf16 v[60:63], a[196:199], v[120:123], v[60:63]
    ds_read_b64_tr_b16 a[210:211], v10 offset:6144
    v_accvgpr_read_b32 v152, a76
    v_mfma_f32_16x16x32_bf16 v[56:59], a[196:199], v[112:115], v[56:59]
    buffer_load_dwordx4 v4, s[12:15], s38 offen offset:128 lds
    v_mfma_f32_16x16x32_bf16 v[40:43], a[192:195], v[112:115], v[40:43]
    s_add_u32 m0, s49, 50944
    v_accvgpr_read_b32 v153, a77
    v_accvgpr_read_b32 v154, a78
    v_mfma_f32_16x16x32_bf16 v[36:39], a[192:195], v[104:107], v[36:39]
    ds_read_b64_tr_b16 a[212:213], v11 offset:0
    v_accvgpr_read_b32 v155, a79
    v_mfma_f32_16x16x32_bf16 v[52:55], a[196:199], v[104:107], v[52:55]
    ds_read_b64_tr_b16 a[214:215], v11 offset:6144
    v_fma_f32 v152, v152, v23, -v23
    v_accvgpr_read_b32 v30, a94
    v_fma_f32 v30, v30, v23, -v23
    v_accvgpr_read_b32 v31, a95
    v_fma_f32 v31, v31, v23, -v23
    v_fma_f32 v154, v154, v23, -v23
    v_fma_f32 v155, v155, v23, -v23
    v_fma_f32 v153, v153, v23, -v23
    v_cvt_pk_bf16_f32 v152, v152, v153
    v_cvt_pk_bf16_f32 v153, v154, v155
    v_accvgpr_read_b32 v154, a92
    v_fma_f32 v154, v154, v23, -v23
    v_accvgpr_read_b32 v155, a93
    v_fma_f32 v155, v155, v23, -v23
    v_cvt_pk_bf16_f32 v154, v154, v155
    v_cvt_pk_bf16_f32 v155, v30, v31
    v_mfma_f32_16x16x32_bf16 v[48:51], a[196:199], v[96:99], v[48:51]
    buffer_load_dwordx4 v4, s[12:15], s76 offen offset:256 lds
    v_mfma_f32_16x16x32_bf16 v[32:35], a[192:195], v[96:99], v[32:35]
    s_waitcnt lgkmcnt(4)
    v_accvgpr_read_b32 v160, a96
    v_accvgpr_read_b32 v161, a97
    v_mfma_f32_16x16x32_bf16 a[224:227], a[200:203], v[128:131], a[224:227]
    s_add_u32 m0, s49, 52224
    ds_read_b64_tr_b16 a[192:193], v8 offset:1024
    v_accvgpr_read_b32 v162, a98
    v_mfma_f32_16x16x32_bf16 a[240:243], a[204:207], v[128:131], a[240:243]
    ds_read_b64_tr_b16 a[194:195], v8 offset:7168
    v_accvgpr_read_b32 v163, a99
    v_mfma_f32_16x16x32_bf16 a[244:247], a[204:207], v[136:139], a[244:247]
    buffer_load_dwordx4 v5, s[12:15], s38 offen offset:0 lds
    v_mfma_f32_16x16x32_bf16 a[228:231], a[200:203], v[136:139], a[228:231]
    s_add_u32 m0, s49, 53120
    v_fma_f32 v160, v160, v20, -v20
    v_fma_f32 v161, v161, v20, -v20
    v_mfma_f32_16x16x32_bf16 a[232:235], a[200:203], v[144:147], a[232:235]
    ds_read_b64_tr_b16 a[196:197], v9 offset:1024
    v_fma_f32 v162, v162, v20, -v20
    v_mfma_f32_16x16x32_bf16 a[248:251], a[204:207], v[144:147], a[248:251]
    ds_read_b64_tr_b16 a[198:199], v9 offset:7168
    v_fma_f32 v163, v163, v20, -v20
    v_mfma_f32_16x16x32_bf16 a[252:255], a[204:207], v[152:155], a[252:255]
    v_cvt_pk_bf16_f32 v160, v160, v161
    v_cvt_pk_bf16_f32 v161, v162, v163
    v_mfma_f32_16x16x32_bf16 a[236:239], a[200:203], v[152:155], a[236:239]
    s_waitcnt lgkmcnt(4)
    buffer_load_dwordx4 v5, s[12:15], s38 offen offset:128 lds
    v_accvgpr_read_b32 v24, a114
    v_fma_f32 v24, v24, v20, -v20
    v_accvgpr_read_b32 v25, a115
    v_fma_f32 v25, v25, v20, -v20
    v_accvgpr_read_b32 v162, a112
    v_fma_f32 v162, v162, v20, -v20
    v_accvgpr_read_b32 v163, a113
    v_fma_f32 v163, v163, v20, -v20
    v_cvt_pk_bf16_f32 v162, v162, v163
    v_cvt_pk_bf16_f32 v163, v24, v25
    v_mfma_f32_16x16x32_bf16 v[92:95], a[208:211], v[152:155], v[92:95]
    s_add_u32 m0, s49, 54016
    ds_read_b64_tr_b16 a[200:201], v10 offset:1024
    v_accvgpr_read_b32 v168, a100
    v_mfma_f32_16x16x32_bf16 v[124:127], a[212:215], v[152:155], v[124:127]
    ds_read_b64_tr_b16 a[202:203], v10 offset:7168
    v_accvgpr_read_b32 v169, a101
    v_mfma_f32_16x16x32_bf16 v[116:119], a[212:215], v[144:147], v[116:119]
    v_accvgpr_read_b32 v170, a102
    v_accvgpr_read_b32 v171, a103
    v_mfma_f32_16x16x32_bf16 v[84:87], a[208:211], v[144:147], v[84:87]
    buffer_store_dwordx4 v[120:123], v28, s[20:23], s55 offen offset:3072 sc1
    v_mfma_f32_16x16x32_bf16 v[76:79], a[208:211], v[136:139], v[76:79]
    s_add_u32 s55, s55, 12288
    ds_read_b64_tr_b16 a[204:205], v11 offset:1024
    v_fma_f32 v168, v168, v21, -v21
    v_mfma_f32_16x16x32_bf16 v[108:111], a[212:215], v[136:139], v[108:111]
    ds_read_b64_tr_b16 a[206:207], v11 offset:7168
    v_fma_f32 v169, v169, v21, -v21
    v_mfma_f32_16x16x32_bf16 v[100:103], a[212:215], v[128:131], v[100:103]
    v_fma_f32 v170, v170, v21, -v21
    v_fma_f32 v171, v171, v21, -v21
    v_mfma_f32_16x16x32_bf16 v[68:71], a[208:211], v[128:131], v[68:71]
    s_waitcnt lgkmcnt(4)
    buffer_load_dwordx4 v5, s[12:15], s76 offen offset:256 lds
    v_mfma_f32_16x16x32_bf16 v[132:135], a[192:195], v[128:131], v[132:135]
    ds_read_b64_tr_b16 a[208:209], v18 offset:2048
    v_cvt_pk_bf16_f32 v168, v168, v169
    v_mfma_f32_16x16x32_bf16 v[164:167], a[196:199], v[128:131], v[164:167]
    ds_read_b64_tr_b16 a[210:211], v18 offset:8192
    v_cvt_pk_bf16_f32 v169, v170, v171
    v_accvgpr_read_b32 v26, a118
    v_fma_f32 v26, v26, v21, -v21
    v_accvgpr_read_b32 v27, a119
    v_fma_f32 v27, v27, v21, -v21
    v_accvgpr_read_b32 v170, a116
    v_fma_f32 v170, v170, v21, -v21
    v_accvgpr_read_b32 v171, a117
    v_fma_f32 v171, v171, v21, -v21
    v_cvt_pk_bf16_f32 v170, v170, v171
    v_cvt_pk_bf16_f32 v171, v26, v27
    v_mfma_f32_16x16x32_bf16 v[172:175], a[196:199], v[136:139], v[172:175]
    v_accvgpr_read_b32 v176, a104
    v_accvgpr_read_b32 v177, a105
    v_mfma_f32_16x16x32_bf16 v[140:143], a[192:195], v[136:139], v[140:143]
    v_accvgpr_read_b32 v178, a106
    v_accvgpr_read_b32 v179, a107
    v_mfma_f32_16x16x32_bf16 v[148:151], a[192:195], v[144:147], v[148:151]
    ds_read_b64_tr_b16 a[212:213], v19 offset:2048
    v_fma_f32 v176, v176, v22, -v22
    v_mfma_f32_16x16x32_bf16 v[180:183], a[196:199], v[144:147], v[180:183]
    ds_read_b64_tr_b16 a[214:215], v19 offset:8192
    v_fma_f32 v177, v177, v22, -v22
    v_mfma_f32_16x16x32_bf16 v[188:191], a[196:199], v[152:155], v[188:191]
    buffer_store_dwordx4 v[128:131], v28, s[20:23], s55 offen offset:0 sc1
    v_mfma_f32_16x16x32_bf16 v[156:159], a[192:195], v[152:155], v[156:159]
    s_waitcnt lgkmcnt(4)
    v_fma_f32 v178, v178, v22, -v22
    v_fma_f32 v179, v179, v22, -v22
    v_mfma_f32_16x16x32_bf16 v[220:223], a[200:203], v[152:155], v[220:223]
    ds_read_b64_tr_b16 a[192:193], v8 offset:12288
    v_cvt_pk_bf16_f32 v176, v176, v177
    v_mfma_f32_16x16x32_bf16 v[252:255], a[204:207], v[152:155], v[252:255]
    ds_read_b64_tr_b16 a[194:195], v8 offset:18432
    v_cvt_pk_bf16_f32 v177, v178, v179
    v_mfma_f32_16x16x32_bf16 v[244:247], a[204:207], v[144:147], v[244:247]
    v_accvgpr_read_b32 v178, a120
    v_accvgpr_read_b32 v179, a121
    v_mfma_f32_16x16x32_bf16 v[212:215], a[200:203], v[144:147], v[212:215]
    v_accvgpr_read_b32 v30, a122
    v_accvgpr_read_b32 v31, a123
    v_fma_f32 v30, v30, v22, -v22
    v_fma_f32 v31, v31, v22, -v22
    v_fma_f32 v178, v178, v22, -v22
    v_fma_f32 v179, v179, v22, -v22
    v_cvt_pk_bf16_f32 v178, v178, v179
    v_cvt_pk_bf16_f32 v179, v30, v31
    v_mfma_f32_16x16x32_bf16 v[204:207], a[200:203], v[136:139], v[204:207]
    ds_read_b64_tr_b16 a[196:197], v9 offset:12288
    v_accvgpr_read_b32 v184, a108
    v_mfma_f32_16x16x32_bf16 v[236:239], a[204:207], v[136:139], v[236:239]
    ds_read_b64_tr_b16 a[198:199], v9 offset:18432
    v_accvgpr_read_b32 v185, a109
    v_mfma_f32_16x16x32_bf16 v[228:231], a[204:207], v[128:131], v[228:231]
    v_accvgpr_read_b32 v186, a110
    v_accvgpr_read_b32 v187, a111
    v_mfma_f32_16x16x32_bf16 v[196:199], a[200:203], v[128:131], v[196:199]
    s_waitcnt lgkmcnt(4)
    v_fma_f32 v184, v184, v23, -v23
    v_fma_f32 v185, v185, v23, -v23
    v_mfma_f32_16x16x32_bf16 v[32:35], a[208:211], v[128:131], v[32:35]
    ds_read_b64_tr_b16 a[200:201], v10 offset:12288
    v_fma_f32 v186, v186, v23, -v23
    v_mfma_f32_16x16x32_bf16 v[48:51], a[212:215], v[128:131], v[48:51]
    ds_read_b64_tr_b16 a[202:203], v10 offset:18432
    v_fma_f32 v187, v187, v23, -v23
    v_mfma_f32_16x16x32_bf16 v[52:55], a[212:215], v[136:139], v[52:55]
    v_cvt_pk_bf16_f32 v184, v184, v185
    v_cvt_pk_bf16_f32 v185, v186, v187
    v_mfma_f32_16x16x32_bf16 v[36:39], a[208:211], v[136:139], v[36:39]
    buffer_store_dwordx4 v[136:139], v28, s[20:23], s55 offen offset:1024 sc1
    v_mfma_f32_16x16x32_bf16 v[40:43], a[208:211], v[144:147], v[40:43]
    ds_read_b64_tr_b16 a[204:205], v11 offset:12288
    v_accvgpr_read_b32 v186, a124
    v_mfma_f32_16x16x32_bf16 v[56:59], a[212:215], v[144:147], v[56:59]
    ds_read_b64_tr_b16 a[206:207], v11 offset:18432
    v_accvgpr_read_b32 v187, a125
    v_accvgpr_read_b32 v24, a126
    v_fma_f32 v24, v24, v23, -v23
    v_accvgpr_read_b32 v25, a127
    v_fma_f32 v25, v25, v23, -v23
    v_fma_f32 v186, v186, v23, -v23
    v_fma_f32 v187, v187, v23, -v23
    v_cvt_pk_bf16_f32 v186, v186, v187
    v_cvt_pk_bf16_f32 v187, v24, v25
    v_mfma_f32_16x16x32_bf16 v[60:63], a[212:215], v[152:155], v[60:63]
    v_accvgpr_read_b32 v192, a128
    v_accvgpr_read_b32 v193, a129
    v_mfma_f32_16x16x32_bf16 v[44:47], a[208:211], v[152:155], v[44:47]
    s_waitcnt lgkmcnt(4)
    v_accvgpr_read_b32 v194, a130
    v_accvgpr_read_b32 v195, a131
    v_mfma_f32_16x16x32_bf16 a[236:239], a[192:195], v[184:187], a[236:239]
    ds_read_b64_tr_b16 a[208:209], v8 offset:13312
    v_fma_f32 v192, v192, v20, -v20
    v_mfma_f32_16x16x32_bf16 a[252:255], a[196:199], v[184:187], a[252:255]
    ds_read_b64_tr_b16 a[210:211], v8 offset:19456
    v_fma_f32 v193, v193, v20, -v20
    v_mfma_f32_16x16x32_bf16 a[248:251], a[196:199], v[176:179], a[248:251]
    v_fma_f32 v194, v194, v20, -v20
    v_fma_f32 v195, v195, v20, -v20
    v_mfma_f32_16x16x32_bf16 a[232:235], a[192:195], v[176:179], a[232:235]
    v_cvt_pk_bf16_f32 v192, v192, v193
    v_cvt_pk_bf16_f32 v193, v194, v195
    v_mfma_f32_16x16x32_bf16 a[228:231], a[192:195], v[168:171], a[228:231]
    ds_read_b64_tr_b16 a[212:213], v9 offset:13312
    v_accvgpr_read_b32 v194, a144
    v_mfma_f32_16x16x32_bf16 a[244:247], a[196:199], v[168:171], a[244:247]
    ds_read_b64_tr_b16 a[214:215], v9 offset:19456
    v_accvgpr_read_b32 v195, a145
    v_mfma_f32_16x16x32_bf16 a[240:243], a[196:199], v[160:163], a[240:243]
    v_accvgpr_read_b32 v26, a146
    v_accvgpr_read_b32 v27, a147
    v_mfma_f32_16x16x32_bf16 a[224:227], a[192:195], v[160:163], a[224:227]
    s_waitcnt lgkmcnt(4)
    v_fma_f32 v194, v194, v20, -v20
    v_fma_f32 v195, v195, v20, -v20
    v_fma_f32 v26, v26, v20, -v20
    v_fma_f32 v27, v27, v20, -v20
    v_cvt_pk_bf16_f32 v194, v194, v195
    v_cvt_pk_bf16_f32 v195, v26, v27
    v_mfma_f32_16x16x32_bf16 v[68:71], a[200:203], v[160:163], v[68:71]
    ds_read_b64_tr_b16 a[192:193], v10 offset:13312
    v_add_u32 v8, 122880, v12
    v_mfma_f32_16x16x32_bf16 v[100:103], a[204:207], v[160:163], v[100:103]
    ds_read_b64_tr_b16 a[194:195], v10 offset:19456
    v_accvgpr_read_b32 v200, a132
    v_mfma_f32_16x16x32_bf16 v[108:111], a[204:207], v[168:171], v[108:111]
    buffer_store_dwordx4 v[144:147], v28, s[20:23], s55 offen offset:2048 sc1
    v_mfma_f32_16x16x32_bf16 v[76:79], a[200:203], v[168:171], v[76:79]
    v_accvgpr_read_b32 v201, a133
    v_accvgpr_read_b32 v202, a134
    v_mfma_f32_16x16x32_bf16 v[84:87], a[200:203], v[176:179], v[84:87]
    ds_read_b64_tr_b16 a[196:197], v11 offset:13312
    v_accvgpr_read_b32 v203, a135
    v_mfma_f32_16x16x32_bf16 v[116:119], a[204:207], v[176:179], v[116:119]
    ds_read_b64_tr_b16 a[198:199], v11 offset:19456
    v_fma_f32 v200, v200, v21, -v21
    v_mfma_f32_16x16x32_bf16 v[124:127], a[204:207], v[184:187], v[124:127]
    v_fma_f32 v201, v201, v21, -v21
    v_fma_f32 v202, v202, v21, -v21
    v_mfma_f32_16x16x32_bf16 v[92:95], a[200:203], v[184:187], v[92:95]
    s_waitcnt lgkmcnt(4)
    v_fma_f32 v203, v203, v21, -v21
    v_cvt_pk_bf16_f32 v200, v200, v201
    v_mfma_f32_16x16x32_bf16 v[156:159], a[208:211], v[184:187], v[156:159]
    ds_read_b64_tr_b16 a[200:201], v18 offset:14336
    v_cvt_pk_bf16_f32 v201, v202, v203
    v_mfma_f32_16x16x32_bf16 v[188:191], a[212:215], v[184:187], v[188:191]
    ds_read_b64_tr_b16 a[202:203], v18 offset:20480
    v_accvgpr_read_b32 v202, a148
    v_accvgpr_read_b32 v30, a150
    v_fma_f32 v30, v30, v21, -v21
    v_accvgpr_read_b32 v31, a151
    v_fma_f32 v31, v31, v21, -v21
    v_fma_f32 v202, v202, v21, -v21
    v_accvgpr_read_b32 v203, a149
    v_fma_f32 v203, v203, v21, -v21
    v_cvt_pk_bf16_f32 v202, v202, v203
    v_cvt_pk_bf16_f32 v203, v30, v31
    v_mfma_f32_16x16x32_bf16 v[180:183], a[212:215], v[176:179], v[180:183]
    s_add_u32 s38, s35, 81920
    v_add_u32 v9, 122880, v13
    v_add_u32 v10, 122880, v14
    v_mfma_f32_16x16x32_bf16 v[148:151], a[208:211], v[176:179], v[148:151]
    s_add_u32 s57, s33, 122880
    v_accvgpr_read_b32 v208, a136
    v_accvgpr_read_b32 v209, a137
    v_mfma_f32_16x16x32_bf16 v[140:143], a[208:211], v[168:171], v[140:143]
    s_cmp_lt_u32 s3, 2
    s_cselect_b32 s38, s38, s57
    ds_read_b64_tr_b16 a[204:205], v19 offset:14336
    v_mfma_f32_16x16x32_bf16 v[172:175], a[212:215], v[168:171], v[172:175]
    s_waitcnt vmcnt(24)
    ds_read_b64_tr_b16 a[206:207], v19 offset:20480
    v_lshlrev_b32 v16, 4, v16
    v_mfma_f32_16x16x32_bf16 v[164:167], a[212:215], v[160:163], v[164:167]
    s_barrier
    v_mfma_f32_16x16x32_bf16 v[132:135], a[208:211], v[160:163], v[132:135]
    s_waitcnt lgkmcnt(4)
    v_accvgpr_read_b32 v210, a138
    v_accvgpr_read_b32 v211, a139
    v_mfma_f32_16x16x32_bf16 v[196:199], a[192:195], v[160:163], v[196:199]
    s_add_u32 s76, s38, s63
    ds_read_b64_tr_b16 a[208:209], v8 offset:0
    v_fma_f32 v208, v208, v22, -v22
    v_mfma_f32_16x16x32_bf16 v[228:231], a[196:199], v[160:163], v[228:231]
    s_add_u32 m0, s49, 0
    ds_read_b64_tr_b16 a[210:211], v8 offset:6144
    v_fma_f32 v209, v209, v22, -v22
    v_mfma_f32_16x16x32_bf16 v[236:239], a[196:199], v[168:171], v[236:239]
    buffer_store_dwordx4 v[152:155], v28, s[20:23], s55 offen offset:3072 sc1
    v_mfma_f32_16x16x32_bf16 v[204:207], a[192:195], v[168:171], v[204:207]
    s_add_u32 s55, s55, 4096
    v_fma_f32 v210, v210, v22, -v22
    v_fma_f32 v211, v211, v22, -v22
    v_accvgpr_read_b32 v24, a154
    v_fma_f32 v24, v24, v22, -v22
    v_accvgpr_read_b32 v25, a155
    v_fma_f32 v25, v25, v22, -v22
    v_cvt_pk_bf16_f32 v208, v208, v209
    v_cvt_pk_bf16_f32 v209, v210, v211
    v_accvgpr_read_b32 v210, a152
    v_fma_f32 v210, v210, v22, -v22
    v_accvgpr_read_b32 v211, a153
    v_fma_f32 v211, v211, v22, -v22
    v_cvt_pk_bf16_f32 v210, v210, v211
    v_cvt_pk_bf16_f32 v211, v24, v25
    v_mfma_f32_16x16x32_bf16 v[212:215], a[192:195], v[176:179], v[212:215]
    s_load_dword s72, s[86:87], s5 offset:4 glc
    ds_read_b64_tr_b16 a[212:213], v9 offset:0
    v_add_u32 v11, 122880, v15
    v_mfma_f32_16x16x32_bf16 v[244:247], a[196:199], v[176:179], v[244:247]
    s_waitcnt vmcnt(5)
    ds_read_b64_tr_b16 a[214:215], v9 offset:6144
    v_xor_b32 v18, s39, v8
    v_mfma_f32_16x16x32_bf16 v[252:255], a[196:199], v[184:187], v[252:255]
    buffer_atomic_or v16, v17, s[24:27], 0 offen
    v_mfma_f32_16x16x32_bf16 v[220:223], a[192:195], v[184:187], v[220:223]
    s_waitcnt lgkmcnt(4)
    buffer_load_dwordx4 v4, s[12:15], s38 offen offset:0 lds
    v_mfma_f32_16x16x32_bf16 v[44:47], a[200:203], v[184:187], v[44:47]
    s_add_u32 m0, s49, 896
    ds_read_b64_tr_b16 a[192:193], v10 offset:0
    v_xor_b32 v19, s39, v9
    v_mfma_f32_16x16x32_bf16 v[60:63], a[204:207], v[184:187], v[60:63]
    ds_read_b64_tr_b16 a[194:195], v10 offset:6144
    v_accvgpr_read_b32 v216, a140
    v_mfma_f32_16x16x32_bf16 v[56:59], a[204:207], v[176:179], v[56:59]
    buffer_load_dwordx4 v4, s[12:15], s38 offen offset:128 lds
    v_mfma_f32_16x16x32_bf16 v[40:43], a[200:203], v[176:179], v[40:43]
    s_add_u32 m0, s49, 1792
    v_accvgpr_read_b32 v217, a141
    v_accvgpr_read_b32 v218, a142
    v_mfma_f32_16x16x32_bf16 v[36:39], a[200:203], v[168:171], v[36:39]
    s_mov_b32 s28, s82
    ds_read_b64_tr_b16 a[196:197], v11 offset:0
    v_accvgpr_read_b32 v219, a143
    v_mfma_f32_16x16x32_bf16 v[52:55], a[204:207], v[168:171], v[52:55]
    s_and_b32 s29, s83, 0xffff
    ds_read_b64_tr_b16 a[198:199], v11 offset:6144
    v_fma_f32 v216, v216, v23, -v23
    v_accvgpr_read_b32 v26, a158
    v_fma_f32 v26, v26, v23, -v23
    v_accvgpr_read_b32 v27, a159
    v_fma_f32 v27, v27, v23, -v23
    v_fma_f32 v218, v218, v23, -v23
    v_fma_f32 v219, v219, v23, -v23
    v_fma_f32 v217, v217, v23, -v23
    v_cvt_pk_bf16_f32 v216, v216, v217
    v_cvt_pk_bf16_f32 v217, v218, v219
    v_accvgpr_read_b32 v218, a156
    v_fma_f32 v218, v218, v23, -v23
    v_accvgpr_read_b32 v219, a157
    v_fma_f32 v219, v219, v23, -v23
    v_cvt_pk_bf16_f32 v218, v218, v219
    v_cvt_pk_bf16_f32 v219, v26, v27
    v_mfma_f32_16x16x32_bf16 v[48:51], a[204:207], v[160:163], v[48:51]
    buffer_store_dwordx4 v[160:163], v28, s[20:23], s55 offen offset:0 sc1
    v_mfma_f32_16x16x32_bf16 v[32:35], a[200:203], v[160:163], v[32:35]
    s_waitcnt lgkmcnt(4)
    v_accvgpr_read_b32 v224, a160
    v_accvgpr_read_b32 v225, a161
    v_mfma_f32_16x16x32_bf16 a[224:227], a[208:211], v[192:195], a[224:227]
    s_mov_b32 s30, 1966080
    ds_read_b64_tr_b16 a[200:201], v8 offset:1024
    v_accvgpr_read_b32 v226, a162
    v_mfma_f32_16x16x32_bf16 a[240:243], a[212:215], v[192:195], a[240:243]
    s_mov_b32 s31, 0x00020000
    ds_read_b64_tr_b16 a[202:203], v8 offset:7168
    v_accvgpr_read_b32 v227, a163
    v_mfma_f32_16x16x32_bf16 a[244:247], a[212:215], v[200:203], a[244:247]
    buffer_load_dwordx4 v4, s[12:15], s76 offen offset:256 lds
    v_mfma_f32_16x16x32_bf16 a[228:231], a[208:211], v[200:203], a[228:231]
    s_add_u32 m0, s49, 3072
    v_fma_f32 v224, v224, v20, -v20
    v_fma_f32 v225, v225, v20, -v20
    v_mfma_f32_16x16x32_bf16 a[232:235], a[208:211], v[208:211], a[232:235]
    s_mul_i32 s44, s47, 10
    ds_read_b64_tr_b16 a[204:205], v9 offset:1024
    v_fma_f32 v226, v226, v20, -v20
    v_mfma_f32_16x16x32_bf16 a[248:251], a[212:215], v[208:211], a[248:251]
    s_sub_u32 s44, s58, s44
    ds_read_b64_tr_b16 a[206:207], v9 offset:7168
    v_fma_f32 v227, v227, v20, -v20
    v_mfma_f32_16x16x32_bf16 a[252:255], a[212:215], v[216:219], a[252:255]
    s_lshl_b32 s62, s44, 2
    v_cvt_pk_bf16_f32 v224, v224, v225
    v_cvt_pk_bf16_f32 v225, v226, v227
    v_mfma_f32_16x16x32_bf16 a[236:239], a[208:211], v[216:219], a[236:239]
    s_waitcnt lgkmcnt(4)
    buffer_load_dwordx4 v5, s[12:15], s38 offen offset:0 lds
    v_accvgpr_read_b32 v30, a178
    v_fma_f32 v30, v30, v20, -v20
    v_accvgpr_read_b32 v31, a179
    v_fma_f32 v31, v31, v20, -v20
    v_accvgpr_read_b32 v226, a176
    v_fma_f32 v226, v226, v20, -v20
    v_accvgpr_read_b32 v227, a177
    v_fma_f32 v227, v227, v20, -v20
    v_cvt_pk_bf16_f32 v226, v226, v227
    v_cvt_pk_bf16_f32 v227, v30, v31
    v_mfma_f32_16x16x32_bf16 v[92:95], a[192:195], v[216:219], v[92:95]
    s_add_u32 m0, s49, 3968
    ds_read_b64_tr_b16 a[208:209], v10 offset:1024
    v_accvgpr_read_b32 v232, a164
    v_mfma_f32_16x16x32_bf16 v[124:127], a[196:199], v[216:219], v[124:127]
    s_add_u32 s62, s62, s3
    ds_read_b64_tr_b16 a[210:211], v10 offset:7168
    v_accvgpr_read_b32 v233, a165
    v_mfma_f32_16x16x32_bf16 v[116:119], a[196:199], v[208:211], v[116:119]
    s_lshl_b32 s62, s62, 9
    v_accvgpr_read_b32 v234, a166
    v_accvgpr_read_b32 v235, a167
    v_mfma_f32_16x16x32_bf16 v[84:87], a[192:195], v[208:211], v[84:87]
    buffer_load_dwordx4 v5, s[12:15], s38 offen offset:128 lds
    v_mfma_f32_16x16x32_bf16 v[76:79], a[192:195], v[200:203], v[76:79]
    s_add_u32 m0, s49, 4864
    ds_read_b64_tr_b16 a[212:213], v11 offset:1024
    v_fma_f32 v232, v232, v21, -v21
    v_mfma_f32_16x16x32_bf16 v[108:111], a[196:199], v[200:203], v[108:111]
    s_add_u32 s62, s62, 3670016
    ds_read_b64_tr_b16 a[214:215], v11 offset:7168
    v_fma_f32 v233, v233, v21, -v21
    v_mfma_f32_16x16x32_bf16 v[100:103], a[196:199], v[192:195], v[100:103]
    s_cmp_lt_u32 s2, 240
    s_cselect_b32 s62, s62, 0x70000000
    v_fma_f32 v234, v234, v21, -v21
    v_mfma_f32_16x16x32_bf16 v[68:71], a[192:195], v[192:195], v[68:71]
    s_waitcnt lgkmcnt(4)
    buffer_store_dwordx4 v[168:171], v28, s[20:23], s55 offen offset:1024 sc1
    v_mfma_f32_16x16x32_bf16 v[132:135], a[200:203], v[192:195], v[132:135]
    s_lshl_b32 s59, s47, 6
    ds_read_b64_tr_b16 a[192:193], v18 offset:2048
    v_fma_f32 v235, v235, v21, -v21
    v_mfma_f32_16x16x32_bf16 v[164:167], a[204:207], v[192:195], v[164:167]
    s_lshr_b32 s56, s3, 1
    ds_read_b64_tr_b16 a[194:195], v18 offset:8192
    v_cvt_pk_bf16_f32 v232, v232, v233
    v_accvgpr_read_b32 v24, a182
    v_fma_f32 v24, v24, v21, -v21
    v_accvgpr_read_b32 v25, a183
    v_fma_f32 v25, v25, v21, -v21
    v_cvt_pk_bf16_f32 v233, v234, v235
    v_accvgpr_read_b32 v234, a180
    v_fma_f32 v234, v234, v21, -v21
    v_accvgpr_read_b32 v235, a181
    v_fma_f32 v235, v235, v21, -v21
    v_cvt_pk_bf16_f32 v234, v234, v235
    v_cvt_pk_bf16_f32 v235, v24, v25
    v_mfma_f32_16x16x32_bf16 v[172:175], a[204:207], v[200:203], v[172:175]
pg_9:
    s_cbranch_execz pg_13
    s_lshl_b32 s56, s56, 5
    v_accvgpr_read_b32 v240, a168
    v_accvgpr_read_b32 v241, a169
    v_mfma_f32_16x16x32_bf16 v[140:143], a[200:203], v[200:203], v[140:143]
    s_add_u32 s59, s59, s56
    v_accvgpr_read_b32 v242, a170
    v_accvgpr_read_b32 v243, a171
    v_mfma_f32_16x16x32_bf16 v[148:151], a[200:203], v[208:211], v[148:151]
    s_and_b32 s56, s3, 1
    ds_read_b64_tr_b16 a[196:197], v19 offset:2048
    v_fma_f32 v240, v240, v22, -v22
    v_mfma_f32_16x16x32_bf16 v[180:183], a[204:207], v[208:211], v[180:183]
    s_lshl_b32 s56, s56, 2
    ds_read_b64_tr_b16 a[198:199], v19 offset:8192
    v_fma_f32 v241, v241, v22, -v22
    v_mfma_f32_16x16x32_bf16 v[188:191], a[204:207], v[216:219], v[188:191]
    s_bfe_u32 s88, s72, 262144
    s_cmp_lg_u32 s88, 15
    s_cbranch_scc1 spin_o0
spin_o0_ret:
    v_fma_f32 v242, v242, v22, -v22
    v_mfma_f32_16x16x32_bf16 v[156:159], a[200:203], v[216:219], v[156:159]
    s_waitcnt lgkmcnt(4)
    buffer_load_dwordx4 v5, s[12:15], s76 offen offset:256 lds
    v_mfma_f32_16x16x32_bf16 v[220:223], a[208:211], v[216:219], v[220:223]
    s_add_u32 s59, s59, s56
    ds_read_b64_tr_b16 a[200:201], v8 offset:12288
    v_fma_f32 v243, v243, v22, -v22
    v_mfma_f32_16x16x32_bf16 v[252:255], a[212:215], v[216:219], v[252:255]
    s_mul_i32 s59, s59, 1280
    ds_read_b64_tr_b16 a[202:203], v8 offset:18432
    v_cvt_pk_bf16_f32 v240, v240, v241
    v_mfma_f32_16x16x32_bf16 v[244:247], a[212:215], v[208:211], v[244:247]
    buffer_load_dwordx4 a[0:3], v28, s[20:23], s8 offen offset:0 sc1
    v_mfma_f32_16x16x32_bf16 v[212:215], a[208:211], v[208:211], v[212:215]
    s_lshl_b32 s44, s44, 7
    v_cvt_pk_bf16_f32 v241, v242, v243
    v_accvgpr_read_b32 v242, a184
    v_accvgpr_read_b32 v26, a186
    v_fma_f32 v26, v26, v22, -v22
    v_accvgpr_read_b32 v27, a187
    v_fma_f32 v27, v27, v22, -v22
    v_fma_f32 v242, v242, v22, -v22
    v_accvgpr_read_b32 v243, a185
    v_fma_f32 v243, v243, v22, -v22
    v_cvt_pk_bf16_f32 v242, v242, v243
    v_cvt_pk_bf16_f32 v243, v26, v27
    v_mfma_f32_16x16x32_bf16 v[204:207], a[208:211], v[200:203], v[204:207]
    s_add_u32 s59, s59, s44
    ds_read_b64_tr_b16 a[204:205], v9 offset:12288
    v_accvgpr_read_b32 v248, a172
    v_mfma_f32_16x16x32_bf16 v[236:239], a[212:215], v[200:203], v[236:239]
    s_lshl_b32 s44, s3, 11
    ds_read_b64_tr_b16 a[206:207], v9 offset:18432
    v_lshrrev_b32 v29, 5, v1
    v_mfma_f32_16x16x32_bf16 v[228:231], a[212:215], v[192:195], v[228:231]
    buffer_load_dwordx4 a[4:7], v28, s[20:23], s8 offen offset:1024 sc1
    v_mfma_f32_16x16x32_bf16 v[196:199], a[208:211], v[192:195], v[196:199]
    s_waitcnt lgkmcnt(4)
    v_lshlrev_b32 v29, 3, v29
    v_bfe_u32 v6, v1, 3, 2
    v_mfma_f32_16x16x32_bf16 v[32:35], a[192:195], v[192:195], v[32:35]
    ds_read_b64_tr_b16 a[208:209], v10 offset:12288
    v_add_u32 v6, v6, v29
    v_mfma_f32_16x16x32_bf16 v[48:51], a[196:199], v[192:195], v[48:51]
    ds_read_b64_tr_b16 a[210:211], v10 offset:18432
    v_mul_u32_u24 v6, 1280, v6
    v_mfma_f32_16x16x32_bf16 v[52:55], a[196:199], v[200:203], v[52:55]
    buffer_load_dwordx4 a[8:11], v28, s[20:23], s8 offen offset:2048 sc1
    v_mfma_f32_16x16x32_bf16 v[36:39], a[192:195], v[200:203], v[36:39]
    v_lshrrev_b32 v29, 4, v1
    v_lshlrev_b32 v29, 1, v29
    v_mfma_f32_16x16x32_bf16 v[40:43], a[192:195], v[208:211], v[40:43]
    ds_read_b64_tr_b16 a[212:213], v11 offset:12288
    v_and_b32 v7, 7, v1
    v_mfma_f32_16x16x32_bf16 v[56:59], a[196:199], v[208:211], v[56:59]
    ds_read_b64_tr_b16 a[214:215], v11 offset:18432
    v_xor_b32 v7, v7, v29
    buffer_store_dwordx4 v[176:179], v28, s[20:23], s55 offen offset:2048 sc1
    v_accvgpr_read_b32 v30, a190
    v_fma_f32 v30, v30, v23, -v23
    v_accvgpr_read_b32 v31, a191
    v_fma_f32 v31, v31, v23, -v23
    v_accvgpr_read_b32 v250, a174
    v_fma_f32 v250, v250, v23, -v23
    v_accvgpr_read_b32 v251, a175
    v_fma_f32 v251, v251, v23, -v23
    v_fma_f32 v248, v248, v23, -v23
    v_accvgpr_read_b32 v249, a173
    v_fma_f32 v249, v249, v23, -v23
    v_cvt_pk_bf16_f32 v248, v248, v249
    v_cvt_pk_bf16_f32 v249, v250, v251
    v_accvgpr_read_b32 v250, a188
    v_fma_f32 v250, v250, v23, -v23
    v_accvgpr_read_b32 v251, a189
    v_fma_f32 v251, v251, v23, -v23
    v_cvt_pk_bf16_f32 v250, v250, v251
    v_cvt_pk_bf16_f32 v251, v30, v31
    v_mfma_f32_16x16x32_bf16 v[60:63], a[196:199], v[216:219], v[60:63]
    v_lshlrev_b32 v16, 4, v16
    v_lshlrev_b32 v7, 4, v7
    v_mfma_f32_16x16x32_bf16 v[44:47], a[192:195], v[216:219], v[44:47]
    s_waitcnt lgkmcnt(4)
    v_add_u32 v6, v6, v7
    v_add_u32 v7, 20480, v6
    v_mfma_f32_16x16x32_bf16 a[236:239], a[200:203], v[248:251], a[236:239]
    s_waitcnt vmcnt(13)
    ds_read_b64_tr_b16 a[192:193], v8 offset:13312
    v_add_u32 v29, 147456, v28
    v_mfma_f32_16x16x32_bf16 a[252:255], a[204:207], v[248:251], a[252:255]
    ds_read_b64_tr_b16 a[194:195], v8 offset:19456
    v_mfma_f32_16x16x32_bf16 a[248:251], a[204:207], v[240:243], a[248:251]
    buffer_atomic_or v16, v17, s[24:27], 0 offen
    v_mfma_f32_16x16x32_bf16 a[232:235], a[200:203], v[240:243], a[232:235]
    buffer_load_dwordx4 a[12:15], v28, s[20:23], s8 offen offset:3072 sc1
    v_mfma_f32_16x16x32_bf16 a[228:231], a[200:203], v[232:235], a[228:231]
    s_add_u32 s8, s8, 4096
    ds_read_b64_tr_b16 a[196:197], v9 offset:13312
    v_add_u32 v8, 24576, v12
    v_mfma_f32_16x16x32_bf16 a[244:247], a[204:207], v[232:235], a[244:247]
    ds_read_b64_tr_b16 a[198:199], v9 offset:19456
    v_mfma_f32_16x16x32_bf16 a[240:243], a[204:207], v[224:227], a[240:243]
    v_add_u32 v9, 24576, v13
    v_mfma_f32_16x16x32_bf16 a[224:227], a[200:203], v[224:227], a[224:227]
    s_waitcnt lgkmcnt(4)
    buffer_store_dwordx4 v[184:187], v28, s[20:23], s55 offen offset:3072 sc1
    v_mfma_f32_16x16x32_bf16 v[68:71], a[208:211], v[224:227], v[68:71]
    s_add_u32 s55, s55, 12288
    ds_read_b64_tr_b16 a[200:201], v10 offset:13312
    s_mov_b32 s16, s64
    v_mfma_f32_16x16x32_bf16 v[100:103], a[212:215], v[224:227], v[100:103]
    s_and_b32 s17, s65, 0xffff
    ds_read_b64_tr_b16 a[202:203], v10 offset:19456
    s_mov_b32 s18, 2621440
    v_mfma_f32_16x16x32_bf16 v[108:111], a[212:215], v[232:235], v[108:111]
    s_mov_b32 s19, 0x00020000
    v_add_u32 v10, 24576, v14
    s_lshl_b32 s45, s52, 4
    v_mfma_f32_16x16x32_bf16 v[76:79], a[208:211], v[232:235], v[76:79]
    s_lshr_b32 s56, s53, 1
    s_lshl2_add_u32 s45, s56, s45
    s_add_u32 s45, s45, s3
    v_mfma_f32_16x16x32_bf16 v[84:87], a[208:211], v[240:243], v[84:87]
    s_lshl_b32 s56, s45, 4
    ds_read_b64_tr_b16 a[204:205], v11 offset:13312
    v_and_b32 v20, 15, v1
    v_mfma_f32_16x16x32_bf16 v[116:119], a[212:215], v[240:243], v[116:119]
    ds_read_b64_tr_b16 a[206:207], v11 offset:19456
    v_add_u32 v20, s56, v20
    v_mfma_f32_16x16x32_bf16 v[124:127], a[212:215], v[248:251], v[124:127]
    buffer_load_dwordx4 a[16:19], v28, s[20:23], s9 offen offset:0 sc1
    v_mfma_f32_16x16x32_bf16 v[92:95], a[208:211], v[248:251], v[92:95]
    s_waitcnt lgkmcnt(4)
    v_bfe_u32 v21, v1, 4, 1
    v_bfe_u32 v22, v1, 5, 1
    v_mfma_f32_16x16x32_bf16 v[156:159], a[192:195], v[248:251], v[156:159]
    ds_read_b64_tr_b16 a[208:209], v18 offset:14336
    v_lshl_add_u32 v21, v21, 1, v22
    v_mfma_f32_16x16x32_bf16 v[188:191], a[196:199], v[248:251], v[188:191]
    ds_read_b64_tr_b16 a[210:211], v18 offset:20480
    v_mul_u32_u24 v22, 1280, v20
    v_mfma_f32_16x16x32_bf16 v[180:183], a[196:199], v[240:243], v[180:183]
    buffer_store_dwordx4 v[192:195], v28, s[20:23], s55 offen offset:0 sc1
    v_mfma_f32_16x16x32_bf16 v[148:151], a[192:195], v[240:243], v[148:151]
    v_lshl_add_u32 v22, v21, 4, v22
    v_lshlrev_b32 v23, 3, v20
    v_mfma_f32_16x16x32_bf16 v[140:143], a[192:195], v[232:235], v[140:143]
    s_lshr_b32 s48, s45, 2
    ds_read_b64_tr_b16 a[212:213], v19 offset:14336
    v_add_u32 v11, 24576, v15
    v_mfma_f32_16x16x32_bf16 v[172:175], a[196:199], v[232:235], v[172:175]
    s_waitcnt vmcnt(52)
    ds_read_b64_tr_b16 a[214:215], v19 offset:20480
    v_xor_b32 v18, s39, v8
    v_mfma_f32_16x16x32_bf16 v[164:167], a[196:199], v[224:227], v[164:167]
    s_barrier
    v_mfma_f32_16x16x32_bf16 v[132:135], a[192:195], v[224:227], v[132:135]
    s_waitcnt lgkmcnt(4)
    buffer_load_dwordx4 a[20:23], v28, s[20:23], s9 offen offset:1024 sc1
    v_mfma_f32_16x16x32_bf16 v[196:199], a[200:203], v[224:227], v[196:199]
    s_lshr_b32 s56, s48, 1
    ds_read_b64_tr_b16 a[192:193], v8 offset:0
    v_xor_b32 v19, s39, v9
    v_mfma_f32_16x16x32_bf16 v[228:231], a[204:207], v[224:227], v[228:231]
    s_lshl_b32 s56, s56, 19
    ds_read_b64_tr_b16 a[194:195], v8 offset:6144
    s_and_b32 s40, s48, 1
    v_mfma_f32_16x16x32_bf16 v[236:239], a[204:207], v[232:235], v[236:239]
    buffer_load_dwordx4 a[24:27], v28, s[20:23], s9 offen offset:2048 sc1
    v_mfma_f32_16x16x32_bf16 v[204:207], a[200:203], v[232:235], v[204:207]
    s_lshl_b32 s40, s40, 12
    s_or_b32 s56, s56, s40
    s_lshl_b32 s40, s48, 10
    v_mfma_f32_16x16x32_bf16 v[212:215], a[200:203], v[240:243], v[212:215]
    s_and_b32 s40, s40, 0x2000
    ds_read_b64_tr_b16 a[196:197], v9 offset:0
    s_or_b32 s56, s56, s40
    v_mfma_f32_16x16x32_bf16 v[244:247], a[204:207], v[240:243], v[244:247]
    s_or_b32 s56, s56, 134217728
    ds_read_b64_tr_b16 a[198:199], v9 offset:6144
    s_lshl_b32 s45, s3, 10
    v_mfma_f32_16x16x32_bf16 v[252:255], a[204:207], v[248:251], v[252:255]
    buffer_load_dwordx4 a[28:31], v28, s[20:23], s9 offen offset:3072 sc1
    v_mfma_f32_16x16x32_bf16 v[220:223], a[200:203], v[248:251], v[220:223]
    s_waitcnt lgkmcnt(4)
    s_add_u32 s9, s9, 4096
    s_add_u32 s45, s45, s56
    v_mfma_f32_16x16x32_bf16 v[44:47], a[208:211], v[248:251], v[44:47]
    s_mul_i32 s56, s51, 81920
    ds_read_b64_tr_b16 a[200:201], v10 offset:0
    s_add_u32 s45, s45, s56
    v_mfma_f32_16x16x32_bf16 v[60:63], a[212:215], v[248:251], v[60:63]
    s_bitcmp0_b32 s53, 0
    s_cselect_b32 s47, 2, 0
    ds_read_b64_tr_b16 a[202:203], v10 offset:6144
    v_mfma_f32_16x16x32_bf16 v[56:59], a[212:215], v[240:243], v[56:59]
    buffer_store_dwordx4 v[200:203], v28, s[20:23], s55 offen offset:1024 sc1
    v_mfma_f32_16x16x32_bf16 v[40:43], a[208:211], v[240:243], v[40:43]
    s_lshl_b32 s47, s47, 13
    s_add_u32 s47, s47, s45
    s_bitcmp0_b32 s53, 0
    s_cselect_b32 s48, 4, 4
    v_mfma_f32_16x16x32_bf16 v[36:39], a[208:211], v[232:235], v[36:39]
    s_lshl_b32 s48, s48, 13
    ds_read_b64_tr_b16 a[204:205], v11 offset:0
    s_add_u32 s48, s48, s45
    v_mfma_f32_16x16x32_bf16 v[52:55], a[212:215], v[232:235], v[52:55]
    s_waitcnt vmcnt(7)
    ds_read_b64_tr_b16 a[206:207], v11 offset:6144
    s_lshl_b32 s56, s51, 2
    v_mfma_f32_16x16x32_bf16 v[48:51], a[212:215], v[224:227], v[48:51]
    s_add_u32 s6, s51, 16
    s_bitcmp0_b32 s53, 0
    s_cselect_b32 s41, 1, 0
    v_mfma_f32_16x16x32_bf16 v[32:35], a[208:211], v[224:227], v[32:35]
    s_waitcnt lgkmcnt(4)
    buffer_load_dwordx4 a[32:35], v28, s[20:23], s10 offen offset:0 sc1
    v_mfma_f32_16x16x32_bf16 a[224:227], a[192:195], a[0:3], a[224:227]
    s_load_dword s72, s[86:87], s5 offset:4 glc
    ds_read_b64_tr_b16 a[208:209], v8 offset:1024
    s_add_u32 s41, s41, s56
    v_mfma_f32_16x16x32_bf16 a[240:243], a[196:199], a[0:3], a[240:243]
    s_bitcmp0_b32 s53, 0
    s_cselect_b32 s42, 2, 2
    ds_read_b64_tr_b16 a[210:211], v8 offset:7168
    v_mfma_f32_16x16x32_bf16 a[244:247], a[196:199], a[4:7], a[244:247]
    s_add_u32 s42, s42, s56
    ds_read_b128 v[64:67], v29 offset:0
    s_bitcmp0_b32 s53, 0
    s_cselect_b32 s43, 3, 4
    v_mfma_f32_16x16x32_bf16 a[228:231], a[192:195], a[4:7], a[228:231]
    s_add_u32 s43, s43, s56
    ds_read_b128 v[72:75], v29 offset:1024
    s_bitcmp0_b32 s53, 0
    s_cselect_b32 s43, s43, s6
    v_mfma_f32_16x16x32_bf16 a[232:235], a[192:195], a[8:11], a[232:235]
    s_lshl_b32 s41, s41, 6
    ds_read_b64_tr_b16 a[212:213], v9 offset:1024
    s_lshl_b32 s42, s42, 6
    v_mfma_f32_16x16x32_bf16 a[248:251], a[196:199], a[8:11], a[248:251]
    s_lshl_b32 s43, s43, 6
    ds_read_b64_tr_b16 a[214:215], v9 offset:7168
    s_bitcmp0_b32 s53, 0
    s_cselect_b32 s66, s42, 0x70000000
    v_mfma_f32_16x16x32_bf16 a[252:255], a[196:199], a[12:15], a[252:255]
    ds_read_b128 v[80:83], v29 offset:2048
    v_add_u32 v23, 3211264, v23
    v_mfma_f32_16x16x32_bf16 a[236:239], a[192:195], a[12:15], a[236:239]
    s_waitcnt lgkmcnt(4)
    buffer_store_dwordx4 v[208:211], v28, s[20:23], s55 offen offset:2048 sc1
    v_mfma_f32_16x16x32_bf16 v[92:95], a[200:203], a[12:15], v[92:95]
    ds_read_b64_tr_b16 a[192:193], v10 offset:1024
    v_mfma_f32_16x16x32_bf16 v[124:127], a[204:207], a[12:15], v[124:127]
    ds_read_b64_tr_b16 a[194:195], v10 offset:7168
    v_mfma_f32_16x16x32_bf16 v[116:119], a[204:207], a[8:11], v[116:119]
    ds_read_b128 v[88:91], v29 offset:3072
    v_mfma_f32_16x16x32_bf16 v[84:87], a[200:203], a[8:11], v[84:87]
    ds_read_b128 v[96:99], v29 offset:4096
    v_mfma_f32_16x16x32_bf16 v[76:79], a[200:203], a[4:7], v[76:79]
    ds_read_b64_tr_b16 a[196:197], v11 offset:1024
    v_mfma_f32_16x16x32_bf16 v[108:111], a[204:207], a[4:7], v[108:111]
    ds_read_b64_tr_b16 a[198:199], v11 offset:7168
    v_mfma_f32_16x16x32_bf16 v[100:103], a[204:207], a[0:3], v[100:103]
    ds_read_b128 v[104:107], v29 offset:5120
    v_mfma_f32_16x16x32_bf16 v[68:71], a[200:203], a[0:3], v[68:71]
    s_waitcnt lgkmcnt(4)
    buffer_load_dwordx4 a[36:39], v28, s[20:23], s10 offen offset:1024 sc1
    v_mfma_f32_16x16x32_bf16 v[132:135], a[208:211], a[0:3], v[132:135]
    ds_read_b64_tr_b16 a[200:201], v18 offset:2048
    v_lshlrev_b32 v16, 4, v16
    v_mfma_f32_16x16x32_bf16 v[164:167], a[212:215], a[0:3], v[164:167]
    s_waitcnt vmcnt(9)
    ds_read_b64_tr_b16 a[202:203], v18 offset:8192
    v_mfma_f32_16x16x32_bf16 v[172:175], a[212:215], a[4:7], v[172:175]
    ds_read_b128 v[112:115], v29 offset:6144
    v_mfma_f32_16x16x32_bf16 v[140:143], a[208:211], a[4:7], v[140:143]
    ds_read_b128 v[120:123], v29 offset:7168
    v_mfma_f32_16x16x32_bf16 v[148:151], a[208:211], a[8:11], v[148:151]
    ds_read_b64_tr_b16 a[204:205], v19 offset:2048
    v_mfma_f32_16x16x32_bf16 v[180:183], a[212:215], a[8:11], v[180:183]
    ds_read_b64_tr_b16 a[206:207], v19 offset:8192
    v_mfma_f32_16x16x32_bf16 v[188:191], a[212:215], a[12:15], v[188:191]
    ds_read_b128 v[128:131], v29 offset:8192
    v_mfma_f32_16x16x32_bf16 v[156:159], a[208:211], a[12:15], v[156:159]
    s_waitcnt lgkmcnt(4)
    buffer_atomic_or v16, v17, s[24:27], 0 offen
    v_mfma_f32_16x16x32_bf16 v[220:223], a[192:195], a[12:15], v[220:223]
    ds_read_b64_tr_b16 a[208:209], v8 offset:12288
    v_mfma_f32_16x16x32_bf16 v[252:255], a[196:199], a[12:15], v[252:255]
    ds_read_b64_tr_b16 a[210:211], v8 offset:18432
    v_mfma_f32_16x16x32_bf16 v[244:247], a[196:199], a[8:11], v[244:247]
    ds_read_b128 v[136:139], v29 offset:9216
    v_mfma_f32_16x16x32_bf16 v[212:215], a[192:195], a[8:11], v[212:215]
    buffer_store_dwordx4 v[216:219], v28, s[20:23], s55 offen offset:3072 sc1
    v_mfma_f32_16x16x32_bf16 v[204:207], a[192:195], a[4:7], v[204:207]
    s_add_u32 s55, s55, 4096
    ds_read_b64_tr_b16 a[212:213], v9 offset:12288
    v_mfma_f32_16x16x32_bf16 v[236:239], a[196:199], a[4:7], v[236:239]
    ds_read_b64_tr_b16 a[214:215], v9 offset:18432
    v_mfma_f32_16x16x32_bf16 v[228:231], a[196:199], a[0:3], v[228:231]
    buffer_load_dwordx4 a[40:43], v28, s[20:23], s10 offen offset:2048 sc1
    v_mfma_f32_16x16x32_bf16 v[196:199], a[192:195], a[0:3], v[196:199]
    s_waitcnt lgkmcnt(4)
    v_mfma_f32_16x16x32_bf16 v[32:35], a[200:203], a[0:3], v[32:35]
    ds_read_b64_tr_b16 a[192:193], v10 offset:12288
    v_mfma_f32_16x16x32_bf16 v[48:51], a[204:207], a[0:3], v[48:51]
    ds_read_b64_tr_b16 a[194:195], v10 offset:18432
    v_mfma_f32_16x16x32_bf16 v[52:55], a[204:207], a[4:7], v[52:55]
    s_bfe_u32 s88, s72, 262148
    s_cmp_lg_u32 s88, 15
    s_cbranch_scc1 spin_o1
spin_o1_ret:
    v_mfma_f32_16x16x32_bf16 v[36:39], a[200:203], a[4:7], v[36:39]
    buffer_load_dwordx4 a[44:47], v28, s[20:23], s10 offen offset:3072 sc1
    v_mfma_f32_16x16x32_bf16 v[40:43], a[200:203], a[8:11], v[40:43]
    s_add_u32 s10, s10, 4096
    ds_read_b64_tr_b16 a[196:197], v11 offset:12288
    v_mfma_f32_16x16x32_bf16 v[56:59], a[204:207], a[8:11], v[56:59]
    s_waitcnt vmcnt(8)
    ds_read_b64_tr_b16 a[198:199], v11 offset:18432
    v_mfma_f32_16x16x32_bf16 v[60:63], a[204:207], a[12:15], v[60:63]
    buffer_load_dwordx4 a[48:51], v28, s[20:23], s8 offen offset:0 sc1
    v_mfma_f32_16x16x32_bf16 v[44:47], a[200:203], a[12:15], v[44:47]
    s_waitcnt lgkmcnt(4)
    v_mfma_f32_16x16x32_bf16 a[236:239], a[208:211], a[28:31], a[236:239]
    ds_read_b64_tr_b16 a[200:201], v8 offset:13312
    v_mfma_f32_16x16x32_bf16 a[252:255], a[212:215], a[28:31], a[252:255]
    ds_read_b64_tr_b16 a[202:203], v8 offset:19456
    v_mfma_f32_16x16x32_bf16 a[248:251], a[212:215], a[24:27], a[248:251]
    v_add_u32 v8, 73728, v12
    v_mfma_f32_16x16x32_bf16 a[232:235], a[208:211], a[24:27], a[232:235]
    buffer_load_dwordx4 a[52:55], v28, s[20:23], s8 offen offset:1024 sc1
    v_mfma_f32_16x16x32_bf16 a[228:231], a[208:211], a[20:23], a[228:231]
    ds_read_b64_tr_b16 a[204:205], v9 offset:13312
    v_add_f32 v64, v64, v72
    buffer_store_dwordx4 v[224:227], v28, s[20:23], s55 offen offset:0 sc1
    v_mfma_f32_16x16x32_bf16 a[244:247], a[212:215], a[20:23], a[244:247]
    ds_read_b64_tr_b16 a[206:207], v9 offset:19456
    v_add_f32 v65, v65, v73
    v_mfma_f32_16x16x32_bf16 a[240:243], a[212:215], a[16:19], a[240:243]
    v_add_f32 v66, v66, v74
    v_add_f32 v67, v67, v75
    v_mfma_f32_16x16x32_bf16 a[224:227], a[208:211], a[16:19], a[224:227]
    s_waitcnt lgkmcnt(4)
    v_add_f32 v64, v64, v80
    v_add_f32 v65, v65, v81
    v_mfma_f32_16x16x32_bf16 v[68:71], a[192:195], a[16:19], v[68:71]
    ds_read_b64_tr_b16 a[208:209], v10 offset:13312
    v_add_f32 v66, v66, v82
    v_mfma_f32_16x16x32_bf16 v[100:103], a[196:199], a[16:19], v[100:103]
    ds_read_b64_tr_b16 a[210:211], v10 offset:19456
    v_add_f32 v67, v67, v83
    v_mfma_f32_16x16x32_bf16 v[108:111], a[196:199], a[20:23], v[108:111]
    v_add_f32 v64, v64, v88
    v_add_f32 v65, v65, v89
    v_mfma_f32_16x16x32_bf16 v[76:79], a[192:195], a[20:23], v[76:79]
    buffer_load_dwordx4 a[56:59], v28, s[20:23], s8 offen offset:2048 sc1
    v_mfma_f32_16x16x32_bf16 v[84:87], a[192:195], a[24:27], v[84:87]
    ds_read_b64_tr_b16 a[212:213], v11 offset:13312
    v_add_f32 v66, v66, v90
    v_mfma_f32_16x16x32_bf16 v[116:119], a[196:199], a[24:27], v[116:119]
    ds_read_b64_tr_b16 a[214:215], v11 offset:19456
    v_add_f32 v67, v67, v91
    v_mfma_f32_16x16x32_bf16 v[124:127], a[196:199], a[28:31], v[124:127]
    v_add_f32 v64, v64, v96
    v_add_f32 v65, v65, v97
    v_mfma_f32_16x16x32_bf16 v[92:95], a[192:195], a[28:31], v[92:95]
    s_waitcnt lgkmcnt(4)
    v_add_f32 v66, v66, v98
    v_add_f32 v67, v67, v99
    v_mfma_f32_16x16x32_bf16 v[156:159], a[200:203], a[28:31], v[156:159]
    ds_read_b64_tr_b16 a[192:193], v18 offset:14336
    v_add_f32 v64, v64, v104
    v_mfma_f32_16x16x32_bf16 v[188:191], a[204:207], a[28:31], v[188:191]
    ds_read_b64_tr_b16 a[194:195], v18 offset:20480
    v_add_f32 v65, v65, v105
    v_mfma_f32_16x16x32_bf16 v[180:183], a[204:207], a[24:27], v[180:183]
    buffer_load_dwordx4 a[60:63], v28, s[20:23], s8 offen offset:3072 sc1
    v_mfma_f32_16x16x32_bf16 v[148:151], a[200:203], a[24:27], v[148:151]
    s_add_u32 s8, s8, 12288
    v_add_f32 v66, v66, v106
    v_add_f32 v67, v67, v107
    buffer_store_dwordx4 v[232:235], v28, s[20:23], s55 offen offset:1024 sc1
    v_mfma_f32_16x16x32_bf16 v[140:143], a[200:203], a[20:23], v[140:143]
    ds_read_b64_tr_b16 a[196:197], v19 offset:14336
    v_add_f32 v64, v64, v112
    v_mfma_f32_16x16x32_bf16 v[172:175], a[204:207], a[20:23], v[172:175]
    s_waitcnt vmcnt(63)
    ds_read_b64_tr_b16 a[198:199], v19 offset:20480
    v_add_f32 v65, v65, v113
    v_mfma_f32_16x16x32_bf16 v[164:167], a[204:207], a[16:19], v[164:167]
    s_barrier
    v_mfma_f32_16x16x32_bf16 v[132:135], a[200:203], a[16:19], v[132:135]
    s_waitcnt lgkmcnt(4)
    v_add_f32 v66, v66, v114
    v_add_f32 v67, v67, v115
    v_mfma_f32_16x16x32_bf16 v[196:199], a[208:211], a[16:19], v[196:199]
    ds_read_b64_tr_b16 a[200:201], v8 offset:0
    v_add_f32 v64, v64, v120
    v_mfma_f32_16x16x32_bf16 v[228:231], a[212:215], a[16:19], v[228:231]
    ds_read_b64_tr_b16 a[202:203], v8 offset:6144
    v_add_f32 v65, v65, v121
    v_mfma_f32_16x16x32_bf16 v[236:239], a[212:215], a[20:23], v[236:239]
    buffer_store_dwordx4 v[240:243], v28, s[20:23], s55 offen offset:2048 sc1
    v_mfma_f32_16x16x32_bf16 v[204:207], a[208:211], a[20:23], v[204:207]
    v_add_f32 v66, v66, v122
    v_add_f32 v67, v67, v123
    v_add_u32 v9, 73728, v13
    v_mfma_f32_16x16x32_bf16 v[212:215], a[208:211], a[24:27], v[212:215]
    ds_read_b64_tr_b16 a[204:205], v9 offset:0
    v_add_f32 v64, v64, v128
    v_mfma_f32_16x16x32_bf16 v[244:247], a[212:215], a[24:27], v[244:247]
    ds_read_b64_tr_b16 a[206:207], v9 offset:6144
    v_add_f32 v65, v65, v129
    v_mfma_f32_16x16x32_bf16 v[252:255], a[212:215], a[28:31], v[252:255]
    buffer_load_dwordx4 a[64:67], v28, s[20:23], s9 offen offset:0 sc1
    v_mfma_f32_16x16x32_bf16 v[220:223], a[208:211], a[28:31], v[220:223]
    s_waitcnt lgkmcnt(4)
    v_add_f32 v66, v66, v130
    v_add_f32 v67, v67, v131
    v_add_u32 v10, 73728, v14
    v_mfma_f32_16x16x32_bf16 v[44:47], a[192:195], a[28:31], v[44:47]
    s_load_dword s72, s[86:87], s5 offset:4 glc
    ds_read_b64_tr_b16 a[208:209], v10 offset:0
    v_add_f32 v64, v64, v136
    v_mfma_f32_16x16x32_bf16 v[60:63], a[196:199], a[28:31], v[60:63]
    ds_read_b64_tr_b16 a[210:211], v10 offset:6144
    v_add_f32 v65, v65, v137
    v_mfma_f32_16x16x32_bf16 v[56:59], a[196:199], a[24:27], v[56:59]
    buffer_load_dwordx4 a[68:71], v28, s[20:23], s9 offen offset:1024 sc1
    v_mfma_f32_16x16x32_bf16 v[40:43], a[192:195], a[24:27], v[40:43]
    v_lshlrev_b32 v16, 4, v16
    v_add_f32 v66, v66, v138
    v_add_u32 v11, 73728, v15
    v_mfma_f32_16x16x32_bf16 v[36:39], a[192:195], a[20:23], v[36:39]
    s_waitcnt vmcnt(11)
    ds_read_b64_tr_b16 a[212:213], v11 offset:0
    v_add_f32 v67, v67, v139
    v_mfma_f32_16x16x32_bf16 v[52:55], a[196:199], a[20:23], v[52:55]
    s_waitcnt vmcnt(9)
    ds_read_b64_tr_b16 a[214:215], v11 offset:6144
    v_cvt_pk_bf16_f32 v64, v64, v64
    v_mfma_f32_16x16x32_bf16 v[48:51], a[196:199], a[16:19], v[48:51]
    buffer_atomic_or v16, v17, s[24:27], 0 offen
    v_mfma_f32_16x16x32_bf16 v[32:35], a[192:195], a[16:19], v[32:35]
    s_waitcnt lgkmcnt(4)
    buffer_load_dwordx4 a[72:75], v28, s[20:23], s9 offen offset:2048 sc1
    v_mfma_f32_16x16x32_bf16 a[224:227], a[200:203], a[32:35], a[224:227]
    ds_read_b64_tr_b16 a[192:193], v8 offset:1024
    v_and_b32 v64, 0xffff0000, v64
    v_mfma_f32_16x16x32_bf16 a[240:243], a[204:207], a[32:35], a[240:243]
    ds_read_b64_tr_b16 a[194:195], v8 offset:7168
    v_cvt_pk_bf16_f32 v65, v65, v65
    v_mfma_f32_16x16x32_bf16 a[244:247], a[204:207], a[36:39], a[244:247]
    buffer_store_dwordx4 v[248:251], v28, s[20:23], s55 offen offset:3072 sc1
    v_mfma_f32_16x16x32_bf16 a[228:231], a[200:203], a[36:39], a[228:231]
    s_add_u32 s55, s55, 12288
    v_and_b32 v65, 0xffff0000, v65
    v_cvt_pk_bf16_f32 v66, v66, v66
    v_mfma_f32_16x16x32_bf16 a[232:235], a[200:203], a[40:43], a[232:235]
    ds_read_b64_tr_b16 a[196:197], v9 offset:1024
    v_and_b32 v66, 0xffff0000, v66
    v_mfma_f32_16x16x32_bf16 a[248:251], a[204:207], a[40:43], a[248:251]
    ds_read_b64_tr_b16 a[198:199], v9 offset:7168
    v_cvt_pk_bf16_f32 v67, v67, v67
    v_mfma_f32_16x16x32_bf16 a[252:255], a[204:207], a[44:47], a[252:255]
    v_and_b32 v67, 0xffff0000, v67
    v_mul_f32 v72, s92, v64
    v_mfma_f32_16x16x32_bf16 a[236:239], a[200:203], a[44:47], a[236:239]
    s_waitcnt lgkmcnt(4)
    buffer_load_dwordx4 a[76:79], v28, s[20:23], s9 offen offset:3072 sc1
    v_mfma_f32_16x16x32_bf16 v[92:95], a[208:211], a[44:47], v[92:95]
    s_add_u32 s9, s9, 12288
    ds_read_b64_tr_b16 a[200:201], v10 offset:1024
    v_xor_b32 v18, s39, v8
    v_mfma_f32_16x16x32_bf16 v[124:127], a[212:215], a[44:47], v[124:127]
    ds_read_b64_tr_b16 a[202:203], v10 offset:7168
    v_xor_b32 v19, s39, v9
    v_mfma_f32_16x16x32_bf16 v[116:119], a[212:215], a[40:43], v[116:119]
    v_exp_f32 v72, v72
    v_mfma_f32_16x16x32_bf16 v[84:87], a[208:211], a[40:43], v[84:87]
    buffer_load_dwordx4 a[80:83], v28, s[20:23], s10 offen offset:0 sc1
    v_mfma_f32_16x16x32_bf16 v[76:79], a[208:211], a[36:39], v[76:79]
    ds_read_b64_tr_b16 a[204:205], v11 offset:1024
    v_add_f32 v72, 1.0, v72
    v_mfma_f32_16x16x32_bf16 v[108:111], a[212:215], a[36:39], v[108:111]
    ds_read_b64_tr_b16 a[206:207], v11 offset:7168
    v_mfma_f32_16x16x32_bf16 v[100:103], a[212:215], a[32:35], v[100:103]
    v_rcp_f32 v72, v72
    v_mfma_f32_16x16x32_bf16 v[68:71], a[208:211], a[32:35], v[68:71]
    s_waitcnt lgkmcnt(4)
    buffer_load_dwordx4 a[84:87], v28, s[20:23], s10 offen offset:1024 sc1
    v_mfma_f32_16x16x32_bf16 v[132:135], a[192:195], a[32:35], v[132:135]
    ds_read_b64_tr_b16 a[208:209], v18 offset:2048
    v_mul_f32 v64, v64, v72
    v_mfma_f32_16x16x32_bf16 v[164:167], a[196:199], a[32:35], v[164:167]
    ds_read_b64_tr_b16 a[210:211], v18 offset:8192
    v_cvt_pk_bf16_f32 v64, v64, v64
    v_mfma_f32_16x16x32_bf16 v[172:175], a[196:199], a[36:39], v[172:175]
    v_and_b32 v64, 0xffff0000, v64
    v_mul_f32 v64, v64, v66
    v_mfma_f32_16x16x32_bf16 v[140:143], a[192:195], a[36:39], v[140:143]
    v_mul_f32 v73, s92, v65
    v_mfma_f32_16x16x32_bf16 v[148:151], a[192:195], a[40:43], v[148:151]
    ds_read_b64_tr_b16 a[212:213], v19 offset:2048
    v_mfma_f32_16x16x32_bf16 v[180:183], a[196:199], a[40:43], v[180:183]
    ds_read_b64_tr_b16 a[214:215], v19 offset:8192
    v_mfma_f32_16x16x32_bf16 v[188:191], a[196:199], a[44:47], v[188:191]
    buffer_load_dwordx4 a[88:91], v28, s[20:23], s10 offen offset:2048 sc1
    v_mfma_f32_16x16x32_bf16 v[156:159], a[192:195], a[44:47], v[156:159]
    s_waitcnt lgkmcnt(4)
    v_exp_f32 v73, v73
    v_mfma_f32_16x16x32_bf16 v[220:223], a[200:203], a[44:47], v[220:223]
    ds_read_b64_tr_b16 a[192:193], v8 offset:12288
    v_add_f32 v73, 1.0, v73
    v_mfma_f32_16x16x32_bf16 v[252:255], a[204:207], a[44:47], v[252:255]
    ds_read_b64_tr_b16 a[194:195], v8 offset:18432
    v_cmp_lt_u32 s[78:79], 31, v1
    v_mfma_f32_16x16x32_bf16 v[244:247], a[204:207], a[40:43], v[244:247]
    s_bfe_u32 s88, s72, 262152
    s_cmp_lg_u32 s88, 15
    s_cbranch_scc1 spin_o2
spin_o2_ret:
    v_mov_b32 v195, s70
    v_mfma_f32_16x16x32_bf16 v[212:215], a[200:203], a[40:43], v[212:215]
    buffer_load_dwordx4 a[92:95], v28, s[20:23], s10 offen offset:3072 sc1
    v_mfma_f32_16x16x32_bf16 v[204:207], a[200:203], a[36:39], v[204:207]
    s_add_u32 s10, s10, 12288
    ds_read_b64_tr_b16 a[196:197], v9 offset:12288
    v_mov_b32 v192, s71
    v_mfma_f32_16x16x32_bf16 v[236:239], a[204:207], a[36:39], v[236:239]
    ds_read_b64_tr_b16 a[198:199], v9 offset:18432
    v_cndmask_b32 v195, v195, v192, s[78:79]
    v_mfma_f32_16x16x32_bf16 v[228:231], a[204:207], a[32:35], v[228:231]
    buffer_load_dwordx4 a[96:99], v28, s[20:23], s8 offen offset:0 sc1
    v_mfma_f32_16x16x32_bf16 v[196:199], a[200:203], a[32:35], v[196:199]
    s_waitcnt lgkmcnt(4)
    v_rcp_f32 v73, v73
    v_mfma_f32_16x16x32_bf16 v[32:35], a[208:211], a[32:35], v[32:35]
    ds_read_b64_tr_b16 a[200:201], v10 offset:12288
    v_mul_f32 v65, v65, v73
    v_mfma_f32_16x16x32_bf16 v[48:51], a[212:215], a[32:35], v[48:51]
    ds_read_b64_tr_b16 a[202:203], v10 offset:18432
    v_cvt_pk_bf16_f32 v65, v65, v65
    v_mfma_f32_16x16x32_bf16 v[52:55], a[212:215], a[36:39], v[52:55]
    buffer_load_dwordx4 a[100:103], v28, s[20:23], s8 offen offset:1024 sc1
    v_mfma_f32_16x16x32_bf16 v[36:39], a[208:211], a[36:39], v[36:39]
    v_and_b32 v65, 0xffff0000, v65
    v_mul_f32 v65, v65, v67
    v_mfma_f32_16x16x32_bf16 v[40:43], a[208:211], a[40:43], v[40:43]
    ds_read_b64_tr_b16 a[204:205], v11 offset:12288
    v_cvt_pk_bf16_f32 v64, v64, v65
    v_mfma_f32_16x16x32_bf16 v[56:59], a[212:215], a[40:43], v[56:59]
    s_waitcnt vmcnt(14)
    ds_read_b64_tr_b16 a[206:207], v11 offset:18432
    v_bfe_u32 v194, v1, 3, 2
    v_mfma_f32_16x16x32_bf16 v[60:63], a[212:215], a[44:47], v[60:63]
    buffer_load_dwordx4 a[104:107], v28, s[20:23], s8 offen offset:2048 sc1
    v_mfma_f32_16x16x32_bf16 v[44:47], a[208:211], a[44:47], v[44:47]
    s_waitcnt lgkmcnt(4)
    v_mov_b32 v192, s41
    v_mov_b32 v193, s42
    v_mfma_f32_16x16x32_bf16 a[236:239], a[192:195], a[60:63], a[236:239]
    s_lshl_b32 s61, s3, 8
    ds_read_b64_tr_b16 a[208:209], v8 offset:13312
    v_cmp_eq_u32 s[78:79], 1, v194
    v_mfma_f32_16x16x32_bf16 a[252:255], a[196:199], a[60:63], a[252:255]
    s_add_u32 s61, s61, 157696
    ds_read_b64_tr_b16 a[210:211], v8 offset:19456
    v_lshlrev_b32 v80, 1, v1
    v_mfma_f32_16x16x32_bf16 a[248:251], a[196:199], a[56:59], a[248:251]
    v_add_u32 v80, s61, v80
    v_and_b32 v81, 1, v1
    v_mfma_f32_16x16x32_bf16 a[232:235], a[192:195], a[56:59], a[232:235]
    buffer_load_dwordx4 a[108:111], v28, s[20:23], s8 offen offset:3072 sc1
    v_mfma_f32_16x16x32_bf16 a[228:231], a[192:195], a[52:55], a[228:231]
pg_10:
    s_cbranch_execz pg_ret2
    s_add_u32 s8, s8, 4096
    ds_read_b64_tr_b16 a[212:213], v9 offset:13312
    v_lshlrev_b32 v81, 7, v81
    v_mfma_f32_16x16x32_bf16 a[244:247], a[196:199], a[52:55], a[244:247]
    s_add_u32 m0, s44, 147456
    ds_read_b64_tr_b16 a[214:215], v9 offset:19456
    v_lshrrev_b32 v83, 4, v1
    v_mfma_f32_16x16x32_bf16 a[240:243], a[196:199], a[48:51], a[240:243]
    v_lshl_add_u32 v81, v83, 4, v81
    v_add_u32 v81, s61, v81
    v_mfma_f32_16x16x32_bf16 a[224:227], a[192:195], a[48:51], a[224:227]
    s_waitcnt lgkmcnt(4)
    buffer_load_dwordx4 v6, s[28:31], s59 offen lds
    v_mfma_f32_16x16x32_bf16 v[68:71], a[200:203], a[48:51], v[68:71]
    s_add_u32 m0, s44, 148480
    ds_read_b64_tr_b16 a[192:193], v10 offset:13312
    v_bfe_u32 v83, v1, 2, 3
    v_mfma_f32_16x16x32_bf16 v[100:103], a[204:207], a[48:51], v[100:103]
    ds_read_b64_tr_b16 a[194:195], v10 offset:19456
    v_lshlrev_b32 v82, 7, v83
    v_mfma_f32_16x16x32_bf16 v[108:111], a[204:207], a[52:55], v[108:111]
    v_lshrrev_b32 v83, 1, v83
    v_xor_b32 v83, s3, v83
    v_mfma_f32_16x16x32_bf16 v[76:79], a[200:203], a[52:55], v[76:79]
    buffer_load_dwordx4 v7, s[28:31], s59 offen lds
    v_mfma_f32_16x16x32_bf16 v[84:87], a[200:203], a[56:59], v[84:87]
    ds_read_b64_tr_b16 a[196:197], v11 offset:13312
    v_lshlrev_b32 v16, 4, v16
    v_mfma_f32_16x16x32_bf16 v[116:119], a[204:207], a[56:59], v[116:119]
    s_waitcnt vmcnt(11)
    ds_read_b64_tr_b16 a[198:199], v11 offset:19456
    v_lshl_add_u32 v82, v83, 5, v82
    v_mfma_f32_16x16x32_bf16 v[124:127], a[204:207], a[60:63], v[124:127]
    buffer_atomic_or v16, v17, s[24:27], 0 offen
    v_mfma_f32_16x16x32_bf16 v[92:95], a[200:203], a[60:63], v[92:95]
    s_waitcnt lgkmcnt(4)
    v_and_b32 v83, 3, v1
    v_lshl_add_u32 v82, v83, 3, v82
    v_mfma_f32_16x16x32_bf16 v[156:159], a[208:211], a[60:63], v[156:159]
    ds_read_b64_tr_b16 a[200:201], v18 offset:14336
    v_lshrrev_b32 v83, 5, v1
    v_mfma_f32_16x16x32_bf16 v[188:191], a[212:215], a[60:63], v[188:191]
    ds_read_b64_tr_b16 a[202:203], v18 offset:20480
    v_mul_u32_u24 v83, 1024, v83
    v_mfma_f32_16x16x32_bf16 v[180:183], a[212:215], a[56:59], v[180:183]
    buffer_load_dwordx4 a[112:115], v28, s[20:23], s9 offen offset:0 sc1
    v_mfma_f32_16x16x32_bf16 v[148:151], a[208:211], a[56:59], v[148:151]
    v_add_u32 v82, v82, v83
    v_add_u32 v82, 147456, v82
    v_mfma_f32_16x16x32_bf16 v[140:143], a[208:211], a[52:55], v[140:143]
    ds_read_b64_tr_b16 a[204:205], v19 offset:14336
    v_lshlrev_b32 v74, 2, v1
    v_mfma_f32_16x16x32_bf16 v[172:175], a[212:215], a[52:55], v[172:175]
    s_waitcnt vmcnt(63)
    ds_read_b64_tr_b16 a[206:207], v19 offset:20480
    v_cmp_gt_u32 vcc, 16, v1
    v_mfma_f32_16x16x32_bf16 v[164:167], a[212:215], a[48:51], v[164:167]
    s_barrier
    v_mfma_f32_16x16x32_bf16 v[132:135], a[208:211], a[48:51], v[132:135]
    s_waitcnt lgkmcnt(4)
    buffer_load_dwordx4 a[116:119], v28, s[20:23], s9 offen offset:1024 sc1
    v_add_u32 v8, 98304, v12
    v_mfma_f32_16x16x32_bf16 v[196:199], a[192:195], a[48:51], v[196:199]
    s_load_dword s72, s[86:87], s5 offset:4 glc
    ds_read_b64_tr_b16 a[208:209], v8 offset:0
    v_mov_b32 v83, 0x7ffffff0
    v_mfma_f32_16x16x32_bf16 v[228:231], a[196:199], a[48:51], v[228:231]
    ds_read_b64_tr_b16 a[210:211], v8 offset:6144
    v_cndmask_b32 v74, v83, v74, vcc
    v_mfma_f32_16x16x32_bf16 v[236:239], a[196:199], a[52:55], v[236:239]
    buffer_load_dwordx4 a[120:123], v28, s[20:23], s9 offen offset:2048 sc1
    v_mfma_f32_16x16x32_bf16 v[204:207], a[192:195], a[52:55], v[204:207]
    v_cndmask_b32 v192, v192, v193, s[78:79]
    v_mov_b32 v193, s43
    v_add_u32 v9, 98304, v13
    v_mfma_f32_16x16x32_bf16 v[212:215], a[192:195], a[56:59], v[212:215]
    ds_read_b64_tr_b16 a[212:213], v9 offset:0
    v_cmp_lt_u32 s[78:79], 1, v194
    v_mfma_f32_16x16x32_bf16 v[244:247], a[196:199], a[56:59], v[244:247]
    ds_read_b64_tr_b16 a[214:215], v9 offset:6144
    v_cndmask_b32 v192, v192, v193, s[78:79]
    v_mfma_f32_16x16x32_bf16 v[252:255], a[196:199], a[60:63], v[252:255]
    buffer_load_dwordx4 a[124:127], v28, s[20:23], s9 offen offset:3072 sc1
    v_mfma_f32_16x16x32_bf16 v[220:223], a[192:195], a[60:63], v[220:223]
    s_waitcnt lgkmcnt(4)
    v_and_b32 v193, 7, v1
    v_lshl_add_u32 v192, v193, 3, v192
    v_add_u32 v10, 98304, v14
    v_mfma_f32_16x16x32_bf16 v[44:47], a[200:203], a[60:63], v[44:47]
    s_add_u32 s9, s9, 4096
    ds_read_b64_tr_b16 a[192:193], v10 offset:0
    v_and_b32 v194, 0x7ff, v195
    v_mfma_f32_16x16x32_bf16 v[60:63], a[204:207], a[60:63], v[60:63]
    ds_read_b64_tr_b16 a[194:195], v10 offset:6144
    v_sub_u32 v194, 2047, v194
    v_mfma_f32_16x16x32_bf16 v[56:59], a[204:207], a[56:59], v[56:59]
    buffer_load_dwordx4 a[128:131], v28, s[20:23], s10 offen offset:0 sc1
    v_mfma_f32_16x16x32_bf16 v[40:43], a[200:203], a[56:59], v[40:43]
    v_mul_u32_u24 v193, 1280, v194
    v_add_u32 v193, v193, v192
    v_add_u32 v11, 98304, v15
    v_mfma_f32_16x16x32_bf16 v[36:39], a[200:203], a[52:55], v[36:39]
    ds_read_b64_tr_b16 a[196:197], v11 offset:0
    v_lshlrev_b32 v194, 3, v194
    v_mfma_f32_16x16x32_bf16 v[52:55], a[204:207], a[52:55], v[52:55]
    s_waitcnt vmcnt(16)
    ds_read_b64_tr_b16 a[198:199], v11 offset:6144
    v_add_u32 v194, 3211264, v194
    v_mfma_f32_16x16x32_bf16 v[48:51], a[204:207], a[48:51], v[48:51]
    v_xor_b32 v18, s39, v8
    v_xor_b32 v19, s39, v9
    v_mfma_f32_16x16x32_bf16 v[32:35], a[200:203], a[48:51], v[32:35]
    s_waitcnt lgkmcnt(4)
    buffer_load_dwordx4 a[132:135], v28, s[20:23], s10 offen offset:1024 sc1
    v_mfma_f32_16x16x32_bf16 a[224:227], a[208:211], a[64:67], a[224:227]
    ds_read_b64_tr_b16 a[200:201], v8 offset:1024
    v_mfma_f32_16x16x32_bf16 a[240:243], a[212:215], a[64:67], a[240:243]
    ds_read_b64_tr_b16 a[202:203], v8 offset:7168
    v_mfma_f32_16x16x32_bf16 a[244:247], a[212:215], a[68:71], a[244:247]
    v_mfma_f32_16x16x32_bf16 a[228:231], a[208:211], a[68:71], a[228:231]
    buffer_load_dwordx4 a[136:139], v28, s[20:23], s10 offen offset:2048 sc1
    v_mfma_f32_16x16x32_bf16 a[232:235], a[208:211], a[72:75], a[232:235]
    s_lshr_b32 s55, s54, 1
    ds_read_b64_tr_b16 a[204:205], v9 offset:1024
    v_bfe_u32 v224, v1, 3, 1
    v_mfma_f32_16x16x32_bf16 a[248:251], a[212:215], a[72:75], a[248:251]
    s_lshl_b32 s55, s55, 19
    ds_read_b64_tr_b16 a[206:207], v9 offset:7168
    v_bfe_u32 v225, v1, 4, 1
    v_mfma_f32_16x16x32_bf16 a[252:255], a[212:215], a[76:79], a[252:255]
    s_and_b32 s60, s54, 1
    v_xor_b32 v224, v224, v225
    v_and_b32 v225, 1, v1
    v_mfma_f32_16x16x32_bf16 a[236:239], a[208:211], a[76:79], a[236:239]
    s_waitcnt lgkmcnt(4)
    buffer_load_dwordx4 a[140:143], v28, s[20:23], s10 offen offset:3072 sc1
    v_mfma_f32_16x16x32_bf16 v[92:95], a[192:195], a[76:79], v[92:95]
    s_add_u32 s10, s10, 4096
    ds_read_b64_tr_b16 a[208:209], v10 offset:1024
    v_lshlrev_b32 v225, 4, v225
    v_mfma_f32_16x16x32_bf16 v[124:127], a[196:199], a[76:79], v[124:127]
    s_lshl_b32 s60, s60, 12
    ds_read_b64_tr_b16 a[210:211], v10 offset:7168
    v_mov_b32 v226, 0x3c80
    v_mfma_f32_16x16x32_bf16 v[116:119], a[196:199], a[72:75], v[116:119]
    s_or_b32 s55, s55, s60
    v_lshlrev_b32 v225, v225, v226
    v_bfe_u32 v226, v1, 1, 2
    v_mfma_f32_16x16x32_bf16 v[84:87], a[192:195], a[72:75], v[84:87]
    s_lshl_b32 s60, s54, 10
    v_lshl_add_u32 v226, v224, 2, v226
    v_cmp_eq_u32 s[74:75], 0, v226
    v_mfma_f32_16x16x32_bf16 v[76:79], a[192:195], a[68:71], v[76:79]
    s_and_b32 s60, s60, 0x2000
    ds_read_b64_tr_b16 a[212:213], v11 offset:1024
    v_cndmask_b32 v208, 0, v225, s[74:75]
    v_mfma_f32_16x16x32_bf16 v[108:111], a[196:199], a[68:71], v[108:111]
    s_or_b32 s55, s55, s60
    ds_read_b64_tr_b16 a[214:215], v11 offset:7168
    v_cmp_eq_u32 s[74:75], 1, v226
    v_mfma_f32_16x16x32_bf16 v[100:103], a[196:199], a[64:67], v[100:103]
    s_or_b32 s55, s55, 134217728
    v_cndmask_b32 v209, 0, v225, s[74:75]
    v_cmp_eq_u32 s[74:75], 2, v226
    v_mfma_f32_16x16x32_bf16 v[68:71], a[192:195], a[64:67], v[68:71]
    s_waitcnt lgkmcnt(4)
    v_cndmask_b32 v210, 0, v225, s[74:75]
    v_cmp_eq_u32 s[74:75], 3, v226
    v_mfma_f32_16x16x32_bf16 v[132:135], a[200:203], a[64:67], v[132:135]
    s_mul_i32 s60, s51, 81920
    ds_read_b64_tr_b16 a[192:193], v18 offset:2048
    v_cndmask_b32 v211, 0, v225, s[74:75]
    v_mfma_f32_16x16x32_bf16 v[164:167], a[204:207], a[64:67], v[164:167]
    s_add_u32 s55, s55, s60
    ds_read_b64_tr_b16 a[194:195], v18 offset:8192
    s_mul_i32 s60, s53, 8389632
    v_mfma_f32_16x16x32_bf16 v[172:175], a[204:207], a[68:71], v[172:175]
    s_bfe_u32 s88, s72, 262156
    s_cmp_lg_u32 s88, 15
    s_cbranch_scc1 spin_o3
spin_o3_ret:
    s_xor_b32 s55, s55, s60
    v_mfma_f32_16x16x32_bf16 v[140:143], a[200:203], a[68:71], v[140:143]
    s_add_u32 s60, s51, 8
    s_lshr_b32 s60, s93, s60
    s_and_b32 s60, s60, 0x2000
    v_mfma_f32_16x16x32_bf16 v[148:151], a[200:203], a[72:75], v[148:151]
    s_xor_b32 s55, s55, s60
    ds_read_b64_tr_b16 a[196:197], v19 offset:2048
    v_mfma_f32_16x16x32_bf16 v[180:183], a[204:207], a[72:75], v[180:183]
    ds_read_b64_tr_b16 a[198:199], v19 offset:8192
    v_mfma_f32_16x16x32_bf16 v[188:191], a[204:207], a[76:79], v[188:191]
    buffer_load_dwordx4 a[144:147], v28, s[20:23], s8 offen offset:0 sc1
    v_mfma_f32_16x16x32_bf16 v[156:159], a[200:203], a[76:79], v[156:159]
    s_waitcnt lgkmcnt(4)
    v_mfma_f32_16x16x32_bf16 v[220:223], a[208:211], a[76:79], v[220:223]
    ds_read_b64_tr_b16 a[200:201], v8 offset:12288
    v_mfma_f32_16x16x32_bf16 v[252:255], a[212:215], a[76:79], v[252:255]
    ds_read_b64_tr_b16 a[202:203], v8 offset:18432
    v_mfma_f32_16x16x32_bf16 v[244:247], a[212:215], a[72:75], v[244:247]
    buffer_load_dwordx2 v[24:25], v23, s[24:27], 0 offen sc1
    v_mfma_f32_16x16x32_bf16 v[212:215], a[208:211], a[72:75], v[212:215]
    buffer_load_dwordx4 a[148:151], v28, s[20:23], s8 offen offset:1024 sc1
    v_mfma_f32_16x16x32_bf16 v[204:207], a[208:211], a[68:71], v[204:207]
    ds_read_b64_tr_b16 a[204:205], v9 offset:12288
    v_mfma_f32_16x16x32_bf16 v[236:239], a[212:215], a[68:71], v[236:239]
    ds_read_b64_tr_b16 a[206:207], v9 offset:18432
    v_mfma_f32_16x16x32_bf16 v[228:231], a[212:215], a[64:67], v[228:231]
    buffer_load_dwordx2 v[200:201], v193, s[16:19], 0 offen
    v_mfma_f32_16x16x32_bf16 v[196:199], a[208:211], a[64:67], v[196:199]
    s_waitcnt lgkmcnt(4)
    buffer_load_dwordx4 a[152:155], v28, s[20:23], s8 offen offset:2048 sc1
    v_mfma_f32_16x16x32_bf16 v[32:35], a[192:195], a[64:67], v[32:35]
    ds_read_b64_tr_b16 a[208:209], v10 offset:12288
    v_mfma_f32_16x16x32_bf16 v[48:51], a[196:199], a[64:67], v[48:51]
    ds_read_b64_tr_b16 a[210:211], v10 offset:18432
    v_mfma_f32_16x16x32_bf16 v[52:55], a[196:199], a[68:71], v[52:55]
    buffer_load_dwordx2 v[202:203], v194, s[24:27], 0 offen sc1
    v_mfma_f32_16x16x32_bf16 v[36:39], a[192:195], a[68:71], v[36:39]
    buffer_load_dwordx4 a[156:159], v28, s[20:23], s8 offen offset:3072 sc1
    v_mfma_f32_16x16x32_bf16 v[40:43], a[192:195], a[72:75], v[40:43]
    s_add_u32 s8, s8, 12288
    ds_read_b64_tr_b16 a[212:213], v11 offset:12288
    v_mfma_f32_16x16x32_bf16 v[56:59], a[196:199], a[72:75], v[56:59]
    s_waitcnt vmcnt(22)
    ds_read_b64_tr_b16 a[214:215], v11 offset:18432
    v_mfma_f32_16x16x32_bf16 v[60:63], a[196:199], a[76:79], v[60:63]
    v_mfma_f32_16x16x32_bf16 v[44:47], a[192:195], a[76:79], v[44:47]
    s_waitcnt lgkmcnt(4)
    v_mfma_f32_16x16x32_bf16 a[236:239], a[200:203], a[92:95], a[236:239]
    ds_read_b64_tr_b16 a[192:193], v8 offset:13312
    v_mfma_f32_16x16x32_bf16 a[252:255], a[204:207], a[92:95], a[252:255]
    ds_read_b64_tr_b16 a[194:195], v8 offset:19456
    v_mfma_f32_16x16x32_bf16 a[248:251], a[204:207], a[88:91], a[248:251]
    v_add_u32 v8, 49152, v12
    v_mfma_f32_16x16x32_bf16 a[232:235], a[200:203], a[88:91], a[232:235]
    v_mfma_f32_16x16x32_bf16 a[228:231], a[200:203], a[84:87], a[228:231]
    ds_read_b64_tr_b16 a[196:197], v9 offset:13312
    v_lshrrev_b32 v136, 5, v192
    v_mfma_f32_16x16x32_bf16 a[244:247], a[204:207], a[84:87], a[244:247]
    ds_read_b64_tr_b16 a[198:199], v9 offset:19456
    v_lshlrev_b32 v136, 9, v136
    v_mfma_f32_16x16x32_bf16 a[240:243], a[204:207], a[80:83], a[240:243]
    v_and_b32 v192, 31, v192
    v_lshl_add_u32 v192, v192, 1, v136
    v_mfma_f32_16x16x32_bf16 a[224:227], a[200:203], a[80:83], a[224:227]
    s_waitcnt lgkmcnt(4)
    v_lshrrev_b32 v193, 5, v1
    v_lshl_add_u32 v192, v193, 8, v192
    v_mfma_f32_16x16x32_bf16 v[68:71], a[208:211], a[80:83], v[68:71]
    ds_read_b64_tr_b16 a[200:201], v10 offset:13312
    v_and_b32 v195, 0xffff0000, v195
    v_mfma_f32_16x16x32_bf16 v[100:103], a[212:215], a[80:83], v[100:103]
    ds_read_b64_tr_b16 a[202:203], v10 offset:19456
    v_ashrrev_i32 v193, 31, v195
    v_mfma_f32_16x16x32_bf16 v[108:111], a[212:215], a[84:87], v[108:111]
    buffer_load_dwordx4 a[160:163], v28, s[20:23], s9 offen offset:0 sc1
    v_mfma_f32_16x16x32_bf16 v[76:79], a[208:211], a[84:87], v[76:79]
    v_not_b32 v193, v193
    v_or_b32 v193, 0x80000000, v193
    v_mfma_f32_16x16x32_bf16 v[84:87], a[208:211], a[88:91], v[84:87]
    ds_read_b64_tr_b16 a[204:205], v11 offset:13312
    v_xor_b32 v195, v195, v193
    v_mfma_f32_16x16x32_bf16 v[116:119], a[212:215], a[88:91], v[116:119]
    ds_read_b64_tr_b16 a[206:207], v11 offset:19456
    v_and_b32 v195, 0xffff0000, v195
    v_mfma_f32_16x16x32_bf16 v[124:127], a[212:215], a[92:95], v[124:127]
    buffer_load_dwordx4 a[164:167], v28, s[20:23], s9 offen offset:1024 sc1
    v_mfma_f32_16x16x32_bf16 v[92:95], a[208:211], a[92:95], v[92:95]
    s_waitcnt lgkmcnt(4)
    v_mul_f32 v195, s92, v195
    v_add_u32 v9, 49152, v13
    v_mfma_f32_16x16x32_bf16 v[156:159], a[192:195], a[92:95], v[156:159]
    s_load_dword s72, s[86:87], s5 offset:4 glc
    ds_read_b64_tr_b16 a[208:209], v18 offset:14336
    v_add_u32 v10, 49152, v14
    v_mfma_f32_16x16x32_bf16 v[188:191], a[196:199], a[92:95], v[188:191]
    ds_read_b64_tr_b16 a[210:211], v18 offset:20480
    v_add_u32 v11, 49152, v15
    v_mfma_f32_16x16x32_bf16 v[180:183], a[196:199], a[88:91], v[180:183]
    buffer_load_dwordx4 a[168:171], v28, s[20:23], s9 offen offset:2048 sc1
    v_mfma_f32_16x16x32_bf16 v[148:151], a[192:195], a[88:91], v[148:151]
    v_exp_f32 v195, v195
    v_mfma_f32_16x16x32_bf16 v[140:143], a[192:195], a[84:87], v[140:143]
    ds_read_b64_tr_b16 a[212:213], v19 offset:14336
    v_add_f32 v195, 1.0, v195
    v_mfma_f32_16x16x32_bf16 v[172:175], a[196:199], a[84:87], v[172:175]
    s_waitcnt vmcnt(19)
    ds_read_b64_tr_b16 a[214:215], v19 offset:20480
    v_xor_b32 v18, s39, v8
    v_mfma_f32_16x16x32_bf16 v[164:167], a[196:199], a[80:83], v[164:167]
    s_barrier
    v_mfma_f32_16x16x32_bf16 v[132:135], a[192:195], a[80:83], v[132:135]
    s_waitcnt lgkmcnt(4)
    buffer_load_dwordx4 a[172:175], v28, s[20:23], s9 offen offset:3072 sc1
    v_mfma_f32_16x16x32_bf16 v[196:199], a[200:203], a[80:83], v[196:199]
    s_add_u32 s9, s9, 12288
    ds_read_b64_tr_b16 a[192:193], v8 offset:0
    v_xor_b32 v19, s39, v9
    v_mfma_f32_16x16x32_bf16 v[228:231], a[204:207], a[80:83], v[228:231]
    ds_read_b64_tr_b16 a[194:195], v8 offset:6144
    v_mfma_f32_16x16x32_bf16 v[236:239], a[204:207], a[84:87], v[236:239]
    buffer_load_dwordx4 a[176:179], v28, s[20:23], s10 offen offset:0 sc1
    v_mfma_f32_16x16x32_bf16 v[204:207], a[200:203], a[84:87], v[204:207]
    v_rcp_f32 v195, v195
    v_mfma_f32_16x16x32_bf16 v[212:215], a[200:203], a[88:91], v[212:215]
    ds_read_b64_tr_b16 a[196:197], v9 offset:0
    v_cvt_pk_bf16_f32 v195, v195, v195
    v_mfma_f32_16x16x32_bf16 v[244:247], a[204:207], a[88:91], v[244:247]
    ds_read_b64_tr_b16 a[198:199], v9 offset:6144
    v_and_b32 v195, 0xffff0000, v195
    v_mfma_f32_16x16x32_bf16 v[252:255], a[204:207], a[92:95], v[252:255]
    ds_write_b16 v80, v64
    v_mfma_f32_16x16x32_bf16 v[220:223], a[200:203], a[92:95], v[220:223]
    s_waitcnt lgkmcnt(4)
    ds_write_b16_d16_hi v80, v64 offset:128
    v_mfma_f32_16x16x32_bf16 v[44:47], a[208:211], a[92:95], v[44:47]
    ds_read_b64_tr_b16 a[200:201], v10 offset:0
    v_mfma_f32_16x16x32_bf16 v[60:63], a[212:215], a[92:95], v[60:63]
    ds_read_b64_tr_b16 a[202:203], v10 offset:6144
    v_mfma_f32_16x16x32_bf16 v[56:59], a[212:215], a[88:91], v[56:59]
    ds_read_b128 v[88:91], v81
    v_mfma_f32_16x16x32_bf16 v[40:43], a[208:211], a[88:91], v[40:43]
    buffer_load_dwordx4 a[180:183], v28, s[20:23], s10 offen offset:1024 sc1
    v_mfma_f32_16x16x32_bf16 v[36:39], a[208:211], a[84:87], v[36:39]
    ds_read_b64_tr_b16 a[204:205], v11 offset:0
    v_mfma_f32_16x16x32_bf16 v[52:55], a[212:215], a[84:87], v[52:55]
    s_waitcnt vmcnt(24)
    ds_read_b64_tr_b16 a[206:207], v11 offset:6144
    v_mfma_f32_16x16x32_bf16 v[48:51], a[212:215], a[80:83], v[48:51]
    ds_read_b128 v[96:99], v81 offset:64
    v_mfma_f32_16x16x32_bf16 v[32:35], a[208:211], a[80:83], v[32:35]
    s_waitcnt lgkmcnt(4)
    ds_read_b64_tr_b16 v[104:105], v82
    v_mfma_f32_16x16x32_bf16 a[224:227], a[192:195], a[96:99], a[224:227]
    ds_read_b64_tr_b16 a[208:209], v8 offset:1024
    v_mfma_f32_16x16x32_bf16 a[240:243], a[196:199], a[96:99], a[240:243]
    ds_read_b64_tr_b16 a[210:211], v8 offset:7168
    v_mfma_f32_16x16x32_bf16 a[244:247], a[196:199], a[100:103], a[244:247]
    ds_read_b64_tr_b16 v[106:107], v82 offset:2048
    v_mfma_f32_16x16x32_bf16 a[228:231], a[192:195], a[100:103], a[228:231]
    buffer_load_dwordx4 a[184:187], v28, s[20:23], s10 offen offset:2048 sc1
    v_mfma_f32_16x16x32_bf16 a[232:235], a[192:195], a[104:107], a[232:235]
    s_lshl1_add_u32 m0, s36, 81920
    ds_read_b64_tr_b16 a[212:213], v9 offset:1024
    s_add_u32 s38, s34, 122880
    v_mfma_f32_16x16x32_bf16 a[248:251], a[196:199], a[104:107], a[248:251]
    s_add_u32 s57, s35, 122880
    ds_read_b64_tr_b16 a[214:215], v9 offset:7168
    s_cmp_lt_u32 s3, 2
    s_cselect_b32 s38, s38, s57
    v_mfma_f32_16x16x32_bf16 a[252:255], a[196:199], a[108:111], a[252:255]
    s_waitcnt vmcnt(8)
    ds_read_b64_tr_b16 v[112:113], v82 offset:4096
    v_lshlrev_b32 v248, 16, v200
    v_mfma_f32_16x16x32_bf16 a[236:239], a[192:195], a[108:111], a[236:239]
    s_waitcnt lgkmcnt(4)
    ds_read_b64_tr_b16 v[114:115], v82 offset:6144
    v_and_b32 v249, 0xffff0000, v200
    v_mfma_f32_16x16x32_bf16 v[92:95], a[200:203], a[108:111], v[92:95]
    ds_read_b64_tr_b16 a[192:193], v10 offset:1024
    v_sub_f32 v248, v248, v202
    v_mfma_f32_16x16x32_bf16 v[124:127], a[204:207], a[108:111], v[124:127]
    ds_read_b64_tr_b16 a[194:195], v10 offset:7168
    v_sub_f32 v249, v249, v202
    v_mfma_f32_16x16x32_bf16 v[116:119], a[204:207], a[104:107], v[116:119]
    s_bfe_u32 s88, s72, 262160
    s_cmp_lg_u32 s88, 15
    s_cbranch_scc1 spin_o4
spin_o4_ret:
    v_cvt_pk_bf16_f32 v193, v248, v249
    v_mfma_f32_16x16x32_bf16 v[84:87], a[200:203], a[104:107], v[84:87]
    buffer_load_dwordx4 v4, s[12:15], s38 offen lds
    v_mfma_f32_16x16x32_bf16 v[76:79], a[200:203], a[100:103], v[76:79]
    s_lshl1_add_u32 m0, s36, 82944
    ds_read_b64_tr_b16 a[196:197], v11 offset:1024
    v_lshlrev_b32 v248, 16, v193
    v_mfma_f32_16x16x32_bf16 v[108:111], a[204:207], a[100:103], v[108:111]
    ds_read_b64_tr_b16 a[198:199], v11 offset:7168
    v_and_b32 v249, 0xffff0000, v193
    v_mfma_f32_16x16x32_bf16 v[100:103], a[204:207], a[96:99], v[100:103]
    buffer_load_dwordx4 a[0:3], v28, s[20:23], s8 offen offset:0 sc1
    v_mfma_f32_16x16x32_bf16 v[68:71], a[200:203], a[96:99], v[68:71]
    s_waitcnt lgkmcnt(4)
    v_mul_f32 v248, v248, v203
    v_mul_f32 v249, v249, v203
    v_mfma_f32_16x16x32_bf16 v[132:135], a[208:211], a[96:99], v[132:135]
    ds_read_b64_tr_b16 a[200:201], v18 offset:2048
    v_cvt_pk_bf16_f32 v193, v248, v249
    v_mfma_f32_16x16x32_bf16 v[164:167], a[212:215], a[96:99], v[164:167]
    ds_read_b64_tr_b16 a[202:203], v18 offset:8192
    v_lshlrev_b32 v248, 16, v193
    v_mfma_f32_16x16x32_bf16 v[172:175], a[212:215], a[100:103], v[172:175]
    buffer_load_dwordx4 a[4:7], v28, s[20:23], s8 offen offset:1024 sc1
    v_mfma_f32_16x16x32_bf16 v[140:143], a[208:211], a[100:103], v[140:143]
    v_and_b32 v249, 0xffff0000, v193
    v_lshlrev_b32 v250, 16, v201
    v_mfma_f32_16x16x32_bf16 v[148:151], a[208:211], a[104:107], v[148:151]
    ds_read_b64_tr_b16 a[204:205], v19 offset:2048
    v_and_b32 v251, 0xffff0000, v201
    v_mfma_f32_16x16x32_bf16 v[180:183], a[212:215], a[104:107], v[180:183]
    ds_read_b64_tr_b16 a[206:207], v19 offset:8192
    v_sub_f32 v250, v250, v202
    v_mfma_f32_16x16x32_bf16 v[188:191], a[212:215], a[108:111], v[188:191]
    v_mfma_f32_16x16x32_bf16 v[120:123], v[88:91], v[104:107], 0
    v_mfma_f32_16x16x32_bf16 v[120:123], v[96:99], v[112:115], v[120:123]
    v_mfma_f32_16x16x32_bf16 v[156:159], a[208:211], a[108:111], v[156:159]
    s_waitcnt lgkmcnt(4)
    buffer_load_dwordx4 a[8:11], v28, s[20:23], s8 offen offset:2048 sc1
    v_mfma_f32_16x16x32_bf16 v[220:223], a[192:195], a[108:111], v[220:223]
    ds_read_b64_tr_b16 a[208:209], v8 offset:12288
    v_sub_f32 v251, v251, v202
    v_mfma_f32_16x16x32_bf16 v[252:255], a[196:199], a[108:111], v[252:255]
    ds_read_b64_tr_b16 a[210:211], v8 offset:18432
    v_cvt_pk_bf16_f32 v193, v250, v251
    v_mfma_f32_16x16x32_bf16 v[244:247], a[196:199], a[104:107], v[244:247]
    v_lshlrev_b32 v250, 16, v193
    v_and_b32 v251, 0xffff0000, v193
    v_mfma_f32_16x16x32_bf16 v[212:215], a[192:195], a[104:107], v[212:215]
    buffer_load_dwordx4 a[12:15], v28, s[20:23], s8 offen offset:3072 sc1
    v_mfma_f32_16x16x32_bf16 v[204:207], a[192:195], a[100:103], v[204:207]
    s_add_u32 s8, s8, 4096
    ds_read_b64_tr_b16 a[212:213], v9 offset:12288
    v_mul_f32 v250, v250, v203
    v_mfma_f32_16x16x32_bf16 v[236:239], a[196:199], a[100:103], v[236:239]
    ds_read_b64_tr_b16 a[214:215], v9 offset:18432
    v_mul_f32 v251, v251, v203
    v_mfma_f32_16x16x32_bf16 v[228:231], a[196:199], a[96:99], v[228:231]
    buffer_atomic_add_f32 v120, v74, s[24:27], s62 offen
    v_mfma_f32_16x16x32_bf16 v[196:199], a[192:195], a[96:99], v[196:199]
    s_waitcnt lgkmcnt(4)
    buffer_load_dwordx4 v5, s[12:15], s38 offen lds
    v_mfma_f32_16x16x32_bf16 v[32:35], a[200:203], a[96:99], v[32:35]
    s_lshl1_add_u32 m0, s36, 90112
    ds_read_b64_tr_b16 a[192:193], v10 offset:12288
    v_cvt_pk_bf16_f32 v193, v250, v251
    v_mfma_f32_16x16x32_bf16 v[48:51], a[204:207], a[96:99], v[48:51]
    s_add_u32 s38, s33, 163840
    ds_read_b64_tr_b16 a[194:195], v10 offset:18432
    v_lshlrev_b32 v250, 16, v193
    v_mfma_f32_16x16x32_bf16 v[52:55], a[204:207], a[100:103], v[52:55]
    buffer_atomic_add_f32 v121, v74, s[24:27], s62 offen offset:256
    v_mfma_f32_16x16x32_bf16 v[36:39], a[200:203], a[100:103], v[36:39]
    buffer_load_dwordx4 a[188:191], v28, s[20:23], s10 offen offset:3072 sc1
    v_mfma_f32_16x16x32_bf16 v[40:43], a[200:203], a[104:107], v[40:43]
    s_add_u32 s57, s34, 163840
    ds_read_b64_tr_b16 a[196:197], v11 offset:12288
    v_and_b32 v251, 0xffff0000, v193
    v_mfma_f32_16x16x32_bf16 v[56:59], a[204:207], a[104:107], v[56:59]
    s_waitcnt vmcnt(27)
    ds_read_b64_tr_b16 a[198:199], v11 offset:18432
    v_mul_f32 v24, v24, -v25
    v_mfma_f32_16x16x32_bf16 v[60:63], a[204:207], a[108:111], v[60:63]
    s_cmp_lt_u32 s3, 2
    s_cselect_b32 s38, s38, s57
    v_lshrrev_b32 v233, 5, v1
    v_mfma_f32_16x16x32_bf16 v[44:47], a[200:203], a[108:111], v[44:47]
    s_waitcnt lgkmcnt(4)
    v_lshlrev_b32 v233, 11, v233
    v_sub_u32 v233, 81920, v233
    v_mfma_f32_16x16x32_bf16 a[236:239], a[208:211], a[124:127], a[236:239]
    s_add_u32 s10, s10, 12288
    ds_read_b64_tr_b16 a[200:201], v8 offset:13312
    v_mov_b32 v122, 1
    v_mfma_f32_16x16x32_bf16 a[252:255], a[212:215], a[124:127], a[252:255]
    ds_read_b64_tr_b16 a[202:203], v8 offset:19456
    v_min_u32 v123, 1, v1
    v_mfma_f32_16x16x32_bf16 a[248:251], a[212:215], a[120:123], a[248:251]
    buffer_load_dwordx4 v4, s[12:15], s38 offen lds
    v_mfma_f32_16x16x32_bf16 a[232:235], a[208:211], a[120:123], a[232:235]
    s_lshl1_add_u32 m0, s36, 91136
    v_lshlrev_b32 v123, 30, v123
    v_add_u32 v8, 0, v12
    v_mfma_f32_16x16x32_bf16 a[228:231], a[208:211], a[116:119], a[228:231]
    ds_read_b64_tr_b16 a[204:205], v9 offset:13312
    v_mfma_f32_16x16x32_bf16 a[244:247], a[212:215], a[116:119], a[244:247]
    ds_read_b64_tr_b16 a[206:207], v9 offset:19456
    v_mfma_f32_16x16x32_bf16 a[240:243], a[212:215], a[112:115], a[240:243]
    buffer_load_dwordx4 v5, s[12:15], s38 offen lds
    v_mfma_f32_16x16x32_bf16 a[224:227], a[208:211], a[112:115], a[224:227]
    s_waitcnt lgkmcnt(4)
    v_add_u32 v9, 0, v13
    s_lshl1_add_u32 m0, s36, 98304
    v_mfma_f32_16x16x32_bf16 v[68:71], a[192:195], a[112:115], v[68:71]
    s_add_u32 s38, s35, 163840
    ds_read_b64_tr_b16 a[208:209], v10 offset:13312
    s_add_u32 s57, s33, 204800
    v_mfma_f32_16x16x32_bf16 v[100:103], a[196:199], a[112:115], v[100:103]
    s_cmp_lt_u32 s3, 2
    s_cselect_b32 s38, s38, s57
    ds_read_b64_tr_b16 a[210:211], v10 offset:19456
    v_mfma_f32_16x16x32_bf16 v[108:111], a[196:199], a[116:119], v[108:111]
    buffer_load_dwordx4 v4, s[12:15], s38 offen lds
    v_mfma_f32_16x16x32_bf16 v[76:79], a[192:195], a[116:119], v[76:79]
    s_lshl1_add_u32 m0, s36, 99328
    v_add_u32 v10, 0, v14
    s_load_dword s72, s[86:87], s5 offset:4 glc
    v_mfma_f32_16x16x32_bf16 v[84:87], a[192:195], a[120:123], v[84:87]
    ds_read_b64_tr_b16 a[212:213], v11 offset:13312
    v_mfma_f32_16x16x32_bf16 v[116:119], a[196:199], a[120:123], v[116:119]
    ds_read_b64_tr_b16 a[214:215], v11 offset:19456
    v_mfma_f32_16x16x32_bf16 v[124:127], a[196:199], a[124:127], v[124:127]
    buffer_load_dwordx4 v5, s[12:15], s38 offen lds
    v_mfma_f32_16x16x32_bf16 v[92:95], a[192:195], a[124:127], v[92:95]
    s_waitcnt lgkmcnt(4)
    v_add_u32 v11, 0, v15
    s_lshl1_add_u32 m0, s36, 106496
    v_mfma_f32_16x16x32_bf16 v[156:159], a[200:203], a[124:127], v[156:159]
    s_add_u32 s38, s34, 204800
    ds_read_b64_tr_b16 a[192:193], v18 offset:14336
    s_add_u32 s57, s35, 204800
    v_mfma_f32_16x16x32_bf16 v[188:191], a[204:207], a[124:127], v[188:191]
    s_cmp_lt_u32 s3, 2
    s_cselect_b32 s38, s38, s57
    ds_read_b64_tr_b16 a[194:195], v18 offset:20480
    v_mfma_f32_16x16x32_bf16 v[180:183], a[204:207], a[120:123], v[180:183]
    buffer_load_dwordx4 v4, s[12:15], s38 offen lds
    v_mfma_f32_16x16x32_bf16 v[148:151], a[200:203], a[120:123], v[148:151]
    v_xor_b32 v18, s39, v8
    v_mfma_f32_16x16x32_bf16 v[140:143], a[200:203], a[116:119], v[140:143]
    s_lshl1_add_u32 m0, s36, 107520
    ds_read_b64_tr_b16 a[196:197], v19 offset:14336
    v_add_f32 v68, -0.5, v68
    v_mfma_f32_16x16x32_bf16 v[172:175], a[204:207], a[116:119], v[172:175]
    s_waitcnt vmcnt(63)
    ds_read_b64_tr_b16 a[198:199], v19 offset:20480
    v_add_f32 v69, -0.5, v69
    v_mfma_f32_16x16x32_bf16 v[164:167], a[204:207], a[112:115], v[164:167]
    s_barrier
    v_mfma_f32_16x16x32_bf16 v[132:135], a[200:203], a[112:115], v[132:135]
    s_waitcnt lgkmcnt(4)
    buffer_load_dwordx4 a[16:19], v28, s[20:23], s9 offen offset:0 sc1
    v_mfma_f32_16x16x32_bf16 v[196:199], a[208:211], a[112:115], v[196:199]
    ds_read_b64_tr_b16 a[200:201], v8 offset:0
    v_add_f32 v70, -0.5, v70
    v_mfma_f32_16x16x32_bf16 v[228:231], a[212:215], a[112:115], v[228:231]
    ds_read_b64_tr_b16 a[202:203], v8 offset:6144
    v_add_f32 v71, -0.5, v71
    v_mfma_f32_16x16x32_bf16 v[236:239], a[212:215], a[116:119], v[236:239]
    buffer_load_dwordx4 v5, s[12:15], s38 offen lds
    v_mfma_f32_16x16x32_bf16 v[204:207], a[208:211], a[116:119], v[204:207]
    v_add_f32 v100, -0.5, v100
    v_add_f32 v101, -0.5, v101
    v_mfma_f32_16x16x32_bf16 v[212:215], a[208:211], a[120:123], v[212:215]
    ds_read_b64_tr_b16 a[204:205], v9 offset:0
    v_add_f32 v102, -0.5, v102
    v_mfma_f32_16x16x32_bf16 v[244:247], a[212:215], a[120:123], v[244:247]
    ds_read_b64_tr_b16 a[206:207], v9 offset:6144
    v_add_f32 v103, -0.5, v103
    v_mfma_f32_16x16x32_bf16 v[252:255], a[212:215], a[124:127], v[252:255]
    v_add_f32 v76, -0.5, v76
    v_add_f32 v77, -0.5, v77
    v_mfma_f32_16x16x32_bf16 v[220:223], a[208:211], a[124:127], v[220:223]
    s_waitcnt lgkmcnt(4)
    buffer_load_dwordx4 a[20:23], v28, s[20:23], s9 offen offset:1024 sc1
    v_mfma_f32_16x16x32_bf16 v[44:47], a[192:195], a[124:127], v[44:47]
    ds_read_b64_tr_b16 a[208:209], v10 offset:0
    v_add_f32 v78, -0.5, v78
    v_mfma_f32_16x16x32_bf16 v[60:63], a[196:199], a[124:127], v[60:63]
    ds_read_b64_tr_b16 a[210:211], v10 offset:6144
    v_add_f32 v79, -0.5, v79
    v_mfma_f32_16x16x32_bf16 v[56:59], a[196:199], a[120:123], v[56:59]
    v_add_f32 v108, -0.5, v108
    v_add_f32 v109, -0.5, v109
    v_mfma_f32_16x16x32_bf16 v[40:43], a[192:195], a[120:123], v[40:43]
    buffer_load_dwordx4 a[24:27], v28, s[20:23], s9 offen offset:2048 sc1
    v_mfma_f32_16x16x32_bf16 v[36:39], a[192:195], a[116:119], v[36:39]
    ds_read_b64_tr_b16 a[212:213], v11 offset:0
    v_add_f32 v110, -0.5, v110
    v_mfma_f32_16x16x32_bf16 v[52:55], a[196:199], a[116:119], v[52:55]
    s_waitcnt vmcnt(32)
    ds_read_b64_tr_b16 a[214:215], v11 offset:6144
    v_add_f32 v111, -0.5, v111
    v_mfma_f32_16x16x32_bf16 v[48:51], a[196:199], a[112:115], v[48:51]
    v_add_f32 v84, -0.5, v84
    v_add_f32 v85, -0.5, v85
    v_mfma_f32_16x16x32_bf16 v[32:35], a[192:195], a[112:115], v[32:35]
    s_waitcnt lgkmcnt(4)
    buffer_load_dwordx4 a[28:31], v28, s[20:23], s9 offen offset:3072 sc1
    v_mfma_f32_16x16x32_bf16 a[224:227], a[200:203], a[128:131], a[224:227]
    s_add_u32 s9, s9, 4096
    ds_read_b64_tr_b16 a[192:193], v8 offset:1024
    v_add_f32 v86, -0.5, v86
    v_mfma_f32_16x16x32_bf16 a[240:243], a[204:207], a[128:131], a[240:243]
pg_11:
    s_cbranch_execz pg_ret2
    ds_read_b64_tr_b16 a[194:195], v8 offset:7168
    v_add_f32 v87, -0.5, v87
    v_mfma_f32_16x16x32_bf16 a[244:247], a[204:207], a[132:135], a[244:247]
    s_bfe_u32 s88, s72, 262164
    s_cmp_lg_u32 s88, 15
    s_cbranch_scc1 spin_o5
spin_o5_ret:
    v_add_f32 v116, -0.5, v116
    v_mfma_f32_16x16x32_bf16 a[228:231], a[200:203], a[132:135], a[228:231]
    buffer_load_dwordx4 a[32:35], v28, s[20:23], s10 offen offset:0 sc1
    v_mfma_f32_16x16x32_bf16 a[232:235], a[200:203], a[136:139], a[232:235]
    ds_read_b64_tr_b16 a[196:197], v9 offset:1024
    v_add_f32 v117, -0.5, v117
    v_mfma_f32_16x16x32_bf16 a[248:251], a[204:207], a[136:139], a[248:251]
    ds_read_b64_tr_b16 a[198:199], v9 offset:7168
    v_add_f32 v118, -0.5, v118
    v_add_f32 v119, -0.5, v119
    v_add_f32 v92, -0.5, v92
    v_add_f32 v93, -0.5, v93
    v_add_f32 v94, -0.5, v94
    v_add_f32 v95, -0.5, v95
    v_add_f32 v124, -0.5, v124
    v_add_f32 v125, -0.5, v125
    v_add_f32 v126, -0.5, v126
    v_add_f32 v127, -0.5, v127
    v_mfma_f32_16x16x32_bf16 a[252:255], a[204:207], a[140:143], a[252:255]
    v_xor_b32 v19, s39, v9
    v_mfma_f32_16x16x32_bf16 a[236:239], a[200:203], a[140:143], a[236:239]
    s_waitcnt lgkmcnt(4)
    v_mfma_f32_16x16x32_bf16 v[92:95], a[208:211], a[140:143], v[92:95]
    ds_read_b64_tr_b16 a[200:201], v10 offset:1024
    v_mfma_f32_16x16x32_bf16 v[124:127], a[212:215], a[140:143], v[124:127]
    ds_read_b64_tr_b16 a[202:203], v10 offset:7168
    v_mfma_f32_16x16x32_bf16 v[116:119], a[212:215], a[136:139], v[116:119]
    buffer_load_dwordx4 a[48:51], v28, s[20:23], s8 offen offset:0 sc1
    v_mfma_f32_16x16x32_bf16 v[84:87], a[208:211], a[136:139], v[84:87]
    v_mfma_f32_16x16x32_bf16 v[76:79], a[208:211], a[132:135], v[76:79]
    ds_read_b64_tr_b16 a[204:205], v11 offset:1024
    v_mfma_f32_16x16x32_bf16 v[108:111], a[212:215], a[132:135], v[108:111]
    ds_read_b64_tr_b16 a[206:207], v11 offset:7168
    v_mfma_f32_16x16x32_bf16 v[100:103], a[212:215], a[128:131], v[100:103]
    buffer_load_dwordx4 a[52:55], v28, s[20:23], s8 offen offset:1024 sc1
    v_mfma_f32_16x16x32_bf16 v[68:71], a[208:211], a[128:131], v[68:71]
    s_waitcnt lgkmcnt(4)
    v_mfma_f32_16x16x32_bf16 v[132:135], a[192:195], a[128:131], v[132:135]
    ds_read_b64_tr_b16 a[208:209], v18 offset:2048
    v_mfma_f32_16x16x32_bf16 v[164:167], a[196:199], a[128:131], v[164:167]
    ds_read_b64_tr_b16 a[210:211], v18 offset:8192
    v_mfma_f32_16x16x32_bf16 v[172:175], a[196:199], a[132:135], v[172:175]
    buffer_load_dwordx4 a[56:59], v28, s[20:23], s8 offen offset:2048 sc1
    v_mfma_f32_16x16x32_bf16 v[140:143], a[192:195], a[132:135], v[140:143]
    v_mfma_f32_16x16x32_bf16 v[148:151], a[192:195], a[136:139], v[148:151]
    ds_read_b64_tr_b16 a[212:213], v19 offset:2048
    v_mfma_f32_16x16x32_bf16 v[180:183], a[196:199], a[136:139], v[180:183]
    ds_read_b64_tr_b16 a[214:215], v19 offset:8192
    v_mfma_f32_16x16x32_bf16 v[188:191], a[196:199], a[140:143], v[188:191]
    buffer_load_dwordx4 a[60:63], v28, s[20:23], s8 offen offset:3072 sc1
    v_mfma_f32_16x16x32_bf16 v[156:159], a[192:195], a[140:143], v[156:159]
    s_waitcnt lgkmcnt(4)
    s_add_u32 s8, s8, 12288
    v_mfma_f32_16x16x32_bf16 v[220:223], a[200:203], a[140:143], v[220:223]
    ds_read_b64_tr_b16 a[192:193], v8 offset:12288
    v_mfma_f32_16x16x32_bf16 v[252:255], a[204:207], a[140:143], v[252:255]
    ds_read_b64_tr_b16 a[194:195], v8 offset:18432
    v_mfma_f32_16x16x32_bf16 v[244:247], a[204:207], a[136:139], v[244:247]
    buffer_load_dwordx4 a[36:39], v28, s[20:23], s10 offen offset:1024 sc1
    v_mfma_f32_16x16x32_bf16 v[212:215], a[200:203], a[136:139], v[212:215]
    v_mfma_f32_16x16x32_bf16 v[204:207], a[200:203], a[132:135], v[204:207]
    ds_read_b64_tr_b16 a[196:197], v9 offset:12288
    v_mfma_f32_16x16x32_bf16 v[236:239], a[204:207], a[132:135], v[236:239]
    ds_read_b64_tr_b16 a[198:199], v9 offset:18432
    v_mfma_f32_16x16x32_bf16 v[228:231], a[204:207], a[128:131], v[228:231]
    buffer_load_dwordx4 a[40:43], v28, s[20:23], s10 offen offset:2048 sc1
    v_mfma_f32_16x16x32_bf16 v[196:199], a[200:203], a[128:131], v[196:199]
    s_waitcnt lgkmcnt(4)
    v_mfma_f32_16x16x32_bf16 v[32:35], a[208:211], a[128:131], v[32:35]
    s_waitcnt vmcnt(18)
    ds_read_b64_tr_b16 a[200:201], v10 offset:12288
    v_mfma_f32_16x16x32_bf16 v[48:51], a[212:215], a[128:131], v[48:51]
    ds_read_b64_tr_b16 a[202:203], v10 offset:18432
    v_mfma_f32_16x16x32_bf16 v[52:55], a[212:215], a[132:135], v[52:55]
    buffer_atomic_add v122, v123, s[24:27], s62 offen offset:128
    v_mfma_f32_16x16x32_bf16 v[36:39], a[208:211], a[132:135], v[36:39]
    buffer_load_dwordx4 a[44:47], v28, s[20:23], s10 offen offset:3072 sc1
    v_mfma_f32_16x16x32_bf16 v[40:43], a[208:211], a[136:139], v[40:43]
    s_add_u32 s10, s10, 4096
    ds_read_b64_tr_b16 a[204:205], v11 offset:12288
    v_mfma_f32_16x16x32_bf16 v[56:59], a[212:215], a[136:139], v[56:59]
    s_waitcnt vmcnt(35)
    ds_read_b64_tr_b16 a[206:207], v11 offset:18432
    v_mfma_f32_16x16x32_bf16 v[60:63], a[212:215], a[140:143], v[60:63]
    v_mfma_f32_16x16x32_bf16 v[44:47], a[208:211], a[140:143], v[44:47]
    s_waitcnt lgkmcnt(4)
    buffer_load_dwordx4 a[64:67], v28, s[20:23], s9 offen offset:0 sc1
    v_mfma_f32_16x16x32_bf16 a[236:239], a[192:195], a[156:159], a[236:239]
    ds_read_b64_tr_b16 a[208:209], v8 offset:13312
    v_mfma_f32_16x16x32_bf16 a[252:255], a[196:199], a[156:159], a[252:255]
    ds_read_b64_tr_b16 a[210:211], v8 offset:19456
    v_mfma_f32_16x16x32_bf16 a[248:251], a[196:199], a[152:155], a[248:251]
    v_add_u32 v8, v233, v12
    v_mfma_f32_16x16x32_bf16 a[232:235], a[192:195], a[152:155], a[232:235]
    buffer_load_dwordx4 a[68:71], v28, s[20:23], s9 offen offset:1024 sc1
    v_mfma_f32_16x16x32_bf16 a[228:231], a[192:195], a[148:151], a[228:231]
    s_lshl_b32 s77, s3, 1
    s_add_u32 s77, s77, 0
    s_cmp_eq_u32 s77, s53
    s_cselect_b32 s77, 0x7ffffff0, 0
    ds_read_b64_tr_b16 a[212:213], v9 offset:13312
    v_mfma_f32_16x16x32_bf16 a[244:247], a[196:199], a[148:151], a[244:247]
    ds_read_b64_tr_b16 a[214:215], v9 offset:19456
    v_or_b32 v6, s77, v28
    v_mfma_f32_16x16x32_bf16 a[240:243], a[196:199], a[144:147], a[240:243]
    s_lshl_b32 s77, s3, 1
    s_add_u32 s77, s77, 1
    s_cmp_eq_u32 s77, s53
    s_cselect_b32 s77, 0x7ffffff0, 0
    v_mfma_f32_16x16x32_bf16 a[224:227], a[192:195], a[144:147], a[224:227]
    s_waitcnt lgkmcnt(4)
    buffer_load_dwordx4 a[72:75], v28, s[20:23], s9 offen offset:2048 sc1
    v_mfma_f32_16x16x32_bf16 v[68:71], a[200:203], a[144:147], v[68:71]
    ds_read_b64_tr_b16 a[192:193], v10 offset:13312
    v_or_b32 v7, s77, v28
    v_mfma_f32_16x16x32_bf16 v[100:103], a[204:207], a[144:147], v[100:103]
    ds_read_b64_tr_b16 a[194:195], v10 offset:19456
    v_add_u32 v9, v233, v13
    v_mfma_f32_16x16x32_bf16 v[108:111], a[204:207], a[148:151], v[108:111]
    v_add_u32 v10, v233, v14
    v_mfma_f32_16x16x32_bf16 v[76:79], a[200:203], a[148:151], v[76:79]
    buffer_load_dwordx4 a[76:79], v28, s[20:23], s9 offen offset:3072 sc1
    v_mfma_f32_16x16x32_bf16 v[84:87], a[200:203], a[152:155], v[84:87]
    s_lshl1_add_u32 m0, s36, 114688
    ds_read_b64_tr_b16 a[196:197], v11 offset:13312
    s_add_u32 s38, s34, 123008
    v_mfma_f32_16x16x32_bf16 v[116:119], a[204:207], a[152:155], v[116:119]
    s_add_u32 s57, s35, 123008
    ds_read_b64_tr_b16 a[198:199], v11 offset:19456
    s_cmp_lt_u32 s3, 2
    s_cselect_b32 s38, s38, s57
    v_mfma_f32_16x16x32_bf16 v[124:127], a[204:207], a[156:159], v[124:127]
    s_add_u32 s9, s9, 12288
    v_add_u32 v11, v233, v15
    v_mfma_f32_16x16x32_bf16 v[92:95], a[200:203], a[156:159], v[92:95]
    s_waitcnt lgkmcnt(4)
    v_mfma_f32_16x16x32_bf16 v[156:159], a[208:211], a[156:159], v[156:159]
    ds_read_b64_tr_b16 a[200:201], v18 offset:14336
    v_mfma_f32_16x16x32_bf16 v[188:191], a[212:215], a[156:159], v[188:191]
    ds_read_b64_tr_b16 a[202:203], v18 offset:20480
    v_mfma_f32_16x16x32_bf16 v[180:183], a[212:215], a[152:155], v[180:183]
    buffer_load_dwordx4 a[80:83], v28, s[20:23], s10 offen offset:0 sc1
    v_mfma_f32_16x16x32_bf16 v[148:151], a[208:211], a[152:155], v[148:151]
    v_mfma_f32_16x16x32_bf16 v[140:143], a[208:211], a[148:151], v[140:143]
    ds_read_b64_tr_b16 a[204:205], v19 offset:14336
    v_mfma_f32_16x16x32_bf16 v[172:175], a[212:215], a[148:151], v[172:175]
    s_waitcnt vmcnt(17)
    ds_read_b64_tr_b16 a[206:207], v19 offset:20480
    v_mfma_f32_16x16x32_bf16 v[164:167], a[212:215], a[144:147], v[164:167]
    s_barrier
    v_mfma_f32_16x16x32_bf16 v[132:135], a[208:211], a[144:147], v[132:135]
    s_waitcnt lgkmcnt(4)
    buffer_load_dwordx4 a[84:87], v28, s[20:23], s10 offen offset:1024 sc1
    v_mfma_f32_16x16x32_bf16 v[196:199], a[192:195], a[144:147], v[196:199]
    ds_read_b64_tr_b16 a[208:209], v8 offset:0
    v_lshrrev_b32 v2, 2, v1
    v_mfma_f32_16x16x32_bf16 v[228:231], a[196:199], a[144:147], v[228:231]
    ds_read_b64_tr_b16 a[210:211], v8 offset:2048
    v_lshlrev_b32 v18, 6, v2
    v_mfma_f32_16x16x32_bf16 v[236:239], a[196:199], a[148:151], v[236:239]
    buffer_load_dwordx4 a[88:91], v28, s[20:23], s10 offen offset:2048 sc1
    v_mfma_f32_16x16x32_bf16 v[204:207], a[192:195], a[148:151], v[204:207]
    v_mul_u32_u24 v2, 1280, v2
    v_and_b32 v19, 3, v1
    v_mfma_f32_16x16x32_bf16 v[212:215], a[192:195], a[152:155], v[212:215]
    ds_read_b64_tr_b16 a[212:213], v9 offset:0
    v_lshl_add_u32 v18, v19, 3, v18
    v_mfma_f32_16x16x32_bf16 v[244:247], a[196:199], a[152:155], v[244:247]
    ds_read_b64_tr_b16 a[214:215], v9 offset:2048
    v_lshl_add_u32 v2, v19, 4, v2
    v_mfma_f32_16x16x32_bf16 v[252:255], a[196:199], a[156:159], v[252:255]
    buffer_load_dwordx4 a[92:95], v28, s[20:23], s10 offen offset:3072 sc1
    v_mfma_f32_16x16x32_bf16 v[220:223], a[192:195], a[156:159], v[220:223]
    s_waitcnt lgkmcnt(4)
    v_and_b32 v19, 16, v1
    v_lshlrev_b32 v19, 1, v19
    v_mfma_f32_16x16x32_bf16 v[44:47], a[200:203], a[156:159], v[44:47]
    s_add_u32 s10, s10, 12288
    ds_read_b64_tr_b16 a[192:193], v8 offset:4096
    v_xor_b32 v2, v2, v19
    v_mfma_f32_16x16x32_bf16 v[60:63], a[204:207], a[156:159], v[60:63]
    ds_read_b64_tr_b16 a[194:195], v8 offset:6144
    v_or_b32 v18, v18, v19
    v_mfma_f32_16x16x32_bf16 v[56:59], a[204:207], a[152:155], v[56:59]
    buffer_load_dwordx4 v4, s[12:15], s38 offen lds
    v_mfma_f32_16x16x32_bf16 v[40:43], a[200:203], a[152:155], v[40:43]
    s_lshl1_add_u32 m0, s36, 115712
    v_xor_b32 v19, 32, v18
    v_add_u32 v2, s39, v2
    v_mfma_f32_16x16x32_bf16 v[36:39], a[200:203], a[148:151], v[36:39]
    s_and_b32 s56, s70, 0x7ff
    ds_read_b64_tr_b16 a[196:197], v9 offset:4096
    v_add_u32 v2, s63, v2
    v_mfma_f32_16x16x32_bf16 v[52:55], a[204:207], a[148:151], v[52:55]
    s_waitcnt vmcnt(40)
    ds_read_b64_tr_b16 a[198:199], v9 offset:6144
    v_add_u32 v18, 147456, v18
    v_mfma_f32_16x16x32_bf16 v[48:51], a[204:207], a[144:147], v[48:51]
    s_sub_u32 s56, 2047, s56
    v_add_u32 v19, 147456, v19
    v_cmp_eq_u32 s[78:79], s56, v20
    v_mfma_f32_16x16x32_bf16 v[32:35], a[200:203], a[144:147], v[32:35]
    s_waitcnt lgkmcnt(4)
    buffer_load_dwordx4 v5, s[12:15], s38 offen lds
    v_mfma_f32_16x16x32_bf16 a[224:227], a[208:211], a[160:163], a[224:227]
    s_lshl1_add_u32 m0, s36, 122880
    ds_read_b64_tr_b16 a[200:201], v8 offset:8192
    v_add_f32 v132, -0.5, v132
    v_mfma_f32_16x16x32_bf16 a[240:243], a[212:215], a[160:163], a[240:243]
    s_add_u32 s38, s33, 163968
    ds_read_b64_tr_b16 a[202:203], v8 offset:10240
    v_add_f32 v133, -0.5, v133
    v_mfma_f32_16x16x32_bf16 a[244:247], a[212:215], a[164:167], a[244:247]
    s_add_u32 s57, s34, 163968
    v_add_f32 v134, -0.5, v134
    v_add_f32 v135, -0.5, v135
    v_mfma_f32_16x16x32_bf16 a[228:231], a[208:211], a[164:167], a[228:231]
    s_cmp_lt_u32 s3, 2
    s_cselect_b32 s38, s38, s57
    v_add_f32 v164, -0.5, v164
    v_mfma_f32_16x16x32_bf16 a[232:235], a[208:211], a[168:171], a[232:235]
    s_and_b32 s56, s71, 0x7ff
    ds_read_b64_tr_b16 a[204:205], v9 offset:8192
    v_add_f32 v165, -0.5, v165
    v_mfma_f32_16x16x32_bf16 a[248:251], a[212:215], a[168:171], a[248:251]
    s_waitcnt vmcnt(29)
    ds_read_b64_tr_b16 a[206:207], v9 offset:10240
    v_add_f32 v166, -0.5, v166
    v_mfma_f32_16x16x32_bf16 a[252:255], a[212:215], a[172:175], a[252:255]
    buffer_load_dwordx4 v4, s[12:15], s38 offen lds
    v_mfma_f32_16x16x32_bf16 a[236:239], a[208:211], a[172:175], a[236:239]
    s_waitcnt lgkmcnt(4)
    v_add_f32 v167, -0.5, v167
    v_add_f32 v140, -0.5, v140
    v_mfma_f32_16x16x32_bf16 a[236:239], a[192:195], a[188:191], a[236:239]
    s_lshl1_add_u32 m0, s36, 123904
    ds_read_b64_tr_b16 a[208:209], v8 offset:12288
    v_add_f32 v141, -0.5, v141
    v_mfma_f32_16x16x32_bf16 a[252:255], a[196:199], a[188:191], a[252:255]
    s_sub_u32 s56, 2047, s56
    ds_read_b64_tr_b16 a[210:211], v8 offset:14336
    v_cmp_eq_u32 s[80:81], s56, v20
    v_mfma_f32_16x16x32_bf16 a[248:251], a[196:199], a[184:187], a[248:251]
    buffer_load_dwordx4 v5, s[12:15], s38 offen lds
    v_mfma_f32_16x16x32_bf16 a[232:235], a[192:195], a[184:187], a[232:235]
    s_lshl1_add_u32 m0, s36, 131072
    v_add_f32 v142, -0.5, v142
    v_add_f32 v143, -0.5, v143
    v_mfma_f32_16x16x32_bf16 a[228:231], a[192:195], a[180:183], a[228:231]
    s_add_u32 s38, s35, 163968
    ds_read_b64_tr_b16 a[212:213], v9 offset:12288
    v_add_f32 v172, -0.5, v172
    v_mfma_f32_16x16x32_bf16 a[244:247], a[196:199], a[180:183], a[244:247]
    s_waitcnt vmcnt(35)
    ds_read_b64_tr_b16 a[214:215], v9 offset:14336
    v_add_f32 v173, -0.5, v173
    v_mfma_f32_16x16x32_bf16 a[240:243], a[196:199], a[176:179], a[240:243]
    s_add_u32 s57, s33, 204928
    v_add_f32 v174, -0.5, v174
    v_add_f32 v175, -0.5, v175
    v_mfma_f32_16x16x32_bf16 a[224:227], a[192:195], a[176:179], a[224:227]
    s_waitcnt lgkmcnt(4)
    v_add_f32 v148, -0.5, v148
    v_add_f32 v149, -0.5, v149
    v_mfma_f32_16x16x32_bf16 a[224:227], a[200:203], a[0:3], a[224:227]
    s_cmp_lt_u32 s3, 2
    s_cselect_b32 s38, s38, s57
    ds_read_b64_tr_b16 a[192:193], v8 offset:16384
    v_mfma_f32_16x16x32_bf16 a[240:243], a[204:207], a[0:3], a[240:243]
    s_bitcmp0_b32 s53, 0
    s_cselect_b32 s68, 0, 0xff00
    s_lshl_b32 s69, 0x10101, s53
    s_or_b32 s68, s68, s69
    s_sub_u32 s48, s48, s47
    ds_read_b64_tr_b16 a[194:195], v8 offset:18432
    v_mfma_f32_16x16x32_bf16 a[244:247], a[204:207], a[4:7], a[244:247]
    buffer_load_dwordx4 v4, s[12:15], s38 offen lds
    v_mfma_f32_16x16x32_bf16 a[228:231], a[200:203], a[4:7], a[228:231]
    s_lshl1_add_u32 m0, s36, 132096
    v_bfe_u32 v12, v1, 3, 2
    v_mul_u32_u24 v23, s48, v12
    v_mfma_f32_16x16x32_bf16 a[232:235], a[200:203], a[8:11], a[232:235]
    ds_read_b64_tr_b16 a[196:197], v9 offset:16384
    v_add_u32 v23, s47, v23
    v_mfma_f32_16x16x32_bf16 a[248:251], a[204:207], a[8:11], a[248:251]
    s_waitcnt vmcnt(22)
    ds_read_b64_tr_b16 a[198:199], v9 offset:18432
    v_and_b32 v12, 7, v1
    v_mfma_f32_16x16x32_bf16 a[252:255], a[204:207], a[12:15], a[252:255]
    buffer_load_dwordx4 v5, s[12:15], s38 offen lds
    v_mfma_f32_16x16x32_bf16 a[236:239], a[200:203], a[12:15], a[236:239]
    s_waitcnt lgkmcnt(4)
    v_mul_u32_u24 v13, 8389632, v12
    v_xor_b32 v23, v23, v13
    v_mfma_f32_16x16x32_bf16 a[236:239], a[208:211], a[28:31], a[236:239]
    s_lshl1_add_u32 m0, s36, 139264
    ds_read_b64_tr_b16 a[200:201], v8 offset:20480
    v_lshrrev_b32 v13, v12, s93
    v_mfma_f32_16x16x32_bf16 a[252:255], a[212:215], a[28:31], a[252:255]
    s_add_u32 s38, s34, 204928
    ds_read_b64_tr_b16 a[202:203], v8 offset:22528
    v_and_b32 v13, 0x2000, v13
    v_mfma_f32_16x16x32_bf16 a[248:251], a[212:215], a[24:27], a[248:251]
    s_add_u32 s57, s35, 204928
    v_xor_b32 v23, v23, v13
    v_add_f32 v150, -0.5, v150
    v_mfma_f32_16x16x32_bf16 a[232:235], a[208:211], a[24:27], a[232:235]
    s_cmp_lt_u32 s3, 2
    s_cselect_b32 s38, s38, s57
    v_add_f32 v151, -0.5, v151
    v_mfma_f32_16x16x32_bf16 a[228:231], a[208:211], a[20:23], a[228:231]
    s_lshr_b32 s56, s2, 4
    ds_read_b64_tr_b16 a[204:205], v9 offset:20480
    v_add_f32 v180, -0.5, v180
    v_mfma_f32_16x16x32_bf16 a[244:247], a[212:215], a[20:23], a[244:247]
    s_waitcnt vmcnt(14)
    ds_read_b64_tr_b16 a[206:207], v9 offset:22528
    v_add_f32 v181, -0.5, v181
    v_mfma_f32_16x16x32_bf16 a[240:243], a[212:215], a[16:19], a[240:243]
    buffer_load_dwordx4 v4, s[12:15], s38 offen lds
    v_mfma_f32_16x16x32_bf16 a[224:227], a[208:211], a[16:19], a[224:227]
    s_waitcnt lgkmcnt(4)
    v_add_f32 v182, -0.5, v182
    v_add_f32 v183, -0.5, v183
    v_mfma_f32_16x16x32_bf16 a[224:227], a[192:195], a[32:35], a[224:227]
    s_lshl1_add_u32 m0, s36, 140288
    ds_read_b64_tr_b16 a[208:209], v8 offset:24576
    v_add_f32 v156, -0.5, v156
    v_mfma_f32_16x16x32_bf16 a[240:243], a[196:199], a[32:35], a[240:243]
    s_lshl_b32 s56, s56, 14
    ds_read_b64_tr_b16 a[210:211], v8 offset:26624
    v_add_f32 v157, -0.5, v157
    v_mfma_f32_16x16x32_bf16 a[244:247], a[196:199], a[36:39], a[244:247]
    buffer_load_dwordx4 v5, s[12:15], s38 offen lds
    v_mfma_f32_16x16x32_bf16 a[228:231], a[192:195], a[36:39], a[228:231]
    s_and_b32 s46, s2, 8
    v_add_f32 v158, -0.5, v158
    v_add_f32 v159, -0.5, v159
    v_mfma_f32_16x16x32_bf16 a[232:235], a[192:195], a[40:43], a[232:235]
    s_lshl_b32 s46, s46, 9
    ds_read_b64_tr_b16 a[212:213], v9 offset:24576
    v_add_f32 v188, -0.5, v188
    v_mfma_f32_16x16x32_bf16 a[248:251], a[196:199], a[40:43], a[248:251]
    s_waitcnt vmcnt(20)
    ds_read_b64_tr_b16 a[214:215], v9 offset:26624
    v_add_f32 v189, -0.5, v189
    v_mfma_f32_16x16x32_bf16 a[252:255], a[196:199], a[44:47], a[252:255]
    buffer_load_dwordx4 v[144:147], v22, s[16:19], s41 offen
    v_mfma_f32_16x16x32_bf16 a[236:239], a[192:195], a[44:47], a[236:239]
    s_waitcnt lgkmcnt(4)
    v_add_f32 v190, -0.5, v190
    v_add_f32 v191, -0.5, v191
    v_mfma_f32_16x16x32_bf16 a[236:239], a[200:203], a[60:63], a[236:239]
    s_add_u32 s56, s56, s46
    ds_read_b64_tr_b16 a[192:193], v8 offset:28672
    v_add_f32 v196, -0.5, v196
    v_mfma_f32_16x16x32_bf16 a[252:255], a[204:207], a[60:63], a[252:255]
    s_add_u32 s56, s56, 4456448
    ds_read_b64_tr_b16 a[194:195], v8 offset:30720
    v_add_f32 v197, -0.5, v197
    v_mfma_f32_16x16x32_bf16 a[248:251], a[204:207], a[56:59], a[248:251]
    buffer_load_dwordx4 v[152:155], v22, s[16:19], s66 offen
    v_mfma_f32_16x16x32_bf16 a[232:235], a[200:203], a[56:59], a[232:235]
    s_lshl_b32 s46, s3, 1
    v_lshrrev_b32 v12, 2, v1
    v_min_u32 v12, 1, v12
    v_mfma_f32_16x16x32_bf16 a[228:231], a[200:203], a[52:55], a[228:231]
    ds_read_b64_tr_b16 a[196:197], v9 offset:28672
    v_lshlrev_b32 v12, 30, v12
    v_mfma_f32_16x16x32_bf16 a[244:247], a[204:207], a[52:55], a[244:247]
    s_waitcnt vmcnt(14)
    ds_read_b64_tr_b16 a[198:199], v9 offset:30720
    v_lshl_or_b32 v12, v1, 7, v12
    v_mfma_f32_16x16x32_bf16 a[240:243], a[204:207], a[48:51], a[240:243]
    buffer_load_dwordx4 v[160:163], v22, s[16:19], s43 offen
    v_mfma_f32_16x16x32_bf16 a[224:227], a[200:203], a[48:51], a[224:227]
    s_waitcnt lgkmcnt(4)
    v_add_f32 v198, -0.5, v198
    v_add_f32 v199, -0.5, v199
    v_mfma_f32_16x16x32_bf16 a[224:227], a[208:211], a[64:67], a[224:227]
    s_lshl_b32 s37, s3, 10
    ds_read_b64_tr_b16 a[200:201], v10 offset:0
    v_add_f32 v228, -0.5, v228
    v_mfma_f32_16x16x32_bf16 a[240:243], a[212:215], a[64:67], a[240:243]
    s_add_u32 s56, s56, s37
    ds_read_b64_tr_b16 a[202:203], v10 offset:2048
    v_add_f32 v229, -0.5, v229
    v_mfma_f32_16x16x32_bf16 a[244:247], a[212:215], a[68:71], a[244:247]
    s_lshr_b32 s46, s93, s46
    v_add_f32 v230, -0.5, v230
    v_add_f32 v231, -0.5, v231
    v_mfma_f32_16x16x32_bf16 a[228:231], a[208:211], a[68:71], a[228:231]
    s_and_b32 s37, s46, 0x2000
    v_add_f32 v204, -0.5, v204
    v_add_f32 v205, -0.5, v205
    v_mfma_f32_16x16x32_bf16 a[232:235], a[208:211], a[72:75], a[232:235]
    s_add_u32 s37, s37, s56
    ds_read_b64_tr_b16 a[204:205], v11 offset:0
    v_add_u32 v3, s37, v12
    v_mfma_f32_16x16x32_bf16 a[248:251], a[212:215], a[72:75], a[248:251]
    s_waitcnt vmcnt(11)
    ds_read_b64_tr_b16 a[206:207], v11 offset:2048
    v_add_f32 v206, -0.5, v206
    v_mfma_f32_16x16x32_bf16 a[252:255], a[212:215], a[76:79], a[252:255]
    s_lshr_b32 s46, s46, 1
    v_add_f32 v207, -0.5, v207
    v_add_f32 v236, -0.5, v236
    v_mfma_f32_16x16x32_bf16 a[236:239], a[208:211], a[76:79], a[236:239]
    s_waitcnt lgkmcnt(4)
    v_add_f32 v237, -0.5, v237
    v_add_f32 v238, -0.5, v238
    v_mfma_f32_16x16x32_bf16 a[236:239], a[192:195], a[92:95], a[236:239]
    s_and_b32 s37, s46, 0x2000
    ds_read_b64_tr_b16 a[208:209], v10 offset:4096
    v_add_f32 v239, -0.5, v239
    v_mfma_f32_16x16x32_bf16 a[252:255], a[196:199], a[92:95], a[252:255]
    s_add_u32 s37, s37, s56
    ds_read_b64_tr_b16 a[210:211], v10 offset:6144
    v_add_u32 v131, s37, v12
    v_mfma_f32_16x16x32_bf16 a[248:251], a[196:199], a[88:91], a[248:251]
    s_lshl_b32 s56, 1, s53
    v_mov_b32 v128, s56
    v_lshlrev_b32 v129, 8, v128
    v_mfma_f32_16x16x32_bf16 a[232:235], a[192:195], a[88:91], a[232:235]
    v_lshlrev_b32 v130, 16, v128
    v_add_f32 v212, -0.5, v212
    v_mfma_f32_16x16x32_bf16 a[228:231], a[192:195], a[84:87], a[228:231]
    s_mov_b32 s67, 0
    ds_read_b64_tr_b16 a[212:213], v11 offset:4096
    v_add_f32 v213, -0.5, v213
    v_mfma_f32_16x16x32_bf16 a[244:247], a[196:199], a[84:87], a[244:247]
    s_mul_i32 s37, s3, 24576
    ds_read_b64_tr_b16 a[214:215], v11 offset:6144
    v_add_f32 v214, -0.5, v214
    v_mfma_f32_16x16x32_bf16 a[240:243], a[196:199], a[80:83], a[240:243]
    s_lshl_b32 s56, s3, 9
    v_add_f32 v215, -0.5, v215
    v_add_f32 v244, -0.5, v244
    v_mfma_f32_16x16x32_bf16 a[224:227], a[192:195], a[80:83], a[224:227]
    s_waitcnt lgkmcnt(4)
    v_add_f32 v245, -0.5, v245
    v_add_f32 v246, -0.5, v246
    v_mfma_f32_16x16x32_bf16 v[68:71], a[200:203], a[160:163], v[68:71]
    s_add_u32 s56, s56, 159744
    ds_read_b64_tr_b16 a[192:193], v10 offset:8192
    v_lshlrev_b32 v138, 3, v1
    v_mfma_f32_16x16x32_bf16 v[100:103], a[204:207], a[160:163], v[100:103]
    ds_read_b64_tr_b16 a[194:195], v10 offset:10240
    v_add_u32 v138, s56, v138
    v_mfma_f32_16x16x32_bf16 v[108:111], a[204:207], a[164:167], v[108:111]
    v_mov_b32 v139, 256
    v_cndmask_b32 v139, 0, v139, s[80:81]
    v_mfma_f32_16x16x32_bf16 v[76:79], a[200:203], a[164:167], v[76:79]
    v_lshl_add_u32 v139, v21, 4, v139
    v_add_u32 v139, s56, v139
    v_mfma_f32_16x16x32_bf16 v[84:87], a[200:203], a[168:171], v[84:87]
    s_mov_b32 s59, 3670016
    ds_read_b64_tr_b16 a[196:197], v11 offset:8192
    v_and_b32 v14, 15, v1
    v_mfma_f32_16x16x32_bf16 v[116:119], a[204:207], a[168:171], v[116:119]
    s_or_b64 s[88:89], s[78:79], s[80:81]
    s_cselect_b32 s59, s59, 0x70000000
    ds_read_b64_tr_b16 a[198:199], v11 offset:10240
    v_mfma_f32_16x16x32_bf16 v[124:127], a[204:207], a[172:175], v[124:127]
    v_accvgpr_read_b32 v64, a224
    v_accvgpr_read_b32 v65, a225
    v_mfma_f32_16x16x32_bf16 v[92:95], a[200:203], a[172:175], v[92:95]
    s_waitcnt lgkmcnt(4)
    v_accvgpr_read_b32 v66, a226
    v_accvgpr_read_b32 v67, a227
    v_mfma_f32_16x16x32_bf16 v[92:95], a[208:211], a[188:191], v[92:95]
    ds_read_b64_tr_b16 a[200:201], v10 offset:12288
    v_accvgpr_read_b32 v72, a240
    v_mfma_f32_16x16x32_bf16 v[124:127], a[212:215], a[188:191], v[124:127]
    ds_read_b64_tr_b16 a[202:203], v10 offset:14336
    v_accvgpr_read_b32 v73, a241
    v_mfma_f32_16x16x32_bf16 v[116:119], a[212:215], a[184:187], v[116:119]
    v_accvgpr_read_b32 v74, a242
    v_accvgpr_read_b32 v75, a243
    v_mfma_f32_16x16x32_bf16 v[84:87], a[208:211], a[184:187], v[84:87]
    v_add_f32 v64, -0.5, v64
    v_add_f32 v65, -0.5, v65
    v_mfma_f32_16x16x32_bf16 v[76:79], a[208:211], a[180:183], v[76:79]
    ds_read_b64_tr_b16 a[204:205], v11 offset:12288
    v_add_f32 v66, -0.5, v66
    v_mfma_f32_16x16x32_bf16 v[108:111], a[212:215], a[180:183], v[108:111]
    ds_read_b64_tr_b16 a[206:207], v11 offset:14336
    v_add_f32 v67, -0.5, v67
    v_mfma_f32_16x16x32_bf16 v[100:103], a[212:215], a[176:179], v[100:103]
    v_add_f32 v72, -0.5, v72
    v_add_f32 v73, -0.5, v73
    v_mfma_f32_16x16x32_bf16 v[68:71], a[208:211], a[176:179], v[68:71]
    s_waitcnt lgkmcnt(4)
    v_add_f32 v74, -0.5, v74
    v_add_f32 v75, -0.5, v75
    v_mfma_f32_16x16x32_bf16 v[68:71], a[192:195], a[0:3], v[68:71]
    ds_read_b64_tr_b16 a[208:209], v10 offset:16384
    v_cvt_pk_bf16_f32 v64, v64, v65
    v_mfma_f32_16x16x32_bf16 v[100:103], a[196:199], a[0:3], v[100:103]
    s_waitcnt vmcnt(2)
    ds_read_b64_tr_b16 a[210:211], v10 offset:18432
    v_cvt_pk_bf16_f32 v65, v66, v67
    v_mfma_f32_16x16x32_bf16 v[108:111], a[196:199], a[4:7], v[108:111]
    v_cvt_pk_bf16_f32 v66, v72, v73
    v_cvt_pk_bf16_f32 v67, v74, v75
    v_mfma_f32_16x16x32_bf16 v[76:79], a[192:195], a[4:7], v[76:79]
    buffer_store_dwordx4 v[64:67], v7, s[24:27], s55 offen sc1
    v_mfma_f32_16x16x32_bf16 v[84:87], a[192:195], a[8:11], v[84:87]
    s_xor_b32 s55, s55, 1024
    ds_read_b64_tr_b16 a[212:213], v11 offset:16384
    v_accvgpr_read_b32 v80, a228
    v_mfma_f32_16x16x32_bf16 v[116:119], a[196:199], a[8:11], v[116:119]
    ds_read_b64_tr_b16 a[214:215], v11 offset:18432
    v_accvgpr_read_b32 v81, a229
    v_mfma_f32_16x16x32_bf16 v[124:127], a[196:199], a[12:15], v[124:127]
    v_accvgpr_read_b32 v82, a230
    v_accvgpr_read_b32 v83, a231
    v_mfma_f32_16x16x32_bf16 v[92:95], a[192:195], a[12:15], v[92:95]
    s_waitcnt lgkmcnt(4)
    v_accvgpr_read_b32 v88, a244
    v_accvgpr_read_b32 v89, a245
    v_mfma_f32_16x16x32_bf16 v[92:95], a[200:203], a[28:31], v[92:95]
    ds_read_b64_tr_b16 a[192:193], v10 offset:20480
    v_accvgpr_read_b32 v90, a246
    v_mfma_f32_16x16x32_bf16 v[124:127], a[204:207], a[28:31], v[124:127]
    ds_read_b64_tr_b16 a[194:195], v10 offset:22528
    v_accvgpr_read_b32 v91, a247
    v_mfma_f32_16x16x32_bf16 v[116:119], a[204:207], a[24:27], v[116:119]
    v_add_f32 v80, -0.5, v80
    v_add_f32 v81, -0.5, v81
    v_mfma_f32_16x16x32_bf16 v[84:87], a[200:203], a[24:27], v[84:87]
    v_add_f32 v82, -0.5, v82
    v_add_f32 v83, -0.5, v83
    v_mfma_f32_16x16x32_bf16 v[76:79], a[200:203], a[20:23], v[76:79]
    ds_read_b64_tr_b16 a[196:197], v11 offset:20480
    v_add_f32 v88, -0.5, v88
    v_mfma_f32_16x16x32_bf16 v[108:111], a[204:207], a[20:23], v[108:111]
    ds_read_b64_tr_b16 a[198:199], v11 offset:22528
    v_add_f32 v89, -0.5, v89
    v_mfma_f32_16x16x32_bf16 v[100:103], a[204:207], a[16:19], v[100:103]
    v_add_f32 v90, -0.5, v90
    v_add_f32 v91, -0.5, v91
    v_mfma_f32_16x16x32_bf16 v[68:71], a[200:203], a[16:19], v[68:71]
    s_waitcnt lgkmcnt(4)
    v_cvt_pk_bf16_f32 v80, v80, v81
    v_cvt_pk_bf16_f32 v81, v82, v83
    v_mfma_f32_16x16x32_bf16 v[68:71], a[208:211], a[32:35], v[68:71]
    ds_read_b64_tr_b16 a[200:201], v10 offset:24576
    v_cvt_pk_bf16_f32 v82, v88, v89
    v_mfma_f32_16x16x32_bf16 v[100:103], a[212:215], a[32:35], v[100:103]
    ds_read_b64_tr_b16 a[202:203], v10 offset:26624
    v_cvt_pk_bf16_f32 v83, v90, v91
    v_mfma_f32_16x16x32_bf16 v[108:111], a[212:215], a[36:39], v[108:111]
    buffer_store_dwordx4 v[80:83], v7, s[24:27], s55 offen sc1
    v_mfma_f32_16x16x32_bf16 v[76:79], a[208:211], a[36:39], v[76:79]
    s_xor_b32 s55, s55, 3072
    v_accvgpr_read_b32 v96, a232
    v_accvgpr_read_b32 v97, a233
    v_mfma_f32_16x16x32_bf16 v[84:87], a[208:211], a[40:43], v[84:87]
    s_add_u32 m0, s36, 147456
    ds_read_b64_tr_b16 a[204:205], v11 offset:24576
    v_accvgpr_read_b32 v98, a234
    v_mfma_f32_16x16x32_bf16 v[116:119], a[212:215], a[40:43], v[116:119]
    s_add_u32 s38, s34, 123136
    ds_read_b64_tr_b16 a[206:207], v11 offset:26624
    v_accvgpr_read_b32 v99, a235
    v_mfma_f32_16x16x32_bf16 v[124:127], a[212:215], a[44:47], v[124:127]
    s_add_u32 s57, s35, 123136
    v_accvgpr_read_b32 v104, a248
    v_accvgpr_read_b32 v105, a249
    v_mfma_f32_16x16x32_bf16 v[92:95], a[208:211], a[44:47], v[92:95]
    s_waitcnt lgkmcnt(4)
    v_accvgpr_read_b32 v106, a250
    v_accvgpr_read_b32 v107, a251
    v_mfma_f32_16x16x32_bf16 v[92:95], a[192:195], a[60:63], v[92:95]
    s_cmp_lt_u32 s3, 2
    s_cselect_b32 s38, s38, s57
    ds_read_b64_tr_b16 a[208:209], v10 offset:28672
    v_mfma_f32_16x16x32_bf16 v[124:127], a[196:199], a[60:63], v[124:127]
    ds_read_b64_tr_b16 a[210:211], v10 offset:30720
    v_add_f32 v96, -0.5, v96
    v_mfma_f32_16x16x32_bf16 v[116:119], a[196:199], a[56:59], v[116:119]
    buffer_load_dwordx4 v2, s[12:15], s38 offen lds
    v_mfma_f32_16x16x32_bf16 v[84:87], a[192:195], a[56:59], v[84:87]
    s_add_u32 m0, s36, 151552
    v_add_f32 v97, -0.5, v97
    v_add_f32 v98, -0.5, v98
    v_mfma_f32_16x16x32_bf16 v[76:79], a[192:195], a[52:55], v[76:79]
    s_add_u32 s38, s33, 164096
    ds_read_b64_tr_b16 a[212:213], v11 offset:28672
    v_add_f32 v99, -0.5, v99
    v_mfma_f32_16x16x32_bf16 v[108:111], a[196:199], a[52:55], v[108:111]
    s_waitcnt vmcnt(6)
    ds_read_b64_tr_b16 a[214:215], v11 offset:30720
    v_add_f32 v104, -0.5, v104
    v_mfma_f32_16x16x32_bf16 v[100:103], a[196:199], a[48:51], v[100:103]
    s_barrier
    v_mfma_f32_16x16x32_bf16 v[68:71], a[192:195], a[48:51], v[68:71]
    s_waitcnt lgkmcnt(4)
    v_add_f32 v105, -0.5, v105
    v_add_f32 v106, -0.5, v106
    v_mfma_f32_16x16x32_bf16 v[68:71], a[200:203], a[64:67], v[68:71]
    s_add_u32 s57, s34, 164096
    ds_read_b64_tr_b16 a[192:193], v8 offset:32768
    v_add_f32 v107, -0.5, v107
    v_mfma_f32_16x16x32_bf16 v[100:103], a[204:207], a[64:67], v[100:103]
    s_cmp_lt_u32 s3, 2
    s_cselect_b32 s38, s38, s57
    ds_read_b64_tr_b16 a[194:195], v8 offset:34816
    v_mfma_f32_16x16x32_bf16 v[108:111], a[204:207], a[68:71], v[108:111]
pg_12:
    s_cbranch_execz pg_ret2
    buffer_load_dwordx4 v2, s[12:15], s38 offen lds
    v_mfma_f32_16x16x32_bf16 v[76:79], a[200:203], a[68:71], v[76:79]
    s_add_u32 m0, s36, 155648
    v_cvt_pk_bf16_f32 v96, v96, v97
    v_cvt_pk_bf16_f32 v97, v98, v99
    v_mfma_f32_16x16x32_bf16 v[84:87], a[200:203], a[72:75], v[84:87]
    s_add_u32 s38, s35, 164096
    ds_read_b64_tr_b16 a[196:197], v9 offset:32768
    v_cvt_pk_bf16_f32 v98, v104, v105
    v_mfma_f32_16x16x32_bf16 v[116:119], a[204:207], a[72:75], v[116:119]
    s_add_u32 s57, s33, 205056
    ds_read_b64_tr_b16 a[198:199], v9 offset:34816
    v_cvt_pk_bf16_f32 v99, v106, v107
    v_mfma_f32_16x16x32_bf16 v[124:127], a[204:207], a[76:79], v[124:127]
    buffer_store_dwordx4 v[96:99], v7, s[24:27], s55 offen sc1
    v_mfma_f32_16x16x32_bf16 v[92:95], a[200:203], a[76:79], v[92:95]
    s_waitcnt lgkmcnt(4)
    v_accvgpr_read_b32 v112, a236
    v_accvgpr_read_b32 v113, a237
    v_mfma_f32_16x16x32_bf16 v[92:95], a[208:211], a[92:95], v[92:95]
    s_cmp_lt_u32 s3, 2
    s_cselect_b32 s38, s38, s57
    ds_read_b64_tr_b16 a[200:201], v8 offset:36864
    v_mfma_f32_16x16x32_bf16 v[124:127], a[212:215], a[92:95], v[124:127]
    s_xor_b32 s55, s55, 1024
    ds_read_b64_tr_b16 a[202:203], v8 offset:38912
    v_accvgpr_read_b32 v114, a238
    v_mfma_f32_16x16x32_bf16 v[116:119], a[212:215], a[88:91], v[116:119]
    buffer_load_dwordx4 v2, s[12:15], s38 offen lds
    v_mfma_f32_16x16x32_bf16 v[84:87], a[208:211], a[88:91], v[84:87]
    s_add_u32 m0, s36, 159744
    v_accvgpr_read_b32 v115, a239
    v_accvgpr_read_b32 v120, a252
    v_mfma_f32_16x16x32_bf16 v[76:79], a[208:211], a[84:87], v[76:79]
    s_add_u32 s38, s34, 205056
    ds_read_b64_tr_b16 a[204:205], v9 offset:36864
    v_accvgpr_read_b32 v121, a253
    v_mfma_f32_16x16x32_bf16 v[108:111], a[212:215], a[84:87], v[108:111]
    s_add_u32 s57, s35, 205056
    ds_read_b64_tr_b16 a[206:207], v9 offset:38912
    v_accvgpr_read_b32 v122, a254
    v_mfma_f32_16x16x32_bf16 v[100:103], a[212:215], a[80:83], v[100:103]
    s_cmp_lt_u32 s3, 2
    s_cselect_b32 s38, s38, s57
    v_accvgpr_read_b32 v123, a255
    v_mfma_f32_16x16x32_bf16 v[68:71], a[208:211], a[80:83], v[68:71]
    s_waitcnt lgkmcnt(4)
    buffer_load_dwordx4 v2, s[12:15], s38 offen lds
    v_mfma_f32_16x16x32_bf16 v[132:135], a[192:195], a[160:163], v[132:135]
    ds_read_b64_tr_b16 a[208:209], v8 offset:40960
    v_add_f32 v112, -0.5, v112
    v_mfma_f32_16x16x32_bf16 v[164:167], a[196:199], a[160:163], v[164:167]
    ds_read_b64_tr_b16 a[210:211], v8 offset:43008
    v_add_f32 v113, -0.5, v113
    v_mfma_f32_16x16x32_bf16 v[172:175], a[196:199], a[164:167], v[172:175]
    v_add_f32 v114, -0.5, v114
    v_add_f32 v115, -0.5, v115
    v_mfma_f32_16x16x32_bf16 v[140:143], a[192:195], a[164:167], v[140:143]
    v_add_f32 v120, -0.5, v120
    v_add_f32 v121, -0.5, v121
    v_mfma_f32_16x16x32_bf16 v[148:151], a[192:195], a[168:171], v[148:151]
    ds_read_b64_tr_b16 a[212:213], v9 offset:40960
    v_add_f32 v122, -0.5, v122
    v_mfma_f32_16x16x32_bf16 v[180:183], a[196:199], a[168:171], v[180:183]
    ds_read_b64_tr_b16 a[214:215], v9 offset:43008
    v_add_f32 v123, -0.5, v123
    v_mfma_f32_16x16x32_bf16 v[188:191], a[196:199], a[172:175], v[188:191]
    v_cvt_pk_bf16_f32 v112, v112, v113
    v_cvt_pk_bf16_f32 v113, v114, v115
    v_mfma_f32_16x16x32_bf16 v[156:159], a[192:195], a[172:175], v[156:159]
    s_waitcnt lgkmcnt(4)
    v_cvt_pk_bf16_f32 v114, v120, v121
    v_cvt_pk_bf16_f32 v115, v122, v123
    v_mfma_f32_16x16x32_bf16 v[156:159], a[200:203], a[188:191], v[156:159]
    ds_read_b64_tr_b16 a[192:193], v8 offset:45056
    v_cvt_pk_bf16_f32 v68, v68, v69
    v_mfma_f32_16x16x32_bf16 v[188:191], a[204:207], a[188:191], v[188:191]
    ds_read_b64_tr_b16 a[194:195], v8 offset:47104
    v_cvt_pk_bf16_f32 v69, v70, v71
    v_mfma_f32_16x16x32_bf16 v[180:183], a[204:207], a[184:187], v[180:183]
    buffer_store_dwordx4 v[112:115], v7, s[24:27], s55 offen sc1
    v_mfma_f32_16x16x32_bf16 v[148:151], a[200:203], a[184:187], v[148:151]
    s_xor_b32 s55, s55, 3072
    v_cvt_pk_bf16_f32 v70, v100, v101
    v_cvt_pk_bf16_f32 v71, v102, v103
    v_mfma_f32_16x16x32_bf16 v[140:143], a[200:203], a[180:183], v[140:143]
    s_add_u32 s55, s55, 16384
    ds_read_b64_tr_b16 a[196:197], v9 offset:45056
    v_cvt_pk_bf16_f32 v76, v76, v77
    v_mfma_f32_16x16x32_bf16 v[172:175], a[204:207], a[180:183], v[172:175]
    ds_read_b64_tr_b16 a[198:199], v9 offset:47104
    v_cvt_pk_bf16_f32 v77, v78, v79
    v_mfma_f32_16x16x32_bf16 v[164:167], a[204:207], a[176:179], v[164:167]
    buffer_store_dwordx4 v[68:71], v6, s[24:27], s55 offen sc1
    v_mfma_f32_16x16x32_bf16 v[132:135], a[200:203], a[176:179], v[132:135]
    s_waitcnt lgkmcnt(4)
    v_cvt_pk_bf16_f32 v78, v108, v109
    v_cvt_pk_bf16_f32 v79, v110, v111
    v_mfma_f32_16x16x32_bf16 v[132:135], a[208:211], a[0:3], v[132:135]
    s_xor_b32 s55, s55, 1024
    ds_read_b64_tr_b16 a[200:201], v8 offset:49152
    v_cvt_pk_bf16_f32 v84, v84, v85
    v_mfma_f32_16x16x32_bf16 v[164:167], a[212:215], a[0:3], v[164:167]
    ds_read_b64_tr_b16 a[202:203], v8 offset:51200
    v_cvt_pk_bf16_f32 v85, v86, v87
    v_mfma_f32_16x16x32_bf16 v[172:175], a[212:215], a[4:7], v[172:175]
    buffer_store_dwordx4 v[76:79], v6, s[24:27], s55 offen sc1
    v_mfma_f32_16x16x32_bf16 v[140:143], a[208:211], a[4:7], v[140:143]
    s_xor_b32 s55, s55, 3072
    v_cvt_pk_bf16_f32 v86, v116, v117
    v_cvt_pk_bf16_f32 v87, v118, v119
    v_mfma_f32_16x16x32_bf16 v[148:151], a[208:211], a[8:11], v[148:151]
    ds_read_b64_tr_b16 a[204:205], v9 offset:49152
    v_cvt_pk_bf16_f32 v92, v92, v93
    v_mfma_f32_16x16x32_bf16 v[180:183], a[212:215], a[8:11], v[180:183]
    ds_read_b64_tr_b16 a[206:207], v9 offset:51200
    v_cvt_pk_bf16_f32 v93, v94, v95
    v_mfma_f32_16x16x32_bf16 v[188:191], a[212:215], a[12:15], v[188:191]
    v_cvt_pk_bf16_f32 v94, v124, v125
    v_cvt_pk_bf16_f32 v95, v126, v127
    v_mfma_f32_16x16x32_bf16 v[156:159], a[208:211], a[12:15], v[156:159]
    s_waitcnt lgkmcnt(4)
    v_lshl_add_u32 v14, s3, 4, v14
    v_lshlrev_b32 v14, 6, v14
    v_mfma_f32_16x16x32_bf16 v[156:159], a[192:195], a[28:31], v[156:159]
    ds_read_b64_tr_b16 a[208:209], v8 offset:53248
    v_lshlrev_b32 v26, 16, v144
    v_mfma_f32_16x16x32_bf16 v[188:191], a[196:199], a[28:31], v[188:191]
    ds_read_b64_tr_b16 a[210:211], v8 offset:55296
    v_and_b32 v27, 0xffff0000, v144
    v_mfma_f32_16x16x32_bf16 v[180:183], a[196:199], a[24:27], v[180:183]
    v_fma_f32 v26, v26, v25, v24
    v_fma_f32 v27, v27, v25, v24
    v_mfma_f32_16x16x32_bf16 v[148:151], a[192:195], a[24:27], v[148:151]
    v_mul_f32 v30, s92, v26
    v_mul_f32 v31, s92, v27
    v_mfma_f32_16x16x32_bf16 v[140:143], a[192:195], a[20:23], v[140:143]
    ds_read_b64_tr_b16 a[212:213], v9 offset:53248
    v_add_f32 v247, -0.5, v247
    v_mfma_f32_16x16x32_bf16 v[172:175], a[196:199], a[20:23], v[172:175]
    ds_read_b64_tr_b16 a[214:215], v9 offset:55296
    v_add_f32 v220, -0.5, v220
    v_mfma_f32_16x16x32_bf16 v[164:167], a[196:199], a[16:19], v[164:167]
    buffer_store_dwordx4 v[84:87], v6, s[24:27], s55 offen sc1
    v_mfma_f32_16x16x32_bf16 v[132:135], a[192:195], a[16:19], v[132:135]
    s_waitcnt lgkmcnt(4)
    v_exp_f32 v30, v30
    v_mfma_f32_16x16x32_bf16 v[132:135], a[200:203], a[32:35], v[132:135]
    s_xor_b32 s55, s55, 1024
    ds_read_b64_tr_b16 a[192:193], v8 offset:57344
    v_add_f32 v221, -0.5, v221
    v_mfma_f32_16x16x32_bf16 v[164:167], a[204:207], a[32:35], v[164:167]
    ds_read_b64_tr_b16 a[194:195], v8 offset:59392
    v_add_f32 v222, -0.5, v222
    v_mfma_f32_16x16x32_bf16 v[172:175], a[204:207], a[36:39], v[172:175]
    v_exp_f32 v31, v31
    v_mfma_f32_16x16x32_bf16 v[140:143], a[200:203], a[36:39], v[140:143]
    v_add_f32 v30, 1.0, v30
    v_add_f32 v31, 1.0, v31
    v_mfma_f32_16x16x32_bf16 v[148:151], a[200:203], a[40:43], v[148:151]
    s_mov_b32 s32, s84
    ds_read_b64_tr_b16 a[196:197], v9 offset:57344
    v_add_f32 v223, -0.5, v223
    v_mfma_f32_16x16x32_bf16 v[180:183], a[204:207], a[40:43], v[180:183]
    s_and_b32 s33, s85, 0xffff
    ds_read_b64_tr_b16 a[198:199], v9 offset:59392
    v_add_f32 v252, -0.5, v252
    v_mfma_f32_16x16x32_bf16 v[188:191], a[204:207], a[44:47], v[188:191]
    s_mov_b32 s34, 2621440
    v_rcp_f32 v30, v30
    v_mfma_f32_16x16x32_bf16 v[156:159], a[200:203], a[44:47], v[156:159]
    s_waitcnt lgkmcnt(4)
    v_rcp_f32 v31, v31
    v_mfma_f32_16x16x32_bf16 v[156:159], a[208:211], a[60:63], v[156:159]
    s_mov_b32 s35, 0x00020000
    ds_read_b64_tr_b16 a[200:201], v8 offset:61440
    v_mul_f32 v26, v26, v30
    v_mfma_f32_16x16x32_bf16 v[188:191], a[212:215], a[60:63], v[188:191]
    ds_read_b64_tr_b16 a[202:203], v8 offset:63488
    v_mul_f32 v27, v27, v31
    v_mfma_f32_16x16x32_bf16 v[180:183], a[212:215], a[56:59], v[180:183]
    buffer_load_dword v137, v136, s[24:27], s59 offen offset:128 sc1
    v_mfma_f32_16x16x32_bf16 v[148:151], a[208:211], a[56:59], v[148:151]
    buffer_store_dwordx4 v[92:95], v6, s[24:27], s55 offen sc1
    v_mfma_f32_16x16x32_bf16 v[140:143], a[208:211], a[52:55], v[140:143]
    s_xor_b32 s55, s55, 3072
    ds_read_b64_tr_b16 a[204:205], v9 offset:61440
    v_cvt_pk_bf16_f32 v168, v26, v27
    v_mfma_f32_16x16x32_bf16 v[172:175], a[212:215], a[52:55], v[172:175]
    s_add_u32 s55, s55, 16384
    ds_read_b64_tr_b16 a[206:207], v9 offset:63488
    v_lshlrev_b32 v26, 16, v145
    v_mfma_f32_16x16x32_bf16 v[164:167], a[212:215], a[48:51], v[164:167]
    v_and_b32 v27, 0xffff0000, v145
    v_fma_f32 v26, v26, v25, v24
    v_mfma_f32_16x16x32_bf16 v[132:135], a[208:211], a[48:51], v[132:135]
    s_waitcnt lgkmcnt(4)
    v_fma_f32 v27, v27, v25, v24
    v_mul_f32 v30, s92, v26
    v_mfma_f32_16x16x32_bf16 v[132:135], a[192:195], a[64:67], v[132:135]
    ds_read_b64_tr_b16 a[208:209], v10 offset:32768
    v_mul_f32 v31, s92, v27
    v_mfma_f32_16x16x32_bf16 v[164:167], a[196:199], a[64:67], v[164:167]
    ds_read_b64_tr_b16 a[210:211], v10 offset:34816
    v_add_f32 v253, -0.5, v253
    v_mfma_f32_16x16x32_bf16 v[172:175], a[196:199], a[68:71], v[172:175]
    s_load_dword s67, s[86:87], s5 glc
    v_exp_f32 v30, v30
    v_mfma_f32_16x16x32_bf16 v[140:143], a[192:195], a[68:71], v[140:143]
    v_exp_f32 v31, v31
    v_mfma_f32_16x16x32_bf16 v[148:151], a[192:195], a[72:75], v[148:151]
    ds_read_b64_tr_b16 a[212:213], v11 offset:32768
    v_add_f32 v30, 1.0, v30
    v_mfma_f32_16x16x32_bf16 v[180:183], a[196:199], a[72:75], v[180:183]
    ds_read_b64_tr_b16 a[214:215], v11 offset:34816
    v_add_f32 v31, 1.0, v31
    v_mfma_f32_16x16x32_bf16 v[188:191], a[196:199], a[76:79], v[188:191]
    v_rcp_f32 v30, v30
    v_mfma_f32_16x16x32_bf16 v[156:159], a[192:195], a[76:79], v[156:159]
    s_waitcnt lgkmcnt(4)
    v_rcp_f32 v31, v31
    v_mfma_f32_16x16x32_bf16 v[156:159], a[200:203], a[92:95], v[156:159]
    ds_read_b64_tr_b16 a[192:193], v10 offset:36864
    v_mul_f32 v26, v26, v30
    v_mfma_f32_16x16x32_bf16 v[188:191], a[204:207], a[92:95], v[188:191]
    ds_read_b64_tr_b16 a[194:195], v10 offset:38912
    v_mul_f32 v27, v27, v31
    v_mfma_f32_16x16x32_bf16 v[180:183], a[204:207], a[88:91], v[180:183]
    v_cvt_pk_bf16_f32 v169, v26, v27
    v_lshlrev_b32 v26, 16, v146
    v_mfma_f32_16x16x32_bf16 v[148:151], a[200:203], a[88:91], v[148:151]
    v_and_b32 v27, 0xffff0000, v146
    v_fma_f32 v26, v26, v25, v24
    v_mfma_f32_16x16x32_bf16 v[140:143], a[200:203], a[84:87], v[140:143]
    ds_read_b64_tr_b16 a[196:197], v11 offset:36864
    v_fma_f32 v27, v27, v25, v24
    v_mfma_f32_16x16x32_bf16 v[172:175], a[204:207], a[84:87], v[172:175]
    ds_read_b64_tr_b16 a[198:199], v11 offset:38912
    v_mul_f32 v30, s92, v26
    v_add_f32 v254, -0.5, v254
    v_add_f32 v255, -0.5, v255
    v_mfma_f32_16x16x32_bf16 v[164:167], a[204:207], a[80:83], v[164:167]
    s_waitcnt vmcnt(5)
    v_mul_f32 v31, s92, v27
    v_add_f32 v32, -0.5, v32
    v_mfma_f32_16x16x32_bf16 v[132:135], a[200:203], a[80:83], v[132:135]
    s_waitcnt lgkmcnt(4)
    v_exp_f32 v30, v30
    v_mfma_f32_16x16x32_bf16 v[196:199], a[208:211], a[160:163], v[196:199]
    ds_read_b64_tr_b16 a[200:201], v10 offset:40960
    v_add_f32 v33, -0.5, v33
    v_mfma_f32_16x16x32_bf16 v[228:231], a[212:215], a[160:163], v[228:231]
    ds_read_b64_tr_b16 a[202:203], v10 offset:43008
    v_add_f32 v34, -0.5, v34
    v_mfma_f32_16x16x32_bf16 v[236:239], a[212:215], a[164:167], v[236:239]
    buffer_atomic_or v128, v131, s[24:27], 0 offen offset:512
    v_mfma_f32_16x16x32_bf16 v[204:207], a[208:211], a[164:167], v[204:207]
    v_exp_f32 v31, v31
    v_mfma_f32_16x16x32_bf16 v[212:215], a[208:211], a[168:171], v[212:215]
    ds_read_b64_tr_b16 a[204:205], v11 offset:40960
    v_add_f32 v30, 1.0, v30
    v_mfma_f32_16x16x32_bf16 v[244:247], a[212:215], a[168:171], v[244:247]
    ds_read_b64_tr_b16 a[206:207], v11 offset:43008
    v_add_f32 v31, 1.0, v31
    v_mfma_f32_16x16x32_bf16 v[252:255], a[212:215], a[172:175], v[252:255]
    v_cvt_pk_bf16_f32 v132, v132, v133
    v_cvt_pk_bf16_f32 v133, v134, v135
    v_mfma_f32_16x16x32_bf16 v[220:223], a[208:211], a[172:175], v[220:223]
    s_waitcnt lgkmcnt(4)
    v_cvt_pk_bf16_f32 v134, v164, v165
    v_cvt_pk_bf16_f32 v135, v166, v167
    v_mfma_f32_16x16x32_bf16 v[220:223], a[192:195], a[188:191], v[220:223]
    ds_read_b64_tr_b16 a[208:209], v10 offset:45056
    v_cvt_pk_bf16_f32 v140, v140, v141
    v_mfma_f32_16x16x32_bf16 v[252:255], a[196:199], a[188:191], v[252:255]
    ds_read_b64_tr_b16 a[210:211], v10 offset:47104
    v_cvt_pk_bf16_f32 v141, v142, v143
    v_mfma_f32_16x16x32_bf16 v[244:247], a[196:199], a[184:187], v[244:247]
    buffer_store_dwordx4 v[132:135], v6, s[24:27], s55 offen sc1
    v_mfma_f32_16x16x32_bf16 v[212:215], a[192:195], a[184:187], v[212:215]
    s_xor_b32 s55, s55, 1024
    v_cvt_pk_bf16_f32 v142, v172, v173
    v_cvt_pk_bf16_f32 v143, v174, v175
    v_mfma_f32_16x16x32_bf16 v[204:207], a[192:195], a[180:183], v[204:207]
    ds_read_b64_tr_b16 a[212:213], v11 offset:45056
    v_cvt_pk_bf16_f32 v148, v148, v149
    v_mfma_f32_16x16x32_bf16 v[236:239], a[196:199], a[180:183], v[236:239]
    ds_read_b64_tr_b16 a[214:215], v11 offset:47104
    v_cvt_pk_bf16_f32 v149, v150, v151
    v_mfma_f32_16x16x32_bf16 v[228:231], a[196:199], a[176:179], v[228:231]
    v_cvt_pk_bf16_f32 v150, v180, v181
    v_cvt_pk_bf16_f32 v151, v182, v183
    v_mfma_f32_16x16x32_bf16 v[196:199], a[192:195], a[176:179], v[196:199]
    s_waitcnt lgkmcnt(4)
    v_cvt_pk_bf16_f32 v156, v156, v157
    v_cvt_pk_bf16_f32 v157, v158, v159
    v_mfma_f32_16x16x32_bf16 v[196:199], a[200:203], a[0:3], v[196:199]
    ds_read_b64_tr_b16 a[192:193], v10 offset:49152
    v_cvt_pk_bf16_f32 v158, v188, v189
    v_mfma_f32_16x16x32_bf16 v[228:231], a[204:207], a[0:3], v[228:231]
    ds_read_b64_tr_b16 a[194:195], v10 offset:51200
    v_cvt_pk_bf16_f32 v159, v190, v191
    v_mfma_f32_16x16x32_bf16 v[236:239], a[204:207], a[4:7], v[236:239]
    buffer_store_dwordx4 v[140:143], v6, s[24:27], s55 offen sc1
    v_mfma_f32_16x16x32_bf16 v[204:207], a[200:203], a[4:7], v[204:207]
    s_xor_b32 s55, s55, 3072
    v_rcp_f32 v30, v30
    v_mfma_f32_16x16x32_bf16 v[212:215], a[200:203], a[8:11], v[212:215]
    ds_read_b64_tr_b16 a[196:197], v11 offset:49152
    v_add_f32 v35, -0.5, v35
    v_mfma_f32_16x16x32_bf16 v[244:247], a[204:207], a[8:11], v[244:247]
    ds_read_b64_tr_b16 a[198:199], v11 offset:51200
    v_add_f32 v48, -0.5, v48
    v_mfma_f32_16x16x32_bf16 v[252:255], a[204:207], a[12:15], v[252:255]
    s_andn2_b32 s69, s67, s68
    s_and_b32 s69, s69, 255
    s_or_b32 s68, s68, s69
    v_mfma_f32_16x16x32_bf16 v[220:223], a[200:203], a[12:15], v[220:223]
    s_waitcnt lgkmcnt(4)
    v_readlane_b32 s56, v23, 0
    v_add_f32 v49, -0.5, v49
    v_mfma_f32_16x16x32_bf16 v[220:223], a[208:211], a[28:31], v[220:223]
    s_add_u32 m0, s37, 0
    ds_read_b64_tr_b16 a[200:201], v10 offset:53248
    v_add_f32 v50, -0.5, v50
    v_mfma_f32_16x16x32_bf16 v[252:255], a[212:215], a[28:31], v[252:255]
    s_bitcmp1_b32 s69, 0
    s_cselect_b32 s56, s56, 0x70000000
    s_cselect_b32 m0, m0, 0x30000
    ds_read_b64_tr_b16 a[202:203], v10 offset:55296
    v_mfma_f32_16x16x32_bf16 v[244:247], a[212:215], a[24:27], v[244:247]
    buffer_load_dwordx4 v28, s[24:27], s56 offen sc1 lds
    v_mfma_f32_16x16x32_bf16 v[212:215], a[208:211], a[24:27], v[212:215]
    v_readlane_b32 s56, v23, 1
    v_add_f32 v51, -0.5, v51
    v_mfma_f32_16x16x32_bf16 v[204:207], a[208:211], a[20:23], v[204:207]
    s_waitcnt vmcnt(5)
    ds_read_b64_tr_b16 a[204:205], v11 offset:53248
    v_cmp_ne_u32 s[78:79], 24, v137
    v_mfma_f32_16x16x32_bf16 v[236:239], a[212:215], a[20:23], v[236:239]
    s_cmp_eq_u64 s[78:79], 0
    s_cselect_b32 s44, s59, 0x70000000
    ds_read_b64_tr_b16 a[206:207], v11 offset:55296
    v_mfma_f32_16x16x32_bf16 v[228:231], a[212:215], a[16:19], v[228:231]
    buffer_load_dwordx4 v[240:243], v192, s[24:27], s44 offen sc1
    v_mfma_f32_16x16x32_bf16 v[196:199], a[208:211], a[16:19], v[196:199]
    s_waitcnt lgkmcnt(4)
    v_rcp_f32 v31, v31
    v_mfma_f32_16x16x32_bf16 v[196:199], a[192:195], a[32:35], v[196:199]
    s_add_u32 m0, s37, 1024
    ds_read_b64_tr_b16 a[208:209], v10 offset:57344
    v_mul_f32 v26, v26, v30
    v_mfma_f32_16x16x32_bf16 v[228:231], a[196:199], a[32:35], v[228:231]
    s_bitcmp1_b32 s69, 1
    s_cselect_b32 s56, s56, 0x70000000
    s_cselect_b32 m0, m0, 0x30000
    ds_read_b64_tr_b16 a[210:211], v10 offset:59392
    v_mfma_f32_16x16x32_bf16 v[236:239], a[196:199], a[36:39], v[236:239]
    buffer_load_dwordx4 v28, s[24:27], s56 offen sc1 lds
    v_mfma_f32_16x16x32_bf16 v[204:207], a[192:195], a[36:39], v[204:207]
    v_readlane_b32 s56, v23, 2
    v_mul_f32 v27, v27, v31
    v_mfma_f32_16x16x32_bf16 v[212:215], a[192:195], a[40:43], v[212:215]
    s_add_u32 m0, s37, 2048
    ds_read_b64_tr_b16 a[212:213], v11 offset:57344
    v_cvt_pk_bf16_f32 v170, v26, v27
    v_mfma_f32_16x16x32_bf16 v[244:247], a[196:199], a[40:43], v[244:247]
    s_bitcmp1_b32 s69, 2
    s_cselect_b32 s56, s56, 0x70000000
    s_cselect_b32 m0, m0, 0x30000
    ds_read_b64_tr_b16 a[214:215], v11 offset:59392
    v_mfma_f32_16x16x32_bf16 v[252:255], a[196:199], a[44:47], v[252:255]
    buffer_load_dwordx4 v28, s[24:27], s56 offen sc1 lds
    v_mfma_f32_16x16x32_bf16 v[220:223], a[192:195], a[44:47], v[220:223]
    s_waitcnt lgkmcnt(4)
    v_readlane_b32 s56, v23, 3
    v_lshlrev_b32 v26, 16, v147
    v_mfma_f32_16x16x32_bf16 v[220:223], a[200:203], a[60:63], v[220:223]
    s_add_u32 m0, s37, 3072
    ds_read_b64_tr_b16 a[192:193], v10 offset:61440
    v_and_b32 v27, 0xffff0000, v147
    v_mfma_f32_16x16x32_bf16 v[252:255], a[204:207], a[60:63], v[252:255]
    s_bitcmp1_b32 s69, 3
    s_cselect_b32 s56, s56, 0x70000000
    s_cselect_b32 m0, m0, 0x30000
    ds_read_b64_tr_b16 a[194:195], v10 offset:63488
    v_mfma_f32_16x16x32_bf16 v[244:247], a[204:207], a[56:59], v[244:247]
    buffer_store_dwordx4 v[148:151], v6, s[24:27], s55 offen sc1
    v_mfma_f32_16x16x32_bf16 v[212:215], a[200:203], a[56:59], v[212:215]
    s_xor_b32 s55, s55, 1024
    v_fma_f32 v26, v26, v25, v24
    v_fma_f32 v27, v27, v25, v24
    v_mfma_f32_16x16x32_bf16 v[204:207], a[200:203], a[52:55], v[204:207]
    ds_read_b64_tr_b16 a[196:197], v11 offset:61440
    v_mul_f32 v30, s92, v26
    v_mfma_f32_16x16x32_bf16 v[236:239], a[204:207], a[52:55], v[236:239]
    s_waitcnt vmcnt(14)
    ds_read_b64_tr_b16 a[198:199], v11 offset:63488
    v_mul_f32 v31, s92, v27
    v_mfma_f32_16x16x32_bf16 v[228:231], a[204:207], a[48:51], v[228:231]
    s_barrier
    v_mfma_f32_16x16x32_bf16 v[196:199], a[200:203], a[48:51], v[196:199]
    s_waitcnt lgkmcnt(4)
    buffer_load_dwordx4 v28, s[24:27], s56 offen sc1 lds
    v_mfma_f32_16x16x32_bf16 v[196:199], a[208:211], a[64:67], v[196:199]
    ds_read_b64_tr_b16 a[200:201], v18 offset:0
    v_readlane_b32 s56, v23, 4
    v_mfma_f32_16x16x32_bf16 v[228:231], a[212:215], a[64:67], v[228:231]
    s_add_u32 m0, s37, 4096
    ds_read_b64_tr_b16 a[202:203], v18 offset:1024
    v_add_f32 v36, -0.5, v36
    v_mfma_f32_16x16x32_bf16 v[236:239], a[212:215], a[68:71], v[236:239]
    buffer_store_dwordx4 v[156:159], v6, s[24:27], s55 offen sc1
    v_mfma_f32_16x16x32_bf16 v[204:207], a[208:211], a[68:71], v[204:207]
    s_bitcmp1_b32 s69, 4
    s_cselect_b32 s56, s56, 0x70000000
    s_cselect_b32 m0, m0, 0x30000
    v_mfma_f32_16x16x32_bf16 v[212:215], a[208:211], a[72:75], v[212:215]
    s_xor_b32 s55, s55, 3072
    ds_read_b64_tr_b16 a[204:205], v19 offset:0
    v_add_f32 v37, -0.5, v37
    v_mfma_f32_16x16x32_bf16 v[244:247], a[212:215], a[72:75], v[244:247]
    s_add_u32 s55, s55, 16384
    ds_read_b64_tr_b16 a[206:207], v19 offset:1024
    v_add_f32 v38, -0.5, v38
    v_mfma_f32_16x16x32_bf16 v[252:255], a[212:215], a[76:79], v[252:255]
    v_exp_f32 v30, v30
    v_mfma_f32_16x16x32_bf16 v[220:223], a[208:211], a[76:79], v[220:223]
    s_waitcnt lgkmcnt(4)
    buffer_load_dwordx4 v28, s[24:27], s56 offen sc1 lds
    v_mfma_f32_16x16x32_bf16 v[220:223], a[192:195], a[92:95], v[220:223]
    ds_read_b64_tr_b16 a[208:209], v18 offset:2048
    v_readlane_b32 s56, v23, 5
    v_mfma_f32_16x16x32_bf16 v[252:255], a[196:199], a[92:95], v[252:255]
    s_add_u32 m0, s37, 5120
    ds_read_b64_tr_b16 a[210:211], v18 offset:3072
    v_add_f32 v39, -0.5, v39
    v_mfma_f32_16x16x32_bf16 v[244:247], a[196:199], a[88:91], v[244:247]
    s_bitcmp1_b32 s69, 5
    s_cselect_b32 s56, s56, 0x70000000
    s_cselect_b32 m0, m0, 0x30000
    v_mfma_f32_16x16x32_bf16 v[212:215], a[192:195], a[88:91], v[212:215]
    buffer_load_dwordx4 v28, s[24:27], s56 offen sc1 lds
    v_mfma_f32_16x16x32_bf16 v[204:207], a[192:195], a[84:87], v[204:207]
    ds_read_b64_tr_b16 a[212:213], v19 offset:2048
    v_readlane_b32 s56, v23, 6
    v_mfma_f32_16x16x32_bf16 v[236:239], a[196:199], a[84:87], v[236:239]
    s_add_u32 m0, s37, 6144
    ds_read_b64_tr_b16 a[214:215], v19 offset:3072
    v_add_f32 v52, -0.5, v52
    v_add_f32 v53, -0.5, v53
    v_add_f32 v54, -0.5, v54
    v_add_f32 v55, -0.5, v55
    v_add_f32 v40, -0.5, v40
    v_add_f32 v41, -0.5, v41
    v_add_f32 v42, -0.5, v42
    v_add_f32 v43, -0.5, v43
    v_add_f32 v56, -0.5, v56
    v_add_f32 v57, -0.5, v57
    v_add_f32 v58, -0.5, v58
    v_add_f32 v59, -0.5, v59
    v_add_f32 v44, -0.5, v44
    v_add_f32 v45, -0.5, v45
    v_add_f32 v46, -0.5, v46
    v_add_f32 v47, -0.5, v47
    v_add_f32 v60, -0.5, v60
    v_add_f32 v61, -0.5, v61
    v_add_f32 v62, -0.5, v62
    v_add_f32 v63, -0.5, v63
    v_mfma_f32_16x16x32_bf16 v[228:231], a[196:199], a[80:83], v[228:231]
    s_waitcnt vmcnt(12)
    v_exp_f32 v31, v31
    v_mfma_f32_16x16x32_bf16 v[196:199], a[192:195], a[80:83], v[196:199]
    s_waitcnt lgkmcnt(4)
    v_add_f32 v30, 1.0, v30
    v_add_f32 v31, 1.0, v31
    v_mfma_f32_16x16x32_bf16 v[32:35], a[200:203], a[160:163], v[32:35]
    s_bitcmp1_b32 s69, 6
    s_cselect_b32 s56, s56, 0x70000000
    s_cselect_b32 m0, m0, 0x30000
    ds_read_b64_tr_b16 a[192:193], v18 offset:4096
    v_mfma_f32_16x16x32_bf16 v[48:51], a[204:207], a[160:163], v[48:51]
    ds_read_b64_tr_b16 a[194:195], v18 offset:5120
    v_and_b32 v4, 0x300, v28
    v_mfma_f32_16x16x32_bf16 v[52:55], a[204:207], a[164:167], v[52:55]
    buffer_atomic_or v128, v3, s[24:27], 0 offen offset:0
    v_mfma_f32_16x16x32_bf16 v[36:39], a[200:203], a[164:167], v[36:39]
    buffer_load_dwordx4 v28, s[24:27], s56 offen sc1 lds
    v_mfma_f32_16x16x32_bf16 v[40:43], a[200:203], a[168:171], v[40:43]
    ds_read_b64_tr_b16 a[196:197], v19 offset:4096
    v_readlane_b32 s56, v23, 7
    v_mfma_f32_16x16x32_bf16 v[56:59], a[204:207], a[168:171], v[56:59]
    s_add_u32 m0, s37, 7168
    ds_read_b64_tr_b16 a[198:199], v19 offset:5120
    v_add3_u32 v4, v4, v28, s37
    v_mfma_f32_16x16x32_bf16 v[60:63], a[204:207], a[172:175], v[60:63]
    s_bitcmp1_b32 s69, 7
    s_cselect_b32 s56, s56, 0x70000000
    s_cselect_b32 m0, m0, 0x30000
    v_mfma_f32_16x16x32_bf16 v[44:47], a[200:203], a[172:175], v[44:47]
    s_waitcnt lgkmcnt(4)
    buffer_load_dwordx4 v28, s[24:27], s56 offen sc1 lds
    v_mfma_f32_16x16x32_bf16 v[44:47], a[208:211], a[188:191], v[44:47]
    ds_read_b64_tr_b16 a[200:201], v18 offset:6144
    v_cvt_pk_bf16_f32 v196, v196, v197
    v_mfma_f32_16x16x32_bf16 v[60:63], a[212:215], a[188:191], v[60:63]
    ds_read_b64_tr_b16 a[202:203], v18 offset:7168
    v_cvt_pk_bf16_f32 v197, v198, v199
    v_mfma_f32_16x16x32_bf16 v[56:59], a[212:215], a[184:187], v[56:59]
    v_cvt_pk_bf16_f32 v198, v228, v229
    v_cvt_pk_bf16_f32 v199, v230, v231
    v_mfma_f32_16x16x32_bf16 v[40:43], a[208:211], a[184:187], v[40:43]
    buffer_store_dwordx4 v[196:199], v6, s[24:27], s55 offen sc1
    v_mfma_f32_16x16x32_bf16 v[36:39], a[208:211], a[180:183], v[36:39]
    s_xor_b32 s55, s55, 1024
    ds_read_b64_tr_b16 a[204:205], v19 offset:6144
    v_cvt_pk_bf16_f32 v204, v204, v205
    v_mfma_f32_16x16x32_bf16 v[52:55], a[212:215], a[180:183], v[52:55]
    ds_read_b64_tr_b16 a[206:207], v19 offset:7168
    v_cvt_pk_bf16_f32 v205, v206, v207
    v_mfma_f32_16x16x32_bf16 v[48:51], a[212:215], a[176:179], v[48:51]
    v_cvt_pk_bf16_f32 v206, v236, v237
    v_cvt_pk_bf16_f32 v207, v238, v239
    v_mfma_f32_16x16x32_bf16 v[32:35], a[208:211], a[176:179], v[32:35]
    s_waitcnt lgkmcnt(4)
    v_cvt_pk_bf16_f32 v212, v212, v213
    v_cvt_pk_bf16_f32 v213, v214, v215
    v_mfma_f32_16x16x32_bf16 v[32:35], a[192:195], a[0:3], v[32:35]
    ds_read_b64_tr_b16 a[208:209], v18 offset:8192
    v_cvt_pk_bf16_f32 v214, v244, v245
    v_mfma_f32_16x16x32_bf16 v[48:51], a[196:199], a[0:3], v[48:51]
    ds_read_b64_tr_b16 a[210:211], v18 offset:9216
    v_cvt_pk_bf16_f32 v215, v246, v247
    v_mfma_f32_16x16x32_bf16 v[52:55], a[196:199], a[4:7], v[52:55]
    buffer_store_dwordx4 v[204:207], v6, s[24:27], s55 offen sc1
    v_mfma_f32_16x16x32_bf16 v[36:39], a[192:195], a[4:7], v[36:39]
    s_xor_b32 s55, s55, 3072
    v_cvt_pk_bf16_f32 v220, v220, v221
    v_cvt_pk_bf16_f32 v221, v222, v223
    v_mfma_f32_16x16x32_bf16 v[40:43], a[192:195], a[8:11], v[40:43]
    ds_read_b64_tr_b16 a[212:213], v19 offset:8192
    v_cvt_pk_bf16_f32 v222, v252, v253
    v_mfma_f32_16x16x32_bf16 v[56:59], a[196:199], a[8:11], v[56:59]
    ds_read_b64_tr_b16 a[214:215], v19 offset:9216
    v_cvt_pk_bf16_f32 v223, v254, v255
    v_mfma_f32_16x16x32_bf16 v[60:63], a[196:199], a[12:15], v[60:63]
    v_rcp_f32 v30, v30
    v_mfma_f32_16x16x32_bf16 v[44:47], a[192:195], a[12:15], v[44:47]
    s_waitcnt lgkmcnt(4)
    v_rcp_f32 v31, v31
    v_mfma_f32_16x16x32_bf16 v[44:47], a[200:203], a[28:31], v[44:47]
    ds_read_b64_tr_b16 a[192:193], v18 offset:10240
    v_mul_f32 v26, v26, v30
    v_mfma_f32_16x16x32_bf16 v[60:63], a[204:207], a[28:31], v[60:63]
    ds_read_b64_tr_b16 a[194:195], v18 offset:11264
    v_mul_f32 v27, v27, v31
    v_mfma_f32_16x16x32_bf16 v[56:59], a[204:207], a[24:27], v[56:59]
    v_cvt_pk_bf16_f32 v171, v26, v27
    s_waitcnt vmcnt(31)
    v_mfma_f32_16x16x32_bf16 v[40:43], a[200:203], a[24:27], v[40:43]
    v_lshlrev_b32 v26, 16, v152
    v_and_b32 v27, 0xffff0000, v152
    v_mfma_f32_16x16x32_bf16 v[36:39], a[200:203], a[20:23], v[36:39]
    ds_read_b64_tr_b16 a[196:197], v19 offset:10240
    v_fma_f32 v26, v26, v25, v24
    v_mfma_f32_16x16x32_bf16 v[52:55], a[204:207], a[20:23], v[52:55]
    ds_read_b64_tr_b16 a[198:199], v19 offset:11264
    v_fma_f32 v27, v27, v25, v24
    v_mfma_f32_16x16x32_bf16 v[48:51], a[204:207], a[16:19], v[48:51]
    buffer_store_dwordx4 v[212:215], v6, s[24:27], s55 offen sc1
    v_mfma_f32_16x16x32_bf16 v[32:35], a[200:203], a[16:19], v[32:35]
    s_waitcnt lgkmcnt(4)
    v_mul_f32 v30, s92, v26
    v_mul_f32 v31, s92, v27
    v_mfma_f32_16x16x32_bf16 v[32:35], a[208:211], a[32:35], v[32:35]
    s_xor_b32 s55, s55, 1024
    ds_read_b64_tr_b16 a[200:201], v18 offset:12288
    v_mfma_f32_16x16x32_bf16 v[48:51], a[212:215], a[32:35], v[48:51]
    ds_read_b64_tr_b16 a[202:203], v18 offset:13312
    v_mfma_f32_16x16x32_bf16 v[52:55], a[212:215], a[36:39], v[52:55]
pg_13:
    s_cbranch_execz pg_ret2
    v_exp_f32 v30, v30
    v_mfma_f32_16x16x32_bf16 v[36:39], a[208:211], a[36:39], v[36:39]
    v_exp_f32 v31, v31
    v_mfma_f32_16x16x32_bf16 v[40:43], a[208:211], a[40:43], v[40:43]
    ds_read_b64_tr_b16 a[204:205], v19 offset:12288
    v_add_f32 v30, 1.0, v30
    v_mfma_f32_16x16x32_bf16 v[56:59], a[212:215], a[40:43], v[56:59]
    ds_read_b64_tr_b16 a[206:207], v19 offset:13312
    v_add_f32 v31, 1.0, v31
    v_mfma_f32_16x16x32_bf16 v[60:63], a[212:215], a[44:47], v[60:63]
    s_waitcnt vmcnt(8)
    v_rcp_f32 v30, v30
    v_mfma_f32_16x16x32_bf16 v[44:47], a[208:211], a[44:47], v[44:47]
    s_waitcnt lgkmcnt(4)
    v_rcp_f32 v31, v31
    v_mfma_f32_16x16x32_bf16 v[44:47], a[192:195], a[60:63], v[44:47]
    ds_read_b64_tr_b16 a[208:209], v18 offset:14336
    v_mul_f32 v26, v26, v30
    v_mfma_f32_16x16x32_bf16 v[60:63], a[196:199], a[60:63], v[60:63]
    ds_read_b64_tr_b16 a[210:211], v18 offset:15360
    v_mul_f32 v27, v27, v31
    v_mfma_f32_16x16x32_bf16 v[56:59], a[196:199], a[56:59], v[56:59]
    buffer_atomic_or v129, v3, s[24:27], 0 offen offset:0
    v_mfma_f32_16x16x32_bf16 v[40:43], a[192:195], a[56:59], v[40:43]
    buffer_store_dwordx4 v[220:223], v6, s[24:27], s55 offen sc1
    v_mfma_f32_16x16x32_bf16 v[36:39], a[192:195], a[52:55], v[36:39]
    s_xor_b32 s55, s55, 3072
    ds_read_b64_tr_b16 a[212:213], v19 offset:14336
    v_cvt_pk_bf16_f32 v176, v26, v27
    v_mfma_f32_16x16x32_bf16 v[52:55], a[196:199], a[52:55], v[52:55]
    s_add_u32 s55, s55, 16384
    ds_read_b64_tr_b16 a[214:215], v19 offset:15360
    v_lshlrev_b32 v26, 16, v153
    v_mfma_f32_16x16x32_bf16 v[48:51], a[196:199], a[48:51], v[48:51]
    v_and_b32 v27, 0xffff0000, v153
    v_fma_f32 v26, v26, v25, v24
    v_mfma_f32_16x16x32_bf16 v[32:35], a[192:195], a[48:51], v[32:35]
    s_waitcnt lgkmcnt(4)
    v_fma_f32 v27, v27, v25, v24
    v_mul_f32 v30, s92, v26
    v_mfma_f32_16x16x32_bf16 v[32:35], a[200:203], a[64:67], v[32:35]
    v_mul_f32 v31, s92, v27
    v_mfma_f32_16x16x32_bf16 v[48:51], a[204:207], a[64:67], v[48:51]
    v_exp_f32 v30, v30
    v_mfma_f32_16x16x32_bf16 v[52:55], a[204:207], a[68:71], v[52:55]
    v_exp_f32 v31, v31
    v_mfma_f32_16x16x32_bf16 v[36:39], a[200:203], a[68:71], v[36:39]
    v_add_f32 v30, 1.0, v30
    v_add_f32 v31, 1.0, v31
    v_mfma_f32_16x16x32_bf16 v[40:43], a[200:203], a[72:75], v[40:43]
    v_rcp_f32 v30, v30
    v_mfma_f32_16x16x32_bf16 v[56:59], a[204:207], a[72:75], v[56:59]
    v_rcp_f32 v31, v31
    v_mfma_f32_16x16x32_bf16 v[60:63], a[204:207], a[76:79], v[60:63]
    v_mul_f32 v26, v26, v30
    v_mul_f32 v27, v27, v31
    v_mfma_f32_16x16x32_bf16 v[44:47], a[200:203], a[76:79], v[44:47]
    s_waitcnt lgkmcnt(0)
    v_cvt_pk_bf16_f32 v177, v26, v27
    v_lshlrev_b32 v26, 16, v154
    v_mfma_f32_16x16x32_bf16 v[44:47], a[208:211], a[92:95], v[44:47]
    s_load_dword s67, s[86:87], s5 glc
    v_and_b32 v27, 0xffff0000, v154
    v_fma_f32 v26, v26, v25, v24
    v_mfma_f32_16x16x32_bf16 v[60:63], a[212:215], a[92:95], v[60:63]
    v_fma_f32 v27, v27, v25, v24
    v_mul_f32 v30, s92, v26
    v_mfma_f32_16x16x32_bf16 v[56:59], a[212:215], a[88:91], v[56:59]
    v_mul_f32 v31, s92, v27
    v_mfma_f32_16x16x32_bf16 v[40:43], a[208:211], a[88:91], v[40:43]
    v_exp_f32 v30, v30
    v_mfma_f32_16x16x32_bf16 v[36:39], a[208:211], a[84:87], v[36:39]
    v_exp_f32 v31, v31
    v_mfma_f32_16x16x32_bf16 v[52:55], a[212:215], a[84:87], v[52:55]
    v_add_f32 v30, 1.0, v30
    v_add_f32 v31, 1.0, v31
    v_mfma_f32_16x16x32_bf16 v[48:51], a[212:215], a[80:83], v[48:51]
    v_rcp_f32 v30, v30
    v_mfma_f32_16x16x32_bf16 v[32:35], a[208:211], a[80:83], v[32:35]
    v_rcp_f32 v31, v31
    s_nop 7
    v_cvt_pk_bf16_f32 v32, v32, v33
    v_cvt_pk_bf16_f32 v33, v34, v35
    v_cvt_pk_bf16_f32 v34, v48, v49
    v_cvt_pk_bf16_f32 v35, v50, v51
    buffer_store_dwordx4 v[32:35], v7, s[24:27], s55 offen sc1
    s_xor_b32 s55, s55, 1024
    v_cvt_pk_bf16_f32 v36, v36, v37
    v_cvt_pk_bf16_f32 v37, v38, v39
    v_cvt_pk_bf16_f32 v38, v52, v53
    v_cvt_pk_bf16_f32 v39, v54, v55
    buffer_store_dwordx4 v[36:39], v7, s[24:27], s55 offen sc1
    s_xor_b32 s55, s55, 3072
    v_cvt_pk_bf16_f32 v40, v40, v41
    v_cvt_pk_bf16_f32 v41, v42, v43
    v_cvt_pk_bf16_f32 v42, v56, v57
    v_cvt_pk_bf16_f32 v43, v58, v59
    buffer_store_dwordx4 v[40:43], v7, s[24:27], s55 offen sc1
    s_xor_b32 s55, s55, 1024
    v_cvt_pk_bf16_f32 v44, v44, v45
    v_cvt_pk_bf16_f32 v45, v46, v47
    v_cvt_pk_bf16_f32 v46, v60, v61
    v_cvt_pk_bf16_f32 v47, v62, v63
    buffer_store_dwordx4 v[44:47], v7, s[24:27], s55 offen sc1
    s_xor_b32 s55, s55, 3072
    s_add_u32 s55, s55, 16384
    v_mul_f32 v26, v26, v30
    v_mul_f32 v27, v27, v31
    v_cvt_pk_bf16_f32 v178, v26, v27
    v_lshlrev_b32 v26, 16, v155
    v_and_b32 v27, 0xffff0000, v155
    v_fma_f32 v26, v26, v25, v24
    v_fma_f32 v27, v27, v25, v24
    v_mul_f32 v30, s92, v26
    v_mul_f32 v31, s92, v27
    v_exp_f32 v30, v30
    v_exp_f32 v31, v31
    s_nop 0
    v_add_f32 v30, 1.0, v30
    v_add_f32 v31, 1.0, v31
    v_rcp_f32 v30, v30
    v_rcp_f32 v31, v31
    s_nop 0
    v_mul_f32 v26, v26, v30
    v_mul_f32 v27, v27, v31
    v_cvt_pk_bf16_f32 v179, v26, v27
    s_waitcnt vmcnt(37)
post_code:
    s_bitcmp0_b32 s53, 0
    s_cselect_b32 s60, 0, 0xff00
    s_mov_b32 s9, 1
    s_mov_b32 s55, s68
    s_waitcnt vmcnt(4)
    buffer_atomic_or v130, v3, s[24:27], 0 offen offset:0
    s_waitcnt lgkmcnt(0)
    s_andn2_b32 s69, s67, s68
    s_load_dword s67, s[86:87], s5 glc
    s_or_b32 s68, s68, s69
    s_and_b32 s8, s69, 0xff
    s_andn2_b32 s69, s69, s8
    s_cmp_lg_u32 s8, 0
    s_cbranch_scc0 e0_issued
e0_iss:
    s_ff1_i32_b32 s56, s8
    v_readlane_b32 s57, v23, s56
    s_lshl_b32 s39, s56, 10
    s_add_u32 m0, s37, s39
    s_bitset0_b32 s8, s56
    s_add_u32 s9, s9, 1
    s_cmp_lg_u32 s8, 0
    buffer_load_dwordx4 v28, s[24:27], s57 offen sc1 lds
    s_cbranch_scc1 e0_iss
e0_issued:
    v_lshlrev_b32 v26, 16, v160
    v_and_b32 v27, 0xffff0000, v160
    v_fma_f32 v26, v26, v25, v24
    v_fma_f32 v27, v27, v25, v24
    v_mul_f32 v30, s92, v26
    v_mul_f32 v31, s92, v27
    v_exp_f32 v30, v30
    v_exp_f32 v31, v31
    s_nop 0
    v_add_f32 v30, 1.0, v30
    v_add_f32 v31, 1.0, v31
    v_rcp_f32 v30, v30
    v_rcp_f32 v31, v31
    s_nop 0
    v_mul_f32 v26, v26, v30
    v_mul_f32 v27, v27, v31
    v_cvt_pk_bf16_f32 v184, v26, v27
    v_lshlrev_b32 v26, 16, v161
    v_and_b32 v27, 0xffff0000, v161
    v_fma_f32 v26, v26, v25, v24
    v_fma_f32 v27, v27, v25, v24
    v_mul_f32 v30, s92, v26
    v_mul_f32 v31, s92, v27
    v_exp_f32 v30, v30
    v_exp_f32 v31, v31
    s_nop 0
    v_add_f32 v30, 1.0, v30
    v_add_f32 v31, 1.0, v31
    v_rcp_f32 v30, v30
    v_rcp_f32 v31, v31
    s_nop 0
    v_mul_f32 v26, v26, v30
    v_mul_f32 v27, v27, v31
    v_cvt_pk_bf16_f32 v185, v26, v27
    v_lshlrev_b32 v26, 16, v162
    v_and_b32 v27, 0xffff0000, v162
    v_fma_f32 v26, v26, v25, v24
    v_fma_f32 v27, v27, v25, v24
    v_mul_f32 v30, s92, v26
    v_mul_f32 v31, s92, v27
    v_exp_f32 v30, v30
    v_exp_f32 v31, v31
    s_nop 0
    v_add_f32 v30, 1.0, v30
    v_add_f32 v31, 1.0, v31
    v_rcp_f32 v30, v30
    v_rcp_f32 v31, v31
    s_nop 0
    v_mul_f32 v26, v26, v30
    v_mul_f32 v27, v27, v31
    v_cvt_pk_bf16_f32 v186, v26, v27
    v_lshlrev_b32 v26, 16, v163
    v_and_b32 v27, 0xffff0000, v163
    v_fma_f32 v26, v26, v25, v24
    v_fma_f32 v27, v27, v25, v24
    v_mul_f32 v30, s92, v26
    v_mul_f32 v31, s92, v27
    v_exp_f32 v30, v30
    v_exp_f32 v31, v31
    s_nop 0
    v_add_f32 v30, 1.0, v30
    v_add_f32 v31, 1.0, v31
    v_rcp_f32 v30, v30
    v_rcp_f32 v31, v31
    s_nop 0
    v_mul_f32 v26, v26, v30
    v_mul_f32 v27, v27, v31
    v_cvt_pk_bf16_f32 v187, v26, v27
w4:
    s_getreg_b32 s56, hwreg(HW_REG_IB_STS)
    s_bfe_u32 s57, s56, 0x20016
    s_and_b32 s56, s56, 15
    s_lshl4_add_u32 s56, s57, s56
    s_cmp_gt_u32 s56, s9
    s_cbranch_scc1 w4
    buffer_atomic_or v130, v131, s[24:27], 0 offen offset:512
    s_mov_b32 s9, 1
    s_lshr_b32 s56, s53, 1
    s_cmp_eq_u32 s56, s3
    s_cbranch_scc0 own_share_ret
    s_lshl_b32 s56, s53, 10
    v_add_u32 v8, s56, v28
    v_add_u32 v11, 73728, v8
    v_add_u32 v10, 49152, v8
    v_add_u32 v9, 24576, v8
    v_add_u32 v8, 0, v8
    s_bitcmp1_b32 s53, 0
    s_cbranch_scc1 own_odd
    ds_write_b128 v8, v[196:199] offset:16384
    ds_write_b128 v9, v[204:207] offset:16384
    ds_write_b128 v10, v[212:215] offset:16384
    ds_write_b128 v11, v[220:223] offset:16384
    ds_write_b128 v8, v[132:135] offset:8192
    ds_write_b128 v9, v[140:143] offset:8192
    ds_write_b128 v10, v[148:151] offset:8192
    ds_write_b128 v11, v[156:159] offset:8192
    ds_write_b128 v8, v[68:71] offset:0
    ds_write_b128 v9, v[76:79] offset:0
    ds_write_b128 v10, v[84:87] offset:0
    ds_write_b128 v11, v[92:95] offset:0
    s_branch own_share_ret
own_odd:
    ds_write_b128 v8, v[32:35] offset:16384
    ds_write_b128 v9, v[36:39] offset:16384
    ds_write_b128 v10, v[40:43] offset:16384
    ds_write_b128 v11, v[44:47] offset:16384
    ds_write_b128 v8, v[64:67] offset:0
    ds_write_b128 v9, v[80:83] offset:0
    ds_write_b128 v10, v[96:99] offset:0
    ds_write_b128 v11, v[112:115] offset:0
own_share_ret:
    s_cmp_lg_u32 s69, 0
    s_cbranch_scc0 e1_issued
e1_iss:
    s_ff1_i32_b32 s56, s69
    v_readlane_b32 s57, v23, s56
    s_lshl_b32 s39, s56, 10
    s_add_u32 m0, s37, s39
    s_bitset0_b32 s69, s56
    s_mov_b32 s9, 0
    s_cmp_lg_u32 s69, 0
    buffer_load_dwordx4 v28, s[24:27], s57 offen sc1 lds
    s_cbranch_scc1 e1_iss
e1_issued:
    s_waitcnt lgkmcnt(0)
    s_barrier
    s_cmp_lg_u64 s[88:89], 0
    s_cbranch_scc1 routed
routed_ret:
ev_loop:
    s_waitcnt lgkmcnt(0)
    s_getreg_b32 s56, hwreg(HW_REG_IB_STS)
    s_bfe_u32 s57, s56, 0x20016
    s_and_b32 s56, s56, 15
    s_lshl4_add_u32 s56, s57, s56
    s_cmp_gt_u32 s56, s9
    s_cselect_b32 s55, s55, s68
    s_andn2_b32 s69, s67, s68
    s_or_b32 s68, s68, s69
    s_cmp_eq_u32 s68, 0xffffff
    s_cbranch_scc1 ev_nopoll
    s_load_dword s67, s[86:87], s5 glc
ev_nopoll:
    s_cmp_lg_u32 s69, 0
    s_cbranch_scc0 ev_issued
ev_iss:
    s_ff1_i32_b32 s56, s69
    v_readlane_b32 s57, v23, s56
    s_lshl_b32 s39, s56, 10
    s_add_u32 m0, s37, s39
    s_bitset0_b32 s69, s56
    s_mov_b32 s9, 0
    s_cmp_lg_u32 s69, 0
    buffer_load_dwordx4 v28, s[24:27], s57 offen sc1 lds
    s_cbranch_scc1 ev_iss
ev_issued:
ev_sel:
    s_andn2_b32 s8, s55, s60
    s_bfe_u32 s56, s8, 524288
    s_cmp_eq_u32 s56, 0xff
    s_cbranch_scc0 ev_r0
    s_or_b32 s60, s60, 255
    s_mov_b32 s38, s41
    ds_read_b128 v[132:135], v4 offset:0
    ds_read_b128 v[140:143], v4 offset:256
    ds_read_b128 v[148:151], v4 offset:2048
    ds_read_b128 v[156:159], v4 offset:2304
    ds_read_b128 v[164:167], v4 offset:4096
    ds_read_b128 v[172:175], v4 offset:4352
    ds_read_b128 v[180:183], v4 offset:6144
    ds_read_b128 v[188:191], v4 offset:6400
    v_lshlrev_b32 v84, 16, v168
    v_and_b32 v85, 0xffff0000, v168
    v_lshlrev_b32 v100, 16, v144
    v_and_b32 v101, 0xffff0000, v144
    v_lshlrev_b32 v86, 16, v169
    v_and_b32 v87, 0xffff0000, v169
    v_lshlrev_b32 v102, 16, v145
    v_and_b32 v103, 0xffff0000, v145
    v_lshlrev_b32 v92, 16, v170
    v_and_b32 v93, 0xffff0000, v170
    v_lshlrev_b32 v108, 16, v146
    v_and_b32 v109, 0xffff0000, v146
    v_lshlrev_b32 v94, 16, v171
    v_and_b32 v95, 0xffff0000, v171
    v_lshlrev_b32 v110, 16, v147
    v_and_b32 v111, 0xffff0000, v147
    s_branch ev_go
ev_r0:
    s_bfe_u32 s56, s8, 524296
    s_cmp_eq_u32 s56, 0xff
    s_cbranch_scc0 ev_r1
    s_or_b32 s60, s60, 65280
    s_mov_b32 s38, s42
    ds_read_b128 v[132:135], v4 offset:8192
    ds_read_b128 v[140:143], v4 offset:8448
    ds_read_b128 v[148:151], v4 offset:10240
    ds_read_b128 v[156:159], v4 offset:10496
    ds_read_b128 v[164:167], v4 offset:12288
    ds_read_b128 v[172:175], v4 offset:12544
    ds_read_b128 v[180:183], v4 offset:14336
    ds_read_b128 v[188:191], v4 offset:14592
    v_lshlrev_b32 v84, 16, v176
    v_and_b32 v85, 0xffff0000, v176
    v_lshlrev_b32 v100, 16, v152
    v_and_b32 v101, 0xffff0000, v152
    v_lshlrev_b32 v86, 16, v177
    v_and_b32 v87, 0xffff0000, v177
    v_lshlrev_b32 v102, 16, v153
    v_and_b32 v103, 0xffff0000, v153
    v_lshlrev_b32 v92, 16, v178
    v_and_b32 v93, 0xffff0000, v178
    v_lshlrev_b32 v108, 16, v154
    v_and_b32 v109, 0xffff0000, v154
    v_lshlrev_b32 v94, 16, v179
    v_and_b32 v95, 0xffff0000, v179
    v_lshlrev_b32 v110, 16, v155
    v_and_b32 v111, 0xffff0000, v155
    s_branch ev_go
ev_r1:
    s_bfe_u32 s56, s8, 524304
    s_cmp_eq_u32 s56, 0xff
    s_cbranch_scc0 ev_r2
    s_or_b32 s60, s60, 16711680
    s_mov_b32 s38, s43
    ds_read_b128 v[132:135], v4 offset:16384
    ds_read_b128 v[140:143], v4 offset:16640
    ds_read_b128 v[148:151], v4 offset:18432
    ds_read_b128 v[156:159], v4 offset:18688
    ds_read_b128 v[164:167], v4 offset:20480
    ds_read_b128 v[172:175], v4 offset:20736
    ds_read_b128 v[180:183], v4 offset:22528
    ds_read_b128 v[188:191], v4 offset:22784
    v_lshlrev_b32 v84, 16, v184
    v_and_b32 v85, 0xffff0000, v184
    v_lshlrev_b32 v100, 16, v160
    v_and_b32 v101, 0xffff0000, v160
    v_lshlrev_b32 v86, 16, v185
    v_and_b32 v87, 0xffff0000, v185
    v_lshlrev_b32 v102, 16, v161
    v_and_b32 v103, 0xffff0000, v161
    v_lshlrev_b32 v92, 16, v186
    v_and_b32 v93, 0xffff0000, v186
    v_lshlrev_b32 v108, 16, v162
    v_and_b32 v109, 0xffff0000, v162
    v_lshlrev_b32 v94, 16, v187
    v_and_b32 v95, 0xffff0000, v187
    v_lshlrev_b32 v110, 16, v163
    v_and_b32 v111, 0xffff0000, v163
    s_branch ev_go
ev_r2:
    s_cmp_eq_u32 s68, 0xffffff
    s_cbranch_scc0 ev_more
w5:
    s_getreg_b32 s56, hwreg(HW_REG_IB_STS)
    s_bfe_u32 s57, s56, 0x20016
    s_and_b32 s56, s56, 15
    s_lshl4_add_u32 s56, s57, s56
    s_cmp_gt_u32 s56, s9
    s_cbranch_scc1 w5
    s_mov_b32 s55, s68
    s_branch ev_sel
ev_more:
    s_add_u32 s101, s101, 1
    s_cmp_gt_u32 s101, 0x2000000
    s_cbranch_scc0 ev_loop
    s_branch ev_done
ev_go:
    s_waitcnt lgkmcnt(7)
    v_mfma_f32_16x16x32_bf16 v[68:71], v[208:211], v[132:135], 0
    s_waitcnt lgkmcnt(6)
    v_mfma_f32_16x16x32_bf16 v[76:79], v[208:211], v[140:143], 0
    s_waitcnt lgkmcnt(5)
    v_mfma_f32_16x16x32_bf16 v[68:71], v[208:211], v[148:151], v[68:71]
    s_waitcnt lgkmcnt(4)
    v_mfma_f32_16x16x32_bf16 v[76:79], v[208:211], v[156:159], v[76:79]
    s_waitcnt lgkmcnt(3)
    v_mfma_f32_16x16x32_bf16 v[68:71], v[208:211], v[164:167], v[68:71]
    s_waitcnt lgkmcnt(2)
    v_mfma_f32_16x16x32_bf16 v[76:79], v[208:211], v[172:175], v[76:79]
    s_waitcnt lgkmcnt(1)
    v_mfma_f32_16x16x32_bf16 v[68:71], v[208:211], v[180:183], v[68:71]
    s_waitcnt lgkmcnt(0)
    v_mfma_f32_16x16x32_bf16 v[76:79], v[208:211], v[188:191], v[76:79]
    s_nop 6
    v_pk_fma_f32 v[68:69], v[68:69], v[84:85], v[100:101]
    v_pk_fma_f32 v[70:71], v[70:71], v[86:87], v[102:103]
    v_pk_fma_f32 v[76:77], v[76:77], v[92:93], v[108:109]
    v_pk_fma_f32 v[78:79], v[78:79], v[94:95], v[110:111]
    v_cvt_pk_bf16_f32 v124, v68, v69
    v_cvt_pk_bf16_f32 v125, v70, v71
    v_cvt_pk_bf16_f32 v126, v76, v77
    v_cvt_pk_bf16_f32 v127, v78, v79
    buffer_store_dwordx4 v[124:127], v22, s[32:35], s38 offen sc1
    s_add_u32 s9, s9, 1
    s_cmp_lg_u32 s60, 0xffffff
    s_cbranch_scc1 ev_sel
ev_done:
    s_or_b32 s56, s2, s3
    s_cbranch_scc1 main_fin
    v_mov_b32 v8, s7
    v_mov_b32 v9, 3203072
    s_mov_b64 exec, 1
    buffer_store_dword v8, v9, s[24:27], 0 offen
main_fin:
main_end:
    s_endpgm
spin_o0:
    s_load_dword s72, s[86:87], s5 offset:4 glc
    s_add_u32 s101, s101, 1
    s_cmp_gt_u32 s101, 0x2000000
    s_waitcnt lgkmcnt(0)
    s_cbranch_scc1 spin_o0_ret
    s_bfe_u32 s88, s72, 262144
    s_cmp_lg_u32 s88, 15
    s_cbranch_scc1 spin_o0
    s_branch spin_o0_ret
spin_o1:
    s_load_dword s72, s[86:87], s5 offset:4 glc
    s_add_u32 s101, s101, 1
    s_cmp_gt_u32 s101, 0x2000000
    s_waitcnt lgkmcnt(0)
    s_cbranch_scc1 spin_o1_ret
    s_bfe_u32 s88, s72, 262148
    s_cmp_lg_u32 s88, 15
    s_cbranch_scc1 spin_o1
    s_branch spin_o1_ret
spin_o2:
    s_load_dword s72, s[86:87], s5 offset:4 glc
    s_add_u32 s101, s101, 1
    s_cmp_gt_u32 s101, 0x2000000
    s_waitcnt lgkmcnt(0)
    s_cbranch_scc1 spin_o2_ret
    s_bfe_u32 s88, s72, 262152
    s_cmp_lg_u32 s88, 15
    s_cbranch_scc1 spin_o2
    s_branch spin_o2_ret
spin_o3:
    s_load_dword s72, s[86:87], s5 offset:4 glc
    s_add_u32 s101, s101, 1
    s_cmp_gt_u32 s101, 0x2000000
    s_waitcnt lgkmcnt(0)
    s_cbranch_scc1 spin_o3_ret
    s_bfe_u32 s88, s72, 262156
    s_cmp_lg_u32 s88, 15
    s_cbranch_scc1 spin_o3
    s_branch spin_o3_ret
spin_o4:
    s_load_dword s72, s[86:87], s5 offset:4 glc
    s_add_u32 s101, s101, 1
    s_cmp_gt_u32 s101, 0x2000000
    s_waitcnt lgkmcnt(0)
    s_cbranch_scc1 spin_o4_ret
    s_bfe_u32 s88, s72, 262160
    s_cmp_lg_u32 s88, 15
    s_cbranch_scc1 spin_o4
    s_branch spin_o4_ret
spin_o5:
    s_load_dword s72, s[86:87], s5 offset:4 glc
    s_add_u32 s101, s101, 1
    s_cmp_gt_u32 s101, 0x2000000
    s_waitcnt lgkmcnt(0)
    s_cbranch_scc1 spin_o5_ret
    s_bfe_u32 s88, s72, 262164
    s_cmp_lg_u32 s88, 15
    s_cbranch_scc1 spin_o5
    s_branch spin_o5_ret
routed:
    s_cmp_eq_u32 s44, s59
    s_cbranch_scc0 spin_y
spin_y_ret:
    v_cvt_pk_bf16_f32 v200, v240, v241
    v_cvt_pk_bf16_f32 v201, v242, v243
    v_lshlrev_b32 v240, 16, v200
    v_and_b32 v241, 0xffff0000, v200
    v_lshlrev_b32 v242, 16, v201
    v_and_b32 v243, 0xffff0000, v201
    v_mul_f32 v240, v240, v195
    v_mul_f32 v241, v241, v195
    v_mul_f32 v242, v242, v195
    v_mul_f32 v243, v243, v195
    v_cvt_pk_bf16_f32 v200, v240, v241
    v_cvt_pk_bf16_f32 v201, v242, v243
    v_lshlrev_b32 v240, 16, v200
    v_and_b32 v241, 0xffff0000, v200
    v_lshlrev_b32 v242, 16, v201
    v_and_b32 v243, 0xffff0000, v201
    v_add_f32 v240, v240, v248
    v_add_f32 v241, v241, v249
    v_add_f32 v242, v242, v250
    v_add_f32 v243, v243, v251
    v_cvt_pk_bf16_f32 v200, v240, v241
    v_cvt_pk_bf16_f32 v201, v242, v243
    v_lshlrev_b32 v240, 16, v200
    v_and_b32 v241, 0xffff0000, v200
    v_lshlrev_b32 v242, 16, v201
    v_and_b32 v243, 0xffff0000, v201
    v_mul_f32 v200, s92, v240
    v_mul_f32 v201, s92, v241
    v_mul_f32 v202, s92, v242
    v_mul_f32 v203, s92, v243
    v_exp_f32 v200, v200
    v_exp_f32 v201, v201
    v_exp_f32 v202, v202
    v_exp_f32 v203, v203
    v_add_f32 v200, 1.0, v200
    v_add_f32 v201, 1.0, v201
    v_add_f32 v202, 1.0, v202
    v_add_f32 v203, 1.0, v203
    v_rcp_f32 v200, v200
    v_rcp_f32 v201, v201
    v_rcp_f32 v202, v202
    v_rcp_f32 v203, v203
    v_mul_f32 v240, v240, v200
    v_mul_f32 v241, v241, v201
    v_mul_f32 v242, v242, v202
    v_mul_f32 v243, v243, v203
    v_cvt_pk_bf16_f32 v240, v240, v241
    v_cvt_pk_bf16_f32 v241, v242, v243
    ds_write_b64 v138, v[240:241]
    s_mov_b64 exec, s[88:89]
    ds_read_b128 v[168:171], v139 offset:0
    ds_read_b128 v[176:179], v139 offset:64
    ds_read_b128 v[184:187], v139 offset:128
    s_waitcnt lgkmcnt(0)
    s_mov_b64 exec, -1
    s_branch routed_ret
spin_y:
    s_add_u32 s101, s101, 1
    s_cmp_gt_u32 s101, 0x2000000
    s_cbranch_scc1 spin_y_x
    buffer_load_dword v137, v136, s[24:27], s59 offen offset:128 sc1
    s_waitcnt vmcnt(0)
    v_cmp_ne_u32 vcc, 24, v137
    s_cbranch_vccnz spin_y
spin_y_x:
    buffer_load_dwordx4 v[240:243], v192, s[24:27], s59 offen sc1
    s_waitcnt vmcnt(0)
    s_branch spin_y_ret
spin_rec:
    s_add_u32 s101, s101, 1
    s_cmp_gt_u32 s101, 0x2000000
    s_cbranch_scc1 spin_rec_x
    buffer_load_dwordx4 v[32:35], v17, s[24:27], s47 offen offset:0 sc1
    buffer_load_dwordx4 v[36:39], v17, s[24:27], s47 offen offset:1024 sc1
    buffer_load_dwordx4 v[40:43], v17, s[24:27], s47 offen offset:2048 sc1
    buffer_load_dwordx4 v[44:47], v17, s[24:27], s47 offen offset:3072 sc1
    s_waitcnt vmcnt(0)
    v_xor_b32 v34, s7, v34
    v_xor_b32 v38, s7, v38
    v_xor_b32 v42, s7, v42
    v_xor_b32 v46, s7, v46
    v_or3_b32 v34, v34, v38, v42
    v_or_b32 v34, v34, v46
    v_cmp_ne_u32 vcc, 0, v34
    s_cbranch_vccnz spin_rec
spin_rec_x:
    s_branch spin_rec_ret
spin_gu:
    s_add_u32 s101, s101, 1
    s_cmp_gt_u32 s101, 0x2000000
    s_cbranch_scc1 spin_gu_x
    buffer_load_dword v61, v60, s[24:27], s37 offen sc1
    s_waitcnt vmcnt(0)
    v_cmp_ne_u32 vcc, s7, v61
    s_cbranch_vccnz spin_gu
spin_gu_x:
    s_branch spin_gu_ret
rare_p:
    s_nop 7
    s_nop 7
    v_max3_f32 v56, v68, v69, v70
    v_max3_f32 v56, v56, v71, v100
    v_max3_f32 v56, v56, v101, v102
    v_max3_f32 v56, v56, v103, v56
    v_mov_b32 v58, v56
    s_nop 1
    v_permlane16_swap_b32 v56, v58
    s_nop 1
    v_max_f32 v56, v56, v58
    v_mov_b32 v58, v56
    s_nop 1
    v_permlane32_swap_b32 v56, v58
    s_nop 1
    v_max_f32 v56, v56, v58
    v_add_f32 v56, 2.0, v56
    v_sub_f32 v32, v32, v56
    v_sub_f32 v33, v33, v56
    v_sub_f32 v34, v34, v56
    v_sub_f32 v35, v35, v56
    v_sub_f32 v68, v68, v56
    v_sub_f32 v69, v69, v56
    v_sub_f32 v70, v70, v56
    v_sub_f32 v71, v71, v56
    v_sub_f32 v100, v100, v56
    v_sub_f32 v101, v101, v56
    v_sub_f32 v102, v102, v56
    v_sub_f32 v103, v103, v56
    v_sub_f32 v132, v132, v56
    v_sub_f32 v133, v133, v56
    v_sub_f32 v134, v134, v56
    v_sub_f32 v135, v135, v56
    v_sub_f32 v164, v164, v56
    v_sub_f32 v165, v165, v56
    v_sub_f32 v166, v166, v56
    v_sub_f32 v167, v167, v56
    v_exp_f32 v48, v68
    v_exp_f32 v49, v69
    v_exp_f32 v50, v70
    v_exp_f32 v51, v71
    v_exp_f32 v52, v100
    v_exp_f32 v53, v101
    v_exp_f32 v54, v102
    v_exp_f32 v55, v103
    s_nop 0
    v_cvt_pk_bf16_f32 v196, v48, v49
    v_cvt_pk_bf16_f32 v197, v50, v51
    v_cvt_pk_bf16_f32 v198, v52, v53
    v_cvt_pk_bf16_f32 v199, v54, v55
    v_add_f32 v24, v48, v49
    v_add_f32 v24, v24, v50
    v_add_f32 v24, v24, v51
    v_add_f32 v24, v24, v52
    v_add_f32 v24, v24, v53
    v_add_f32 v24, v24, v54
    v_add_f32 v24, v24, v55
    v_max3_f32 v56, v76, v77, v78
    v_max3_f32 v56, v56, v79, v108
    v_max3_f32 v56, v56, v109, v110
    v_max3_f32 v56, v56, v111, v56
    v_mov_b32 v58, v56
    s_nop 1
    v_permlane16_swap_b32 v56, v58
    s_nop 1
    v_max_f32 v56, v56, v58
    v_mov_b32 v58, v56
    s_nop 1
    v_permlane32_swap_b32 v56, v58
    s_nop 1
    v_max_f32 v56, v56, v58
    v_add_f32 v56, 2.0, v56
    v_sub_f32 v36, v36, v56
    v_sub_f32 v37, v37, v56
    v_sub_f32 v38, v38, v56
    v_sub_f32 v39, v39, v56
    v_sub_f32 v76, v76, v56
    v_sub_f32 v77, v77, v56
    v_sub_f32 v78, v78, v56
    v_sub_f32 v79, v79, v56
    v_sub_f32 v108, v108, v56
    v_sub_f32 v109, v109, v56
    v_sub_f32 v110, v110, v56
    v_sub_f32 v111, v111, v56
    v_sub_f32 v140, v140, v56
    v_sub_f32 v141, v141, v56
    v_sub_f32 v142, v142, v56
    v_sub_f32 v143, v143, v56
    v_sub_f32 v172, v172, v56
    v_sub_f32 v173, v173, v56
    v_sub_f32 v174, v174, v56
    v_sub_f32 v175, v175, v56
    v_exp_f32 v48, v76
    v_exp_f32 v49, v77
    v_exp_f32 v50, v78
    v_exp_f32 v51, v79
    v_exp_f32 v52, v108
    v_exp_f32 v53, v109
    v_exp_f32 v54, v110
    v_exp_f32 v55, v111
    s_nop 0
    v_cvt_pk_bf16_f32 v204, v48, v49
    v_cvt_pk_bf16_f32 v205, v50, v51
    v_cvt_pk_bf16_f32 v206, v52, v53
    v_cvt_pk_bf16_f32 v207, v54, v55
    v_add_f32 v25, v48, v49
    v_add_f32 v25, v25, v50
    v_add_f32 v25, v25, v51
    v_add_f32 v25, v25, v52
    v_add_f32 v25, v25, v53
    v_add_f32 v25, v25, v54
    v_add_f32 v25, v25, v55
    v_max3_f32 v56, v84, v85, v86
    v_max3_f32 v56, v56, v87, v116
    v_max3_f32 v56, v56, v117, v118
    v_max3_f32 v56, v56, v119, v56
    v_mov_b32 v58, v56
    s_nop 1
    v_permlane16_swap_b32 v56, v58
    s_nop 1
    v_max_f32 v56, v56, v58
    v_mov_b32 v58, v56
    s_nop 1
    v_permlane32_swap_b32 v56, v58
    s_nop 1
    v_max_f32 v56, v56, v58
    v_add_f32 v56, 2.0, v56
    v_sub_f32 v40, v40, v56
    v_sub_f32 v41, v41, v56
    v_sub_f32 v42, v42, v56
    v_sub_f32 v43, v43, v56
    v_sub_f32 v84, v84, v56
    v_sub_f32 v85, v85, v56
    v_sub_f32 v86, v86, v56
    v_sub_f32 v87, v87, v56
    v_sub_f32 v116, v116, v56
    v_sub_f32 v117, v117, v56
    v_sub_f32 v118, v118, v56
    v_sub_f32 v119, v119, v56
    v_sub_f32 v148, v148, v56
    v_sub_f32 v149, v149, v56
    v_sub_f32 v150, v150, v56
    v_sub_f32 v151, v151, v56
    v_sub_f32 v180, v180, v56
    v_sub_f32 v181, v181, v56
    v_sub_f32 v182, v182, v56
    v_sub_f32 v183, v183, v56
    v_exp_f32 v48, v84
    v_exp_f32 v49, v85
    v_exp_f32 v50, v86
    v_exp_f32 v51, v87
    v_exp_f32 v52, v116
    v_exp_f32 v53, v117
    v_exp_f32 v54, v118
    v_exp_f32 v55, v119
    s_nop 0
    v_cvt_pk_bf16_f32 v212, v48, v49
    v_cvt_pk_bf16_f32 v213, v50, v51
    v_cvt_pk_bf16_f32 v214, v52, v53
    v_cvt_pk_bf16_f32 v215, v54, v55
    v_add_f32 v26, v48, v49
    v_add_f32 v26, v26, v50
    v_add_f32 v26, v26, v51
    v_add_f32 v26, v26, v52
    v_add_f32 v26, v26, v53
    v_add_f32 v26, v26, v54
    v_add_f32 v26, v26, v55
    v_max3_f32 v56, v92, v93, v94
    v_max3_f32 v56, v56, v95, v124
    v_max3_f32 v56, v56, v125, v126
    v_max3_f32 v56, v56, v127, v56
    v_mov_b32 v58, v56
    s_nop 1
    v_permlane16_swap_b32 v56, v58
    s_nop 1
    v_max_f32 v56, v56, v58
    v_mov_b32 v58, v56
    s_nop 1
    v_permlane32_swap_b32 v56, v58
    s_nop 1
    v_max_f32 v56, v56, v58
    v_add_f32 v56, 2.0, v56
    v_sub_f32 v44, v44, v56
    v_sub_f32 v45, v45, v56
    v_sub_f32 v46, v46, v56
    v_sub_f32 v47, v47, v56
    v_sub_f32 v92, v92, v56
    v_sub_f32 v93, v93, v56
    v_sub_f32 v94, v94, v56
    v_sub_f32 v95, v95, v56
    v_sub_f32 v124, v124, v56
    v_sub_f32 v125, v125, v56
    v_sub_f32 v126, v126, v56
    v_sub_f32 v127, v127, v56
    v_sub_f32 v156, v156, v56
    v_sub_f32 v157, v157, v56
    v_sub_f32 v158, v158, v56
    v_sub_f32 v159, v159, v56
    v_sub_f32 v188, v188, v56
    v_sub_f32 v189, v189, v56
    v_sub_f32 v190, v190, v56
    v_sub_f32 v191, v191, v56
    v_exp_f32 v48, v92
    v_exp_f32 v49, v93
    v_exp_f32 v50, v94
    v_exp_f32 v51, v95
    v_exp_f32 v52, v124
    v_exp_f32 v53, v125
    v_exp_f32 v54, v126
    v_exp_f32 v55, v127
    s_nop 0
    v_cvt_pk_bf16_f32 v220, v48, v49
    v_cvt_pk_bf16_f32 v221, v50, v51
    v_cvt_pk_bf16_f32 v222, v52, v53
    v_cvt_pk_bf16_f32 v223, v54, v55
    v_add_f32 v27, v48, v49
    v_add_f32 v27, v27, v50
    v_add_f32 v27, v27, v51
    v_add_f32 v27, v27, v52
    v_add_f32 v27, v27, v53
    v_add_f32 v27, v27, v54
    v_add_f32 v27, v27, v55
    s_nop 1
    s_branch rare_p_ret
rare_a:
    s_nop 7
    s_nop 7
    v_max3_f32 v56, v132, v133, v134
    v_max3_f32 v56, v56, v135, v164
    v_max3_f32 v56, v56, v165, v166
    v_max3_f32 v56, v56, v167, 0
    v_mov_b32 v58, v56
    s_nop 1
    v_permlane16_swap_b32 v56, v58
    s_nop 1
    v_max_f32 v56, v56, v58
    v_mov_b32 v58, v56
    s_nop 1
    v_permlane32_swap_b32 v56, v58
    s_nop 1
    v_max_f32 v56, v56, v58
    v_exp_f32 v57, -v56
    v_sub_f32 v32, v32, v56
    v_sub_f32 v33, v33, v56
    v_sub_f32 v34, v34, v56
    v_sub_f32 v35, v35, v56
    v_mul_f32 v20, v20, v57
    v_sub_f32 v58, 1.0, v57
    v_sub_f32 v132, v132, v56
    v_sub_f32 v133, v133, v56
    v_sub_f32 v134, v134, v56
    v_sub_f32 v135, v135, v56
    v_sub_f32 v164, v164, v56
    v_sub_f32 v165, v165, v56
    v_sub_f32 v166, v166, v56
    v_sub_f32 v167, v167, v56
    v_sub_f32 v68, v68, v56
    v_sub_f32 v69, v69, v56
    v_sub_f32 v70, v70, v56
    v_sub_f32 v71, v71, v56
    v_sub_f32 v100, v100, v56
    v_sub_f32 v101, v101, v56
    v_sub_f32 v102, v102, v56
    v_sub_f32 v103, v103, v56
    v_accvgpr_read_b32 v48, a0
    v_accvgpr_read_b32 v49, a1
    v_accvgpr_read_b32 v50, a2
    v_accvgpr_read_b32 v51, a3
    v_fma_f32 v48, v48, v57, v58
    v_fma_f32 v49, v49, v57, v58
    v_fma_f32 v50, v50, v57, v58
    v_fma_f32 v51, v51, v57, v58
    v_accvgpr_write_b32 a0, v48
    v_accvgpr_write_b32 a1, v49
    v_accvgpr_write_b32 a2, v50
    v_accvgpr_write_b32 a3, v51
    v_accvgpr_read_b32 v48, a16
    v_accvgpr_read_b32 v49, a17
    v_accvgpr_read_b32 v50, a18
    v_accvgpr_read_b32 v51, a19
    v_fma_f32 v48, v48, v57, v58
    v_fma_f32 v49, v49, v57, v58
    v_fma_f32 v50, v50, v57, v58
    v_fma_f32 v51, v51, v57, v58
    v_accvgpr_write_b32 a16, v48
    v_accvgpr_write_b32 a17, v49
    v_accvgpr_write_b32 a18, v50
    v_accvgpr_write_b32 a19, v51
    v_accvgpr_read_b32 v48, a32
    v_accvgpr_read_b32 v49, a33
    v_accvgpr_read_b32 v50, a34
    v_accvgpr_read_b32 v51, a35
    v_fma_f32 v48, v48, v57, v58
    v_fma_f32 v49, v49, v57, v58
    v_fma_f32 v50, v50, v57, v58
    v_fma_f32 v51, v51, v57, v58
    v_accvgpr_write_b32 a32, v48
    v_accvgpr_write_b32 a33, v49
    v_accvgpr_write_b32 a34, v50
    v_accvgpr_write_b32 a35, v51
    v_accvgpr_read_b32 v48, a48
    v_accvgpr_read_b32 v49, a49
    v_accvgpr_read_b32 v50, a50
    v_accvgpr_read_b32 v51, a51
    v_fma_f32 v48, v48, v57, v58
    v_fma_f32 v49, v49, v57, v58
    v_fma_f32 v50, v50, v57, v58
    v_fma_f32 v51, v51, v57, v58
    v_accvgpr_write_b32 a48, v48
    v_accvgpr_write_b32 a49, v49
    v_accvgpr_write_b32 a50, v50
    v_accvgpr_write_b32 a51, v51
    v_accvgpr_read_b32 v48, a64
    v_accvgpr_read_b32 v49, a65
    v_accvgpr_read_b32 v50, a66
    v_accvgpr_read_b32 v51, a67
    v_fma_f32 v48, v48, v57, v58
    v_fma_f32 v49, v49, v57, v58
    v_fma_f32 v50, v50, v57, v58
    v_fma_f32 v51, v51, v57, v58
    v_accvgpr_write_b32 a64, v48
    v_accvgpr_write_b32 a65, v49
    v_accvgpr_write_b32 a66, v50
    v_accvgpr_write_b32 a67, v51
    v_accvgpr_read_b32 v48, a80
    v_accvgpr_read_b32 v49, a81
    v_accvgpr_read_b32 v50, a82
    v_accvgpr_read_b32 v51, a83
    v_fma_f32 v48, v48, v57, v58
    v_fma_f32 v49, v49, v57, v58
    v_fma_f32 v50, v50, v57, v58
    v_fma_f32 v51, v51, v57, v58
    v_accvgpr_write_b32 a80, v48
    v_accvgpr_write_b32 a81, v49
    v_accvgpr_write_b32 a82, v50
    v_accvgpr_write_b32 a83, v51
    v_accvgpr_read_b32 v48, a96
    v_accvgpr_read_b32 v49, a97
    v_accvgpr_read_b32 v50, a98
    v_accvgpr_read_b32 v51, a99
    v_fma_f32 v48, v48, v57, v58
    v_fma_f32 v49, v49, v57, v58
    v_fma_f32 v50, v50, v57, v58
    v_fma_f32 v51, v51, v57, v58
    v_accvgpr_write_b32 a96, v48
    v_accvgpr_write_b32 a97, v49
    v_accvgpr_write_b32 a98, v50
    v_accvgpr_write_b32 a99, v51
    v_accvgpr_read_b32 v48, a112
    v_accvgpr_read_b32 v49, a113
    v_accvgpr_read_b32 v50, a114
    v_accvgpr_read_b32 v51, a115
    v_fma_f32 v48, v48, v57, v58
    v_fma_f32 v49, v49, v57, v58
    v_fma_f32 v50, v50, v57, v58
    v_fma_f32 v51, v51, v57, v58
    v_accvgpr_write_b32 a112, v48
    v_accvgpr_write_b32 a113, v49
    v_accvgpr_write_b32 a114, v50
    v_accvgpr_write_b32 a115, v51
    v_accvgpr_read_b32 v48, a128
    v_accvgpr_read_b32 v49, a129
    v_accvgpr_read_b32 v50, a130
    v_accvgpr_read_b32 v51, a131
    v_fma_f32 v48, v48, v57, v58
    v_fma_f32 v49, v49, v57, v58
    v_fma_f32 v50, v50, v57, v58
    v_fma_f32 v51, v51, v57, v58
    v_accvgpr_write_b32 a128, v48
    v_accvgpr_write_b32 a129, v49
    v_accvgpr_write_b32 a130, v50
    v_accvgpr_write_b32 a131, v51
    v_accvgpr_read_b32 v48, a144
    v_accvgpr_read_b32 v49, a145
    v_accvgpr_read_b32 v50, a146
    v_accvgpr_read_b32 v51, a147
    v_fma_f32 v48, v48, v57, v58
    v_fma_f32 v49, v49, v57, v58
    v_fma_f32 v50, v50, v57, v58
    v_fma_f32 v51, v51, v57, v58
    v_accvgpr_write_b32 a144, v48
    v_accvgpr_write_b32 a145, v49
    v_accvgpr_write_b32 a146, v50
    v_accvgpr_write_b32 a147, v51
    v_accvgpr_read_b32 v48, a160
    v_accvgpr_read_b32 v49, a161
    v_accvgpr_read_b32 v50, a162
    v_accvgpr_read_b32 v51, a163
    v_fma_f32 v48, v48, v57, v58
    v_fma_f32 v49, v49, v57, v58
    v_fma_f32 v50, v50, v57, v58
    v_fma_f32 v51, v51, v57, v58
    v_accvgpr_write_b32 a160, v48
    v_accvgpr_write_b32 a161, v49
    v_accvgpr_write_b32 a162, v50
    v_accvgpr_write_b32 a163, v51
    v_accvgpr_read_b32 v48, a176
    v_accvgpr_read_b32 v49, a177
    v_accvgpr_read_b32 v50, a178
    v_accvgpr_read_b32 v51, a179
    v_fma_f32 v48, v48, v57, v58
    v_fma_f32 v49, v49, v57, v58
    v_fma_f32 v50, v50, v57, v58
    v_fma_f32 v51, v51, v57, v58
    v_accvgpr_write_b32 a176, v48
    v_accvgpr_write_b32 a177, v49
    v_accvgpr_write_b32 a178, v50
    v_accvgpr_write_b32 a179, v51
    v_exp_f32 v48, v132
    v_exp_f32 v49, v133
    v_exp_f32 v50, v134
    v_exp_f32 v51, v135
    v_exp_f32 v52, v164
    v_exp_f32 v53, v165
    v_exp_f32 v54, v166
    v_exp_f32 v55, v167
    s_nop 0
    v_cvt_pk_bf16_f32 v228, v48, v49
    v_cvt_pk_bf16_f32 v229, v50, v51
    v_cvt_pk_bf16_f32 v230, v52, v53
    v_cvt_pk_bf16_f32 v231, v54, v55
    v_add_f32 v24, v48, v49
    v_add_f32 v24, v24, v50
    v_add_f32 v24, v24, v51
    v_add_f32 v24, v24, v52
    v_add_f32 v24, v24, v53
    v_add_f32 v24, v24, v54
    v_add_f32 v24, v24, v55
    v_max3_f32 v56, v140, v141, v142
    v_max3_f32 v56, v56, v143, v172
    v_max3_f32 v56, v56, v173, v174
    v_max3_f32 v56, v56, v175, 0
    v_mov_b32 v58, v56
    s_nop 1
    v_permlane16_swap_b32 v56, v58
    s_nop 1
    v_max_f32 v56, v56, v58
    v_mov_b32 v58, v56
    s_nop 1
    v_permlane32_swap_b32 v56, v58
    s_nop 1
    v_max_f32 v56, v56, v58
    v_exp_f32 v57, -v56
    v_sub_f32 v36, v36, v56
    v_sub_f32 v37, v37, v56
    v_sub_f32 v38, v38, v56
    v_sub_f32 v39, v39, v56
    v_mul_f32 v21, v21, v57
    v_sub_f32 v58, 1.0, v57
    v_sub_f32 v140, v140, v56
    v_sub_f32 v141, v141, v56
    v_sub_f32 v142, v142, v56
    v_sub_f32 v143, v143, v56
    v_sub_f32 v172, v172, v56
    v_sub_f32 v173, v173, v56
    v_sub_f32 v174, v174, v56
    v_sub_f32 v175, v175, v56
    v_sub_f32 v76, v76, v56
    v_sub_f32 v77, v77, v56
    v_sub_f32 v78, v78, v56
    v_sub_f32 v79, v79, v56
    v_sub_f32 v108, v108, v56
    v_sub_f32 v109, v109, v56
    v_sub_f32 v110, v110, v56
    v_sub_f32 v111, v111, v56
    v_accvgpr_read_b32 v48, a4
    v_accvgpr_read_b32 v49, a5
    v_accvgpr_read_b32 v50, a6
    v_accvgpr_read_b32 v51, a7
    v_fma_f32 v48, v48, v57, v58
    v_fma_f32 v49, v49, v57, v58
    v_fma_f32 v50, v50, v57, v58
    v_fma_f32 v51, v51, v57, v58
    v_accvgpr_write_b32 a4, v48
    v_accvgpr_write_b32 a5, v49
    v_accvgpr_write_b32 a6, v50
    v_accvgpr_write_b32 a7, v51
    v_accvgpr_read_b32 v48, a20
    v_accvgpr_read_b32 v49, a21
    v_accvgpr_read_b32 v50, a22
    v_accvgpr_read_b32 v51, a23
    v_fma_f32 v48, v48, v57, v58
    v_fma_f32 v49, v49, v57, v58
    v_fma_f32 v50, v50, v57, v58
    v_fma_f32 v51, v51, v57, v58
    v_accvgpr_write_b32 a20, v48
    v_accvgpr_write_b32 a21, v49
    v_accvgpr_write_b32 a22, v50
    v_accvgpr_write_b32 a23, v51
    v_accvgpr_read_b32 v48, a36
    v_accvgpr_read_b32 v49, a37
    v_accvgpr_read_b32 v50, a38
    v_accvgpr_read_b32 v51, a39
    v_fma_f32 v48, v48, v57, v58
    v_fma_f32 v49, v49, v57, v58
    v_fma_f32 v50, v50, v57, v58
    v_fma_f32 v51, v51, v57, v58
    v_accvgpr_write_b32 a36, v48
    v_accvgpr_write_b32 a37, v49
    v_accvgpr_write_b32 a38, v50
    v_accvgpr_write_b32 a39, v51
    v_accvgpr_read_b32 v48, a52
    v_accvgpr_read_b32 v49, a53
    v_accvgpr_read_b32 v50, a54
    v_accvgpr_read_b32 v51, a55
    v_fma_f32 v48, v48, v57, v58
    v_fma_f32 v49, v49, v57, v58
    v_fma_f32 v50, v50, v57, v58
    v_fma_f32 v51, v51, v57, v58
    v_accvgpr_write_b32 a52, v48
    v_accvgpr_write_b32 a53, v49
    v_accvgpr_write_b32 a54, v50
    v_accvgpr_write_b32 a55, v51
    v_accvgpr_read_b32 v48, a68
    v_accvgpr_read_b32 v49, a69
    v_accvgpr_read_b32 v50, a70
    v_accvgpr_read_b32 v51, a71
    v_fma_f32 v48, v48, v57, v58
    v_fma_f32 v49, v49, v57, v58
    v_fma_f32 v50, v50, v57, v58
    v_fma_f32 v51, v51, v57, v58
    v_accvgpr_write_b32 a68, v48
    v_accvgpr_write_b32 a69, v49
    v_accvgpr_write_b32 a70, v50
    v_accvgpr_write_b32 a71, v51
    v_accvgpr_read_b32 v48, a84
    v_accvgpr_read_b32 v49, a85
    v_accvgpr_read_b32 v50, a86
    v_accvgpr_read_b32 v51, a87
    v_fma_f32 v48, v48, v57, v58
    v_fma_f32 v49, v49, v57, v58
    v_fma_f32 v50, v50, v57, v58
    v_fma_f32 v51, v51, v57, v58
    v_accvgpr_write_b32 a84, v48
    v_accvgpr_write_b32 a85, v49
    v_accvgpr_write_b32 a86, v50
    v_accvgpr_write_b32 a87, v51
    v_accvgpr_read_b32 v48, a100
    v_accvgpr_read_b32 v49, a101
    v_accvgpr_read_b32 v50, a102
    v_accvgpr_read_b32 v51, a103
    v_fma_f32 v48, v48, v57, v58
    v_fma_f32 v49, v49, v57, v58
    v_fma_f32 v50, v50, v57, v58
    v_fma_f32 v51, v51, v57, v58
    v_accvgpr_write_b32 a100, v48
    v_accvgpr_write_b32 a101, v49
    v_accvgpr_write_b32 a102, v50
    v_accvgpr_write_b32 a103, v51
    v_accvgpr_read_b32 v48, a116
    v_accvgpr_read_b32 v49, a117
    v_accvgpr_read_b32 v50, a118
    v_accvgpr_read_b32 v51, a119
    v_fma_f32 v48, v48, v57, v58
    v_fma_f32 v49, v49, v57, v58
    v_fma_f32 v50, v50, v57, v58
    v_fma_f32 v51, v51, v57, v58
    v_accvgpr_write_b32 a116, v48
    v_accvgpr_write_b32 a117, v49
    v_accvgpr_write_b32 a118, v50
    v_accvgpr_write_b32 a119, v51
    v_accvgpr_read_b32 v48, a132
    v_accvgpr_read_b32 v49, a133
    v_accvgpr_read_b32 v50, a134
    v_accvgpr_read_b32 v51, a135
    v_fma_f32 v48, v48, v57, v58
    v_fma_f32 v49, v49, v57, v58
    v_fma_f32 v50, v50, v57, v58
    v_fma_f32 v51, v51, v57, v58
    v_accvgpr_write_b32 a132, v48
    v_accvgpr_write_b32 a133, v49
    v_accvgpr_write_b32 a134, v50
    v_accvgpr_write_b32 a135, v51
    v_accvgpr_read_b32 v48, a148
    v_accvgpr_read_b32 v49, a149
    v_accvgpr_read_b32 v50, a150
    v_accvgpr_read_b32 v51, a151
    v_fma_f32 v48, v48, v57, v58
    v_fma_f32 v49, v49, v57, v58
    v_fma_f32 v50, v50, v57, v58
    v_fma_f32 v51, v51, v57, v58
    v_accvgpr_write_b32 a148, v48
    v_accvgpr_write_b32 a149, v49
    v_accvgpr_write_b32 a150, v50
    v_accvgpr_write_b32 a151, v51
    v_accvgpr_read_b32 v48, a164
    v_accvgpr_read_b32 v49, a165
    v_accvgpr_read_b32 v50, a166
    v_accvgpr_read_b32 v51, a167
    v_fma_f32 v48, v48, v57, v58
    v_fma_f32 v49, v49, v57, v58
    v_fma_f32 v50, v50, v57, v58
    v_fma_f32 v51, v51, v57, v58
    v_accvgpr_write_b32 a164, v48
    v_accvgpr_write_b32 a165, v49
    v_accvgpr_write_b32 a166, v50
    v_accvgpr_write_b32 a167, v51
    v_accvgpr_read_b32 v48, a180
    v_accvgpr_read_b32 v49, a181
    v_accvgpr_read_b32 v50, a182
    v_accvgpr_read_b32 v51, a183
    v_fma_f32 v48, v48, v57, v58
    v_fma_f32 v49, v49, v57, v58
    v_fma_f32 v50, v50, v57, v58
    v_fma_f32 v51, v51, v57, v58
    v_accvgpr_write_b32 a180, v48
    v_accvgpr_write_b32 a181, v49
    v_accvgpr_write_b32 a182, v50
    v_accvgpr_write_b32 a183, v51
    v_exp_f32 v48, v140
    v_exp_f32 v49, v141
    v_exp_f32 v50, v142
    v_exp_f32 v51, v143
    v_exp_f32 v52, v172
    v_exp_f32 v53, v173
    v_exp_f32 v54, v174
    v_exp_f32 v55, v175
    s_nop 0
    v_cvt_pk_bf16_f32 v236, v48, v49
    v_cvt_pk_bf16_f32 v237, v50, v51
    v_cvt_pk_bf16_f32 v238, v52, v53
    v_cvt_pk_bf16_f32 v239, v54, v55
    v_add_f32 v25, v48, v49
    v_add_f32 v25, v25, v50
    v_add_f32 v25, v25, v51
    v_add_f32 v25, v25, v52
    v_add_f32 v25, v25, v53
    v_add_f32 v25, v25, v54
    v_add_f32 v25, v25, v55
    v_max3_f32 v56, v148, v149, v150
    v_max3_f32 v56, v56, v151, v180
    v_max3_f32 v56, v56, v181, v182
    v_max3_f32 v56, v56, v183, 0
    v_mov_b32 v58, v56
    s_nop 1
    v_permlane16_swap_b32 v56, v58
    s_nop 1
    v_max_f32 v56, v56, v58
    v_mov_b32 v58, v56
    s_nop 1
    v_permlane32_swap_b32 v56, v58
    s_nop 1
    v_max_f32 v56, v56, v58
    v_exp_f32 v57, -v56
    v_sub_f32 v40, v40, v56
    v_sub_f32 v41, v41, v56
    v_sub_f32 v42, v42, v56
    v_sub_f32 v43, v43, v56
    v_mul_f32 v22, v22, v57
    v_sub_f32 v58, 1.0, v57
    v_sub_f32 v148, v148, v56
    v_sub_f32 v149, v149, v56
    v_sub_f32 v150, v150, v56
    v_sub_f32 v151, v151, v56
    v_sub_f32 v180, v180, v56
    v_sub_f32 v181, v181, v56
    v_sub_f32 v182, v182, v56
    v_sub_f32 v183, v183, v56
    v_sub_f32 v84, v84, v56
    v_sub_f32 v85, v85, v56
    v_sub_f32 v86, v86, v56
    v_sub_f32 v87, v87, v56
    v_sub_f32 v116, v116, v56
    v_sub_f32 v117, v117, v56
    v_sub_f32 v118, v118, v56
    v_sub_f32 v119, v119, v56
    v_accvgpr_read_b32 v48, a8
    v_accvgpr_read_b32 v49, a9
    v_accvgpr_read_b32 v50, a10
    v_accvgpr_read_b32 v51, a11
    v_fma_f32 v48, v48, v57, v58
    v_fma_f32 v49, v49, v57, v58
    v_fma_f32 v50, v50, v57, v58
    v_fma_f32 v51, v51, v57, v58
    v_accvgpr_write_b32 a8, v48
    v_accvgpr_write_b32 a9, v49
    v_accvgpr_write_b32 a10, v50
    v_accvgpr_write_b32 a11, v51
    v_accvgpr_read_b32 v48, a24
    v_accvgpr_read_b32 v49, a25
    v_accvgpr_read_b32 v50, a26
    v_accvgpr_read_b32 v51, a27
    v_fma_f32 v48, v48, v57, v58
    v_fma_f32 v49, v49, v57, v58
    v_fma_f32 v50, v50, v57, v58
    v_fma_f32 v51, v51, v57, v58
    v_accvgpr_write_b32 a24, v48
    v_accvgpr_write_b32 a25, v49
    v_accvgpr_write_b32 a26, v50
    v_accvgpr_write_b32 a27, v51
    v_accvgpr_read_b32 v48, a40
    v_accvgpr_read_b32 v49, a41
    v_accvgpr_read_b32 v50, a42
    v_accvgpr_read_b32 v51, a43
    v_fma_f32 v48, v48, v57, v58
    v_fma_f32 v49, v49, v57, v58
    v_fma_f32 v50, v50, v57, v58
    v_fma_f32 v51, v51, v57, v58
    v_accvgpr_write_b32 a40, v48
    v_accvgpr_write_b32 a41, v49
    v_accvgpr_write_b32 a42, v50
    v_accvgpr_write_b32 a43, v51
    v_accvgpr_read_b32 v48, a56
    v_accvgpr_read_b32 v49, a57
    v_accvgpr_read_b32 v50, a58
    v_accvgpr_read_b32 v51, a59
    v_fma_f32 v48, v48, v57, v58
    v_fma_f32 v49, v49, v57, v58
    v_fma_f32 v50, v50, v57, v58
    v_fma_f32 v51, v51, v57, v58
    v_accvgpr_write_b32 a56, v48
    v_accvgpr_write_b32 a57, v49
    v_accvgpr_write_b32 a58, v50
    v_accvgpr_write_b32 a59, v51
    v_accvgpr_read_b32 v48, a72
    v_accvgpr_read_b32 v49, a73
    v_accvgpr_read_b32 v50, a74
    v_accvgpr_read_b32 v51, a75
    v_fma_f32 v48, v48, v57, v58
    v_fma_f32 v49, v49, v57, v58
    v_fma_f32 v50, v50, v57, v58
    v_fma_f32 v51, v51, v57, v58
    v_accvgpr_write_b32 a72, v48
    v_accvgpr_write_b32 a73, v49
    v_accvgpr_write_b32 a74, v50
    v_accvgpr_write_b32 a75, v51
    v_accvgpr_read_b32 v48, a88
    v_accvgpr_read_b32 v49, a89
    v_accvgpr_read_b32 v50, a90
    v_accvgpr_read_b32 v51, a91
    v_fma_f32 v48, v48, v57, v58
    v_fma_f32 v49, v49, v57, v58
    v_fma_f32 v50, v50, v57, v58
    v_fma_f32 v51, v51, v57, v58
    v_accvgpr_write_b32 a88, v48
    v_accvgpr_write_b32 a89, v49
    v_accvgpr_write_b32 a90, v50
    v_accvgpr_write_b32 a91, v51
    v_accvgpr_read_b32 v48, a104
    v_accvgpr_read_b32 v49, a105
    v_accvgpr_read_b32 v50, a106
    v_accvgpr_read_b32 v51, a107
    v_fma_f32 v48, v48, v57, v58
    v_fma_f32 v49, v49, v57, v58
    v_fma_f32 v50, v50, v57, v58
    v_fma_f32 v51, v51, v57, v58
    v_accvgpr_write_b32 a104, v48
    v_accvgpr_write_b32 a105, v49
    v_accvgpr_write_b32 a106, v50
    v_accvgpr_write_b32 a107, v51
    v_accvgpr_read_b32 v48, a120
    v_accvgpr_read_b32 v49, a121
    v_accvgpr_read_b32 v50, a122
    v_accvgpr_read_b32 v51, a123
    v_fma_f32 v48, v48, v57, v58
    v_fma_f32 v49, v49, v57, v58
    v_fma_f32 v50, v50, v57, v58
    v_fma_f32 v51, v51, v57, v58
    v_accvgpr_write_b32 a120, v48
    v_accvgpr_write_b32 a121, v49
    v_accvgpr_write_b32 a122, v50
    v_accvgpr_write_b32 a123, v51
    v_accvgpr_read_b32 v48, a136
    v_accvgpr_read_b32 v49, a137
    v_accvgpr_read_b32 v50, a138
    v_accvgpr_read_b32 v51, a139
    v_fma_f32 v48, v48, v57, v58
    v_fma_f32 v49, v49, v57, v58
    v_fma_f32 v50, v50, v57, v58
    v_fma_f32 v51, v51, v57, v58
    v_accvgpr_write_b32 a136, v48
    v_accvgpr_write_b32 a137, v49
    v_accvgpr_write_b32 a138, v50
    v_accvgpr_write_b32 a139, v51
    v_accvgpr_read_b32 v48, a152
    v_accvgpr_read_b32 v49, a153
    v_accvgpr_read_b32 v50, a154
    v_accvgpr_read_b32 v51, a155
    v_fma_f32 v48, v48, v57, v58
    v_fma_f32 v49, v49, v57, v58
    v_fma_f32 v50, v50, v57, v58
    v_fma_f32 v51, v51, v57, v58
    v_accvgpr_write_b32 a152, v48
    v_accvgpr_write_b32 a153, v49
    v_accvgpr_write_b32 a154, v50
    v_accvgpr_write_b32 a155, v51
    v_accvgpr_read_b32 v48, a168
    v_accvgpr_read_b32 v49, a169
    v_accvgpr_read_b32 v50, a170
    v_accvgpr_read_b32 v51, a171
    v_fma_f32 v48, v48, v57, v58
    v_fma_f32 v49, v49, v57, v58
    v_fma_f32 v50, v50, v57, v58
    v_fma_f32 v51, v51, v57, v58
    v_accvgpr_write_b32 a168, v48
    v_accvgpr_write_b32 a169, v49
    v_accvgpr_write_b32 a170, v50
    v_accvgpr_write_b32 a171, v51
    v_accvgpr_read_b32 v48, a184
    v_accvgpr_read_b32 v49, a185
    v_accvgpr_read_b32 v50, a186
    v_accvgpr_read_b32 v51, a187
    v_fma_f32 v48, v48, v57, v58
    v_fma_f32 v49, v49, v57, v58
    v_fma_f32 v50, v50, v57, v58
    v_fma_f32 v51, v51, v57, v58
    v_accvgpr_write_b32 a184, v48
    v_accvgpr_write_b32 a185, v49
    v_accvgpr_write_b32 a186, v50
    v_accvgpr_write_b32 a187, v51
    v_exp_f32 v48, v148
    v_exp_f32 v49, v149
    v_exp_f32 v50, v150
    v_exp_f32 v51, v151
    v_exp_f32 v52, v180
    v_exp_f32 v53, v181
    v_exp_f32 v54, v182
    v_exp_f32 v55, v183
    s_nop 0
    v_cvt_pk_bf16_f32 v244, v48, v49
    v_cvt_pk_bf16_f32 v245, v50, v51
    v_cvt_pk_bf16_f32 v246, v52, v53
    v_cvt_pk_bf16_f32 v247, v54, v55
    v_add_f32 v26, v48, v49
    v_add_f32 v26, v26, v50
    v_add_f32 v26, v26, v51
    v_add_f32 v26, v26, v52
    v_add_f32 v26, v26, v53
    v_add_f32 v26, v26, v54
    v_add_f32 v26, v26, v55
    v_max3_f32 v56, v156, v157, v158
    v_max3_f32 v56, v56, v159, v188
    v_max3_f32 v56, v56, v189, v190
    v_max3_f32 v56, v56, v191, 0
    v_mov_b32 v58, v56
    s_nop 1
    v_permlane16_swap_b32 v56, v58
    s_nop 1
    v_max_f32 v56, v56, v58
    v_mov_b32 v58, v56
    s_nop 1
    v_permlane32_swap_b32 v56, v58
    s_nop 1
    v_max_f32 v56, v56, v58
    v_exp_f32 v57, -v56
    v_sub_f32 v44, v44, v56
    v_sub_f32 v45, v45, v56
    v_sub_f32 v46, v46, v56
    v_sub_f32 v47, v47, v56
    v_mul_f32 v23, v23, v57
    v_sub_f32 v58, 1.0, v57
    v_sub_f32 v156, v156, v56
    v_sub_f32 v157, v157, v56
    v_sub_f32 v158, v158, v56
    v_sub_f32 v159, v159, v56
    v_sub_f32 v188, v188, v56
    v_sub_f32 v189, v189, v56
    v_sub_f32 v190, v190, v56
    v_sub_f32 v191, v191, v56
    v_sub_f32 v92, v92, v56
    v_sub_f32 v93, v93, v56
    v_sub_f32 v94, v94, v56
    v_sub_f32 v95, v95, v56
    v_sub_f32 v124, v124, v56
    v_sub_f32 v125, v125, v56
    v_sub_f32 v126, v126, v56
    v_sub_f32 v127, v127, v56
    v_accvgpr_read_b32 v48, a12
    v_accvgpr_read_b32 v49, a13
    v_accvgpr_read_b32 v50, a14
    v_accvgpr_read_b32 v51, a15
    v_fma_f32 v48, v48, v57, v58
    v_fma_f32 v49, v49, v57, v58
    v_fma_f32 v50, v50, v57, v58
    v_fma_f32 v51, v51, v57, v58
    v_accvgpr_write_b32 a12, v48
    v_accvgpr_write_b32 a13, v49
    v_accvgpr_write_b32 a14, v50
    v_accvgpr_write_b32 a15, v51
    v_accvgpr_read_b32 v48, a28
    v_accvgpr_read_b32 v49, a29
    v_accvgpr_read_b32 v50, a30
    v_accvgpr_read_b32 v51, a31
    v_fma_f32 v48, v48, v57, v58
    v_fma_f32 v49, v49, v57, v58
    v_fma_f32 v50, v50, v57, v58
    v_fma_f32 v51, v51, v57, v58
    v_accvgpr_write_b32 a28, v48
    v_accvgpr_write_b32 a29, v49
    v_accvgpr_write_b32 a30, v50
    v_accvgpr_write_b32 a31, v51
    v_accvgpr_read_b32 v48, a44
    v_accvgpr_read_b32 v49, a45
    v_accvgpr_read_b32 v50, a46
    v_accvgpr_read_b32 v51, a47
    v_fma_f32 v48, v48, v57, v58
    v_fma_f32 v49, v49, v57, v58
    v_fma_f32 v50, v50, v57, v58
    v_fma_f32 v51, v51, v57, v58
    v_accvgpr_write_b32 a44, v48
    v_accvgpr_write_b32 a45, v49
    v_accvgpr_write_b32 a46, v50
    v_accvgpr_write_b32 a47, v51
    v_accvgpr_read_b32 v48, a60
    v_accvgpr_read_b32 v49, a61
    v_accvgpr_read_b32 v50, a62
    v_accvgpr_read_b32 v51, a63
    v_fma_f32 v48, v48, v57, v58
    v_fma_f32 v49, v49, v57, v58
    v_fma_f32 v50, v50, v57, v58
    v_fma_f32 v51, v51, v57, v58
    v_accvgpr_write_b32 a60, v48
    v_accvgpr_write_b32 a61, v49
    v_accvgpr_write_b32 a62, v50
    v_accvgpr_write_b32 a63, v51
    v_accvgpr_read_b32 v48, a76
    v_accvgpr_read_b32 v49, a77
    v_accvgpr_read_b32 v50, a78
    v_accvgpr_read_b32 v51, a79
    v_fma_f32 v48, v48, v57, v58
    v_fma_f32 v49, v49, v57, v58
    v_fma_f32 v50, v50, v57, v58
    v_fma_f32 v51, v51, v57, v58
    v_accvgpr_write_b32 a76, v48
    v_accvgpr_write_b32 a77, v49
    v_accvgpr_write_b32 a78, v50
    v_accvgpr_write_b32 a79, v51
    v_accvgpr_read_b32 v48, a92
    v_accvgpr_read_b32 v49, a93
    v_accvgpr_read_b32 v50, a94
    v_accvgpr_read_b32 v51, a95
    v_fma_f32 v48, v48, v57, v58
    v_fma_f32 v49, v49, v57, v58
    v_fma_f32 v50, v50, v57, v58
    v_fma_f32 v51, v51, v57, v58
    v_accvgpr_write_b32 a92, v48
    v_accvgpr_write_b32 a93, v49
    v_accvgpr_write_b32 a94, v50
    v_accvgpr_write_b32 a95, v51
    v_accvgpr_read_b32 v48, a108
    v_accvgpr_read_b32 v49, a109
    v_accvgpr_read_b32 v50, a110
    v_accvgpr_read_b32 v51, a111
    v_fma_f32 v48, v48, v57, v58
    v_fma_f32 v49, v49, v57, v58
    v_fma_f32 v50, v50, v57, v58
    v_fma_f32 v51, v51, v57, v58
    v_accvgpr_write_b32 a108, v48
    v_accvgpr_write_b32 a109, v49
    v_accvgpr_write_b32 a110, v50
    v_accvgpr_write_b32 a111, v51
    v_accvgpr_read_b32 v48, a124
    v_accvgpr_read_b32 v49, a125
    v_accvgpr_read_b32 v50, a126
    v_accvgpr_read_b32 v51, a127
    v_fma_f32 v48, v48, v57, v58
    v_fma_f32 v49, v49, v57, v58
    v_fma_f32 v50, v50, v57, v58
    v_fma_f32 v51, v51, v57, v58
    v_accvgpr_write_b32 a124, v48
    v_accvgpr_write_b32 a125, v49
    v_accvgpr_write_b32 a126, v50
    v_accvgpr_write_b32 a127, v51
    v_accvgpr_read_b32 v48, a140
    v_accvgpr_read_b32 v49, a141
    v_accvgpr_read_b32 v50, a142
    v_accvgpr_read_b32 v51, a143
    v_fma_f32 v48, v48, v57, v58
    v_fma_f32 v49, v49, v57, v58
    v_fma_f32 v50, v50, v57, v58
    v_fma_f32 v51, v51, v57, v58
    v_accvgpr_write_b32 a140, v48
    v_accvgpr_write_b32 a141, v49
    v_accvgpr_write_b32 a142, v50
    v_accvgpr_write_b32 a143, v51
    v_accvgpr_read_b32 v48, a156
    v_accvgpr_read_b32 v49, a157
    v_accvgpr_read_b32 v50, a158
    v_accvgpr_read_b32 v51, a159
    v_fma_f32 v48, v48, v57, v58
    v_fma_f32 v49, v49, v57, v58
    v_fma_f32 v50, v50, v57, v58
    v_fma_f32 v51, v51, v57, v58
    v_accvgpr_write_b32 a156, v48
    v_accvgpr_write_b32 a157, v49
    v_accvgpr_write_b32 a158, v50
    v_accvgpr_write_b32 a159, v51
    v_accvgpr_read_b32 v48, a172
    v_accvgpr_read_b32 v49, a173
    v_accvgpr_read_b32 v50, a174
    v_accvgpr_read_b32 v51, a175
    v_fma_f32 v48, v48, v57, v58
    v_fma_f32 v49, v49, v57, v58
    v_fma_f32 v50, v50, v57, v58
    v_fma_f32 v51, v51, v57, v58
    v_accvgpr_write_b32 a172, v48
    v_accvgpr_write_b32 a173, v49
    v_accvgpr_write_b32 a174, v50
    v_accvgpr_write_b32 a175, v51
    v_accvgpr_read_b32 v48, a188
    v_accvgpr_read_b32 v49, a189
    v_accvgpr_read_b32 v50, a190
    v_accvgpr_read_b32 v51, a191
    v_fma_f32 v48, v48, v57, v58
    v_fma_f32 v49, v49, v57, v58
    v_fma_f32 v50, v50, v57, v58
    v_fma_f32 v51, v51, v57, v58
    v_accvgpr_write_b32 a188, v48
    v_accvgpr_write_b32 a189, v49
    v_accvgpr_write_b32 a190, v50
    v_accvgpr_write_b32 a191, v51
    v_exp_f32 v48, v156
    v_exp_f32 v49, v157
    v_exp_f32 v50, v158
    v_exp_f32 v51, v159
    v_exp_f32 v52, v188
    v_exp_f32 v53, v189
    v_exp_f32 v54, v190
    v_exp_f32 v55, v191
    s_nop 0
    v_cvt_pk_bf16_f32 v252, v48, v49
    v_cvt_pk_bf16_f32 v253, v50, v51
    v_cvt_pk_bf16_f32 v254, v52, v53
    v_cvt_pk_bf16_f32 v255, v54, v55
    v_add_f32 v27, v48, v49
    v_add_f32 v27, v27, v50
    v_add_f32 v27, v27, v51
    v_add_f32 v27, v27, v52
    v_add_f32 v27, v27, v53
    v_add_f32 v27, v27, v54
    v_add_f32 v27, v27, v55
    s_nop 1
    s_branch rare_a_ret
rare_b:
    s_nop 7
    s_nop 7
    v_max3_f32 v56, v68, v69, v70
    v_max3_f32 v56, v56, v71, v100
    v_max3_f32 v56, v56, v101, v102
    v_max3_f32 v56, v56, v103, 0
    v_mov_b32 v58, v56
    s_nop 1
    v_permlane16_swap_b32 v56, v58
    s_nop 1
    v_max_f32 v56, v56, v58
    v_mov_b32 v58, v56
    s_nop 1
    v_permlane32_swap_b32 v56, v58
    s_nop 1
    v_max_f32 v56, v56, v58
    v_exp_f32 v57, -v56
    v_sub_f32 v32, v32, v56
    v_sub_f32 v33, v33, v56
    v_sub_f32 v34, v34, v56
    v_sub_f32 v35, v35, v56
    v_mul_f32 v20, v20, v57
    v_sub_f32 v58, 1.0, v57
    v_sub_f32 v68, v68, v56
    v_sub_f32 v69, v69, v56
    v_sub_f32 v70, v70, v56
    v_sub_f32 v71, v71, v56
    v_sub_f32 v100, v100, v56
    v_sub_f32 v101, v101, v56
    v_sub_f32 v102, v102, v56
    v_sub_f32 v103, v103, v56
    v_sub_f32 v132, v132, v56
    v_sub_f32 v133, v133, v56
    v_sub_f32 v134, v134, v56
    v_sub_f32 v135, v135, v56
    v_sub_f32 v164, v164, v56
    v_sub_f32 v165, v165, v56
    v_sub_f32 v166, v166, v56
    v_sub_f32 v167, v167, v56
    v_accvgpr_read_b32 v48, a0
    v_accvgpr_read_b32 v49, a1
    v_accvgpr_read_b32 v50, a2
    v_accvgpr_read_b32 v51, a3
    v_fma_f32 v48, v48, v57, v58
    v_fma_f32 v49, v49, v57, v58
    v_fma_f32 v50, v50, v57, v58
    v_fma_f32 v51, v51, v57, v58
    v_accvgpr_write_b32 a0, v48
    v_accvgpr_write_b32 a1, v49
    v_accvgpr_write_b32 a2, v50
    v_accvgpr_write_b32 a3, v51
    v_accvgpr_read_b32 v48, a16
    v_accvgpr_read_b32 v49, a17
    v_accvgpr_read_b32 v50, a18
    v_accvgpr_read_b32 v51, a19
    v_fma_f32 v48, v48, v57, v58
    v_fma_f32 v49, v49, v57, v58
    v_fma_f32 v50, v50, v57, v58
    v_fma_f32 v51, v51, v57, v58
    v_accvgpr_write_b32 a16, v48
    v_accvgpr_write_b32 a17, v49
    v_accvgpr_write_b32 a18, v50
    v_accvgpr_write_b32 a19, v51
    v_accvgpr_read_b32 v48, a32
    v_accvgpr_read_b32 v49, a33
    v_accvgpr_read_b32 v50, a34
    v_accvgpr_read_b32 v51, a35
    v_fma_f32 v48, v48, v57, v58
    v_fma_f32 v49, v49, v57, v58
    v_fma_f32 v50, v50, v57, v58
    v_fma_f32 v51, v51, v57, v58
    v_accvgpr_write_b32 a32, v48
    v_accvgpr_write_b32 a33, v49
    v_accvgpr_write_b32 a34, v50
    v_accvgpr_write_b32 a35, v51
    v_accvgpr_read_b32 v48, a48
    v_accvgpr_read_b32 v49, a49
    v_accvgpr_read_b32 v50, a50
    v_accvgpr_read_b32 v51, a51
    v_fma_f32 v48, v48, v57, v58
    v_fma_f32 v49, v49, v57, v58
    v_fma_f32 v50, v50, v57, v58
    v_fma_f32 v51, v51, v57, v58
    v_accvgpr_write_b32 a48, v48
    v_accvgpr_write_b32 a49, v49
    v_accvgpr_write_b32 a50, v50
    v_accvgpr_write_b32 a51, v51
    v_accvgpr_read_b32 v48, a64
    v_accvgpr_read_b32 v49, a65
    v_accvgpr_read_b32 v50, a66
    v_accvgpr_read_b32 v51, a67
    v_fma_f32 v48, v48, v57, v58
    v_fma_f32 v49, v49, v57, v58
    v_fma_f32 v50, v50, v57, v58
    v_fma_f32 v51, v51, v57, v58
    v_accvgpr_write_b32 a64, v48
    v_accvgpr_write_b32 a65, v49
    v_accvgpr_write_b32 a66, v50
    v_accvgpr_write_b32 a67, v51
    v_accvgpr_read_b32 v48, a80
    v_accvgpr_read_b32 v49, a81
    v_accvgpr_read_b32 v50, a82
    v_accvgpr_read_b32 v51, a83
    v_fma_f32 v48, v48, v57, v58
    v_fma_f32 v49, v49, v57, v58
    v_fma_f32 v50, v50, v57, v58
    v_fma_f32 v51, v51, v57, v58
    v_accvgpr_write_b32 a80, v48
    v_accvgpr_write_b32 a81, v49
    v_accvgpr_write_b32 a82, v50
    v_accvgpr_write_b32 a83, v51
    v_accvgpr_read_b32 v48, a96
    v_accvgpr_read_b32 v49, a97
    v_accvgpr_read_b32 v50, a98
    v_accvgpr_read_b32 v51, a99
    v_fma_f32 v48, v48, v57, v58
    v_fma_f32 v49, v49, v57, v58
    v_fma_f32 v50, v50, v57, v58
    v_fma_f32 v51, v51, v57, v58
    v_accvgpr_write_b32 a96, v48
    v_accvgpr_write_b32 a97, v49
    v_accvgpr_write_b32 a98, v50
    v_accvgpr_write_b32 a99, v51
    v_accvgpr_read_b32 v48, a112
    v_accvgpr_read_b32 v49, a113
    v_accvgpr_read_b32 v50, a114
    v_accvgpr_read_b32 v51, a115
    v_fma_f32 v48, v48, v57, v58
    v_fma_f32 v49, v49, v57, v58
    v_fma_f32 v50, v50, v57, v58
    v_fma_f32 v51, v51, v57, v58
    v_accvgpr_write_b32 a112, v48
    v_accvgpr_write_b32 a113, v49
    v_accvgpr_write_b32 a114, v50
    v_accvgpr_write_b32 a115, v51
    v_accvgpr_read_b32 v48, a128
    v_accvgpr_read_b32 v49, a129
    v_accvgpr_read_b32 v50, a130
    v_accvgpr_read_b32 v51, a131
    v_fma_f32 v48, v48, v57, v58
    v_fma_f32 v49, v49, v57, v58
    v_fma_f32 v50, v50, v57, v58
    v_fma_f32 v51, v51, v57, v58
    v_accvgpr_write_b32 a128, v48
    v_accvgpr_write_b32 a129, v49
    v_accvgpr_write_b32 a130, v50
    v_accvgpr_write_b32 a131, v51
    v_accvgpr_read_b32 v48, a144
    v_accvgpr_read_b32 v49, a145
    v_accvgpr_read_b32 v50, a146
    v_accvgpr_read_b32 v51, a147
    v_fma_f32 v48, v48, v57, v58
    v_fma_f32 v49, v49, v57, v58
    v_fma_f32 v50, v50, v57, v58
    v_fma_f32 v51, v51, v57, v58
    v_accvgpr_write_b32 a144, v48
    v_accvgpr_write_b32 a145, v49
    v_accvgpr_write_b32 a146, v50
    v_accvgpr_write_b32 a147, v51
    v_accvgpr_read_b32 v48, a160
    v_accvgpr_read_b32 v49, a161
    v_accvgpr_read_b32 v50, a162
    v_accvgpr_read_b32 v51, a163
    v_fma_f32 v48, v48, v57, v58
    v_fma_f32 v49, v49, v57, v58
    v_fma_f32 v50, v50, v57, v58
    v_fma_f32 v51, v51, v57, v58
    v_accvgpr_write_b32 a160, v48
    v_accvgpr_write_b32 a161, v49
    v_accvgpr_write_b32 a162, v50
    v_accvgpr_write_b32 a163, v51
    v_accvgpr_read_b32 v48, a176
    v_accvgpr_read_b32 v49, a177
    v_accvgpr_read_b32 v50, a178
    v_accvgpr_read_b32 v51, a179
    v_fma_f32 v48, v48, v57, v58
    v_fma_f32 v49, v49, v57, v58
    v_fma_f32 v50, v50, v57, v58
    v_fma_f32 v51, v51, v57, v58
    v_accvgpr_write_b32 a176, v48
    v_accvgpr_write_b32 a177, v49
    v_accvgpr_write_b32 a178, v50
    v_accvgpr_write_b32 a179, v51
    v_exp_f32 v48, v68
    v_exp_f32 v49, v69
    v_exp_f32 v50, v70
    v_exp_f32 v51, v71
    v_exp_f32 v52, v100
    v_exp_f32 v53, v101
    v_exp_f32 v54, v102
    v_exp_f32 v55, v103
    s_nop 0
    v_cvt_pk_bf16_f32 v196, v48, v49
    v_cvt_pk_bf16_f32 v197, v50, v51
    v_cvt_pk_bf16_f32 v198, v52, v53
    v_cvt_pk_bf16_f32 v199, v54, v55
    v_add_f32 v24, v48, v49
    v_add_f32 v24, v24, v50
    v_add_f32 v24, v24, v51
    v_add_f32 v24, v24, v52
    v_add_f32 v24, v24, v53
    v_add_f32 v24, v24, v54
    v_add_f32 v24, v24, v55
    v_max3_f32 v56, v76, v77, v78
    v_max3_f32 v56, v56, v79, v108
    v_max3_f32 v56, v56, v109, v110
    v_max3_f32 v56, v56, v111, 0
    v_mov_b32 v58, v56
    s_nop 1
    v_permlane16_swap_b32 v56, v58
    s_nop 1
    v_max_f32 v56, v56, v58
    v_mov_b32 v58, v56
    s_nop 1
    v_permlane32_swap_b32 v56, v58
    s_nop 1
    v_max_f32 v56, v56, v58
    v_exp_f32 v57, -v56
    v_sub_f32 v36, v36, v56
    v_sub_f32 v37, v37, v56
    v_sub_f32 v38, v38, v56
    v_sub_f32 v39, v39, v56
    v_mul_f32 v21, v21, v57
    v_sub_f32 v58, 1.0, v57
    v_sub_f32 v76, v76, v56
    v_sub_f32 v77, v77, v56
    v_sub_f32 v78, v78, v56
    v_sub_f32 v79, v79, v56
    v_sub_f32 v108, v108, v56
    v_sub_f32 v109, v109, v56
    v_sub_f32 v110, v110, v56
    v_sub_f32 v111, v111, v56
    v_sub_f32 v140, v140, v56
    v_sub_f32 v141, v141, v56
    v_sub_f32 v142, v142, v56
    v_sub_f32 v143, v143, v56
    v_sub_f32 v172, v172, v56
    v_sub_f32 v173, v173, v56
    v_sub_f32 v174, v174, v56
    v_sub_f32 v175, v175, v56
    v_accvgpr_read_b32 v48, a4
    v_accvgpr_read_b32 v49, a5
    v_accvgpr_read_b32 v50, a6
    v_accvgpr_read_b32 v51, a7
    v_fma_f32 v48, v48, v57, v58
    v_fma_f32 v49, v49, v57, v58
    v_fma_f32 v50, v50, v57, v58
    v_fma_f32 v51, v51, v57, v58
    v_accvgpr_write_b32 a4, v48
    v_accvgpr_write_b32 a5, v49
    v_accvgpr_write_b32 a6, v50
    v_accvgpr_write_b32 a7, v51
    v_accvgpr_read_b32 v48, a20
    v_accvgpr_read_b32 v49, a21
    v_accvgpr_read_b32 v50, a22
    v_accvgpr_read_b32 v51, a23
    v_fma_f32 v48, v48, v57, v58
    v_fma_f32 v49, v49, v57, v58
    v_fma_f32 v50, v50, v57, v58
    v_fma_f32 v51, v51, v57, v58
    v_accvgpr_write_b32 a20, v48
    v_accvgpr_write_b32 a21, v49
    v_accvgpr_write_b32 a22, v50
    v_accvgpr_write_b32 a23, v51
    v_accvgpr_read_b32 v48, a36
    v_accvgpr_read_b32 v49, a37
    v_accvgpr_read_b32 v50, a38
    v_accvgpr_read_b32 v51, a39
    v_fma_f32 v48, v48, v57, v58
    v_fma_f32 v49, v49, v57, v58
    v_fma_f32 v50, v50, v57, v58
    v_fma_f32 v51, v51, v57, v58
    v_accvgpr_write_b32 a36, v48
    v_accvgpr_write_b32 a37, v49
    v_accvgpr_write_b32 a38, v50
    v_accvgpr_write_b32 a39, v51
    v_accvgpr_read_b32 v48, a52
    v_accvgpr_read_b32 v49, a53
    v_accvgpr_read_b32 v50, a54
    v_accvgpr_read_b32 v51, a55
    v_fma_f32 v48, v48, v57, v58
    v_fma_f32 v49, v49, v57, v58
    v_fma_f32 v50, v50, v57, v58
    v_fma_f32 v51, v51, v57, v58
    v_accvgpr_write_b32 a52, v48
    v_accvgpr_write_b32 a53, v49
    v_accvgpr_write_b32 a54, v50
    v_accvgpr_write_b32 a55, v51
    v_accvgpr_read_b32 v48, a68
    v_accvgpr_read_b32 v49, a69
    v_accvgpr_read_b32 v50, a70
    v_accvgpr_read_b32 v51, a71
    v_fma_f32 v48, v48, v57, v58
    v_fma_f32 v49, v49, v57, v58
    v_fma_f32 v50, v50, v57, v58
    v_fma_f32 v51, v51, v57, v58
    v_accvgpr_write_b32 a68, v48
    v_accvgpr_write_b32 a69, v49
    v_accvgpr_write_b32 a70, v50
    v_accvgpr_write_b32 a71, v51
    v_accvgpr_read_b32 v48, a84
    v_accvgpr_read_b32 v49, a85
    v_accvgpr_read_b32 v50, a86
    v_accvgpr_read_b32 v51, a87
    v_fma_f32 v48, v48, v57, v58
    v_fma_f32 v49, v49, v57, v58
    v_fma_f32 v50, v50, v57, v58
    v_fma_f32 v51, v51, v57, v58
    v_accvgpr_write_b32 a84, v48
    v_accvgpr_write_b32 a85, v49
    v_accvgpr_write_b32 a86, v50
    v_accvgpr_write_b32 a87, v51
    v_accvgpr_read_b32 v48, a100
    v_accvgpr_read_b32 v49, a101
    v_accvgpr_read_b32 v50, a102
    v_accvgpr_read_b32 v51, a103
    v_fma_f32 v48, v48, v57, v58
    v_fma_f32 v49, v49, v57, v58
    v_fma_f32 v50, v50, v57, v58
    v_fma_f32 v51, v51, v57, v58
    v_accvgpr_write_b32 a100, v48
    v_accvgpr_write_b32 a101, v49
    v_accvgpr_write_b32 a102, v50
    v_accvgpr_write_b32 a103, v51
    v_accvgpr_read_b32 v48, a116
    v_accvgpr_read_b32 v49, a117
    v_accvgpr_read_b32 v50, a118
    v_accvgpr_read_b32 v51, a119
    v_fma_f32 v48, v48, v57, v58
    v_fma_f32 v49, v49, v57, v58
    v_fma_f32 v50, v50, v57, v58
    v_fma_f32 v51, v51, v57, v58
    v_accvgpr_write_b32 a116, v48
    v_accvgpr_write_b32 a117, v49
    v_accvgpr_write_b32 a118, v50
    v_accvgpr_write_b32 a119, v51
    v_accvgpr_read_b32 v48, a132
    v_accvgpr_read_b32 v49, a133
    v_accvgpr_read_b32 v50, a134
    v_accvgpr_read_b32 v51, a135
    v_fma_f32 v48, v48, v57, v58
    v_fma_f32 v49, v49, v57, v58
    v_fma_f32 v50, v50, v57, v58
    v_fma_f32 v51, v51, v57, v58
    v_accvgpr_write_b32 a132, v48
    v_accvgpr_write_b32 a133, v49
    v_accvgpr_write_b32 a134, v50
    v_accvgpr_write_b32 a135, v51
    v_accvgpr_read_b32 v48, a148
    v_accvgpr_read_b32 v49, a149
    v_accvgpr_read_b32 v50, a150
    v_accvgpr_read_b32 v51, a151
    v_fma_f32 v48, v48, v57, v58
    v_fma_f32 v49, v49, v57, v58
    v_fma_f32 v50, v50, v57, v58
    v_fma_f32 v51, v51, v57, v58
    v_accvgpr_write_b32 a148, v48
    v_accvgpr_write_b32 a149, v49
    v_accvgpr_write_b32 a150, v50
    v_accvgpr_write_b32 a151, v51
    v_accvgpr_read_b32 v48, a164
    v_accvgpr_read_b32 v49, a165
    v_accvgpr_read_b32 v50, a166
    v_accvgpr_read_b32 v51, a167
    v_fma_f32 v48, v48, v57, v58
    v_fma_f32 v49, v49, v57, v58
    v_fma_f32 v50, v50, v57, v58
    v_fma_f32 v51, v51, v57, v58
    v_accvgpr_write_b32 a164, v48
    v_accvgpr_write_b32 a165, v49
    v_accvgpr_write_b32 a166, v50
    v_accvgpr_write_b32 a167, v51
    v_accvgpr_read_b32 v48, a180
    v_accvgpr_read_b32 v49, a181
    v_accvgpr_read_b32 v50, a182
    v_accvgpr_read_b32 v51, a183
    v_fma_f32 v48, v48, v57, v58
    v_fma_f32 v49, v49, v57, v58
    v_fma_f32 v50, v50, v57, v58
    v_fma_f32 v51, v51, v57, v58
    v_accvgpr_write_b32 a180, v48
    v_accvgpr_write_b32 a181, v49
    v_accvgpr_write_b32 a182, v50
    v_accvgpr_write_b32 a183, v51
    v_exp_f32 v48, v76
    v_exp_f32 v49, v77
    v_exp_f32 v50, v78
    v_exp_f32 v51, v79
    v_exp_f32 v52, v108
    v_exp_f32 v53, v109
    v_exp_f32 v54, v110
    v_exp_f32 v55, v111
    s_nop 0
    v_cvt_pk_bf16_f32 v204, v48, v49
    v_cvt_pk_bf16_f32 v205, v50, v51
    v_cvt_pk_bf16_f32 v206, v52, v53
    v_cvt_pk_bf16_f32 v207, v54, v55
    v_add_f32 v25, v48, v49
    v_add_f32 v25, v25, v50
    v_add_f32 v25, v25, v51
    v_add_f32 v25, v25, v52
    v_add_f32 v25, v25, v53
    v_add_f32 v25, v25, v54
    v_add_f32 v25, v25, v55
    v_max3_f32 v56, v84, v85, v86
    v_max3_f32 v56, v56, v87, v116
    v_max3_f32 v56, v56, v117, v118
    v_max3_f32 v56, v56, v119, 0
    v_mov_b32 v58, v56
    s_nop 1
    v_permlane16_swap_b32 v56, v58
    s_nop 1
    v_max_f32 v56, v56, v58
    v_mov_b32 v58, v56
    s_nop 1
    v_permlane32_swap_b32 v56, v58
    s_nop 1
    v_max_f32 v56, v56, v58
    v_exp_f32 v57, -v56
    v_sub_f32 v40, v40, v56
    v_sub_f32 v41, v41, v56
    v_sub_f32 v42, v42, v56
    v_sub_f32 v43, v43, v56
    v_mul_f32 v22, v22, v57
    v_sub_f32 v58, 1.0, v57
    v_sub_f32 v84, v84, v56
    v_sub_f32 v85, v85, v56
    v_sub_f32 v86, v86, v56
    v_sub_f32 v87, v87, v56
    v_sub_f32 v116, v116, v56
    v_sub_f32 v117, v117, v56
    v_sub_f32 v118, v118, v56
    v_sub_f32 v119, v119, v56
    v_sub_f32 v148, v148, v56
    v_sub_f32 v149, v149, v56
    v_sub_f32 v150, v150, v56
    v_sub_f32 v151, v151, v56
    v_sub_f32 v180, v180, v56
    v_sub_f32 v181, v181, v56
    v_sub_f32 v182, v182, v56
    v_sub_f32 v183, v183, v56
    v_accvgpr_read_b32 v48, a8
    v_accvgpr_read_b32 v49, a9
    v_accvgpr_read_b32 v50, a10
    v_accvgpr_read_b32 v51, a11
    v_fma_f32 v48, v48, v57, v58
    v_fma_f32 v49, v49, v57, v58
    v_fma_f32 v50, v50, v57, v58
    v_fma_f32 v51, v51, v57, v58
    v_accvgpr_write_b32 a8, v48
    v_accvgpr_write_b32 a9, v49
    v_accvgpr_write_b32 a10, v50
    v_accvgpr_write_b32 a11, v51
    v_accvgpr_read_b32 v48, a24
    v_accvgpr_read_b32 v49, a25
    v_accvgpr_read_b32 v50, a26
    v_accvgpr_read_b32 v51, a27
    v_fma_f32 v48, v48, v57, v58
    v_fma_f32 v49, v49, v57, v58
    v_fma_f32 v50, v50, v57, v58
    v_fma_f32 v51, v51, v57, v58
    v_accvgpr_write_b32 a24, v48
    v_accvgpr_write_b32 a25, v49
    v_accvgpr_write_b32 a26, v50
    v_accvgpr_write_b32 a27, v51
    v_accvgpr_read_b32 v48, a40
    v_accvgpr_read_b32 v49, a41
    v_accvgpr_read_b32 v50, a42
    v_accvgpr_read_b32 v51, a43
    v_fma_f32 v48, v48, v57, v58
    v_fma_f32 v49, v49, v57, v58
    v_fma_f32 v50, v50, v57, v58
    v_fma_f32 v51, v51, v57, v58
    v_accvgpr_write_b32 a40, v48
    v_accvgpr_write_b32 a41, v49
    v_accvgpr_write_b32 a42, v50
    v_accvgpr_write_b32 a43, v51
    v_accvgpr_read_b32 v48, a56
    v_accvgpr_read_b32 v49, a57
    v_accvgpr_read_b32 v50, a58
    v_accvgpr_read_b32 v51, a59
    v_fma_f32 v48, v48, v57, v58
    v_fma_f32 v49, v49, v57, v58
    v_fma_f32 v50, v50, v57, v58
    v_fma_f32 v51, v51, v57, v58
    v_accvgpr_write_b32 a56, v48
    v_accvgpr_write_b32 a57, v49
    v_accvgpr_write_b32 a58, v50
    v_accvgpr_write_b32 a59, v51
    v_accvgpr_read_b32 v48, a72
    v_accvgpr_read_b32 v49, a73
    v_accvgpr_read_b32 v50, a74
    v_accvgpr_read_b32 v51, a75
    v_fma_f32 v48, v48, v57, v58
    v_fma_f32 v49, v49, v57, v58
    v_fma_f32 v50, v50, v57, v58
    v_fma_f32 v51, v51, v57, v58
    v_accvgpr_write_b32 a72, v48
    v_accvgpr_write_b32 a73, v49
    v_accvgpr_write_b32 a74, v50
    v_accvgpr_write_b32 a75, v51
    v_accvgpr_read_b32 v48, a88
    v_accvgpr_read_b32 v49, a89
    v_accvgpr_read_b32 v50, a90
    v_accvgpr_read_b32 v51, a91
    v_fma_f32 v48, v48, v57, v58
    v_fma_f32 v49, v49, v57, v58
    v_fma_f32 v50, v50, v57, v58
    v_fma_f32 v51, v51, v57, v58
    v_accvgpr_write_b32 a88, v48
    v_accvgpr_write_b32 a89, v49
    v_accvgpr_write_b32 a90, v50
    v_accvgpr_write_b32 a91, v51
    v_accvgpr_read_b32 v48, a104
    v_accvgpr_read_b32 v49, a105
    v_accvgpr_read_b32 v50, a106
    v_accvgpr_read_b32 v51, a107
    v_fma_f32 v48, v48, v57, v58
    v_fma_f32 v49, v49, v57, v58
    v_fma_f32 v50, v50, v57, v58
    v_fma_f32 v51, v51, v57, v58
    v_accvgpr_write_b32 a104, v48
    v_accvgpr_write_b32 a105, v49
    v_accvgpr_write_b32 a106, v50
    v_accvgpr_write_b32 a107, v51
    v_accvgpr_read_b32 v48, a120
    v_accvgpr_read_b32 v49, a121
    v_accvgpr_read_b32 v50, a122
    v_accvgpr_read_b32 v51, a123
    v_fma_f32 v48, v48, v57, v58
    v_fma_f32 v49, v49, v57, v58
    v_fma_f32 v50, v50, v57, v58
    v_fma_f32 v51, v51, v57, v58
    v_accvgpr_write_b32 a120, v48
    v_accvgpr_write_b32 a121, v49
    v_accvgpr_write_b32 a122, v50
    v_accvgpr_write_b32 a123, v51
    v_accvgpr_read_b32 v48, a136
    v_accvgpr_read_b32 v49, a137
    v_accvgpr_read_b32 v50, a138
    v_accvgpr_read_b32 v51, a139
    v_fma_f32 v48, v48, v57, v58
    v_fma_f32 v49, v49, v57, v58
    v_fma_f32 v50, v50, v57, v58
    v_fma_f32 v51, v51, v57, v58
    v_accvgpr_write_b32 a136, v48
    v_accvgpr_write_b32 a137, v49
    v_accvgpr_write_b32 a138, v50
    v_accvgpr_write_b32 a139, v51
    v_accvgpr_read_b32 v48, a152
    v_accvgpr_read_b32 v49, a153
    v_accvgpr_read_b32 v50, a154
    v_accvgpr_read_b32 v51, a155
    v_fma_f32 v48, v48, v57, v58
    v_fma_f32 v49, v49, v57, v58
    v_fma_f32 v50, v50, v57, v58
    v_fma_f32 v51, v51, v57, v58
    v_accvgpr_write_b32 a152, v48
    v_accvgpr_write_b32 a153, v49
    v_accvgpr_write_b32 a154, v50
    v_accvgpr_write_b32 a155, v51
    v_accvgpr_read_b32 v48, a168
    v_accvgpr_read_b32 v49, a169
    v_accvgpr_read_b32 v50, a170
    v_accvgpr_read_b32 v51, a171
    v_fma_f32 v48, v48, v57, v58
    v_fma_f32 v49, v49, v57, v58
    v_fma_f32 v50, v50, v57, v58
    v_fma_f32 v51, v51, v57, v58
    v_accvgpr_write_b32 a168, v48
    v_accvgpr_write_b32 a169, v49
    v_accvgpr_write_b32 a170, v50
    v_accvgpr_write_b32 a171, v51
    v_accvgpr_read_b32 v48, a184
    v_accvgpr_read_b32 v49, a185
    v_accvgpr_read_b32 v50, a186
    v_accvgpr_read_b32 v51, a187
    v_fma_f32 v48, v48, v57, v58
    v_fma_f32 v49, v49, v57, v58
    v_fma_f32 v50, v50, v57, v58
    v_fma_f32 v51, v51, v57, v58
    v_accvgpr_write_b32 a184, v48
    v_accvgpr_write_b32 a185, v49
    v_accvgpr_write_b32 a186, v50
    v_accvgpr_write_b32 a187, v51
    v_exp_f32 v48, v84
    v_exp_f32 v49, v85
    v_exp_f32 v50, v86
    v_exp_f32 v51, v87
    v_exp_f32 v52, v116
    v_exp_f32 v53, v117
    v_exp_f32 v54, v118
    v_exp_f32 v55, v119
    s_nop 0
    v_cvt_pk_bf16_f32 v212, v48, v49
    v_cvt_pk_bf16_f32 v213, v50, v51
    v_cvt_pk_bf16_f32 v214, v52, v53
    v_cvt_pk_bf16_f32 v215, v54, v55
    v_add_f32 v26, v48, v49
    v_add_f32 v26, v26, v50
    v_add_f32 v26, v26, v51
    v_add_f32 v26, v26, v52
    v_add_f32 v26, v26, v53
    v_add_f32 v26, v26, v54
    v_add_f32 v26, v26, v55
    v_max3_f32 v56, v92, v93, v94
    v_max3_f32 v56, v56, v95, v124
    v_max3_f32 v56, v56, v125, v126
    v_max3_f32 v56, v56, v127, 0
    v_mov_b32 v58, v56
    s_nop 1
    v_permlane16_swap_b32 v56, v58
    s_nop 1
    v_max_f32 v56, v56, v58
    v_mov_b32 v58, v56
    s_nop 1
    v_permlane32_swap_b32 v56, v58
    s_nop 1
    v_max_f32 v56, v56, v58
    v_exp_f32 v57, -v56
    v_sub_f32 v44, v44, v56
    v_sub_f32 v45, v45, v56
    v_sub_f32 v46, v46, v56
    v_sub_f32 v47, v47, v56
    v_mul_f32 v23, v23, v57
    v_sub_f32 v58, 1.0, v57
    v_sub_f32 v92, v92, v56
    v_sub_f32 v93, v93, v56
    v_sub_f32 v94, v94, v56
    v_sub_f32 v95, v95, v56
    v_sub_f32 v124, v124, v56
    v_sub_f32 v125, v125, v56
    v_sub_f32 v126, v126, v56
    v_sub_f32 v127, v127, v56
    v_sub_f32 v156, v156, v56
    v_sub_f32 v157, v157, v56
    v_sub_f32 v158, v158, v56
    v_sub_f32 v159, v159, v56
    v_sub_f32 v188, v188, v56
    v_sub_f32 v189, v189, v56
    v_sub_f32 v190, v190, v56
    v_sub_f32 v191, v191, v56
    v_accvgpr_read_b32 v48, a12
    v_accvgpr_read_b32 v49, a13
    v_accvgpr_read_b32 v50, a14
    v_accvgpr_read_b32 v51, a15
    v_fma_f32 v48, v48, v57, v58
    v_fma_f32 v49, v49, v57, v58
    v_fma_f32 v50, v50, v57, v58
    v_fma_f32 v51, v51, v57, v58
    v_accvgpr_write_b32 a12, v48
    v_accvgpr_write_b32 a13, v49
    v_accvgpr_write_b32 a14, v50
    v_accvgpr_write_b32 a15, v51
    v_accvgpr_read_b32 v48, a28
    v_accvgpr_read_b32 v49, a29
    v_accvgpr_read_b32 v50, a30
    v_accvgpr_read_b32 v51, a31
    v_fma_f32 v48, v48, v57, v58
    v_fma_f32 v49, v49, v57, v58
    v_fma_f32 v50, v50, v57, v58
    v_fma_f32 v51, v51, v57, v58
    v_accvgpr_write_b32 a28, v48
    v_accvgpr_write_b32 a29, v49
    v_accvgpr_write_b32 a30, v50
    v_accvgpr_write_b32 a31, v51
    v_accvgpr_read_b32 v48, a44
    v_accvgpr_read_b32 v49, a45
    v_accvgpr_read_b32 v50, a46
    v_accvgpr_read_b32 v51, a47
    v_fma_f32 v48, v48, v57, v58
    v_fma_f32 v49, v49, v57, v58
    v_fma_f32 v50, v50, v57, v58
    v_fma_f32 v51, v51, v57, v58
    v_accvgpr_write_b32 a44, v48
    v_accvgpr_write_b32 a45, v49
    v_accvgpr_write_b32 a46, v50
    v_accvgpr_write_b32 a47, v51
    v_accvgpr_read_b32 v48, a60
    v_accvgpr_read_b32 v49, a61
    v_accvgpr_read_b32 v50, a62
    v_accvgpr_read_b32 v51, a63
    v_fma_f32 v48, v48, v57, v58
    v_fma_f32 v49, v49, v57, v58
    v_fma_f32 v50, v50, v57, v58
    v_fma_f32 v51, v51, v57, v58
    v_accvgpr_write_b32 a60, v48
    v_accvgpr_write_b32 a61, v49
    v_accvgpr_write_b32 a62, v50
    v_accvgpr_write_b32 a63, v51
    v_accvgpr_read_b32 v48, a76
    v_accvgpr_read_b32 v49, a77
    v_accvgpr_read_b32 v50, a78
    v_accvgpr_read_b32 v51, a79
    v_fma_f32 v48, v48, v57, v58
    v_fma_f32 v49, v49, v57, v58
    v_fma_f32 v50, v50, v57, v58
    v_fma_f32 v51, v51, v57, v58
    v_accvgpr_write_b32 a76, v48
    v_accvgpr_write_b32 a77, v49
    v_accvgpr_write_b32 a78, v50
    v_accvgpr_write_b32 a79, v51
    v_accvgpr_read_b32 v48, a92
    v_accvgpr_read_b32 v49, a93
    v_accvgpr_read_b32 v50, a94
    v_accvgpr_read_b32 v51, a95
    v_fma_f32 v48, v48, v57, v58
    v_fma_f32 v49, v49, v57, v58
    v_fma_f32 v50, v50, v57, v58
    v_fma_f32 v51, v51, v57, v58
    v_accvgpr_write_b32 a92, v48
    v_accvgpr_write_b32 a93, v49
    v_accvgpr_write_b32 a94, v50
    v_accvgpr_write_b32 a95, v51
    v_accvgpr_read_b32 v48, a108
    v_accvgpr_read_b32 v49, a109
    v_accvgpr_read_b32 v50, a110
    v_accvgpr_read_b32 v51, a111
    v_fma_f32 v48, v48, v57, v58
    v_fma_f32 v49, v49, v57, v58
    v_fma_f32 v50, v50, v57, v58
    v_fma_f32 v51, v51, v57, v58
    v_accvgpr_write_b32 a108, v48
    v_accvgpr_write_b32 a109, v49
    v_accvgpr_write_b32 a110, v50
    v_accvgpr_write_b32 a111, v51
    v_accvgpr_read_b32 v48, a124
    v_accvgpr_read_b32 v49, a125
    v_accvgpr_read_b32 v50, a126
    v_accvgpr_read_b32 v51, a127
    v_fma_f32 v48, v48, v57, v58
    v_fma_f32 v49, v49, v57, v58
    v_fma_f32 v50, v50, v57, v58
    v_fma_f32 v51, v51, v57, v58
    v_accvgpr_write_b32 a124, v48
    v_accvgpr_write_b32 a125, v49
    v_accvgpr_write_b32 a126, v50
    v_accvgpr_write_b32 a127, v51
    v_accvgpr_read_b32 v48, a140
    v_accvgpr_read_b32 v49, a141
    v_accvgpr_read_b32 v50, a142
    v_accvgpr_read_b32 v51, a143
    v_fma_f32 v48, v48, v57, v58
    v_fma_f32 v49, v49, v57, v58
    v_fma_f32 v50, v50, v57, v58
    v_fma_f32 v51, v51, v57, v58
    v_accvgpr_write_b32 a140, v48
    v_accvgpr_write_b32 a141, v49
    v_accvgpr_write_b32 a142, v50
    v_accvgpr_write_b32 a143, v51
    v_accvgpr_read_b32 v48, a156
    v_accvgpr_read_b32 v49, a157
    v_accvgpr_read_b32 v50, a158
    v_accvgpr_read_b32 v51, a159
    v_fma_f32 v48, v48, v57, v58
    v_fma_f32 v49, v49, v57, v58
    v_fma_f32 v50, v50, v57, v58
    v_fma_f32 v51, v51, v57, v58
    v_accvgpr_write_b32 a156, v48
    v_accvgpr_write_b32 a157, v49
    v_accvgpr_write_b32 a158, v50
    v_accvgpr_write_b32 a159, v51
    v_accvgpr_read_b32 v48, a172
    v_accvgpr_read_b32 v49, a173
    v_accvgpr_read_b32 v50, a174
    v_accvgpr_read_b32 v51, a175
    v_fma_f32 v48, v48, v57, v58
    v_fma_f32 v49, v49, v57, v58
    v_fma_f32 v50, v50, v57, v58
    v_fma_f32 v51, v51, v57, v58
    v_accvgpr_write_b32 a172, v48
    v_accvgpr_write_b32 a173, v49
    v_accvgpr_write_b32 a174, v50
    v_accvgpr_write_b32 a175, v51
    v_accvgpr_read_b32 v48, a188
    v_accvgpr_read_b32 v49, a189
    v_accvgpr_read_b32 v50, a190
    v_accvgpr_read_b32 v51, a191
    v_fma_f32 v48, v48, v57, v58
    v_fma_f32 v49, v49, v57, v58
    v_fma_f32 v50, v50, v57, v58
    v_fma_f32 v51, v51, v57, v58
    v_accvgpr_write_b32 a188, v48
    v_accvgpr_write_b32 a189, v49
    v_accvgpr_write_b32 a190, v50
    v_accvgpr_write_b32 a191, v51
    v_exp_f32 v48, v92
    v_exp_f32 v49, v93
    v_exp_f32 v50, v94
    v_exp_f32 v51, v95
    v_exp_f32 v52, v124
    v_exp_f32 v53, v125
    v_exp_f32 v54, v126
    v_exp_f32 v55, v127
    s_nop 0
    v_cvt_pk_bf16_f32 v220, v48, v49
    v_cvt_pk_bf16_f32 v221, v50, v51
    v_cvt_pk_bf16_f32 v222, v52, v53
    v_cvt_pk_bf16_f32 v223, v54, v55
    v_add_f32 v27, v48, v49
    v_add_f32 v27, v27, v50
    v_add_f32 v27, v27, v51
    v_add_f32 v27, v27, v52
    v_add_f32 v27, v27, v53
    v_add_f32 v27, v27, v54
    v_add_f32 v27, v27, v55
    s_nop 1
    s_branch rare_b_ret
rare_e:
    s_nop 7
    s_nop 7
    v_max3_f32 v56, v132, v133, v134
    v_max3_f32 v56, v56, v135, v164
    v_max3_f32 v56, v56, v165, v166
    v_max3_f32 v56, v56, v167, 0
    v_mov_b32 v58, v56
    s_nop 1
    v_permlane16_swap_b32 v56, v58
    s_nop 1
    v_max_f32 v56, v56, v58
    v_mov_b32 v58, v56
    s_nop 1
    v_permlane32_swap_b32 v56, v58
    s_nop 1
    v_max_f32 v56, v56, v58
    v_exp_f32 v57, -v56
    v_sub_f32 v32, v32, v56
    v_sub_f32 v33, v33, v56
    v_sub_f32 v34, v34, v56
    v_sub_f32 v35, v35, v56
    v_mul_f32 v20, v20, v57
    v_sub_f32 v58, 1.0, v57
    v_sub_f32 v132, v132, v56
    v_sub_f32 v133, v133, v56
    v_sub_f32 v134, v134, v56
    v_sub_f32 v135, v135, v56
    v_sub_f32 v164, v164, v56
    v_sub_f32 v165, v165, v56
    v_sub_f32 v166, v166, v56
    v_sub_f32 v167, v167, v56
    v_accvgpr_read_b32 v48, a0
    v_accvgpr_read_b32 v49, a1
    v_accvgpr_read_b32 v50, a2
    v_accvgpr_read_b32 v51, a3
    v_fma_f32 v48, v48, v57, v58
    v_fma_f32 v49, v49, v57, v58
    v_fma_f32 v50, v50, v57, v58
    v_fma_f32 v51, v51, v57, v58
    v_accvgpr_write_b32 a0, v48
    v_accvgpr_write_b32 a1, v49
    v_accvgpr_write_b32 a2, v50
    v_accvgpr_write_b32 a3, v51
    v_accvgpr_read_b32 v48, a16
    v_accvgpr_read_b32 v49, a17
    v_accvgpr_read_b32 v50, a18
    v_accvgpr_read_b32 v51, a19
    v_fma_f32 v48, v48, v57, v58
    v_fma_f32 v49, v49, v57, v58
    v_fma_f32 v50, v50, v57, v58
    v_fma_f32 v51, v51, v57, v58
    v_accvgpr_write_b32 a16, v48
    v_accvgpr_write_b32 a17, v49
    v_accvgpr_write_b32 a18, v50
    v_accvgpr_write_b32 a19, v51
    v_accvgpr_read_b32 v48, a32
    v_accvgpr_read_b32 v49, a33
    v_accvgpr_read_b32 v50, a34
    v_accvgpr_read_b32 v51, a35
    v_fma_f32 v48, v48, v57, v58
    v_fma_f32 v49, v49, v57, v58
    v_fma_f32 v50, v50, v57, v58
    v_fma_f32 v51, v51, v57, v58
    v_accvgpr_write_b32 a32, v48
    v_accvgpr_write_b32 a33, v49
    v_accvgpr_write_b32 a34, v50
    v_accvgpr_write_b32 a35, v51
    v_accvgpr_read_b32 v48, a48
    v_accvgpr_read_b32 v49, a49
    v_accvgpr_read_b32 v50, a50
    v_accvgpr_read_b32 v51, a51
    v_fma_f32 v48, v48, v57, v58
    v_fma_f32 v49, v49, v57, v58
    v_fma_f32 v50, v50, v57, v58
    v_fma_f32 v51, v51, v57, v58
    v_accvgpr_write_b32 a48, v48
    v_accvgpr_write_b32 a49, v49
    v_accvgpr_write_b32 a50, v50
    v_accvgpr_write_b32 a51, v51
    v_accvgpr_read_b32 v48, a64
    v_accvgpr_read_b32 v49, a65
    v_accvgpr_read_b32 v50, a66
    v_accvgpr_read_b32 v51, a67
    v_fma_f32 v48, v48, v57, v58
    v_fma_f32 v49, v49, v57, v58
    v_fma_f32 v50, v50, v57, v58
    v_fma_f32 v51, v51, v57, v58
    v_accvgpr_write_b32 a64, v48
    v_accvgpr_write_b32 a65, v49
    v_accvgpr_write_b32 a66, v50
    v_accvgpr_write_b32 a67, v51
    v_accvgpr_read_b32 v48, a80
    v_accvgpr_read_b32 v49, a81
    v_accvgpr_read_b32 v50, a82
    v_accvgpr_read_b32 v51, a83
    v_fma_f32 v48, v48, v57, v58
    v_fma_f32 v49, v49, v57, v58
    v_fma_f32 v50, v50, v57, v58
    v_fma_f32 v51, v51, v57, v58
    v_accvgpr_write_b32 a80, v48
    v_accvgpr_write_b32 a81, v49
    v_accvgpr_write_b32 a82, v50
    v_accvgpr_write_b32 a83, v51
    v_accvgpr_read_b32 v48, a96
    v_accvgpr_read_b32 v49, a97
    v_accvgpr_read_b32 v50, a98
    v_accvgpr_read_b32 v51, a99
    v_fma_f32 v48, v48, v57, v58
    v_fma_f32 v49, v49, v57, v58
    v_fma_f32 v50, v50, v57, v58
    v_fma_f32 v51, v51, v57, v58
    v_accvgpr_write_b32 a96, v48
    v_accvgpr_write_b32 a97, v49
    v_accvgpr_write_b32 a98, v50
    v_accvgpr_write_b32 a99, v51
    v_accvgpr_read_b32 v48, a112
    v_accvgpr_read_b32 v49, a113
    v_accvgpr_read_b32 v50, a114
    v_accvgpr_read_b32 v51, a115
    v_fma_f32 v48, v48, v57, v58
    v_fma_f32 v49, v49, v57, v58
    v_fma_f32 v50, v50, v57, v58
    v_fma_f32 v51, v51, v57, v58
    v_accvgpr_write_b32 a112, v48
    v_accvgpr_write_b32 a113, v49
    v_accvgpr_write_b32 a114, v50
    v_accvgpr_write_b32 a115, v51
    v_accvgpr_read_b32 v48, a128
    v_accvgpr_read_b32 v49, a129
    v_accvgpr_read_b32 v50, a130
    v_accvgpr_read_b32 v51, a131
    v_fma_f32 v48, v48, v57, v58
    v_fma_f32 v49, v49, v57, v58
    v_fma_f32 v50, v50, v57, v58
    v_fma_f32 v51, v51, v57, v58
    v_accvgpr_write_b32 a128, v48
    v_accvgpr_write_b32 a129, v49
    v_accvgpr_write_b32 a130, v50
    v_accvgpr_write_b32 a131, v51
    v_accvgpr_read_b32 v48, a144
    v_accvgpr_read_b32 v49, a145
    v_accvgpr_read_b32 v50, a146
    v_accvgpr_read_b32 v51, a147
    v_fma_f32 v48, v48, v57, v58
    v_fma_f32 v49, v49, v57, v58
    v_fma_f32 v50, v50, v57, v58
    v_fma_f32 v51, v51, v57, v58
    v_accvgpr_write_b32 a144, v48
    v_accvgpr_write_b32 a145, v49
    v_accvgpr_write_b32 a146, v50
    v_accvgpr_write_b32 a147, v51
    v_accvgpr_read_b32 v48, a160
    v_accvgpr_read_b32 v49, a161
    v_accvgpr_read_b32 v50, a162
    v_accvgpr_read_b32 v51, a163
    v_fma_f32 v48, v48, v57, v58
    v_fma_f32 v49, v49, v57, v58
    v_fma_f32 v50, v50, v57, v58
    v_fma_f32 v51, v51, v57, v58
    v_accvgpr_write_b32 a160, v48
    v_accvgpr_write_b32 a161, v49
    v_accvgpr_write_b32 a162, v50
    v_accvgpr_write_b32 a163, v51
    v_accvgpr_read_b32 v48, a176
    v_accvgpr_read_b32 v49, a177
    v_accvgpr_read_b32 v50, a178
    v_accvgpr_read_b32 v51, a179
    v_fma_f32 v48, v48, v57, v58
    v_fma_f32 v49, v49, v57, v58
    v_fma_f32 v50, v50, v57, v58
    v_fma_f32 v51, v51, v57, v58
    v_accvgpr_write_b32 a176, v48
    v_accvgpr_write_b32 a177, v49
    v_accvgpr_write_b32 a178, v50
    v_accvgpr_write_b32 a179, v51
    v_exp_f32 v48, v132
    v_exp_f32 v49, v133
    v_exp_f32 v50, v134
    v_exp_f32 v51, v135
    v_exp_f32 v52, v164
    v_exp_f32 v53, v165
    v_exp_f32 v54, v166
    v_exp_f32 v55, v167
    s_nop 0
    v_cvt_pk_bf16_f32 v228, v48, v49
    v_cvt_pk_bf16_f32 v229, v50, v51
    v_cvt_pk_bf16_f32 v230, v52, v53
    v_cvt_pk_bf16_f32 v231, v54, v55
    v_add_f32 v24, v48, v49
    v_add_f32 v24, v24, v50
    v_add_f32 v24, v24, v51
    v_add_f32 v24, v24, v52
    v_add_f32 v24, v24, v53
    v_add_f32 v24, v24, v54
    v_add_f32 v24, v24, v55
    v_max3_f32 v56, v140, v141, v142
    v_max3_f32 v56, v56, v143, v172
    v_max3_f32 v56, v56, v173, v174
    v_max3_f32 v56, v56, v175, 0
    v_mov_b32 v58, v56
    s_nop 1
    v_permlane16_swap_b32 v56, v58
    s_nop 1
    v_max_f32 v56, v56, v58
    v_mov_b32 v58, v56
    s_nop 1
    v_permlane32_swap_b32 v56, v58
    s_nop 1
    v_max_f32 v56, v56, v58
    v_exp_f32 v57, -v56
    v_sub_f32 v36, v36, v56
    v_sub_f32 v37, v37, v56
    v_sub_f32 v38, v38, v56
    v_sub_f32 v39, v39, v56
    v_mul_f32 v21, v21, v57
    v_sub_f32 v58, 1.0, v57
    v_sub_f32 v140, v140, v56
    v_sub_f32 v141, v141, v56
    v_sub_f32 v142, v142, v56
    v_sub_f32 v143, v143, v56
    v_sub_f32 v172, v172, v56
    v_sub_f32 v173, v173, v56
    v_sub_f32 v174, v174, v56
    v_sub_f32 v175, v175, v56
    v_accvgpr_read_b32 v48, a4
    v_accvgpr_read_b32 v49, a5
    v_accvgpr_read_b32 v50, a6
    v_accvgpr_read_b32 v51, a7
    v_fma_f32 v48, v48, v57, v58
    v_fma_f32 v49, v49, v57, v58
    v_fma_f32 v50, v50, v57, v58
    v_fma_f32 v51, v51, v57, v58
    v_accvgpr_write_b32 a4, v48
    v_accvgpr_write_b32 a5, v49
    v_accvgpr_write_b32 a6, v50
    v_accvgpr_write_b32 a7, v51
    v_accvgpr_read_b32 v48, a20
    v_accvgpr_read_b32 v49, a21
    v_accvgpr_read_b32 v50, a22
    v_accvgpr_read_b32 v51, a23
    v_fma_f32 v48, v48, v57, v58
    v_fma_f32 v49, v49, v57, v58
    v_fma_f32 v50, v50, v57, v58
    v_fma_f32 v51, v51, v57, v58
    v_accvgpr_write_b32 a20, v48
    v_accvgpr_write_b32 a21, v49
    v_accvgpr_write_b32 a22, v50
    v_accvgpr_write_b32 a23, v51
    v_accvgpr_read_b32 v48, a36
    v_accvgpr_read_b32 v49, a37
    v_accvgpr_read_b32 v50, a38
    v_accvgpr_read_b32 v51, a39
    v_fma_f32 v48, v48, v57, v58
    v_fma_f32 v49, v49, v57, v58
    v_fma_f32 v50, v50, v57, v58
    v_fma_f32 v51, v51, v57, v58
    v_accvgpr_write_b32 a36, v48
    v_accvgpr_write_b32 a37, v49
    v_accvgpr_write_b32 a38, v50
    v_accvgpr_write_b32 a39, v51
    v_accvgpr_read_b32 v48, a52
    v_accvgpr_read_b32 v49, a53
    v_accvgpr_read_b32 v50, a54
    v_accvgpr_read_b32 v51, a55
    v_fma_f32 v48, v48, v57, v58
    v_fma_f32 v49, v49, v57, v58
    v_fma_f32 v50, v50, v57, v58
    v_fma_f32 v51, v51, v57, v58
    v_accvgpr_write_b32 a52, v48
    v_accvgpr_write_b32 a53, v49
    v_accvgpr_write_b32 a54, v50
    v_accvgpr_write_b32 a55, v51
    v_accvgpr_read_b32 v48, a68
    v_accvgpr_read_b32 v49, a69
    v_accvgpr_read_b32 v50, a70
    v_accvgpr_read_b32 v51, a71
    v_fma_f32 v48, v48, v57, v58
    v_fma_f32 v49, v49, v57, v58
    v_fma_f32 v50, v50, v57, v58
    v_fma_f32 v51, v51, v57, v58
    v_accvgpr_write_b32 a68, v48
    v_accvgpr_write_b32 a69, v49
    v_accvgpr_write_b32 a70, v50
    v_accvgpr_write_b32 a71, v51
    v_accvgpr_read_b32 v48, a84
    v_accvgpr_read_b32 v49, a85
    v_accvgpr_read_b32 v50, a86
    v_accvgpr_read_b32 v51, a87
    v_fma_f32 v48, v48, v57, v58
    v_fma_f32 v49, v49, v57, v58
    v_fma_f32 v50, v50, v57, v58
    v_fma_f32 v51, v51, v57, v58
    v_accvgpr_write_b32 a84, v48
    v_accvgpr_write_b32 a85, v49
    v_accvgpr_write_b32 a86, v50
    v_accvgpr_write_b32 a87, v51
    v_accvgpr_read_b32 v48, a100
    v_accvgpr_read_b32 v49, a101
    v_accvgpr_read_b32 v50, a102
    v_accvgpr_read_b32 v51, a103
    v_fma_f32 v48, v48, v57, v58
    v_fma_f32 v49, v49, v57, v58
    v_fma_f32 v50, v50, v57, v58
    v_fma_f32 v51, v51, v57, v58
    v_accvgpr_write_b32 a100, v48
    v_accvgpr_write_b32 a101, v49
    v_accvgpr_write_b32 a102, v50
    v_accvgpr_write_b32 a103, v51
    v_accvgpr_read_b32 v48, a116
    v_accvgpr_read_b32 v49, a117
    v_accvgpr_read_b32 v50, a118
    v_accvgpr_read_b32 v51, a119
    v_fma_f32 v48, v48, v57, v58
    v_fma_f32 v49, v49, v57, v58
    v_fma_f32 v50, v50, v57, v58
    v_fma_f32 v51, v51, v57, v58
    v_accvgpr_write_b32 a116, v48
    v_accvgpr_write_b32 a117, v49
    v_accvgpr_write_b32 a118, v50
    v_accvgpr_write_b32 a119, v51
    v_accvgpr_read_b32 v48, a132
    v_accvgpr_read_b32 v49, a133
    v_accvgpr_read_b32 v50, a134
    v_accvgpr_read_b32 v51, a135
    v_fma_f32 v48, v48, v57, v58
    v_fma_f32 v49, v49, v57, v58
    v_fma_f32 v50, v50, v57, v58
    v_fma_f32 v51, v51, v57, v58
    v_accvgpr_write_b32 a132, v48
    v_accvgpr_write_b32 a133, v49
    v_accvgpr_write_b32 a134, v50
    v_accvgpr_write_b32 a135, v51
    v_accvgpr_read_b32 v48, a148
    v_accvgpr_read_b32 v49, a149
    v_accvgpr_read_b32 v50, a150
    v_accvgpr_read_b32 v51, a151
    v_fma_f32 v48, v48, v57, v58
    v_fma_f32 v49, v49, v57, v58
    v_fma_f32 v50, v50, v57, v58
    v_fma_f32 v51, v51, v57, v58
    v_accvgpr_write_b32 a148, v48
    v_accvgpr_write_b32 a149, v49
    v_accvgpr_write_b32 a150, v50
    v_accvgpr_write_b32 a151, v51
    v_accvgpr_read_b32 v48, a164
    v_accvgpr_read_b32 v49, a165
    v_accvgpr_read_b32 v50, a166
    v_accvgpr_read_b32 v51, a167
    v_fma_f32 v48, v48, v57, v58
    v_fma_f32 v49, v49, v57, v58
    v_fma_f32 v50, v50, v57, v58
    v_fma_f32 v51, v51, v57, v58
    v_accvgpr_write_b32 a164, v48
    v_accvgpr_write_b32 a165, v49
    v_accvgpr_write_b32 a166, v50
    v_accvgpr_write_b32 a167, v51
    v_accvgpr_read_b32 v48, a180
    v_accvgpr_read_b32 v49, a181
    v_accvgpr_read_b32 v50, a182
    v_accvgpr_read_b32 v51, a183
    v_fma_f32 v48, v48, v57, v58
    v_fma_f32 v49, v49, v57, v58
    v_fma_f32 v50, v50, v57, v58
    v_fma_f32 v51, v51, v57, v58
    v_accvgpr_write_b32 a180, v48
    v_accvgpr_write_b32 a181, v49
    v_accvgpr_write_b32 a182, v50
    v_accvgpr_write_b32 a183, v51
    v_exp_f32 v48, v140
    v_exp_f32 v49, v141
    v_exp_f32 v50, v142
    v_exp_f32 v51, v143
    v_exp_f32 v52, v172
    v_exp_f32 v53, v173
    v_exp_f32 v54, v174
    v_exp_f32 v55, v175
    s_nop 0
    v_cvt_pk_bf16_f32 v236, v48, v49
    v_cvt_pk_bf16_f32 v237, v50, v51
    v_cvt_pk_bf16_f32 v238, v52, v53
    v_cvt_pk_bf16_f32 v239, v54, v55
    v_add_f32 v25, v48, v49
    v_add_f32 v25, v25, v50
    v_add_f32 v25, v25, v51
    v_add_f32 v25, v25, v52
    v_add_f32 v25, v25, v53
    v_add_f32 v25, v25, v54
    v_add_f32 v25, v25, v55
    v_max3_f32 v56, v148, v149, v150
    v_max3_f32 v56, v56, v151, v180
    v_max3_f32 v56, v56, v181, v182
    v_max3_f32 v56, v56, v183, 0
    v_mov_b32 v58, v56
    s_nop 1
    v_permlane16_swap_b32 v56, v58
    s_nop 1
    v_max_f32 v56, v56, v58
    v_mov_b32 v58, v56
    s_nop 1
    v_permlane32_swap_b32 v56, v58
    s_nop 1
    v_max_f32 v56, v56, v58
    v_exp_f32 v57, -v56
    v_sub_f32 v40, v40, v56
    v_sub_f32 v41, v41, v56
    v_sub_f32 v42, v42, v56
    v_sub_f32 v43, v43, v56
    v_mul_f32 v22, v22, v57
    v_sub_f32 v58, 1.0, v57
    v_sub_f32 v148, v148, v56
    v_sub_f32 v149, v149, v56
    v_sub_f32 v150, v150, v56
    v_sub_f32 v151, v151, v56
    v_sub_f32 v180, v180, v56
    v_sub_f32 v181, v181, v56
    v_sub_f32 v182, v182, v56
    v_sub_f32 v183, v183, v56
    v_accvgpr_read_b32 v48, a8
    v_accvgpr_read_b32 v49, a9
    v_accvgpr_read_b32 v50, a10
    v_accvgpr_read_b32 v51, a11
    v_fma_f32 v48, v48, v57, v58
    v_fma_f32 v49, v49, v57, v58
    v_fma_f32 v50, v50, v57, v58
    v_fma_f32 v51, v51, v57, v58
    v_accvgpr_write_b32 a8, v48
    v_accvgpr_write_b32 a9, v49
    v_accvgpr_write_b32 a10, v50
    v_accvgpr_write_b32 a11, v51
    v_accvgpr_read_b32 v48, a24
    v_accvgpr_read_b32 v49, a25
    v_accvgpr_read_b32 v50, a26
    v_accvgpr_read_b32 v51, a27
    v_fma_f32 v48, v48, v57, v58
    v_fma_f32 v49, v49, v57, v58
    v_fma_f32 v50, v50, v57, v58
    v_fma_f32 v51, v51, v57, v58
    v_accvgpr_write_b32 a24, v48
    v_accvgpr_write_b32 a25, v49
    v_accvgpr_write_b32 a26, v50
    v_accvgpr_write_b32 a27, v51
    v_accvgpr_read_b32 v48, a40
    v_accvgpr_read_b32 v49, a41
    v_accvgpr_read_b32 v50, a42
    v_accvgpr_read_b32 v51, a43
    v_fma_f32 v48, v48, v57, v58
    v_fma_f32 v49, v49, v57, v58
    v_fma_f32 v50, v50, v57, v58
    v_fma_f32 v51, v51, v57, v58
    v_accvgpr_write_b32 a40, v48
    v_accvgpr_write_b32 a41, v49
    v_accvgpr_write_b32 a42, v50
    v_accvgpr_write_b32 a43, v51
    v_accvgpr_read_b32 v48, a56
    v_accvgpr_read_b32 v49, a57
    v_accvgpr_read_b32 v50, a58
    v_accvgpr_read_b32 v51, a59
    v_fma_f32 v48, v48, v57, v58
    v_fma_f32 v49, v49, v57, v58
    v_fma_f32 v50, v50, v57, v58
    v_fma_f32 v51, v51, v57, v58
    v_accvgpr_write_b32 a56, v48
    v_accvgpr_write_b32 a57, v49
    v_accvgpr_write_b32 a58, v50
    v_accvgpr_write_b32 a59, v51
    v_accvgpr_read_b32 v48, a72
    v_accvgpr_read_b32 v49, a73
    v_accvgpr_read_b32 v50, a74
    v_accvgpr_read_b32 v51, a75
    v_fma_f32 v48, v48, v57, v58
    v_fma_f32 v49, v49, v57, v58
    v_fma_f32 v50, v50, v57, v58
    v_fma_f32 v51, v51, v57, v58
    v_accvgpr_write_b32 a72, v48
    v_accvgpr_write_b32 a73, v49
    v_accvgpr_write_b32 a74, v50
    v_accvgpr_write_b32 a75, v51
    v_accvgpr_read_b32 v48, a88
    v_accvgpr_read_b32 v49, a89
    v_accvgpr_read_b32 v50, a90
    v_accvgpr_read_b32 v51, a91
    v_fma_f32 v48, v48, v57, v58
    v_fma_f32 v49, v49, v57, v58
    v_fma_f32 v50, v50, v57, v58
    v_fma_f32 v51, v51, v57, v58
    v_accvgpr_write_b32 a88, v48
    v_accvgpr_write_b32 a89, v49
    v_accvgpr_write_b32 a90, v50
    v_accvgpr_write_b32 a91, v51
    v_accvgpr_read_b32 v48, a104
    v_accvgpr_read_b32 v49, a105
    v_accvgpr_read_b32 v50, a106
    v_accvgpr_read_b32 v51, a107
    v_fma_f32 v48, v48, v57, v58
    v_fma_f32 v49, v49, v57, v58
    v_fma_f32 v50, v50, v57, v58
    v_fma_f32 v51, v51, v57, v58
    v_accvgpr_write_b32 a104, v48
    v_accvgpr_write_b32 a105, v49
    v_accvgpr_write_b32 a106, v50
    v_accvgpr_write_b32 a107, v51
    v_accvgpr_read_b32 v48, a120
    v_accvgpr_read_b32 v49, a121
    v_accvgpr_read_b32 v50, a122
    v_accvgpr_read_b32 v51, a123
    v_fma_f32 v48, v48, v57, v58
    v_fma_f32 v49, v49, v57, v58
    v_fma_f32 v50, v50, v57, v58
    v_fma_f32 v51, v51, v57, v58
    v_accvgpr_write_b32 a120, v48
    v_accvgpr_write_b32 a121, v49
    v_accvgpr_write_b32 a122, v50
    v_accvgpr_write_b32 a123, v51
    v_accvgpr_read_b32 v48, a136
    v_accvgpr_read_b32 v49, a137
    v_accvgpr_read_b32 v50, a138
    v_accvgpr_read_b32 v51, a139
    v_fma_f32 v48, v48, v57, v58
    v_fma_f32 v49, v49, v57, v58
    v_fma_f32 v50, v50, v57, v58
    v_fma_f32 v51, v51, v57, v58
    v_accvgpr_write_b32 a136, v48
    v_accvgpr_write_b32 a137, v49
    v_accvgpr_write_b32 a138, v50
    v_accvgpr_write_b32 a139, v51
    v_accvgpr_read_b32 v48, a152
    v_accvgpr_read_b32 v49, a153
    v_accvgpr_read_b32 v50, a154
    v_accvgpr_read_b32 v51, a155
    v_fma_f32 v48, v48, v57, v58
    v_fma_f32 v49, v49, v57, v58
    v_fma_f32 v50, v50, v57, v58
    v_fma_f32 v51, v51, v57, v58
    v_accvgpr_write_b32 a152, v48
    v_accvgpr_write_b32 a153, v49
    v_accvgpr_write_b32 a154, v50
    v_accvgpr_write_b32 a155, v51
    v_accvgpr_read_b32 v48, a168
    v_accvgpr_read_b32 v49, a169
    v_accvgpr_read_b32 v50, a170
    v_accvgpr_read_b32 v51, a171
    v_fma_f32 v48, v48, v57, v58
    v_fma_f32 v49, v49, v57, v58
    v_fma_f32 v50, v50, v57, v58
    v_fma_f32 v51, v51, v57, v58
    v_accvgpr_write_b32 a168, v48
    v_accvgpr_write_b32 a169, v49
    v_accvgpr_write_b32 a170, v50
    v_accvgpr_write_b32 a171, v51
    v_accvgpr_read_b32 v48, a184
    v_accvgpr_read_b32 v49, a185
    v_accvgpr_read_b32 v50, a186
    v_accvgpr_read_b32 v51, a187
    v_fma_f32 v48, v48, v57, v58
    v_fma_f32 v49, v49, v57, v58
    v_fma_f32 v50, v50, v57, v58
    v_fma_f32 v51, v51, v57, v58
    v_accvgpr_write_b32 a184, v48
    v_accvgpr_write_b32 a185, v49
    v_accvgpr_write_b32 a186, v50
    v_accvgpr_write_b32 a187, v51
    v_exp_f32 v48, v148
    v_exp_f32 v49, v149
    v_exp_f32 v50, v150
    v_exp_f32 v51, v151
    v_exp_f32 v52, v180
    v_exp_f32 v53, v181
    v_exp_f32 v54, v182
    v_exp_f32 v55, v183
    s_nop 0
    v_cvt_pk_bf16_f32 v244, v48, v49
    v_cvt_pk_bf16_f32 v245, v50, v51
    v_cvt_pk_bf16_f32 v246, v52, v53
    v_cvt_pk_bf16_f32 v247, v54, v55
    v_add_f32 v26, v48, v49
    v_add_f32 v26, v26, v50
    v_add_f32 v26, v26, v51
    v_add_f32 v26, v26, v52
    v_add_f32 v26, v26, v53
    v_add_f32 v26, v26, v54
    v_add_f32 v26, v26, v55
    v_max3_f32 v56, v156, v157, v158
    v_max3_f32 v56, v56, v159, v188
    v_max3_f32 v56, v56, v189, v190
    v_max3_f32 v56, v56, v191, 0
    v_mov_b32 v58, v56
    s_nop 1
    v_permlane16_swap_b32 v56, v58
    s_nop 1
    v_max_f32 v56, v56, v58
    v_mov_b32 v58, v56
    s_nop 1
    v_permlane32_swap_b32 v56, v58
    s_nop 1
    v_max_f32 v56, v56, v58
    v_exp_f32 v57, -v56
    v_sub_f32 v44, v44, v56
    v_sub_f32 v45, v45, v56
    v_sub_f32 v46, v46, v56
    v_sub_f32 v47, v47, v56
    v_mul_f32 v23, v23, v57
    v_sub_f32 v58, 1.0, v57
    v_sub_f32 v156, v156, v56
    v_sub_f32 v157, v157, v56
    v_sub_f32 v158, v158, v56
    v_sub_f32 v159, v159, v56
    v_sub_f32 v188, v188, v56
    v_sub_f32 v189, v189, v56
    v_sub_f32 v190, v190, v56
    v_sub_f32 v191, v191, v56
    v_accvgpr_read_b32 v48, a12
    v_accvgpr_read_b32 v49, a13
    v_accvgpr_read_b32 v50, a14
    v_accvgpr_read_b32 v51, a15
    v_fma_f32 v48, v48, v57, v58
    v_fma_f32 v49, v49, v57, v58
    v_fma_f32 v50, v50, v57, v58
    v_fma_f32 v51, v51, v57, v58
    v_accvgpr_write_b32 a12, v48
    v_accvgpr_write_b32 a13, v49
    v_accvgpr_write_b32 a14, v50
    v_accvgpr_write_b32 a15, v51
    v_accvgpr_read_b32 v48, a28
    v_accvgpr_read_b32 v49, a29
    v_accvgpr_read_b32 v50, a30
    v_accvgpr_read_b32 v51, a31
    v_fma_f32 v48, v48, v57, v58
    v_fma_f32 v49, v49, v57, v58
    v_fma_f32 v50, v50, v57, v58
    v_fma_f32 v51, v51, v57, v58
    v_accvgpr_write_b32 a28, v48
    v_accvgpr_write_b32 a29, v49
    v_accvgpr_write_b32 a30, v50
    v_accvgpr_write_b32 a31, v51
    v_accvgpr_read_b32 v48, a44
    v_accvgpr_read_b32 v49, a45
    v_accvgpr_read_b32 v50, a46
    v_accvgpr_read_b32 v51, a47
    v_fma_f32 v48, v48, v57, v58
    v_fma_f32 v49, v49, v57, v58
    v_fma_f32 v50, v50, v57, v58
    v_fma_f32 v51, v51, v57, v58
    v_accvgpr_write_b32 a44, v48
    v_accvgpr_write_b32 a45, v49
    v_accvgpr_write_b32 a46, v50
    v_accvgpr_write_b32 a47, v51
    v_accvgpr_read_b32 v48, a60
    v_accvgpr_read_b32 v49, a61
    v_accvgpr_read_b32 v50, a62
    v_accvgpr_read_b32 v51, a63
    v_fma_f32 v48, v48, v57, v58
    v_fma_f32 v49, v49, v57, v58
    v_fma_f32 v50, v50, v57, v58
    v_fma_f32 v51, v51, v57, v58
    v_accvgpr_write_b32 a60, v48
    v_accvgpr_write_b32 a61, v49
    v_accvgpr_write_b32 a62, v50
    v_accvgpr_write_b32 a63, v51
    v_accvgpr_read_b32 v48, a76
    v_accvgpr_read_b32 v49, a77
    v_accvgpr_read_b32 v50, a78
    v_accvgpr_read_b32 v51, a79
    v_fma_f32 v48, v48, v57, v58
    v_fma_f32 v49, v49, v57, v58
    v_fma_f32 v50, v50, v57, v58
    v_fma_f32 v51, v51, v57, v58
    v_accvgpr_write_b32 a76, v48
    v_accvgpr_write_b32 a77, v49
    v_accvgpr_write_b32 a78, v50
    v_accvgpr_write_b32 a79, v51
    v_accvgpr_read_b32 v48, a92
    v_accvgpr_read_b32 v49, a93
    v_accvgpr_read_b32 v50, a94
    v_accvgpr_read_b32 v51, a95
    v_fma_f32 v48, v48, v57, v58
    v_fma_f32 v49, v49, v57, v58
    v_fma_f32 v50, v50, v57, v58
    v_fma_f32 v51, v51, v57, v58
    v_accvgpr_write_b32 a92, v48
    v_accvgpr_write_b32 a93, v49
    v_accvgpr_write_b32 a94, v50
    v_accvgpr_write_b32 a95, v51
    v_accvgpr_read_b32 v48, a108
    v_accvgpr_read_b32 v49, a109
    v_accvgpr_read_b32 v50, a110
    v_accvgpr_read_b32 v51, a111
    v_fma_f32 v48, v48, v57, v58
    v_fma_f32 v49, v49, v57, v58
    v_fma_f32 v50, v50, v57, v58
    v_fma_f32 v51, v51, v57, v58
    v_accvgpr_write_b32 a108, v48
    v_accvgpr_write_b32 a109, v49
    v_accvgpr_write_b32 a110, v50
    v_accvgpr_write_b32 a111, v51
    v_accvgpr_read_b32 v48, a124
    v_accvgpr_read_b32 v49, a125
    v_accvgpr_read_b32 v50, a126
    v_accvgpr_read_b32 v51, a127
    v_fma_f32 v48, v48, v57, v58
    v_fma_f32 v49, v49, v57, v58
    v_fma_f32 v50, v50, v57, v58
    v_fma_f32 v51, v51, v57, v58
    v_accvgpr_write_b32 a124, v48
    v_accvgpr_write_b32 a125, v49
    v_accvgpr_write_b32 a126, v50
    v_accvgpr_write_b32 a127, v51
    v_accvgpr_read_b32 v48, a140
    v_accvgpr_read_b32 v49, a141
    v_accvgpr_read_b32 v50, a142
    v_accvgpr_read_b32 v51, a143
    v_fma_f32 v48, v48, v57, v58
    v_fma_f32 v49, v49, v57, v58
    v_fma_f32 v50, v50, v57, v58
    v_fma_f32 v51, v51, v57, v58
    v_accvgpr_write_b32 a140, v48
    v_accvgpr_write_b32 a141, v49
    v_accvgpr_write_b32 a142, v50
    v_accvgpr_write_b32 a143, v51
    v_accvgpr_read_b32 v48, a156
    v_accvgpr_read_b32 v49, a157
    v_accvgpr_read_b32 v50, a158
    v_accvgpr_read_b32 v51, a159
    v_fma_f32 v48, v48, v57, v58
    v_fma_f32 v49, v49, v57, v58
    v_fma_f32 v50, v50, v57, v58
    v_fma_f32 v51, v51, v57, v58
    v_accvgpr_write_b32 a156, v48
    v_accvgpr_write_b32 a157, v49
    v_accvgpr_write_b32 a158, v50
    v_accvgpr_write_b32 a159, v51
    v_accvgpr_read_b32 v48, a172
    v_accvgpr_read_b32 v49, a173
    v_accvgpr_read_b32 v50, a174
    v_accvgpr_read_b32 v51, a175
    v_fma_f32 v48, v48, v57, v58
    v_fma_f32 v49, v49, v57, v58
    v_fma_f32 v50, v50, v57, v58
    v_fma_f32 v51, v51, v57, v58
    v_accvgpr_write_b32 a172, v48
    v_accvgpr_write_b32 a173, v49
    v_accvgpr_write_b32 a174, v50
    v_accvgpr_write_b32 a175, v51
    v_accvgpr_read_b32 v48, a188
    v_accvgpr_read_b32 v49, a189
    v_accvgpr_read_b32 v50, a190
    v_accvgpr_read_b32 v51, a191
    v_fma_f32 v48, v48, v57, v58
    v_fma_f32 v49, v49, v57, v58
    v_fma_f32 v50, v50, v57, v58
    v_fma_f32 v51, v51, v57, v58
    v_accvgpr_write_b32 a188, v48
    v_accvgpr_write_b32 a189, v49
    v_accvgpr_write_b32 a190, v50
    v_accvgpr_write_b32 a191, v51
    v_exp_f32 v48, v156
    v_exp_f32 v49, v157
    v_exp_f32 v50, v158
    v_exp_f32 v51, v159
    v_exp_f32 v52, v188
    v_exp_f32 v53, v189
    v_exp_f32 v54, v190
    v_exp_f32 v55, v191
    s_nop 0
    v_cvt_pk_bf16_f32 v252, v48, v49
    v_cvt_pk_bf16_f32 v253, v50, v51
    v_cvt_pk_bf16_f32 v254, v52, v53
    v_cvt_pk_bf16_f32 v255, v54, v55
    v_add_f32 v27, v48, v49
    v_add_f32 v27, v27, v50
    v_add_f32 v27, v27, v51
    v_add_f32 v27, v27, v52
    v_add_f32 v27, v27, v53
    v_add_f32 v27, v27, v54
    v_add_f32 v27, v27, v55
    s_nop 1
    s_branch rare_e_ret
.section .rodata,"a"
.p2align 6
.amdhsa_kernel recurrent_scan__sliding_block_cached__moe_arch_mod__prompt_kernel
  .amdhsa_next_free_vgpr 512
  .amdhsa_next_free_sgpr 102
  .amdhsa_accum_offset 256
  .amdhsa_group_segment_fixed_size 0
  .amdhsa_kernarg_size 104
  .amdhsa_user_sgpr_count 2
  .amdhsa_user_sgpr_kernarg_segment_ptr 1
  .amdhsa_system_sgpr_workgroup_id_x 1
  .amdhsa_float_denorm_mode_32 3
.end_amdhsa_kernel
```

```asm
; @launch grid=(256,1,1) block=(256,1,1) lds=163840
.amdgcn_target "amdgcn-amd-amdhsa--gfx950"
.text
.globl recurrent_scan__sliding_block_cached__moe_arch_mod__prompt_kernel
.p2align 8
.type recurrent_scan__sliding_block_cached__moe_arch_mod__prompt_kernel,@function
recurrent_scan__sliding_block_cached__moe_arch_mod__prompt_kernel:
    s_cmp_ge_u32 s2, 256
    s_cbranch_scc1 main_end
    s_load_dwordx16 s[64:79], s[0:1], 0
    s_load_dwordx4 s[80:83], s[0:1], 64
    s_load_dwordx2 s[84:85], s[0:1], 80
    s_load_dwordx2 s[86:87], s[0:1], 96
    s_bfe_u32 s30, s2, 0x20003
    s_lshl_b32 s30, s30, 3
    s_lshr_b32 s30, 0x18183060, s30
    s_and_b32 s30, s30, 0xff
    s_load_dwordx2 s[28:29], s[0:1], s30
    s_bfe_u32 s30, s2, 0x10003
    s_bfe_u32 s31, s2, 0x10005
    s_lshl1_add_u32 s30, s30, s31
    s_lshl_b32 s30, s30, 21
    s_bitcmp1_b32 s2, 3
    s_cselect_b32 s31, 0, 0x300000
    s_bitcmp1_b32 s2, 4
    s_cselect_b32 s30, s30, s31
    s_lshr_b32 s56, s2, 3
    s_lshl_b32 s56, s56, 11
    v_lshrrev_b32 v17, 4, v0
    v_lshlrev_b32 v17, 7, v17
    v_add_u32 v17, s56, v17
    s_getpc_b64 s[88:89]
    global_load_dword a220, v17, s[88:89]
    v_lshrrev_b32 v17, 6, v0
    v_lshlrev_b32 v17, 12, v17
    v_and_b32 v1, 63, v0
    v_lshl_add_u32 v17, v1, 4, v17
    v_and_b32 v1, 63, v0
    v_lshrrev_b32 v29, 6, v0
    v_mov_b32 v16, v0
    v_readfirstlane_b32 s3, v29
    s_and_b32 s53, s2, 7
    s_lshr_b32 s52, s2, 5
    s_bfe_u32 s51, s2, 0x20003
    s_lshl_b32 s50, s53, 2
    s_add_u32 s50, s50, s51
    s_lshr_b32 s60, s2, 3
    s_and_b32 s60, s60, 7
    s_xor_b32 s60, s60, s2
    s_lshl_b32 s60, s60, 3
    s_lshl_b32 s56, s3, 1
    s_add_u32 s60, s60, s56
    v_bfe_u32 v240, v1, 2, 1
    v_add_u32 v240, s60, v240
    v_lshrrev_b32 v241, 3, v1
    v_lshlrev_b32 v241, 6, v241
    v_and_b32 v29, 3, v1
    v_lshl_add_u32 v241, v29, 4, v241
    v_mul_u32_u24 v242, 1280, v240
    v_add_u32 v242, v242, v241
    v_lshrrev_b32 v29, 4, v1
    v_lshlrev_b32 v29, 1, v29
    v_and_b32 v7, 7, v1
    v_xor_b32 v7, v7, v29
    v_lshlrev_b32 v7, 4, v7
    v_lshrrev_b32 v29, 5, v1
    v_lshlrev_b32 v29, 3, v29
    v_bfe_u32 v5, v1, 3, 2
    v_add_u32 v5, v5, v29
    v_mul_u32_u24 v2, 12288, v5
    v_add_u32 v2, v2, v7
    v_add_u32 v3, 196608, v2
    s_lshl_b32 s54, s52, 2
    s_add_u32 s54, s54, s3
    s_mul_i32 s49, s3, 6144
    s_lshr_b32 s59, s3, 1
    s_lshl_b32 s59, s59, 5
    s_and_b32 s56, s3, 1
    s_lshl_b32 s56, s56, 2
    s_add_u32 s59, s59, s56
    s_mul_i32 s36, s59, 12288
    s_mov_b32 s37, 786432
    s_add_u32 s45, s51, s52
    s_and_b32 s45, s45, 3
    s_lshl_b32 s45, s45, 2
    s_lshr_b32 s45, 0x5050, s45
    s_and_b32 s45, s45, 15
    s_mul_i32 s56, s45, 786432
    s_add_u32 s36, s36, s56
    s_lshl_b32 s45, s45, 13
    s_lshr_b32 s56, s2, 3
    s_lshl_b32 s56, s56, 8
    v_add_u32 v22, s56, v16
    s_mov_b32 s56, 357913942
    v_mul_hi_u32 v23, s56, v22
    v_mul_u32_u24 v24, 12, v23
    v_sub_u32 v24, v22, v24
    v_mul_u32_u24 v23, 12288, v23
    v_lshl_add_u32 v23, v24, 7, v23
    s_mul_i32 s40, s51, 384
    s_sub_u32 s40, 1572864, s40
    v_lshlrev_b32 v24, 7, v1
    s_mul_i32 s47, s50, 786432
    s_add_u32 s47, s47, 589824
    s_lshl_b32 s48, s52, 13
    s_mul_i32 s56, s50, 384
    s_sub_u32 s57, 7864320, s56
    s_waitcnt lgkmcnt(0)
k_in:
    s_load_dword s4, s[28:29], s30 offset:1024
    s_mov_b32 s12, s64
    s_and_b32 s13, s65, 0xffff
    s_mov_b32 s14, 2621440
    s_mov_b32 s15, 0x00020000
    s_mov_b32 s16, s76
    s_and_b32 s17, s77, 0xffff
    s_mov_b32 s18, 1280
    s_mov_b32 s19, 0x00020000
    buffer_load_dwordx4 v[64:67], v242, s[12:15], 0 offen
    buffer_load_dwordx4 v[68:71], v242, s[12:15], 0 offen offset:512
    buffer_load_dwordx4 v[72:75], v242, s[12:15], 0 offen offset:1024
    v_mov_b32 v25, 3203072
    global_load_dword v26, v25, s[86:87] sc1
    s_lshr_b32 s44, s2, 3
    s_lshl_b32 s44, s44, 7
    s_add_u32 s44, s44, 4784128
    s_load_dword s92, s[86:87], s44 glc
    s_lshr_b32 s58, s2, 4
    s_lshl_b32 s58, s58, 14
    s_and_b32 s44, s2, 15
    s_lshl_b32 s44, s44, 2
    s_add_u32 s44, s44, s3
    s_lshl_b32 s44, s44, 7
    s_add_u32 s58, s58, s44
    s_add_u32 s58, s58, 4456448
    v_and_b32 v27, 31, v1
    v_lshlrev_b32 v27, 2, v27
    v_lshrrev_b32 v25, 5, v1
    v_lshl_add_u32 v27, v25, 13, v27
    v_add_u32 v27, s58, v27
    v_mov_b32 v25, 0
    global_store_dword v27, v25, s[86:87] sc1
    buffer_load_dwordx4 v[76:79], v241, s[16:19], 0 offen offset:0
    buffer_load_dwordx4 v[80:83], v241, s[16:19], 0 offen offset:512
    buffer_load_dwordx4 v[84:87], v241, s[16:19], 0 offen offset:1024
    s_add_u32 s8, s70, s56
    s_addc_u32 s9, s71, 0
    s_and_b32 s9, s9, 0xffff
    s_mov_b32 s10, s57
    s_mov_b32 s11, 0x00020000
    s_add_u32 m0, s49, 49152
    s_nop 0
    buffer_load_dwordx4 v2, s[8:11], s36 offen offset:0 lds
    s_add_u32 m0, s49, 50048
    s_nop 0
    buffer_load_dwordx4 v2, s[8:11], s36 offen offset:128 lds
    s_add_u32 m0, s49, 50944
    s_nop 0
    buffer_load_dwordx4 v2, s[8:11], s36 offen offset:256 lds
    s_add_u32 m0, s49, 52224
    s_nop 0
    buffer_load_dwordx4 v3, s[8:11], s36 offen offset:0 lds
    s_add_u32 m0, s49, 53120
    s_nop 0
    buffer_load_dwordx4 v3, s[8:11], s36 offen offset:128 lds
    s_add_u32 m0, s49, 54016
    s_nop 0
    buffer_load_dwordx4 v3, s[8:11], s36 offen offset:256 lds
    s_add_u32 s36, s36, s37
    s_sub_u32 s55, s36, 7864320
    s_min_u32 s36, s36, s55
    s_mov_b32 s24, s86
    s_and_b32 s25, s87, 0xffff
    s_mov_b32 s26, 268435456
    s_mov_b32 s27, 0x00020000
    s_lshl_b32 s56, s2, 2
    s_add_u32 s56, s56, s3
    s_cmp_lt_u32 s56, 20
    s_cselect_b32 s57, 0, 0x70000000
    s_add_u32 s57, s57, 3670016
    s_lshl_b32 s56, s56, 10
    s_add_u32 s56, s56, s57
    v_mov_b32 v160, 0
    v_mov_b32 v161, 0
    v_mov_b32 v162, 0
    v_mov_b32 v163, 0
    v_lshlrev_b32 v164, 4, v1
    buffer_store_dwordx4 v[160:163], v164, s[24:27], s56 offen sc1
    v_lshrrev_b32 v243, 6, v240
    v_mul_u32_u24 v243, 81920, v243
    v_bfe_u32 v29, v240, 4, 2
    v_lshl_add_u32 v243, v29, 10, v243
    v_and_b32 v29, 15, v240
    v_lshl_add_u32 v243, v29, 6, v243
    v_lshrrev_b32 v29, 3, v1
    v_lshl_add_u32 v243, v29, 12, v243
    v_and_b32 v29, 3, v1
    v_lshl_add_u32 v243, v29, 4, v243
    s_mov_b32 s38, 0x3acccccd
    s_mov_b32 s39, 0x3727c5ac
    s_mov_b32 s41, 0
    s_mov_b32 s42, 32768
    s_mov_b32 s43, 65536
    v_bfe_u32 v29, v1, 2, 3
    v_lshlrev_b32 v12, 7, v29
    v_lshrrev_b32 v29, 1, v29
    v_xor_b32 v29, 0, v29
    v_lshl_add_u32 v12, v29, 5, v12
    v_and_b32 v29, 3, v1
    v_lshl_add_u32 v12, v29, 3, v12
    v_lshrrev_b32 v29, 5, v1
    v_mul_u32_u24 v29, 3072, v29
    v_add_u32 v12, v12, v29
    v_xor_b32 v13, 32, v12
    v_xor_b32 v14, 64, v12
    v_xor_b32 v15, 96, v12
    v_add_u32 v8, 49152, v12
    v_add_u32 v9, 49152, v13
    v_add_u32 v10, 49152, v14
    v_add_u32 v11, 49152, v15
    v_and_b32 v28, 15, v1
    v_lshlrev_b32 v28, 6, v28
    v_lshrrev_b32 v29, 4, v1
    v_lshl_add_u32 v28, v29, 4, v28
    s_mul_i32 s56, s54, 81920
    s_add_u32 s56, s56, 0
    s_add_u32 s20, s86, s56
    s_addc_u32 s21, s87, 0
    s_and_b32 s21, s21, 0xffff
    s_mov_b32 s22, 81920
    s_mov_b32 s23, 0x00020000
    s_lshl_b32 s46, s54, 7
    s_add_u32 s46, s46, 4784128
    s_mov_b32 s101, 0
    s_lshl_b32 s56, s53, 12
    s_add_u32 s46, s46, s56
    s_load_dword s47, s[86:87], s46 glc
    s_lshr_b32 s6, s2, 3
    s_lshl_b32 s6, s6, 7
    s_lshl_b32 s56, s53, 2
    s_add_u32 s6, s6, s56
    s_add_u32 s6, s6, 4784128
    s_cmp_eq_u32 s3, 0
    s_cselect_b32 s6, s6, 0x70000000
    v_lshlrev_b32 v20, 12, v1
    s_mov_b64 exec, 0
pg_ret:
    s_mov_b64 exec, -1
    s_waitcnt vmcnt(12)
x_in:
    v_lshlrev_b32 v96, 16, v64
    v_and_b32 v97, 0xffff0000, v64
    v_lshlrev_b32 v98, 16, v65
    v_and_b32 v99, 0xffff0000, v65
    v_lshlrev_b32 v100, 16, v66
    v_and_b32 v101, 0xffff0000, v66
    v_lshlrev_b32 v102, 16, v67
    v_and_b32 v103, 0xffff0000, v67
    v_lshlrev_b32 v104, 16, v68
    v_and_b32 v105, 0xffff0000, v68
    v_lshlrev_b32 v106, 16, v69
    v_and_b32 v107, 0xffff0000, v69
    v_lshlrev_b32 v108, 16, v70
    v_and_b32 v109, 0xffff0000, v70
    v_lshlrev_b32 v110, 16, v71
    v_and_b32 v111, 0xffff0000, v71
    v_lshlrev_b32 v112, 16, v72
    v_and_b32 v113, 0xffff0000, v72
    v_lshlrev_b32 v114, 16, v73
    v_and_b32 v115, 0xffff0000, v73
    v_lshlrev_b32 v116, 16, v74
    v_and_b32 v117, 0xffff0000, v74
    v_lshlrev_b32 v118, 16, v75
    v_and_b32 v119, 0xffff0000, v75
    v_pk_add_f32 v[120:121], v[96:97], v[98:99]
    v_pk_add_f32 v[122:123], v[100:101], v[102:103]
    v_pk_add_f32 v[120:121], v[120:121], v[104:105]
    v_pk_add_f32 v[122:123], v[122:123], v[106:107]
    v_pk_add_f32 v[120:121], v[120:121], v[108:109]
    v_pk_add_f32 v[122:123], v[122:123], v[110:111]
    s_mov_b32 exec_hi, 0
    v_pk_add_f32 v[120:121], v[120:121], v[112:113]
    v_pk_add_f32 v[122:123], v[122:123], v[114:115]
    v_pk_add_f32 v[120:121], v[120:121], v[116:117]
    v_pk_add_f32 v[122:123], v[122:123], v[118:119]
    s_mov_b64 exec, -1
    v_pk_add_f32 v[120:121], v[120:121], v[122:123]
    v_add_f32 v120, v120, v121
    s_nop 1
    v_add_f32_dpp v120, v120, v120 quad_perm:[1,0,3,2] row_mask:0xf bank_mask:0xf
    s_nop 1
    v_add_f32_dpp v120, v120, v120 quad_perm:[2,3,0,1] row_mask:0xf bank_mask:0xf
    s_nop 1
    v_add_f32_dpp v120, v120, v120 row_ror:8 row_mask:0xf bank_mask:0xf
    v_mov_b32 v124, v120
    s_nop 1
    v_permlane16_swap_b32 v120, v124
    s_nop 1
    v_add_f32 v120, v120, v124
    v_mov_b32 v124, v120
    s_nop 1
    v_permlane32_swap_b32 v120, v124
    s_nop 1
    v_add_f32 v120, v120, v124
    v_mul_f32 v126, s38, v120
    v_mul_f32 v128, s38, -v120
    v_mul_f32 v129, s38, -v120
    v_pk_add_f32 v[132:133], v[96:97], v[128:129]
    v_pk_mul_f32 v[120:121], v[132:133], v[132:133]
    v_pk_add_f32 v[134:135], v[98:99], v[128:129]
    v_pk_mul_f32 v[122:123], v[134:135], v[134:135]
    v_pk_add_f32 v[136:137], v[100:101], v[128:129]
    v_pk_fma_f32 v[120:121], v[136:137], v[136:137], v[120:121]
    v_pk_add_f32 v[138:139], v[102:103], v[128:129]
    v_pk_fma_f32 v[122:123], v[138:139], v[138:139], v[122:123]
    v_pk_add_f32 v[132:133], v[104:105], v[128:129]
    v_pk_fma_f32 v[120:121], v[132:133], v[132:133], v[120:121]
    v_pk_add_f32 v[134:135], v[106:107], v[128:129]
    v_pk_fma_f32 v[122:123], v[134:135], v[134:135], v[122:123]
    v_pk_add_f32 v[136:137], v[108:109], v[128:129]
    v_pk_fma_f32 v[120:121], v[136:137], v[136:137], v[120:121]
    v_pk_add_f32 v[138:139], v[110:111], v[128:129]
    v_pk_fma_f32 v[122:123], v[138:139], v[138:139], v[122:123]
    s_mov_b32 exec_hi, 0
    v_pk_add_f32 v[132:133], v[112:113], v[128:129]
    v_pk_fma_f32 v[120:121], v[132:133], v[132:133], v[120:121]
    v_pk_add_f32 v[134:135], v[114:115], v[128:129]
    v_pk_fma_f32 v[122:123], v[134:135], v[134:135], v[122:123]
    v_pk_add_f32 v[136:137], v[116:117], v[128:129]
    v_pk_fma_f32 v[120:121], v[136:137], v[136:137], v[120:121]
    v_pk_add_f32 v[138:139], v[118:119], v[128:129]
    v_pk_fma_f32 v[122:123], v[138:139], v[138:139], v[122:123]
    s_mov_b64 exec, -1
    v_pk_add_f32 v[120:121], v[120:121], v[122:123]
    v_add_f32 v120, v120, v121
    s_nop 1
    v_add_f32_dpp v120, v120, v120 quad_perm:[1,0,3,2] row_mask:0xf bank_mask:0xf
    s_nop 1
    v_add_f32_dpp v120, v120, v120 quad_perm:[2,3,0,1] row_mask:0xf bank_mask:0xf
    s_nop 1
    v_add_f32_dpp v120, v120, v120 row_ror:8 row_mask:0xf bank_mask:0xf
    v_mov_b32 v124, v120
    s_nop 1
    v_permlane16_swap_b32 v120, v124
    s_nop 1
    v_add_f32 v120, v120, v124
    v_mov_b32 v124, v120
    s_nop 1
    v_permlane32_swap_b32 v120, v124
    s_nop 1
    v_add_f32 v120, v120, v124
    v_mul_f32 v130, s38, v120
    v_cvt_pk_bf16_f32 v126, v126, v126
    v_and_b32 v126, 0xffff0000, v126
    v_cvt_pk_bf16_f32 v130, v130, v130
    v_and_b32 v130, 0xffff0000, v130
    v_add_f32 v130, s39, v130
    v_cvt_pk_bf16_f32 v130, v130, v130
    v_and_b32 v130, 0xffff0000, v130
    v_sqrt_f32 v130, v130
    v_sub_f32 v128, 0, v126
    v_cvt_pk_bf16_f32 v130, v130, v130
    v_and_b32 v130, 0xffff0000, v130
    v_rcp_f32 v127, v130
    v_sub_f32 v129, 0, v126
    v_mul_f32 v120, 0x3dd53b95, v127
    v_mul_f32 v121, 0x3dd53b95, v127
    v_mov_b32 v130, v127
    v_mov_b32 v131, v127
    v_pk_add_f32 v[96:97], v[96:97], v[128:129]
    v_pk_mul_f32 v[132:133], v[96:97], v[120:121]
    v_cvt_pk_bf16_f32 v144, v132, v133
    v_pk_add_f32 v[98:99], v[98:99], v[128:129]
    v_pk_mul_f32 v[134:135], v[98:99], v[120:121]
    v_cvt_pk_bf16_f32 v145, v134, v135
    v_pk_add_f32 v[100:101], v[100:101], v[128:129]
    v_pk_mul_f32 v[136:137], v[100:101], v[120:121]
    v_cvt_pk_bf16_f32 v146, v136, v137
    v_pk_add_f32 v[102:103], v[102:103], v[128:129]
    v_pk_mul_f32 v[138:139], v[102:103], v[120:121]
    v_cvt_pk_bf16_f32 v147, v138, v139
    buffer_store_dwordx4 v[144:147], v243, s[24:27], s41 offen sc1
    v_pk_add_f32 v[104:105], v[104:105], v[128:129]
    v_pk_mul_f32 v[132:133], v[104:105], v[120:121]
    v_cvt_pk_bf16_f32 v148, v132, v133
    v_pk_add_f32 v[106:107], v[106:107], v[128:129]
    v_pk_mul_f32 v[134:135], v[106:107], v[120:121]
    v_cvt_pk_bf16_f32 v149, v134, v135
    v_pk_add_f32 v[108:109], v[108:109], v[128:129]
    v_pk_mul_f32 v[136:137], v[108:109], v[120:121]
    v_cvt_pk_bf16_f32 v150, v136, v137
    v_pk_add_f32 v[110:111], v[110:111], v[128:129]
    v_pk_mul_f32 v[138:139], v[110:111], v[120:121]
    v_cvt_pk_bf16_f32 v151, v138, v139
    buffer_store_dwordx4 v[148:151], v243, s[24:27], s42 offen sc1
    v_pk_add_f32 v[112:113], v[112:113], v[128:129]
    v_pk_mul_f32 v[132:133], v[112:113], v[120:121]
    v_cvt_pk_bf16_f32 v152, v132, v133
    v_pk_add_f32 v[114:115], v[114:115], v[128:129]
    v_pk_mul_f32 v[134:135], v[114:115], v[120:121]
    v_cvt_pk_bf16_f32 v153, v134, v135
    v_pk_add_f32 v[116:117], v[116:117], v[128:129]
    v_pk_mul_f32 v[136:137], v[116:117], v[120:121]
    v_cvt_pk_bf16_f32 v154, v136, v137
    v_pk_add_f32 v[118:119], v[118:119], v[128:129]
    v_pk_mul_f32 v[138:139], v[118:119], v[120:121]
    v_cvt_pk_bf16_f32 v155, v138, v139
    s_mov_b32 exec_hi, 0
    buffer_store_dwordx4 v[152:155], v243, s[24:27], s43 offen sc1
    s_mov_b64 exec, -1
    s_branch pg_start
    .p2align 12
pg_0:
    s_cbranch_execz pg_4
pg_start:
    s_waitcnt vmcnt(10)
    v_readfirstlane_b32 s7, v26
    v_cvt_pk_bf16_f32 v64, v96, v97
    v_lshlrev_b32 v96, 16, v64
    v_and_b32 v97, 0xffff0000, v64
    v_pk_mul_f32 v[96:97], v[96:97], v[130:131]
    v_cvt_pk_bf16_f32 v64, v96, v97
    v_lshlrev_b32 v96, 16, v64
    v_and_b32 v97, 0xffff0000, v64
    v_lshlrev_b32 v132, 16, v76
    v_and_b32 v133, 0xffff0000, v76
    v_pk_mul_f32 v[120:121], v[96:97], v[132:133]
    s_add_u32 m0, s49, 73728
    s_nop 0
    buffer_load_dwordx4 v2, s[8:11], s36 offen offset:0 lds
    s_add_u32 m0, s49, 74624
    s_nop 0
    buffer_load_dwordx4 v2, s[8:11], s36 offen offset:128 lds
    v_cvt_pk_bf16_f32 v65, v98, v99
    v_lshlrev_b32 v98, 16, v65
    v_and_b32 v99, 0xffff0000, v65
    v_pk_mul_f32 v[98:99], v[98:99], v[130:131]
    v_cvt_pk_bf16_f32 v65, v98, v99
    v_lshlrev_b32 v98, 16, v65
    v_and_b32 v99, 0xffff0000, v65
    v_lshlrev_b32 v134, 16, v77
    v_and_b32 v135, 0xffff0000, v77
    v_pk_mul_f32 v[122:123], v[98:99], v[134:135]
    s_add_u32 m0, s49, 75520
    s_nop 0
    buffer_load_dwordx4 v2, s[8:11], s36 offen offset:256 lds
    s_add_u32 m0, s49, 76800
    s_nop 0
    buffer_load_dwordx4 v3, s[8:11], s36 offen offset:0 lds
    v_cvt_pk_bf16_f32 v66, v100, v101
    v_lshlrev_b32 v100, 16, v66
    v_and_b32 v101, 0xffff0000, v66
    v_pk_mul_f32 v[100:101], v[100:101], v[130:131]
    v_cvt_pk_bf16_f32 v66, v100, v101
    v_lshlrev_b32 v100, 16, v66
    v_and_b32 v101, 0xffff0000, v66
    v_lshlrev_b32 v136, 16, v78
    v_and_b32 v137, 0xffff0000, v78
    v_pk_fma_f32 v[120:121], v[100:101], v[136:137], v[120:121]
    s_add_u32 m0, s49, 77696
    s_nop 0
    buffer_load_dwordx4 v3, s[8:11], s36 offen offset:128 lds
    s_add_u32 m0, s49, 78592
    s_nop 0
    buffer_load_dwordx4 v3, s[8:11], s36 offen offset:256 lds
    s_add_u32 s36, s36, s37
    s_sub_u32 s55, s36, 7864320
    s_min_u32 s36, s36, s55
    v_cvt_pk_bf16_f32 v67, v102, v103
    v_lshlrev_b32 v102, 16, v67
    v_and_b32 v103, 0xffff0000, v67
    v_pk_mul_f32 v[102:103], v[102:103], v[130:131]
    v_cvt_pk_bf16_f32 v67, v102, v103
    v_lshlrev_b32 v102, 16, v67
    v_and_b32 v103, 0xffff0000, v67
    v_lshlrev_b32 v138, 16, v79
    v_and_b32 v139, 0xffff0000, v79
    v_pk_fma_f32 v[122:123], v[102:103], v[138:139], v[122:123]
    s_add_u32 m0, s49, 98304
    s_nop 0
    buffer_load_dwordx4 v2, s[8:11], s36 offen offset:0 lds
    s_add_u32 m0, s49, 99200
    s_nop 0
    buffer_load_dwordx4 v2, s[8:11], s36 offen offset:128 lds
    v_cvt_pk_bf16_f32 v68, v104, v105
    v_lshlrev_b32 v104, 16, v68
    v_and_b32 v105, 0xffff0000, v68
    v_pk_mul_f32 v[104:105], v[104:105], v[130:131]
    v_cvt_pk_bf16_f32 v68, v104, v105
    v_lshlrev_b32 v104, 16, v68
    v_and_b32 v105, 0xffff0000, v68
    v_lshlrev_b32 v132, 16, v80
    v_and_b32 v133, 0xffff0000, v80
    v_pk_fma_f32 v[120:121], v[104:105], v[132:133], v[120:121]
    s_add_u32 m0, s49, 100096
    s_nop 0
    buffer_load_dwordx4 v2, s[8:11], s36 offen offset:256 lds
    s_add_u32 m0, s49, 101376
    s_nop 0
    buffer_load_dwordx4 v3, s[8:11], s36 offen offset:0 lds
    s_waitcnt vmcnt(10) lgkmcnt(0)
    s_lshr_b32 s7, s7, 4
    s_mul_i32 s7, s7, 0x2c9277b5
    s_add_u32 s7, s7, 0x6c564b05
    s_lshl_b32 s7, s7, 4
    s_barrier
    v_mov_b32 v21, s7
    s_mov_b64 exec, 255
    buffer_store_dword v21, v20, s[24:27], s6 offen sc1
    s_mov_b64 exec, 0x11
    v_lshlrev_b32 v29, 3, v240
    s_mov_b32 s56, 3211264
    buffer_store_dwordx2 v[126:127], v29, s[24:27], s56 offen sc1
    s_mov_b64 exec, -1
    s_mov_b32 s63, -1
    s_lshr_b32 s61, s2, 6
    s_or_b32 s61, s61, s3
    s_cbranch_scc1 race_skip
    s_waitcnt lgkmcnt(0)
    s_mov_b32 s63, -1
    s_load_dword s4, s[86:87], s58 offset:0x2000 glc
    s_load_dword s63, s[86:87], s58 glc
    s_waitcnt lgkmcnt(1)
race_skip:
    v_cvt_pk_bf16_f32 v69, v106, v107
    v_lshlrev_b32 v106, 16, v69
    v_and_b32 v107, 0xffff0000, v69
    v_pk_mul_f32 v[106:107], v[106:107], v[130:131]
    v_cvt_pk_bf16_f32 v69, v106, v107
    v_lshlrev_b32 v106, 16, v69
    v_and_b32 v107, 0xffff0000, v69
    v_lshlrev_b32 v134, 16, v81
    v_and_b32 v135, 0xffff0000, v81
    v_pk_fma_f32 v[122:123], v[106:107], v[134:135], v[122:123]
    s_and_b32 s93, s63, 0x2000
    s_getreg_b32 s61, hwreg(HW_REG_XCC_ID, 2, 1)
    s_mul_i32 s61, s61, 0x6000
    s_lshl_b32 s93, s93, 1
    s_xor_b32 s93, s93, s61
    s_add_u32 m0, s49, 102272
    s_nop 0
    buffer_load_dwordx4 v3, s[8:11], s36 offen offset:128 lds
    s_add_u32 m0, s49, 103168
    s_nop 0
    buffer_load_dwordx4 v3, s[8:11], s36 offen offset:256 lds
    s_add_u32 s36, s36, s37
    s_sub_u32 s55, s36, 7864320
    s_min_u32 s36, s36, s55
    s_mov_b64 exec, -1
    s_add_u32 m0, s49, 122880
    s_nop 0
    buffer_load_dwordx4 v2, s[8:11], s36 offen offset:0 lds
    s_add_u32 m0, s49, 123776
    s_nop 0
    buffer_load_dwordx4 v2, s[8:11], s36 offen offset:128 lds
    s_add_u32 m0, s49, 124672
    s_nop 0
    buffer_load_dwordx4 v2, s[8:11], s36 offen offset:256 lds
    s_add_u32 m0, s49, 125952
    s_nop 0
    buffer_load_dwordx4 v3, s[8:11], s36 offen offset:0 lds
    s_add_u32 m0, s49, 126848
    s_nop 0
    buffer_load_dwordx4 v3, s[8:11], s36 offen offset:128 lds
    s_add_u32 m0, s49, 127744
    s_nop 0
    buffer_load_dwordx4 v3, s[8:11], s36 offen offset:256 lds
    s_add_u32 s36, s36, s37
    s_sub_u32 s55, s36, 7864320
    s_min_u32 s36, s36, s55
    s_mov_b64 exec, 0
    s_cmp_eq_u32 s3, 0
    s_cbranch_scc1 pg_0
    s_cmp_eq_u32 s3, 1
    s_cbranch_scc1 pg_1
    s_cmp_eq_u32 s3, 2
    s_cbranch_scc1 pg_2
    s_cmp_eq_u32 s3, 3
    s_cbranch_scc1 pg_3
pg_ret2:
    s_mov_b64 exec, -1
    ds_read_b64_tr_b16 a[192:193], v8 offset:0
    ds_read_b64_tr_b16 a[194:195], v8 offset:6144
    ds_read_b64_tr_b16 a[196:197], v9 offset:0
    ds_read_b64_tr_b16 a[198:199], v9 offset:6144
    ds_read_b64_tr_b16 a[200:201], v10 offset:0
    ds_read_b64_tr_b16 a[202:203], v10 offset:6144
    ds_read_b64_tr_b16 a[204:205], v11 offset:0
    ds_read_b64_tr_b16 a[206:207], v11 offset:6144
spin_ln:
    s_load_dwordx8 s[28:35], s[86:87], s46 glc
    s_add_u32 s101, s101, 1
    s_cmp_gt_u32 s101, 0x2000000
    s_cselect_b32 s57, 0, -1
    s_waitcnt lgkmcnt(0)
    s_xor_b32 s56, s28, s7
    s_xor_b32 s29, s29, s7
    s_or_b32 s56, s56, s29
    s_xor_b32 s30, s30, s7
    s_or_b32 s56, s56, s30
    s_xor_b32 s31, s31, s7
    s_or_b32 s56, s56, s31
    s_xor_b32 s32, s32, s7
    s_or_b32 s56, s56, s32
    s_xor_b32 s33, s33, s7
    s_or_b32 s56, s56, s33
    s_xor_b32 s34, s34, s7
    s_or_b32 s56, s56, s34
    s_xor_b32 s35, s35, s7
    s_or_b32 s56, s56, s35
    s_and_b32 s56, s56, s57
    s_cbranch_scc1 spin_ln
z_skip:
    s_add_u32 s46, s45, 0
    s_sub_u32 s5, s46, 81920
    s_min_u32 s46, s46, s5
    buffer_load_dwordx4 a[0:3], v28, s[20:23], s46 offen offset:0 sc1
    buffer_load_dwordx4 a[4:7], v28, s[20:23], s46 offen offset:1024 sc1
    buffer_load_dwordx4 a[8:11], v28, s[20:23], s46 offen offset:2048 sc1
    buffer_load_dwordx4 a[12:15], v28, s[20:23], s46 offen offset:3072 sc1
    s_add_u32 s46, s45, 4096
    s_sub_u32 s5, s46, 81920
    s_min_u32 s46, s46, s5
    buffer_load_dwordx4 a[16:19], v28, s[20:23], s46 offen offset:0 sc1
    buffer_load_dwordx4 a[20:23], v28, s[20:23], s46 offen offset:1024 sc1
    buffer_load_dwordx4 a[24:27], v28, s[20:23], s46 offen offset:2048 sc1
    buffer_load_dwordx4 a[28:31], v28, s[20:23], s46 offen offset:3072 sc1
    v_cvt_pk_bf16_f32 v70, v108, v109
    v_lshlrev_b32 v108, 16, v70
    v_and_b32 v109, 0xffff0000, v70
    v_pk_mul_f32 v[108:109], v[108:109], v[130:131]
    v_cvt_pk_bf16_f32 v70, v108, v109
    v_lshlrev_b32 v108, 16, v70
    v_and_b32 v109, 0xffff0000, v70
    v_lshlrev_b32 v136, 16, v82
    v_and_b32 v137, 0xffff0000, v82
    v_pk_fma_f32 v[120:121], v[108:109], v[136:137], v[120:121]
    v_cvt_pk_bf16_f32 v71, v110, v111
    v_lshlrev_b32 v110, 16, v71
    v_and_b32 v111, 0xffff0000, v71
    v_pk_mul_f32 v[110:111], v[110:111], v[130:131]
    v_cvt_pk_bf16_f32 v71, v110, v111
    v_lshlrev_b32 v110, 16, v71
    v_and_b32 v111, 0xffff0000, v71
    v_lshlrev_b32 v138, 16, v83
    v_and_b32 v139, 0xffff0000, v83
    v_pk_fma_f32 v[122:123], v[110:111], v[138:139], v[122:123]
    s_mov_b32 exec_hi, 0
    v_cvt_pk_bf16_f32 v72, v112, v113
    v_lshlrev_b32 v112, 16, v72
    v_and_b32 v113, 0xffff0000, v72
    v_pk_mul_f32 v[112:113], v[112:113], v[130:131]
    v_cvt_pk_bf16_f32 v72, v112, v113
    v_lshlrev_b32 v112, 16, v72
    v_and_b32 v113, 0xffff0000, v72
    v_lshlrev_b32 v132, 16, v84
    v_and_b32 v133, 0xffff0000, v84
    v_pk_fma_f32 v[120:121], v[112:113], v[132:133], v[120:121]
    v_cvt_pk_bf16_f32 v73, v114, v115
    v_lshlrev_b32 v114, 16, v73
    v_and_b32 v115, 0xffff0000, v73
    v_pk_mul_f32 v[114:115], v[114:115], v[130:131]
    v_cvt_pk_bf16_f32 v73, v114, v115
    v_lshlrev_b32 v114, 16, v73
    v_and_b32 v115, 0xffff0000, v73
    v_lshlrev_b32 v134, 16, v85
    v_and_b32 v135, 0xffff0000, v85
    v_pk_fma_f32 v[122:123], v[114:115], v[134:135], v[122:123]
    v_cvt_pk_bf16_f32 v74, v116, v117
    v_lshlrev_b32 v116, 16, v74
    v_and_b32 v117, 0xffff0000, v74
    v_pk_mul_f32 v[116:117], v[116:117], v[130:131]
    v_cvt_pk_bf16_f32 v74, v116, v117
    v_lshlrev_b32 v116, 16, v74
    v_and_b32 v117, 0xffff0000, v74
    v_lshlrev_b32 v136, 16, v86
    v_and_b32 v137, 0xffff0000, v86
    v_pk_fma_f32 v[120:121], v[116:117], v[136:137], v[120:121]
    v_cvt_pk_bf16_f32 v75, v118, v119
    v_lshlrev_b32 v118, 16, v75
    v_and_b32 v119, 0xffff0000, v75
    v_pk_mul_f32 v[118:119], v[118:119], v[130:131]
    v_cvt_pk_bf16_f32 v75, v118, v119
    v_lshlrev_b32 v118, 16, v75
    v_and_b32 v119, 0xffff0000, v75
    v_lshlrev_b32 v138, 16, v87
    v_and_b32 v139, 0xffff0000, v87
    v_pk_fma_f32 v[122:123], v[118:119], v[138:139], v[122:123]
    s_mov_b64 exec, -1
    v_pk_add_f32 v[120:121], v[120:121], v[122:123]
    v_add_f32 v120, v120, v121
    s_nop 1
    v_add_f32_dpp v120, v120, v120 quad_perm:[1,0,3,2] row_mask:0xf bank_mask:0xf
    s_nop 1
    v_add_f32_dpp v120, v120, v120 quad_perm:[2,3,0,1] row_mask:0xf bank_mask:0xf
    s_nop 1
    v_add_f32_dpp v120, v120, v120 row_ror:8 row_mask:0xf bank_mask:0xf
    v_mov_b32 v124, v120
    s_nop 1
    v_permlane16_swap_b32 v120, v124
    s_nop 1
    v_add_f32 v120, v120, v124
    v_mov_b32 v124, v120
    s_nop 1
    v_permlane32_swap_b32 v120, v124
    s_nop 1
    v_add_f32 v120, v120, v124
    v_cvt_pk_bf16_f32 v120, v120, v120
    v_and_b32 v120, 0xffff0000, v120
    v_ashrrev_i32 v122, 31, v120
    v_or_b32 v122, 0x80000000, v122
    v_xor_b32 v120, v120, v122
    v_and_b32 v120, 0xffff0000, v120
    v_sub_u32 v122, 2047, v240
    v_or_b32 v120, v120, v122
    s_nop 1
    v_mov_b32_dpp v121, v120 row_ror:4 row_mask:0xf bank_mask:0xf
    v_mov_b32 v122, s7
    v_mov_b32 v123, s93
    s_lshl_b32 s56, s2, 2
    s_add_u32 s56, s56, s3
    s_lshl_b32 s56, s56, 4
    s_add_u32 s56, s56, 3162112
    v_mov_b32 v29, 0
    s_mov_b64 s[74:75], s[66:67]
    s_mul_i32 s57, s50, 786432
    s_add_u32 s57, s57, 688128
    s_cmp_eq_u32 s3, 1
    s_cselect_b64 s[74:75], s[68:69], s[74:75]
    s_cmp_eq_u32 s3, 2
    s_cselect_b64 s[74:75], s[78:79], s[74:75]
    s_cselect_b32 s57, 0, s57
    s_cmp_eq_u32 s3, 3
    s_cselect_b64 s[74:75], s[80:81], s[74:75]
    s_cselect_b32 s57, 0, s57
    s_load_dword s76, s[74:75], s57
    s_mov_b64 s[74:75], s[72:73]
    s_mul_i32 s57, s50, 245760
    s_cmp_eq_u32 s3, 1
    s_cselect_b64 s[74:75], s[82:83], s[74:75]
    s_cselect_b32 s57, 0, s57
    s_mul_i32 s77, s2, 10240
    s_cmp_eq_u32 s3, 2
    s_cselect_b64 s[74:75], s[84:85], s[74:75]
    s_cselect_b32 s57, s77, s57
    s_lshr_b32 s77, s2, 3
    s_lshl_b32 s77, s77, 22
    s_add_u32 s77, s77, 67563520
    s_cmp_eq_u32 s3, 3
    s_cselect_b64 s[74:75], s[86:87], s[74:75]
    s_cselect_b32 s57, s77, s57
    s_load_dword s76, s[74:75], s57
    s_waitcnt vmcnt(4)
    s_mov_b64 exec, 1
    s_waitcnt vmcnt(16)
    buffer_store_dwordx4 v[120:123], v29, s[24:27], s56 offen sc1
    s_mov_b64 exec, -1
head_code:
    v_mfma_f32_16x16x32_bf16 v[64:67], a[192:195], a[0:3], 0
    s_add_u32 s46, s45, 8192
    ds_read_b64_tr_b16 a[208:209], v8 offset:1024
    s_sub_u32 s77, s46, 81920
    v_mfma_f32_16x16x32_bf16 v[68:71], a[196:199], a[0:3], 0
    s_min_u32 s46, s46, s77
    ds_read_b64_tr_b16 a[210:211], v8 offset:7168
    v_mfma_f32_16x16x32_bf16 v[76:79], a[196:199], a[4:7], 0
    buffer_load_dwordx4 a[32:35], v28, s[20:23], s46 offen offset:0 sc1
    v_mfma_f32_16x16x32_bf16 v[72:75], a[192:195], a[4:7], 0
    v_mfma_f32_16x16x32_bf16 v[80:83], a[192:195], a[8:11], 0
    ds_read_b64_tr_b16 a[212:213], v9 offset:1024
    v_mfma_f32_16x16x32_bf16 v[84:87], a[196:199], a[8:11], 0
    ds_read_b64_tr_b16 a[214:215], v9 offset:7168
    v_mfma_f32_16x16x32_bf16 v[92:95], a[196:199], a[12:15], 0
    v_mfma_f32_16x16x32_bf16 v[88:91], a[192:195], a[12:15], 0
    s_waitcnt lgkmcnt(4)
    v_mfma_f32_16x16x32_bf16 v[120:123], a[200:203], a[12:15], 0
    ds_read_b64_tr_b16 a[192:193], v10 offset:1024
    v_mul_u32_u24 v56, 3072, v5
    v_mfma_f32_16x16x32_bf16 v[124:127], a[204:207], a[12:15], 0
    ds_read_b64_tr_b16 a[194:195], v10 offset:7168
    v_add_u32 v56, v56, v7
    v_mfma_f32_16x16x32_bf16 v[116:119], a[204:207], a[8:11], 0
    buffer_load_dwordx4 a[36:39], v28, s[20:23], s46 offen offset:1024 sc1
    v_mfma_f32_16x16x32_bf16 v[112:115], a[200:203], a[8:11], 0
    v_add_u32 v57, 49152, v56
    v_lshrrev_b32 v29, 3, v1
    v_mfma_f32_16x16x32_bf16 v[104:107], a[200:203], a[4:7], 0
    ds_read_b64_tr_b16 a[196:197], v11 offset:1024
    v_mul_u32_u24 v62, 1280, v29
    v_mfma_f32_16x16x32_bf16 v[108:111], a[204:207], a[4:7], 0
    ds_read_b64_tr_b16 a[198:199], v11 offset:7168
    v_add_u32 v62, v62, v7
    v_mfma_f32_16x16x32_bf16 v[100:103], a[204:207], a[0:3], 0
    v_add_u32 v63, 10240, v62
    v_mul_u32_u24 v31, 384, v29
    v_mfma_f32_16x16x32_bf16 v[96:99], a[200:203], a[0:3], 0
    s_waitcnt lgkmcnt(4)
    v_add_u32 v6, v31, v7
    v_add_u32 v7, 3072, v6
    v_mfma_f32_16x16x32_bf16 v[128:131], a[208:211], a[0:3], 0
    ds_read_b64_tr_b16 a[200:201], v8 offset:2048
    v_bfe_u32 v29, v1, 4, 1
    v_mfma_f32_16x16x32_bf16 v[132:135], a[212:215], a[0:3], 0
    ds_read_b64_tr_b16 a[202:203], v8 offset:8192
    v_bfe_u32 v30, v1, 5, 1
    v_mfma_f32_16x16x32_bf16 v[140:143], a[212:215], a[4:7], 0
    buffer_load_dwordx4 a[40:43], v28, s[20:23], s46 offen offset:2048 sc1
    v_mfma_f32_16x16x32_bf16 v[136:139], a[208:211], a[4:7], 0
    v_lshl_add_u32 v29, v29, 1, v30
    v_and_b32 v30, 7, v1
    v_mfma_f32_16x16x32_bf16 v[144:147], a[208:211], a[8:11], 0
    ds_read_b64_tr_b16 a[204:205], v9 offset:2048
    v_xor_b32 v30, v30, v29
    v_mfma_f32_16x16x32_bf16 v[148:151], a[212:215], a[8:11], 0
    ds_read_b64_tr_b16 a[206:207], v9 offset:8192
    v_lshl_add_u32 v4, v30, 4, v31
    v_mfma_f32_16x16x32_bf16 v[156:159], a[212:215], a[12:15], 0
    buffer_load_dwordx4 a[44:47], v28, s[20:23], s46 offen offset:3072 sc1
    v_mfma_f32_16x16x32_bf16 v[152:155], a[208:211], a[12:15], 0
    s_waitcnt lgkmcnt(4)
    v_xor_b32 v30, 4, v30
    v_lshl_add_u32 v5, v30, 4, v31
    v_mfma_f32_16x16x32_bf16 v[184:187], a[192:195], a[12:15], 0
    s_add_u32 s46, s45, 12288
    ds_read_b64_tr_b16 a[208:209], v10 offset:2048
    v_add_u32 v5, 3072, v5
    v_mfma_f32_16x16x32_bf16 v[188:191], a[196:199], a[12:15], 0
    s_sub_u32 s77, s46, 81920
    ds_read_b64_tr_b16 a[210:211], v10 offset:8192
    v_bfe_u32 v30, v1, 1, 1
    v_mfma_f32_16x16x32_bf16 v[180:183], a[196:199], a[8:11], 0
    s_min_u32 s46, s46, s77
    v_bfe_u32 v31, v1, 2, 1
    v_lshl_add_u32 v30, v30, 1, v31
    v_mfma_f32_16x16x32_bf16 v[176:179], a[192:195], a[8:11], 0
    v_bfe_u32 v31, v1, 3, 1
    v_lshl_add_u32 v30, v31, 2, v30
    v_mfma_f32_16x16x32_bf16 v[168:171], a[192:195], a[4:7], 0
    ds_read_b64_tr_b16 a[212:213], v11 offset:2048
    v_xor_b32 v30, v30, v29
    v_mfma_f32_16x16x32_bf16 v[172:175], a[196:199], a[4:7], 0
    ds_read_b64_tr_b16 a[214:215], v11 offset:8192
    v_lshlrev_b32 v30, 4, v30
    v_mfma_f32_16x16x32_bf16 v[164:167], a[196:199], a[0:3], 0
    buffer_load_dwordx4 a[48:51], v28, s[20:23], s46 offen offset:0 sc1
    v_mfma_f32_16x16x32_bf16 v[160:163], a[192:195], a[0:3], 0
    s_waitcnt lgkmcnt(4)
    v_mul_u32_u24 v31, 3072, v31
    v_and_b32 v29, 7, v1
    v_mfma_f32_16x16x32_bf16 v[192:195], a[200:203], a[0:3], 0
    ds_read_b64_tr_b16 a[192:193], v8 offset:12288
    v_lshl_add_u32 v31, v29, 7, v31
    v_mfma_f32_16x16x32_bf16 v[196:199], a[204:207], a[0:3], 0
    ds_read_b64_tr_b16 a[194:195], v8 offset:18432
    v_subrev_u32 v31, s49, v31
    v_mfma_f32_16x16x32_bf16 v[204:207], a[204:207], a[4:7], 0
    buffer_load_dwordx4 a[52:55], v28, s[20:23], s46 offen offset:1024 sc1
    v_mfma_f32_16x16x32_bf16 v[200:203], a[200:203], a[4:7], 0
    v_add_u32 v18, v31, v30
    v_xor_b32 v30, 64, v30
    v_mfma_f32_16x16x32_bf16 v[208:211], a[200:203], a[8:11], 0
    ds_read_b64_tr_b16 a[196:197], v9 offset:12288
    v_add_u32 v19, v31, v30
    v_mfma_f32_16x16x32_bf16 v[212:215], a[204:207], a[8:11], 0
    s_mul_i32 s56, s50, 786432
    ds_read_b64_tr_b16 a[198:199], v9 offset:18432
    s_add_u32 s56, s56, 589824
    v_mfma_f32_16x16x32_bf16 v[220:223], a[204:207], a[12:15], 0
    s_add_u32 s12, s66, s56
    s_addc_u32 s13, s67, 0
    s_and_b32 s13, s13, 0xffff
    v_mfma_f32_16x16x32_bf16 v[216:219], a[200:203], a[12:15], 0
    s_waitcnt lgkmcnt(4)
    s_mov_b32 s14, 196608
    s_mov_b32 s15, 0x00020000
    v_mfma_f32_16x16x32_bf16 v[248:251], a[208:211], a[12:15], 0
    s_add_u32 s16, s68, s56
    s_addc_u32 s17, s69, 0
    ds_read_b64_tr_b16 a[200:201], v10 offset:12288
    v_mfma_f32_16x16x32_bf16 v[252:255], a[212:215], a[12:15], 0
    s_and_b32 s17, s17, 0xffff
    ds_read_b64_tr_b16 a[202:203], v10 offset:18432
    s_mov_b32 s18, 196608
    v_mfma_f32_16x16x32_bf16 v[244:247], a[212:215], a[8:11], 0
    buffer_load_dwordx4 a[56:59], v28, s[20:23], s46 offen offset:2048 sc1
    v_mfma_f32_16x16x32_bf16 v[240:243], a[208:211], a[8:11], 0
    s_mov_b32 s19, 0x00020000
    s_mov_b32 s28, s78
    s_and_b32 s29, s79, 0xffff
    v_mfma_f32_16x16x32_bf16 v[232:235], a[208:211], a[4:7], 0
    s_mov_b32 s30, 1966080
    ds_read_b64_tr_b16 a[204:205], v11 offset:12288
    s_mov_b32 s31, 0x00020000
    v_mfma_f32_16x16x32_bf16 v[236:239], a[212:215], a[4:7], 0
    s_waitcnt vmcnt(8)
    ds_read_b64_tr_b16 a[206:207], v11 offset:18432
    s_mov_b32 s32, s80
    v_mfma_f32_16x16x32_bf16 v[228:231], a[212:215], a[0:3], 0
    s_and_b32 s33, s81, 0xffff
    s_mov_b32 s34, 1966080
    s_mov_b32 s35, 0x00020000
    v_mfma_f32_16x16x32_bf16 v[224:227], a[208:211], a[0:3], 0
    s_waitcnt lgkmcnt(4)
    s_mov_b32 s5, s58
    s_min_u32 s58, s2, 239
    v_mfma_f32_16x16x32_bf16 v[64:67], a[192:195], a[16:19], v[64:67]
    s_mul_hi_u32 s56, s58, 178956971
    ds_read_b64_tr_b16 a[208:209], v8 offset:13312
    s_mul_i32 s57, s56, 24
    v_mfma_f32_16x16x32_bf16 v[68:71], a[196:199], a[16:19], v[68:71]
    s_sub_u32 s57, s58, s57
    ds_read_b64_tr_b16 a[210:211], v8 offset:19456
    s_lshl_b32 s60, s56, 6
    v_mfma_f32_16x16x32_bf16 v[76:79], a[196:199], a[20:23], v[76:79]
    buffer_load_dwordx4 a[60:63], v28, s[20:23], s46 offen offset:3072 sc1
    v_mfma_f32_16x16x32_bf16 v[72:75], a[192:195], a[20:23], v[72:75]
    s_add_u32 s46, s45, 16384
    s_sub_u32 s77, s46, 81920
    s_min_u32 s46, s46, s77
    v_mfma_f32_16x16x32_bf16 v[80:83], a[192:195], a[24:27], v[80:83]
    s_add_u32 s60, s60, s59
    ds_read_b64_tr_b16 a[212:213], v9 offset:13312
    s_mul_i32 s60, s60, 3072
    v_mfma_f32_16x16x32_bf16 v[84:87], a[196:199], a[24:27], v[84:87]
    s_lshl_b32 s44, s57, 7
    ds_read_b64_tr_b16 a[214:215], v9 offset:19456
    s_add_u32 s60, s60, s44
    v_mfma_f32_16x16x32_bf16 v[92:95], a[196:199], a[28:31], v[92:95]
    buffer_load_dwordx4 a[64:67], v28, s[20:23], s46 offen offset:0 sc1
    v_mfma_f32_16x16x32_bf16 v[88:91], a[192:195], a[28:31], v[88:91]
    s_waitcnt lgkmcnt(4)
    s_lshl_b32 s61, s56, 7
    s_mul_i32 s62, s56, 1536
    v_mfma_f32_16x16x32_bf16 v[120:123], a[200:203], a[28:31], v[120:123]
    s_lshl_b32 s44, s57, 6
    ds_read_b64_tr_b16 a[192:193], v10 offset:13312
    s_add_u32 s62, s62, s44
    v_mfma_f32_16x16x32_bf16 v[124:127], a[204:207], a[28:31], v[124:127]
    s_lshl_b32 s44, s3, 4
    ds_read_b64_tr_b16 a[194:195], v10 offset:19456
    s_add_u32 s62, s62, s44
    v_mfma_f32_16x16x32_bf16 v[116:119], a[204:207], a[24:27], v[116:119]
    s_lshl_b32 s62, s62, 4
    s_add_u32 s62, s62, 3276800
    s_lshl_b32 s4, s2, 8
    v_mfma_f32_16x16x32_bf16 v[112:115], a[200:203], a[24:27], v[112:115]
    s_lshl_b32 s44, s3, 2
    s_add_u32 s4, s4, s44
    s_add_u32 s4, s4, 4718592
    v_mfma_f32_16x16x32_bf16 v[104:107], a[200:203], a[20:23], v[104:107]
    s_mov_b32 s92, 0xbfb8aa3b
    ds_read_b64_tr_b16 a[196:197], v11 offset:13312
    s_lshl_b32 s44, s3, 12
    v_mfma_f32_16x16x32_bf16 v[108:111], a[204:207], a[20:23], v[108:111]
    s_mov_b32 s38, s49
    ds_read_b64_tr_b16 a[198:199], v11 offset:19456
    s_mov_b32 s40, s49
    v_mfma_f32_16x16x32_bf16 v[100:103], a[204:207], a[16:19], v[100:103]
    buffer_load_dwordx4 a[68:71], v28, s[20:23], s46 offen offset:1024 sc1
    v_mfma_f32_16x16x32_bf16 v[96:99], a[200:203], a[16:19], v[96:99]
    s_waitcnt lgkmcnt(4)
    s_mov_b32 s39, 24576
    s_mov_b32 s47, 3162112
    v_mfma_f32_16x16x32_bf16 v[128:131], a[208:211], a[16:19], v[128:131]
    s_mov_b32 s88, 0xaaaaaaaa
    ds_read_b64_tr_b16 a[200:201], v8 offset:14336
    s_mov_b32 s89, 0xaaaaaaaa
    v_mfma_f32_16x16x32_bf16 v[132:135], a[212:215], a[16:19], v[132:135]
    ds_read_b64_tr_b16 a[202:203], v8 offset:20480
    v_mfma_f32_16x16x32_bf16 v[140:143], a[212:215], a[20:23], v[140:143]
    v_add_u32 v8, 73728, v12
    v_mfma_f32_16x16x32_bf16 v[136:139], a[208:211], a[20:23], v[136:139]
    buffer_load_dwordx4 a[72:75], v28, s[20:23], s46 offen offset:2048 sc1
    v_mfma_f32_16x16x32_bf16 v[144:147], a[208:211], a[24:27], v[144:147]
    ds_read_b64_tr_b16 a[204:205], v9 offset:14336
    v_mfma_f32_16x16x32_bf16 v[148:151], a[212:215], a[24:27], v[148:151]
    ds_read_b64_tr_b16 a[206:207], v9 offset:20480
    v_mfma_f32_16x16x32_bf16 v[156:159], a[212:215], a[28:31], v[156:159]
    v_add_u32 v9, 73728, v13
    v_mfma_f32_16x16x32_bf16 v[152:155], a[208:211], a[28:31], v[152:155]
    s_waitcnt lgkmcnt(4)
    v_mfma_f32_16x16x32_bf16 v[184:187], a[192:195], a[28:31], v[184:187]
    ds_read_b64_tr_b16 a[208:209], v10 offset:14336
    v_mfma_f32_16x16x32_bf16 v[188:191], a[196:199], a[28:31], v[188:191]
    ds_read_b64_tr_b16 a[210:211], v10 offset:20480
    v_mfma_f32_16x16x32_bf16 v[180:183], a[196:199], a[24:27], v[180:183]
    buffer_load_dwordx4 a[76:79], v28, s[20:23], s46 offen offset:3072 sc1
    v_mfma_f32_16x16x32_bf16 v[176:179], a[192:195], a[24:27], v[176:179]
    v_add_u32 v10, 73728, v14
    v_mfma_f32_16x16x32_bf16 v[168:171], a[192:195], a[20:23], v[168:171]
    s_add_u32 s46, s45, 20480
    ds_read_b64_tr_b16 a[212:213], v11 offset:14336
    s_sub_u32 s77, s46, 81920
    v_mfma_f32_16x16x32_bf16 v[172:175], a[196:199], a[20:23], v[172:175]
    s_waitcnt vmcnt(35)
    ds_read_b64_tr_b16 a[214:215], v11 offset:20480
    s_min_u32 s46, s46, s77
    v_mfma_f32_16x16x32_bf16 v[164:167], a[196:199], a[16:19], v[164:167]
    s_barrier
    v_mfma_f32_16x16x32_bf16 v[160:163], a[192:195], a[16:19], v[160:163]
    s_waitcnt lgkmcnt(4)
    v_add_u32 v11, 73728, v15
    v_mfma_f32_16x16x32_bf16 v[192:195], a[200:203], a[16:19], v[192:195]
    ds_read_b64_tr_b16 a[192:193], v8 offset:0
    v_mfma_f32_16x16x32_bf16 v[196:199], a[204:207], a[16:19], v[196:199]
    ds_read_b64_tr_b16 a[194:195], v8 offset:6144
    v_mfma_f32_16x16x32_bf16 v[204:207], a[204:207], a[20:23], v[204:207]
    buffer_load_dwordx4 a[80:83], v28, s[20:23], s46 offen offset:0 sc1
    v_mfma_f32_16x16x32_bf16 v[200:203], a[200:203], a[20:23], v[200:203]
    v_mfma_f32_16x16x32_bf16 v[208:211], a[200:203], a[24:27], v[208:211]
    ds_read_b64_tr_b16 a[196:197], v8 offset:12288
    v_mfma_f32_16x16x32_bf16 v[212:215], a[204:207], a[24:27], v[212:215]
    ds_read_b64_tr_b16 a[198:199], v8 offset:18432
    v_mfma_f32_16x16x32_bf16 v[220:223], a[204:207], a[28:31], v[220:223]
    buffer_load_dwordx4 a[84:87], v28, s[20:23], s46 offen offset:1024 sc1
    v_mfma_f32_16x16x32_bf16 v[216:219], a[200:203], a[28:31], v[216:219]
    s_waitcnt lgkmcnt(4)
    v_mfma_f32_16x16x32_bf16 v[248:251], a[208:211], a[28:31], v[248:251]
    ds_read_b64_tr_b16 a[200:201], v9 offset:0
    v_mfma_f32_16x16x32_bf16 v[252:255], a[212:215], a[28:31], v[252:255]
    ds_read_b64_tr_b16 a[202:203], v9 offset:6144
    v_mfma_f32_16x16x32_bf16 v[244:247], a[212:215], a[24:27], v[244:247]
    v_mfma_f32_16x16x32_bf16 v[240:243], a[208:211], a[24:27], v[240:243]
    v_mfma_f32_16x16x32_bf16 v[232:235], a[208:211], a[20:23], v[232:235]
    ds_read_b64_tr_b16 a[204:205], v9 offset:12288
    v_mfma_f32_16x16x32_bf16 v[236:239], a[212:215], a[20:23], v[236:239]
    s_waitcnt vmcnt(10)
    s_waitcnt vmcnt(6)
    ds_read_b64_tr_b16 a[206:207], v9 offset:18432
    v_mfma_f32_16x16x32_bf16 v[228:231], a[212:215], a[16:19], v[228:231]
    buffer_load_dwordx4 a[88:91], v28, s[20:23], s46 offen offset:2048 sc1
    v_mfma_f32_16x16x32_bf16 v[224:227], a[208:211], a[16:19], v[224:227]
    s_waitcnt lgkmcnt(4)
    v_mfma_f32_16x16x32_bf16 v[64:67], a[192:195], a[32:35], v[64:67]
    ds_read_b64_tr_b16 a[208:209], v10 offset:0
    v_mfma_f32_16x16x32_bf16 v[64:67], a[196:199], a[48:51], v[64:67]
    ds_read_b64_tr_b16 a[210:211], v10 offset:6144
    v_mfma_f32_16x16x32_bf16 v[72:75], a[196:199], a[52:55], v[72:75]
    v_mfma_f32_16x16x32_bf16 v[72:75], a[192:195], a[36:39], v[72:75]
    buffer_load_dwordx4 a[92:95], v28, s[20:23], s46 offen offset:3072 sc1
    v_mfma_f32_16x16x32_bf16 v[80:83], a[192:195], a[40:43], v[80:83]
    ds_read_b64_tr_b16 a[212:213], v10 offset:12288
    v_mfma_f32_16x16x32_bf16 v[80:83], a[196:199], a[56:59], v[80:83]
    ds_read_b64_tr_b16 a[214:215], v10 offset:18432
    v_mfma_f32_16x16x32_bf16 v[88:91], a[196:199], a[60:63], v[88:91]
    s_add_u32 s46, s45, 24576
    s_sub_u32 s77, s46, 81920
    s_min_u32 s46, s46, s77
    v_mfma_f32_16x16x32_bf16 v[88:91], a[192:195], a[44:47], v[88:91]
pg_1:
    s_cbranch_execz pg_5
    s_waitcnt lgkmcnt(4)
    v_mfma_f32_16x16x32_bf16 v[92:95], a[200:203], a[44:47], v[92:95]
    ds_read_b64_tr_b16 a[192:193], v11 offset:0
    v_mfma_f32_16x16x32_bf16 v[92:95], a[204:207], a[60:63], v[92:95]
    ds_read_b64_tr_b16 a[194:195], v11 offset:6144
    v_mfma_f32_16x16x32_bf16 v[84:87], a[204:207], a[56:59], v[84:87]
    buffer_load_dwordx4 a[96:99], v28, s[20:23], s46 offen offset:0 sc1
    v_mfma_f32_16x16x32_bf16 v[84:87], a[200:203], a[40:43], v[84:87]
    v_mfma_f32_16x16x32_bf16 v[76:79], a[200:203], a[36:39], v[76:79]
    ds_read_b64_tr_b16 a[196:197], v11 offset:12288
    v_mfma_f32_16x16x32_bf16 v[76:79], a[204:207], a[52:55], v[76:79]
    ds_read_b64_tr_b16 a[198:199], v11 offset:18432
    v_mfma_f32_16x16x32_bf16 v[68:71], a[204:207], a[48:51], v[68:71]
    v_mfma_f32_16x16x32_bf16 v[68:71], a[200:203], a[32:35], v[68:71]
    s_waitcnt lgkmcnt(4)
    v_mfma_f32_16x16x32_bf16 v[96:99], a[208:211], a[32:35], v[96:99]
    ds_read_b64_tr_b16 a[200:201], v8 offset:1024
    v_mfma_f32_16x16x32_bf16 v[96:99], a[212:215], a[48:51], v[96:99]
    ds_read_b64_tr_b16 a[202:203], v8 offset:7168
    v_mfma_f32_16x16x32_bf16 v[104:107], a[212:215], a[52:55], v[104:107]
    buffer_load_dwordx4 a[100:103], v28, s[20:23], s46 offen offset:1024 sc1
    v_mfma_f32_16x16x32_bf16 v[104:107], a[208:211], a[36:39], v[104:107]
    v_mfma_f32_16x16x32_bf16 v[112:115], a[208:211], a[40:43], v[112:115]
    ds_read_b64_tr_b16 a[204:205], v8 offset:13312
    v_mfma_f32_16x16x32_bf16 v[112:115], a[212:215], a[56:59], v[112:115]
    ds_read_b64_tr_b16 a[206:207], v8 offset:19456
    v_mfma_f32_16x16x32_bf16 v[120:123], a[212:215], a[60:63], v[120:123]
    v_mfma_f32_16x16x32_bf16 v[120:123], a[208:211], a[44:47], v[120:123]
    s_waitcnt lgkmcnt(4)
    v_mfma_f32_16x16x32_bf16 v[124:127], a[192:195], a[44:47], v[124:127]
    ds_read_b64_tr_b16 a[208:209], v9 offset:1024
    v_mfma_f32_16x16x32_bf16 v[124:127], a[196:199], a[60:63], v[124:127]
    ds_read_b64_tr_b16 a[210:211], v9 offset:7168
    v_mfma_f32_16x16x32_bf16 v[116:119], a[196:199], a[56:59], v[116:119]
    buffer_load_dwordx4 a[104:107], v28, s[20:23], s46 offen offset:2048 sc1
    v_mfma_f32_16x16x32_bf16 v[116:119], a[192:195], a[40:43], v[116:119]
    v_mfma_f32_16x16x32_bf16 v[108:111], a[192:195], a[36:39], v[108:111]
    ds_read_b64_tr_b16 a[212:213], v9 offset:13312
    v_mfma_f32_16x16x32_bf16 v[108:111], a[196:199], a[52:55], v[108:111]
    ds_read_b64_tr_b16 a[214:215], v9 offset:19456
    v_mfma_f32_16x16x32_bf16 v[100:103], a[196:199], a[48:51], v[100:103]
    buffer_load_dwordx4 a[108:111], v28, s[20:23], s46 offen offset:3072 sc1
    v_mfma_f32_16x16x32_bf16 v[100:103], a[192:195], a[32:35], v[100:103]
    s_waitcnt lgkmcnt(4)
    v_mfma_f32_16x16x32_bf16 v[128:131], a[200:203], a[32:35], v[128:131]
    ds_read_b64_tr_b16 a[192:193], v10 offset:1024
    v_mfma_f32_16x16x32_bf16 v[128:131], a[204:207], a[48:51], v[128:131]
    ds_read_b64_tr_b16 a[194:195], v10 offset:7168
    v_mfma_f32_16x16x32_bf16 v[136:139], a[204:207], a[52:55], v[136:139]
    v_mfma_f32_16x16x32_bf16 v[136:139], a[200:203], a[36:39], v[136:139]
    s_add_u32 m0, s49, 0
    v_mfma_f32_16x16x32_bf16 v[144:147], a[200:203], a[40:43], v[144:147]
    ds_read_b64_tr_b16 a[196:197], v10 offset:13312
    v_mfma_f32_16x16x32_bf16 v[144:147], a[204:207], a[56:59], v[144:147]
    ds_read_b64_tr_b16 a[198:199], v10 offset:19456
    v_mfma_f32_16x16x32_bf16 v[152:155], a[204:207], a[60:63], v[152:155]
    buffer_load_dwordx4 v2, s[8:11], s36 offen offset:0 lds
    v_mfma_f32_16x16x32_bf16 v[152:155], a[200:203], a[44:47], v[152:155]
    s_waitcnt lgkmcnt(4)
    v_mfma_f32_16x16x32_bf16 v[156:159], a[208:211], a[44:47], v[156:159]
    ds_read_b64_tr_b16 a[200:201], v11 offset:1024
    v_mfma_f32_16x16x32_bf16 v[156:159], a[212:215], a[60:63], v[156:159]
    s_add_u32 m0, s49, 896
    ds_read_b64_tr_b16 a[202:203], v11 offset:7168
    v_mfma_f32_16x16x32_bf16 v[148:151], a[212:215], a[56:59], v[148:151]
    buffer_load_dwordx4 v2, s[8:11], s36 offen offset:128 lds
    v_mfma_f32_16x16x32_bf16 v[148:151], a[208:211], a[40:43], v[148:151]
    v_mfma_f32_16x16x32_bf16 v[140:143], a[208:211], a[36:39], v[140:143]
    ds_read_b64_tr_b16 a[204:205], v11 offset:13312
    v_mfma_f32_16x16x32_bf16 v[140:143], a[212:215], a[52:55], v[140:143]
    ds_read_b64_tr_b16 a[206:207], v11 offset:19456
    v_mfma_f32_16x16x32_bf16 v[132:135], a[212:215], a[48:51], v[132:135]
    v_mfma_f32_16x16x32_bf16 v[132:135], a[208:211], a[32:35], v[132:135]
    s_waitcnt lgkmcnt(4)
    v_mfma_f32_16x16x32_bf16 v[160:163], a[192:195], a[32:35], v[160:163]
    s_add_u32 m0, s49, 1792
    ds_read_b64_tr_b16 a[208:209], v8 offset:2048
    v_mfma_f32_16x16x32_bf16 v[160:163], a[196:199], a[48:51], v[160:163]
    ds_read_b64_tr_b16 a[210:211], v8 offset:8192
    v_mfma_f32_16x16x32_bf16 v[168:171], a[196:199], a[52:55], v[168:171]
    buffer_load_dwordx4 v2, s[8:11], s36 offen offset:256 lds
    v_mfma_f32_16x16x32_bf16 v[168:171], a[192:195], a[36:39], v[168:171]
    v_mfma_f32_16x16x32_bf16 v[176:179], a[192:195], a[40:43], v[176:179]
    ds_read_b64_tr_b16 a[212:213], v8 offset:14336
    v_mfma_f32_16x16x32_bf16 v[176:179], a[196:199], a[56:59], v[176:179]
    ds_read_b64_tr_b16 a[214:215], v8 offset:20480
    v_mfma_f32_16x16x32_bf16 v[184:187], a[196:199], a[60:63], v[184:187]
    s_add_u32 m0, s49, 3072
    v_add_u32 v8, 98304, v12
    v_mfma_f32_16x16x32_bf16 v[184:187], a[192:195], a[44:47], v[184:187]
    s_waitcnt lgkmcnt(4)
    v_mfma_f32_16x16x32_bf16 v[188:191], a[200:203], a[44:47], v[188:191]
    ds_read_b64_tr_b16 a[192:193], v9 offset:2048
    v_mfma_f32_16x16x32_bf16 v[188:191], a[204:207], a[60:63], v[188:191]
    ds_read_b64_tr_b16 a[194:195], v9 offset:8192
    v_mfma_f32_16x16x32_bf16 v[180:183], a[204:207], a[56:59], v[180:183]
    buffer_load_dwordx4 v3, s[8:11], s36 offen offset:0 lds
    v_mfma_f32_16x16x32_bf16 v[180:183], a[200:203], a[40:43], v[180:183]
    v_mfma_f32_16x16x32_bf16 v[172:175], a[200:203], a[36:39], v[172:175]
    ds_read_b64_tr_b16 a[196:197], v9 offset:14336
    v_mfma_f32_16x16x32_bf16 v[172:175], a[204:207], a[52:55], v[172:175]
    s_add_u32 m0, s49, 3968
    ds_read_b64_tr_b16 a[198:199], v9 offset:20480
    v_mfma_f32_16x16x32_bf16 v[164:167], a[204:207], a[48:51], v[164:167]
    buffer_load_dwordx4 v3, s[8:11], s36 offen offset:128 lds
    v_mfma_f32_16x16x32_bf16 v[164:167], a[200:203], a[32:35], v[164:167]
    s_waitcnt lgkmcnt(4)
    v_add_u32 v9, 98304, v13
    v_mfma_f32_16x16x32_bf16 v[192:195], a[208:211], a[32:35], v[192:195]
    ds_read_b64_tr_b16 a[200:201], v10 offset:2048
    v_mfma_f32_16x16x32_bf16 v[192:195], a[212:215], a[48:51], v[192:195]
    ds_read_b64_tr_b16 a[202:203], v10 offset:8192
    v_mfma_f32_16x16x32_bf16 v[200:203], a[212:215], a[52:55], v[200:203]
    v_mfma_f32_16x16x32_bf16 v[200:203], a[208:211], a[36:39], v[200:203]
    s_add_u32 m0, s49, 4864
    v_mfma_f32_16x16x32_bf16 v[208:211], a[208:211], a[40:43], v[208:211]
    ds_read_b64_tr_b16 a[204:205], v10 offset:14336
    v_mfma_f32_16x16x32_bf16 v[208:211], a[212:215], a[56:59], v[208:211]
    ds_read_b64_tr_b16 a[206:207], v10 offset:20480
    v_mfma_f32_16x16x32_bf16 v[216:219], a[212:215], a[60:63], v[216:219]
    buffer_load_dwordx4 v3, s[8:11], s36 offen offset:256 lds
    v_mfma_f32_16x16x32_bf16 v[216:219], a[208:211], a[44:47], v[216:219]
    s_waitcnt lgkmcnt(4)
    v_add_u32 v10, 98304, v14
    s_add_u32 s36, s36, s37
    v_mfma_f32_16x16x32_bf16 v[220:223], a[192:195], a[44:47], v[220:223]
    s_sub_u32 s55, s36, 7864320
    ds_read_b64_tr_b16 a[208:209], v11 offset:2048
    s_min_u32 s36, s36, s55
    v_mfma_f32_16x16x32_bf16 v[220:223], a[196:199], a[60:63], v[220:223]
    s_add_u32 s46, s45, 28672
    ds_read_b64_tr_b16 a[210:211], v11 offset:8192
    s_sub_u32 s77, s46, 81920
    v_mfma_f32_16x16x32_bf16 v[212:215], a[196:199], a[56:59], v[212:215]
    s_min_u32 s46, s46, s77
    v_mfma_f32_16x16x32_bf16 v[212:215], a[192:195], a[40:43], v[212:215]
    buffer_load_dwordx4 a[112:115], v28, s[20:23], s46 offen offset:0 sc1
    v_mfma_f32_16x16x32_bf16 v[204:207], a[192:195], a[36:39], v[204:207]
    ds_read_b64_tr_b16 a[212:213], v11 offset:14336
    v_mfma_f32_16x16x32_bf16 v[204:207], a[196:199], a[52:55], v[204:207]
    s_waitcnt vmcnt(42)
    ds_read_b64_tr_b16 a[214:215], v11 offset:20480
    v_mfma_f32_16x16x32_bf16 v[196:199], a[196:199], a[48:51], v[196:199]
    s_barrier
    v_mfma_f32_16x16x32_bf16 v[196:199], a[192:195], a[32:35], v[196:199]
    s_waitcnt lgkmcnt(4)
    v_add_u32 v11, 98304, v15
    v_mfma_f32_16x16x32_bf16 v[224:227], a[200:203], a[32:35], v[224:227]
    ds_read_b64_tr_b16 a[192:193], v8 offset:0
    v_mfma_f32_16x16x32_bf16 v[224:227], a[204:207], a[48:51], v[224:227]
    ds_read_b64_tr_b16 a[194:195], v8 offset:6144
    v_mfma_f32_16x16x32_bf16 v[232:235], a[204:207], a[52:55], v[232:235]
    buffer_load_dwordx4 a[116:119], v28, s[20:23], s46 offen offset:1024 sc1
    v_mfma_f32_16x16x32_bf16 v[232:235], a[200:203], a[36:39], v[232:235]
    v_mfma_f32_16x16x32_bf16 v[240:243], a[200:203], a[40:43], v[240:243]
    ds_read_b64_tr_b16 a[196:197], v8 offset:12288
    v_mov_b32 v23, 0
    v_mfma_f32_16x16x32_bf16 v[240:243], a[204:207], a[56:59], v[240:243]
    ds_read_b64_tr_b16 a[198:199], v8 offset:18432
    v_mfma_f32_16x16x32_bf16 v[248:251], a[204:207], a[60:63], v[248:251]
    buffer_load_dword a218, v23, s[24:27], s4 offen offset:128 sc1
    v_mfma_f32_16x16x32_bf16 v[248:251], a[200:203], a[44:47], v[248:251]
    s_waitcnt lgkmcnt(4)
    v_mfma_f32_16x16x32_bf16 v[252:255], a[208:211], a[44:47], v[252:255]
    ds_read_b64_tr_b16 a[200:201], v9 offset:0
    v_mfma_f32_16x16x32_bf16 v[252:255], a[212:215], a[60:63], v[252:255]
    ds_read_b64_tr_b16 a[202:203], v9 offset:6144
    v_mfma_f32_16x16x32_bf16 v[244:247], a[212:215], a[56:59], v[244:247]
    buffer_load_dwordx4 a[120:123], v28, s[20:23], s46 offen offset:2048 sc1
    v_mfma_f32_16x16x32_bf16 v[244:247], a[208:211], a[40:43], v[244:247]
    v_mfma_f32_16x16x32_bf16 v[236:239], a[208:211], a[36:39], v[236:239]
    ds_read_b64_tr_b16 a[204:205], v9 offset:12288
    v_mfma_f32_16x16x32_bf16 v[236:239], a[212:215], a[52:55], v[236:239]
    s_waitcnt vmcnt(18)
    s_waitcnt vmcnt(14)
    ds_read_b64_tr_b16 a[206:207], v9 offset:18432
    v_mfma_f32_16x16x32_bf16 v[228:231], a[212:215], a[48:51], v[228:231]
    buffer_load_dwordx4 a[124:127], v28, s[20:23], s46 offen offset:3072 sc1
    v_mfma_f32_16x16x32_bf16 v[228:231], a[208:211], a[32:35], v[228:231]
    s_waitcnt lgkmcnt(4)
    v_mfma_f32_16x16x32_bf16 v[64:67], a[192:195], a[64:67], v[64:67]
    ds_read_b64_tr_b16 a[208:209], v10 offset:0
    v_mfma_f32_16x16x32_bf16 v[64:67], a[196:199], a[80:83], v[64:67]
    s_add_u32 s46, s45, 32768
    ds_read_b64_tr_b16 a[210:211], v10 offset:6144
    s_sub_u32 s77, s46, 81920
    v_mfma_f32_16x16x32_bf16 v[72:75], a[196:199], a[84:87], v[72:75]
    s_min_u32 s46, s46, s77
    v_mfma_f32_16x16x32_bf16 v[72:75], a[192:195], a[68:71], v[72:75]
    v_mfma_f32_16x16x32_bf16 v[80:83], a[192:195], a[72:75], v[80:83]
    ds_read_b64_tr_b16 a[212:213], v10 offset:12288
    v_mfma_f32_16x16x32_bf16 v[80:83], a[196:199], a[88:91], v[80:83]
    ds_read_b64_tr_b16 a[214:215], v10 offset:18432
    v_mfma_f32_16x16x32_bf16 v[88:91], a[196:199], a[92:95], v[88:91]
    buffer_load_dwordx4 a[128:131], v28, s[20:23], s46 offen offset:0 sc1
    v_mfma_f32_16x16x32_bf16 v[88:91], a[192:195], a[76:79], v[88:91]
    s_waitcnt lgkmcnt(4)
    v_mfma_f32_16x16x32_bf16 v[92:95], a[200:203], a[76:79], v[92:95]
    ds_read_b64_tr_b16 a[192:193], v11 offset:0
    v_mfma_f32_16x16x32_bf16 v[92:95], a[204:207], a[92:95], v[92:95]
    ds_read_b64_tr_b16 a[194:195], v11 offset:6144
    v_mfma_f32_16x16x32_bf16 v[84:87], a[204:207], a[88:91], v[84:87]
    v_mfma_f32_16x16x32_bf16 v[84:87], a[200:203], a[72:75], v[84:87]
    buffer_load_dwordx4 a[132:135], v28, s[20:23], s46 offen offset:1024 sc1
    v_mfma_f32_16x16x32_bf16 v[76:79], a[200:203], a[68:71], v[76:79]
    ds_read_b64_tr_b16 a[196:197], v11 offset:12288
    v_mfma_f32_16x16x32_bf16 v[76:79], a[204:207], a[84:87], v[76:79]
    ds_read_b64_tr_b16 a[198:199], v11 offset:18432
    v_mfma_f32_16x16x32_bf16 v[68:71], a[204:207], a[80:83], v[68:71]
    v_mfma_f32_16x16x32_bf16 v[68:71], a[200:203], a[64:67], v[68:71]
    s_waitcnt lgkmcnt(4)
    v_mfma_f32_16x16x32_bf16 v[96:99], a[208:211], a[64:67], v[96:99]
    ds_read_b64_tr_b16 a[200:201], v8 offset:1024
    v_mfma_f32_16x16x32_bf16 v[96:99], a[212:215], a[80:83], v[96:99]
    ds_read_b64_tr_b16 a[202:203], v8 offset:7168
    v_mfma_f32_16x16x32_bf16 v[104:107], a[212:215], a[84:87], v[104:107]
    buffer_load_dwordx4 a[136:139], v28, s[20:23], s46 offen offset:2048 sc1
    v_mfma_f32_16x16x32_bf16 v[104:107], a[208:211], a[68:71], v[104:107]
    v_mfma_f32_16x16x32_bf16 v[112:115], a[208:211], a[72:75], v[112:115]
    ds_read_b64_tr_b16 a[204:205], v8 offset:13312
    v_mfma_f32_16x16x32_bf16 v[112:115], a[212:215], a[88:91], v[112:115]
    ds_read_b64_tr_b16 a[206:207], v8 offset:19456
    v_mfma_f32_16x16x32_bf16 v[120:123], a[212:215], a[92:95], v[120:123]
    v_mfma_f32_16x16x32_bf16 v[120:123], a[208:211], a[76:79], v[120:123]
    s_waitcnt lgkmcnt(4)
    v_mfma_f32_16x16x32_bf16 v[124:127], a[192:195], a[76:79], v[124:127]
    ds_read_b64_tr_b16 a[208:209], v9 offset:1024
    v_mfma_f32_16x16x32_bf16 v[124:127], a[196:199], a[92:95], v[124:127]
    ds_read_b64_tr_b16 a[210:211], v9 offset:7168
    v_mfma_f32_16x16x32_bf16 v[116:119], a[196:199], a[88:91], v[116:119]
    buffer_load_dwordx4 a[140:143], v28, s[20:23], s46 offen offset:3072 sc1
    v_mfma_f32_16x16x32_bf16 v[116:119], a[192:195], a[72:75], v[116:119]
    v_mfma_f32_16x16x32_bf16 v[108:111], a[192:195], a[68:71], v[108:111]
    ds_read_b64_tr_b16 a[212:213], v9 offset:13312
    v_mfma_f32_16x16x32_bf16 v[108:111], a[196:199], a[84:87], v[108:111]
    ds_read_b64_tr_b16 a[214:215], v9 offset:19456
    v_mfma_f32_16x16x32_bf16 v[100:103], a[196:199], a[80:83], v[100:103]
    s_add_u32 m0, s49, 24576
    v_mfma_f32_16x16x32_bf16 v[100:103], a[192:195], a[64:67], v[100:103]
    s_waitcnt lgkmcnt(4)
    v_mfma_f32_16x16x32_bf16 v[128:131], a[200:203], a[64:67], v[128:131]
    ds_read_b64_tr_b16 a[192:193], v10 offset:1024
    v_mfma_f32_16x16x32_bf16 v[128:131], a[204:207], a[80:83], v[128:131]
    ds_read_b64_tr_b16 a[194:195], v10 offset:7168
    v_mfma_f32_16x16x32_bf16 v[136:139], a[204:207], a[84:87], v[136:139]
    buffer_load_dwordx4 v2, s[8:11], s36 offen offset:0 lds
    v_mfma_f32_16x16x32_bf16 v[136:139], a[200:203], a[68:71], v[136:139]
    v_mfma_f32_16x16x32_bf16 v[144:147], a[200:203], a[72:75], v[144:147]
    s_add_u32 m0, s49, 25472
    ds_read_b64_tr_b16 a[196:197], v10 offset:13312
    v_mfma_f32_16x16x32_bf16 v[144:147], a[204:207], a[88:91], v[144:147]
    ds_read_b64_tr_b16 a[198:199], v10 offset:19456
    v_mfma_f32_16x16x32_bf16 v[152:155], a[204:207], a[92:95], v[152:155]
    buffer_load_dwordx4 v2, s[8:11], s36 offen offset:128 lds
    v_mfma_f32_16x16x32_bf16 v[152:155], a[200:203], a[76:79], v[152:155]
    s_waitcnt lgkmcnt(4)
    v_mfma_f32_16x16x32_bf16 v[156:159], a[208:211], a[76:79], v[156:159]
    ds_read_b64_tr_b16 a[200:201], v11 offset:1024
    v_mfma_f32_16x16x32_bf16 v[156:159], a[212:215], a[92:95], v[156:159]
    ds_read_b64_tr_b16 a[202:203], v11 offset:7168
    v_mfma_f32_16x16x32_bf16 v[148:151], a[212:215], a[88:91], v[148:151]
    buffer_load_dwordx4 v[32:35], v17, s[24:27], s47 offen offset:0 sc1
    v_mfma_f32_16x16x32_bf16 v[148:151], a[208:211], a[72:75], v[148:151]
    s_add_u32 m0, s49, 26368
    v_mfma_f32_16x16x32_bf16 v[140:143], a[208:211], a[68:71], v[140:143]
    ds_read_b64_tr_b16 a[204:205], v11 offset:13312
    v_mfma_f32_16x16x32_bf16 v[140:143], a[212:215], a[84:87], v[140:143]
    ds_read_b64_tr_b16 a[206:207], v11 offset:19456
    v_mfma_f32_16x16x32_bf16 v[132:135], a[212:215], a[80:83], v[132:135]
    buffer_load_dwordx4 v2, s[8:11], s36 offen offset:256 lds
    v_mfma_f32_16x16x32_bf16 v[132:135], a[208:211], a[64:67], v[132:135]
    s_waitcnt lgkmcnt(4)
    v_mfma_f32_16x16x32_bf16 v[160:163], a[192:195], a[64:67], v[160:163]
    ds_read_b64_tr_b16 a[208:209], v8 offset:2048
    v_mfma_f32_16x16x32_bf16 v[160:163], a[196:199], a[80:83], v[160:163]
    s_add_u32 m0, s49, 27648
    ds_read_b64_tr_b16 a[210:211], v8 offset:8192
    v_mfma_f32_16x16x32_bf16 v[168:171], a[196:199], a[84:87], v[168:171]
    buffer_load_dwordx4 v3, s[8:11], s36 offen offset:0 lds
    v_mfma_f32_16x16x32_bf16 v[168:171], a[192:195], a[68:71], v[168:171]
    v_mfma_f32_16x16x32_bf16 v[176:179], a[192:195], a[72:75], v[176:179]
    ds_read_b64_tr_b16 a[212:213], v8 offset:14336
    v_mfma_f32_16x16x32_bf16 v[176:179], a[196:199], a[88:91], v[176:179]
    ds_read_b64_tr_b16 a[214:215], v8 offset:20480
    v_mfma_f32_16x16x32_bf16 v[184:187], a[196:199], a[92:95], v[184:187]
    buffer_load_dwordx4 v[36:39], v17, s[24:27], s47 offen offset:1024 sc1
    v_mfma_f32_16x16x32_bf16 v[184:187], a[192:195], a[76:79], v[184:187]
    s_waitcnt lgkmcnt(4)
    v_add_u32 v8, 122880, v12
    v_mfma_f32_16x16x32_bf16 v[188:191], a[200:203], a[76:79], v[188:191]
    s_add_u32 m0, s49, 28544
    ds_read_b64_tr_b16 a[192:193], v9 offset:2048
    v_mfma_f32_16x16x32_bf16 v[188:191], a[204:207], a[92:95], v[188:191]
    ds_read_b64_tr_b16 a[194:195], v9 offset:8192
    v_mfma_f32_16x16x32_bf16 v[180:183], a[204:207], a[88:91], v[180:183]
    buffer_load_dwordx4 v3, s[8:11], s36 offen offset:128 lds
    v_mfma_f32_16x16x32_bf16 v[180:183], a[200:203], a[72:75], v[180:183]
    v_mfma_f32_16x16x32_bf16 v[172:175], a[200:203], a[68:71], v[172:175]
    ds_read_b64_tr_b16 a[196:197], v9 offset:14336
    v_mfma_f32_16x16x32_bf16 v[172:175], a[204:207], a[84:87], v[172:175]
    ds_read_b64_tr_b16 a[198:199], v9 offset:20480
    v_mfma_f32_16x16x32_bf16 v[164:167], a[204:207], a[80:83], v[164:167]
    s_add_u32 m0, s49, 29440
    v_add_u32 v9, 122880, v13
    v_mfma_f32_16x16x32_bf16 v[164:167], a[200:203], a[64:67], v[164:167]
    s_waitcnt lgkmcnt(4)
    v_mfma_f32_16x16x32_bf16 v[192:195], a[208:211], a[64:67], v[192:195]
    ds_read_b64_tr_b16 a[200:201], v10 offset:2048
    v_mfma_f32_16x16x32_bf16 v[192:195], a[212:215], a[80:83], v[192:195]
    ds_read_b64_tr_b16 a[202:203], v10 offset:8192
    v_mfma_f32_16x16x32_bf16 v[200:203], a[212:215], a[84:87], v[200:203]
    buffer_load_dwordx4 v3, s[8:11], s36 offen offset:256 lds
    v_mfma_f32_16x16x32_bf16 v[200:203], a[208:211], a[68:71], v[200:203]
    buffer_load_dwordx4 v[40:43], v17, s[24:27], s47 offen offset:2048 sc1
    v_mfma_f32_16x16x32_bf16 v[208:211], a[208:211], a[72:75], v[208:211]
    s_add_u32 s36, s36, s37
    ds_read_b64_tr_b16 a[204:205], v10 offset:14336
    s_sub_u32 s55, s36, 7864320
    v_mfma_f32_16x16x32_bf16 v[208:211], a[212:215], a[88:91], v[208:211]
    s_min_u32 s36, s36, s55
    ds_read_b64_tr_b16 a[206:207], v10 offset:20480
    s_add_u32 s46, s45, 36864
    v_mfma_f32_16x16x32_bf16 v[216:219], a[212:215], a[92:95], v[216:219]
    s_sub_u32 s77, s46, 81920
    v_add_u32 v10, 122880, v14
    s_min_u32 s46, s46, s77
    v_mfma_f32_16x16x32_bf16 v[216:219], a[208:211], a[76:79], v[216:219]
    s_waitcnt lgkmcnt(4)
    v_mfma_f32_16x16x32_bf16 v[220:223], a[192:195], a[76:79], v[220:223]
    ds_read_b64_tr_b16 a[208:209], v11 offset:2048
    v_mfma_f32_16x16x32_bf16 v[220:223], a[196:199], a[92:95], v[220:223]
    ds_read_b64_tr_b16 a[210:211], v11 offset:8192
    v_mfma_f32_16x16x32_bf16 v[212:215], a[196:199], a[88:91], v[212:215]
    buffer_load_dwordx4 a[144:147], v28, s[20:23], s46 offen offset:0 sc1
    v_mfma_f32_16x16x32_bf16 v[212:215], a[192:195], a[72:75], v[212:215]
    v_mfma_f32_16x16x32_bf16 v[204:207], a[192:195], a[68:71], v[204:207]
    ds_read_b64_tr_b16 a[212:213], v11 offset:14336
    v_mfma_f32_16x16x32_bf16 v[204:207], a[196:199], a[84:87], v[204:207]
    s_waitcnt vmcnt(54)
    ds_read_b64_tr_b16 a[214:215], v11 offset:20480
    v_mfma_f32_16x16x32_bf16 v[196:199], a[196:199], a[80:83], v[196:199]
    s_barrier
    v_mfma_f32_16x16x32_bf16 v[196:199], a[192:195], a[64:67], v[196:199]
    s_waitcnt lgkmcnt(4)
    buffer_load_dwordx4 a[148:151], v28, s[20:23], s46 offen offset:1024 sc1
    v_mfma_f32_16x16x32_bf16 v[224:227], a[200:203], a[64:67], v[224:227]
    ds_read_b64_tr_b16 a[192:193], v8 offset:0
    v_add_u32 v11, 122880, v15
    v_mfma_f32_16x16x32_bf16 v[224:227], a[204:207], a[80:83], v[224:227]
    ds_read_b64_tr_b16 a[194:195], v8 offset:6144
    v_mfma_f32_16x16x32_bf16 v[232:235], a[204:207], a[84:87], v[232:235]
    buffer_load_dwordx4 v[44:47], v17, s[24:27], s47 offen offset:3072 sc1
    v_mfma_f32_16x16x32_bf16 v[232:235], a[200:203], a[68:71], v[232:235]
    buffer_load_dwordx4 a[152:155], v28, s[20:23], s46 offen offset:2048 sc1
    v_mfma_f32_16x16x32_bf16 v[240:243], a[200:203], a[72:75], v[240:243]
    ds_read_b64_tr_b16 a[196:197], v8 offset:12288
    v_mfma_f32_16x16x32_bf16 v[240:243], a[204:207], a[88:91], v[240:243]
    ds_read_b64_tr_b16 a[198:199], v8 offset:18432
    v_mfma_f32_16x16x32_bf16 v[248:251], a[204:207], a[92:95], v[248:251]
    v_mfma_f32_16x16x32_bf16 v[248:251], a[200:203], a[76:79], v[248:251]
    s_waitcnt lgkmcnt(4)
    v_mfma_f32_16x16x32_bf16 v[252:255], a[208:211], a[76:79], v[252:255]
    ds_read_b64_tr_b16 a[200:201], v9 offset:0
    v_mfma_f32_16x16x32_bf16 v[252:255], a[212:215], a[92:95], v[252:255]
    ds_read_b64_tr_b16 a[202:203], v9 offset:6144
    v_mfma_f32_16x16x32_bf16 v[244:247], a[212:215], a[88:91], v[244:247]
    buffer_load_dwordx4 a[156:159], v28, s[20:23], s46 offen offset:3072 sc1
    v_mfma_f32_16x16x32_bf16 v[244:247], a[208:211], a[72:75], v[244:247]
    v_mfma_f32_16x16x32_bf16 v[236:239], a[208:211], a[68:71], v[236:239]
    s_add_u32 s46, s45, 40960
    ds_read_b64_tr_b16 a[204:205], v9 offset:12288
    s_sub_u32 s77, s46, 81920
    v_mfma_f32_16x16x32_bf16 v[236:239], a[212:215], a[84:87], v[236:239]
    s_waitcnt vmcnt(29)
    s_waitcnt vmcnt(18)
    ds_read_b64_tr_b16 a[206:207], v9 offset:18432
    v_mfma_f32_16x16x32_bf16 v[228:231], a[212:215], a[80:83], v[228:231]
    s_min_u32 s46, s46, s77
    v_mfma_f32_16x16x32_bf16 v[228:231], a[208:211], a[64:67], v[228:231]
    s_waitcnt lgkmcnt(4)
    v_mfma_f32_16x16x32_bf16 v[64:67], a[192:195], a[96:99], v[64:67]
    ds_read_b64_tr_b16 a[208:209], v10 offset:0
    v_mfma_f32_16x16x32_bf16 v[64:67], a[196:199], a[112:115], v[64:67]
    ds_read_b64_tr_b16 a[210:211], v10 offset:6144
    v_mfma_f32_16x16x32_bf16 v[72:75], a[196:199], a[116:119], v[72:75]
    buffer_load_dwordx4 a[160:163], v28, s[20:23], s46 offen offset:0 sc1
    v_mfma_f32_16x16x32_bf16 v[72:75], a[192:195], a[100:103], v[72:75]
    v_mfma_f32_16x16x32_bf16 v[80:83], a[192:195], a[104:107], v[80:83]
    ds_read_b64_tr_b16 a[212:213], v10 offset:12288
    v_mfma_f32_16x16x32_bf16 v[80:83], a[196:199], a[120:123], v[80:83]
    ds_read_b64_tr_b16 a[214:215], v10 offset:18432
    v_mfma_f32_16x16x32_bf16 v[88:91], a[196:199], a[124:127], v[88:91]
    buffer_load_dwordx4 a[164:167], v28, s[20:23], s46 offen offset:1024 sc1
    v_mfma_f32_16x16x32_bf16 v[88:91], a[192:195], a[108:111], v[88:91]
    s_waitcnt lgkmcnt(4)
    v_mfma_f32_16x16x32_bf16 v[92:95], a[200:203], a[108:111], v[92:95]
    ds_read_b64_tr_b16 a[192:193], v11 offset:0
    v_mfma_f32_16x16x32_bf16 v[92:95], a[204:207], a[124:127], v[92:95]
    ds_read_b64_tr_b16 a[194:195], v11 offset:6144
    v_mfma_f32_16x16x32_bf16 v[84:87], a[204:207], a[120:123], v[84:87]
    v_mfma_f32_16x16x32_bf16 v[84:87], a[200:203], a[104:107], v[84:87]
    v_mfma_f32_16x16x32_bf16 v[76:79], a[200:203], a[100:103], v[76:79]
    ds_read_b64_tr_b16 a[196:197], v11 offset:12288
    v_mfma_f32_16x16x32_bf16 v[76:79], a[204:207], a[116:119], v[76:79]
    ds_read_b64_tr_b16 a[198:199], v11 offset:18432
    v_mfma_f32_16x16x32_bf16 v[68:71], a[204:207], a[112:115], v[68:71]
    buffer_load_dwordx4 a[168:171], v28, s[20:23], s46 offen offset:2048 sc1
    v_mfma_f32_16x16x32_bf16 v[68:71], a[200:203], a[96:99], v[68:71]
    s_waitcnt lgkmcnt(4)
    v_mfma_f32_16x16x32_bf16 v[96:99], a[208:211], a[96:99], v[96:99]
    ds_read_b64_tr_b16 a[200:201], v8 offset:1024
    v_mfma_f32_16x16x32_bf16 v[96:99], a[212:215], a[112:115], v[96:99]
    ds_read_b64_tr_b16 a[202:203], v8 offset:7168
    v_mfma_f32_16x16x32_bf16 v[104:107], a[212:215], a[116:119], v[104:107]
    v_mfma_f32_16x16x32_bf16 v[104:107], a[208:211], a[100:103], v[104:107]
    buffer_load_dwordx4 a[172:175], v28, s[20:23], s46 offen offset:3072 sc1
    v_mfma_f32_16x16x32_bf16 v[112:115], a[208:211], a[104:107], v[112:115]
    ds_read_b64_tr_b16 a[204:205], v8 offset:13312
    v_mfma_f32_16x16x32_bf16 v[112:115], a[212:215], a[120:123], v[112:115]
    ds_read_b64_tr_b16 a[206:207], v8 offset:19456
    v_mfma_f32_16x16x32_bf16 v[120:123], a[212:215], a[124:127], v[120:123]
    v_mfma_f32_16x16x32_bf16 v[120:123], a[208:211], a[108:111], v[120:123]
    s_waitcnt lgkmcnt(4)
    v_mfma_f32_16x16x32_bf16 v[124:127], a[192:195], a[108:111], v[124:127]
    ds_read_b64_tr_b16 a[208:209], v9 offset:1024
    v_mfma_f32_16x16x32_bf16 v[124:127], a[196:199], a[124:127], v[124:127]
    s_add_u32 m0, s49, 49152
    ds_read_b64_tr_b16 a[210:211], v9 offset:7168
    v_mfma_f32_16x16x32_bf16 v[116:119], a[196:199], a[120:123], v[116:119]
    buffer_load_dwordx4 v2, s[8:11], s36 offen offset:0 lds
    v_mfma_f32_16x16x32_bf16 v[116:119], a[192:195], a[104:107], v[116:119]
    v_mfma_f32_16x16x32_bf16 v[108:111], a[192:195], a[100:103], v[108:111]
    ds_read_b64_tr_b16 a[212:213], v9 offset:13312
    v_mfma_f32_16x16x32_bf16 v[108:111], a[196:199], a[116:119], v[108:111]
    ds_read_b64_tr_b16 a[214:215], v9 offset:19456
    v_mfma_f32_16x16x32_bf16 v[100:103], a[196:199], a[112:115], v[100:103]
    v_mfma_f32_16x16x32_bf16 v[100:103], a[192:195], a[96:99], v[100:103]
    s_waitcnt lgkmcnt(4)
    s_add_u32 m0, s49, 50048
    v_mfma_f32_16x16x32_bf16 v[128:131], a[200:203], a[96:99], v[128:131]
    ds_read_b64_tr_b16 a[192:193], v10 offset:1024
    v_mfma_f32_16x16x32_bf16 v[128:131], a[204:207], a[112:115], v[128:131]
    ds_read_b64_tr_b16 a[194:195], v10 offset:7168
    v_mfma_f32_16x16x32_bf16 v[136:139], a[204:207], a[116:119], v[136:139]
    buffer_load_dwordx4 v2, s[8:11], s36 offen offset:128 lds
    v_mfma_f32_16x16x32_bf16 v[136:139], a[200:203], a[100:103], v[136:139]
    v_mfma_f32_16x16x32_bf16 v[144:147], a[200:203], a[104:107], v[144:147]
    ds_read_b64_tr_b16 a[196:197], v10 offset:13312
    v_mfma_f32_16x16x32_bf16 v[144:147], a[204:207], a[120:123], v[144:147]
    ds_read_b64_tr_b16 a[198:199], v10 offset:19456
    v_mfma_f32_16x16x32_bf16 v[152:155], a[204:207], a[124:127], v[152:155]
    s_add_u32 m0, s49, 50944
    v_mfma_f32_16x16x32_bf16 v[152:155], a[200:203], a[108:111], v[152:155]
    s_waitcnt lgkmcnt(4)
    v_mfma_f32_16x16x32_bf16 v[156:159], a[208:211], a[108:111], v[156:159]
    ds_read_b64_tr_b16 a[200:201], v11 offset:1024
    v_mfma_f32_16x16x32_bf16 v[156:159], a[212:215], a[124:127], v[156:159]
    ds_read_b64_tr_b16 a[202:203], v11 offset:7168
    v_mfma_f32_16x16x32_bf16 v[148:151], a[212:215], a[120:123], v[148:151]
    buffer_load_dwordx4 v2, s[8:11], s36 offen offset:256 lds
    v_mfma_f32_16x16x32_bf16 v[148:151], a[208:211], a[104:107], v[148:151]
    v_mfma_f32_16x16x32_bf16 v[140:143], a[208:211], a[100:103], v[140:143]
    s_add_u32 m0, s49, 52224
    ds_read_b64_tr_b16 a[204:205], v11 offset:13312
    v_mfma_f32_16x16x32_bf16 v[140:143], a[212:215], a[116:119], v[140:143]
    ds_read_b64_tr_b16 a[206:207], v11 offset:19456
    v_mfma_f32_16x16x32_bf16 v[132:135], a[212:215], a[112:115], v[132:135]
    buffer_load_dwordx4 v3, s[8:11], s36 offen offset:0 lds
    v_mfma_f32_16x16x32_bf16 v[132:135], a[208:211], a[96:99], v[132:135]
    s_waitcnt lgkmcnt(4)
    v_mfma_f32_16x16x32_bf16 v[160:163], a[192:195], a[96:99], v[160:163]
    ds_read_b64_tr_b16 a[208:209], v8 offset:2048
    v_mfma_f32_16x16x32_bf16 v[160:163], a[196:199], a[112:115], v[160:163]
    ds_read_b64_tr_b16 a[210:211], v8 offset:8192
    v_mfma_f32_16x16x32_bf16 v[168:171], a[196:199], a[116:119], v[168:171]
    v_mfma_f32_16x16x32_bf16 v[168:171], a[192:195], a[100:103], v[168:171]
    s_add_u32 m0, s49, 53120
    v_mfma_f32_16x16x32_bf16 v[176:179], a[192:195], a[104:107], v[176:179]
    ds_read_b64_tr_b16 a[212:213], v8 offset:14336
    v_mfma_f32_16x16x32_bf16 v[176:179], a[196:199], a[120:123], v[176:179]
    ds_read_b64_tr_b16 a[214:215], v8 offset:20480
    v_mfma_f32_16x16x32_bf16 v[184:187], a[196:199], a[124:127], v[184:187]
    buffer_load_dwordx4 v3, s[8:11], s36 offen offset:128 lds
    v_mfma_f32_16x16x32_bf16 v[184:187], a[192:195], a[108:111], v[184:187]
    s_waitcnt lgkmcnt(4)
    v_add_u32 v8, 0, v12
    v_mfma_f32_16x16x32_bf16 v[188:191], a[200:203], a[108:111], v[188:191]
    ds_read_b64_tr_b16 a[192:193], v9 offset:2048
    v_mfma_f32_16x16x32_bf16 v[188:191], a[204:207], a[124:127], v[188:191]
    s_add_u32 m0, s49, 54016
    ds_read_b64_tr_b16 a[194:195], v9 offset:8192
    v_mfma_f32_16x16x32_bf16 v[180:183], a[204:207], a[120:123], v[180:183]
    buffer_load_dwordx4 v3, s[8:11], s36 offen offset:256 lds
    v_mfma_f32_16x16x32_bf16 v[180:183], a[200:203], a[104:107], v[180:183]
    s_add_u32 s36, s36, s37
    s_sub_u32 s55, s36, 7864320
    s_min_u32 s36, s36, s55
    v_mfma_f32_16x16x32_bf16 v[172:175], a[200:203], a[100:103], v[172:175]
    ds_read_b64_tr_b16 a[196:197], v9 offset:14336
    v_mfma_f32_16x16x32_bf16 v[172:175], a[204:207], a[116:119], v[172:175]
    s_add_u32 s46, s45, 45056
    ds_read_b64_tr_b16 a[198:199], v9 offset:20480
    s_sub_u32 s77, s46, 81920
    v_mfma_f32_16x16x32_bf16 v[164:167], a[204:207], a[112:115], v[164:167]
    s_min_u32 s46, s46, s77
    v_add_u32 v9, 0, v13
    v_mfma_f32_16x16x32_bf16 v[164:167], a[200:203], a[96:99], v[164:167]
    s_waitcnt lgkmcnt(4)
    v_mfma_f32_16x16x32_bf16 v[192:195], a[208:211], a[96:99], v[192:195]
    ds_read_b64_tr_b16 a[200:201], v10 offset:2048
    v_mfma_f32_16x16x32_bf16 v[192:195], a[212:215], a[112:115], v[192:195]
    ds_read_b64_tr_b16 a[202:203], v10 offset:8192
    v_mfma_f32_16x16x32_bf16 v[200:203], a[212:215], a[116:119], v[200:203]
    buffer_load_dwordx4 a[176:179], v28, s[20:23], s46 offen offset:0 sc1
    v_mfma_f32_16x16x32_bf16 v[200:203], a[208:211], a[100:103], v[200:203]
    v_mfma_f32_16x16x32_bf16 v[208:211], a[208:211], a[104:107], v[208:211]
    ds_read_b64_tr_b16 a[204:205], v10 offset:14336
    v_mfma_f32_16x16x32_bf16 v[208:211], a[212:215], a[120:123], v[208:211]
    ds_read_b64_tr_b16 a[206:207], v10 offset:20480
    v_mfma_f32_16x16x32_bf16 v[216:219], a[212:215], a[124:127], v[216:219]
    v_add_u32 v10, 0, v14
    v_mfma_f32_16x16x32_bf16 v[216:219], a[208:211], a[108:111], v[216:219]
    s_waitcnt lgkmcnt(4)
    v_mfma_f32_16x16x32_bf16 v[220:223], a[192:195], a[108:111], v[220:223]
    s_waitcnt vmcnt(13)
    ds_read_b64_tr_b16 a[208:209], v11 offset:2048
    v_xor_b32 v34, s7, v34
    v_mfma_f32_16x16x32_bf16 v[220:223], a[196:199], a[124:127], v[220:223]
    ds_read_b64_tr_b16 a[210:211], v11 offset:8192
    v_xor_b32 v38, s7, v38
    v_mfma_f32_16x16x32_bf16 v[212:215], a[196:199], a[120:123], v[212:215]
    buffer_load_dwordx4 a[180:183], v28, s[20:23], s46 offen offset:1024 sc1
    v_mfma_f32_16x16x32_bf16 v[212:215], a[192:195], a[104:107], v[212:215]
    v_xor_b32 v42, s7, v42
    v_xor_b32 v46, s7, v46
    v_mfma_f32_16x16x32_bf16 v[204:207], a[192:195], a[100:103], v[204:207]
    ds_read_b64_tr_b16 a[212:213], v11 offset:14336
    v_or3_b32 v34, v34, v38, v42
    v_mfma_f32_16x16x32_bf16 v[204:207], a[196:199], a[116:119], v[204:207]
    s_waitcnt vmcnt(35)
    ds_read_b64_tr_b16 a[214:215], v11 offset:20480
    v_or_b32 v34, v34, v46
    v_mfma_f32_16x16x32_bf16 v[196:199], a[196:199], a[112:115], v[196:199]
pg_2:
    s_cbranch_execz pg_6
    s_barrier
    v_mfma_f32_16x16x32_bf16 v[196:199], a[192:195], a[96:99], v[196:199]
    s_waitcnt lgkmcnt(4)
    v_cmp_ne_u32 vcc, 0, v34
    v_add_u32 v11, 0, v15
    v_mfma_f32_16x16x32_bf16 v[224:227], a[200:203], a[96:99], v[224:227]
    ds_read_b64_tr_b16 a[192:193], v8 offset:0
    v_mfma_f32_16x16x32_bf16 v[224:227], a[204:207], a[112:115], v[224:227]
    ds_read_b64_tr_b16 a[194:195], v8 offset:6144
    v_mfma_f32_16x16x32_bf16 v[232:235], a[204:207], a[116:119], v[232:235]
    s_cbranch_vccnz spin_rec
spin_rec_ret:
    v_max_u32 v20, v32, v33
    v_mfma_f32_16x16x32_bf16 v[232:235], a[200:203], a[100:103], v[232:235]
    buffer_load_dwordx4 a[184:187], v28, s[20:23], s46 offen offset:2048 sc1
    v_mfma_f32_16x16x32_bf16 v[240:243], a[200:203], a[104:107], v[240:243]
    ds_read_b64_tr_b16 a[196:197], v8 offset:12288
    v_min_u32 v21, v32, v33
    v_mfma_f32_16x16x32_bf16 v[240:243], a[204:207], a[120:123], v[240:243]
    ds_read_b64_tr_b16 a[198:199], v8 offset:18432
    v_med3_u32 v21, v20, v21, v36
    v_mfma_f32_16x16x32_bf16 v[248:251], a[204:207], a[124:127], v[248:251]
    buffer_load_dwordx4 a[188:191], v28, s[20:23], s46 offen offset:3072 sc1
    v_mfma_f32_16x16x32_bf16 v[248:251], a[200:203], a[108:111], v[248:251]
    s_waitcnt lgkmcnt(4)
    v_max_u32 v20, v20, v36
    v_med3_u32 v21, v20, v21, v37
    v_mfma_f32_16x16x32_bf16 v[252:255], a[208:211], a[108:111], v[252:255]
    s_add_u32 s46, s45, 49152
    ds_read_b64_tr_b16 a[200:201], v9 offset:0
    v_max_u32 v20, v20, v37
    v_mfma_f32_16x16x32_bf16 v[252:255], a[212:215], a[124:127], v[252:255]
    s_sub_u32 s77, s46, 81920
    ds_read_b64_tr_b16 a[202:203], v9 offset:6144
    v_med3_u32 v21, v20, v21, v40
    v_mfma_f32_16x16x32_bf16 v[244:247], a[212:215], a[120:123], v[244:247]
    s_min_u32 s46, s46, s77
    v_max_u32 v20, v20, v40
    v_med3_u32 v21, v20, v21, v41
    v_mfma_f32_16x16x32_bf16 v[244:247], a[208:211], a[104:107], v[244:247]
    buffer_load_dwordx4 a[0:3], v28, s[20:23], s46 offen offset:0 sc1
    v_mfma_f32_16x16x32_bf16 v[236:239], a[208:211], a[100:103], v[236:239]
    ds_read_b64_tr_b16 a[204:205], v9 offset:12288
    v_max_u32 v20, v20, v41
    v_mfma_f32_16x16x32_bf16 v[236:239], a[212:215], a[116:119], v[236:239]
    s_waitcnt vmcnt(29)
    s_waitcnt vmcnt(15)
    ds_read_b64_tr_b16 a[206:207], v9 offset:18432
    v_mfma_f32_16x16x32_bf16 v[228:231], a[212:215], a[112:115], v[228:231]
    v_med3_u32 v21, v20, v21, v44
    v_max_u32 v20, v20, v44
    v_mfma_f32_16x16x32_bf16 v[228:231], a[208:211], a[96:99], v[228:231]
    s_waitcnt lgkmcnt(4)
    v_med3_u32 v21, v20, v21, v45
    v_max_u32 v20, v20, v45
    v_mfma_f32_16x16x32_bf16 v[64:67], a[192:195], a[128:131], v[64:67]
    ds_read_b64_tr_b16 a[208:209], v10 offset:0
    v_mov_b32_dpp v22, v20 row_ror:8 row_mask:0xf bank_mask:0xf
    v_mfma_f32_16x16x32_bf16 v[64:67], a[196:199], a[144:147], v[64:67]
    ds_read_b64_tr_b16 a[210:211], v10 offset:6144
    v_mov_b32_dpp v23, v21 row_ror:8 row_mask:0xf bank_mask:0xf
    v_mfma_f32_16x16x32_bf16 v[72:75], a[196:199], a[148:151], v[72:75]
    buffer_load_dwordx4 a[4:7], v28, s[20:23], s46 offen offset:1024 sc1
    v_mfma_f32_16x16x32_bf16 v[72:75], a[192:195], a[132:135], v[72:75]
    v_min_u32 v24, v20, v22
    v_max_u32 v20, v20, v22
    v_mfma_f32_16x16x32_bf16 v[80:83], a[192:195], a[136:139], v[80:83]
    ds_read_b64_tr_b16 a[212:213], v10 offset:12288
    v_max3_u32 v21, v24, v21, v23
    v_mfma_f32_16x16x32_bf16 v[80:83], a[196:199], a[152:155], v[80:83]
    ds_read_b64_tr_b16 a[214:215], v10 offset:18432
    v_mov_b32_dpp v22, v20 row_ror:4 row_mask:0xf bank_mask:0xf
    v_mfma_f32_16x16x32_bf16 v[88:91], a[196:199], a[156:159], v[88:91]
    v_mov_b32_dpp v23, v21 row_ror:4 row_mask:0xf bank_mask:0xf
    v_min_u32 v24, v20, v22
    v_mfma_f32_16x16x32_bf16 v[88:91], a[192:195], a[140:143], v[88:91]
    s_waitcnt lgkmcnt(4)
    v_max_u32 v20, v20, v22
    v_max3_u32 v21, v24, v21, v23
    v_mfma_f32_16x16x32_bf16 v[92:95], a[200:203], a[140:143], v[92:95]
    ds_read_b64_tr_b16 a[192:193], v11 offset:0
    v_mov_b32_dpp v22, v20 row_ror:2 row_mask:0xf bank_mask:0xf
    v_mfma_f32_16x16x32_bf16 v[92:95], a[204:207], a[156:159], v[92:95]
    ds_read_b64_tr_b16 a[194:195], v11 offset:6144
    v_mov_b32_dpp v23, v21 row_ror:2 row_mask:0xf bank_mask:0xf
    v_mfma_f32_16x16x32_bf16 v[84:87], a[204:207], a[152:155], v[84:87]
    buffer_load_dwordx4 a[8:11], v28, s[20:23], s46 offen offset:2048 sc1
    v_mfma_f32_16x16x32_bf16 v[84:87], a[200:203], a[136:139], v[84:87]
    v_min_u32 v24, v20, v22
    v_max_u32 v20, v20, v22
    v_mfma_f32_16x16x32_bf16 v[76:79], a[200:203], a[132:135], v[76:79]
    ds_read_b64_tr_b16 a[196:197], v11 offset:12288
    v_max3_u32 v21, v24, v21, v23
    v_mfma_f32_16x16x32_bf16 v[76:79], a[204:207], a[148:151], v[76:79]
    ds_read_b64_tr_b16 a[198:199], v11 offset:18432
    v_mov_b32_dpp v22, v20 row_ror:1 row_mask:0xf bank_mask:0xf
    v_mfma_f32_16x16x32_bf16 v[68:71], a[204:207], a[144:147], v[68:71]
    buffer_load_dwordx4 a[12:15], v28, s[20:23], s46 offen offset:3072 sc1
    v_mfma_f32_16x16x32_bf16 v[68:71], a[200:203], a[128:131], v[68:71]
    s_waitcnt lgkmcnt(4)
    v_mov_b32_dpp v23, v21 row_ror:1 row_mask:0xf bank_mask:0xf
    v_min_u32 v24, v20, v22
    v_mfma_f32_16x16x32_bf16 v[96:99], a[208:211], a[128:131], v[96:99]
    s_andn2_b32 s88, s2, 7
    ds_read_b64_tr_b16 a[200:201], v8 offset:1024
    v_max_u32 v20, v20, v22
    v_mfma_f32_16x16x32_bf16 v[96:99], a[212:215], a[144:147], v[96:99]
    s_lshl_b32 s88, s88, 2
    ds_read_b64_tr_b16 a[202:203], v8 offset:7168
    v_max3_u32 v21, v24, v21, v23
    v_mfma_f32_16x16x32_bf16 v[104:107], a[212:215], a[148:151], v[104:107]
    s_lshr_b32 s89, s53, 1
    v_mov_b32 v22, v20
    v_mov_b32 v23, v21
    v_mfma_f32_16x16x32_bf16 v[104:107], a[208:211], a[132:135], v[104:107]
    s_add_u32 s88, s88, s89
    v_permlane16_swap_b32 v20, v22
    v_mfma_f32_16x16x32_bf16 v[112:115], a[208:211], a[136:139], v[112:115]
    s_add_u32 m0, s49, 73728
    ds_read_b64_tr_b16 a[204:205], v8 offset:13312
    v_lshl_add_u32 v60, v1, 2, s88
    v_mfma_f32_16x16x32_bf16 v[112:115], a[212:215], a[152:155], v[112:115]
    s_andn2_b32 s88, s2, 0x18
    ds_read_b64_tr_b16 a[206:207], v8 offset:19456
    v_accvgpr_write_b32 a96, 1.0
    v_mfma_f32_16x16x32_bf16 v[120:123], a[212:215], a[156:159], v[120:123]
    buffer_load_dwordx4 v2, s[8:11], s36 offen offset:0 lds
    v_mfma_f32_16x16x32_bf16 v[120:123], a[208:211], a[140:143], v[120:123]
    s_waitcnt lgkmcnt(4)
    v_permlane16_swap_b32 v21, v23
    v_mfma_f32_16x16x32_bf16 v[124:127], a[192:195], a[140:143], v[124:127]
    s_lshl_b32 s88, s88, 2
    ds_read_b64_tr_b16 a[208:209], v9 offset:1024
    v_min_u32 v24, v20, v22
    v_mfma_f32_16x16x32_bf16 v[124:127], a[196:199], a[156:159], v[124:127]
    s_add_u32 s88, s88, s3
    ds_read_b64_tr_b16 a[210:211], v9 offset:7168
    v_max_u32 v20, v20, v22
    v_mfma_f32_16x16x32_bf16 v[116:119], a[196:199], a[152:155], v[116:119]
    s_add_u32 m0, s49, 74624
    v_max3_u32 v21, v24, v21, v23
    v_mov_b32 v22, v20
    v_mfma_f32_16x16x32_bf16 v[116:119], a[192:195], a[136:139], v[116:119]
    buffer_load_dwordx4 v2, s[8:11], s36 offen offset:128 lds
    v_mfma_f32_16x16x32_bf16 v[108:111], a[192:195], a[132:135], v[108:111]
    ds_read_b64_tr_b16 a[212:213], v9 offset:13312
    v_mov_b32 v23, v21
    v_mfma_f32_16x16x32_bf16 v[108:111], a[196:199], a[148:151], v[108:111]
    ds_read_b64_tr_b16 a[214:215], v9 offset:19456
    v_and_b32 v61, 3, v1
    v_mfma_f32_16x16x32_bf16 v[100:103], a[196:199], a[144:147], v[100:103]
    v_permlane32_swap_b32 v20, v22
    v_mfma_f32_16x16x32_bf16 v[100:103], a[192:195], a[128:131], v[100:103]
    s_waitcnt lgkmcnt(4)
    v_permlane32_swap_b32 v21, v23
    v_mfma_f32_16x16x32_bf16 v[128:131], a[200:203], a[128:131], v[128:131]
    ds_read_b64_tr_b16 a[192:193], v10 offset:1024
    v_min_u32 v24, v20, v22
    v_mfma_f32_16x16x32_bf16 v[128:131], a[204:207], a[144:147], v[128:131]
    s_add_u32 m0, s49, 75520
    ds_read_b64_tr_b16 a[194:195], v10 offset:7168
    v_max_u32 v20, v20, v22
    v_mfma_f32_16x16x32_bf16 v[136:139], a[204:207], a[148:151], v[136:139]
    buffer_load_dwordx4 v2, s[8:11], s36 offen offset:256 lds
    v_mfma_f32_16x16x32_bf16 v[136:139], a[200:203], a[132:135], v[136:139]
    v_max3_u32 v21, v24, v21, v23
    v_lshl_add_u32 v61, v61, 5, s88
    v_mfma_f32_16x16x32_bf16 v[144:147], a[200:203], a[136:139], v[144:147]
    s_lshl_b32 s56, s3, 3
    ds_read_b64_tr_b16 a[196:197], v10 offset:13312
    v_cmp_gt_u32 s[88:89], 8, v1
    v_mfma_f32_16x16x32_bf16 v[144:147], a[204:207], a[152:155], v[144:147]
    s_add_u32 s56, s56, 147456
    ds_read_b64_tr_b16 a[198:199], v10 offset:19456
    v_mov_b32 v22, s56
    v_mfma_f32_16x16x32_bf16 v[152:155], a[204:207], a[156:159], v[152:155]
    v_mov_b32 v23, 147456
    v_cndmask_b32 v60, v61, v60, s[88:89]
    v_mfma_f32_16x16x32_bf16 v[152:155], a[200:203], a[140:143], v[152:155]
    s_waitcnt lgkmcnt(4)
    v_lshlrev_b32 v61, 2, v1
    v_cmp_gt_u32 s[88:89], 12, v1
    v_mfma_f32_16x16x32_bf16 v[156:159], a[208:211], a[140:143], v[156:159]
    s_add_u32 m0, s49, 76800
    ds_read_b64_tr_b16 a[200:201], v11 offset:1024
    v_cndmask_b32 v60, v61, v60, s[88:89]
    v_mfma_f32_16x16x32_bf16 v[156:159], a[212:215], a[156:159], v[156:159]
    ds_read_b64_tr_b16 a[202:203], v11 offset:7168
    v_lshlrev_b32 v60, 4, v60
    v_mfma_f32_16x16x32_bf16 v[148:151], a[212:215], a[152:155], v[148:151]
    buffer_load_dwordx4 v3, s[8:11], s36 offen offset:0 lds
    v_mfma_f32_16x16x32_bf16 v[148:151], a[208:211], a[136:139], v[148:151]
    v_accvgpr_write_b32 a97, 1.0
    v_accvgpr_write_b32 a98, 1.0
    v_mfma_f32_16x16x32_bf16 v[140:143], a[208:211], a[132:135], v[140:143]
    ds_read_b64_tr_b16 a[204:205], v11 offset:13312
    v_accvgpr_write_b32 a99, 1.0
    v_mfma_f32_16x16x32_bf16 v[140:143], a[212:215], a[148:151], v[140:143]
    ds_read_b64_tr_b16 a[206:207], v11 offset:19456
    v_accvgpr_write_b32 a100, 1.0
    v_mfma_f32_16x16x32_bf16 v[132:135], a[212:215], a[144:147], v[132:135]
    s_add_u32 m0, s49, 77696
    v_accvgpr_write_b32 a101, 1.0
    v_accvgpr_write_b32 a102, 1.0
    v_mfma_f32_16x16x32_bf16 v[132:135], a[208:211], a[128:131], v[132:135]
    s_waitcnt lgkmcnt(4)
    v_accvgpr_write_b32 a103, 1.0
    v_accvgpr_write_b32 a104, 1.0
    v_mfma_f32_16x16x32_bf16 v[160:163], a[192:195], a[128:131], v[160:163]
    ds_read_b64_tr_b16 a[208:209], v8 offset:2048
    v_accvgpr_write_b32 a105, 1.0
    v_mfma_f32_16x16x32_bf16 v[160:163], a[196:199], a[144:147], v[160:163]
    ds_read_b64_tr_b16 a[210:211], v8 offset:8192
    v_accvgpr_write_b32 a106, 1.0
    v_mfma_f32_16x16x32_bf16 v[168:171], a[196:199], a[148:151], v[168:171]
    buffer_load_dwordx4 v3, s[8:11], s36 offen offset:128 lds
    v_mfma_f32_16x16x32_bf16 v[168:171], a[192:195], a[132:135], v[168:171]
    v_accvgpr_write_b32 a107, 1.0
    v_accvgpr_write_b32 a108, 1.0
    v_mfma_f32_16x16x32_bf16 v[176:179], a[192:195], a[136:139], v[176:179]
    s_add_u32 m0, s49, 78592
    ds_read_b64_tr_b16 a[212:213], v8 offset:14336
    v_accvgpr_write_b32 a109, 1.0
    v_mfma_f32_16x16x32_bf16 v[176:179], a[196:199], a[152:155], v[176:179]
    ds_read_b64_tr_b16 a[214:215], v8 offset:20480
    v_accvgpr_write_b32 a110, 1.0
    v_mfma_f32_16x16x32_bf16 v[184:187], a[196:199], a[156:159], v[184:187]
    buffer_load_dwordx4 v3, s[8:11], s36 offen offset:256 lds
    v_mfma_f32_16x16x32_bf16 v[184:187], a[192:195], a[140:143], v[184:187]
    s_waitcnt lgkmcnt(4)
    v_accvgpr_write_b32 a111, 1.0
    v_accvgpr_write_b32 a112, 1.0
    v_mfma_f32_16x16x32_bf16 v[188:191], a[200:203], a[140:143], v[188:191]
    s_add_u32 s36, s36, s37
    ds_read_b64_tr_b16 a[192:193], v9 offset:2048
    v_accvgpr_write_b32 a113, 1.0
    v_mfma_f32_16x16x32_bf16 v[188:191], a[204:207], a[156:159], v[188:191]
    s_sub_u32 s55, s36, 7864320
    ds_read_b64_tr_b16 a[194:195], v9 offset:8192
    v_accvgpr_write_b32 a114, 1.0
    v_mfma_f32_16x16x32_bf16 v[180:183], a[204:207], a[152:155], v[180:183]
    s_min_u32 s36, s36, s55
    ds_write_b64 v22, v[20:21]
    v_accvgpr_write_b32 a115, 1.0
    v_mfma_f32_16x16x32_bf16 v[180:183], a[200:203], a[136:139], v[180:183]
    s_add_u32 s46, s45, 53248
    v_accvgpr_write_b32 a116, 1.0
    v_accvgpr_write_b32 a117, 1.0
    v_mfma_f32_16x16x32_bf16 v[172:175], a[200:203], a[132:135], v[172:175]
    s_sub_u32 s77, s46, 81920
    ds_read_b64_tr_b16 a[196:197], v9 offset:14336
    v_accvgpr_write_b32 a118, 1.0
    v_mfma_f32_16x16x32_bf16 v[172:175], a[204:207], a[148:151], v[172:175]
    s_min_u32 s46, s46, s77
    ds_read_b64_tr_b16 a[198:199], v9 offset:20480
    v_accvgpr_write_b32 a119, 1.0
    v_mfma_f32_16x16x32_bf16 v[164:167], a[204:207], a[144:147], v[164:167]
    buffer_load_dwordx4 a[16:19], v28, s[20:23], s46 offen offset:0 sc1
    v_mfma_f32_16x16x32_bf16 v[164:167], a[200:203], a[128:131], v[164:167]
    s_waitcnt lgkmcnt(4)
    v_accvgpr_write_b32 a120, 1.0
    v_accvgpr_write_b32 a121, 1.0
    v_mfma_f32_16x16x32_bf16 v[192:195], a[208:211], a[128:131], v[192:195]
    ds_read_b64_tr_b16 a[200:201], v10 offset:2048
    v_accvgpr_write_b32 a122, 1.0
    v_mfma_f32_16x16x32_bf16 v[192:195], a[212:215], a[144:147], v[192:195]
    ds_read_b64_tr_b16 a[202:203], v10 offset:8192
    v_accvgpr_write_b32 a123, 1.0
    v_mfma_f32_16x16x32_bf16 v[200:203], a[212:215], a[148:151], v[200:203]
    buffer_load_dwordx4 a[20:23], v28, s[20:23], s46 offen offset:1024 sc1
    v_mfma_f32_16x16x32_bf16 v[200:203], a[208:211], a[132:135], v[200:203]
    v_accvgpr_write_b32 a124, 1.0
    v_accvgpr_write_b32 a125, 1.0
    v_mfma_f32_16x16x32_bf16 v[208:211], a[208:211], a[136:139], v[208:211]
    ds_read_b64_tr_b16 a[204:205], v10 offset:14336
    v_accvgpr_write_b32 a126, 1.0
    v_mfma_f32_16x16x32_bf16 v[208:211], a[212:215], a[152:155], v[208:211]
    ds_read_b64_tr_b16 a[206:207], v10 offset:20480
    v_accvgpr_write_b32 a127, 1.0
    v_mfma_f32_16x16x32_bf16 v[216:219], a[212:215], a[156:159], v[216:219]
    v_add_u32 v8, 24576, v12
    v_add_u32 v9, 24576, v13
    v_mfma_f32_16x16x32_bf16 v[216:219], a[208:211], a[140:143], v[216:219]
    s_waitcnt lgkmcnt(4)
    v_add_u32 v10, 24576, v14
    v_mfma_f32_16x16x32_bf16 v[220:223], a[192:195], a[140:143], v[220:223]
    ds_read_b64_tr_b16 a[208:209], v11 offset:2048
    v_mfma_f32_16x16x32_bf16 v[220:223], a[196:199], a[156:159], v[220:223]
    ds_read_b64_tr_b16 a[210:211], v11 offset:8192
    v_mfma_f32_16x16x32_bf16 v[212:215], a[196:199], a[152:155], v[212:215]
    buffer_load_dwordx4 a[24:27], v28, s[20:23], s46 offen offset:2048 sc1
    v_mfma_f32_16x16x32_bf16 v[212:215], a[192:195], a[136:139], v[212:215]
    v_mfma_f32_16x16x32_bf16 v[204:207], a[192:195], a[132:135], v[204:207]
    ds_read_b64_tr_b16 a[212:213], v11 offset:14336
    v_mfma_f32_16x16x32_bf16 v[204:207], a[196:199], a[148:151], v[204:207]
    s_waitcnt vmcnt(33)
    ds_read_b64_tr_b16 a[214:215], v11 offset:20480
    v_mfma_f32_16x16x32_bf16 v[196:199], a[196:199], a[144:147], v[196:199]
    s_barrier
    v_mfma_f32_16x16x32_bf16 v[196:199], a[192:195], a[128:131], v[196:199]
    s_waitcnt lgkmcnt(4)
    v_add_u32 v11, 24576, v15
    v_mfma_f32_16x16x32_bf16 v[224:227], a[200:203], a[128:131], v[224:227]
    ds_read_b64_tr_b16 a[192:193], v8 offset:0
    v_mfma_f32_16x16x32_bf16 v[224:227], a[204:207], a[144:147], v[224:227]
    ds_read_b64_tr_b16 a[194:195], v8 offset:6144
    v_mfma_f32_16x16x32_bf16 v[232:235], a[204:207], a[148:151], v[232:235]
    ds_read_b128 v[32:35], v23
    v_mfma_f32_16x16x32_bf16 v[232:235], a[200:203], a[132:135], v[232:235]
    ds_read_b128 v[36:39], v23 offset:16
    v_mfma_f32_16x16x32_bf16 v[240:243], a[200:203], a[136:139], v[240:243]
    ds_read_b64_tr_b16 a[196:197], v8 offset:12288
    v_mfma_f32_16x16x32_bf16 v[240:243], a[204:207], a[152:155], v[240:243]
    ds_read_b64_tr_b16 a[198:199], v8 offset:18432
    v_mfma_f32_16x16x32_bf16 v[248:251], a[204:207], a[156:159], v[248:251]
    buffer_load_dwordx4 a[28:31], v28, s[20:23], s46 offen offset:3072 sc1
    v_mfma_f32_16x16x32_bf16 v[248:251], a[200:203], a[140:143], v[248:251]
    s_waitcnt lgkmcnt(4)
    s_add_u32 s46, s45, 57344
    s_sub_u32 s77, s46, 81920
    v_mfma_f32_16x16x32_bf16 v[252:255], a[208:211], a[140:143], v[252:255]
    s_min_u32 s46, s46, s77
    ds_read_b64_tr_b16 a[200:201], v9 offset:0
    v_mfma_f32_16x16x32_bf16 v[252:255], a[212:215], a[156:159], v[252:255]
    ds_read_b64_tr_b16 a[202:203], v9 offset:6144
    v_mfma_f32_16x16x32_bf16 v[244:247], a[212:215], a[152:155], v[244:247]
    buffer_load_dwordx4 a[32:35], v28, s[20:23], s46 offen offset:0 sc1
    v_mfma_f32_16x16x32_bf16 v[244:247], a[208:211], a[136:139], v[244:247]
    v_mfma_f32_16x16x32_bf16 v[236:239], a[208:211], a[132:135], v[236:239]
    ds_read_b64_tr_b16 a[204:205], v9 offset:12288
    v_mfma_f32_16x16x32_bf16 v[236:239], a[212:215], a[148:151], v[236:239]
    s_waitcnt vmcnt(25)
    s_waitcnt vmcnt(15)
    ds_read_b64_tr_b16 a[206:207], v9 offset:18432
    v_mfma_f32_16x16x32_bf16 v[228:231], a[212:215], a[144:147], v[228:231]
    buffer_load_dwordx4 a[36:39], v28, s[20:23], s46 offen offset:1024 sc1
    v_mfma_f32_16x16x32_bf16 v[228:231], a[208:211], a[128:131], v[228:231]
    s_waitcnt lgkmcnt(4)
    v_mfma_f32_16x16x32_bf16 v[64:67], a[192:195], a[160:163], v[64:67]
    ds_read_b64_tr_b16 a[208:209], v10 offset:0
    v_mfma_f32_16x16x32_bf16 v[64:67], a[196:199], a[176:179], v[64:67]
    ds_read_b64_tr_b16 a[210:211], v10 offset:6144
    v_accvgpr_write_b32 a128, 1.0
    v_mfma_f32_16x16x32_bf16 v[72:75], a[196:199], a[180:183], v[72:75]
    v_accvgpr_write_b32 a129, 1.0
    v_mfma_f32_16x16x32_bf16 v[72:75], a[192:195], a[164:167], v[72:75]
    buffer_load_dwordx4 a[40:43], v28, s[20:23], s46 offen offset:2048 sc1
    v_mfma_f32_16x16x32_bf16 v[80:83], a[192:195], a[168:171], v[80:83]
    ds_read_b64_tr_b16 a[212:213], v10 offset:12288
    v_max_u32 v20, v32, v33
    v_mfma_f32_16x16x32_bf16 v[80:83], a[196:199], a[184:187], v[80:83]
    ds_read_b64_tr_b16 a[214:215], v10 offset:18432
    v_min_u32 v21, v32, v33
    v_mfma_f32_16x16x32_bf16 v[88:91], a[196:199], a[188:191], v[88:91]
    v_med3_u32 v21, v20, v21, v34
    v_max_u32 v20, v20, v34
    v_mfma_f32_16x16x32_bf16 v[88:91], a[192:195], a[172:175], v[88:91]
    s_waitcnt lgkmcnt(4)
    v_med3_u32 v21, v20, v21, v35
    v_max_u32 v20, v20, v35
    v_mfma_f32_16x16x32_bf16 v[92:95], a[200:203], a[172:175], v[92:95]
    ds_read_b64_tr_b16 a[192:193], v11 offset:0
    v_med3_u32 v21, v20, v21, v36
    v_mfma_f32_16x16x32_bf16 v[92:95], a[204:207], a[188:191], v[92:95]
    ds_read_b64_tr_b16 a[194:195], v11 offset:6144
    v_max_u32 v20, v20, v36
    v_mfma_f32_16x16x32_bf16 v[84:87], a[204:207], a[184:187], v[84:87]
    buffer_load_dwordx4 a[44:47], v28, s[20:23], s46 offen offset:3072 sc1
    v_mfma_f32_16x16x32_bf16 v[84:87], a[200:203], a[168:171], v[84:87]
    v_med3_u32 v21, v20, v21, v37
    v_max_u32 v20, v20, v37
    v_mfma_f32_16x16x32_bf16 v[76:79], a[200:203], a[164:167], v[76:79]
    ds_read_b64_tr_b16 a[196:197], v11 offset:12288
    v_med3_u32 v21, v20, v21, v38
    v_mfma_f32_16x16x32_bf16 v[76:79], a[204:207], a[180:183], v[76:79]
    ds_read_b64_tr_b16 a[198:199], v11 offset:18432
    v_max_u32 v20, v20, v38
    v_mfma_f32_16x16x32_bf16 v[68:71], a[204:207], a[176:179], v[68:71]
    v_med3_u32 v21, v20, v21, v39
    v_max_u32 v20, v20, v39
    v_mfma_f32_16x16x32_bf16 v[68:71], a[200:203], a[160:163], v[68:71]
    s_waitcnt lgkmcnt(4)
    v_and_b32 v22, 1, v1
    v_cmp_eq_u32 vcc, 1, v22
    v_mfma_f32_16x16x32_bf16 v[96:99], a[208:211], a[160:163], v[96:99]
    s_add_u32 m0, s49, 98304
    ds_read_b64_tr_b16 a[200:201], v8 offset:1024
    v_readfirstlane_b32 s70, v20
    v_mfma_f32_16x16x32_bf16 v[96:99], a[212:215], a[176:179], v[96:99]
    ds_read_b64_tr_b16 a[202:203], v8 offset:7168
    v_readfirstlane_b32 s71, v21
    v_mfma_f32_16x16x32_bf16 v[104:107], a[212:215], a[180:183], v[104:107]
    buffer_load_dwordx4 v2, s[8:11], s36 offen offset:0 lds
    v_mfma_f32_16x16x32_bf16 v[104:107], a[208:211], a[164:167], v[104:107]
    v_cndmask_b32 v22, v20, v21, vcc
    v_and_b32 v22, 0x7ff, v22
    v_mfma_f32_16x16x32_bf16 v[112:115], a[208:211], a[168:171], v[112:115]
    ds_read_b64_tr_b16 a[204:205], v8 offset:13312
    v_sub_u32 v22, 2047, v22
    v_mfma_f32_16x16x32_bf16 v[112:115], a[212:215], a[184:187], v[112:115]
    s_add_u32 m0, s49, 99200
    ds_read_b64_tr_b16 a[206:207], v8 offset:19456
    v_mul_u32_u24 v23, 1280, v22
    v_mfma_f32_16x16x32_bf16 v[120:123], a[212:215], a[188:191], v[120:123]
    buffer_load_dwordx4 v2, s[8:11], s36 offen offset:128 lds
    v_mfma_f32_16x16x32_bf16 v[120:123], a[208:211], a[172:175], v[120:123]
    s_waitcnt lgkmcnt(4)
    v_lshrrev_b32 v24, 4, v1
    v_lshl_add_u32 v23, v24, 4, v23
    v_mfma_f32_16x16x32_bf16 v[124:127], a[192:195], a[172:175], v[124:127]
    ds_read_b64_tr_b16 a[208:209], v9 offset:1024
    v_add_u32 v23, s61, v23
    v_mfma_f32_16x16x32_bf16 v[124:127], a[196:199], a[188:191], v[124:127]
    ds_read_b64_tr_b16 a[210:211], v9 offset:7168
    v_lshlrev_b32 v24, 3, v22
    v_mfma_f32_16x16x32_bf16 v[116:119], a[196:199], a[184:187], v[116:119]
    s_mov_b32 s56, 3211264
    v_accvgpr_write_b32 a130, 1.0
    v_accvgpr_write_b32 a131, 1.0
    v_mfma_f32_16x16x32_bf16 v[116:119], a[192:195], a[168:171], v[116:119]
    v_accvgpr_write_b32 a132, 1.0
    v_accvgpr_write_b32 a133, 1.0
    v_mfma_f32_16x16x32_bf16 v[108:111], a[192:195], a[164:167], v[108:111]
    s_add_u32 m0, s49, 100096
    ds_read_b64_tr_b16 a[212:213], v9 offset:13312
    v_accvgpr_write_b32 a134, 1.0
    v_mfma_f32_16x16x32_bf16 v[108:111], a[196:199], a[180:183], v[108:111]
    ds_read_b64_tr_b16 a[214:215], v9 offset:19456
    v_accvgpr_write_b32 a135, 1.0
    v_mfma_f32_16x16x32_bf16 v[100:103], a[196:199], a[176:179], v[100:103]
    buffer_load_dwordx4 v2, s[8:11], s36 offen offset:256 lds
    v_mfma_f32_16x16x32_bf16 v[100:103], a[192:195], a[160:163], v[100:103]
    s_waitcnt lgkmcnt(4)
    v_accvgpr_write_b32 a136, 1.0
    v_accvgpr_write_b32 a137, 1.0
    v_mfma_f32_16x16x32_bf16 v[128:131], a[200:203], a[160:163], v[128:131]
    ds_read_b64_tr_b16 a[192:193], v10 offset:1024
    v_accvgpr_write_b32 a138, 1.0
    v_mfma_f32_16x16x32_bf16 v[128:131], a[204:207], a[176:179], v[128:131]
    ds_read_b64_tr_b16 a[194:195], v10 offset:7168
    v_accvgpr_write_b32 a139, 1.0
    v_mfma_f32_16x16x32_bf16 v[136:139], a[204:207], a[180:183], v[136:139]
    s_add_u32 m0, s49, 101376
    v_accvgpr_write_b32 a140, 1.0
    v_accvgpr_write_b32 a141, 1.0
    v_mfma_f32_16x16x32_bf16 v[136:139], a[200:203], a[164:167], v[136:139]
    buffer_load_dwordx4 v3, s[8:11], s36 offen offset:0 lds
    v_mfma_f32_16x16x32_bf16 v[144:147], a[200:203], a[168:171], v[144:147]
    ds_read_b64_tr_b16 a[196:197], v10 offset:13312
    v_accvgpr_write_b32 a142, 1.0
    v_mfma_f32_16x16x32_bf16 v[144:147], a[204:207], a[184:187], v[144:147]
    ds_read_b64_tr_b16 a[198:199], v10 offset:19456
    v_accvgpr_write_b32 a143, 1.0
    v_mfma_f32_16x16x32_bf16 v[152:155], a[204:207], a[188:191], v[152:155]
    v_accvgpr_write_b32 a144, 1.0
    v_accvgpr_write_b32 a145, 1.0
    v_mfma_f32_16x16x32_bf16 v[152:155], a[200:203], a[172:175], v[152:155]
    s_waitcnt lgkmcnt(4)
    v_accvgpr_write_b32 a146, 1.0
    v_accvgpr_write_b32 a147, 1.0
    v_mfma_f32_16x16x32_bf16 v[156:159], a[208:211], a[172:175], v[156:159]
    ds_read_b64_tr_b16 a[200:201], v11 offset:1024
    v_accvgpr_write_b32 a148, 1.0
    v_mfma_f32_16x16x32_bf16 v[156:159], a[212:215], a[188:191], v[156:159]
    s_add_u32 m0, s49, 102272
    ds_read_b64_tr_b16 a[202:203], v11 offset:7168
    v_accvgpr_write_b32 a149, 1.0
    v_mfma_f32_16x16x32_bf16 v[148:151], a[212:215], a[184:187], v[148:151]
    buffer_load_dwordx4 v3, s[8:11], s36 offen offset:128 lds
    v_mfma_f32_16x16x32_bf16 v[148:151], a[208:211], a[168:171], v[148:151]
    v_accvgpr_write_b32 a150, 1.0
    v_accvgpr_write_b32 a151, 1.0
    v_mfma_f32_16x16x32_bf16 v[140:143], a[208:211], a[164:167], v[140:143]
    ds_read_b64_tr_b16 a[204:205], v11 offset:13312
    v_accvgpr_write_b32 a152, 1.0
    v_mfma_f32_16x16x32_bf16 v[140:143], a[212:215], a[180:183], v[140:143]
    ds_read_b64_tr_b16 a[206:207], v11 offset:19456
    v_accvgpr_write_b32 a153, 1.0
    v_mfma_f32_16x16x32_bf16 v[132:135], a[212:215], a[176:179], v[132:135]
    v_accvgpr_write_b32 a154, 1.0
    v_accvgpr_write_b32 a155, 1.0
    v_mfma_f32_16x16x32_bf16 v[132:135], a[208:211], a[160:163], v[132:135]
    s_waitcnt lgkmcnt(4)
    v_accvgpr_write_b32 a156, 1.0
    v_accvgpr_write_b32 a157, 1.0
    v_mfma_f32_16x16x32_bf16 v[160:163], a[192:195], a[160:163], v[160:163]
    s_add_u32 m0, s49, 103168
    ds_read_b64_tr_b16 a[208:209], v8 offset:2048
    v_accvgpr_write_b32 a158, 1.0
    v_mfma_f32_16x16x32_bf16 v[160:163], a[196:199], a[176:179], v[160:163]
    ds_read_b64_tr_b16 a[210:211], v8 offset:8192
    v_accvgpr_write_b32 a159, 1.0
    v_mfma_f32_16x16x32_bf16 v[168:171], a[196:199], a[180:183], v[168:171]
    buffer_load_dwordx4 v3, s[8:11], s36 offen offset:256 lds
    v_mfma_f32_16x16x32_bf16 v[168:171], a[192:195], a[164:167], v[168:171]
    s_add_u32 s36, s36, s37
    s_sub_u32 s55, s36, 7864320
    s_min_u32 s36, s36, s55
    v_mfma_f32_16x16x32_bf16 v[176:179], a[192:195], a[168:171], v[176:179]
    s_add_u32 s46, s45, 61440
    ds_read_b64_tr_b16 a[212:213], v8 offset:14336
    s_sub_u32 s77, s46, 81920
    v_mfma_f32_16x16x32_bf16 v[176:179], a[196:199], a[184:187], v[176:179]
    s_min_u32 s46, s46, s77
    ds_read_b64_tr_b16 a[214:215], v8 offset:20480
    v_mfma_f32_16x16x32_bf16 v[184:187], a[196:199], a[188:191], v[184:187]
    v_add_u32 v8, 49152, v12
    v_mfma_f32_16x16x32_bf16 v[184:187], a[192:195], a[172:175], v[184:187]
    s_waitcnt lgkmcnt(4)
    v_mfma_f32_16x16x32_bf16 v[188:191], a[200:203], a[172:175], v[188:191]
    ds_read_b64_tr_b16 a[192:193], v9 offset:2048
    v_mfma_f32_16x16x32_bf16 v[188:191], a[204:207], a[188:191], v[188:191]
    ds_read_b64_tr_b16 a[194:195], v9 offset:8192
    v_mfma_f32_16x16x32_bf16 v[180:183], a[204:207], a[184:187], v[180:183]
    buffer_load_dwordx4 a[48:51], v28, s[20:23], s46 offen offset:0 sc1
    v_mfma_f32_16x16x32_bf16 v[180:183], a[200:203], a[168:171], v[180:183]
    v_mfma_f32_16x16x32_bf16 v[172:175], a[200:203], a[164:167], v[172:175]
    ds_read_b64_tr_b16 a[196:197], v9 offset:14336
    v_mfma_f32_16x16x32_bf16 v[172:175], a[204:207], a[180:183], v[172:175]
    ds_read_b64_tr_b16 a[198:199], v9 offset:20480
    v_mfma_f32_16x16x32_bf16 v[164:167], a[204:207], a[176:179], v[164:167]
    buffer_load_dwordx4 a[52:55], v28, s[20:23], s46 offen offset:1024 sc1
    v_mfma_f32_16x16x32_bf16 v[164:167], a[200:203], a[160:163], v[164:167]
    s_waitcnt lgkmcnt(4)
    v_add_u32 v9, 49152, v13
    v_mfma_f32_16x16x32_bf16 v[192:195], a[208:211], a[160:163], v[192:195]
    ds_read_b64_tr_b16 a[200:201], v10 offset:2048
    v_mfma_f32_16x16x32_bf16 v[192:195], a[212:215], a[176:179], v[192:195]
    ds_read_b64_tr_b16 a[202:203], v10 offset:8192
    v_mfma_f32_16x16x32_bf16 v[200:203], a[212:215], a[180:183], v[200:203]
    v_mfma_f32_16x16x32_bf16 v[200:203], a[208:211], a[164:167], v[200:203]
    v_mfma_f32_16x16x32_bf16 v[208:211], a[208:211], a[168:171], v[208:211]
    ds_read_b64_tr_b16 a[204:205], v10 offset:14336
    v_mfma_f32_16x16x32_bf16 v[208:211], a[212:215], a[184:187], v[208:211]
    ds_read_b64_tr_b16 a[206:207], v10 offset:20480
    v_mfma_f32_16x16x32_bf16 v[216:219], a[212:215], a[188:191], v[216:219]
    buffer_load_dwordx4 a[56:59], v28, s[20:23], s46 offen offset:2048 sc1
    v_mfma_f32_16x16x32_bf16 v[216:219], a[208:211], a[172:175], v[216:219]
    s_waitcnt lgkmcnt(4)
    v_add_u32 v10, 49152, v14
    v_mfma_f32_16x16x32_bf16 v[220:223], a[192:195], a[172:175], v[220:223]
    ds_read_b64_tr_b16 a[208:209], v11 offset:2048
    v_mfma_f32_16x16x32_bf16 v[220:223], a[196:199], a[188:191], v[220:223]
    ds_read_b64_tr_b16 a[210:211], v11 offset:8192
    v_mfma_f32_16x16x32_bf16 v[212:215], a[196:199], a[184:187], v[212:215]
    buffer_load_dwordx4 a[60:63], v28, s[20:23], s46 offen offset:3072 sc1
    v_mfma_f32_16x16x32_bf16 v[212:215], a[192:195], a[168:171], v[212:215]
    v_mfma_f32_16x16x32_bf16 v[204:207], a[192:195], a[164:167], v[204:207]
    ds_read_b64_tr_b16 a[212:213], v11 offset:14336
    v_mfma_f32_16x16x32_bf16 v[204:207], a[196:199], a[180:183], v[204:207]
    s_waitcnt vmcnt(32)
    ds_read_b64_tr_b16 a[214:215], v11 offset:20480
    v_mfma_f32_16x16x32_bf16 v[196:199], a[196:199], a[176:179], v[196:199]
    s_barrier
    v_mfma_f32_16x16x32_bf16 v[196:199], a[192:195], a[160:163], v[196:199]
    s_waitcnt lgkmcnt(4)
    global_load_dwordx4 v[48:51], v23, s[64:65]
    v_mfma_f32_16x16x32_bf16 v[224:227], a[200:203], a[160:163], v[224:227]
    ds_read_b64_tr_b16 a[192:193], v8 offset:0
    v_add_u32 v11, 49152, v15
    v_mfma_f32_16x16x32_bf16 v[224:227], a[204:207], a[176:179], v[224:227]
    s_add_u32 m0, s44, 147456
    ds_read_b64_tr_b16 a[194:195], v8 offset:6144
    v_mfma_f32_16x16x32_bf16 v[232:235], a[204:207], a[180:183], v[232:235]
pg_3:
    s_cbranch_execz pg_7
    global_load_dwordx4 v[52:55], v23, s[64:65] offset:64
    v_mfma_f32_16x16x32_bf16 v[232:235], a[200:203], a[164:167], v[232:235]
    buffer_load_dwordx2 v[40:41], v24, s[24:27], s56 offen sc1
    v_mfma_f32_16x16x32_bf16 v[240:243], a[200:203], a[168:171], v[240:243]
    ds_read_b64_tr_b16 a[196:197], v8 offset:12288
    v_bfe_u32 v26, v1, 2, 3
    v_mfma_f32_16x16x32_bf16 v[240:243], a[204:207], a[184:187], v[240:243]
    ds_read_b64_tr_b16 a[198:199], v8 offset:18432
    v_lshlrev_b32 v25, 7, v26
    v_mfma_f32_16x16x32_bf16 v[248:251], a[204:207], a[188:191], v[248:251]
    buffer_load_dword v61, v60, s[24:27], s47 offen offset:12 sc1
    v_mfma_f32_16x16x32_bf16 v[248:251], a[200:203], a[172:175], v[248:251]
    s_waitcnt lgkmcnt(4)
    buffer_load_dwordx4 v56, s[28:31], s60 offen lds
    v_mfma_f32_16x16x32_bf16 v[252:255], a[208:211], a[172:175], v[252:255]
    s_add_u32 m0, s44, 148480
    ds_read_b64_tr_b16 a[200:201], v9 offset:0
    v_lshrrev_b32 v26, 1, v26
    v_mfma_f32_16x16x32_bf16 v[252:255], a[212:215], a[188:191], v[252:255]
    ds_read_b64_tr_b16 a[202:203], v9 offset:6144
    v_xor_b32 v26, s3, v26
    v_mfma_f32_16x16x32_bf16 v[244:247], a[212:215], a[184:187], v[244:247]
    buffer_load_dwordx4 v56, s[32:35], s60 offen lds
    v_mfma_f32_16x16x32_bf16 v[244:247], a[208:211], a[168:171], v[244:247]
    s_add_u32 m0, s44, 149504
    v_lshl_add_u32 v25, v26, 5, v25
    v_and_b32 v26, 3, v1
    v_mfma_f32_16x16x32_bf16 v[236:239], a[208:211], a[164:167], v[236:239]
    ds_read_b64_tr_b16 a[204:205], v9 offset:12288
    v_lshl_add_u32 v25, v26, 3, v25
    v_mfma_f32_16x16x32_bf16 v[236:239], a[212:215], a[180:183], v[236:239]
    s_waitcnt vmcnt(30)
    s_waitcnt vmcnt(20)
    ds_read_b64_tr_b16 a[206:207], v9 offset:18432
    v_mfma_f32_16x16x32_bf16 v[228:231], a[212:215], a[176:179], v[228:231]
    buffer_load_dwordx4 v57, s[28:31], s60 offen lds
    v_mfma_f32_16x16x32_bf16 v[228:231], a[208:211], a[160:163], v[228:231]
    s_waitcnt lgkmcnt(4)
    v_lshrrev_b32 v26, 5, v1
    v_mul_u32_u24 v26, 2048, v26
    v_mfma_f32_16x16x32_bf16 v[64:67], a[192:195], a[0:3], v[64:67]
    s_add_u32 m0, s44, 150528
    ds_read_b64_tr_b16 a[208:209], v10 offset:0
    v_add_u32 v25, v25, v26
    v_mfma_f32_16x16x32_bf16 v[64:67], a[196:199], a[16:19], v[64:67]
    ds_read_b64_tr_b16 a[210:211], v10 offset:6144
    v_add_u32 v25, 147456, v25
    v_mfma_f32_16x16x32_bf16 v[72:75], a[196:199], a[20:23], v[72:75]
    buffer_load_dwordx4 v57, s[32:35], s60 offen lds
    v_mfma_f32_16x16x32_bf16 v[72:75], a[192:195], a[4:7], v[72:75]
    v_lshlrev_b32 v26, 4, v1
    v_cmp_gt_u32 vcc, 16, v1
    v_mfma_f32_16x16x32_bf16 v[80:83], a[192:195], a[8:11], v[80:83]
    ds_read_b64_tr_b16 a[212:213], v10 offset:12288
    v_mov_b32 v27, 0x7ffffff0
    v_mfma_f32_16x16x32_bf16 v[80:83], a[196:199], a[24:27], v[80:83]
    ds_read_b64_tr_b16 a[214:215], v10 offset:18432
    v_cndmask_b32 v26, v27, v26, vcc
    v_mfma_f32_16x16x32_bf16 v[88:91], a[196:199], a[28:31], v[88:91]
    v_accvgpr_write_b32 a160, 1.0
    v_mfma_f32_16x16x32_bf16 v[88:91], a[192:195], a[12:15], v[88:91]
    s_waitcnt lgkmcnt(4)
    v_accvgpr_write_b32 a161, 1.0
    v_mfma_f32_16x16x32_bf16 v[92:95], a[200:203], a[12:15], v[92:95]
    s_add_u32 s46, s45, 65536
    ds_read_b64_tr_b16 a[192:193], v11 offset:0
    v_accvgpr_write_b32 a162, 1.0
    v_mfma_f32_16x16x32_bf16 v[92:95], a[204:207], a[28:31], v[92:95]
    s_sub_u32 s77, s46, 81920
    ds_read_b64_tr_b16 a[194:195], v11 offset:6144
    v_accvgpr_write_b32 a163, 1.0
    v_mfma_f32_16x16x32_bf16 v[84:87], a[204:207], a[24:27], v[84:87]
    s_min_u32 s46, s46, s77
    v_accvgpr_write_b32 a164, 1.0
    v_mfma_f32_16x16x32_bf16 v[84:87], a[200:203], a[8:11], v[84:87]
    buffer_load_dwordx4 a[64:67], v28, s[20:23], s46 offen offset:0 sc1
    v_mfma_f32_16x16x32_bf16 v[76:79], a[200:203], a[4:7], v[76:79]
    ds_read_b64_tr_b16 a[196:197], v11 offset:12288
    v_accvgpr_write_b32 a165, 1.0
    v_mfma_f32_16x16x32_bf16 v[76:79], a[204:207], a[20:23], v[76:79]
    ds_read_b64_tr_b16 a[198:199], v11 offset:18432
    v_accvgpr_write_b32 a166, 1.0
    v_mfma_f32_16x16x32_bf16 v[68:71], a[204:207], a[16:19], v[68:71]
    v_accvgpr_write_b32 a167, 1.0
    v_mfma_f32_16x16x32_bf16 v[68:71], a[200:203], a[0:3], v[68:71]
    s_waitcnt lgkmcnt(4)
    v_accvgpr_write_b32 a168, 1.0
    v_mfma_f32_16x16x32_bf16 v[96:99], a[208:211], a[0:3], v[96:99]
    ds_read_b64_tr_b16 a[200:201], v8 offset:1024
    v_accvgpr_write_b32 a169, 1.0
    v_mfma_f32_16x16x32_bf16 v[96:99], a[212:215], a[16:19], v[96:99]
    ds_read_b64_tr_b16 a[202:203], v8 offset:7168
    v_accvgpr_write_b32 a170, 1.0
    v_mfma_f32_16x16x32_bf16 v[104:107], a[212:215], a[20:23], v[104:107]
    buffer_load_dwordx4 a[68:71], v28, s[20:23], s46 offen offset:1024 sc1
    v_mfma_f32_16x16x32_bf16 v[104:107], a[208:211], a[4:7], v[104:107]
    v_accvgpr_write_b32 a171, 1.0
    v_accvgpr_write_b32 a172, 1.0
    v_mfma_f32_16x16x32_bf16 v[112:115], a[208:211], a[8:11], v[112:115]
    ds_read_b64_tr_b16 a[204:205], v8 offset:13312
    v_accvgpr_write_b32 a173, 1.0
    v_mfma_f32_16x16x32_bf16 v[112:115], a[212:215], a[24:27], v[112:115]
    ds_read_b64_tr_b16 a[206:207], v8 offset:19456
    v_accvgpr_write_b32 a174, 1.0
    v_mfma_f32_16x16x32_bf16 v[120:123], a[212:215], a[28:31], v[120:123]
    v_accvgpr_write_b32 a175, 1.0
    v_accvgpr_write_b32 a176, 1.0
    v_mfma_f32_16x16x32_bf16 v[120:123], a[208:211], a[12:15], v[120:123]
    s_waitcnt lgkmcnt(4)
    v_accvgpr_write_b32 a177, 1.0
    v_accvgpr_write_b32 a178, 1.0
    v_mfma_f32_16x16x32_bf16 v[124:127], a[192:195], a[12:15], v[124:127]
    ds_read_b64_tr_b16 a[208:209], v9 offset:1024
    v_accvgpr_write_b32 a179, 1.0
    v_mfma_f32_16x16x32_bf16 v[124:127], a[196:199], a[28:31], v[124:127]
    ds_read_b64_tr_b16 a[210:211], v9 offset:7168
    v_accvgpr_write_b32 a180, 1.0
    v_mfma_f32_16x16x32_bf16 v[116:119], a[196:199], a[24:27], v[116:119]
    buffer_load_dwordx4 a[72:75], v28, s[20:23], s46 offen offset:2048 sc1
    v_mfma_f32_16x16x32_bf16 v[116:119], a[192:195], a[8:11], v[116:119]
    v_accvgpr_write_b32 a181, 1.0
    v_accvgpr_write_b32 a182, 1.0
    v_mfma_f32_16x16x32_bf16 v[108:111], a[192:195], a[4:7], v[108:111]
    ds_read_b64_tr_b16 a[212:213], v9 offset:13312
    v_accvgpr_write_b32 a183, 1.0
    v_mfma_f32_16x16x32_bf16 v[108:111], a[196:199], a[20:23], v[108:111]
    ds_read_b64_tr_b16 a[214:215], v9 offset:19456
    v_accvgpr_write_b32 a184, 1.0
    v_mfma_f32_16x16x32_bf16 v[100:103], a[196:199], a[16:19], v[100:103]
    buffer_load_dwordx4 a[76:79], v28, s[20:23], s46 offen offset:3072 sc1
    v_mfma_f32_16x16x32_bf16 v[100:103], a[192:195], a[0:3], v[100:103]
    s_waitcnt lgkmcnt(4)
    v_accvgpr_write_b32 a185, 1.0
    v_accvgpr_write_b32 a186, 1.0
    v_mfma_f32_16x16x32_bf16 v[128:131], a[200:203], a[0:3], v[128:131]
    ds_read_b64_tr_b16 a[192:193], v10 offset:1024
    v_accvgpr_write_b32 a187, 1.0
    v_mfma_f32_16x16x32_bf16 v[128:131], a[204:207], a[16:19], v[128:131]
    ds_read_b64_tr_b16 a[194:195], v10 offset:7168
    v_accvgpr_write_b32 a188, 1.0
    v_mfma_f32_16x16x32_bf16 v[136:139], a[204:207], a[20:23], v[136:139]
    v_accvgpr_write_b32 a189, 1.0
    v_accvgpr_write_b32 a190, 1.0
    v_mfma_f32_16x16x32_bf16 v[136:139], a[200:203], a[4:7], v[136:139]
    v_accvgpr_write_b32 a191, 1.0
    v_mfma_f32_16x16x32_bf16 v[144:147], a[200:203], a[8:11], v[144:147]
    s_add_u32 m0, s49, 122880
    ds_read_b64_tr_b16 a[196:197], v10 offset:13312
    v_mfma_f32_16x16x32_bf16 v[144:147], a[204:207], a[24:27], v[144:147]
    ds_read_b64_tr_b16 a[198:199], v10 offset:19456
    v_mfma_f32_16x16x32_bf16 v[152:155], a[204:207], a[28:31], v[152:155]
    buffer_load_dwordx4 v2, s[8:11], s36 offen offset:0 lds
    v_mfma_f32_16x16x32_bf16 v[152:155], a[200:203], a[12:15], v[152:155]
    s_waitcnt lgkmcnt(4)
    v_mfma_f32_16x16x32_bf16 v[156:159], a[208:211], a[12:15], v[156:159]
    ds_read_b64_tr_b16 a[200:201], v11 offset:1024
    v_mfma_f32_16x16x32_bf16 v[156:159], a[212:215], a[28:31], v[156:159]
    ds_read_b64_tr_b16 a[202:203], v11 offset:7168
    v_mfma_f32_16x16x32_bf16 v[148:151], a[212:215], a[24:27], v[148:151]
    s_add_u32 m0, s49, 123776
    v_mfma_f32_16x16x32_bf16 v[148:151], a[208:211], a[8:11], v[148:151]
    buffer_load_dwordx4 v2, s[8:11], s36 offen offset:128 lds
    v_mfma_f32_16x16x32_bf16 v[140:143], a[208:211], a[4:7], v[140:143]
    ds_read_b64_tr_b16 a[204:205], v11 offset:13312
    v_mfma_f32_16x16x32_bf16 v[140:143], a[212:215], a[20:23], v[140:143]
    ds_read_b64_tr_b16 a[206:207], v11 offset:19456
    v_mfma_f32_16x16x32_bf16 v[132:135], a[212:215], a[16:19], v[132:135]
    v_mfma_f32_16x16x32_bf16 v[132:135], a[208:211], a[0:3], v[132:135]
    s_waitcnt lgkmcnt(4)
    v_mfma_f32_16x16x32_bf16 v[160:163], a[192:195], a[0:3], v[160:163]
    ds_read_b64_tr_b16 a[208:209], v8 offset:2048
    v_mfma_f32_16x16x32_bf16 v[160:163], a[196:199], a[16:19], v[160:163]
    s_add_u32 m0, s49, 124672
    ds_read_b64_tr_b16 a[210:211], v8 offset:8192
    v_mfma_f32_16x16x32_bf16 v[168:171], a[196:199], a[20:23], v[168:171]
    buffer_load_dwordx4 v2, s[8:11], s36 offen offset:256 lds
    v_mfma_f32_16x16x32_bf16 v[168:171], a[192:195], a[4:7], v[168:171]
    v_mfma_f32_16x16x32_bf16 v[176:179], a[192:195], a[8:11], v[176:179]
    ds_read_b64_tr_b16 a[212:213], v8 offset:14336
    v_mfma_f32_16x16x32_bf16 v[176:179], a[196:199], a[24:27], v[176:179]
    ds_read_b64_tr_b16 a[214:215], v8 offset:20480
    v_mfma_f32_16x16x32_bf16 v[184:187], a[196:199], a[28:31], v[184:187]
    v_add_u32 v8, 73728, v12
    v_mfma_f32_16x16x32_bf16 v[184:187], a[192:195], a[12:15], v[184:187]
    s_waitcnt lgkmcnt(4)
    s_add_u32 m0, s49, 125952
    v_mfma_f32_16x16x32_bf16 v[188:191], a[200:203], a[12:15], v[188:191]
    ds_read_b64_tr_b16 a[192:193], v9 offset:2048
    v_mfma_f32_16x16x32_bf16 v[188:191], a[204:207], a[28:31], v[188:191]
    ds_read_b64_tr_b16 a[194:195], v9 offset:8192
    v_mfma_f32_16x16x32_bf16 v[180:183], a[204:207], a[24:27], v[180:183]
    buffer_load_dwordx4 v3, s[8:11], s36 offen offset:0 lds
    v_mfma_f32_16x16x32_bf16 v[180:183], a[200:203], a[8:11], v[180:183]
    v_mfma_f32_16x16x32_bf16 v[172:175], a[200:203], a[4:7], v[172:175]
    ds_read_b64_tr_b16 a[196:197], v9 offset:14336
    v_mfma_f32_16x16x32_bf16 v[172:175], a[204:207], a[20:23], v[172:175]
    ds_read_b64_tr_b16 a[198:199], v9 offset:20480
    v_mfma_f32_16x16x32_bf16 v[164:167], a[204:207], a[16:19], v[164:167]
    s_add_u32 m0, s49, 126848
    v_add_u32 v9, 73728, v13
    v_mfma_f32_16x16x32_bf16 v[164:167], a[200:203], a[0:3], v[164:167]
    s_waitcnt lgkmcnt(4)
    v_mfma_f32_16x16x32_bf16 v[192:195], a[208:211], a[0:3], v[192:195]
    ds_read_b64_tr_b16 a[200:201], v10 offset:2048
    v_mfma_f32_16x16x32_bf16 v[192:195], a[212:215], a[16:19], v[192:195]
    ds_read_b64_tr_b16 a[202:203], v10 offset:8192
    v_mfma_f32_16x16x32_bf16 v[200:203], a[212:215], a[20:23], v[200:203]
    buffer_load_dwordx4 v3, s[8:11], s36 offen offset:128 lds
    v_mfma_f32_16x16x32_bf16 v[200:203], a[208:211], a[4:7], v[200:203]
    v_mfma_f32_16x16x32_bf16 v[208:211], a[208:211], a[8:11], v[208:211]
    s_add_u32 m0, s49, 127744
    ds_read_b64_tr_b16 a[204:205], v10 offset:14336
    v_mfma_f32_16x16x32_bf16 v[208:211], a[212:215], a[24:27], v[208:211]
    ds_read_b64_tr_b16 a[206:207], v10 offset:20480
    v_mfma_f32_16x16x32_bf16 v[216:219], a[212:215], a[28:31], v[216:219]
    buffer_load_dwordx4 v3, s[8:11], s36 offen offset:256 lds
    v_mfma_f32_16x16x32_bf16 v[216:219], a[208:211], a[12:15], v[216:219]
    s_waitcnt lgkmcnt(4)
    v_add_u32 v10, 73728, v14
    s_add_u32 s36, s36, s37
    v_mfma_f32_16x16x32_bf16 v[220:223], a[192:195], a[12:15], v[220:223]
    s_sub_u32 s55, s36, 7864320
    ds_read_b64_tr_b16 a[208:209], v11 offset:2048
    s_min_u32 s36, s36, s55
    v_mfma_f32_16x16x32_bf16 v[220:223], a[196:199], a[28:31], v[220:223]
    s_add_u32 s46, s45, 69632
    ds_read_b64_tr_b16 a[210:211], v11 offset:8192
    s_sub_u32 s77, s46, 81920
    v_mfma_f32_16x16x32_bf16 v[212:215], a[196:199], a[24:27], v[212:215]
    s_min_u32 s46, s46, s77
    v_mfma_f32_16x16x32_bf16 v[212:215], a[192:195], a[8:11], v[212:215]
    v_mfma_f32_16x16x32_bf16 v[204:207], a[192:195], a[4:7], v[204:207]
    ds_read_b64_tr_b16 a[212:213], v11 offset:14336
    v_mfma_f32_16x16x32_bf16 v[204:207], a[196:199], a[20:23], v[204:207]
    s_waitcnt vmcnt(36)
    ds_read_b64_tr_b16 a[214:215], v11 offset:20480
    v_mfma_f32_16x16x32_bf16 v[196:199], a[196:199], a[16:19], v[196:199]
    s_barrier
    v_mfma_f32_16x16x32_bf16 v[196:199], a[192:195], a[0:3], v[196:199]
    s_waitcnt lgkmcnt(4)
    buffer_load_dwordx4 a[80:83], v28, s[20:23], s46 offen offset:0 sc1
    v_mfma_f32_16x16x32_bf16 v[224:227], a[200:203], a[0:3], v[224:227]
    ds_read_b64_tr_b16 a[192:193], v8 offset:0
    v_add_u32 v11, 73728, v15
    v_mfma_f32_16x16x32_bf16 v[224:227], a[204:207], a[16:19], v[224:227]
    ds_read_b64_tr_b16 a[194:195], v8 offset:6144
    v_mfma_f32_16x16x32_bf16 v[232:235], a[204:207], a[20:23], v[232:235]
    buffer_load_dwordx4 a[84:87], v28, s[20:23], s46 offen offset:1024 sc1
    v_mfma_f32_16x16x32_bf16 v[232:235], a[200:203], a[4:7], v[232:235]
    v_mfma_f32_16x16x32_bf16 v[240:243], a[200:203], a[8:11], v[240:243]
    ds_read_b64_tr_b16 a[196:197], v8 offset:12288
    v_mfma_f32_16x16x32_bf16 v[240:243], a[204:207], a[24:27], v[240:243]
    ds_read_b64_tr_b16 a[198:199], v8 offset:18432
    v_mfma_f32_16x16x32_bf16 v[248:251], a[204:207], a[28:31], v[248:251]
    v_mfma_f32_16x16x32_bf16 v[248:251], a[200:203], a[12:15], v[248:251]
    s_waitcnt lgkmcnt(4)
    v_mfma_f32_16x16x32_bf16 v[252:255], a[208:211], a[12:15], v[252:255]
    ds_read_b64_tr_b16 a[200:201], v9 offset:0
    v_mfma_f32_16x16x32_bf16 v[252:255], a[212:215], a[28:31], v[252:255]
    ds_read_b64_tr_b16 a[202:203], v9 offset:6144
    v_mfma_f32_16x16x32_bf16 v[244:247], a[212:215], a[24:27], v[244:247]
    buffer_load_dwordx4 a[88:91], v28, s[20:23], s46 offen offset:2048 sc1
    v_mfma_f32_16x16x32_bf16 v[244:247], a[208:211], a[8:11], v[244:247]
    v_mfma_f32_16x16x32_bf16 v[236:239], a[208:211], a[4:7], v[236:239]
    ds_read_b64_tr_b16 a[204:205], v9 offset:12288
    v_mfma_f32_16x16x32_bf16 v[236:239], a[212:215], a[20:23], v[236:239]
    s_waitcnt vmcnt(31)
    s_waitcnt vmcnt(21)
    ds_read_b64_tr_b16 a[206:207], v9 offset:18432
    v_mfma_f32_16x16x32_bf16 v[228:231], a[212:215], a[16:19], v[228:231]
    v_mfma_f32_16x16x32_bf16 v[228:231], a[208:211], a[0:3], v[228:231]
    s_waitcnt lgkmcnt(4)
    v_mfma_f32_16x16x32_bf16 v[64:67], a[192:195], a[32:35], v[64:67]
    ds_read_b64_tr_b16 a[208:209], v10 offset:0
    v_mfma_f32_16x16x32_bf16 v[64:67], a[196:199], a[48:51], v[64:67]
    ds_read_b64_tr_b16 a[210:211], v10 offset:6144
    v_accvgpr_write_b32 a0, 1.0
    v_mfma_f32_16x16x32_bf16 v[72:75], a[196:199], a[52:55], v[72:75]
    buffer_load_dwordx4 a[92:95], v28, s[20:23], s46 offen offset:3072 sc1
    v_mfma_f32_16x16x32_bf16 v[72:75], a[192:195], a[36:39], v[72:75]
    s_add_u32 s46, s45, 73728
    v_accvgpr_write_b32 a1, 1.0
    v_mfma_f32_16x16x32_bf16 v[80:83], a[192:195], a[40:43], v[80:83]
    s_sub_u32 s77, s46, 81920
    ds_read_b64_tr_b16 a[212:213], v10 offset:12288
    v_accvgpr_write_b32 a2, 1.0
    v_mfma_f32_16x16x32_bf16 v[80:83], a[196:199], a[56:59], v[80:83]
    s_min_u32 s46, s46, s77
    ds_read_b64_tr_b16 a[214:215], v10 offset:18432
    v_accvgpr_write_b32 a3, 1.0
    v_mfma_f32_16x16x32_bf16 v[88:91], a[196:199], a[60:63], v[88:91]
    buffer_load_dwordx4 a[224:227], v28, s[20:23], s46 offen offset:0 sc1
    v_mfma_f32_16x16x32_bf16 v[88:91], a[192:195], a[44:47], v[88:91]
    s_waitcnt lgkmcnt(4)
    v_accvgpr_write_b32 a4, 1.0
    v_mfma_f32_16x16x32_bf16 v[92:95], a[200:203], a[44:47], v[92:95]
    s_waitcnt vmcnt(20)
    ds_read_b64_tr_b16 a[192:193], v11 offset:0
    v_lshlrev_b32 v42, 16, v48
    v_mfma_f32_16x16x32_bf16 v[92:95], a[204:207], a[60:63], v[92:95]
    ds_read_b64_tr_b16 a[194:195], v11 offset:6144
    v_and_b32 v43, 0xffff0000, v48
    v_mfma_f32_16x16x32_bf16 v[84:87], a[204:207], a[56:59], v[84:87]
    v_sub_f32 v42, v42, v40
    v_sub_f32 v43, v43, v40
    v_mfma_f32_16x16x32_bf16 v[84:87], a[200:203], a[40:43], v[84:87]
    v_cvt_pk_bf16_f32 v44, v42, v43
    v_lshlrev_b32 v42, 16, v44
    v_mfma_f32_16x16x32_bf16 v[76:79], a[200:203], a[36:39], v[76:79]
    ds_read_b64_tr_b16 a[196:197], v11 offset:12288
    v_and_b32 v43, 0xffff0000, v44
    v_mfma_f32_16x16x32_bf16 v[76:79], a[204:207], a[52:55], v[76:79]
    ds_read_b64_tr_b16 a[198:199], v11 offset:18432
    v_mul_f32 v42, v42, v41
    v_mfma_f32_16x16x32_bf16 v[68:71], a[204:207], a[48:51], v[68:71]
    buffer_load_dwordx4 a[228:231], v28, s[20:23], s46 offen offset:1024 sc1
    v_mfma_f32_16x16x32_bf16 v[68:71], a[200:203], a[32:35], v[68:71]
    s_waitcnt lgkmcnt(4)
    v_mul_f32 v43, v43, v41
    v_cvt_pk_bf16_f32 v48, v42, v43
    v_mfma_f32_16x16x32_bf16 v[96:99], a[208:211], a[32:35], v[96:99]
    ds_read_b64_tr_b16 a[200:201], v8 offset:1024
    v_lshlrev_b32 v42, 16, v49
    v_mfma_f32_16x16x32_bf16 v[96:99], a[212:215], a[48:51], v[96:99]
    ds_read_b64_tr_b16 a[202:203], v8 offset:7168
    v_and_b32 v43, 0xffff0000, v49
    v_mfma_f32_16x16x32_bf16 v[104:107], a[212:215], a[52:55], v[104:107]
    s_waitcnt vmcnt(20)
    v_sub_f32 v42, v42, v40
    v_sub_f32 v43, v43, v40
    v_mfma_f32_16x16x32_bf16 v[104:107], a[208:211], a[36:39], v[104:107]
    buffer_load_dwordx4 a[232:235], v28, s[20:23], s46 offen offset:2048 sc1
    v_mfma_f32_16x16x32_bf16 v[112:115], a[208:211], a[40:43], v[112:115]
    ds_read_b64_tr_b16 a[204:205], v8 offset:13312
    v_cvt_pk_bf16_f32 v44, v42, v43
    v_mfma_f32_16x16x32_bf16 v[112:115], a[212:215], a[56:59], v[112:115]
    ds_read_b64_tr_b16 a[206:207], v8 offset:19456
    v_lshlrev_b32 v42, 16, v44
    v_mfma_f32_16x16x32_bf16 v[120:123], a[212:215], a[60:63], v[120:123]
    v_and_b32 v43, 0xffff0000, v44
    v_mul_f32 v42, v42, v41
    v_mfma_f32_16x16x32_bf16 v[120:123], a[208:211], a[44:47], v[120:123]
    s_waitcnt lgkmcnt(4)
    v_mul_f32 v43, v43, v41
    v_cvt_pk_bf16_f32 v49, v42, v43
    v_mfma_f32_16x16x32_bf16 v[124:127], a[192:195], a[44:47], v[124:127]
    ds_read_b64_tr_b16 a[208:209], v9 offset:1024
    v_lshlrev_b32 v42, 16, v50
    v_mfma_f32_16x16x32_bf16 v[124:127], a[196:199], a[60:63], v[124:127]
    ds_read_b64_tr_b16 a[210:211], v9 offset:7168
    v_and_b32 v43, 0xffff0000, v50
    v_mfma_f32_16x16x32_bf16 v[116:119], a[196:199], a[56:59], v[116:119]
    buffer_load_dwordx4 a[236:239], v28, s[20:23], s46 offen offset:3072 sc1
    v_mfma_f32_16x16x32_bf16 v[116:119], a[192:195], a[40:43], v[116:119]
    v_sub_f32 v42, v42, v40
    v_sub_f32 v43, v43, v40
    v_mfma_f32_16x16x32_bf16 v[108:111], a[192:195], a[36:39], v[108:111]
    s_add_u32 s46, s45, 77824
    ds_read_b64_tr_b16 a[212:213], v9 offset:13312
    v_cvt_pk_bf16_f32 v44, v42, v43
    v_mfma_f32_16x16x32_bf16 v[108:111], a[196:199], a[52:55], v[108:111]
    s_sub_u32 s77, s46, 81920
    ds_read_b64_tr_b16 a[214:215], v9 offset:19456
    v_lshlrev_b32 v42, 16, v44
    v_mfma_f32_16x16x32_bf16 v[100:103], a[196:199], a[48:51], v[100:103]
    s_min_u32 s46, s46, s77
    v_and_b32 v43, 0xffff0000, v44
    v_mul_f32 v42, v42, v41
    v_mfma_f32_16x16x32_bf16 v[100:103], a[192:195], a[32:35], v[100:103]
    s_waitcnt lgkmcnt(4)
    v_mul_f32 v43, v43, v41
    v_cvt_pk_bf16_f32 v50, v42, v43
    v_mfma_f32_16x16x32_bf16 v[128:131], a[200:203], a[32:35], v[128:131]
    ds_read_b64_tr_b16 a[192:193], v10 offset:1024
    v_lshlrev_b32 v42, 16, v51
    v_mfma_f32_16x16x32_bf16 v[128:131], a[204:207], a[48:51], v[128:131]
    ds_read_b64_tr_b16 a[194:195], v10 offset:7168
    v_and_b32 v43, 0xffff0000, v51
    v_mfma_f32_16x16x32_bf16 v[136:139], a[204:207], a[52:55], v[136:139]
    buffer_load_dwordx4 a[240:243], v28, s[20:23], s46 offen offset:0 sc1
    v_mfma_f32_16x16x32_bf16 v[136:139], a[200:203], a[36:39], v[136:139]
    v_sub_f32 v42, v42, v40
    v_sub_f32 v43, v43, v40
    v_mfma_f32_16x16x32_bf16 v[144:147], a[200:203], a[40:43], v[144:147]
    ds_read_b64_tr_b16 a[196:197], v10 offset:13312
    v_cvt_pk_bf16_f32 v44, v42, v43
    v_mfma_f32_16x16x32_bf16 v[144:147], a[204:207], a[56:59], v[144:147]
    ds_read_b64_tr_b16 a[198:199], v10 offset:19456
    v_lshlrev_b32 v42, 16, v44
    v_mfma_f32_16x16x32_bf16 v[152:155], a[204:207], a[60:63], v[152:155]
    buffer_load_dwordx4 a[244:247], v28, s[20:23], s46 offen offset:1024 sc1
    v_mfma_f32_16x16x32_bf16 v[152:155], a[200:203], a[44:47], v[152:155]
    s_waitcnt lgkmcnt(4)
    v_and_b32 v43, 0xffff0000, v44
    v_mul_f32 v42, v42, v41
    v_mfma_f32_16x16x32_bf16 v[156:159], a[208:211], a[44:47], v[156:159]
    ds_read_b64_tr_b16 a[200:201], v11 offset:1024
    v_mul_f32 v43, v43, v41
    v_mfma_f32_16x16x32_bf16 v[156:159], a[212:215], a[60:63], v[156:159]
    ds_read_b64_tr_b16 a[202:203], v11 offset:7168
    v_cvt_pk_bf16_f32 v51, v42, v43
    v_mfma_f32_16x16x32_bf16 v[148:151], a[212:215], a[56:59], v[148:151]
    v_lshlrev_b32 v42, 16, v52
    v_and_b32 v43, 0xffff0000, v52
    v_mfma_f32_16x16x32_bf16 v[148:151], a[208:211], a[40:43], v[148:151]
    v_sub_f32 v42, v42, v40
    v_sub_f32 v43, v43, v40
    v_mfma_f32_16x16x32_bf16 v[140:143], a[208:211], a[36:39], v[140:143]
    ds_read_b64_tr_b16 a[204:205], v11 offset:13312
    v_cvt_pk_bf16_f32 v44, v42, v43
    v_mfma_f32_16x16x32_bf16 v[140:143], a[212:215], a[52:55], v[140:143]
    ds_read_b64_tr_b16 a[206:207], v11 offset:19456
    v_lshlrev_b32 v42, 16, v44
    v_mfma_f32_16x16x32_bf16 v[132:135], a[212:215], a[48:51], v[132:135]
    buffer_load_dwordx4 a[248:251], v28, s[20:23], s46 offen offset:2048 sc1
    v_mfma_f32_16x16x32_bf16 v[132:135], a[208:211], a[32:35], v[132:135]
    s_waitcnt lgkmcnt(4)
    v_and_b32 v43, 0xffff0000, v44
    v_mul_f32 v42, v42, v41
    v_mfma_f32_16x16x32_bf16 v[160:163], a[192:195], a[32:35], v[160:163]
    ds_read_b64_tr_b16 a[208:209], v8 offset:2048
    v_mul_f32 v43, v43, v41
    v_mfma_f32_16x16x32_bf16 v[160:163], a[196:199], a[48:51], v[160:163]
    ds_read_b64_tr_b16 a[210:211], v8 offset:8192
    v_cvt_pk_bf16_f32 v52, v42, v43
    v_mfma_f32_16x16x32_bf16 v[168:171], a[196:199], a[52:55], v[168:171]
    v_lshlrev_b32 v42, 16, v53
    v_and_b32 v43, 0xffff0000, v53
    v_mfma_f32_16x16x32_bf16 v[168:171], a[192:195], a[36:39], v[168:171]
    buffer_load_dwordx4 a[252:255], v28, s[20:23], s46 offen offset:3072 sc1
    v_mfma_f32_16x16x32_bf16 v[176:179], a[192:195], a[40:43], v[176:179]
    ds_read_b64_tr_b16 a[212:213], v8 offset:14336
    v_sub_f32 v42, v42, v40
    v_mfma_f32_16x16x32_bf16 v[176:179], a[196:199], a[56:59], v[176:179]
    ds_read_b64_tr_b16 a[214:215], v8 offset:20480
    v_sub_f32 v43, v43, v40
    v_mfma_f32_16x16x32_bf16 v[184:187], a[196:199], a[60:63], v[184:187]
    v_cvt_pk_bf16_f32 v44, v42, v43
    v_lshlrev_b32 v42, 16, v44
    v_mfma_f32_16x16x32_bf16 v[184:187], a[192:195], a[44:47], v[184:187]
    s_waitcnt lgkmcnt(4)
    v_and_b32 v43, 0xffff0000, v44
    v_mul_f32 v42, v42, v41
    v_mfma_f32_16x16x32_bf16 v[188:191], a[200:203], a[44:47], v[188:191]
    ds_read_b64_tr_b16 a[192:193], v9 offset:2048
    v_mul_f32 v43, v43, v41
    v_mfma_f32_16x16x32_bf16 v[188:191], a[204:207], a[60:63], v[188:191]
    s_add_u32 m0, s49, 0
    ds_read_b64_tr_b16 a[194:195], v9 offset:8192
    v_cvt_pk_bf16_f32 v53, v42, v43
    v_mfma_f32_16x16x32_bf16 v[180:183], a[204:207], a[56:59], v[180:183]
    buffer_load_dwordx4 v4, s[12:15], s38 offen offset:0 lds
    v_mfma_f32_16x16x32_bf16 v[180:183], a[200:203], a[40:43], v[180:183]
    v_lshlrev_b32 v42, 16, v54
    v_and_b32 v43, 0xffff0000, v54
    v_mfma_f32_16x16x32_bf16 v[172:175], a[200:203], a[36:39], v[172:175]
    ds_read_b64_tr_b16 a[196:197], v9 offset:14336
    v_sub_f32 v42, v42, v40
    v_mfma_f32_16x16x32_bf16 v[172:175], a[204:207], a[52:55], v[172:175]
    ds_read_b64_tr_b16 a[198:199], v9 offset:20480
    v_sub_f32 v43, v43, v40
    v_mfma_f32_16x16x32_bf16 v[164:167], a[204:207], a[48:51], v[164:167]
    v_cvt_pk_bf16_f32 v44, v42, v43
    v_lshlrev_b32 v42, 16, v44
    v_mfma_f32_16x16x32_bf16 v[164:167], a[200:203], a[32:35], v[164:167]
    s_waitcnt lgkmcnt(4)
    v_and_b32 v43, 0xffff0000, v44
    v_mul_f32 v42, v42, v41
    v_mfma_f32_16x16x32_bf16 v[192:195], a[208:211], a[32:35], v[192:195]
    s_add_u32 m0, s49, 896
    ds_read_b64_tr_b16 a[200:201], v10 offset:2048
    v_mul_f32 v43, v43, v41
    v_mfma_f32_16x16x32_bf16 v[192:195], a[212:215], a[48:51], v[192:195]
    ds_read_b64_tr_b16 a[202:203], v10 offset:8192
    v_cvt_pk_bf16_f32 v54, v42, v43
    v_mfma_f32_16x16x32_bf16 v[200:203], a[212:215], a[52:55], v[200:203]
    buffer_load_dwordx4 v4, s[12:15], s38 offen offset:128 lds
    v_mfma_f32_16x16x32_bf16 v[200:203], a[208:211], a[36:39], v[200:203]
    v_lshlrev_b32 v42, 16, v55
    v_and_b32 v43, 0xffff0000, v55
    v_mfma_f32_16x16x32_bf16 v[208:211], a[208:211], a[40:43], v[208:211]
    ds_read_b64_tr_b16 a[204:205], v10 offset:14336
    v_sub_f32 v42, v42, v40
    v_mfma_f32_16x16x32_bf16 v[208:211], a[212:215], a[56:59], v[208:211]
    ds_read_b64_tr_b16 a[206:207], v10 offset:20480
    v_sub_f32 v43, v43, v40
    v_mfma_f32_16x16x32_bf16 v[216:219], a[212:215], a[60:63], v[216:219]
    s_add_u32 m0, s49, 1792
    v_cvt_pk_bf16_f32 v44, v42, v43
    v_lshlrev_b32 v42, 16, v44
    v_mfma_f32_16x16x32_bf16 v[216:219], a[208:211], a[44:47], v[216:219]
    s_waitcnt lgkmcnt(4)
    v_and_b32 v43, 0xffff0000, v44
    v_mul_f32 v42, v42, v41
    v_mfma_f32_16x16x32_bf16 v[220:223], a[192:195], a[44:47], v[220:223]
    ds_read_b64_tr_b16 a[208:209], v11 offset:2048
    v_mul_f32 v43, v43, v41
    v_mfma_f32_16x16x32_bf16 v[220:223], a[196:199], a[60:63], v[220:223]
    ds_read_b64_tr_b16 a[210:211], v11 offset:8192
    v_cvt_pk_bf16_f32 v55, v42, v43
    v_mfma_f32_16x16x32_bf16 v[212:215], a[196:199], a[56:59], v[212:215]
    buffer_load_dwordx4 v4, s[12:15], s38 offen offset:256 lds
    v_mfma_f32_16x16x32_bf16 v[212:215], a[192:195], a[40:43], v[212:215]
    v_lshrrev_b32 v60, 14, v61
    v_and_b32 v61, 0x2000, v61
    v_mfma_f32_16x16x32_bf16 v[204:207], a[192:195], a[36:39], v[204:207]
    s_add_u32 m0, s49, 3072
    ds_read_b64_tr_b16 a[212:213], v11 offset:14336
    v_cmp_ne_u32 s[88:89], 0, v60
    v_mfma_f32_16x16x32_bf16 v[204:207], a[196:199], a[52:55], v[204:207]
    s_waitcnt vmcnt(25)
    ds_read_b64_tr_b16 a[214:215], v11 offset:20480
    v_accvgpr_write_b32 a5, 1.0
    v_mfma_f32_16x16x32_bf16 v[196:199], a[196:199], a[48:51], v[196:199]
    s_barrier
    v_mfma_f32_16x16x32_bf16 v[196:199], a[192:195], a[32:35], v[196:199]
    s_waitcnt lgkmcnt(4)
    buffer_load_dwordx4 v5, s[12:15], s38 offen offset:0 lds
    v_add_u32 v8, 98304, v12
    v_mfma_f32_16x16x32_bf16 v[224:227], a[200:203], a[32:35], v[224:227]
    s_lshr_b64 s[88:89], s[88:89], 12
    ds_read_b64_tr_b16 a[192:193], v8 offset:0
    v_accvgpr_write_b32 a6, 1.0
    v_mfma_f32_16x16x32_bf16 v[224:227], a[204:207], a[48:51], v[224:227]
    s_bcnt1_i32_b64 s93, s[88:89]
    ds_read_b64_tr_b16 a[194:195], v8 offset:6144
    v_cmp_ne_u32 s[88:89], 0, v61
    v_mfma_f32_16x16x32_bf16 v[232:235], a[204:207], a[52:55], v[232:235]
    s_cmp_gt_u32 s93, 26
    s_cselect_b32 s93, -1, 0
    v_accvgpr_write_b32 a7, 1.0
    v_mfma_f32_16x16x32_bf16 v[232:235], a[200:203], a[36:39], v[232:235]
    s_add_u32 m0, s49, 3968
    v_accvgpr_write_b32 a8, 1.0
    v_accvgpr_write_b32 a9, 1.0
    v_mfma_f32_16x16x32_bf16 v[240:243], a[200:203], a[40:43], v[240:243]
    s_xor_b32 s88, s88, s93
    ds_read_b64_tr_b16 a[196:197], v8 offset:12288
    v_accvgpr_write_b32 a10, 1.0
    v_mfma_f32_16x16x32_bf16 v[240:243], a[204:207], a[56:59], v[240:243]
    s_and_b32 s88, s88, 0xfff
    ds_read_b64_tr_b16 a[198:199], v8 offset:18432
    v_accvgpr_write_b32 a11, 1.0
    v_mfma_f32_16x16x32_bf16 v[248:251], a[204:207], a[60:63], v[248:251]
    buffer_load_dwordx4 v5, s[12:15], s38 offen offset:128 lds
    v_mfma_f32_16x16x32_bf16 v[248:251], a[200:203], a[44:47], v[248:251]
    s_waitcnt lgkmcnt(4)
    v_accvgpr_write_b32 a12, 1.0
    v_accvgpr_write_b32 a13, 1.0
    v_add_u32 v9, 98304, v13
    v_mfma_f32_16x16x32_bf16 v[252:255], a[208:211], a[44:47], v[252:255]
    s_lshl_b32 s93, s88, 13
    ds_read_b64_tr_b16 a[200:201], v9 offset:0
    v_accvgpr_write_b32 a14, 1.0
    v_mfma_f32_16x16x32_bf16 v[252:255], a[212:215], a[60:63], v[252:255]
    s_add_u32 m0, s49, 4864
    ds_read_b64_tr_b16 a[202:203], v9 offset:6144
    v_accvgpr_write_b32 a15, 1.0
    v_mfma_f32_16x16x32_bf16 v[244:247], a[212:215], a[56:59], v[244:247]
    buffer_load_dwordx4 v5, s[12:15], s38 offen offset:256 lds
    v_mfma_f32_16x16x32_bf16 v[244:247], a[208:211], a[40:43], v[244:247]
pg_4:
    s_cbranch_execz pg_8
    s_add_u32 s38, s38, 24576
    v_accvgpr_write_b32 a16, 1.0
    v_accvgpr_write_b32 a17, 1.0
    v_mfma_f32_16x16x32_bf16 v[236:239], a[208:211], a[36:39], v[236:239]
    s_add_u32 s88, s51, 8
    ds_read_b64_tr_b16 a[204:205], v9 offset:12288
    v_accvgpr_write_b32 a18, 1.0
    v_mfma_f32_16x16x32_bf16 v[236:239], a[212:215], a[52:55], v[236:239]
    s_waitcnt vmcnt(24)
    s_waitcnt vmcnt(14)
    ds_read_b64_tr_b16 a[206:207], v9 offset:18432
    v_mfma_f32_16x16x32_bf16 v[228:231], a[212:215], a[48:51], v[228:231]
    s_lshr_b32 s88, s93, s88
    v_accvgpr_write_b32 a19, 1.0
    v_accvgpr_write_b32 a20, 1.0
    v_mfma_f32_16x16x32_bf16 v[228:231], a[208:211], a[32:35], v[228:231]
    s_waitcnt lgkmcnt(4)
    v_accvgpr_write_b32 a21, 1.0
    v_accvgpr_write_b32 a22, 1.0
    v_add_u32 v10, 98304, v14
    v_mfma_f32_16x16x32_bf16 v[64:67], a[192:195], a[64:67], v[64:67]
    s_add_u32 m0, s49, 24576
    ds_read_b64_tr_b16 a[208:209], v10 offset:0
    v_accvgpr_write_b32 a23, 1.0
    v_mfma_f32_16x16x32_bf16 v[64:67], a[196:199], a[80:83], v[64:67]
    s_and_b32 s88, s88, 0x2000
    ds_read_b64_tr_b16 a[210:211], v10 offset:6144
    v_accvgpr_write_b32 a24, 1.0
    v_mfma_f32_16x16x32_bf16 v[72:75], a[196:199], a[84:87], v[72:75]
    s_add_u32 s5, s5, s88
    ds_read_b64_tr_b16 v[32:33], v25 offset:0
    v_accvgpr_write_b32 a25, 1.0
    v_mfma_f32_16x16x32_bf16 v[72:75], a[192:195], a[68:71], v[72:75]
    s_lshl_b32 s88, s52, 15
    ds_read_b64_tr_b16 v[34:35], v25 offset:4096
    v_accvgpr_write_b32 a26, 1.0
    v_mfma_f32_16x16x32_bf16 v[80:83], a[192:195], a[72:75], v[80:83]
    s_lshl_b32 s89, s53, 9
    ds_read_b64_tr_b16 a[212:213], v10 offset:12288
    v_accvgpr_write_b32 a27, 1.0
    v_mfma_f32_16x16x32_bf16 v[80:83], a[196:199], a[88:91], v[80:83]
    s_add_u32 s88, s88, s89
    ds_read_b64_tr_b16 a[214:215], v10 offset:18432
    v_accvgpr_write_b32 a28, 1.0
    v_mfma_f32_16x16x32_bf16 v[88:91], a[196:199], a[92:95], v[88:91]
    s_lshl_b32 s89, s3, 7
    ds_read_b64_tr_b16 v[36:37], v25 offset:1024
    v_accvgpr_write_b32 a29, 1.0
    v_mfma_f32_16x16x32_bf16 v[88:91], a[192:195], a[76:79], v[88:91]
    s_waitcnt lgkmcnt(4)
    buffer_load_dwordx4 v4, s[12:15], s38 offen offset:0 lds
    v_add_u32 v11, 98304, v15
    v_mfma_f32_16x16x32_bf16 v[92:95], a[200:203], a[76:79], v[92:95]
    s_add_u32 m0, s49, 25472
    ds_read_b64_tr_b16 a[192:193], v11 offset:0
    v_accvgpr_write_b32 a30, 1.0
    v_mfma_f32_16x16x32_bf16 v[92:95], a[204:207], a[92:95], v[92:95]
    s_add_u32 s88, s88, s89
    ds_read_b64_tr_b16 a[194:195], v11 offset:6144
    v_accvgpr_write_b32 a31, 1.0
    v_mfma_f32_16x16x32_bf16 v[84:87], a[204:207], a[88:91], v[84:87]
    s_add_u32 s88, s88, 4456452
    ds_read_b64_tr_b16 v[38:39], v25 offset:5120
    v_accvgpr_write_b32 a32, 1.0
    v_mfma_f32_16x16x32_bf16 v[84:87], a[200:203], a[72:75], v[84:87]
    s_lshr_b32 s89, s93, 8
    ds_read_b64_tr_b16 v[40:41], v25 offset:8192
    v_lshrrev_b32 v60, v1, s89
    v_mfma_f32_16x16x32_bf16 v[76:79], a[200:203], a[68:71], v[76:79]
    ds_read_b64_tr_b16 a[196:197], v11 offset:12288
    v_and_b32 v60, 0x2000, v60
    v_mfma_f32_16x16x32_bf16 v[76:79], a[204:207], a[84:87], v[76:79]
    ds_read_b64_tr_b16 a[198:199], v11 offset:18432
    v_add_u32 v60, s88, v60
    v_mfma_f32_16x16x32_bf16 v[68:71], a[204:207], a[80:83], v[68:71]
    ds_read_b64_tr_b16 v[42:43], v25 offset:12288
    v_bfe_u32 v61, v1, 1, 1
    v_mfma_f32_16x16x32_bf16 v[68:71], a[200:203], a[64:67], v[68:71]
    s_waitcnt lgkmcnt(4)
    buffer_load_dwordx4 v4, s[12:15], s38 offen offset:128 lds
    v_mfma_f32_16x16x32_bf16 v[96:99], a[208:211], a[64:67], v[96:99]
    s_add_u32 m0, s49, 26368
    ds_read_b64_tr_b16 a[200:201], v8 offset:1024
    v_lshl_add_u32 v60, v61, 14, v60
    v_mfma_f32_16x16x32_bf16 v[96:99], a[212:215], a[80:83], v[96:99]
    ds_read_b64_tr_b16 a[202:203], v8 offset:7168
    v_and_b32 v61, 1, v1
    v_mfma_f32_16x16x32_bf16 v[104:107], a[212:215], a[84:87], v[104:107]
    ds_read_b64_tr_b16 v[44:45], v25 offset:9216
    v_lshl_add_u32 v60, v61, 12, v60
    v_mfma_f32_16x16x32_bf16 v[104:107], a[208:211], a[68:71], v[104:107]
    ds_read_b64_tr_b16 v[46:47], v25 offset:13312
    v_lshrrev_b32 v61, 2, v1
    v_mfma_f32_16x16x32_bf16 v[112:115], a[208:211], a[72:75], v[112:115]
    ds_read_b64_tr_b16 a[204:205], v8 offset:13312
    v_min_u32 v61, 1, v61
    v_mfma_f32_16x16x32_bf16 v[112:115], a[212:215], a[88:91], v[112:115]
    ds_read_b64_tr_b16 a[206:207], v8 offset:19456
    v_lshl_or_b32 v60, v61, 30, v60
    v_mfma_f32_16x16x32_bf16 v[120:123], a[212:215], a[92:95], v[120:123]
    buffer_load_dwordx4 v4, s[12:15], s38 offen offset:256 lds
    v_accvgpr_write_b32 a223, v60
    v_mfma_f32_16x16x32_bf16 v[120:123], a[208:211], a[76:79], v[120:123]
    s_waitcnt lgkmcnt(4)
    v_accvgpr_write_b32 a33, 1.0
    v_accvgpr_write_b32 a34, 1.0
    v_mfma_f32_16x16x32_bf16 v[124:127], a[192:195], a[76:79], v[124:127]
    s_add_u32 m0, s49, 27648
    ds_read_b64_tr_b16 a[208:209], v9 offset:1024
    v_accvgpr_write_b32 a35, 1.0
    v_mfma_f32_16x16x32_bf16 v[124:127], a[196:199], a[92:95], v[124:127]
    s_mul_hi_u32 s47, s58, 429496730
    ds_read_b64_tr_b16 a[210:211], v9 offset:7168
    v_accvgpr_write_b32 a36, 1.0
    v_mfma_f32_16x16x32_bf16 v[116:119], a[196:199], a[88:91], v[116:119]
    buffer_load_dwordx4 v5, s[12:15], s38 offen offset:0 lds
    v_mfma_f32_16x16x32_bf16 v[116:119], a[192:195], a[72:75], v[116:119]
    s_add_u32 m0, s49, 28544
    v_accvgpr_write_b32 a37, 1.0
    v_accvgpr_write_b32 a38, 1.0
    v_mfma_f32_16x16x32_bf16 v[108:111], a[192:195], a[68:71], v[108:111]
    s_lshl_b32 s37, s47, 8
    ds_read_b64_tr_b16 a[212:213], v9 offset:13312
    v_accvgpr_write_b32 a39, 1.0
    v_mfma_f32_16x16x32_bf16 v[108:111], a[196:199], a[84:87], v[108:111]
    s_add_u32 s37, s37, 4718736
    ds_read_b64_tr_b16 a[214:215], v9 offset:19456
    v_accvgpr_write_b32 a40, 1.0
    v_mfma_f32_16x16x32_bf16 v[100:103], a[196:199], a[80:83], v[100:103]
    buffer_load_dwordx4 v5, s[12:15], s38 offen offset:128 lds
    v_mfma_f32_16x16x32_bf16 v[100:103], a[192:195], a[64:67], v[100:103]
    s_waitcnt lgkmcnt(4)
    v_accvgpr_write_b32 a41, 1.0
    v_accvgpr_write_b32 a42, 1.0
    v_mfma_f32_16x16x32_bf16 v[128:131], a[200:203], a[64:67], v[128:131]
    s_add_u32 m0, s49, 29440
    ds_read_b64_tr_b16 a[192:193], v10 offset:1024
    v_accvgpr_write_b32 a43, 1.0
    v_mfma_f32_16x16x32_bf16 v[128:131], a[204:207], a[80:83], v[128:131]
    s_mov_b32 s32, s82
    ds_read_b64_tr_b16 a[194:195], v10 offset:7168
    v_accvgpr_write_b32 a44, 1.0
    v_mfma_f32_16x16x32_bf16 v[136:139], a[204:207], a[84:87], v[136:139]
    v_mfma_f32_16x16x32_bf16 v[20:23], v[48:51], v[32:35], 0
    v_mfma_f32_16x16x32_bf16 v[58:61], v[48:51], v[36:39], 0
    v_mfma_f32_16x16x32_bf16 v[20:23], v[52:55], v[40:43], v[20:23]
    v_mfma_f32_16x16x32_bf16 v[58:61], v[52:55], v[44:47], v[58:61]
    v_mfma_f32_16x16x32_bf16 v[136:139], a[200:203], a[68:71], v[136:139]
    buffer_load_dwordx4 v5, s[12:15], s38 offen offset:256 lds
    v_mfma_f32_16x16x32_bf16 v[144:147], a[200:203], a[72:75], v[144:147]
    s_add_u32 s38, s38, 24576
    ds_read_b64_tr_b16 a[196:197], v10 offset:13312
    v_accvgpr_write_b32 a45, 1.0
    v_mfma_f32_16x16x32_bf16 v[144:147], a[204:207], a[88:91], v[144:147]
    s_and_b32 s33, s83, 0xffff
    ds_read_b64_tr_b16 a[198:199], v10 offset:19456
    v_accvgpr_write_b32 a46, 1.0
    v_mfma_f32_16x16x32_bf16 v[152:155], a[204:207], a[92:95], v[152:155]
    s_mov_b32 s34, 1966080
    v_accvgpr_write_b32 a47, 1.0
    v_accvgpr_write_b32 a48, 1.0
    v_mfma_f32_16x16x32_bf16 v[152:155], a[200:203], a[76:79], v[152:155]
    s_waitcnt lgkmcnt(4)
    v_accvgpr_write_b32 a49, 1.0
    v_accvgpr_write_b32 a50, 1.0
    v_mfma_f32_16x16x32_bf16 v[156:159], a[208:211], a[76:79], v[156:159]
    s_add_u32 m0, s49, 73728
    ds_read_b64_tr_b16 a[200:201], v11 offset:1024
    v_accvgpr_write_b32 a51, 1.0
    v_mfma_f32_16x16x32_bf16 v[156:159], a[212:215], a[92:95], v[156:159]
    s_mov_b32 s35, 0x00020000
    ds_read_b64_tr_b16 a[202:203], v11 offset:7168
    v_accvgpr_write_b32 a52, 1.0
    v_mfma_f32_16x16x32_bf16 v[148:151], a[212:215], a[88:91], v[148:151]
    buffer_load_dwordx4 v6, s[16:19], s40 offen offset:0 lds
    v_mfma_f32_16x16x32_bf16 v[148:151], a[208:211], a[72:75], v[148:151]
    s_mul_i32 s60, s47, 80640
    v_accvgpr_write_b32 a53, 1.0
    v_accvgpr_write_b32 a54, 1.0
    v_mfma_f32_16x16x32_bf16 v[140:143], a[208:211], a[68:71], v[140:143]
    s_lshl_b32 s56, s58, 7
    ds_read_b64_tr_b16 a[204:205], v11 offset:13312
    v_accvgpr_write_b32 a55, 1.0
    v_mfma_f32_16x16x32_bf16 v[140:143], a[212:215], a[84:87], v[140:143]
    s_add_u32 m0, s49, 74624
    ds_read_b64_tr_b16 a[206:207], v11 offset:19456
    v_accvgpr_write_b32 a56, 1.0
    v_mfma_f32_16x16x32_bf16 v[132:135], a[212:215], a[80:83], v[132:135]
    buffer_load_dwordx4 v6, s[16:19], s40 offen offset:128 lds
    v_mfma_f32_16x16x32_bf16 v[132:135], a[208:211], a[64:67], v[132:135]
    s_waitcnt lgkmcnt(4)
    v_accvgpr_write_b32 a57, 1.0
    v_accvgpr_write_b32 a58, 1.0
    v_mfma_f32_16x16x32_bf16 v[160:163], a[192:195], a[64:67], v[160:163]
    s_add_u32 s60, s60, s56
    ds_read_b64_tr_b16 a[208:209], v8 offset:2048
    v_accvgpr_write_b32 a59, 1.0
    v_mfma_f32_16x16x32_bf16 v[160:163], a[196:199], a[80:83], v[160:163]
    s_mul_i32 s56, s53, 983040
    ds_read_b64_tr_b16 a[210:211], v8 offset:8192
    v_accvgpr_write_b32 a60, 1.0
    v_mfma_f32_16x16x32_bf16 v[168:171], a[196:199], a[84:87], v[168:171]
    s_add_u32 s28, s72, s56
    s_addc_u32 s29, s73, 0
    v_accvgpr_write_b32 a61, 1.0
    v_mfma_f32_16x16x32_bf16 v[168:171], a[192:195], a[68:71], v[168:171]
    s_and_b32 s29, s29, 0xffff
    v_accvgpr_write_b32 a62, 1.0
    v_accvgpr_write_b32 a63, 1.0
    v_mfma_f32_16x16x32_bf16 v[176:179], a[192:195], a[72:75], v[176:179]
    s_add_u32 m0, s49, 75520
    ds_read_b64_tr_b16 a[212:213], v8 offset:14336
    v_mov_b32 v22, v58
    v_mfma_f32_16x16x32_bf16 v[176:179], a[196:199], a[88:91], v[176:179]
    s_mov_b32 s30, 983040
    ds_read_b64_tr_b16 a[214:215], v8 offset:20480
    v_mov_b32 v23, v59
    v_mfma_f32_16x16x32_bf16 v[184:187], a[196:199], a[92:95], v[184:187]
    buffer_store_dwordx4 v[20:23], v26, s[24:27], s62 offen sc1
    v_mfma_f32_16x16x32_bf16 v[184:187], a[192:195], a[76:79], v[184:187]
    s_waitcnt lgkmcnt(4)
    buffer_load_dwordx4 v6, s[16:19], s40 offen offset:256 lds
    v_mfma_f32_16x16x32_bf16 v[188:191], a[200:203], a[76:79], v[188:191]
    s_mov_b32 s31, 0x00020000
    ds_read_b64_tr_b16 a[192:193], v9 offset:2048
    v_mov_b32 v32, 0xc0933333
    v_mfma_f32_16x16x32_bf16 v[188:191], a[204:207], a[92:95], v[188:191]
    s_lshr_b32 s48, s2, 3
    ds_read_b64_tr_b16 a[194:195], v9 offset:8192
    v_mov_b32 v33, 0xc0933333
    v_mfma_f32_16x16x32_bf16 v[180:183], a[204:207], a[88:91], v[180:183]
    s_add_u32 m0, s49, 76800
    v_mov_b32 v34, 0xc0933333
    v_mov_b32 v35, 0xc0933333
    v_mfma_f32_16x16x32_bf16 v[180:183], a[200:203], a[72:75], v[180:183]
    buffer_load_dwordx4 v7, s[16:19], s40 offen offset:0 lds
    v_mfma_f32_16x16x32_bf16 v[172:175], a[200:203], a[68:71], v[172:175]
    s_lshl_b32 s48, s48, 2
    ds_read_b64_tr_b16 a[196:197], v9 offset:14336
    v_mov_b32 v36, 0xc0933333
    v_mfma_f32_16x16x32_bf16 v[172:175], a[204:207], a[84:87], v[172:175]
    s_add_u32 s48, s48, s3
    ds_read_b64_tr_b16 a[198:199], v9 offset:20480
    v_mov_b32 v37, 0xc0933333
    v_mfma_f32_16x16x32_bf16 v[164:167], a[204:207], a[80:83], v[164:167]
    s_mul_i32 s6, s48, 7680
    v_lshlrev_b32 v16, 7, v16
    v_mov_b32 v38, 0xc0933333
    v_mfma_f32_16x16x32_bf16 v[164:167], a[200:203], a[64:67], v[164:167]
    s_waitcnt lgkmcnt(4)
    v_mov_b32 v39, 0xc0933333
    v_mov_b32 v40, 0xc0933333
    v_mfma_f32_16x16x32_bf16 v[192:195], a[208:211], a[64:67], v[192:195]
    s_lshl_b32 s57, s51, 8
    ds_read_b64_tr_b16 a[200:201], v10 offset:2048
    v_mov_b32 v41, 0xc0933333
    v_mfma_f32_16x16x32_bf16 v[192:195], a[212:215], a[80:83], v[192:195]
    s_add_u32 m0, s49, 77696
    ds_read_b64_tr_b16 a[202:203], v10 offset:8192
    v_mov_b32 v42, 0xc0933333
    v_mfma_f32_16x16x32_bf16 v[200:203], a[212:215], a[84:87], v[200:203]
    buffer_load_dwordx4 v7, s[16:19], s40 offen offset:128 lds
    v_mfma_f32_16x16x32_bf16 v[200:203], a[208:211], a[68:71], v[200:203]
    s_add_u32 s56, s56, s57
    v_mov_b32 v43, 0xc0933333
    v_mov_b32 v44, 0xc0933333
    v_mfma_f32_16x16x32_bf16 v[208:211], a[208:211], a[72:75], v[208:211]
    s_lshr_b32 s63, s51, 1
    ds_read_b64_tr_b16 a[204:205], v10 offset:14336
    v_mov_b32 v45, 0xc0933333
    v_mfma_f32_16x16x32_bf16 v[208:211], a[212:215], a[88:91], v[208:211]
    s_lshl_b32 s63, s63, 7
    ds_read_b64_tr_b16 a[206:207], v10 offset:20480
    v_mov_b32 v46, 0xc0933333
    v_mfma_f32_16x16x32_bf16 v[216:219], a[212:215], a[92:95], v[216:219]
    s_add_u32 s63, s63, 768
    v_mov_b32 v47, 0xc0933333
    v_add_u32 v8, 122880, v12
    v_mfma_f32_16x16x32_bf16 v[216:219], a[208:211], a[76:79], v[216:219]
    s_waitcnt lgkmcnt(4)
    v_add_u32 v9, 122880, v13
    v_lshrrev_b32 v60, 2, v1
    v_mfma_f32_16x16x32_bf16 v[220:223], a[192:195], a[76:79], v[220:223]
    s_add_u32 m0, s49, 78592
    ds_read_b64_tr_b16 a[208:209], v11 offset:2048
    v_min_u32 v60, 9, v60
    v_mfma_f32_16x16x32_bf16 v[220:223], a[196:199], a[92:95], v[220:223]
    s_sub_u32 s63, s63, s57
    ds_read_b64_tr_b16 a[210:211], v11 offset:8192
    v_mul_u32_u24 v60, 6144, v60
    v_mfma_f32_16x16x32_bf16 v[212:215], a[196:199], a[88:91], v[212:215]
    buffer_load_dwordx4 v7, s[16:19], s40 offen offset:256 lds
    v_mfma_f32_16x16x32_bf16 v[212:215], a[192:195], a[72:75], v[212:215]
    s_add_u32 s40, s40, 24576
    v_and_b32 v61, 3, v1
    v_lshl_add_u32 v60, v61, 2, v60
    v_mfma_f32_16x16x32_bf16 v[204:207], a[192:195], a[68:71], v[204:207]
    s_mov_b32 s66, 0
    ds_read_b64_tr_b16 a[212:213], v11 offset:14336
    v_add_u32 v10, 122880, v14
    v_mfma_f32_16x16x32_bf16 v[204:207], a[196:199], a[84:87], v[204:207]
    s_waitcnt vmcnt(31)
    ds_read_b64_tr_b16 a[214:215], v11 offset:20480
    s_sub_u32 s57, 7864320, s56
    v_mfma_f32_16x16x32_bf16 v[196:199], a[196:199], a[80:83], v[196:199]
    s_barrier
    v_mfma_f32_16x16x32_bf16 v[196:199], a[192:195], a[64:67], v[196:199]
    s_waitcnt lgkmcnt(4)
    v_add_u32 v11, 122880, v15
    s_add_u32 s8, s72, s56
    s_addc_u32 s9, s73, 0
    v_mfma_f32_16x16x32_bf16 v[224:227], a[200:203], a[64:67], v[224:227]
    s_and_b32 s9, s9, 0xffff
    ds_read_b64_tr_b16 a[192:193], v8 offset:0
    s_mov_b32 s10, s57
    v_mfma_f32_16x16x32_bf16 v[224:227], a[204:207], a[80:83], v[224:227]
    s_mov_b32 s11, 0x00020000
    ds_read_b64_tr_b16 a[194:195], v8 offset:6144
    s_mul_i32 s36, s51, 245760
    v_mfma_f32_16x16x32_bf16 v[232:235], a[204:207], a[84:87], v[232:235]
    s_mul_i32 s56, s3, 20480
    s_add_u32 s36, s36, s56
    s_lshl_b32 s59, s53, 23
    v_mfma_f32_16x16x32_bf16 v[232:235], a[200:203], a[68:71], v[232:235]
    s_add_u32 s59, s59, 67108864
    s_add_u32 s20, s86, s59
    s_addc_u32 s21, s87, 0
    v_mfma_f32_16x16x32_bf16 v[240:243], a[200:203], a[72:75], v[240:243]
    s_and_b32 s21, s21, 0xffff
    ds_read_b64_tr_b16 a[196:197], v8 offset:12288
    s_mov_b32 s22, 8388608
    v_mfma_f32_16x16x32_bf16 v[240:243], a[204:207], a[88:91], v[240:243]
    s_mov_b32 s23, 0x00020000
    ds_read_b64_tr_b16 a[198:199], v8 offset:18432
    s_add_u32 s55, s51, 8
    v_mfma_f32_16x16x32_bf16 v[248:251], a[204:207], a[92:95], v[248:251]
    s_lshr_b32 s55, s93, s55
    s_and_b32 s55, s55, 0x2000
    s_lshl_b32 s59, s54, 16
    v_mfma_f32_16x16x32_bf16 v[248:251], a[200:203], a[76:79], v[248:251]
    s_waitcnt lgkmcnt(4)
    s_or_b32 s55, s55, s59
    s_and_b32 s59, s3, 1
    v_mfma_f32_16x16x32_bf16 v[252:255], a[208:211], a[76:79], v[252:255]
    s_lshl_b32 s59, s59, 14
    ds_read_b64_tr_b16 a[200:201], v9 offset:0
    s_or_b32 s55, s55, s59
    v_mfma_f32_16x16x32_bf16 v[252:255], a[212:215], a[92:95], v[252:255]
    s_mul_i32 s59, s51, 0x202000
    ds_read_b64_tr_b16 a[202:203], v9 offset:6144
    s_and_b32 s59, s59, 6299648
    v_mfma_f32_16x16x32_bf16 v[244:247], a[212:215], a[88:91], v[244:247]
    s_xor_b32 s55, s55, s59
    v_lshlrev_b32 v2, 7, v1
    v_and_b32 v3, 3, v1
    v_mfma_f32_16x16x32_bf16 v[244:247], a[208:211], a[72:75], v[244:247]
    v_lshlrev_b32 v3, 11, v3
    v_lshlrev_b32 v28, 4, v1
    v_mfma_f32_16x16x32_bf16 v[236:239], a[208:211], a[68:71], v[236:239]
    ds_read_b64_tr_b16 a[204:205], v9 offset:12288
    v_mov_b32 v31, v16
    v_mfma_f32_16x16x32_bf16 v[236:239], a[212:215], a[84:87], v[236:239]
    s_waitcnt vmcnt(23)
    s_waitcnt vmcnt(19)
    ds_read_b64_tr_b16 a[206:207], v9 offset:18432
    v_mfma_f32_16x16x32_bf16 v[228:231], a[212:215], a[80:83], v[228:231]
    s_mov_b32 s41, s49
    s_add_u32 s42, s49, 24576
    s_add_u32 s43, s49, 49152
    v_mfma_f32_16x16x32_bf16 v[228:231], a[208:211], a[64:67], v[228:231]
    s_waitcnt lgkmcnt(4)
    s_mov_b32 s45, 6
    s_sub_u32 s56, 73728, s49
    v_mfma_f32_16x16x32_bf16 v[64:67], a[192:195], a[224:227], v[64:67]
    ds_read_b64_tr_b16 a[208:209], v10 offset:0
    v_add_u32 v16, s49, v18
    v_mfma_f32_16x16x32_bf16 v[64:67], a[196:199], a[240:243], v[64:67]
    ds_read_b64_tr_b16 a[210:211], v10 offset:6144
    v_add_u32 v17, s49, v19
    v_mfma_f32_16x16x32_bf16 v[72:75], a[196:199], a[244:247], v[72:75]
    v_add_u32 v12, s56, v12
    v_add_u32 v13, s56, v13
    v_mfma_f32_16x16x32_bf16 v[72:75], a[192:195], a[228:231], v[72:75]
    v_add_u32 v14, s56, v14
    v_add_u32 v15, s56, v15
    v_mfma_f32_16x16x32_bf16 v[80:83], a[192:195], a[232:235], v[80:83]
    ds_read_b64_tr_b16 a[212:213], v10 offset:12288
    v_mov_b32 v30, 0x47800000
    v_mfma_f32_16x16x32_bf16 v[80:83], a[196:199], a[248:251], v[80:83]
    ds_read_b64_tr_b16 a[214:215], v10 offset:18432
    v_mov_b32 v20, 0
    v_mfma_f32_16x16x32_bf16 v[88:91], a[196:199], a[252:255], v[88:91]
    v_mov_b32 v21, 0
    v_mov_b32 v22, 0
    v_mfma_f32_16x16x32_bf16 v[88:91], a[192:195], a[236:239], v[88:91]
    s_waitcnt lgkmcnt(4)
    v_mov_b32 v23, 0
    v_mov_b32 v56, 0x3c000000
    v_mfma_f32_16x16x32_bf16 v[92:95], a[200:203], a[236:239], v[92:95]
    ds_read_b64_tr_b16 a[192:193], v11 offset:0
    v_accvgpr_write_b32 a64, 1.0
    v_mfma_f32_16x16x32_bf16 v[92:95], a[204:207], a[252:255], v[92:95]
    ds_read_b64_tr_b16 a[194:195], v11 offset:6144
    v_accvgpr_write_b32 a65, 1.0
    v_mfma_f32_16x16x32_bf16 v[84:87], a[204:207], a[248:251], v[84:87]
    s_getpc_b64 s[74:75]
ct3:
    s_add_u32 s74, s74, at_switch-ct3
    s_addc_u32 s75, s75, 0
    global_load_dword a222, v2, s[74:75]
    v_mfma_f32_16x16x32_bf16 v[84:87], a[200:203], a[232:235], v[84:87]
    v_min_u32 v2, 15, v1
    v_mfma_f32_16x16x32_bf16 v[76:79], a[200:203], a[228:231], v[76:79]
    s_lshl_b32 s59, s3, 4
    ds_read_b64_tr_b16 a[196:197], v11 offset:12288
    v_add_u32 v2, s59, v2
    v_mfma_f32_16x16x32_bf16 v[76:79], a[204:207], a[244:247], v[76:79]
    ds_read_b64_tr_b16 a[198:199], v11 offset:18432
    v_mul_u32_u24 v2, 1280, v2
    v_mfma_f32_16x16x32_bf16 v[68:71], a[204:207], a[240:243], v[68:71]
    buffer_load_dword a217, v2, s[32:35], s60 offen
    v_mfma_f32_16x16x32_bf16 v[68:71], a[200:203], a[224:227], v[68:71]
    s_waitcnt lgkmcnt(4)
    v_and_b32 v2, 1, v1
    v_lshlrev_b32 v2, 7, v2
    v_mfma_f32_16x16x32_bf16 v[96:99], a[208:211], a[224:227], v[96:99]
    s_lshl_b32 s59, s48, 8
    ds_read_b64_tr_b16 a[200:201], v8 offset:1024
    v_add_u32 v2, s59, v2
    v_mfma_f32_16x16x32_bf16 v[96:99], a[212:215], a[240:243], v[96:99]
    ds_read_b64_tr_b16 a[202:203], v8 offset:7168
    v_accvgpr_write_b32 a66, 1.0
    v_mfma_f32_16x16x32_bf16 v[104:107], a[212:215], a[244:247], v[104:107]
    v_accvgpr_write_b32 a67, 1.0
    v_mfma_f32_16x16x32_bf16 v[104:107], a[208:211], a[228:231], v[104:107]
    v_accvgpr_write_b32 a68, 1.0
    v_mfma_f32_16x16x32_bf16 v[112:115], a[208:211], a[232:235], v[112:115]
    ds_read_b64_tr_b16 a[204:205], v8 offset:13312
    v_accvgpr_write_b32 a69, 1.0
    v_mfma_f32_16x16x32_bf16 v[112:115], a[212:215], a[248:251], v[112:115]
    ds_read_b64_tr_b16 a[206:207], v8 offset:19456
    v_cvt_pk_bf16_f32 v64, v64, v65
    v_mfma_f32_16x16x32_bf16 v[120:123], a[212:215], a[252:255], v[120:123]
    s_getpc_b64 s[74:75]
ct4:
    s_add_u32 s74, s74, tail_code-ct4
    s_addc_u32 s75, s75, 0
    global_load_dword a218, v2, s[74:75]
    v_mfma_f32_16x16x32_bf16 v[120:123], a[208:211], a[236:239], v[120:123]
    s_waitcnt lgkmcnt(4)
    v_and_b32 v31, 3, v1
    v_lshlrev_b32 v31, 7, v31
    v_mfma_f32_16x16x32_bf16 v[124:127], a[192:195], a[236:239], v[124:127]
    s_lshl_b32 s59, s48, 9
    ds_read_b64_tr_b16 a[208:209], v9 offset:1024
    v_cvt_pk_bf16_f32 v65, v66, v67
    v_mfma_f32_16x16x32_bf16 v[124:127], a[196:199], a[252:255], v[124:127]
    s_and_b32 s59, s59, 0x7fff
    ds_read_b64_tr_b16 a[210:211], v9 offset:7168
    v_add_u32 v31, s59, v31
    v_mfma_f32_16x16x32_bf16 v[116:119], a[196:199], a[248:251], v[116:119]
    v_min_u32 v2, 11, v1
    v_lshlrev_b32 v2, 7, v2
    v_mfma_f32_16x16x32_bf16 v[116:119], a[192:195], a[232:235], v[116:119]
    v_cvt_pk_bf16_f32 v66, v68, v69
    v_cvt_pk_bf16_f32 v67, v70, v71
    v_mfma_f32_16x16x32_bf16 v[108:111], a[192:195], a[228:231], v[108:111]
    ds_read_b64_tr_b16 a[212:213], v9 offset:13312
    v_cvt_pk_bf16_f32 v72, v72, v73
    v_mfma_f32_16x16x32_bf16 v[108:111], a[196:199], a[244:247], v[108:111]
    ds_read_b64_tr_b16 a[214:215], v9 offset:19456
    v_cvt_pk_bf16_f32 v73, v74, v75
    v_mfma_f32_16x16x32_bf16 v[100:103], a[196:199], a[240:243], v[100:103]
    s_and_b32 s88, s3, 1
    v_permlane16_swap_b32 v64, v66
    v_mfma_f32_16x16x32_bf16 v[100:103], a[192:195], a[224:227], v[100:103]
    s_waitcnt lgkmcnt(4)
    v_permlane16_swap_b32 v65, v67
    v_mfma_f32_16x16x32_bf16 v[128:131], a[200:203], a[224:227], v[128:131]
    s_mul_i32 s88, s88, 20480
    ds_read_b64_tr_b16 a[192:193], v10 offset:1024
    v_cvt_pk_bf16_f32 v74, v76, v77
    v_mfma_f32_16x16x32_bf16 v[128:131], a[204:207], a[240:243], v[128:131]
    s_add_u32 s89, s51, 0
    ds_read_b64_tr_b16 a[194:195], v10 offset:7168
    v_cvt_pk_bf16_f32 v75, v78, v79
    v_mfma_f32_16x16x32_bf16 v[136:139], a[204:207], a[244:247], v[136:139]
    s_and_b32 s89, s89, 3
    v_permlane16_swap_b32 v72, v74
    v_mfma_f32_16x16x32_bf16 v[136:139], a[200:203], a[228:231], v[136:139]
    s_mul_i32 s89, s89, 245760
    v_permlane16_swap_b32 v73, v75
    v_mfma_f32_16x16x32_bf16 v[144:147], a[200:203], a[232:235], v[144:147]
    s_add_u32 s32, s89, s88
    ds_read_b64_tr_b16 a[196:197], v10 offset:13312
    v_cvt_pk_bf16_f32 v80, v80, v81
    v_mfma_f32_16x16x32_bf16 v[144:147], a[204:207], a[248:251], v[144:147]
    s_add_u32 s89, s51, 1
    ds_read_b64_tr_b16 a[198:199], v10 offset:19456
    v_cvt_pk_bf16_f32 v81, v82, v83
    v_mfma_f32_16x16x32_bf16 v[152:155], a[204:207], a[252:255], v[152:155]
    s_and_b32 s89, s89, 3
    v_cvt_pk_bf16_f32 v82, v84, v85
    v_cvt_pk_bf16_f32 v83, v86, v87
    v_mfma_f32_16x16x32_bf16 v[152:155], a[200:203], a[236:239], v[152:155]
    s_waitcnt lgkmcnt(4)
    v_permlane16_swap_b32 v80, v82
    v_mfma_f32_16x16x32_bf16 v[156:159], a[208:211], a[236:239], v[156:159]
    s_mul_i32 s89, s89, 245760
    ds_read_b64_tr_b16 a[200:201], v11 offset:1024
    v_cvt_pk_bf16_f32 v88, v88, v89
    v_mfma_f32_16x16x32_bf16 v[156:159], a[212:215], a[252:255], v[156:159]
    s_add_u32 s33, s89, s88
    ds_read_b64_tr_b16 a[202:203], v11 offset:7168
    v_cvt_pk_bf16_f32 v89, v90, v91
    v_mfma_f32_16x16x32_bf16 v[148:151], a[212:215], a[248:251], v[148:151]
    s_add_u32 s89, s51, 2
    v_permlane16_swap_b32 v81, v83
    v_mfma_f32_16x16x32_bf16 v[148:151], a[208:211], a[232:235], v[148:151]
    s_and_b32 s89, s89, 3
    v_cvt_pk_bf16_f32 v90, v92, v93
    v_cvt_pk_bf16_f32 v91, v94, v95
    v_mfma_f32_16x16x32_bf16 v[140:143], a[208:211], a[228:231], v[140:143]
    s_mul_i32 s89, s89, 245760
    ds_read_b64_tr_b16 a[204:205], v11 offset:13312
    v_cvt_pk_bf16_f32 v96, v96, v97
    v_mfma_f32_16x16x32_bf16 v[140:143], a[212:215], a[244:247], v[140:143]
    s_add_u32 s34, s89, s88
    ds_read_b64_tr_b16 a[206:207], v11 offset:19456
    v_cvt_pk_bf16_f32 v97, v98, v99
    v_mfma_f32_16x16x32_bf16 v[132:135], a[212:215], a[240:243], v[132:135]
    s_add_u32 s89, s51, 3
    v_permlane16_swap_b32 v88, v90
    v_mfma_f32_16x16x32_bf16 v[132:135], a[208:211], a[224:227], v[132:135]
    s_waitcnt lgkmcnt(4)
    v_permlane16_swap_b32 v89, v91
    v_mfma_f32_16x16x32_bf16 v[160:163], a[192:195], a[224:227], v[160:163]
    s_and_b32 s89, s89, 3
    ds_read_b64_tr_b16 a[208:209], v8 offset:2048
    v_cvt_pk_bf16_f32 v98, v100, v101
    v_mfma_f32_16x16x32_bf16 v[160:163], a[196:199], a[240:243], v[160:163]
    s_mul_i32 s89, s89, 245760
    ds_read_b64_tr_b16 a[210:211], v8 offset:8192
    v_cvt_pk_bf16_f32 v99, v102, v103
    v_mfma_f32_16x16x32_bf16 v[168:171], a[196:199], a[244:247], v[168:171]
    s_add_u32 s35, s89, s88
    v_permlane16_swap_b32 v96, v98
    v_mfma_f32_16x16x32_bf16 v[168:171], a[192:195], a[228:231], v[168:171]
    v_permlane16_swap_b32 v97, v99
    v_mfma_f32_16x16x32_bf16 v[176:179], a[192:195], a[232:235], v[176:179]
    ds_read_b64_tr_b16 a[212:213], v8 offset:14336
    v_cvt_pk_bf16_f32 v104, v104, v105
    v_mfma_f32_16x16x32_bf16 v[176:179], a[196:199], a[248:251], v[176:179]
    ds_read_b64_tr_b16 a[214:215], v8 offset:20480
    v_cvt_pk_bf16_f32 v105, v106, v107
    v_mfma_f32_16x16x32_bf16 v[184:187], a[196:199], a[252:255], v[184:187]
    v_cvt_pk_bf16_f32 v106, v108, v109
    v_cvt_pk_bf16_f32 v107, v110, v111
    v_mfma_f32_16x16x32_bf16 v[184:187], a[192:195], a[236:239], v[184:187]
    s_waitcnt lgkmcnt(4)
    v_permlane16_swap_b32 v104, v106
    v_mfma_f32_16x16x32_bf16 v[188:191], a[200:203], a[236:239], v[188:191]
    ds_read_b64_tr_b16 a[192:193], v9 offset:2048
    v_cvt_pk_bf16_f32 v112, v112, v113
    v_mfma_f32_16x16x32_bf16 v[188:191], a[204:207], a[252:255], v[188:191]
    ds_read_b64_tr_b16 a[194:195], v9 offset:8192
    v_cvt_pk_bf16_f32 v113, v114, v115
    v_mfma_f32_16x16x32_bf16 v[180:183], a[204:207], a[248:251], v[180:183]
    v_permlane16_swap_b32 v105, v107
    v_mfma_f32_16x16x32_bf16 v[180:183], a[200:203], a[232:235], v[180:183]
    v_cvt_pk_bf16_f32 v114, v116, v117
    v_cvt_pk_bf16_f32 v115, v118, v119
    v_mfma_f32_16x16x32_bf16 v[172:175], a[200:203], a[228:231], v[172:175]
    ds_read_b64_tr_b16 a[196:197], v9 offset:14336
    v_cvt_pk_bf16_f32 v120, v120, v121
    v_mfma_f32_16x16x32_bf16 v[172:175], a[204:207], a[244:247], v[172:175]
    ds_read_b64_tr_b16 a[198:199], v9 offset:20480
    v_cvt_pk_bf16_f32 v121, v122, v123
    v_mfma_f32_16x16x32_bf16 v[164:167], a[204:207], a[240:243], v[164:167]
pg_5:
    s_cbranch_execz pg_9
    v_permlane16_swap_b32 v112, v114
    v_mfma_f32_16x16x32_bf16 v[164:167], a[200:203], a[224:227], v[164:167]
    s_waitcnt lgkmcnt(4)
    v_permlane16_swap_b32 v113, v115
    v_mfma_f32_16x16x32_bf16 v[192:195], a[208:211], a[224:227], v[192:195]
    ds_read_b64_tr_b16 a[200:201], v10 offset:2048
    v_cvt_pk_bf16_f32 v122, v124, v125
    v_mfma_f32_16x16x32_bf16 v[192:195], a[212:215], a[240:243], v[192:195]
    ds_read_b64_tr_b16 a[202:203], v10 offset:8192
    v_cvt_pk_bf16_f32 v123, v126, v127
    v_mfma_f32_16x16x32_bf16 v[200:203], a[212:215], a[244:247], v[200:203]
    v_permlane16_swap_b32 v120, v122
    v_mfma_f32_16x16x32_bf16 v[200:203], a[208:211], a[228:231], v[200:203]
    v_permlane16_swap_b32 v121, v123
    v_mfma_f32_16x16x32_bf16 v[208:211], a[208:211], a[232:235], v[208:211]
    ds_read_b64_tr_b16 a[204:205], v10 offset:14336
    v_cvt_pk_bf16_f32 v128, v128, v129
    v_mfma_f32_16x16x32_bf16 v[208:211], a[212:215], a[248:251], v[208:211]
    ds_read_b64_tr_b16 a[206:207], v10 offset:20480
    v_cvt_pk_bf16_f32 v129, v130, v131
    v_mfma_f32_16x16x32_bf16 v[216:219], a[212:215], a[252:255], v[216:219]
    v_cvt_pk_bf16_f32 v130, v132, v133
    v_cvt_pk_bf16_f32 v131, v134, v135
    v_mfma_f32_16x16x32_bf16 v[216:219], a[208:211], a[236:239], v[216:219]
    s_waitcnt lgkmcnt(4)
    v_permlane16_swap_b32 v128, v130
    v_mfma_f32_16x16x32_bf16 v[220:223], a[192:195], a[236:239], v[220:223]
    ds_read_b64_tr_b16 a[208:209], v11 offset:2048
    v_cvt_pk_bf16_f32 v136, v136, v137
    v_mfma_f32_16x16x32_bf16 v[220:223], a[196:199], a[252:255], v[220:223]
    ds_read_b64_tr_b16 a[210:211], v11 offset:8192
    v_cvt_pk_bf16_f32 v137, v138, v139
    v_mfma_f32_16x16x32_bf16 v[212:215], a[196:199], a[248:251], v[212:215]
    v_permlane16_swap_b32 v129, v131
    v_mfma_f32_16x16x32_bf16 v[212:215], a[192:195], a[232:235], v[212:215]
    v_cvt_pk_bf16_f32 v138, v140, v141
    v_cvt_pk_bf16_f32 v139, v142, v143
    v_mfma_f32_16x16x32_bf16 v[204:207], a[192:195], a[228:231], v[204:207]
    ds_read_b64_tr_b16 a[212:213], v11 offset:14336
    v_cvt_pk_bf16_f32 v144, v144, v145
    v_mfma_f32_16x16x32_bf16 v[204:207], a[196:199], a[244:247], v[204:207]
    s_waitcnt vmcnt(16)
    ds_read_b64_tr_b16 a[214:215], v11 offset:20480
    v_cvt_pk_bf16_f32 v145, v146, v147
    v_mfma_f32_16x16x32_bf16 v[196:199], a[196:199], a[240:243], v[196:199]
    s_barrier
    v_mfma_f32_16x16x32_bf16 v[196:199], a[192:195], a[224:227], v[196:199]
    s_waitcnt lgkmcnt(4)
    v_permlane16_swap_b32 v136, v138
    v_mfma_f32_16x16x32_bf16 v[224:227], a[200:203], a[224:227], v[224:227]
    ds_read_b128 a[192:195], v16 offset:0
    v_cvt_pk_bf16_f32 v146, v148, v149
    v_mfma_f32_16x16x32_bf16 v[224:227], a[204:207], a[240:243], v[224:227]
    v_permlane16_swap_b32 v137, v139
    v_mfma_f32_16x16x32_bf16 v[232:235], a[204:207], a[244:247], v[232:235]
    v_permlane16_swap_b32 v144, v146
    v_mfma_f32_16x16x32_bf16 v[232:235], a[200:203], a[228:231], v[232:235]
    v_cvt_pk_bf16_f32 v147, v150, v151
    v_cvt_pk_bf16_f32 v152, v152, v153
    v_mfma_f32_16x16x32_bf16 v[240:243], a[200:203], a[232:235], v[240:243]
    ds_read_b128 a[196:199], v17 offset:0
    v_cvt_pk_bf16_f32 v153, v154, v155
    v_mfma_f32_16x16x32_bf16 v[240:243], a[204:207], a[248:251], v[240:243]
    v_permlane16_swap_b32 v145, v147
    v_mfma_f32_16x16x32_bf16 v[248:251], a[204:207], a[252:255], v[248:251]
    v_cvt_pk_bf16_f32 v154, v156, v157
    v_cvt_pk_bf16_f32 v155, v158, v159
    v_mfma_f32_16x16x32_bf16 v[248:251], a[200:203], a[236:239], v[248:251]
    s_waitcnt lgkmcnt(2)
    v_permlane16_swap_b32 v152, v154
    v_mfma_f32_16x16x32_bf16 v[252:255], a[208:211], a[236:239], v[252:255]
    ds_read_b128 a[200:203], v16 offset:1024
    v_mov_b32 v26, s7
    v_mfma_f32_16x16x32_bf16 v[252:255], a[212:215], a[252:255], v[252:255]
    v_permlane16_swap_b32 v153, v155
    v_mfma_f32_16x16x32_bf16 v[244:247], a[212:215], a[248:251], v[244:247]
    v_min_u32 v27, 1, v1
    v_lshlrev_b32 v27, 30, v27
    v_mfma_f32_16x16x32_bf16 v[244:247], a[208:211], a[232:235], v[244:247]
    s_waitcnt vmcnt(7)
    v_cvt_pk_bf16_f32 v160, v160, v161
    v_cvt_pk_bf16_f32 v161, v162, v163
    v_mfma_f32_16x16x32_bf16 v[236:239], a[208:211], a[228:231], v[236:239]
    ds_read_b128 a[204:207], v17 offset:1024
    v_cvt_pk_bf16_f32 v162, v164, v165
    v_mfma_f32_16x16x32_bf16 v[236:239], a[212:215], a[244:247], v[236:239]
    buffer_store_dword v26, v27, s[24:27], s4 offen offset:144 sc1
    v_mfma_f32_16x16x32_bf16 v[228:231], a[212:215], a[240:243], v[228:231]
    v_permlane16_swap_b32 v160, v162
    v_mfma_f32_16x16x32_bf16 v[228:231], a[208:211], a[224:227], v[228:231]
    s_waitcnt lgkmcnt(2)
    v_cvt_pk_bf16_f32 v163, v166, v167
    v_cvt_pk_bf16_f32 v168, v168, v169
    v_mfma_f32_16x16x32_bf16 v[68:71], a[192:195], v[64:67], v[32:35]
    ds_read_b128 a[208:211], v16 offset:2048
    v_cvt_pk_bf16_f32 v169, v170, v171
    v_mfma_f32_16x16x32_bf16 v[68:71], a[196:199], v[96:99], v[68:71]
    v_permlane16_swap_b32 v161, v163
    v_mfma_f32_16x16x32_bf16 v[76:79], a[196:199], v[104:107], v[36:39]
    v_cvt_pk_bf16_f32 v170, v172, v173
    v_cvt_pk_bf16_f32 v171, v174, v175
    v_mfma_f32_16x16x32_bf16 v[76:79], a[192:195], v[72:75], v[76:79]
    v_permlane16_swap_b32 v168, v170
    v_mfma_f32_16x16x32_bf16 v[84:87], a[192:195], v[80:83], v[40:43]
    ds_read_b128 a[212:215], v17 offset:2048
    v_cvt_pk_bf16_f32 v176, v176, v177
    v_mfma_f32_16x16x32_bf16 v[84:87], a[196:199], v[112:115], v[84:87]
    v_permlane16_swap_b32 v169, v171
    v_cvt_pk_bf16_f32 v177, v178, v179
    v_cvt_pk_bf16_f32 v178, v180, v181
    v_cvt_pk_bf16_f32 v179, v182, v183
    v_cvt_pk_bf16_f32 v184, v184, v185
    v_permlane16_swap_b32 v176, v178
    v_permlane16_swap_b32 v177, v179
    v_cvt_pk_bf16_f32 v185, v186, v187
    v_cvt_pk_bf16_f32 v186, v188, v189
    v_cvt_pk_bf16_f32 v187, v190, v191
    v_cvt_pk_bf16_f32 v192, v192, v193
    v_permlane16_swap_b32 v184, v186
    v_permlane16_swap_b32 v185, v187
    v_mfma_f32_16x16x32_bf16 v[92:95], a[196:199], v[120:123], v[44:47]
    v_cvt_pk_bf16_f32 v193, v194, v195
    v_cvt_pk_bf16_f32 v194, v196, v197
    v_mfma_f32_16x16x32_bf16 v[92:95], a[192:195], v[88:91], v[92:95]
    s_waitcnt lgkmcnt(2)
    v_permlane16_swap_b32 v192, v194
    v_mfma_f32_16x16x32_bf16 v[92:95], a[200:203], v[152:155], v[92:95]
    ds_read_b128 a[192:195], v16 offset:6144
    v_cvt_pk_bf16_f32 v195, v198, v199
    v_mfma_f32_16x16x32_bf16 v[92:95], a[204:207], v[184:187], v[92:95]
    v_cvt_pk_bf16_f32 v200, v200, v201
    v_cvt_pk_bf16_f32 v201, v202, v203
    v_mfma_f32_16x16x32_bf16 v[84:87], a[204:207], v[176:179], v[84:87]
    v_permlane16_swap_b32 v193, v195
    v_mfma_f32_16x16x32_bf16 v[84:87], a[200:203], v[144:147], v[84:87]
    v_cvt_pk_bf16_f32 v202, v204, v205
    v_cvt_pk_bf16_f32 v203, v206, v207
    v_mfma_f32_16x16x32_bf16 v[76:79], a[200:203], v[136:139], v[76:79]
    ds_read_b128 a[196:199], v17 offset:6144
    v_cvt_pk_bf16_f32 v208, v208, v209
    v_mfma_f32_16x16x32_bf16 v[76:79], a[204:207], v[168:171], v[76:79]
    s_add_u32 m0, s49, 49152
    v_permlane16_swap_b32 v200, v202
    v_permlane16_swap_b32 v201, v203
    v_cvt_pk_bf16_f32 v209, v210, v211
    v_cvt_pk_bf16_f32 v210, v212, v213
    v_cvt_pk_bf16_f32 v211, v214, v215
    v_cvt_pk_bf16_f32 v216, v216, v217
    v_permlane16_swap_b32 v208, v210
    v_permlane16_swap_b32 v209, v211
    v_cvt_pk_bf16_f32 v217, v218, v219
    v_cvt_pk_bf16_f32 v218, v220, v221
    v_cvt_pk_bf16_f32 v219, v222, v223
    v_cvt_pk_bf16_f32 v224, v224, v225
    v_permlane16_swap_b32 v216, v218
    v_permlane16_swap_b32 v217, v219
    v_cvt_pk_bf16_f32 v225, v226, v227
    v_cvt_pk_bf16_f32 v226, v228, v229
    v_cvt_pk_bf16_f32 v227, v230, v231
    v_cvt_pk_bf16_f32 v232, v232, v233
    v_permlane16_swap_b32 v224, v226
    v_permlane16_swap_b32 v225, v227
    v_cvt_pk_bf16_f32 v233, v234, v235
    v_cvt_pk_bf16_f32 v234, v236, v237
    v_cvt_pk_bf16_f32 v235, v238, v239
    v_cvt_pk_bf16_f32 v240, v240, v241
    v_permlane16_swap_b32 v232, v234
    v_permlane16_swap_b32 v233, v235
    v_cvt_pk_bf16_f32 v241, v242, v243
    v_cvt_pk_bf16_f32 v242, v244, v245
    v_cvt_pk_bf16_f32 v243, v246, v247
    v_cvt_pk_bf16_f32 v248, v248, v249
    v_permlane16_swap_b32 v240, v242
    v_permlane16_swap_b32 v241, v243
    v_cvt_pk_bf16_f32 v249, v250, v251
    v_cvt_pk_bf16_f32 v250, v252, v253
    v_cvt_pk_bf16_f32 v251, v254, v255
    v_accvgpr_write_b32 a70, 1.0
    v_permlane16_swap_b32 v248, v250
    v_permlane16_swap_b32 v249, v251
    v_mfma_f32_16x16x32_bf16 v[68:71], a[204:207], v[160:163], v[68:71]
    buffer_load_dwordx4 v4, s[12:15], s38 offen offset:0 lds
    v_mfma_f32_16x16x32_bf16 v[68:71], a[200:203], v[128:131], v[68:71]
    s_waitcnt lgkmcnt(2)
    v_accvgpr_write_b32 a71, 1.0
    v_accvgpr_write_b32 a72, 1.0
    v_mfma_f32_16x16x32_bf16 v[68:71], a[208:211], v[192:195], v[68:71]
    ds_read_b128 a[200:203], v16 offset:7168
    v_accvgpr_write_b32 a73, 1.0
    v_mfma_f32_16x16x32_bf16 v[68:71], a[212:215], v[224:227], v[68:71]
    v_accvgpr_write_b32 a74, 1.0
    v_accvgpr_write_b32 a75, 1.0
    v_mfma_f32_16x16x32_bf16 v[76:79], a[212:215], v[232:235], v[76:79]
    v_accvgpr_write_b32 a76, 1.0
    v_accvgpr_write_b32 a77, 1.0
    v_mfma_f32_16x16x32_bf16 v[76:79], a[208:211], v[200:203], v[76:79]
    s_add_u32 m0, s49, 50048
    v_accvgpr_write_b32 a78, 1.0
    v_accvgpr_write_b32 a79, 1.0
    v_mfma_f32_16x16x32_bf16 v[84:87], a[208:211], v[208:211], v[84:87]
    ds_read_b128 a[204:207], v17 offset:7168
    v_accvgpr_write_b32 a80, 1.0
    v_mfma_f32_16x16x32_bf16 v[84:87], a[212:215], v[240:243], v[84:87]
    buffer_load_dwordx4 v4, s[12:15], s38 offen offset:128 lds
    v_mfma_f32_16x16x32_bf16 v[92:95], a[212:215], v[248:251], v[92:95]
    v_accvgpr_write_b32 a81, 1.0
    v_accvgpr_write_b32 a82, 1.0
    v_mfma_f32_16x16x32_bf16 v[92:95], a[208:211], v[216:219], v[92:95]
    s_waitcnt lgkmcnt(2)
    v_accvgpr_write_b32 a83, 1.0
    v_accvgpr_write_b32 a84, 1.0
    v_mfma_f32_16x16x32_bf16 v[124:127], a[192:195], v[88:91], v[44:47]
    ds_read_b128 a[208:211], v16 offset:8192
    v_accvgpr_write_b32 a85, 1.0
    v_mfma_f32_16x16x32_bf16 v[124:127], a[196:199], v[120:123], v[124:127]
    v_accvgpr_write_b32 a86, 1.0
    v_accvgpr_write_b32 a87, 1.0
    v_mfma_f32_16x16x32_bf16 v[116:119], a[196:199], v[112:115], v[40:43]
    s_add_u32 m0, s49, 50944
    v_accvgpr_write_b32 a88, 1.0
    v_accvgpr_write_b32 a89, 1.0
    v_mfma_f32_16x16x32_bf16 v[116:119], a[192:195], v[80:83], v[116:119]
    buffer_load_dwordx4 v4, s[12:15], s38 offen offset:256 lds
    v_mfma_f32_16x16x32_bf16 v[108:111], a[192:195], v[72:75], v[36:39]
    ds_read_b128 a[212:215], v17 offset:8192
    v_accvgpr_write_b32 a90, 1.0
    v_mfma_f32_16x16x32_bf16 v[108:111], a[196:199], v[104:107], v[108:111]
    v_accvgpr_write_b32 a91, 1.0
    v_accvgpr_write_b32 a92, 1.0
    v_mfma_f32_16x16x32_bf16 v[100:103], a[196:199], v[96:99], v[32:35]
    v_accvgpr_write_b32 a93, 1.0
    v_accvgpr_write_b32 a94, 1.0
    v_mfma_f32_16x16x32_bf16 v[100:103], a[192:195], v[64:67], v[100:103]
    s_waitcnt lgkmcnt(2)
    v_accvgpr_write_b32 a95, 1.0
    v_mfma_f32_16x16x32_bf16 v[100:103], a[200:203], v[128:131], v[100:103]
    s_add_u32 m0, s49, 52224
    ds_read_b128 a[192:195], v16 offset:12288
    v_mfma_f32_16x16x32_bf16 v[100:103], a[204:207], v[160:163], v[100:103]
    buffer_load_dwordx4 v5, s[12:15], s38 offen offset:0 lds
    v_mfma_f32_16x16x32_bf16 v[108:111], a[204:207], v[168:171], v[108:111]
    v_exp_f32 v48, v68
    v_mfma_f32_16x16x32_bf16 v[108:111], a[200:203], v[136:139], v[108:111]
    v_exp_f32 v49, v69
    v_mfma_f32_16x16x32_bf16 v[116:119], a[200:203], v[144:147], v[116:119]
    ds_read_b128 a[196:199], v17 offset:12288
    v_cvt_pk_bf16_f32 v196, v48, v49
    v_mfma_f32_16x16x32_bf16 v[116:119], a[204:207], v[176:179], v[116:119]
    v_exp_f32 v50, v70
    v_mfma_f32_16x16x32_bf16 v[124:127], a[204:207], v[184:187], v[124:127]
    v_exp_f32 v51, v71
    v_mfma_f32_16x16x32_bf16 v[124:127], a[200:203], v[152:155], v[124:127]
    s_waitcnt lgkmcnt(2)
    v_add_f32 v24, v48, v49
    v_add_f32 v24, v24, v50
    v_mfma_f32_16x16x32_bf16 v[124:127], a[208:211], v[216:219], v[124:127]
    s_add_u32 m0, s49, 53120
    ds_read_b128 a[200:203], v16 offset:13312
    v_cvt_pk_bf16_f32 v197, v50, v51
    v_mfma_f32_16x16x32_bf16 v[124:127], a[212:215], v[248:251], v[124:127]
    buffer_load_dwordx4 v5, s[12:15], s38 offen offset:128 lds
    v_mfma_f32_16x16x32_bf16 v[116:119], a[212:215], v[240:243], v[116:119]
    v_exp_f32 v48, v76
    v_mfma_f32_16x16x32_bf16 v[116:119], a[208:211], v[208:211], v[116:119]
    v_add_f32 v24, v24, v51
    v_mfma_f32_16x16x32_bf16 v[108:111], a[208:211], v[200:203], v[108:111]
    ds_read_b128 a[204:207], v17 offset:13312
    v_mfma_f32_16x16x32_bf16 v[108:111], a[212:215], v[232:235], v[108:111]
    s_add_u32 m0, s49, 54016
    v_exp_f32 v49, v77
    v_mfma_f32_16x16x32_bf16 v[100:103], a[212:215], v[224:227], v[100:103]
    buffer_load_dwordx4 v5, s[12:15], s38 offen offset:256 lds
    v_mfma_f32_16x16x32_bf16 v[100:103], a[208:211], v[192:195], v[100:103]
    s_waitcnt lgkmcnt(2)
    v_exp_f32 v50, v78
    v_mfma_f32_16x16x32_bf16 v[132:135], a[192:195], v[64:67], v[32:35]
    s_add_u32 s38, s38, 24576
    ds_read_b128 a[208:211], v16 offset:14336
    v_cvt_pk_bf16_f32 v204, v48, v49
    v_mfma_f32_16x16x32_bf16 v[132:135], a[196:199], v[96:99], v[132:135]
    v_exp_f32 v51, v79
    v_mfma_f32_16x16x32_bf16 v[140:143], a[196:199], v[104:107], v[36:39]
    v_add_f32 v25, v48, v49
    v_add_f32 v25, v25, v50
    v_mfma_f32_16x16x32_bf16 v[140:143], a[192:195], v[72:75], v[140:143]
    v_exp_f32 v48, v84
    v_mfma_f32_16x16x32_bf16 v[148:151], a[192:195], v[80:83], v[40:43]
    s_add_u32 m0, s49, 98304
    ds_read_b128 a[212:215], v17 offset:14336
    v_cvt_pk_bf16_f32 v205, v50, v51
    v_mfma_f32_16x16x32_bf16 v[148:151], a[196:199], v[112:115], v[148:151]
    buffer_load_dwordx4 v6, s[16:19], s40 offen offset:0 lds
    v_mfma_f32_16x16x32_bf16 v[156:159], a[196:199], v[120:123], v[44:47]
    v_exp_f32 v52, v100
    v_mfma_f32_16x16x32_bf16 v[156:159], a[192:195], v[88:91], v[156:159]
    s_waitcnt lgkmcnt(2)
    v_exp_f32 v53, v101
    v_mfma_f32_16x16x32_bf16 v[156:159], a[200:203], v[152:155], v[156:159]
    ds_read_b128 a[192:195], v16 offset:18432
    v_add_f32 v24, v24, v52
    v_mfma_f32_16x16x32_bf16 v[156:159], a[204:207], v[184:187], v[156:159]
    v_exp_f32 v54, v102
    v_mfma_f32_16x16x32_bf16 v[148:151], a[204:207], v[176:179], v[148:151]
    s_add_u32 m0, s49, 99200
    v_exp_f32 v55, v103
    v_mfma_f32_16x16x32_bf16 v[148:151], a[200:203], v[144:147], v[148:151]
    buffer_load_dwordx4 v6, s[16:19], s40 offen offset:128 lds
    v_mfma_f32_16x16x32_bf16 v[140:143], a[200:203], v[136:139], v[140:143]
    ds_read_b128 a[196:199], v17 offset:18432
    v_cvt_pk_bf16_f32 v198, v52, v53
    v_mfma_f32_16x16x32_bf16 v[140:143], a[204:207], v[168:171], v[140:143]
    v_add_f32 v24, v24, v53
    v_add_f32 v24, v24, v54
    v_mfma_f32_16x16x32_bf16 v[132:135], a[204:207], v[160:163], v[132:135]
    v_exp_f32 v52, v108
    v_mfma_f32_16x16x32_bf16 v[132:135], a[200:203], v[128:131], v[132:135]
    s_waitcnt lgkmcnt(2)
    v_cvt_pk_bf16_f32 v199, v54, v55
    v_add_f32 v24, v24, v55
    v_mfma_f32_16x16x32_bf16 v[132:135], a[208:211], v[192:195], v[132:135]
    ds_read_b128 a[200:203], v16 offset:19456
    v_add_f32 v25, v25, v51
    v_mfma_f32_16x16x32_bf16 v[132:135], a[212:215], v[224:227], v[132:135]
    s_add_u32 m0, s49, 100096
    v_exp_f32 v53, v109
    v_mfma_f32_16x16x32_bf16 v[140:143], a[212:215], v[232:235], v[140:143]
    buffer_load_dwordx4 v6, s[16:19], s40 offen offset:256 lds
    v_mfma_f32_16x16x32_bf16 v[140:143], a[208:211], v[200:203], v[140:143]
    v_exp_f32 v54, v110
    v_mfma_f32_16x16x32_bf16 v[148:151], a[208:211], v[208:211], v[148:151]
    ds_read_b128 a[204:207], v17 offset:19456
    v_add_f32 v25, v25, v52
    v_mfma_f32_16x16x32_bf16 v[148:151], a[212:215], v[240:243], v[148:151]
    v_exp_f32 v55, v111
    v_mfma_f32_16x16x32_bf16 v[156:159], a[212:215], v[248:251], v[156:159]
    v_exp_f32 v49, v85
    v_mfma_f32_16x16x32_bf16 v[156:159], a[208:211], v[216:219], v[156:159]
    s_waitcnt lgkmcnt(2)
    v_exp_f32 v50, v86
    v_mfma_f32_16x16x32_bf16 v[188:191], a[192:195], v[88:91], v[44:47]
    s_add_u32 m0, s49, 101376
    ds_read_b128 a[208:211], v16 offset:20480
    v_cvt_pk_bf16_f32 v206, v52, v53
    v_mfma_f32_16x16x32_bf16 v[188:191], a[196:199], v[120:123], v[188:191]
    buffer_load_dwordx4 v7, s[16:19], s40 offen offset:0 lds
    v_mfma_f32_16x16x32_bf16 v[180:183], a[196:199], v[112:115], v[40:43]
    v_add_f32 v25, v25, v53
    v_add_f32 v25, v25, v54
    v_mfma_f32_16x16x32_bf16 v[180:183], a[192:195], v[80:83], v[180:183]
    v_exp_f32 v51, v87
    v_mfma_f32_16x16x32_bf16 v[172:175], a[192:195], v[72:75], v[36:39]
    ds_read_b128 a[212:215], v17 offset:20480
    v_cvt_pk_bf16_f32 v207, v54, v55
    v_mfma_f32_16x16x32_bf16 v[172:175], a[196:199], v[104:107], v[172:175]
    s_waitcnt vmcnt(14)
    v_exp_f32 v52, v116
    v_mfma_f32_16x16x32_bf16 v[164:167], a[196:199], v[96:99], v[32:35]
    s_barrier
    v_mfma_f32_16x16x32_bf16 v[164:167], a[192:195], v[64:67], v[164:167]
    s_waitcnt lgkmcnt(2)
    v_add_f32 v25, v25, v55
    v_cvt_pk_bf16_f32 v212, v48, v49
    v_add_u32 v16, s42, v18
    v_mfma_f32_16x16x32_bf16 v[164:167], a[200:203], v[128:131], v[164:167]
    s_add_u32 m0, s49, 102272
    ds_read_b128 a[224:227], v16 offset:0
    v_add_f32 v26, v48, v49
    v_mfma_f32_16x16x32_bf16 v[164:167], a[204:207], v[160:163], v[164:167]
    buffer_load_dwordx4 v7, s[16:19], s40 offen offset:128 lds
    v_add_u32 v17, s42, v19
    v_mfma_f32_16x16x32_bf16 v[172:175], a[204:207], v[168:171], v[172:175]
    ds_read_b128 a[228:231], v17 offset:0
    v_add_f32 v26, v26, v50
    v_mfma_f32_16x16x32_bf16 v[172:175], a[200:203], v[136:139], v[172:175]
    v_exp_f32 v53, v117
    v_mfma_f32_16x16x32_bf16 v[180:183], a[200:203], v[144:147], v[180:183]
    s_add_u32 m0, s49, 103168
    ds_read_b128 a[232:235], v16 offset:1024
    v_cvt_pk_bf16_f32 v213, v50, v51
    v_mfma_f32_16x16x32_bf16 v[180:183], a[204:207], v[176:179], v[180:183]
    buffer_load_dwordx4 v7, s[16:19], s40 offen offset:256 lds
    v_mfma_f32_16x16x32_bf16 v[188:191], a[204:207], v[184:187], v[188:191]
    s_add_u32 s40, s40, 24576
    ds_read_b128 a[236:239], v17 offset:1024
    v_add_f32 v26, v26, v51
    v_mfma_f32_16x16x32_bf16 v[188:191], a[200:203], v[152:155], v[188:191]
    s_waitcnt lgkmcnt(4)
    v_exp_f32 v54, v118
    v_mfma_f32_16x16x32_bf16 v[188:191], a[208:211], v[216:219], v[188:191]
    ds_read_b128 a[240:243], v16 offset:2048
    v_add_f32 v26, v26, v52
    v_mfma_f32_16x16x32_bf16 v[188:191], a[212:215], v[248:251], v[188:191]
    v_exp_f32 v55, v119
    v_mfma_f32_16x16x32_bf16 v[180:183], a[212:215], v[240:243], v[180:183]
    ds_read_b128 a[244:247], v17 offset:2048
    v_cvt_pk_bf16_f32 v214, v52, v53
    v_mfma_f32_16x16x32_bf16 v[180:183], a[208:211], v[208:211], v[180:183]
    v_exp_f32 v48, v92
    v_mfma_f32_16x16x32_bf16 v[172:175], a[208:211], v[200:203], v[172:175]
    v_exp_f32 v49, v93
    v_mfma_f32_16x16x32_bf16 v[172:175], a[212:215], v[232:235], v[172:175]
    v_exp_f32 v50, v94
    v_mfma_f32_16x16x32_bf16 v[164:167], a[212:215], v[224:227], v[164:167]
    v_add_f32 v26, v26, v53
    v_add_f32 v26, v26, v54
    v_mfma_f32_16x16x32_bf16 v[164:167], a[208:211], v[192:195], v[164:167]
    v_cvt_pk_bf16_f32 v215, v54, v55
    v_add_f32 v26, v26, v55
    v_max3_f32 v29, v24, v25, v26
    v_cvt_pk_bf16_f32 v220, v48, v49
    v_exp_f32 v51, v95
    v_add_f32 v27, v48, v49
    v_cvt_pk_bf16_f32 v221, v50, v51
    v_exp_f32 v52, v124
    v_exp_f32 v53, v125
    v_add_f32 v27, v27, v50
    v_cvt_pk_bf16_f32 v222, v52, v53
    v_exp_f32 v54, v126
    v_exp_f32 v55, v127
    v_add_f32 v27, v27, v51
    v_cvt_pk_bf16_f32 v223, v54, v55
    v_add_f32 v27, v27, v52
    v_add_f32 v27, v27, v53
    v_add_f32 v27, v27, v54
    v_add_f32 v27, v27, v55
    v_max_f32 v29, v29, v27
    v_cmp_nle_f32 vcc, v29, v30
    v_min3_f32 v29, v24, v25, v26
    v_min_f32 v29, v29, v27
    v_cmp_gt_f32 s[88:89], v56, v29
    s_or_b64 vcc, vcc, s[88:89]
    s_cbranch_vccnz rare_p
rare_p_ret:
    s_waitcnt lgkmcnt(0)
at_switch:
at_dry:
    s_mov_b32 s76, 0
    s_branch at_loop
    .p2align 12
pg_6:
    s_cbranch_execz pg_10
at_loop:
    v_mfma_f32_16x16x32_bf16 v[68:71], a[224:227], v[64:67], v[32:35]
    ds_read_b128 a[192:195], v16 offset:6144
    v_add_f32 v20, v20, v24
    v_mfma_f32_16x16x32_bf16 v[68:71], a[228:231], v[96:99], v[68:71]
    s_add_u32 s77, s38, s76
    v_add_f32 v21, v21, v25
    v_add_f32 v22, v22, v26
    v_mfma_f32_16x16x32_bf16 v[68:71], a[232:235], v[128:131], v[68:71]
    v_add_f32 v23, v23, v27
    v_add_u32 v8, s41, v12
    v_mfma_f32_16x16x32_bf16 v[68:71], a[236:239], v[160:163], v[68:71]
    ds_read_b128 a[196:199], v17 offset:6144
    v_add_u32 v9, s41, v13
    v_mfma_f32_16x16x32_bf16 v[68:71], a[240:243], v[192:195], v[68:71]
    v_exp_f32 v48, v132
    v_mfma_f32_16x16x32_bf16 v[68:71], a[244:247], v[224:227], v[68:71]
    s_add_u32 m0, s41, 0
    v_exp_f32 v49, v133
    v_mfma_f32_16x16x32_bf16 v[76:79], a[244:247], v[232:235], v[36:39]
    ds_read_b128 a[200:203], v16 offset:7168
    v_cvt_pk_bf16_f32 v228, v48, v49
    v_mfma_f32_16x16x32_bf16 v[76:79], a[240:243], v[200:203], v[76:79]
    buffer_load_dwordx4 v4, s[12:15], s38 offen offset:0 lds
    v_mfma_f32_16x16x32_bf16 v[76:79], a[236:239], v[168:171], v[76:79]
    v_exp_f32 v50, v134
    v_mfma_f32_16x16x32_bf16 v[76:79], a[232:235], v[136:139], v[76:79]
    ds_read_b128 a[204:207], v17 offset:7168
    v_add_f32 v24, v48, v49
    v_mfma_f32_16x16x32_bf16 v[76:79], a[228:231], v[104:107], v[76:79]
    v_exp_f32 v51, v135
    v_mfma_f32_16x16x32_bf16 v[76:79], a[224:227], v[72:75], v[76:79]
    v_exp_f32 v52, v164
    v_mfma_f32_16x16x32_bf16 v[84:87], a[224:227], v[80:83], v[40:43]
    ds_read_b128 a[208:211], v16 offset:8192
    v_add_f32 v24, v24, v50
    v_mfma_f32_16x16x32_bf16 v[84:87], a[228:231], v[112:115], v[84:87]
    v_exp_f32 v53, v165
    v_mfma_f32_16x16x32_bf16 v[84:87], a[232:235], v[144:147], v[84:87]
    v_exp_f32 v54, v166
    v_mfma_f32_16x16x32_bf16 v[84:87], a[236:239], v[176:179], v[84:87]
    ds_read_b128 a[212:215], v17 offset:8192
    v_add_u32 v10, s41, v14
    v_mfma_f32_16x16x32_bf16 v[84:87], a[240:243], v[208:211], v[84:87]
    v_exp_f32 v55, v167
    v_mfma_f32_16x16x32_bf16 v[84:87], a[244:247], v[240:243], v[84:87]
    s_add_u32 m0, s41, 896
    v_cvt_pk_bf16_f32 v229, v50, v51
    v_add_f32 v24, v24, v51
    v_mfma_f32_16x16x32_bf16 v[92:95], a[244:247], v[248:251], v[44:47]
    buffer_load_dwordx4 v4, s[12:15], s38 offen offset:128 lds
    v_mfma_f32_16x16x32_bf16 v[92:95], a[240:243], v[216:219], v[92:95]
    v_exp_f32 v48, v140
    v_mfma_f32_16x16x32_bf16 v[92:95], a[236:239], v[184:187], v[92:95]
    v_add_u32 v11, s41, v15
    v_add_f32 v24, v24, v52
    v_mfma_f32_16x16x32_bf16 v[92:95], a[232:235], v[152:155], v[92:95]
    v_exp_f32 v49, v141
    v_mfma_f32_16x16x32_bf16 v[92:95], a[228:231], v[120:123], v[92:95]
    v_cvt_pk_bf16_f32 v230, v52, v53
    v_add_f32 v24, v24, v53
    v_mfma_f32_16x16x32_bf16 v[92:95], a[224:227], v[88:91], v[92:95]
    s_waitcnt lgkmcnt(0)
    v_exp_f32 v50, v142
    v_mfma_f32_16x16x32_bf16 v[124:127], a[192:195], v[88:91], v[44:47]
    ds_read_b64_tr_b16 a[224:225], v8 offset:0
    v_add_f32 v24, v24, v54
    v_mfma_f32_16x16x32_bf16 v[124:127], a[196:199], v[120:123], v[124:127]
    ds_read_b64_tr_b16 a[226:227], v8 offset:6144
    v_cvt_pk_bf16_f32 v231, v54, v55
    v_mfma_f32_16x16x32_bf16 v[124:127], a[200:203], v[152:155], v[124:127]
    v_exp_f32 v51, v143
    v_mfma_f32_16x16x32_bf16 v[124:127], a[204:207], v[184:187], v[124:127]
    ds_read_b64_tr_b16 a[228:229], v9 offset:0
    v_add_f32 v24, v24, v55
    v_mfma_f32_16x16x32_bf16 v[124:127], a[208:211], v[216:219], v[124:127]
    ds_read_b64_tr_b16 a[230:231], v9 offset:6144
    v_cvt_pk_bf16_f32 v236, v48, v49
    v_mfma_f32_16x16x32_bf16 v[124:127], a[212:215], v[248:251], v[124:127]
    v_exp_f32 v52, v172
    v_mfma_f32_16x16x32_bf16 v[116:119], a[212:215], v[240:243], v[40:43]
    ds_read_b64_tr_b16 a[232:233], v10 offset:0
    v_add_f32 v25, v48, v49
    v_mfma_f32_16x16x32_bf16 v[116:119], a[208:211], v[208:211], v[116:119]
    s_add_u32 m0, s41, 1792
    ds_read_b64_tr_b16 a[234:235], v10 offset:6144
    v_add_f32 v25, v25, v50
    v_mfma_f32_16x16x32_bf16 v[116:119], a[204:207], v[176:179], v[116:119]
    buffer_load_dwordx4 v4, s[12:15], s77 offen offset:256 lds
    v_mfma_f32_16x16x32_bf16 v[116:119], a[200:203], v[144:147], v[116:119]
    ds_read_b64_tr_b16 a[236:237], v11 offset:0
    v_cvt_pk_bf16_f32 v237, v50, v51
    v_mfma_f32_16x16x32_bf16 v[116:119], a[196:199], v[112:115], v[116:119]
    ds_read_b64_tr_b16 a[238:239], v11 offset:6144
    v_add_f32 v25, v25, v51
    v_mfma_f32_16x16x32_bf16 v[116:119], a[192:195], v[80:83], v[116:119]
    v_exp_f32 v53, v173
    v_mfma_f32_16x16x32_bf16 v[108:111], a[192:195], v[72:75], v[36:39]
    ds_read_b64_tr_b16 a[240:241], v8 offset:1024
    v_add_f32 v25, v25, v52
    v_mfma_f32_16x16x32_bf16 v[108:111], a[196:199], v[104:107], v[108:111]
    ds_read_b64_tr_b16 a[242:243], v8 offset:7168
    v_cvt_pk_bf16_f32 v238, v52, v53
    v_mfma_f32_16x16x32_bf16 v[108:111], a[200:203], v[136:139], v[108:111]
    v_exp_f32 v54, v174
    v_mfma_f32_16x16x32_bf16 v[108:111], a[204:207], v[168:171], v[108:111]
    ds_read_b64_tr_b16 a[244:245], v9 offset:1024
    v_add_f32 v25, v25, v53
    v_mfma_f32_16x16x32_bf16 v[108:111], a[208:211], v[200:203], v[108:111]
    ds_read_b64_tr_b16 a[246:247], v9 offset:7168
    v_add_f32 v25, v25, v54
    v_mfma_f32_16x16x32_bf16 v[108:111], a[212:215], v[232:235], v[108:111]
    v_exp_f32 v55, v175
    v_mfma_f32_16x16x32_bf16 v[100:103], a[212:215], v[224:227], v[32:35]
    v_exp_f32 v48, v148
    v_mfma_f32_16x16x32_bf16 v[100:103], a[208:211], v[192:195], v[100:103]
    v_exp_f32 v49, v149
    v_mfma_f32_16x16x32_bf16 v[100:103], a[204:207], v[160:163], v[100:103]
    v_exp_f32 v50, v150
    v_mfma_f32_16x16x32_bf16 v[100:103], a[200:203], v[128:131], v[100:103]
    s_add_u32 m0, s41, 3072
    v_exp_f32 v51, v151
    v_mfma_f32_16x16x32_bf16 v[100:103], a[196:199], v[96:99], v[100:103]
    buffer_load_dwordx4 v5, s[12:15], s38 offen offset:0 lds
    v_mfma_f32_16x16x32_bf16 v[100:103], a[192:195], v[64:67], v[100:103]
    s_waitcnt lgkmcnt(0)
    v_cvt_pk_bf16_f32 v239, v54, v55
    v_add_f32 v25, v25, v55
    v_mfma_f32_16x16x32_bf16 a[0:3], a[224:227], v[196:199], a[0:3]
    ds_read_b64_tr_b16 a[192:193], v10 offset:1024
    v_cvt_pk_bf16_f32 v244, v48, v49
    v_mfma_f32_16x16x32_bf16 a[16:19], a[228:231], v[196:199], a[16:19]
    ds_read_b64_tr_b16 a[194:195], v10 offset:7168
    v_add_f32 v26, v48, v49
    v_mfma_f32_16x16x32_bf16 a[32:35], a[232:235], v[196:199], a[32:35]
    v_exp_f32 v52, v180
    v_mfma_f32_16x16x32_bf16 a[48:51], a[236:239], v[196:199], a[48:51]
    ds_read_b64_tr_b16 a[196:197], v11 offset:1024
    v_add_f32 v26, v26, v50
    v_mfma_f32_16x16x32_bf16 a[64:67], a[240:243], v[196:199], a[64:67]
    ds_read_b64_tr_b16 a[198:199], v11 offset:7168
    v_cvt_pk_bf16_f32 v245, v50, v51
    v_mfma_f32_16x16x32_bf16 a[80:83], a[244:247], v[196:199], a[80:83]
    v_exp_f32 v53, v181
    v_mfma_f32_16x16x32_bf16 a[84:87], a[244:247], v[204:207], a[84:87]
    ds_read_b64_tr_b16 a[200:201], v8 offset:2048
    v_add_f32 v26, v26, v51
    v_mfma_f32_16x16x32_bf16 a[68:71], a[240:243], v[204:207], a[68:71]
    ds_read_b64_tr_b16 a[202:203], v8 offset:8192
    v_add_f32 v26, v26, v52
    v_mfma_f32_16x16x32_bf16 a[52:55], a[236:239], v[204:207], a[52:55]
    v_exp_f32 v54, v182
    v_mfma_f32_16x16x32_bf16 a[36:39], a[232:235], v[204:207], a[36:39]
    ds_read_b64_tr_b16 a[204:205], v9 offset:2048
    v_cvt_pk_bf16_f32 v246, v52, v53
    v_mfma_f32_16x16x32_bf16 a[20:23], a[228:231], v[204:207], a[20:23]
    ds_read_b64_tr_b16 a[206:207], v9 offset:8192
    v_add_f32 v26, v26, v53
    v_mfma_f32_16x16x32_bf16 a[4:7], a[224:227], v[204:207], a[4:7]
    s_add_u32 m0, s41, 3968
    v_exp_f32 v55, v183
    v_mfma_f32_16x16x32_bf16 a[8:11], a[224:227], v[212:215], a[8:11]
    ds_read_b64_tr_b16 a[208:209], v10 offset:2048
    v_add_f32 v26, v26, v54
    v_mfma_f32_16x16x32_bf16 a[24:27], a[228:231], v[212:215], a[24:27]
    ds_read_b64_tr_b16 a[210:211], v10 offset:8192
    v_cvt_pk_bf16_f32 v247, v54, v55
    v_mfma_f32_16x16x32_bf16 a[40:43], a[232:235], v[212:215], a[40:43]
    buffer_load_dwordx4 v5, s[12:15], s38 offen offset:128 lds
    v_mfma_f32_16x16x32_bf16 a[56:59], a[236:239], v[212:215], a[56:59]
    ds_read_b64_tr_b16 a[212:213], v11 offset:2048
    v_add_f32 v26, v26, v55
    v_mfma_f32_16x16x32_bf16 a[72:75], a[240:243], v[212:215], a[72:75]
    ds_read_b64_tr_b16 a[214:215], v11 offset:8192
    v_max3_f32 v29, v24, v25, v26
    v_mfma_f32_16x16x32_bf16 a[88:91], a[244:247], v[212:215], a[88:91]
    v_exp_f32 v48, v156
    v_mfma_f32_16x16x32_bf16 a[92:95], a[244:247], v[220:223], a[92:95]
    v_exp_f32 v49, v157
    v_mfma_f32_16x16x32_bf16 a[76:79], a[240:243], v[220:223], a[76:79]
    v_exp_f32 v50, v158
    v_mfma_f32_16x16x32_bf16 a[60:63], a[236:239], v[220:223], a[60:63]
    v_exp_f32 v51, v159
    v_mfma_f32_16x16x32_bf16 a[44:47], a[232:235], v[220:223], a[44:47]
    v_exp_f32 v52, v188
    v_mfma_f32_16x16x32_bf16 a[28:31], a[228:231], v[220:223], a[28:31]
    v_exp_f32 v53, v189
    v_mfma_f32_16x16x32_bf16 a[12:15], a[224:227], v[220:223], a[12:15]
    s_waitcnt lgkmcnt(0)
    v_cvt_pk_bf16_f32 v252, v48, v49
    v_add_f32 v27, v48, v49
    v_mfma_f32_16x16x32_bf16 a[108:111], a[192:195], v[220:223], a[108:111]
    ds_read_b128 a[224:227], v16 offset:12288
    v_add_f32 v27, v27, v50
    v_mfma_f32_16x16x32_bf16 a[124:127], a[196:199], v[220:223], a[124:127]
    s_add_u32 m0, s41, 4864
    v_exp_f32 v54, v190
    v_mfma_f32_16x16x32_bf16 a[140:143], a[200:203], v[220:223], a[140:143]
    buffer_load_dwordx4 v5, s[12:15], s77 offen offset:256 lds
    v_mfma_f32_16x16x32_bf16 a[156:159], a[204:207], v[220:223], a[156:159]
    ds_read_b128 a[228:231], v17 offset:12288
    v_cvt_pk_bf16_f32 v253, v50, v51
    v_mfma_f32_16x16x32_bf16 a[172:175], a[208:211], v[220:223], a[172:175]
    s_add_u32 s38, s38, s39
    v_exp_f32 v55, v191
    v_mfma_f32_16x16x32_bf16 a[188:191], a[212:215], v[220:223], a[188:191]
    s_add_u32 s77, s40, s66
    v_add_f32 v27, v27, v51
    v_mfma_f32_16x16x32_bf16 a[184:187], a[212:215], v[212:215], a[184:187]
    ds_read_b128 a[232:235], v16 offset:13312
    v_add_f32 v27, v27, v52
    v_mfma_f32_16x16x32_bf16 a[168:171], a[208:211], v[212:215], a[168:171]
    v_cvt_pk_bf16_f32 v254, v52, v53
    v_mfma_f32_16x16x32_bf16 a[152:155], a[204:207], v[212:215], a[152:155]
    v_add_f32 v27, v27, v53
    v_mfma_f32_16x16x32_bf16 a[136:139], a[200:203], v[212:215], a[136:139]
    ds_read_b128 a[236:239], v17 offset:13312
    v_add_f32 v27, v27, v54
    v_mfma_f32_16x16x32_bf16 a[120:123], a[196:199], v[212:215], a[120:123]
    v_cvt_pk_bf16_f32 v255, v54, v55
    v_mfma_f32_16x16x32_bf16 a[104:107], a[192:195], v[212:215], a[104:107]
    v_add_f32 v27, v27, v55
    v_mfma_f32_16x16x32_bf16 a[100:103], a[192:195], v[204:207], a[100:103]
    ds_read_b128 a[240:243], v16 offset:14336
    v_max_f32 v29, v29, v27
    v_mfma_f32_16x16x32_bf16 a[116:119], a[196:199], v[204:207], a[116:119]
    v_cmp_nle_f32 vcc, v29, v30
    v_mfma_f32_16x16x32_bf16 a[132:135], a[200:203], v[204:207], a[132:135]
    v_mfma_f32_16x16x32_bf16 a[148:151], a[204:207], v[204:207], a[148:151]
    s_add_u32 m0, s43, 73728
    ds_read_b128 a[244:247], v17 offset:14336
    v_mfma_f32_16x16x32_bf16 a[164:167], a[208:211], v[204:207], a[164:167]
    buffer_load_dwordx4 v6, s[16:19], s40 offen offset:0 lds
    v_mfma_f32_16x16x32_bf16 a[180:183], a[212:215], v[204:207], a[180:183]
    v_mfma_f32_16x16x32_bf16 a[176:179], a[212:215], v[196:199], a[176:179]
    s_cmp_eq_u32 s45, 2
    s_cselect_b64 s[88:89], -1, 0
    s_cselect_b64 s[12:13], s[8:9], s[12:13]
    v_mfma_f32_16x16x32_bf16 a[160:163], a[208:211], v[196:199], a[160:163]
    s_cmp_eq_u32 s45, 2
    s_cselect_b32 s14, s10, s14
    s_cselect_b32 s38, s36, s38
    v_mfma_f32_16x16x32_bf16 a[144:147], a[204:207], v[196:199], a[144:147]
    s_cmp_eq_u32 s45, 2
    s_cselect_b32 s39, 81920, s39
    s_cselect_b32 s76, s63, s76
    v_mfma_f32_16x16x32_bf16 a[128:131], a[200:203], v[196:199], a[128:131]
    v_cndmask_b32 v4, v4, v62, s[88:89]
    v_cndmask_b32 v5, v5, v63, s[88:89]
    v_mfma_f32_16x16x32_bf16 a[112:115], a[196:199], v[196:199], a[112:115]
    v_mfma_f32_16x16x32_bf16 a[96:99], a[192:195], v[196:199], a[96:99]
    s_waitcnt lgkmcnt(0)
    s_cbranch_vccnz rare_a
rare_a_ret:
    v_mfma_f32_16x16x32_bf16 v[132:135], a[224:227], v[64:67], v[32:35]
    ds_read_b128 a[192:195], v16 offset:18432
    v_add_f32 v20, v20, v24
    v_mfma_f32_16x16x32_bf16 v[132:135], a[228:231], v[96:99], v[132:135]
    v_add_f32 v21, v21, v25
    v_add_f32 v22, v22, v26
    v_mfma_f32_16x16x32_bf16 v[132:135], a[232:235], v[128:131], v[132:135]
    v_add_f32 v23, v23, v27
    v_mfma_f32_16x16x32_bf16 v[132:135], a[236:239], v[160:163], v[132:135]
    ds_read_b128 a[196:199], v17 offset:18432
    v_mfma_f32_16x16x32_bf16 v[132:135], a[240:243], v[192:195], v[132:135]
    v_exp_f32 v48, v68
    v_mfma_f32_16x16x32_bf16 v[132:135], a[244:247], v[224:227], v[132:135]
    s_add_u32 m0, s43, 74624
    v_exp_f32 v49, v69
    v_mfma_f32_16x16x32_bf16 v[140:143], a[244:247], v[232:235], v[36:39]
    ds_read_b128 a[200:203], v16 offset:19456
    v_cvt_pk_bf16_f32 v196, v48, v49
    v_mfma_f32_16x16x32_bf16 v[140:143], a[240:243], v[200:203], v[140:143]
    buffer_load_dwordx4 v6, s[16:19], s40 offen offset:128 lds
    v_mfma_f32_16x16x32_bf16 v[140:143], a[236:239], v[168:171], v[140:143]
    v_exp_f32 v50, v70
    v_mfma_f32_16x16x32_bf16 v[140:143], a[232:235], v[136:139], v[140:143]
    ds_read_b128 a[204:207], v17 offset:19456
    v_add_f32 v24, v48, v49
    v_mfma_f32_16x16x32_bf16 v[140:143], a[228:231], v[104:107], v[140:143]
    v_exp_f32 v51, v71
    v_mfma_f32_16x16x32_bf16 v[140:143], a[224:227], v[72:75], v[140:143]
    v_exp_f32 v52, v100
    v_mfma_f32_16x16x32_bf16 v[148:151], a[224:227], v[80:83], v[40:43]
    ds_read_b128 a[208:211], v16 offset:20480
    v_add_f32 v24, v24, v50
    v_mfma_f32_16x16x32_bf16 v[148:151], a[228:231], v[112:115], v[148:151]
    v_exp_f32 v53, v101
    v_mfma_f32_16x16x32_bf16 v[148:151], a[232:235], v[144:147], v[148:151]
    v_exp_f32 v54, v102
    v_mfma_f32_16x16x32_bf16 v[148:151], a[236:239], v[176:179], v[148:151]
    ds_read_b128 a[212:215], v17 offset:20480
    v_cvt_pk_bf16_f32 v197, v50, v51
    v_mfma_f32_16x16x32_bf16 v[148:151], a[240:243], v[208:211], v[148:151]
    v_exp_f32 v55, v103
    v_mfma_f32_16x16x32_bf16 v[148:151], a[244:247], v[240:243], v[148:151]
    v_add_f32 v24, v24, v51
    v_add_f32 v24, v24, v52
    v_mfma_f32_16x16x32_bf16 v[156:159], a[244:247], v[248:251], v[44:47]
    v_exp_f32 v48, v76
    v_mfma_f32_16x16x32_bf16 v[156:159], a[240:243], v[216:219], v[156:159]
    s_add_u32 m0, s43, 75520
    v_exp_f32 v49, v77
    v_mfma_f32_16x16x32_bf16 v[156:159], a[236:239], v[184:187], v[156:159]
    buffer_load_dwordx4 v6, s[16:19], s77 offen offset:256 lds
    v_mfma_f32_16x16x32_bf16 v[156:159], a[232:235], v[152:155], v[156:159]
    v_cvt_pk_bf16_f32 v198, v52, v53
    v_add_f32 v24, v24, v53
    v_mfma_f32_16x16x32_bf16 v[156:159], a[228:231], v[120:123], v[156:159]
    v_exp_f32 v50, v78
    v_mfma_f32_16x16x32_bf16 v[156:159], a[224:227], v[88:91], v[156:159]
    s_waitcnt lgkmcnt(0)
    v_add_f32 v24, v24, v54
    v_cvt_pk_bf16_f32 v199, v54, v55
    v_mfma_f32_16x16x32_bf16 v[188:191], a[192:195], v[88:91], v[44:47]
    ds_read_b64_tr_b16 a[224:225], v8 offset:12288
    v_add_f32 v24, v24, v55
    v_mfma_f32_16x16x32_bf16 v[188:191], a[196:199], v[120:123], v[188:191]
    ds_read_b64_tr_b16 a[226:227], v8 offset:18432
    v_cvt_pk_bf16_f32 v204, v48, v49
    v_mfma_f32_16x16x32_bf16 v[188:191], a[200:203], v[152:155], v[188:191]
    v_exp_f32 v51, v79
    v_mfma_f32_16x16x32_bf16 v[188:191], a[204:207], v[184:187], v[188:191]
    ds_read_b64_tr_b16 a[228:229], v9 offset:12288
    v_add_f32 v25, v48, v49
    v_mfma_f32_16x16x32_bf16 v[188:191], a[208:211], v[216:219], v[188:191]
    ds_read_b64_tr_b16 a[230:231], v9 offset:18432
    v_add_f32 v25, v25, v50
    v_mfma_f32_16x16x32_bf16 v[188:191], a[212:215], v[248:251], v[188:191]
    v_exp_f32 v52, v108
    v_mfma_f32_16x16x32_bf16 v[180:183], a[212:215], v[240:243], v[40:43]
    ds_read_b64_tr_b16 a[232:233], v10 offset:12288
    v_cvt_pk_bf16_f32 v205, v50, v51
    v_mfma_f32_16x16x32_bf16 v[180:183], a[208:211], v[208:211], v[180:183]
    ds_read_b64_tr_b16 a[234:235], v10 offset:18432
    v_add_f32 v25, v25, v51
    v_mfma_f32_16x16x32_bf16 v[180:183], a[204:207], v[176:179], v[180:183]
    v_exp_f32 v53, v109
    v_mfma_f32_16x16x32_bf16 v[180:183], a[200:203], v[144:147], v[180:183]
    s_add_u32 m0, s43, 76800
    ds_read_b64_tr_b16 a[236:237], v11 offset:12288
    v_add_f32 v25, v25, v52
    v_mfma_f32_16x16x32_bf16 v[180:183], a[196:199], v[112:115], v[180:183]
    ds_read_b64_tr_b16 a[238:239], v11 offset:18432
    v_cvt_pk_bf16_f32 v206, v52, v53
    v_mfma_f32_16x16x32_bf16 v[180:183], a[192:195], v[80:83], v[180:183]
    buffer_load_dwordx4 v7, s[16:19], s40 offen offset:0 lds
    v_mfma_f32_16x16x32_bf16 v[172:175], a[192:195], v[72:75], v[36:39]
    ds_read_b64_tr_b16 a[240:241], v8 offset:13312
    v_add_f32 v25, v25, v53
    v_mfma_f32_16x16x32_bf16 v[172:175], a[196:199], v[104:107], v[172:175]
    ds_read_b64_tr_b16 a[242:243], v8 offset:19456
    v_add_u32 v16, s43, v18
    v_mfma_f32_16x16x32_bf16 v[172:175], a[200:203], v[136:139], v[172:175]
    v_exp_f32 v54, v110
    v_mfma_f32_16x16x32_bf16 v[172:175], a[204:207], v[168:171], v[172:175]
    ds_read_b64_tr_b16 a[244:245], v9 offset:13312
    v_add_f32 v25, v25, v54
    v_mfma_f32_16x16x32_bf16 v[172:175], a[208:211], v[200:203], v[172:175]
    ds_read_b64_tr_b16 a[246:247], v9 offset:19456
    v_add_u32 v17, s43, v19
    v_mfma_f32_16x16x32_bf16 v[172:175], a[212:215], v[232:235], v[172:175]
    v_exp_f32 v55, v111
    v_mfma_f32_16x16x32_bf16 v[164:167], a[212:215], v[224:227], v[32:35]
    v_exp_f32 v48, v84
    v_mfma_f32_16x16x32_bf16 v[164:167], a[208:211], v[192:195], v[164:167]
    v_exp_f32 v49, v85
    v_mfma_f32_16x16x32_bf16 v[164:167], a[204:207], v[160:163], v[164:167]
    v_exp_f32 v50, v86
    v_mfma_f32_16x16x32_bf16 v[164:167], a[200:203], v[128:131], v[164:167]
    v_exp_f32 v51, v87
    v_mfma_f32_16x16x32_bf16 v[164:167], a[196:199], v[96:99], v[164:167]
    v_cvt_pk_bf16_f32 v207, v54, v55
    v_add_f32 v25, v25, v55
    v_mfma_f32_16x16x32_bf16 v[164:167], a[192:195], v[64:67], v[164:167]
    s_waitcnt lgkmcnt(0)
    v_exp_f32 v52, v116
    v_mfma_f32_16x16x32_bf16 a[0:3], a[224:227], v[228:231], a[0:3]
    s_add_u32 m0, s43, 77696
    ds_read_b64_tr_b16 a[192:193], v10 offset:13312
    v_cvt_pk_bf16_f32 v212, v48, v49
    v_mfma_f32_16x16x32_bf16 a[16:19], a[228:231], v[228:231], a[16:19]
    ds_read_b64_tr_b16 a[194:195], v10 offset:19456
    v_add_f32 v26, v48, v49
    v_mfma_f32_16x16x32_bf16 a[32:35], a[232:235], v[228:231], a[32:35]
    buffer_load_dwordx4 v7, s[16:19], s40 offen offset:128 lds
    v_mfma_f32_16x16x32_bf16 a[48:51], a[236:239], v[228:231], a[48:51]
    ds_read_b64_tr_b16 a[196:197], v11 offset:13312
    v_add_f32 v26, v26, v50
    v_mfma_f32_16x16x32_bf16 a[64:67], a[240:243], v[228:231], a[64:67]
    ds_read_b64_tr_b16 a[198:199], v11 offset:19456
    v_cvt_pk_bf16_f32 v213, v50, v51
    v_mfma_f32_16x16x32_bf16 a[80:83], a[244:247], v[228:231], a[80:83]
    v_exp_f32 v53, v117
    v_mfma_f32_16x16x32_bf16 a[84:87], a[244:247], v[236:239], a[84:87]
    ds_read_b64_tr_b16 a[200:201], v8 offset:14336
    v_add_f32 v26, v26, v51
    v_mfma_f32_16x16x32_bf16 a[68:71], a[240:243], v[236:239], a[68:71]
    ds_read_b64_tr_b16 a[202:203], v8 offset:20480
    v_add_f32 v26, v26, v52
    v_mfma_f32_16x16x32_bf16 a[52:55], a[236:239], v[236:239], a[52:55]
    v_exp_f32 v54, v118
    v_mfma_f32_16x16x32_bf16 a[36:39], a[232:235], v[236:239], a[36:39]
    ds_read_b64_tr_b16 a[204:205], v9 offset:14336
    v_cvt_pk_bf16_f32 v214, v52, v53
    v_mfma_f32_16x16x32_bf16 a[20:23], a[228:231], v[236:239], a[20:23]
    ds_read_b64_tr_b16 a[206:207], v9 offset:20480
    v_add_f32 v26, v26, v53
    v_mfma_f32_16x16x32_bf16 a[4:7], a[224:227], v[236:239], a[4:7]
    v_exp_f32 v55, v119
    v_mfma_f32_16x16x32_bf16 a[8:11], a[224:227], v[244:247], a[8:11]
    ds_read_b64_tr_b16 a[208:209], v10 offset:14336
    v_add_f32 v26, v26, v54
    v_mfma_f32_16x16x32_bf16 a[24:27], a[228:231], v[244:247], a[24:27]
    s_add_u32 m0, s43, 78592
    ds_read_b64_tr_b16 a[210:211], v10 offset:20480
    v_cvt_pk_bf16_f32 v215, v54, v55
    v_mfma_f32_16x16x32_bf16 a[40:43], a[232:235], v[244:247], a[40:43]
    buffer_load_dwordx4 v7, s[16:19], s77 offen offset:256 lds
    v_mfma_f32_16x16x32_bf16 a[56:59], a[236:239], v[244:247], a[56:59]
    ds_read_b64_tr_b16 a[212:213], v11 offset:14336
    v_add_f32 v26, v26, v55
    v_mfma_f32_16x16x32_bf16 a[72:75], a[240:243], v[244:247], a[72:75]
    s_add_u32 s40, s40, 24576
    ds_read_b64_tr_b16 a[214:215], v11 offset:20480
    v_max3_f32 v29, v24, v25, v26
    v_mfma_f32_16x16x32_bf16 a[88:91], a[244:247], v[244:247], a[88:91]
    s_add_u32 s77, s38, s39
    v_exp_f32 v48, v92
    v_mfma_f32_16x16x32_bf16 a[92:95], a[244:247], v[252:255], a[92:95]
    v_exp_f32 v49, v93
    v_mfma_f32_16x16x32_bf16 a[76:79], a[240:243], v[252:255], a[76:79]
    v_exp_f32 v50, v94
    v_mfma_f32_16x16x32_bf16 a[60:63], a[236:239], v[252:255], a[60:63]
    v_exp_f32 v51, v95
    v_mfma_f32_16x16x32_bf16 a[44:47], a[232:235], v[252:255], a[44:47]
    s_waitcnt vmcnt(12)
    v_exp_f32 v52, v124
    v_mfma_f32_16x16x32_bf16 a[28:31], a[228:231], v[252:255], a[28:31]
    s_barrier
    v_mfma_f32_16x16x32_bf16 a[12:15], a[224:227], v[252:255], a[12:15]
    s_waitcnt lgkmcnt(0)
    v_exp_f32 v53, v125
    v_mfma_f32_16x16x32_bf16 a[108:111], a[192:195], v[252:255], a[108:111]
    ds_read_b128 a[224:227], v16 offset:0
    v_cvt_pk_bf16_f32 v220, v48, v49
    v_mfma_f32_16x16x32_bf16 a[124:127], a[196:199], v[252:255], a[124:127]
    v_add_f32 v27, v48, v49
    v_mfma_f32_16x16x32_bf16 a[140:143], a[200:203], v[252:255], a[140:143]
    v_exp_f32 v54, v126
    v_mfma_f32_16x16x32_bf16 a[156:159], a[204:207], v[252:255], a[156:159]
    ds_read_b128 a[228:231], v17 offset:0
    v_add_f32 v27, v27, v50
    v_mfma_f32_16x16x32_bf16 a[172:175], a[208:211], v[252:255], a[172:175]
    v_exp_f32 v55, v127
    v_mfma_f32_16x16x32_bf16 a[188:191], a[212:215], v[252:255], a[188:191]
    v_cvt_pk_bf16_f32 v221, v50, v51
    v_add_f32 v27, v27, v51
    v_mfma_f32_16x16x32_bf16 a[184:187], a[212:215], v[244:247], a[184:187]
    ds_read_b128 a[232:235], v16 offset:1024
    v_add_f32 v27, v27, v52
    v_mfma_f32_16x16x32_bf16 a[168:171], a[208:211], v[244:247], a[168:171]
    v_cvt_pk_bf16_f32 v222, v52, v53
    v_mfma_f32_16x16x32_bf16 a[152:155], a[204:207], v[244:247], a[152:155]
    v_add_f32 v27, v27, v53
    v_mfma_f32_16x16x32_bf16 a[136:139], a[200:203], v[244:247], a[136:139]
    ds_read_b128 a[236:239], v17 offset:1024
    v_add_f32 v27, v27, v54
    v_mfma_f32_16x16x32_bf16 a[120:123], a[196:199], v[244:247], a[120:123]
    buffer_load_dword a216, v2, s[28:31], s6 offen
    v_mfma_f32_16x16x32_bf16 a[104:107], a[192:195], v[244:247], a[104:107]
    s_add_u32 s6, s6, 1536
    v_cvt_pk_bf16_f32 v223, v54, v55
    v_mfma_f32_16x16x32_bf16 a[100:103], a[192:195], v[236:239], a[100:103]
    s_mov_b32 s44, s41
    ds_read_b128 a[240:243], v16 offset:2048
    v_add_f32 v27, v27, v55
    v_mfma_f32_16x16x32_bf16 a[116:119], a[196:199], v[236:239], a[116:119]
    s_mov_b32 s41, s42
    v_max_f32 v29, v29, v27
    v_mfma_f32_16x16x32_bf16 a[132:135], a[200:203], v[236:239], a[132:135]
    s_mov_b32 s42, s43
    v_cmp_nle_f32 vcc, v29, v30
    s_mov_b32 s43, s44
    v_mfma_f32_16x16x32_bf16 a[148:151], a[204:207], v[236:239], a[148:151]
    ds_read_b128 a[244:247], v17 offset:2048
    v_mfma_f32_16x16x32_bf16 a[164:167], a[208:211], v[236:239], a[164:167]
    s_cmp_eq_u32 s45, 1
    s_cselect_b64 s[88:89], -1, 0
    s_cselect_b64 s[16:17], s[8:9], s[16:17]
    v_mfma_f32_16x16x32_bf16 a[180:183], a[212:215], v[236:239], a[180:183]
    s_cmp_eq_u32 s45, 1
    s_cselect_b32 s18, s10, s18
    s_cselect_b32 s40, s77, s40
    v_mfma_f32_16x16x32_bf16 a[176:179], a[212:215], v[228:231], a[176:179]
    s_cmp_eq_u32 s45, 1
    s_cselect_b32 s66, s63, s66
    v_mfma_f32_16x16x32_bf16 a[160:163], a[208:211], v[228:231], a[160:163]
    v_cndmask_b32 v6, v6, v62, s[88:89]
    v_cndmask_b32 v7, v7, v63, s[88:89]
    v_mfma_f32_16x16x32_bf16 a[144:147], a[204:207], v[228:231], a[144:147]
    s_sub_u32 s45, s45, 1
    v_mfma_f32_16x16x32_bf16 a[128:131], a[200:203], v[228:231], a[128:131]
    v_mfma_f32_16x16x32_bf16 a[112:115], a[196:199], v[228:231], a[112:115]
    s_waitcnt lgkmcnt(0)
    v_mfma_f32_16x16x32_bf16 a[96:99], a[192:195], v[228:231], a[96:99]
    s_cbranch_vccnz rare_b
rare_b_ret:
    s_cbranch_scc0 at_loop
tail_code:
    v_add_u32 v8, s41, v12
    v_add_u32 v9, s41, v13
    v_add_u32 v10, s41, v14
    v_add_u32 v11, s41, v15
    s_waitcnt lgkmcnt(0)
    ds_read_b64_tr_b16 a[192:193], v8 offset:0
    ds_read_b64_tr_b16 a[194:195], v8 offset:6144
    ds_read_b64_tr_b16 a[196:197], v9 offset:0
    ds_read_b64_tr_b16 a[198:199], v9 offset:6144
    ds_read_b64_tr_b16 a[200:201], v10 offset:0
    ds_read_b64_tr_b16 a[202:203], v10 offset:6144
    ds_read_b64_tr_b16 a[204:205], v11 offset:0
    ds_read_b64_tr_b16 a[206:207], v11 offset:6144
    s_waitcnt lgkmcnt(4)
    v_mfma_f32_16x16x32_bf16 a[0:3], a[192:195], v[196:199], a[0:3]
    s_add_u32 s38, s33, 0
    ds_read_b64_tr_b16 a[208:209], v8 offset:1024
    v_add_f32 v20, v20, v24
    v_mfma_f32_16x16x32_bf16 a[16:19], a[196:199], v[196:199], a[16:19]
    s_add_u32 s57, s34, 0
    ds_read_b64_tr_b16 a[210:211], v8 offset:7168
    v_add_f32 v21, v21, v25
    v_mfma_f32_16x16x32_bf16 a[20:23], a[196:199], v[204:207], a[20:23]
    buffer_load_dword v61, v60, s[24:27], s37 offen sc1
    v_mfma_f32_16x16x32_bf16 a[4:7], a[192:195], v[204:207], a[4:7]
    s_cmp_lt_u32 s3, 2
    s_cselect_b32 s38, s38, s57
    v_add_f32 v22, v22, v26
    v_mfma_f32_16x16x32_bf16 a[8:11], a[192:195], v[212:215], a[8:11]
    s_add_u32 s76, s38, s63
    ds_read_b64_tr_b16 a[212:213], v9 offset:1024
    v_add_f32 v23, v23, v27
    v_mfma_f32_16x16x32_bf16 a[24:27], a[196:199], v[212:215], a[24:27]
    s_add_u32 m0, s49, 24576
    ds_read_b64_tr_b16 a[214:215], v9 offset:7168
    s_and_b32 s59, s51, 1
    v_mfma_f32_16x16x32_bf16 a[28:31], a[196:199], v[220:223], a[28:31]
    buffer_load_dwordx4 v4, s[12:15], s38 offen offset:0 lds
    v_mfma_f32_16x16x32_bf16 a[12:15], a[192:195], v[220:223], a[12:15]
    s_waitcnt lgkmcnt(4)
    v_exp_f32 v48, v132
    v_mfma_f32_16x16x32_bf16 a[44:47], a[200:203], v[220:223], a[44:47]
    s_lshl_b32 s59, s59, 6
    ds_read_b64_tr_b16 a[192:193], v10 offset:1024
    s_sub_u32 s44, s49, 73728
    v_mfma_f32_16x16x32_bf16 a[60:63], a[204:207], v[220:223], a[60:63]
    s_add_u32 m0, s49, 25472
    ds_read_b64_tr_b16 a[194:195], v10 offset:7168
    v_add_u32 v12, s44, v12
    v_mfma_f32_16x16x32_bf16 a[56:59], a[204:207], v[212:215], a[56:59]
    buffer_load_dwordx4 v4, s[12:15], s38 offen offset:128 lds
    v_mfma_f32_16x16x32_bf16 a[40:43], a[200:203], v[212:215], a[40:43]
    v_add_u32 v13, s44, v13
    v_add_u32 v14, s44, v14
    v_mfma_f32_16x16x32_bf16 a[36:39], a[200:203], v[204:207], a[36:39]
    ds_read_b64_tr_b16 a[196:197], v11 offset:1024
    v_add_u32 v15, s44, v15
    v_mfma_f32_16x16x32_bf16 a[52:55], a[204:207], v[204:207], a[52:55]
    s_add_u32 m0, s49, 26368
    ds_read_b64_tr_b16 a[198:199], v11 offset:7168
    s_mov_b32 s39, s59
    v_mfma_f32_16x16x32_bf16 a[48:51], a[204:207], v[196:199], a[48:51]
    buffer_load_dwordx4 v4, s[12:15], s76 offen offset:256 lds
    v_mfma_f32_16x16x32_bf16 a[32:35], a[200:203], v[196:199], a[32:35]
    s_waitcnt lgkmcnt(4)
    v_exp_f32 v49, v133
    v_mfma_f32_16x16x32_bf16 a[64:67], a[208:211], v[196:199], a[64:67]
    s_lshl_b32 s36, s3, 10
    ds_read_b64_tr_b16 a[200:201], v8 offset:2048
    v_cvt_pk_bf16_f32 v228, v48, v49
    v_mfma_f32_16x16x32_bf16 a[80:83], a[212:215], v[196:199], a[80:83]
    s_add_u32 m0, s49, 27648
    ds_read_b64_tr_b16 a[202:203], v8 offset:8192
    v_add_f32 v24, v48, v49
    v_mfma_f32_16x16x32_bf16 a[84:87], a[212:215], v[204:207], a[84:87]
    buffer_load_dwordx4 v5, s[12:15], s38 offen offset:0 lds
    v_mfma_f32_16x16x32_bf16 a[68:71], a[208:211], v[204:207], a[68:71]
    v_exp_f32 v50, v134
    v_mfma_f32_16x16x32_bf16 a[72:75], a[208:211], v[212:215], a[72:75]
    ds_read_b64_tr_b16 a[204:205], v9 offset:2048
    v_add_f32 v24, v24, v50
    v_mfma_f32_16x16x32_bf16 a[88:91], a[212:215], v[212:215], a[88:91]
    s_add_u32 m0, s49, 28544
    ds_read_b64_tr_b16 a[206:207], v9 offset:8192
    v_mfma_f32_16x16x32_bf16 a[92:95], a[212:215], v[220:223], a[92:95]
    buffer_load_dwordx4 v5, s[12:15], s38 offen offset:128 lds
    v_mfma_f32_16x16x32_bf16 a[76:79], a[208:211], v[220:223], a[76:79]
    s_waitcnt lgkmcnt(4)
    v_exp_f32 v51, v135
    v_mfma_f32_16x16x32_bf16 a[108:111], a[192:195], v[220:223], a[108:111]
    ds_read_b64_tr_b16 a[208:209], v10 offset:2048
    v_cvt_pk_bf16_f32 v229, v50, v51
    v_mfma_f32_16x16x32_bf16 a[124:127], a[196:199], v[220:223], a[124:127]
    s_add_u32 m0, s49, 29440
    ds_read_b64_tr_b16 a[210:211], v10 offset:8192
    v_add_f32 v24, v24, v51
    v_mfma_f32_16x16x32_bf16 a[120:123], a[196:199], v[212:215], a[120:123]
    buffer_load_dwordx4 v5, s[12:15], s76 offen offset:256 lds
    v_mfma_f32_16x16x32_bf16 a[104:107], a[192:195], v[212:215], a[104:107]
    s_add_u32 s38, s35, 0
    v_exp_f32 v52, v164
    v_mfma_f32_16x16x32_bf16 a[100:103], a[192:195], v[204:207], a[100:103]
    s_add_u32 s57, s33, 40960
    ds_read_b64_tr_b16 a[212:213], v11 offset:2048
    v_add_f32 v24, v24, v52
    v_mfma_f32_16x16x32_bf16 a[116:119], a[196:199], v[204:207], a[116:119]
    s_cmp_lt_u32 s3, 2
    s_cselect_b32 s38, s38, s57
    ds_read_b64_tr_b16 a[214:215], v11 offset:8192
    v_mfma_f32_16x16x32_bf16 a[112:115], a[196:199], v[196:199], a[112:115]
    s_add_u32 s76, s38, s63
    v_exp_f32 v53, v165
    v_mfma_f32_16x16x32_bf16 a[96:99], a[192:195], v[196:199], a[96:99]
    s_waitcnt lgkmcnt(4)
    v_exp_f32 v54, v166
    v_mfma_f32_16x16x32_bf16 a[128:131], a[200:203], v[196:199], a[128:131]
    s_add_u32 m0, s49, 73728
    ds_read_b64_tr_b16 a[192:193], v8 offset:12288
    v_cvt_pk_bf16_f32 v230, v52, v53
    v_mfma_f32_16x16x32_bf16 a[144:147], a[204:207], v[196:199], a[144:147]
pg_7:
    s_cbranch_execz pg_11
    ds_read_b64_tr_b16 a[194:195], v8 offset:18432
    v_add_f32 v24, v24, v53
    v_mfma_f32_16x16x32_bf16 a[148:151], a[204:207], v[204:207], a[148:151]
    buffer_load_dwordx4 v4, s[12:15], s38 offen offset:0 lds
    v_mfma_f32_16x16x32_bf16 a[132:135], a[200:203], v[204:207], a[132:135]
    v_exp_f32 v55, v167
    v_mfma_f32_16x16x32_bf16 a[136:139], a[200:203], v[212:215], a[136:139]
    s_add_u32 m0, s49, 74624
    ds_read_b64_tr_b16 a[196:197], v9 offset:12288
    v_add_f32 v24, v24, v54
    v_mfma_f32_16x16x32_bf16 a[152:155], a[204:207], v[212:215], a[152:155]
    ds_read_b64_tr_b16 a[198:199], v9 offset:18432
    v_cvt_pk_bf16_f32 v231, v54, v55
    v_mfma_f32_16x16x32_bf16 a[156:159], a[204:207], v[220:223], a[156:159]
    buffer_load_dwordx4 v4, s[12:15], s38 offen offset:128 lds
    v_mfma_f32_16x16x32_bf16 a[140:143], a[200:203], v[220:223], a[140:143]
    s_waitcnt lgkmcnt(4)
    v_exp_f32 v48, v140
    v_mfma_f32_16x16x32_bf16 a[172:175], a[208:211], v[220:223], a[172:175]
    ds_read_b64_tr_b16 a[200:201], v10 offset:12288
    v_add_f32 v24, v24, v55
    v_mfma_f32_16x16x32_bf16 a[188:191], a[212:215], v[220:223], a[188:191]
    s_add_u32 m0, s49, 75520
    ds_read_b64_tr_b16 a[202:203], v10 offset:18432
    v_mfma_f32_16x16x32_bf16 a[184:187], a[212:215], v[212:215], a[184:187]
    buffer_load_dwordx4 v4, s[12:15], s76 offen offset:256 lds
    v_mfma_f32_16x16x32_bf16 a[168:171], a[208:211], v[212:215], a[168:171]
    v_exp_f32 v49, v141
    v_mfma_f32_16x16x32_bf16 a[164:167], a[208:211], v[204:207], a[164:167]
    ds_read_b64_tr_b16 a[204:205], v11 offset:12288
    v_cvt_pk_bf16_f32 v236, v48, v49
    v_mfma_f32_16x16x32_bf16 a[180:183], a[212:215], v[204:207], a[180:183]
    ds_read_b64_tr_b16 a[206:207], v11 offset:18432
    v_add_f32 v25, v48, v49
    v_mfma_f32_16x16x32_bf16 a[176:179], a[212:215], v[196:199], a[176:179]
    s_add_u32 m0, s49, 76800
    v_exp_f32 v50, v142
    v_mfma_f32_16x16x32_bf16 a[160:163], a[208:211], v[196:199], a[160:163]
    s_waitcnt lgkmcnt(4)
    v_exp_f32 v51, v143
    v_add_f32 v25, v25, v50
    v_cvt_pk_bf16_f32 v237, v50, v51
    v_exp_f32 v52, v172
    v_exp_f32 v53, v173
    v_add_f32 v25, v25, v51
    v_cvt_pk_bf16_f32 v238, v52, v53
    v_exp_f32 v54, v174
    v_exp_f32 v55, v175
    v_add_f32 v25, v25, v52
    v_cvt_pk_bf16_f32 v239, v54, v55
    v_add_f32 v25, v25, v53
    v_add_f32 v25, v25, v54
    v_add_f32 v25, v25, v55
    v_exp_f32 v48, v148
    v_exp_f32 v49, v149
    v_exp_f32 v50, v150
    v_cvt_pk_bf16_f32 v244, v48, v49
    v_exp_f32 v51, v151
    v_add_f32 v26, v48, v49
    v_cvt_pk_bf16_f32 v245, v50, v51
    v_exp_f32 v52, v180
    v_exp_f32 v53, v181
    v_add_f32 v26, v26, v50
    v_cvt_pk_bf16_f32 v246, v52, v53
    v_exp_f32 v54, v182
    v_exp_f32 v55, v183
    v_add_f32 v26, v26, v51
    v_cvt_pk_bf16_f32 v247, v54, v55
    v_add_f32 v26, v26, v52
    v_add_f32 v26, v26, v53
    v_add_f32 v26, v26, v54
    v_add_f32 v26, v26, v55
    v_max3_f32 v29, v24, v25, v26
    v_exp_f32 v48, v156
    v_exp_f32 v49, v157
    v_exp_f32 v50, v158
    v_cvt_pk_bf16_f32 v252, v48, v49
    v_exp_f32 v51, v159
    v_add_f32 v27, v48, v49
    v_cvt_pk_bf16_f32 v253, v50, v51
    v_exp_f32 v52, v188
    v_exp_f32 v53, v189
    v_add_f32 v27, v27, v50
    v_cvt_pk_bf16_f32 v254, v52, v53
    v_exp_f32 v54, v190
    v_exp_f32 v55, v191
    v_add_f32 v27, v27, v51
    v_cvt_pk_bf16_f32 v255, v54, v55
    v_add_f32 v27, v27, v52
    v_add_f32 v27, v27, v53
    v_add_f32 v27, v27, v54
    v_add_f32 v27, v27, v55
    v_max_f32 v29, v29, v27
    v_cmp_nle_f32 vcc, v29, v30
    s_cbranch_vccnz rare_e
rare_e_ret:
    v_mfma_f32_16x16x32_bf16 a[0:3], a[192:195], v[228:231], a[0:3]
    ds_read_b64_tr_b16 a[208:209], v8 offset:13312
    v_add_f32 v20, v20, v24
    v_mfma_f32_16x16x32_bf16 a[16:19], a[196:199], v[228:231], a[16:19]
    ds_read_b64_tr_b16 a[210:211], v8 offset:19456
    v_add_f32 v21, v21, v25
    v_mfma_f32_16x16x32_bf16 a[20:23], a[196:199], v[236:239], a[20:23]
    buffer_load_dwordx4 v5, s[12:15], s38 offen offset:0 lds
    v_mfma_f32_16x16x32_bf16 a[4:7], a[192:195], v[236:239], a[4:7]
    s_add_u32 m0, s49, 77696
    v_add_f32 v22, v22, v26
    v_add_f32 v23, v23, v27
    v_mfma_f32_16x16x32_bf16 a[8:11], a[192:195], v[244:247], a[8:11]
    ds_read_b64_tr_b16 a[212:213], v9 offset:13312
    v_mov_b32 v56, v20
    v_mfma_f32_16x16x32_bf16 a[24:27], a[196:199], v[244:247], a[24:27]
    ds_read_b64_tr_b16 a[214:215], v9 offset:19456
    v_mov_b32 v57, v21
    v_mfma_f32_16x16x32_bf16 a[28:31], a[196:199], v[252:255], a[28:31]
    buffer_load_dwordx4 v5, s[12:15], s38 offen offset:128 lds
    v_mfma_f32_16x16x32_bf16 a[12:15], a[192:195], v[252:255], a[12:15]
    s_waitcnt lgkmcnt(4)
    v_permlane16_swap_b32 v20, v56
    v_mfma_f32_16x16x32_bf16 a[44:47], a[200:203], v[252:255], a[44:47]
    s_add_u32 m0, s49, 78592
    ds_read_b64_tr_b16 a[192:193], v10 offset:13312
    v_add_f32 v20, v20, v56
    v_mfma_f32_16x16x32_bf16 a[60:63], a[204:207], v[252:255], a[60:63]
    ds_read_b64_tr_b16 a[194:195], v10 offset:19456
    v_mov_b32 v56, v20
    v_mfma_f32_16x16x32_bf16 a[56:59], a[204:207], v[244:247], a[56:59]
    buffer_load_dwordx4 v5, s[12:15], s76 offen offset:256 lds
    v_mfma_f32_16x16x32_bf16 a[40:43], a[200:203], v[244:247], a[40:43]
    v_permlane32_swap_b32 v20, v56
    v_mfma_f32_16x16x32_bf16 a[36:39], a[200:203], v[236:239], a[36:39]
    s_waitcnt vmcnt(12)
    ds_read_b64_tr_b16 a[196:197], v11 offset:13312
    v_cmp_ne_u32 vcc, s7, v61
    v_mfma_f32_16x16x32_bf16 a[52:55], a[204:207], v[236:239], a[52:55]
    s_lshl_b32 s11, s54, 16
    ds_read_b64_tr_b16 a[198:199], v11 offset:19456
    v_add_f32 v20, v20, v56
    v_mfma_f32_16x16x32_bf16 a[48:51], a[204:207], v[228:231], a[48:51]
    s_cbranch_vccnz spin_gu
spin_gu_ret:
    v_mul_f32 v20, 0x3c800000, v20
    v_mfma_f32_16x16x32_bf16 a[32:35], a[200:203], v[228:231], a[32:35]
    s_waitcnt lgkmcnt(4)
    v_rcp_f32 v20, v20
    v_mfma_f32_16x16x32_bf16 a[64:67], a[208:211], v[228:231], a[64:67]
    s_nop 0
    ds_read_b64_tr_b16 a[200:201], v8 offset:14336
    v_mov_b32 v58, v22
    v_mfma_f32_16x16x32_bf16 a[80:83], a[212:215], v[228:231], a[80:83]
    s_lshl_b32 s61, s47, 10
    ds_read_b64_tr_b16 a[202:203], v8 offset:20480
    v_mov_b32 v59, v23
    v_mfma_f32_16x16x32_bf16 a[84:87], a[212:215], v[236:239], a[84:87]
    s_add_u32 s61, s61, 3276800
    v_permlane16_swap_b32 v21, v57
    v_mfma_f32_16x16x32_bf16 a[68:71], a[208:211], v[236:239], a[68:71]
    s_add_u32 s56, s3, 0
    v_permlane16_swap_b32 v22, v58
    v_mfma_f32_16x16x32_bf16 a[72:75], a[208:211], v[244:247], a[72:75]
    s_min_u32 s56, s56, 9
    ds_read_b64_tr_b16 a[204:205], v9 offset:14336
    v_add_f32 v21, v21, v57
    v_mfma_f32_16x16x32_bf16 a[88:91], a[212:215], v[244:247], a[88:91]
    s_mul_i32 s57, s56, 24576
    ds_read_b64_tr_b16 a[206:207], v9 offset:20480
    v_mov_b32 v57, v21
    v_mfma_f32_16x16x32_bf16 a[92:95], a[212:215], v[252:255], a[92:95]
    s_add_u32 s57, s57, s61
    v_permlane32_swap_b32 v21, v57
    v_mfma_f32_16x16x32_bf16 a[76:79], a[208:211], v[252:255], a[76:79]
    s_waitcnt lgkmcnt(4)
    v_permlane16_swap_b32 v23, v59
    v_mfma_f32_16x16x32_bf16 a[108:111], a[192:195], v[252:255], a[108:111]
    s_lshl_b32 s56, s56, 10
    ds_read_b64_tr_b16 a[208:209], v10 offset:14336
    v_add_f32 v21, v21, v57
    v_mfma_f32_16x16x32_bf16 a[124:127], a[196:199], v[252:255], a[124:127]
    s_add_u32 m0, s56, 147456
    ds_read_b64_tr_b16 a[210:211], v10 offset:20480
    v_mul_f32 v21, 0x3c800000, v21
    v_mfma_f32_16x16x32_bf16 a[120:123], a[196:199], v[244:247], a[120:123]
    buffer_load_dwordx4 v28, s[24:27], s57 offen sc1 lds
    v_mfma_f32_16x16x32_bf16 a[104:107], a[192:195], v[244:247], a[104:107]
    s_add_u32 s56, s3, 4
    v_rcp_f32 v21, v21
    v_mfma_f32_16x16x32_bf16 a[100:103], a[192:195], v[236:239], a[100:103]
    s_min_u32 s56, s56, 9
    ds_read_b64_tr_b16 a[212:213], v11 offset:14336
    v_add_f32 v22, v22, v58
    v_mfma_f32_16x16x32_bf16 a[116:119], a[196:199], v[236:239], a[116:119]
    s_waitcnt vmcnt(34)
    ds_read_b64_tr_b16 a[214:215], v11 offset:20480
    v_mov_b32 v58, v22
    v_mfma_f32_16x16x32_bf16 a[112:115], a[196:199], v[228:231], a[112:115]
    s_barrier
    v_mfma_f32_16x16x32_bf16 a[96:99], a[192:195], v[228:231], a[96:99]
    s_waitcnt lgkmcnt(4)
    v_permlane32_swap_b32 v22, v58
    v_add_u32 v8, 49152, v12
    v_mfma_f32_16x16x32_bf16 a[128:131], a[200:203], v[228:231], a[128:131]
    s_mul_i32 s57, s56, 24576
    ds_read_b64_tr_b16 a[192:193], v8 offset:0
    v_add_f32 v22, v22, v58
    v_mfma_f32_16x16x32_bf16 a[144:147], a[204:207], v[228:231], a[144:147]
    s_add_u32 s57, s57, s61
    ds_read_b64_tr_b16 a[194:195], v8 offset:6144
    v_mul_f32 v22, 0x3c800000, v22
    v_mfma_f32_16x16x32_bf16 a[148:151], a[204:207], v[236:239], a[148:151]
    s_lshl_b32 s56, s56, 10
    v_rcp_f32 v22, v22
    v_mfma_f32_16x16x32_bf16 a[132:135], a[200:203], v[236:239], a[132:135]
    s_add_u32 m0, s56, 147456
    v_add_f32 v23, v23, v59
    v_mov_b32 v59, v23
    v_add_u32 v9, 49152, v13
    v_mfma_f32_16x16x32_bf16 a[136:139], a[200:203], v[244:247], a[136:139]
    s_and_b32 s72, s3, 1
    ds_read_b64_tr_b16 a[196:197], v9 offset:0
    v_add_u32 v10, 49152, v14
    v_mfma_f32_16x16x32_bf16 a[152:155], a[204:207], v[244:247], a[152:155]
    s_lshl_b32 s72, s72, 14
    ds_read_b64_tr_b16 a[198:199], v9 offset:6144
    v_add_u32 v11, 49152, v15
    v_mfma_f32_16x16x32_bf16 a[156:159], a[204:207], v[252:255], a[156:159]
    buffer_load_dwordx4 v28, s[24:27], s57 offen sc1 lds
    v_mfma_f32_16x16x32_bf16 a[140:143], a[200:203], v[252:255], a[140:143]
    s_waitcnt lgkmcnt(4)
    v_permlane32_swap_b32 v23, v59
    v_mfma_f32_16x16x32_bf16 a[172:175], a[208:211], v[252:255], a[172:175]
    s_add_u32 s56, s3, 8
    ds_read_b64_tr_b16 a[200:201], v10 offset:0
    v_add_f32 v23, v23, v59
    v_mfma_f32_16x16x32_bf16 a[188:191], a[212:215], v[252:255], a[188:191]
    s_min_u32 s56, s56, 9
    ds_read_b64_tr_b16 a[202:203], v10 offset:6144
    v_mul_f32 v23, 0x3c800000, v23
    v_mfma_f32_16x16x32_bf16 a[184:187], a[212:215], v[244:247], a[184:187]
    s_mul_i32 s57, s56, 24576
    v_rcp_f32 v23, v23
    v_mfma_f32_16x16x32_bf16 a[168:171], a[208:211], v[244:247], a[168:171]
    s_add_u32 s57, s57, s61
    v_xor_b32 v18, s39, v8
    v_xor_b32 v19, s39, v9
    v_mfma_f32_16x16x32_bf16 a[164:167], a[208:211], v[236:239], a[164:167]
    s_lshl_b32 s56, s56, 10
    ds_read_b64_tr_b16 a[204:205], v11 offset:0
    v_accvgpr_read_b32 v64, a0
    v_mfma_f32_16x16x32_bf16 a[180:183], a[212:215], v[236:239], a[180:183]
    s_add_u32 m0, s56, 147456
    ds_read_b64_tr_b16 a[206:207], v11 offset:6144
    v_accvgpr_read_b32 v65, a1
    v_accvgpr_read_b32 v24, a18
    v_fma_f32 v24, v24, v20, -v20
    v_accvgpr_read_b32 v25, a19
    v_fma_f32 v25, v25, v20, -v20
    v_accvgpr_read_b32 v66, a2
    v_fma_f32 v66, v66, v20, -v20
    v_accvgpr_read_b32 v67, a3
    v_fma_f32 v67, v67, v20, -v20
    v_fma_f32 v64, v64, v20, -v20
    v_fma_f32 v65, v65, v20, -v20
    v_cvt_pk_bf16_f32 v64, v64, v65
    v_cvt_pk_bf16_f32 v65, v66, v67
    v_accvgpr_read_b32 v66, a16
    v_fma_f32 v66, v66, v20, -v20
    v_accvgpr_read_b32 v67, a17
    v_fma_f32 v67, v67, v20, -v20
    v_cvt_pk_bf16_f32 v66, v66, v67
    v_cvt_pk_bf16_f32 v67, v24, v25
    v_accvgpr_read_b32 v26, a22
    v_fma_f32 v26, v26, v21, -v21
    v_accvgpr_read_b32 v27, a23
    v_fma_f32 v27, v27, v21, -v21
    v_accvgpr_read_b32 v74, a6
    v_fma_f32 v74, v74, v21, -v21
    v_accvgpr_read_b32 v75, a7
    v_fma_f32 v75, v75, v21, -v21
    v_accvgpr_read_b32 v72, a4
    v_fma_f32 v72, v72, v21, -v21
    v_accvgpr_read_b32 v73, a5
    v_fma_f32 v73, v73, v21, -v21
    v_cvt_pk_bf16_f32 v72, v72, v73
    v_cvt_pk_bf16_f32 v73, v74, v75
    v_accvgpr_read_b32 v74, a20
    v_fma_f32 v74, v74, v21, -v21
    v_accvgpr_read_b32 v75, a21
    v_fma_f32 v75, v75, v21, -v21
    v_cvt_pk_bf16_f32 v74, v74, v75
    v_cvt_pk_bf16_f32 v75, v26, v27
    v_accvgpr_read_b32 v30, a26
    v_fma_f32 v30, v30, v22, -v22
    v_accvgpr_read_b32 v31, a27
    v_fma_f32 v31, v31, v22, -v22
    v_accvgpr_read_b32 v82, a10
    v_fma_f32 v82, v82, v22, -v22
    v_accvgpr_read_b32 v83, a11
    v_fma_f32 v83, v83, v22, -v22
    v_accvgpr_read_b32 v80, a8
    v_fma_f32 v80, v80, v22, -v22
    v_accvgpr_read_b32 v81, a9
    v_fma_f32 v81, v81, v22, -v22
    v_cvt_pk_bf16_f32 v80, v80, v81
    v_cvt_pk_bf16_f32 v81, v82, v83
    v_accvgpr_read_b32 v82, a24
    v_fma_f32 v82, v82, v22, -v22
    v_accvgpr_read_b32 v83, a25
    v_fma_f32 v83, v83, v22, -v22
    v_cvt_pk_bf16_f32 v82, v82, v83
    v_cvt_pk_bf16_f32 v83, v30, v31
    v_accvgpr_read_b32 v24, a30
    v_fma_f32 v24, v24, v23, -v23
    v_accvgpr_read_b32 v25, a31
    v_fma_f32 v25, v25, v23, -v23
    v_accvgpr_read_b32 v90, a14
    v_fma_f32 v90, v90, v23, -v23
    v_accvgpr_read_b32 v91, a15
    v_fma_f32 v91, v91, v23, -v23
    v_accvgpr_read_b32 v88, a12
    v_fma_f32 v88, v88, v23, -v23
    v_accvgpr_read_b32 v89, a13
    v_fma_f32 v89, v89, v23, -v23
    v_cvt_pk_bf16_f32 v88, v88, v89
    v_cvt_pk_bf16_f32 v89, v90, v91
    v_accvgpr_read_b32 v90, a28
    v_fma_f32 v90, v90, v23, -v23
    v_accvgpr_read_b32 v91, a29
    v_fma_f32 v91, v91, v23, -v23
    v_cvt_pk_bf16_f32 v90, v90, v91
    v_cvt_pk_bf16_f32 v91, v24, v25
    v_mfma_f32_16x16x32_bf16 a[176:179], a[212:215], v[228:231], a[176:179]
    buffer_load_dwordx4 v28, s[24:27], s57 offen sc1 lds
    v_mfma_f32_16x16x32_bf16 a[160:163], a[208:211], v[228:231], a[160:163]
    s_waitcnt lgkmcnt(4)
    v_accvgpr_read_b32 v96, a32
    v_accvgpr_read_b32 v97, a33
    v_mfma_f32_16x16x32_bf16 a[224:227], a[192:195], v[64:67], 0.5
    s_add_u32 s38, s34, 40960
    ds_read_b64_tr_b16 a[208:209], v8 offset:1024
    v_accvgpr_read_b32 v98, a34
    v_mfma_f32_16x16x32_bf16 a[240:243], a[196:199], v[64:67], 0.5
    s_add_u32 s57, s35, 40960
    ds_read_b64_tr_b16 a[210:211], v8 offset:7168
    v_accvgpr_read_b32 v99, a35
    v_mfma_f32_16x16x32_bf16 a[244:247], a[196:199], v[72:75], 0.5
    buffer_store_dwordx4 v[64:67], v28, s[20:23], s55 offen offset:0 sc1
    v_mfma_f32_16x16x32_bf16 a[228:231], a[192:195], v[72:75], 0.5
    s_cmp_lt_u32 s3, 2
    s_cselect_b32 s38, s38, s57
    v_fma_f32 v96, v96, v20, -v20
    v_mfma_f32_16x16x32_bf16 a[232:235], a[192:195], v[80:83], 0.5
    s_add_u32 s76, s38, s63
    ds_read_b64_tr_b16 a[212:213], v9 offset:1024
    v_fma_f32 v97, v97, v20, -v20
    v_mfma_f32_16x16x32_bf16 a[248:251], a[196:199], v[80:83], 0.5
    s_add_u32 m0, s49, 98304
    ds_read_b64_tr_b16 a[214:215], v9 offset:7168
    v_fma_f32 v98, v98, v20, -v20
    v_mfma_f32_16x16x32_bf16 a[252:255], a[196:199], v[88:91], 0.5
    buffer_store_dwordx4 v[72:75], v28, s[20:23], s55 offen offset:1024 sc1
    v_mfma_f32_16x16x32_bf16 a[236:239], a[192:195], v[88:91], 0.5
    s_waitcnt lgkmcnt(4)
    v_fma_f32 v99, v99, v20, -v20
    v_cvt_pk_bf16_f32 v96, v96, v97
    buffer_store_dwordx4 v[80:83], v28, s[20:23], s55 offen offset:2048 sc1
    buffer_store_dwordx4 v[88:91], v28, s[20:23], s55 offen offset:3072 sc1
    v_accvgpr_read_b32 v26, a50
    v_fma_f32 v26, v26, v20, -v20
    v_accvgpr_read_b32 v27, a51
    v_fma_f32 v27, v27, v20, -v20
    v_cvt_pk_bf16_f32 v97, v98, v99
    v_accvgpr_read_b32 v98, a48
    v_fma_f32 v98, v98, v20, -v20
    v_accvgpr_read_b32 v99, a49
    v_fma_f32 v99, v99, v20, -v20
    v_cvt_pk_bf16_f32 v98, v98, v99
    v_cvt_pk_bf16_f32 v99, v26, v27
    v_mfma_f32_16x16x32_bf16 v[92:95], a[200:203], v[88:91], 0.5
    s_add_u32 s55, s55, 4096
    ds_read_b64_tr_b16 a[192:193], v10 offset:1024
    v_accvgpr_read_b32 v104, a36
    v_mfma_f32_16x16x32_bf16 v[124:127], a[204:207], v[88:91], 0.5
    s_or_b32 s11, s11, s72
    ds_read_b64_tr_b16 a[194:195], v10 offset:7168
    v_accvgpr_read_b32 v105, a37
    v_mfma_f32_16x16x32_bf16 v[116:119], a[204:207], v[80:83], 0.5
    s_lshr_b32 s73, s93, 8
    v_accvgpr_read_b32 v106, a38
    v_accvgpr_read_b32 v107, a39
    v_mfma_f32_16x16x32_bf16 v[84:87], a[200:203], v[80:83], 0.5
    s_add_u32 s8, s51, 1
    v_fma_f32 v104, v104, v21, -v21
    v_fma_f32 v105, v105, v21, -v21
    v_mfma_f32_16x16x32_bf16 v[76:79], a[200:203], v[72:75], 0.5
    s_and_b32 s8, s8, 3
    ds_read_b64_tr_b16 a[196:197], v11 offset:1024
    v_fma_f32 v106, v106, v21, -v21
    v_mfma_f32_16x16x32_bf16 v[108:111], a[204:207], v[72:75], 0.5
    s_lshr_b32 s72, s73, s8
    ds_read_b64_tr_b16 a[198:199], v11 offset:7168
    v_fma_f32 v107, v107, v21, -v21
    v_mfma_f32_16x16x32_bf16 v[100:103], a[204:207], v[64:67], 0.5
    s_and_b32 s72, s72, 0x2000
    v_cvt_pk_bf16_f32 v104, v104, v105
    v_cvt_pk_bf16_f32 v105, v106, v107
    v_mfma_f32_16x16x32_bf16 v[68:71], a[200:203], v[64:67], 0.5
    s_waitcnt lgkmcnt(4)
    v_accvgpr_read_b32 v106, a52
    v_accvgpr_read_b32 v107, a53
    v_mfma_f32_16x16x32_bf16 v[132:135], a[208:211], v[64:67], 0.5
    s_mul_i32 s8, s8, 0x202000
    ds_read_b64_tr_b16 a[200:201], v18 offset:2048
    v_accvgpr_read_b32 v30, a54
    v_mfma_f32_16x16x32_bf16 v[164:167], a[212:215], v[64:67], 0.5
    s_xor_b32 s8, s8, s72
    ds_read_b64_tr_b16 a[202:203], v18 offset:8192
    v_accvgpr_read_b32 v31, a55
    v_fma_f32 v30, v30, v21, -v21
    v_fma_f32 v31, v31, v21, -v21
    v_fma_f32 v106, v106, v21, -v21
    v_fma_f32 v107, v107, v21, -v21
    v_cvt_pk_bf16_f32 v106, v106, v107
    v_cvt_pk_bf16_f32 v107, v30, v31
    v_mfma_f32_16x16x32_bf16 v[172:175], a[212:215], v[72:75], 0.5
    buffer_load_dwordx4 v4, s[12:15], s38 offen offset:0 lds
    v_mfma_f32_16x16x32_bf16 v[140:143], a[208:211], v[72:75], 0.5
    s_add_u32 m0, s49, 99200
    v_accvgpr_read_b32 v112, a40
    v_accvgpr_read_b32 v113, a41
    v_mfma_f32_16x16x32_bf16 v[148:151], a[208:211], v[80:83], 0.5
    s_and_b32 s8, s8, 6299648
    ds_read_b64_tr_b16 a[204:205], v19 offset:2048
    v_accvgpr_read_b32 v114, a42
    v_mfma_f32_16x16x32_bf16 v[180:183], a[212:215], v[80:83], 0.5
    s_xor_b32 s8, s8, s11
    ds_read_b64_tr_b16 a[206:207], v19 offset:8192
    v_accvgpr_read_b32 v115, a43
    v_mfma_f32_16x16x32_bf16 v[188:191], a[212:215], v[88:91], 0.5
    buffer_load_dwordx4 v4, s[12:15], s38 offen offset:128 lds
    v_mfma_f32_16x16x32_bf16 v[156:159], a[208:211], v[88:91], 0.5
    s_waitcnt lgkmcnt(4)
    v_fma_f32 v112, v112, v22, -v22
    v_fma_f32 v113, v113, v22, -v22
    v_mfma_f32_16x16x32_bf16 v[220:223], a[192:195], v[88:91], 0.5
    s_add_u32 m0, s49, 100096
    ds_read_b64_tr_b16 a[208:209], v8 offset:12288
    v_fma_f32 v114, v114, v22, -v22
    v_mfma_f32_16x16x32_bf16 v[252:255], a[196:199], v[88:91], 0.5
    s_add_u32 s9, s51, 2
    ds_read_b64_tr_b16 a[210:211], v8 offset:18432
    v_fma_f32 v115, v115, v22, -v22
    v_mfma_f32_16x16x32_bf16 v[244:247], a[196:199], v[80:83], 0.5
    s_and_b32 s9, s9, 3
    v_cvt_pk_bf16_f32 v112, v112, v113
    v_cvt_pk_bf16_f32 v113, v114, v115
    v_mfma_f32_16x16x32_bf16 v[212:215], a[192:195], v[80:83], 0.5
    buffer_store_dwordx4 v[96:99], v28, s[20:23], s55 offen offset:0 sc1
    v_accvgpr_read_b32 v24, a58
    v_fma_f32 v24, v24, v22, -v22
    v_accvgpr_read_b32 v25, a59
    v_fma_f32 v25, v25, v22, -v22
    v_accvgpr_read_b32 v114, a56
    v_fma_f32 v114, v114, v22, -v22
    v_accvgpr_read_b32 v115, a57
    v_fma_f32 v115, v115, v22, -v22
    v_cvt_pk_bf16_f32 v114, v114, v115
    v_cvt_pk_bf16_f32 v115, v24, v25
    v_mfma_f32_16x16x32_bf16 v[204:207], a[192:195], v[72:75], 0.5
    s_lshr_b32 s72, s73, s9
    ds_read_b64_tr_b16 a[212:213], v9 offset:12288
    v_accvgpr_read_b32 v120, a44
    v_mfma_f32_16x16x32_bf16 v[236:239], a[196:199], v[72:75], 0.5
    s_and_b32 s72, s72, 0x2000
    ds_read_b64_tr_b16 a[214:215], v9 offset:18432
    v_accvgpr_read_b32 v121, a45
    v_mfma_f32_16x16x32_bf16 v[228:231], a[196:199], v[64:67], 0.5
    s_mul_i32 s9, s9, 0x202000
    v_accvgpr_read_b32 v122, a46
    v_accvgpr_read_b32 v123, a47
    v_mfma_f32_16x16x32_bf16 v[196:199], a[192:195], v[64:67], 0.5
    s_waitcnt lgkmcnt(4)
    buffer_load_dwordx4 v4, s[12:15], s76 offen offset:256 lds
    v_mfma_f32_16x16x32_bf16 v[32:35], a[200:203], v[64:67], 0.5
    s_add_u32 m0, s49, 101376
    ds_read_b64_tr_b16 a[192:193], v10 offset:12288
    v_fma_f32 v120, v120, v23, -v23
    v_mfma_f32_16x16x32_bf16 v[48:51], a[204:207], v[64:67], 0.5
    s_xor_b32 s9, s9, s72
    ds_read_b64_tr_b16 a[194:195], v10 offset:18432
    v_fma_f32 v121, v121, v23, -v23
    v_mfma_f32_16x16x32_bf16 v[52:55], a[204:207], v[72:75], 0.5
    s_and_b32 s9, s9, 6299648
    v_fma_f32 v122, v122, v23, -v23
    v_fma_f32 v123, v123, v23, -v23
    v_mfma_f32_16x16x32_bf16 v[36:39], a[200:203], v[72:75], 0.5
    buffer_load_dwordx4 v5, s[12:15], s38 offen offset:0 lds
    v_mfma_f32_16x16x32_bf16 v[40:43], a[200:203], v[80:83], 0.5
    s_add_u32 m0, s49, 102272
    ds_read_b64_tr_b16 a[196:197], v11 offset:12288
    v_cvt_pk_bf16_f32 v120, v120, v121
    v_mfma_f32_16x16x32_bf16 v[56:59], a[204:207], v[80:83], 0.5
    s_xor_b32 s9, s9, s11
    ds_read_b64_tr_b16 a[198:199], v11 offset:18432
    v_cvt_pk_bf16_f32 v121, v122, v123
    v_accvgpr_read_b32 v26, a62
    v_fma_f32 v26, v26, v23, -v23
    v_accvgpr_read_b32 v27, a63
    v_fma_f32 v27, v27, v23, -v23
    v_accvgpr_read_b32 v122, a60
    v_fma_f32 v122, v122, v23, -v23
    v_accvgpr_read_b32 v123, a61
    v_fma_f32 v123, v123, v23, -v23
    v_cvt_pk_bf16_f32 v122, v122, v123
    v_cvt_pk_bf16_f32 v123, v26, v27
    v_mfma_f32_16x16x32_bf16 v[60:63], a[204:207], v[88:91], 0.5
    s_add_u32 s10, s51, 3
    v_accvgpr_read_b32 v128, a64
    v_accvgpr_read_b32 v129, a65
    v_mfma_f32_16x16x32_bf16 v[44:47], a[200:203], v[88:91], 0.5
    s_waitcnt lgkmcnt(4)
    buffer_load_dwordx4 v5, s[12:15], s38 offen offset:128 lds
    v_mfma_f32_16x16x32_bf16 a[236:239], a[208:211], v[120:123], a[236:239]
    s_add_u32 m0, s49, 103168
    ds_read_b64_tr_b16 a[200:201], v8 offset:13312
    v_accvgpr_read_b32 v130, a66
    v_mfma_f32_16x16x32_bf16 a[252:255], a[212:215], v[120:123], a[252:255]
    s_and_b32 s10, s10, 3
    ds_read_b64_tr_b16 a[202:203], v8 offset:19456
    v_accvgpr_read_b32 v131, a67
    v_mfma_f32_16x16x32_bf16 a[248:251], a[212:215], v[112:115], a[248:251]
    s_lshr_b32 s72, s73, s10
    v_fma_f32 v128, v128, v20, -v20
    v_fma_f32 v129, v129, v20, -v20
    v_mfma_f32_16x16x32_bf16 a[232:235], a[208:211], v[112:115], a[232:235]
    s_and_b32 s72, s72, 0x2000
    v_fma_f32 v130, v130, v20, -v20
    v_fma_f32 v131, v131, v20, -v20
    v_mfma_f32_16x16x32_bf16 a[228:231], a[208:211], v[104:107], a[228:231]
    s_mul_i32 s10, s10, 0x202000
    ds_read_b64_tr_b16 a[204:205], v9 offset:13312
    v_cvt_pk_bf16_f32 v128, v128, v129
    v_mfma_f32_16x16x32_bf16 a[244:247], a[212:215], v[104:107], a[244:247]
    s_xor_b32 s10, s10, s72
    ds_read_b64_tr_b16 a[206:207], v9 offset:19456
    v_cvt_pk_bf16_f32 v129, v130, v131
    v_mfma_f32_16x16x32_bf16 a[240:243], a[212:215], v[96:99], a[240:243]
    buffer_store_dwordx4 v[104:107], v28, s[20:23], s55 offen offset:1024 sc1
    v_mfma_f32_16x16x32_bf16 a[224:227], a[208:211], v[96:99], a[224:227]
    s_waitcnt lgkmcnt(4)
    v_accvgpr_read_b32 v130, a80
    v_accvgpr_read_b32 v131, a81
    v_accvgpr_read_b32 v30, a82
    v_fma_f32 v30, v30, v20, -v20
    v_accvgpr_read_b32 v31, a83
    v_fma_f32 v31, v31, v20, -v20
    v_fma_f32 v130, v130, v20, -v20
    v_fma_f32 v131, v131, v20, -v20
    v_cvt_pk_bf16_f32 v130, v130, v131
    v_cvt_pk_bf16_f32 v131, v30, v31
    v_mfma_f32_16x16x32_bf16 v[68:71], a[192:195], v[96:99], v[68:71]
    s_and_b32 s10, s10, 6299648
    ds_read_b64_tr_b16 a[208:209], v10 offset:13312
    v_add_u32 v8, 0, v12
    v_mfma_f32_16x16x32_bf16 v[100:103], a[196:199], v[96:99], v[100:103]
    s_xor_b32 s10, s10, s11
    ds_read_b64_tr_b16 a[210:211], v10 offset:19456
    v_accvgpr_read_b32 v136, a68
    v_mfma_f32_16x16x32_bf16 v[108:111], a[196:199], v[104:107], v[108:111]
    buffer_load_dwordx4 v5, s[12:15], s76 offen offset:256 lds
    v_mfma_f32_16x16x32_bf16 v[76:79], a[192:195], v[104:107], v[76:79]
    s_lshl_b32 s72, 1, s51
    v_mov_b32 v16, s72
    v_accvgpr_read_b32 v17, a223
    v_mfma_f32_16x16x32_bf16 v[84:87], a[192:195], v[112:115], v[84:87]
    s_mov_b32 s72, 0
    ds_read_b64_tr_b16 a[212:213], v11 offset:13312
    v_accvgpr_read_b32 v137, a69
    v_mfma_f32_16x16x32_bf16 v[116:119], a[196:199], v[112:115], v[116:119]
    ds_read_b64_tr_b16 a[214:215], v11 offset:19456
    v_accvgpr_read_b32 v138, a70
    v_mfma_f32_16x16x32_bf16 v[124:127], a[196:199], v[120:123], v[124:127]
    v_accvgpr_read_b32 v139, a71
    v_fma_f32 v136, v136, v21, -v21
    v_mfma_f32_16x16x32_bf16 v[92:95], a[192:195], v[120:123], v[92:95]
    s_waitcnt lgkmcnt(4)
    v_fma_f32 v137, v137, v21, -v21
    v_fma_f32 v138, v138, v21, -v21
    v_mfma_f32_16x16x32_bf16 v[156:159], a[200:203], v[120:123], v[156:159]
pg_8:
    s_cbranch_execz pg_12
    ds_read_b64_tr_b16 a[192:193], v18 offset:14336
    v_fma_f32 v139, v139, v21, -v21
    v_mfma_f32_16x16x32_bf16 v[188:191], a[204:207], v[120:123], v[188:191]
    ds_read_b64_tr_b16 a[194:195], v18 offset:20480
    v_cvt_pk_bf16_f32 v136, v136, v137
    v_accvgpr_read_b32 v24, a86
    v_fma_f32 v24, v24, v21, -v21
    v_accvgpr_read_b32 v25, a87
    v_fma_f32 v25, v25, v21, -v21
    v_cvt_pk_bf16_f32 v137, v138, v139
    v_accvgpr_read_b32 v138, a84
    v_fma_f32 v138, v138, v21, -v21
    v_accvgpr_read_b32 v139, a85
    v_fma_f32 v139, v139, v21, -v21
    v_cvt_pk_bf16_f32 v138, v138, v139
    v_cvt_pk_bf16_f32 v139, v24, v25
    v_mfma_f32_16x16x32_bf16 v[180:183], a[204:207], v[112:115], v[180:183]
    s_add_u32 s38, s33, 81920
    v_add_u32 v9, 0, v13
    v_add_u32 v10, 0, v14
    v_mfma_f32_16x16x32_bf16 v[148:151], a[200:203], v[112:115], v[148:151]
    s_add_u32 s57, s34, 81920
    v_accvgpr_read_b32 v144, a72
    v_accvgpr_read_b32 v145, a73
    v_mfma_f32_16x16x32_bf16 v[140:143], a[200:203], v[104:107], v[140:143]
    s_cmp_lt_u32 s3, 2
    s_cselect_b32 s38, s38, s57
    ds_read_b64_tr_b16 a[196:197], v19 offset:14336
    v_mfma_f32_16x16x32_bf16 v[172:175], a[204:207], v[104:107], v[172:175]
    s_waitcnt vmcnt(35)
    ds_read_b64_tr_b16 a[198:199], v19 offset:20480
    v_accvgpr_read_b32 v146, a74
    v_mfma_f32_16x16x32_bf16 v[164:167], a[204:207], v[96:99], v[164:167]
    s_barrier
    v_mfma_f32_16x16x32_bf16 v[132:135], a[200:203], v[96:99], v[132:135]
    s_waitcnt lgkmcnt(4)
    v_accvgpr_read_b32 v147, a75
    v_fma_f32 v144, v144, v22, -v22
    v_mfma_f32_16x16x32_bf16 v[196:199], a[208:211], v[96:99], v[196:199]
    s_add_u32 s76, s38, s63
    ds_read_b64_tr_b16 a[200:201], v8 offset:0
    v_fma_f32 v145, v145, v22, -v22
    v_mfma_f32_16x16x32_bf16 v[228:231], a[212:215], v[96:99], v[228:231]
    s_add_u32 m0, s49, 49152
    ds_read_b64_tr_b16 a[202:203], v8 offset:6144
    v_fma_f32 v146, v146, v22, -v22
    v_mfma_f32_16x16x32_bf16 v[236:239], a[212:215], v[104:107], v[236:239]
    buffer_store_dwordx4 v[112:115], v28, s[20:23], s55 offen offset:2048 sc1
    v_mfma_f32_16x16x32_bf16 v[204:207], a[208:211], v[104:107], v[204:207]
    s_waitcnt vmcnt(9)
    v_fma_f32 v147, v147, v22, -v22
    v_cvt_pk_bf16_f32 v144, v144, v145
    v_accvgpr_read_b32 v26, a90
    v_fma_f32 v26, v26, v22, -v22
    v_accvgpr_read_b32 v27, a91
    v_fma_f32 v27, v27, v22, -v22
    v_cvt_pk_bf16_f32 v145, v146, v147
    v_accvgpr_read_b32 v146, a88
    v_fma_f32 v146, v146, v22, -v22
    v_accvgpr_read_b32 v147, a89
    v_fma_f32 v147, v147, v22, -v22
    v_cvt_pk_bf16_f32 v146, v146, v147
    v_cvt_pk_bf16_f32 v147, v26, v27
    v_mfma_f32_16x16x32_bf16 v[212:215], a[208:211], v[112:115], v[212:215]
    ds_read_b64_tr_b16 a[204:205], v9 offset:0
    v_add_u32 v11, 0, v15
    v_mfma_f32_16x16x32_bf16 v[244:247], a[212:215], v[112:115], v[244:247]
    ds_read_b64_tr_b16 a[206:207], v9 offset:6144
    v_xor_b32 v18, s39, v8
    v_mfma_f32_16x16x32_bf16 v[252:255], a[212:215], v[120:123], v[252:255]
    buffer_atomic_or v16, v17, s[24:27], 0 offen
    v_mfma_f32_16x16x32_bf16 v[220:223], a[208:211], v[120:123], v[220:223]
    s_waitcnt lgkmcnt(4)
    buffer_load_dwordx4 v4, s[12:15], s38 offen offset:0 lds
    v_mfma_f32_16x16x32_bf16 v[44:47], a[192:195], v[120:123], v[44:47]
    s_add_u32 m0, s49, 50048
    ds_read_b64_tr_b16 a[208:209], v10 offset:0
    v_xor_b32 v19, s39, v9
    v_mfma_f32_16x16x32_bf16 v[60:63], a[196:199], v[120:123], v[60:63]
    ds_read_b64_tr_b16 a[210:211], v10 offset:6144
    v_accvgpr_read_b32 v152, a76
    v_mfma_f32_16x16x32_bf16 v[56:59], a[196:199], v[112:115], v[56:59]
    buffer_load_dwordx4 v4, s[12:15], s38 offen offset:128 lds
    v_mfma_f32_16x16x32_bf16 v[40:43], a[192:195], v[112:115], v[40:43]
    s_add_u32 m0, s49, 50944
    v_accvgpr_read_b32 v153, a77
    v_accvgpr_read_b32 v154, a78
    v_mfma_f32_16x16x32_bf16 v[36:39], a[192:195], v[104:107], v[36:39]
    ds_read_b64_tr_b16 a[212:213], v11 offset:0
    v_accvgpr_read_b32 v155, a79
    v_mfma_f32_16x16x32_bf16 v[52:55], a[196:199], v[104:107], v[52:55]
    ds_read_b64_tr_b16 a[214:215], v11 offset:6144
    v_fma_f32 v152, v152, v23, -v23
    v_accvgpr_read_b32 v30, a94
    v_fma_f32 v30, v30, v23, -v23
    v_accvgpr_read_b32 v31, a95
    v_fma_f32 v31, v31, v23, -v23
    v_fma_f32 v154, v154, v23, -v23
    v_fma_f32 v155, v155, v23, -v23
    v_fma_f32 v153, v153, v23, -v23
    v_cvt_pk_bf16_f32 v152, v152, v153
    v_cvt_pk_bf16_f32 v153, v154, v155
    v_accvgpr_read_b32 v154, a92
    v_fma_f32 v154, v154, v23, -v23
    v_accvgpr_read_b32 v155, a93
    v_fma_f32 v155, v155, v23, -v23
    v_cvt_pk_bf16_f32 v154, v154, v155
    v_cvt_pk_bf16_f32 v155, v30, v31
    v_mfma_f32_16x16x32_bf16 v[48:51], a[196:199], v[96:99], v[48:51]
    buffer_load_dwordx4 v4, s[12:15], s76 offen offset:256 lds
    v_mfma_f32_16x16x32_bf16 v[32:35], a[192:195], v[96:99], v[32:35]
    s_waitcnt lgkmcnt(4)
    v_accvgpr_read_b32 v160, a96
    v_accvgpr_read_b32 v161, a97
    v_mfma_f32_16x16x32_bf16 a[224:227], a[200:203], v[128:131], a[224:227]
    s_add_u32 m0, s49, 52224
    ds_read_b64_tr_b16 a[192:193], v8 offset:1024
    v_accvgpr_read_b32 v162, a98
    v_mfma_f32_16x16x32_bf16 a[240:243], a[204:207], v[128:131], a[240:243]
    ds_read_b64_tr_b16 a[194:195], v8 offset:7168
    v_accvgpr_read_b32 v163, a99
    v_mfma_f32_16x16x32_bf16 a[244:247], a[204:207], v[136:139], a[244:247]
    buffer_load_dwordx4 v5, s[12:15], s38 offen offset:0 lds
    v_mfma_f32_16x16x32_bf16 a[228:231], a[200:203], v[136:139], a[228:231]
    s_add_u32 m0, s49, 53120
    v_fma_f32 v160, v160, v20, -v20
    v_fma_f32 v161, v161, v20, -v20
    v_mfma_f32_16x16x32_bf16 a[232:235], a[200:203], v[144:147], a[232:235]
    ds_read_b64_tr_b16 a[196:197], v9 offset:1024
    v_fma_f32 v162, v162, v20, -v20
    v_mfma_f32_16x16x32_bf16 a[248:251], a[204:207], v[144:147], a[248:251]
    ds_read_b64_tr_b16 a[198:199], v9 offset:7168
    v_fma_f32 v163, v163, v20, -v20
    v_mfma_f32_16x16x32_bf16 a[252:255], a[204:207], v[152:155], a[252:255]
    v_cvt_pk_bf16_f32 v160, v160, v161
    v_cvt_pk_bf16_f32 v161, v162, v163
    v_mfma_f32_16x16x32_bf16 a[236:239], a[200:203], v[152:155], a[236:239]
    s_waitcnt lgkmcnt(4)
    buffer_load_dwordx4 v5, s[12:15], s38 offen offset:128 lds
    v_accvgpr_read_b32 v24, a114
    v_fma_f32 v24, v24, v20, -v20
    v_accvgpr_read_b32 v25, a115
    v_fma_f32 v25, v25, v20, -v20
    v_accvgpr_read_b32 v162, a112
    v_fma_f32 v162, v162, v20, -v20
    v_accvgpr_read_b32 v163, a113
    v_fma_f32 v163, v163, v20, -v20
    v_cvt_pk_bf16_f32 v162, v162, v163
    v_cvt_pk_bf16_f32 v163, v24, v25
    v_mfma_f32_16x16x32_bf16 v[92:95], a[208:211], v[152:155], v[92:95]
    s_add_u32 m0, s49, 54016
    ds_read_b64_tr_b16 a[200:201], v10 offset:1024
    v_accvgpr_read_b32 v168, a100
    v_mfma_f32_16x16x32_bf16 v[124:127], a[212:215], v[152:155], v[124:127]
    ds_read_b64_tr_b16 a[202:203], v10 offset:7168
    v_accvgpr_read_b32 v169, a101
    v_mfma_f32_16x16x32_bf16 v[116:119], a[212:215], v[144:147], v[116:119]
    v_accvgpr_read_b32 v170, a102
    v_accvgpr_read_b32 v171, a103
    v_mfma_f32_16x16x32_bf16 v[84:87], a[208:211], v[144:147], v[84:87]
    buffer_store_dwordx4 v[120:123], v28, s[20:23], s55 offen offset:3072 sc1
    v_mfma_f32_16x16x32_bf16 v[76:79], a[208:211], v[136:139], v[76:79]
    s_add_u32 s55, s55, 12288
    ds_read_b64_tr_b16 a[204:205], v11 offset:1024
    v_fma_f32 v168, v168, v21, -v21
    v_mfma_f32_16x16x32_bf16 v[108:111], a[212:215], v[136:139], v[108:111]
    ds_read_b64_tr_b16 a[206:207], v11 offset:7168
    v_fma_f32 v169, v169, v21, -v21
    v_mfma_f32_16x16x32_bf16 v[100:103], a[212:215], v[128:131], v[100:103]
    v_fma_f32 v170, v170, v21, -v21
    v_fma_f32 v171, v171, v21, -v21
    v_mfma_f32_16x16x32_bf16 v[68:71], a[208:211], v[128:131], v[68:71]
    s_waitcnt lgkmcnt(4)
    buffer_load_dwordx4 v5, s[12:15], s76 offen offset:256 lds
    v_mfma_f32_16x16x32_bf16 v[132:135], a[192:195], v[128:131], v[132:135]
    ds_read_b64_tr_b16 a[208:209], v18 offset:2048
    v_cvt_pk_bf16_f32 v168, v168, v169
    v_mfma_f32_16x16x32_bf16 v[164:167], a[196:199], v[128:131], v[164:167]
    ds_read_b64_tr_b16 a[210:211], v18 offset:8192
    v_cvt_pk_bf16_f32 v169, v170, v171
    v_accvgpr_read_b32 v26, a118
    v_fma_f32 v26, v26, v21, -v21
    v_accvgpr_read_b32 v27, a119
    v_fma_f32 v27, v27, v21, -v21
    v_accvgpr_read_b32 v170, a116
    v_fma_f32 v170, v170, v21, -v21
    v_accvgpr_read_b32 v171, a117
    v_fma_f32 v171, v171, v21, -v21
    v_cvt_pk_bf16_f32 v170, v170, v171
    v_cvt_pk_bf16_f32 v171, v26, v27
    v_mfma_f32_16x16x32_bf16 v[172:175], a[196:199], v[136:139], v[172:175]
    v_accvgpr_read_b32 v176, a104
    v_accvgpr_read_b32 v177, a105
    v_mfma_f32_16x16x32_bf16 v[140:143], a[192:195], v[136:139], v[140:143]
    v_accvgpr_read_b32 v178, a106
    v_accvgpr_read_b32 v179, a107
    v_mfma_f32_16x16x32_bf16 v[148:151], a[192:195], v[144:147], v[148:151]
    ds_read_b64_tr_b16 a[212:213], v19 offset:2048
    v_fma_f32 v176, v176, v22, -v22
    v_mfma_f32_16x16x32_bf16 v[180:183], a[196:199], v[144:147], v[180:183]
    ds_read_b64_tr_b16 a[214:215], v19 offset:8192
    v_fma_f32 v177, v177, v22, -v22
    v_mfma_f32_16x16x32_bf16 v[188:191], a[196:199], v[152:155], v[188:191]
    buffer_store_dwordx4 v[128:131], v28, s[20:23], s55 offen offset:0 sc1
    v_mfma_f32_16x16x32_bf16 v[156:159], a[192:195], v[152:155], v[156:159]
    s_waitcnt lgkmcnt(4)
    v_fma_f32 v178, v178, v22, -v22
    v_fma_f32 v179, v179, v22, -v22
    v_mfma_f32_16x16x32_bf16 v[220:223], a[200:203], v[152:155], v[220:223]
    ds_read_b64_tr_b16 a[192:193], v8 offset:12288
    v_cvt_pk_bf16_f32 v176, v176, v177
    v_mfma_f32_16x16x32_bf16 v[252:255], a[204:207], v[152:155], v[252:255]
    ds_read_b64_tr_b16 a[194:195], v8 offset:18432
    v_cvt_pk_bf16_f32 v177, v178, v179
    v_mfma_f32_16x16x32_bf16 v[244:247], a[204:207], v[144:147], v[244:247]
    v_accvgpr_read_b32 v178, a120
    v_accvgpr_read_b32 v179, a121
    v_mfma_f32_16x16x32_bf16 v[212:215], a[200:203], v[144:147], v[212:215]
    v_accvgpr_read_b32 v30, a122
    v_accvgpr_read_b32 v31, a123
    v_fma_f32 v30, v30, v22, -v22
    v_fma_f32 v31, v31, v22, -v22
    v_fma_f32 v178, v178, v22, -v22
    v_fma_f32 v179, v179, v22, -v22
    v_cvt_pk_bf16_f32 v178, v178, v179
    v_cvt_pk_bf16_f32 v179, v30, v31
    v_mfma_f32_16x16x32_bf16 v[204:207], a[200:203], v[136:139], v[204:207]
    ds_read_b64_tr_b16 a[196:197], v9 offset:12288
    v_accvgpr_read_b32 v184, a108
    v_mfma_f32_16x16x32_bf16 v[236:239], a[204:207], v[136:139], v[236:239]
    ds_read_b64_tr_b16 a[198:199], v9 offset:18432
    v_accvgpr_read_b32 v185, a109
    v_mfma_f32_16x16x32_bf16 v[228:231], a[204:207], v[128:131], v[228:231]
    v_accvgpr_read_b32 v186, a110
    v_accvgpr_read_b32 v187, a111
    v_mfma_f32_16x16x32_bf16 v[196:199], a[200:203], v[128:131], v[196:199]
    s_waitcnt lgkmcnt(4)
    v_fma_f32 v184, v184, v23, -v23
    v_fma_f32 v185, v185, v23, -v23
    v_mfma_f32_16x16x32_bf16 v[32:35], a[208:211], v[128:131], v[32:35]
    ds_read_b64_tr_b16 a[200:201], v10 offset:12288
    v_fma_f32 v186, v186, v23, -v23
    v_mfma_f32_16x16x32_bf16 v[48:51], a[212:215], v[128:131], v[48:51]
    ds_read_b64_tr_b16 a[202:203], v10 offset:18432
    v_fma_f32 v187, v187, v23, -v23
    v_mfma_f32_16x16x32_bf16 v[52:55], a[212:215], v[136:139], v[52:55]
    v_cvt_pk_bf16_f32 v184, v184, v185
    v_cvt_pk_bf16_f32 v185, v186, v187
    v_mfma_f32_16x16x32_bf16 v[36:39], a[208:211], v[136:139], v[36:39]
    buffer_store_dwordx4 v[136:139], v28, s[20:23], s55 offen offset:1024 sc1
    v_mfma_f32_16x16x32_bf16 v[40:43], a[208:211], v[144:147], v[40:43]
    ds_read_b64_tr_b16 a[204:205], v11 offset:12288
    v_accvgpr_read_b32 v186, a124
    v_mfma_f32_16x16x32_bf16 v[56:59], a[212:215], v[144:147], v[56:59]
    ds_read_b64_tr_b16 a[206:207], v11 offset:18432
    v_accvgpr_read_b32 v187, a125
    v_accvgpr_read_b32 v24, a126
    v_fma_f32 v24, v24, v23, -v23
    v_accvgpr_read_b32 v25, a127
    v_fma_f32 v25, v25, v23, -v23
    v_fma_f32 v186, v186, v23, -v23
    v_fma_f32 v187, v187, v23, -v23
    v_cvt_pk_bf16_f32 v186, v186, v187
    v_cvt_pk_bf16_f32 v187, v24, v25
    v_mfma_f32_16x16x32_bf16 v[60:63], a[212:215], v[152:155], v[60:63]
    v_accvgpr_read_b32 v192, a128
    v_accvgpr_read_b32 v193, a129
    v_mfma_f32_16x16x32_bf16 v[44:47], a[208:211], v[152:155], v[44:47]
    s_waitcnt lgkmcnt(4)
    v_accvgpr_read_b32 v194, a130
    v_accvgpr_read_b32 v195, a131
    v_mfma_f32_16x16x32_bf16 a[236:239], a[192:195], v[184:187], a[236:239]
    ds_read_b64_tr_b16 a[208:209], v8 offset:13312
    v_fma_f32 v192, v192, v20, -v20
    v_mfma_f32_16x16x32_bf16 a[252:255], a[196:199], v[184:187], a[252:255]
    ds_read_b64_tr_b16 a[210:211], v8 offset:19456
    v_fma_f32 v193, v193, v20, -v20
    v_mfma_f32_16x16x32_bf16 a[248:251], a[196:199], v[176:179], a[248:251]
    v_fma_f32 v194, v194, v20, -v20
    v_fma_f32 v195, v195, v20, -v20
    v_mfma_f32_16x16x32_bf16 a[232:235], a[192:195], v[176:179], a[232:235]
    v_cvt_pk_bf16_f32 v192, v192, v193
    v_cvt_pk_bf16_f32 v193, v194, v195
    v_mfma_f32_16x16x32_bf16 a[228:231], a[192:195], v[168:171], a[228:231]
    ds_read_b64_tr_b16 a[212:213], v9 offset:13312
    v_accvgpr_read_b32 v194, a144
    v_mfma_f32_16x16x32_bf16 a[244:247], a[196:199], v[168:171], a[244:247]
    ds_read_b64_tr_b16 a[214:215], v9 offset:19456
    v_accvgpr_read_b32 v195, a145
    v_mfma_f32_16x16x32_bf16 a[240:243], a[196:199], v[160:163], a[240:243]
    v_accvgpr_read_b32 v26, a146
    v_accvgpr_read_b32 v27, a147
    v_mfma_f32_16x16x32_bf16 a[224:227], a[192:195], v[160:163], a[224:227]
    s_waitcnt lgkmcnt(4)
    v_fma_f32 v194, v194, v20, -v20
    v_fma_f32 v195, v195, v20, -v20
    v_fma_f32 v26, v26, v20, -v20
    v_fma_f32 v27, v27, v20, -v20
    v_cvt_pk_bf16_f32 v194, v194, v195
    v_cvt_pk_bf16_f32 v195, v26, v27
    v_mfma_f32_16x16x32_bf16 v[68:71], a[200:203], v[160:163], v[68:71]
    ds_read_b64_tr_b16 a[192:193], v10 offset:13312
    v_add_u32 v8, 122880, v12
    v_mfma_f32_16x16x32_bf16 v[100:103], a[204:207], v[160:163], v[100:103]
    ds_read_b64_tr_b16 a[194:195], v10 offset:19456
    v_accvgpr_read_b32 v200, a132
    v_mfma_f32_16x16x32_bf16 v[108:111], a[204:207], v[168:171], v[108:111]
    buffer_store_dwordx4 v[144:147], v28, s[20:23], s55 offen offset:2048 sc1
    v_mfma_f32_16x16x32_bf16 v[76:79], a[200:203], v[168:171], v[76:79]
    v_accvgpr_read_b32 v201, a133
    v_accvgpr_read_b32 v202, a134
    v_mfma_f32_16x16x32_bf16 v[84:87], a[200:203], v[176:179], v[84:87]
    ds_read_b64_tr_b16 a[196:197], v11 offset:13312
    v_accvgpr_read_b32 v203, a135
    v_mfma_f32_16x16x32_bf16 v[116:119], a[204:207], v[176:179], v[116:119]
    ds_read_b64_tr_b16 a[198:199], v11 offset:19456
    v_fma_f32 v200, v200, v21, -v21
    v_mfma_f32_16x16x32_bf16 v[124:127], a[204:207], v[184:187], v[124:127]
    v_fma_f32 v201, v201, v21, -v21
    v_fma_f32 v202, v202, v21, -v21
    v_mfma_f32_16x16x32_bf16 v[92:95], a[200:203], v[184:187], v[92:95]
    s_waitcnt lgkmcnt(4)
    v_fma_f32 v203, v203, v21, -v21
    v_cvt_pk_bf16_f32 v200, v200, v201
    v_mfma_f32_16x16x32_bf16 v[156:159], a[208:211], v[184:187], v[156:159]
    ds_read_b64_tr_b16 a[200:201], v18 offset:14336
    v_cvt_pk_bf16_f32 v201, v202, v203
    v_mfma_f32_16x16x32_bf16 v[188:191], a[212:215], v[184:187], v[188:191]
    ds_read_b64_tr_b16 a[202:203], v18 offset:20480
    v_accvgpr_read_b32 v202, a148
    v_accvgpr_read_b32 v30, a150
    v_fma_f32 v30, v30, v21, -v21
    v_accvgpr_read_b32 v31, a151
    v_fma_f32 v31, v31, v21, -v21
    v_fma_f32 v202, v202, v21, -v21
    v_accvgpr_read_b32 v203, a149
    v_fma_f32 v203, v203, v21, -v21
    v_cvt_pk_bf16_f32 v202, v202, v203
    v_cvt_pk_bf16_f32 v203, v30, v31
    v_mfma_f32_16x16x32_bf16 v[180:183], a[212:215], v[176:179], v[180:183]
    s_add_u32 s38, s35, 81920
    v_add_u32 v9, 122880, v13
    v_add_u32 v10, 122880, v14
    v_mfma_f32_16x16x32_bf16 v[148:151], a[208:211], v[176:179], v[148:151]
    s_add_u32 s57, s33, 122880
    v_accvgpr_read_b32 v208, a136
    v_accvgpr_read_b32 v209, a137
    v_mfma_f32_16x16x32_bf16 v[140:143], a[208:211], v[168:171], v[140:143]
    s_cmp_lt_u32 s3, 2
    s_cselect_b32 s38, s38, s57
    ds_read_b64_tr_b16 a[204:205], v19 offset:14336
    v_mfma_f32_16x16x32_bf16 v[172:175], a[212:215], v[168:171], v[172:175]
    s_waitcnt vmcnt(24)
    ds_read_b64_tr_b16 a[206:207], v19 offset:20480
    v_lshlrev_b32 v16, 4, v16
    v_mfma_f32_16x16x32_bf16 v[164:167], a[212:215], v[160:163], v[164:167]
    s_barrier
    v_mfma_f32_16x16x32_bf16 v[132:135], a[208:211], v[160:163], v[132:135]
    s_waitcnt lgkmcnt(4)
    v_accvgpr_read_b32 v210, a138
    v_accvgpr_read_b32 v211, a139
    v_mfma_f32_16x16x32_bf16 v[196:199], a[192:195], v[160:163], v[196:199]
    s_add_u32 s76, s38, s63
    ds_read_b64_tr_b16 a[208:209], v8 offset:0
    v_fma_f32 v208, v208, v22, -v22
    v_mfma_f32_16x16x32_bf16 v[228:231], a[196:199], v[160:163], v[228:231]
    s_add_u32 m0, s49, 0
    ds_read_b64_tr_b16 a[210:211], v8 offset:6144
    v_fma_f32 v209, v209, v22, -v22
    v_mfma_f32_16x16x32_bf16 v[236:239], a[196:199], v[168:171], v[236:239]
    buffer_store_dwordx4 v[152:155], v28, s[20:23], s55 offen offset:3072 sc1
    v_mfma_f32_16x16x32_bf16 v[204:207], a[192:195], v[168:171], v[204:207]
    s_add_u32 s55, s55, 4096
    v_fma_f32 v210, v210, v22, -v22
    v_fma_f32 v211, v211, v22, -v22
    v_accvgpr_read_b32 v24, a154
    v_fma_f32 v24, v24, v22, -v22
    v_accvgpr_read_b32 v25, a155
    v_fma_f32 v25, v25, v22, -v22
    v_cvt_pk_bf16_f32 v208, v208, v209
    v_cvt_pk_bf16_f32 v209, v210, v211
    v_accvgpr_read_b32 v210, a152
    v_fma_f32 v210, v210, v22, -v22
    v_accvgpr_read_b32 v211, a153
    v_fma_f32 v211, v211, v22, -v22
    v_cvt_pk_bf16_f32 v210, v210, v211
    v_cvt_pk_bf16_f32 v211, v24, v25
    v_mfma_f32_16x16x32_bf16 v[212:215], a[192:195], v[176:179], v[212:215]
    s_load_dword s72, s[86:87], s5 offset:4 glc
    ds_read_b64_tr_b16 a[212:213], v9 offset:0
    v_add_u32 v11, 122880, v15
    v_mfma_f32_16x16x32_bf16 v[244:247], a[196:199], v[176:179], v[244:247]
    s_waitcnt vmcnt(5)
    ds_read_b64_tr_b16 a[214:215], v9 offset:6144
    v_xor_b32 v18, s39, v8
    v_mfma_f32_16x16x32_bf16 v[252:255], a[196:199], v[184:187], v[252:255]
    buffer_atomic_or v16, v17, s[24:27], 0 offen
    v_mfma_f32_16x16x32_bf16 v[220:223], a[192:195], v[184:187], v[220:223]
    s_waitcnt lgkmcnt(4)
    buffer_load_dwordx4 v4, s[12:15], s38 offen offset:0 lds
    v_mfma_f32_16x16x32_bf16 v[44:47], a[200:203], v[184:187], v[44:47]
    s_add_u32 m0, s49, 896
    ds_read_b64_tr_b16 a[192:193], v10 offset:0
    v_xor_b32 v19, s39, v9
    v_mfma_f32_16x16x32_bf16 v[60:63], a[204:207], v[184:187], v[60:63]
    ds_read_b64_tr_b16 a[194:195], v10 offset:6144
    v_accvgpr_read_b32 v216, a140
    v_mfma_f32_16x16x32_bf16 v[56:59], a[204:207], v[176:179], v[56:59]
    buffer_load_dwordx4 v4, s[12:15], s38 offen offset:128 lds
    v_mfma_f32_16x16x32_bf16 v[40:43], a[200:203], v[176:179], v[40:43]
    s_add_u32 m0, s49, 1792
    v_accvgpr_read_b32 v217, a141
    v_accvgpr_read_b32 v218, a142
    v_mfma_f32_16x16x32_bf16 v[36:39], a[200:203], v[168:171], v[36:39]
    s_mov_b32 s28, s82
    ds_read_b64_tr_b16 a[196:197], v11 offset:0
    v_accvgpr_read_b32 v219, a143
    v_mfma_f32_16x16x32_bf16 v[52:55], a[204:207], v[168:171], v[52:55]
    s_and_b32 s29, s83, 0xffff
    ds_read_b64_tr_b16 a[198:199], v11 offset:6144
    v_fma_f32 v216, v216, v23, -v23
    v_accvgpr_read_b32 v26, a158
    v_fma_f32 v26, v26, v23, -v23
    v_accvgpr_read_b32 v27, a159
    v_fma_f32 v27, v27, v23, -v23
    v_fma_f32 v218, v218, v23, -v23
    v_fma_f32 v219, v219, v23, -v23
    v_fma_f32 v217, v217, v23, -v23
    v_cvt_pk_bf16_f32 v216, v216, v217
    v_cvt_pk_bf16_f32 v217, v218, v219
    v_accvgpr_read_b32 v218, a156
    v_fma_f32 v218, v218, v23, -v23
    v_accvgpr_read_b32 v219, a157
    v_fma_f32 v219, v219, v23, -v23
    v_cvt_pk_bf16_f32 v218, v218, v219
    v_cvt_pk_bf16_f32 v219, v26, v27
    v_mfma_f32_16x16x32_bf16 v[48:51], a[204:207], v[160:163], v[48:51]
    buffer_store_dwordx4 v[160:163], v28, s[20:23], s55 offen offset:0 sc1
    v_mfma_f32_16x16x32_bf16 v[32:35], a[200:203], v[160:163], v[32:35]
    s_waitcnt lgkmcnt(4)
    v_accvgpr_read_b32 v224, a160
    v_accvgpr_read_b32 v225, a161
    v_mfma_f32_16x16x32_bf16 a[224:227], a[208:211], v[192:195], a[224:227]
    s_mov_b32 s30, 1966080
    ds_read_b64_tr_b16 a[200:201], v8 offset:1024
    v_accvgpr_read_b32 v226, a162
    v_mfma_f32_16x16x32_bf16 a[240:243], a[212:215], v[192:195], a[240:243]
    s_mov_b32 s31, 0x00020000
    ds_read_b64_tr_b16 a[202:203], v8 offset:7168
    v_accvgpr_read_b32 v227, a163
    v_mfma_f32_16x16x32_bf16 a[244:247], a[212:215], v[200:203], a[244:247]
    buffer_load_dwordx4 v4, s[12:15], s76 offen offset:256 lds
    v_mfma_f32_16x16x32_bf16 a[228:231], a[208:211], v[200:203], a[228:231]
    s_add_u32 m0, s49, 3072
    v_fma_f32 v224, v224, v20, -v20
    v_fma_f32 v225, v225, v20, -v20
    v_mfma_f32_16x16x32_bf16 a[232:235], a[208:211], v[208:211], a[232:235]
    s_mul_i32 s44, s47, 10
    ds_read_b64_tr_b16 a[204:205], v9 offset:1024
    v_fma_f32 v226, v226, v20, -v20
    v_mfma_f32_16x16x32_bf16 a[248:251], a[212:215], v[208:211], a[248:251]
    s_sub_u32 s44, s58, s44
    ds_read_b64_tr_b16 a[206:207], v9 offset:7168
    v_fma_f32 v227, v227, v20, -v20
    v_mfma_f32_16x16x32_bf16 a[252:255], a[212:215], v[216:219], a[252:255]
    s_lshl_b32 s62, s44, 2
    v_cvt_pk_bf16_f32 v224, v224, v225
    v_cvt_pk_bf16_f32 v225, v226, v227
    v_mfma_f32_16x16x32_bf16 a[236:239], a[208:211], v[216:219], a[236:239]
    s_waitcnt lgkmcnt(4)
    buffer_load_dwordx4 v5, s[12:15], s38 offen offset:0 lds
    v_accvgpr_read_b32 v30, a178
    v_fma_f32 v30, v30, v20, -v20
    v_accvgpr_read_b32 v31, a179
    v_fma_f32 v31, v31, v20, -v20
    v_accvgpr_read_b32 v226, a176
    v_fma_f32 v226, v226, v20, -v20
    v_accvgpr_read_b32 v227, a177
    v_fma_f32 v227, v227, v20, -v20
    v_cvt_pk_bf16_f32 v226, v226, v227
    v_cvt_pk_bf16_f32 v227, v30, v31
    v_mfma_f32_16x16x32_bf16 v[92:95], a[192:195], v[216:219], v[92:95]
    s_add_u32 m0, s49, 3968
    ds_read_b64_tr_b16 a[208:209], v10 offset:1024
    v_accvgpr_read_b32 v232, a164
    v_mfma_f32_16x16x32_bf16 v[124:127], a[196:199], v[216:219], v[124:127]
    s_add_u32 s62, s62, s3
    ds_read_b64_tr_b16 a[210:211], v10 offset:7168
    v_accvgpr_read_b32 v233, a165
    v_mfma_f32_16x16x32_bf16 v[116:119], a[196:199], v[208:211], v[116:119]
    s_lshl_b32 s62, s62, 9
    v_accvgpr_read_b32 v234, a166
    v_accvgpr_read_b32 v235, a167
    v_mfma_f32_16x16x32_bf16 v[84:87], a[192:195], v[208:211], v[84:87]
    buffer_load_dwordx4 v5, s[12:15], s38 offen offset:128 lds
    v_mfma_f32_16x16x32_bf16 v[76:79], a[192:195], v[200:203], v[76:79]
    s_add_u32 m0, s49, 4864
    ds_read_b64_tr_b16 a[212:213], v11 offset:1024
    v_fma_f32 v232, v232, v21, -v21
    v_mfma_f32_16x16x32_bf16 v[108:111], a[196:199], v[200:203], v[108:111]
    s_add_u32 s62, s62, 3670016
    ds_read_b64_tr_b16 a[214:215], v11 offset:7168
    v_fma_f32 v233, v233, v21, -v21
    v_mfma_f32_16x16x32_bf16 v[100:103], a[196:199], v[192:195], v[100:103]
    s_cmp_lt_u32 s2, 240
    s_cselect_b32 s62, s62, 0x70000000
    v_fma_f32 v234, v234, v21, -v21
    v_mfma_f32_16x16x32_bf16 v[68:71], a[192:195], v[192:195], v[68:71]
    s_waitcnt lgkmcnt(4)
    buffer_store_dwordx4 v[168:171], v28, s[20:23], s55 offen offset:1024 sc1
    v_mfma_f32_16x16x32_bf16 v[132:135], a[200:203], v[192:195], v[132:135]
    s_lshl_b32 s59, s47, 6
    ds_read_b64_tr_b16 a[192:193], v18 offset:2048
    v_fma_f32 v235, v235, v21, -v21
    v_mfma_f32_16x16x32_bf16 v[164:167], a[204:207], v[192:195], v[164:167]
    s_lshr_b32 s56, s3, 1
    ds_read_b64_tr_b16 a[194:195], v18 offset:8192
    v_cvt_pk_bf16_f32 v232, v232, v233
    v_accvgpr_read_b32 v24, a182
    v_fma_f32 v24, v24, v21, -v21
    v_accvgpr_read_b32 v25, a183
    v_fma_f32 v25, v25, v21, -v21
    v_cvt_pk_bf16_f32 v233, v234, v235
    v_accvgpr_read_b32 v234, a180
    v_fma_f32 v234, v234, v21, -v21
    v_accvgpr_read_b32 v235, a181
    v_fma_f32 v235, v235, v21, -v21
    v_cvt_pk_bf16_f32 v234, v234, v235
    v_cvt_pk_bf16_f32 v235, v24, v25
    v_mfma_f32_16x16x32_bf16 v[172:175], a[204:207], v[200:203], v[172:175]
pg_9:
    s_cbranch_execz pg_13
    s_lshl_b32 s56, s56, 5
    v_accvgpr_read_b32 v240, a168
    v_accvgpr_read_b32 v241, a169
    v_mfma_f32_16x16x32_bf16 v[140:143], a[200:203], v[200:203], v[140:143]
    s_add_u32 s59, s59, s56
    v_accvgpr_read_b32 v242, a170
    v_accvgpr_read_b32 v243, a171
    v_mfma_f32_16x16x32_bf16 v[148:151], a[200:203], v[208:211], v[148:151]
    s_and_b32 s56, s3, 1
    ds_read_b64_tr_b16 a[196:197], v19 offset:2048
    v_fma_f32 v240, v240, v22, -v22
    v_mfma_f32_16x16x32_bf16 v[180:183], a[204:207], v[208:211], v[180:183]
    s_lshl_b32 s56, s56, 2
    ds_read_b64_tr_b16 a[198:199], v19 offset:8192
    v_fma_f32 v241, v241, v22, -v22
    v_mfma_f32_16x16x32_bf16 v[188:191], a[204:207], v[216:219], v[188:191]
    s_bfe_u32 s88, s72, 262144
    s_cmp_lg_u32 s88, 15
    s_cbranch_scc1 spin_o0
spin_o0_ret:
    v_fma_f32 v242, v242, v22, -v22
    v_mfma_f32_16x16x32_bf16 v[156:159], a[200:203], v[216:219], v[156:159]
    s_waitcnt lgkmcnt(4)
    buffer_load_dwordx4 v5, s[12:15], s76 offen offset:256 lds
    v_mfma_f32_16x16x32_bf16 v[220:223], a[208:211], v[216:219], v[220:223]
    s_add_u32 s59, s59, s56
    ds_read_b64_tr_b16 a[200:201], v8 offset:12288
    v_fma_f32 v243, v243, v22, -v22
    v_mfma_f32_16x16x32_bf16 v[252:255], a[212:215], v[216:219], v[252:255]
    s_mul_i32 s59, s59, 1280
    ds_read_b64_tr_b16 a[202:203], v8 offset:18432
    v_cvt_pk_bf16_f32 v240, v240, v241
    v_mfma_f32_16x16x32_bf16 v[244:247], a[212:215], v[208:211], v[244:247]
    buffer_load_dwordx4 a[0:3], v28, s[20:23], s8 offen offset:0 sc1
    v_mfma_f32_16x16x32_bf16 v[212:215], a[208:211], v[208:211], v[212:215]
    s_lshl_b32 s44, s44, 7
    v_cvt_pk_bf16_f32 v241, v242, v243
    v_accvgpr_read_b32 v242, a184
    v_accvgpr_read_b32 v26, a186
    v_fma_f32 v26, v26, v22, -v22
    v_accvgpr_read_b32 v27, a187
    v_fma_f32 v27, v27, v22, -v22
    v_fma_f32 v242, v242, v22, -v22
    v_accvgpr_read_b32 v243, a185
    v_fma_f32 v243, v243, v22, -v22
    v_cvt_pk_bf16_f32 v242, v242, v243
    v_cvt_pk_bf16_f32 v243, v26, v27
    v_mfma_f32_16x16x32_bf16 v[204:207], a[208:211], v[200:203], v[204:207]
    s_add_u32 s59, s59, s44
    ds_read_b64_tr_b16 a[204:205], v9 offset:12288
    v_accvgpr_read_b32 v248, a172
    v_mfma_f32_16x16x32_bf16 v[236:239], a[212:215], v[200:203], v[236:239]
    s_lshl_b32 s44, s3, 11
    ds_read_b64_tr_b16 a[206:207], v9 offset:18432
    v_lshrrev_b32 v29, 5, v1
    v_mfma_f32_16x16x32_bf16 v[228:231], a[212:215], v[192:195], v[228:231]
    buffer_load_dwordx4 a[4:7], v28, s[20:23], s8 offen offset:1024 sc1
    v_mfma_f32_16x16x32_bf16 v[196:199], a[208:211], v[192:195], v[196:199]
    s_waitcnt lgkmcnt(4)
    v_lshlrev_b32 v29, 3, v29
    v_bfe_u32 v6, v1, 3, 2
    v_mfma_f32_16x16x32_bf16 v[32:35], a[192:195], v[192:195], v[32:35]
    ds_read_b64_tr_b16 a[208:209], v10 offset:12288
    v_add_u32 v6, v6, v29
    v_mfma_f32_16x16x32_bf16 v[48:51], a[196:199], v[192:195], v[48:51]
    ds_read_b64_tr_b16 a[210:211], v10 offset:18432
    v_mul_u32_u24 v6, 1280, v6
    v_mfma_f32_16x16x32_bf16 v[52:55], a[196:199], v[200:203], v[52:55]
    buffer_load_dwordx4 a[8:11], v28, s[20:23], s8 offen offset:2048 sc1
    v_mfma_f32_16x16x32_bf16 v[36:39], a[192:195], v[200:203], v[36:39]
    v_lshrrev_b32 v29, 4, v1
    v_lshlrev_b32 v29, 1, v29
    v_mfma_f32_16x16x32_bf16 v[40:43], a[192:195], v[208:211], v[40:43]
    ds_read_b64_tr_b16 a[212:213], v11 offset:12288
    v_and_b32 v7, 7, v1
    v_mfma_f32_16x16x32_bf16 v[56:59], a[196:199], v[208:211], v[56:59]
    ds_read_b64_tr_b16 a[214:215], v11 offset:18432
    v_xor_b32 v7, v7, v29
    buffer_store_dwordx4 v[176:179], v28, s[20:23], s55 offen offset:2048 sc1
    v_accvgpr_read_b32 v30, a190
    v_fma_f32 v30, v30, v23, -v23
    v_accvgpr_read_b32 v31, a191
    v_fma_f32 v31, v31, v23, -v23
    v_accvgpr_read_b32 v250, a174
    v_fma_f32 v250, v250, v23, -v23
    v_accvgpr_read_b32 v251, a175
    v_fma_f32 v251, v251, v23, -v23
    v_fma_f32 v248, v248, v23, -v23
    v_accvgpr_read_b32 v249, a173
    v_fma_f32 v249, v249, v23, -v23
    v_cvt_pk_bf16_f32 v248, v248, v249
    v_cvt_pk_bf16_f32 v249, v250, v251
    v_accvgpr_read_b32 v250, a188
    v_fma_f32 v250, v250, v23, -v23
    v_accvgpr_read_b32 v251, a189
    v_fma_f32 v251, v251, v23, -v23
    v_cvt_pk_bf16_f32 v250, v250, v251
    v_cvt_pk_bf16_f32 v251, v30, v31
    v_mfma_f32_16x16x32_bf16 v[60:63], a[196:199], v[216:219], v[60:63]
    v_lshlrev_b32 v16, 4, v16
    v_lshlrev_b32 v7, 4, v7
    v_mfma_f32_16x16x32_bf16 v[44:47], a[192:195], v[216:219], v[44:47]
    s_waitcnt lgkmcnt(4)
    v_add_u32 v6, v6, v7
    v_add_u32 v7, 20480, v6
    v_mfma_f32_16x16x32_bf16 a[236:239], a[200:203], v[248:251], a[236:239]
    s_waitcnt vmcnt(13)
    ds_read_b64_tr_b16 a[192:193], v8 offset:13312
    v_add_u32 v29, 147456, v28
    v_mfma_f32_16x16x32_bf16 a[252:255], a[204:207], v[248:251], a[252:255]
    ds_read_b64_tr_b16 a[194:195], v8 offset:19456
    v_mfma_f32_16x16x32_bf16 a[248:251], a[204:207], v[240:243], a[248:251]
    buffer_atomic_or v16, v17, s[24:27], 0 offen
    v_mfma_f32_16x16x32_bf16 a[232:235], a[200:203], v[240:243], a[232:235]
    buffer_load_dwordx4 a[12:15], v28, s[20:23], s8 offen offset:3072 sc1
    v_mfma_f32_16x16x32_bf16 a[228:231], a[200:203], v[232:235], a[228:231]
    s_add_u32 s8, s8, 4096
    ds_read_b64_tr_b16 a[196:197], v9 offset:13312
    v_add_u32 v8, 24576, v12
    v_mfma_f32_16x16x32_bf16 a[244:247], a[204:207], v[232:235], a[244:247]
    ds_read_b64_tr_b16 a[198:199], v9 offset:19456
    v_mfma_f32_16x16x32_bf16 a[240:243], a[204:207], v[224:227], a[240:243]
    v_add_u32 v9, 24576, v13
    v_mfma_f32_16x16x32_bf16 a[224:227], a[200:203], v[224:227], a[224:227]
    s_waitcnt lgkmcnt(4)
    buffer_store_dwordx4 v[184:187], v28, s[20:23], s55 offen offset:3072 sc1
    v_mfma_f32_16x16x32_bf16 v[68:71], a[208:211], v[224:227], v[68:71]
    s_add_u32 s55, s55, 12288
    ds_read_b64_tr_b16 a[200:201], v10 offset:13312
    s_mov_b32 s16, s64
    v_mfma_f32_16x16x32_bf16 v[100:103], a[212:215], v[224:227], v[100:103]
    s_and_b32 s17, s65, 0xffff
    ds_read_b64_tr_b16 a[202:203], v10 offset:19456
    s_mov_b32 s18, 2621440
    v_mfma_f32_16x16x32_bf16 v[108:111], a[212:215], v[232:235], v[108:111]
    s_mov_b32 s19, 0x00020000
    v_add_u32 v10, 24576, v14
    s_lshl_b32 s45, s52, 4
    v_mfma_f32_16x16x32_bf16 v[76:79], a[208:211], v[232:235], v[76:79]
    s_lshr_b32 s56, s53, 1
    s_lshl2_add_u32 s45, s56, s45
    s_add_u32 s45, s45, s3
    v_mfma_f32_16x16x32_bf16 v[84:87], a[208:211], v[240:243], v[84:87]
    s_lshl_b32 s56, s45, 4
    ds_read_b64_tr_b16 a[204:205], v11 offset:13312
    v_and_b32 v20, 15, v1
    v_mfma_f32_16x16x32_bf16 v[116:119], a[212:215], v[240:243], v[116:119]
    ds_read_b64_tr_b16 a[206:207], v11 offset:19456
    v_add_u32 v20, s56, v20
    v_mfma_f32_16x16x32_bf16 v[124:127], a[212:215], v[248:251], v[124:127]
    buffer_load_dwordx4 a[16:19], v28, s[20:23], s9 offen offset:0 sc1
    v_mfma_f32_16x16x32_bf16 v[92:95], a[208:211], v[248:251], v[92:95]
    s_waitcnt lgkmcnt(4)
    v_bfe_u32 v21, v1, 4, 1
    v_bfe_u32 v22, v1, 5, 1
    v_mfma_f32_16x16x32_bf16 v[156:159], a[192:195], v[248:251], v[156:159]
    ds_read_b64_tr_b16 a[208:209], v18 offset:14336
    v_lshl_add_u32 v21, v21, 1, v22
    v_mfma_f32_16x16x32_bf16 v[188:191], a[196:199], v[248:251], v[188:191]
    ds_read_b64_tr_b16 a[210:211], v18 offset:20480
    v_mul_u32_u24 v22, 1280, v20
    v_mfma_f32_16x16x32_bf16 v[180:183], a[196:199], v[240:243], v[180:183]
    buffer_store_dwordx4 v[192:195], v28, s[20:23], s55 offen offset:0 sc1
    v_mfma_f32_16x16x32_bf16 v[148:151], a[192:195], v[240:243], v[148:151]
    v_lshl_add_u32 v22, v21, 4, v22
    v_lshlrev_b32 v23, 3, v20
    v_mfma_f32_16x16x32_bf16 v[140:143], a[192:195], v[232:235], v[140:143]
    s_lshr_b32 s48, s45, 2
    ds_read_b64_tr_b16 a[212:213], v19 offset:14336
    v_add_u32 v11, 24576, v15
    v_mfma_f32_16x16x32_bf16 v[172:175], a[196:199], v[232:235], v[172:175]
    s_waitcnt vmcnt(52)
    ds_read_b64_tr_b16 a[214:215], v19 offset:20480
    v_xor_b32 v18, s39, v8
    v_mfma_f32_16x16x32_bf16 v[164:167], a[196:199], v[224:227], v[164:167]
    s_barrier
    v_mfma_f32_16x16x32_bf16 v[132:135], a[192:195], v[224:227], v[132:135]
    s_waitcnt lgkmcnt(4)
    buffer_load_dwordx4 a[20:23], v28, s[20:23], s9 offen offset:1024 sc1
    v_mfma_f32_16x16x32_bf16 v[196:199], a[200:203], v[224:227], v[196:199]
    s_lshr_b32 s56, s48, 1
    ds_read_b64_tr_b16 a[192:193], v8 offset:0
    v_xor_b32 v19, s39, v9
    v_mfma_f32_16x16x32_bf16 v[228:231], a[204:207], v[224:227], v[228:231]
    s_lshl_b32 s56, s56, 19
    ds_read_b64_tr_b16 a[194:195], v8 offset:6144
    s_and_b32 s40, s48, 1
    v_mfma_f32_16x16x32_bf16 v[236:239], a[204:207], v[232:235], v[236:239]
    buffer_load_dwordx4 a[24:27], v28, s[20:23], s9 offen offset:2048 sc1
    v_mfma_f32_16x16x32_bf16 v[204:207], a[200:203], v[232:235], v[204:207]
    s_lshl_b32 s40, s40, 12
    s_or_b32 s56, s56, s40
    s_lshl_b32 s40, s48, 10
    v_mfma_f32_16x16x32_bf16 v[212:215], a[200:203], v[240:243], v[212:215]
    s_and_b32 s40, s40, 0x2000
    ds_read_b64_tr_b16 a[196:197], v9 offset:0
    s_or_b32 s56, s56, s40
    v_mfma_f32_16x16x32_bf16 v[244:247], a[204:207], v[240:243], v[244:247]
    s_or_b32 s56, s56, 134217728
    ds_read_b64_tr_b16 a[198:199], v9 offset:6144
    s_lshl_b32 s45, s3, 10
    v_mfma_f32_16x16x32_bf16 v[252:255], a[204:207], v[248:251], v[252:255]
    buffer_load_dwordx4 a[28:31], v28, s[20:23], s9 offen offset:3072 sc1
    v_mfma_f32_16x16x32_bf16 v[220:223], a[200:203], v[248:251], v[220:223]
    s_waitcnt lgkmcnt(4)
    s_add_u32 s9, s9, 4096
    s_add_u32 s45, s45, s56
    v_mfma_f32_16x16x32_bf16 v[44:47], a[208:211], v[248:251], v[44:47]
    s_mul_i32 s56, s51, 81920
    ds_read_b64_tr_b16 a[200:201], v10 offset:0
    s_add_u32 s45, s45, s56
    v_mfma_f32_16x16x32_bf16 v[60:63], a[212:215], v[248:251], v[60:63]
    s_bitcmp0_b32 s53, 0
    s_cselect_b32 s47, 2, 0
    ds_read_b64_tr_b16 a[202:203], v10 offset:6144
    v_mfma_f32_16x16x32_bf16 v[56:59], a[212:215], v[240:243], v[56:59]
    buffer_store_dwordx4 v[200:203], v28, s[20:23], s55 offen offset:1024 sc1
    v_mfma_f32_16x16x32_bf16 v[40:43], a[208:211], v[240:243], v[40:43]
    s_lshl_b32 s47, s47, 13
    s_add_u32 s47, s47, s45
    s_bitcmp0_b32 s53, 0
    s_cselect_b32 s48, 4, 4
    v_mfma_f32_16x16x32_bf16 v[36:39], a[208:211], v[232:235], v[36:39]
    s_lshl_b32 s48, s48, 13
    ds_read_b64_tr_b16 a[204:205], v11 offset:0
    s_add_u32 s48, s48, s45
    v_mfma_f32_16x16x32_bf16 v[52:55], a[212:215], v[232:235], v[52:55]
    s_waitcnt vmcnt(7)
    ds_read_b64_tr_b16 a[206:207], v11 offset:6144
    s_lshl_b32 s56, s51, 2
    v_mfma_f32_16x16x32_bf16 v[48:51], a[212:215], v[224:227], v[48:51]
    s_add_u32 s6, s51, 16
    s_bitcmp0_b32 s53, 0
    s_cselect_b32 s41, 1, 0
    v_mfma_f32_16x16x32_bf16 v[32:35], a[208:211], v[224:227], v[32:35]
    s_waitcnt lgkmcnt(4)
    buffer_load_dwordx4 a[32:35], v28, s[20:23], s10 offen offset:0 sc1
    v_mfma_f32_16x16x32_bf16 a[224:227], a[192:195], a[0:3], a[224:227]
    s_load_dword s72, s[86:87], s5 offset:4 glc
    ds_read_b64_tr_b16 a[208:209], v8 offset:1024
    s_add_u32 s41, s41, s56
    v_mfma_f32_16x16x32_bf16 a[240:243], a[196:199], a[0:3], a[240:243]
    s_bitcmp0_b32 s53, 0
    s_cselect_b32 s42, 2, 2
    ds_read_b64_tr_b16 a[210:211], v8 offset:7168
    v_mfma_f32_16x16x32_bf16 a[244:247], a[196:199], a[4:7], a[244:247]
    s_add_u32 s42, s42, s56
    ds_read_b128 v[64:67], v29 offset:0
    s_bitcmp0_b32 s53, 0
    s_cselect_b32 s43, 3, 4
    v_mfma_f32_16x16x32_bf16 a[228:231], a[192:195], a[4:7], a[228:231]
    s_add_u32 s43, s43, s56
    ds_read_b128 v[72:75], v29 offset:1024
    s_bitcmp0_b32 s53, 0
    s_cselect_b32 s43, s43, s6
    v_mfma_f32_16x16x32_bf16 a[232:235], a[192:195], a[8:11], a[232:235]
    s_lshl_b32 s41, s41, 6
    ds_read_b64_tr_b16 a[212:213], v9 offset:1024
    s_lshl_b32 s42, s42, 6
    v_mfma_f32_16x16x32_bf16 a[248:251], a[196:199], a[8:11], a[248:251]
    s_lshl_b32 s43, s43, 6
    ds_read_b64_tr_b16 a[214:215], v9 offset:7168
    s_bitcmp0_b32 s53, 0
    s_cselect_b32 s66, s42, 0x70000000
    v_mfma_f32_16x16x32_bf16 a[252:255], a[196:199], a[12:15], a[252:255]
    ds_read_b128 v[80:83], v29 offset:2048
    v_add_u32 v23, 3211264, v23
    v_mfma_f32_16x16x32_bf16 a[236:239], a[192:195], a[12:15], a[236:239]
    s_waitcnt lgkmcnt(4)
    buffer_store_dwordx4 v[208:211], v28, s[20:23], s55 offen offset:2048 sc1
    v_mfma_f32_16x16x32_bf16 v[92:95], a[200:203], a[12:15], v[92:95]
    ds_read_b64_tr_b16 a[192:193], v10 offset:1024
    v_mfma_f32_16x16x32_bf16 v[124:127], a[204:207], a[12:15], v[124:127]
    ds_read_b64_tr_b16 a[194:195], v10 offset:7168
    v_mfma_f32_16x16x32_bf16 v[116:119], a[204:207], a[8:11], v[116:119]
    ds_read_b128 v[88:91], v29 offset:3072
    v_mfma_f32_16x16x32_bf16 v[84:87], a[200:203], a[8:11], v[84:87]
    ds_read_b128 v[96:99], v29 offset:4096
    v_mfma_f32_16x16x32_bf16 v[76:79], a[200:203], a[4:7], v[76:79]
    ds_read_b64_tr_b16 a[196:197], v11 offset:1024
    v_mfma_f32_16x16x32_bf16 v[108:111], a[204:207], a[4:7], v[108:111]
    ds_read_b64_tr_b16 a[198:199], v11 offset:7168
    v_mfma_f32_16x16x32_bf16 v[100:103], a[204:207], a[0:3], v[100:103]
    ds_read_b128 v[104:107], v29 offset:5120
    v_mfma_f32_16x16x32_bf16 v[68:71], a[200:203], a[0:3], v[68:71]
    s_waitcnt lgkmcnt(4)
    buffer_load_dwordx4 a[36:39], v28, s[20:23], s10 offen offset:1024 sc1
    v_mfma_f32_16x16x32_bf16 v[132:135], a[208:211], a[0:3], v[132:135]
    ds_read_b64_tr_b16 a[200:201], v18 offset:2048
    v_lshlrev_b32 v16, 4, v16
    v_mfma_f32_16x16x32_bf16 v[164:167], a[212:215], a[0:3], v[164:167]
    s_waitcnt vmcnt(9)
    ds_read_b64_tr_b16 a[202:203], v18 offset:8192
    v_mfma_f32_16x16x32_bf16 v[172:175], a[212:215], a[4:7], v[172:175]
    ds_read_b128 v[112:115], v29 offset:6144
    v_mfma_f32_16x16x32_bf16 v[140:143], a[208:211], a[4:7], v[140:143]
    ds_read_b128 v[120:123], v29 offset:7168
    v_mfma_f32_16x16x32_bf16 v[148:151], a[208:211], a[8:11], v[148:151]
    ds_read_b64_tr_b16 a[204:205], v19 offset:2048
    v_mfma_f32_16x16x32_bf16 v[180:183], a[212:215], a[8:11], v[180:183]
    ds_read_b64_tr_b16 a[206:207], v19 offset:8192
    v_mfma_f32_16x16x32_bf16 v[188:191], a[212:215], a[12:15], v[188:191]
    ds_read_b128 v[128:131], v29 offset:8192
    v_mfma_f32_16x16x32_bf16 v[156:159], a[208:211], a[12:15], v[156:159]
    s_waitcnt lgkmcnt(4)
    buffer_atomic_or v16, v17, s[24:27], 0 offen
    v_mfma_f32_16x16x32_bf16 v[220:223], a[192:195], a[12:15], v[220:223]
    ds_read_b64_tr_b16 a[208:209], v8 offset:12288
    v_mfma_f32_16x16x32_bf16 v[252:255], a[196:199], a[12:15], v[252:255]
    ds_read_b64_tr_b16 a[210:211], v8 offset:18432
    v_mfma_f32_16x16x32_bf16 v[244:247], a[196:199], a[8:11], v[244:247]
    ds_read_b128 v[136:139], v29 offset:9216
    v_mfma_f32_16x16x32_bf16 v[212:215], a[192:195], a[8:11], v[212:215]
    buffer_store_dwordx4 v[216:219], v28, s[20:23], s55 offen offset:3072 sc1
    v_mfma_f32_16x16x32_bf16 v[204:207], a[192:195], a[4:7], v[204:207]
    s_add_u32 s55, s55, 4096
    ds_read_b64_tr_b16 a[212:213], v9 offset:12288
    v_mfma_f32_16x16x32_bf16 v[236:239], a[196:199], a[4:7], v[236:239]
    ds_read_b64_tr_b16 a[214:215], v9 offset:18432
    v_mfma_f32_16x16x32_bf16 v[228:231], a[196:199], a[0:3], v[228:231]
    buffer_load_dwordx4 a[40:43], v28, s[20:23], s10 offen offset:2048 sc1
    v_mfma_f32_16x16x32_bf16 v[196:199], a[192:195], a[0:3], v[196:199]
    s_waitcnt lgkmcnt(4)
    v_mfma_f32_16x16x32_bf16 v[32:35], a[200:203], a[0:3], v[32:35]
    ds_read_b64_tr_b16 a[192:193], v10 offset:12288
    v_mfma_f32_16x16x32_bf16 v[48:51], a[204:207], a[0:3], v[48:51]
    ds_read_b64_tr_b16 a[194:195], v10 offset:18432
    v_mfma_f32_16x16x32_bf16 v[52:55], a[204:207], a[4:7], v[52:55]
    s_bfe_u32 s88, s72, 262148
    s_cmp_lg_u32 s88, 15
    s_cbranch_scc1 spin_o1
spin_o1_ret:
    v_mfma_f32_16x16x32_bf16 v[36:39], a[200:203], a[4:7], v[36:39]
    buffer_load_dwordx4 a[44:47], v28, s[20:23], s10 offen offset:3072 sc1
    v_mfma_f32_16x16x32_bf16 v[40:43], a[200:203], a[8:11], v[40:43]
    s_add_u32 s10, s10, 4096
    ds_read_b64_tr_b16 a[196:197], v11 offset:12288
    v_mfma_f32_16x16x32_bf16 v[56:59], a[204:207], a[8:11], v[56:59]
    s_waitcnt vmcnt(8)
    ds_read_b64_tr_b16 a[198:199], v11 offset:18432
    v_mfma_f32_16x16x32_bf16 v[60:63], a[204:207], a[12:15], v[60:63]
    buffer_load_dwordx4 a[48:51], v28, s[20:23], s8 offen offset:0 sc1
    v_mfma_f32_16x16x32_bf16 v[44:47], a[200:203], a[12:15], v[44:47]
    s_waitcnt lgkmcnt(4)
    v_mfma_f32_16x16x32_bf16 a[236:239], a[208:211], a[28:31], a[236:239]
    ds_read_b64_tr_b16 a[200:201], v8 offset:13312
    v_mfma_f32_16x16x32_bf16 a[252:255], a[212:215], a[28:31], a[252:255]
    ds_read_b64_tr_b16 a[202:203], v8 offset:19456
    v_mfma_f32_16x16x32_bf16 a[248:251], a[212:215], a[24:27], a[248:251]
    v_add_u32 v8, 73728, v12
    v_mfma_f32_16x16x32_bf16 a[232:235], a[208:211], a[24:27], a[232:235]
    buffer_load_dwordx4 a[52:55], v28, s[20:23], s8 offen offset:1024 sc1
    v_mfma_f32_16x16x32_bf16 a[228:231], a[208:211], a[20:23], a[228:231]
    ds_read_b64_tr_b16 a[204:205], v9 offset:13312
    v_add_f32 v64, v64, v72
    buffer_store_dwordx4 v[224:227], v28, s[20:23], s55 offen offset:0 sc1
    v_mfma_f32_16x16x32_bf16 a[244:247], a[212:215], a[20:23], a[244:247]
    ds_read_b64_tr_b16 a[206:207], v9 offset:19456
    v_add_f32 v65, v65, v73
    v_mfma_f32_16x16x32_bf16 a[240:243], a[212:215], a[16:19], a[240:243]
    v_add_f32 v66, v66, v74
    v_add_f32 v67, v67, v75
    v_mfma_f32_16x16x32_bf16 a[224:227], a[208:211], a[16:19], a[224:227]
    s_waitcnt lgkmcnt(4)
    v_add_f32 v64, v64, v80
    v_add_f32 v65, v65, v81
    v_mfma_f32_16x16x32_bf16 v[68:71], a[192:195], a[16:19], v[68:71]
    ds_read_b64_tr_b16 a[208:209], v10 offset:13312
    v_add_f32 v66, v66, v82
    v_mfma_f32_16x16x32_bf16 v[100:103], a[196:199], a[16:19], v[100:103]
    ds_read_b64_tr_b16 a[210:211], v10 offset:19456
    v_add_f32 v67, v67, v83
    v_mfma_f32_16x16x32_bf16 v[108:111], a[196:199], a[20:23], v[108:111]
    v_add_f32 v64, v64, v88
    v_add_f32 v65, v65, v89
    v_mfma_f32_16x16x32_bf16 v[76:79], a[192:195], a[20:23], v[76:79]
    buffer_load_dwordx4 a[56:59], v28, s[20:23], s8 offen offset:2048 sc1
    v_mfma_f32_16x16x32_bf16 v[84:87], a[192:195], a[24:27], v[84:87]
    ds_read_b64_tr_b16 a[212:213], v11 offset:13312
    v_add_f32 v66, v66, v90
    v_mfma_f32_16x16x32_bf16 v[116:119], a[196:199], a[24:27], v[116:119]
    ds_read_b64_tr_b16 a[214:215], v11 offset:19456
    v_add_f32 v67, v67, v91
    v_mfma_f32_16x16x32_bf16 v[124:127], a[196:199], a[28:31], v[124:127]
    v_add_f32 v64, v64, v96
    v_add_f32 v65, v65, v97
    v_mfma_f32_16x16x32_bf16 v[92:95], a[192:195], a[28:31], v[92:95]
    s_waitcnt lgkmcnt(4)
    v_add_f32 v66, v66, v98
    v_add_f32 v67, v67, v99
    v_mfma_f32_16x16x32_bf16 v[156:159], a[200:203], a[28:31], v[156:159]
    ds_read_b64_tr_b16 a[192:193], v18 offset:14336
    v_add_f32 v64, v64, v104
    v_mfma_f32_16x16x32_bf16 v[188:191], a[204:207], a[28:31], v[188:191]
    ds_read_b64_tr_b16 a[194:195], v18 offset:20480
    v_add_f32 v65, v65, v105
    v_mfma_f32_16x16x32_bf16 v[180:183], a[204:207], a[24:27], v[180:183]
    buffer_load_dwordx4 a[60:63], v28, s[20:23], s8 offen offset:3072 sc1
    v_mfma_f32_16x16x32_bf16 v[148:151], a[200:203], a[24:27], v[148:151]
    s_add_u32 s8, s8, 12288
    v_add_f32 v66, v66, v106
    v_add_f32 v67, v67, v107
    buffer_store_dwordx4 v[232:235], v28, s[20:23], s55 offen offset:1024 sc1
    v_mfma_f32_16x16x32_bf16 v[140:143], a[200:203], a[20:23], v[140:143]
    ds_read_b64_tr_b16 a[196:197], v19 offset:14336
    v_add_f32 v64, v64, v112
    v_mfma_f32_16x16x32_bf16 v[172:175], a[204:207], a[20:23], v[172:175]
    s_waitcnt vmcnt(63)
    ds_read_b64_tr_b16 a[198:199], v19 offset:20480
    v_add_f32 v65, v65, v113
    v_mfma_f32_16x16x32_bf16 v[164:167], a[204:207], a[16:19], v[164:167]
    s_barrier
    v_mfma_f32_16x16x32_bf16 v[132:135], a[200:203], a[16:19], v[132:135]
    s_waitcnt lgkmcnt(4)
    v_add_f32 v66, v66, v114
    v_add_f32 v67, v67, v115
    v_mfma_f32_16x16x32_bf16 v[196:199], a[208:211], a[16:19], v[196:199]
    ds_read_b64_tr_b16 a[200:201], v8 offset:0
    v_add_f32 v64, v64, v120
    v_mfma_f32_16x16x32_bf16 v[228:231], a[212:215], a[16:19], v[228:231]
    ds_read_b64_tr_b16 a[202:203], v8 offset:6144
    v_add_f32 v65, v65, v121
    v_mfma_f32_16x16x32_bf16 v[236:239], a[212:215], a[20:23], v[236:239]
    buffer_store_dwordx4 v[240:243], v28, s[20:23], s55 offen offset:2048 sc1
    v_mfma_f32_16x16x32_bf16 v[204:207], a[208:211], a[20:23], v[204:207]
    v_add_f32 v66, v66, v122
    v_add_f32 v67, v67, v123
    v_add_u32 v9, 73728, v13
    v_mfma_f32_16x16x32_bf16 v[212:215], a[208:211], a[24:27], v[212:215]
    ds_read_b64_tr_b16 a[204:205], v9 offset:0
    v_add_f32 v64, v64, v128
    v_mfma_f32_16x16x32_bf16 v[244:247], a[212:215], a[24:27], v[244:247]
    ds_read_b64_tr_b16 a[206:207], v9 offset:6144
    v_add_f32 v65, v65, v129
    v_mfma_f32_16x16x32_bf16 v[252:255], a[212:215], a[28:31], v[252:255]
    buffer_load_dwordx4 a[64:67], v28, s[20:23], s9 offen offset:0 sc1
    v_mfma_f32_16x16x32_bf16 v[220:223], a[208:211], a[28:31], v[220:223]
    s_waitcnt lgkmcnt(4)
    v_add_f32 v66, v66, v130
    v_add_f32 v67, v67, v131
    v_add_u32 v10, 73728, v14
    v_mfma_f32_16x16x32_bf16 v[44:47], a[192:195], a[28:31], v[44:47]
    s_load_dword s72, s[86:87], s5 offset:4 glc
    ds_read_b64_tr_b16 a[208:209], v10 offset:0
    v_add_f32 v64, v64, v136
    v_mfma_f32_16x16x32_bf16 v[60:63], a[196:199], a[28:31], v[60:63]
    ds_read_b64_tr_b16 a[210:211], v10 offset:6144
    v_add_f32 v65, v65, v137
    v_mfma_f32_16x16x32_bf16 v[56:59], a[196:199], a[24:27], v[56:59]
    buffer_load_dwordx4 a[68:71], v28, s[20:23], s9 offen offset:1024 sc1
    v_mfma_f32_16x16x32_bf16 v[40:43], a[192:195], a[24:27], v[40:43]
    v_lshlrev_b32 v16, 4, v16
    v_add_f32 v66, v66, v138
    v_add_u32 v11, 73728, v15
    v_mfma_f32_16x16x32_bf16 v[36:39], a[192:195], a[20:23], v[36:39]
    s_waitcnt vmcnt(11)
    ds_read_b64_tr_b16 a[212:213], v11 offset:0
    v_add_f32 v67, v67, v139
    v_mfma_f32_16x16x32_bf16 v[52:55], a[196:199], a[20:23], v[52:55]
    s_waitcnt vmcnt(9)
    ds_read_b64_tr_b16 a[214:215], v11 offset:6144
    v_cvt_pk_bf16_f32 v64, v64, v64
    v_mfma_f32_16x16x32_bf16 v[48:51], a[196:199], a[16:19], v[48:51]
    buffer_atomic_or v16, v17, s[24:27], 0 offen
    v_mfma_f32_16x16x32_bf16 v[32:35], a[192:195], a[16:19], v[32:35]
    s_waitcnt lgkmcnt(4)
    buffer_load_dwordx4 a[72:75], v28, s[20:23], s9 offen offset:2048 sc1
    v_mfma_f32_16x16x32_bf16 a[224:227], a[200:203], a[32:35], a[224:227]
    ds_read_b64_tr_b16 a[192:193], v8 offset:1024
    v_and_b32 v64, 0xffff0000, v64
    v_mfma_f32_16x16x32_bf16 a[240:243], a[204:207], a[32:35], a[240:243]
    ds_read_b64_tr_b16 a[194:195], v8 offset:7168
    v_cvt_pk_bf16_f32 v65, v65, v65
    v_mfma_f32_16x16x32_bf16 a[244:247], a[204:207], a[36:39], a[244:247]
    buffer_store_dwordx4 v[248:251], v28, s[20:23], s55 offen offset:3072 sc1
    v_mfma_f32_16x16x32_bf16 a[228:231], a[200:203], a[36:39], a[228:231]
    s_add_u32 s55, s55, 12288
    v_and_b32 v65, 0xffff0000, v65
    v_cvt_pk_bf16_f32 v66, v66, v66
    v_mfma_f32_16x16x32_bf16 a[232:235], a[200:203], a[40:43], a[232:235]
    ds_read_b64_tr_b16 a[196:197], v9 offset:1024
    v_and_b32 v66, 0xffff0000, v66
    v_mfma_f32_16x16x32_bf16 a[248:251], a[204:207], a[40:43], a[248:251]
    ds_read_b64_tr_b16 a[198:199], v9 offset:7168
    v_cvt_pk_bf16_f32 v67, v67, v67
    v_mfma_f32_16x16x32_bf16 a[252:255], a[204:207], a[44:47], a[252:255]
    v_and_b32 v67, 0xffff0000, v67
    v_mul_f32 v72, s92, v64
    v_mfma_f32_16x16x32_bf16 a[236:239], a[200:203], a[44:47], a[236:239]
    s_waitcnt lgkmcnt(4)
    buffer_load_dwordx4 a[76:79], v28, s[20:23], s9 offen offset:3072 sc1
    v_mfma_f32_16x16x32_bf16 v[92:95], a[208:211], a[44:47], v[92:95]
    s_add_u32 s9, s9, 12288
    ds_read_b64_tr_b16 a[200:201], v10 offset:1024
    v_xor_b32 v18, s39, v8
    v_mfma_f32_16x16x32_bf16 v[124:127], a[212:215], a[44:47], v[124:127]
    ds_read_b64_tr_b16 a[202:203], v10 offset:7168
    v_xor_b32 v19, s39, v9
    v_mfma_f32_16x16x32_bf16 v[116:119], a[212:215], a[40:43], v[116:119]
    v_exp_f32 v72, v72
    v_mfma_f32_16x16x32_bf16 v[84:87], a[208:211], a[40:43], v[84:87]
    buffer_load_dwordx4 a[80:83], v28, s[20:23], s10 offen offset:0 sc1
    v_mfma_f32_16x16x32_bf16 v[76:79], a[208:211], a[36:39], v[76:79]
    ds_read_b64_tr_b16 a[204:205], v11 offset:1024
    v_add_f32 v72, 1.0, v72
    v_mfma_f32_16x16x32_bf16 v[108:111], a[212:215], a[36:39], v[108:111]
    ds_read_b64_tr_b16 a[206:207], v11 offset:7168
    v_mfma_f32_16x16x32_bf16 v[100:103], a[212:215], a[32:35], v[100:103]
    v_rcp_f32 v72, v72
    v_mfma_f32_16x16x32_bf16 v[68:71], a[208:211], a[32:35], v[68:71]
    s_waitcnt lgkmcnt(4)
    buffer_load_dwordx4 a[84:87], v28, s[20:23], s10 offen offset:1024 sc1
    v_mfma_f32_16x16x32_bf16 v[132:135], a[192:195], a[32:35], v[132:135]
    ds_read_b64_tr_b16 a[208:209], v18 offset:2048
    v_mul_f32 v64, v64, v72
    v_mfma_f32_16x16x32_bf16 v[164:167], a[196:199], a[32:35], v[164:167]
    ds_read_b64_tr_b16 a[210:211], v18 offset:8192
    v_cvt_pk_bf16_f32 v64, v64, v64
    v_mfma_f32_16x16x32_bf16 v[172:175], a[196:199], a[36:39], v[172:175]
    v_and_b32 v64, 0xffff0000, v64
    v_mul_f32 v64, v64, v66
    v_mfma_f32_16x16x32_bf16 v[140:143], a[192:195], a[36:39], v[140:143]
    v_mul_f32 v73, s92, v65
    v_mfma_f32_16x16x32_bf16 v[148:151], a[192:195], a[40:43], v[148:151]
    ds_read_b64_tr_b16 a[212:213], v19 offset:2048
    v_mfma_f32_16x16x32_bf16 v[180:183], a[196:199], a[40:43], v[180:183]
    ds_read_b64_tr_b16 a[214:215], v19 offset:8192
    v_mfma_f32_16x16x32_bf16 v[188:191], a[196:199], a[44:47], v[188:191]
    buffer_load_dwordx4 a[88:91], v28, s[20:23], s10 offen offset:2048 sc1
    v_mfma_f32_16x16x32_bf16 v[156:159], a[192:195], a[44:47], v[156:159]
    s_waitcnt lgkmcnt(4)
    v_exp_f32 v73, v73
    v_mfma_f32_16x16x32_bf16 v[220:223], a[200:203], a[44:47], v[220:223]
    ds_read_b64_tr_b16 a[192:193], v8 offset:12288
    v_add_f32 v73, 1.0, v73
    v_mfma_f32_16x16x32_bf16 v[252:255], a[204:207], a[44:47], v[252:255]
    ds_read_b64_tr_b16 a[194:195], v8 offset:18432
    v_cmp_lt_u32 s[78:79], 31, v1
    v_mfma_f32_16x16x32_bf16 v[244:247], a[204:207], a[40:43], v[244:247]
    s_bfe_u32 s88, s72, 262152
    s_cmp_lg_u32 s88, 15
    s_cbranch_scc1 spin_o2
spin_o2_ret:
    v_mov_b32 v195, s70
    v_mfma_f32_16x16x32_bf16 v[212:215], a[200:203], a[40:43], v[212:215]
    buffer_load_dwordx4 a[92:95], v28, s[20:23], s10 offen offset:3072 sc1
    v_mfma_f32_16x16x32_bf16 v[204:207], a[200:203], a[36:39], v[204:207]
    s_add_u32 s10, s10, 12288
    ds_read_b64_tr_b16 a[196:197], v9 offset:12288
    v_mov_b32 v192, s71
    v_mfma_f32_16x16x32_bf16 v[236:239], a[204:207], a[36:39], v[236:239]
    ds_read_b64_tr_b16 a[198:199], v9 offset:18432
    v_cndmask_b32 v195, v195, v192, s[78:79]
    v_mfma_f32_16x16x32_bf16 v[228:231], a[204:207], a[32:35], v[228:231]
    buffer_load_dwordx4 a[96:99], v28, s[20:23], s8 offen offset:0 sc1
    v_mfma_f32_16x16x32_bf16 v[196:199], a[200:203], a[32:35], v[196:199]
    s_waitcnt lgkmcnt(4)
    v_rcp_f32 v73, v73
    v_mfma_f32_16x16x32_bf16 v[32:35], a[208:211], a[32:35], v[32:35]
    ds_read_b64_tr_b16 a[200:201], v10 offset:12288
    v_mul_f32 v65, v65, v73
    v_mfma_f32_16x16x32_bf16 v[48:51], a[212:215], a[32:35], v[48:51]
    ds_read_b64_tr_b16 a[202:203], v10 offset:18432
    v_cvt_pk_bf16_f32 v65, v65, v65
    v_mfma_f32_16x16x32_bf16 v[52:55], a[212:215], a[36:39], v[52:55]
    buffer_load_dwordx4 a[100:103], v28, s[20:23], s8 offen offset:1024 sc1
    v_mfma_f32_16x16x32_bf16 v[36:39], a[208:211], a[36:39], v[36:39]
    v_and_b32 v65, 0xffff0000, v65
    v_mul_f32 v65, v65, v67
    v_mfma_f32_16x16x32_bf16 v[40:43], a[208:211], a[40:43], v[40:43]
    ds_read_b64_tr_b16 a[204:205], v11 offset:12288
    v_cvt_pk_bf16_f32 v64, v64, v65
    v_mfma_f32_16x16x32_bf16 v[56:59], a[212:215], a[40:43], v[56:59]
    s_waitcnt vmcnt(14)
    ds_read_b64_tr_b16 a[206:207], v11 offset:18432
    v_bfe_u32 v194, v1, 3, 2
    v_mfma_f32_16x16x32_bf16 v[60:63], a[212:215], a[44:47], v[60:63]
    buffer_load_dwordx4 a[104:107], v28, s[20:23], s8 offen offset:2048 sc1
    v_mfma_f32_16x16x32_bf16 v[44:47], a[208:211], a[44:47], v[44:47]
    s_waitcnt lgkmcnt(4)
    v_mov_b32 v192, s41
    v_mov_b32 v193, s42
    v_mfma_f32_16x16x32_bf16 a[236:239], a[192:195], a[60:63], a[236:239]
    s_lshl_b32 s61, s3, 8
    ds_read_b64_tr_b16 a[208:209], v8 offset:13312
    v_cmp_eq_u32 s[78:79], 1, v194
    v_mfma_f32_16x16x32_bf16 a[252:255], a[196:199], a[60:63], a[252:255]
    s_add_u32 s61, s61, 157696
    ds_read_b64_tr_b16 a[210:211], v8 offset:19456
    v_lshlrev_b32 v80, 1, v1
    v_mfma_f32_16x16x32_bf16 a[248:251], a[196:199], a[56:59], a[248:251]
    v_add_u32 v80, s61, v80
    v_and_b32 v81, 1, v1
    v_mfma_f32_16x16x32_bf16 a[232:235], a[192:195], a[56:59], a[232:235]
    buffer_load_dwordx4 a[108:111], v28, s[20:23], s8 offen offset:3072 sc1
    v_mfma_f32_16x16x32_bf16 a[228:231], a[192:195], a[52:55], a[228:231]
pg_10:
    s_cbranch_execz pg_ret2
    s_add_u32 s8, s8, 4096
    ds_read_b64_tr_b16 a[212:213], v9 offset:13312
    v_lshlrev_b32 v81, 7, v81
    v_mfma_f32_16x16x32_bf16 a[244:247], a[196:199], a[52:55], a[244:247]
    s_add_u32 m0, s44, 147456
    ds_read_b64_tr_b16 a[214:215], v9 offset:19456
    v_lshrrev_b32 v83, 4, v1
    v_mfma_f32_16x16x32_bf16 a[240:243], a[196:199], a[48:51], a[240:243]
    v_lshl_add_u32 v81, v83, 4, v81
    v_add_u32 v81, s61, v81
    v_mfma_f32_16x16x32_bf16 a[224:227], a[192:195], a[48:51], a[224:227]
    s_waitcnt lgkmcnt(4)
    buffer_load_dwordx4 v6, s[28:31], s59 offen lds
    v_mfma_f32_16x16x32_bf16 v[68:71], a[200:203], a[48:51], v[68:71]
    s_add_u32 m0, s44, 148480
    ds_read_b64_tr_b16 a[192:193], v10 offset:13312
    v_bfe_u32 v83, v1, 2, 3
    v_mfma_f32_16x16x32_bf16 v[100:103], a[204:207], a[48:51], v[100:103]
    ds_read_b64_tr_b16 a[194:195], v10 offset:19456
    v_lshlrev_b32 v82, 7, v83
    v_mfma_f32_16x16x32_bf16 v[108:111], a[204:207], a[52:55], v[108:111]
    v_lshrrev_b32 v83, 1, v83
    v_xor_b32 v83, s3, v83
    v_mfma_f32_16x16x32_bf16 v[76:79], a[200:203], a[52:55], v[76:79]
    buffer_load_dwordx4 v7, s[28:31], s59 offen lds
    v_mfma_f32_16x16x32_bf16 v[84:87], a[200:203], a[56:59], v[84:87]
    ds_read_b64_tr_b16 a[196:197], v11 offset:13312
    v_lshlrev_b32 v16, 4, v16
    v_mfma_f32_16x16x32_bf16 v[116:119], a[204:207], a[56:59], v[116:119]
    s_waitcnt vmcnt(11)
    ds_read_b64_tr_b16 a[198:199], v11 offset:19456
    v_lshl_add_u32 v82, v83, 5, v82
    v_mfma_f32_16x16x32_bf16 v[124:127], a[204:207], a[60:63], v[124:127]
    buffer_atomic_or v16, v17, s[24:27], 0 offen
    v_mfma_f32_16x16x32_bf16 v[92:95], a[200:203], a[60:63], v[92:95]
    s_waitcnt lgkmcnt(4)
    v_and_b32 v83, 3, v1
    v_lshl_add_u32 v82, v83, 3, v82
    v_mfma_f32_16x16x32_bf16 v[156:159], a[208:211], a[60:63], v[156:159]
    ds_read_b64_tr_b16 a[200:201], v18 offset:14336
    v_lshrrev_b32 v83, 5, v1
    v_mfma_f32_16x16x32_bf16 v[188:191], a[212:215], a[60:63], v[188:191]
    ds_read_b64_tr_b16 a[202:203], v18 offset:20480
    v_mul_u32_u24 v83, 1024, v83
    v_mfma_f32_16x16x32_bf16 v[180:183], a[212:215], a[56:59], v[180:183]
    buffer_load_dwordx4 a[112:115], v28, s[20:23], s9 offen offset:0 sc1
    v_mfma_f32_16x16x32_bf16 v[148:151], a[208:211], a[56:59], v[148:151]
    v_add_u32 v82, v82, v83
    v_add_u32 v82, 147456, v82
    v_mfma_f32_16x16x32_bf16 v[140:143], a[208:211], a[52:55], v[140:143]
    ds_read_b64_tr_b16 a[204:205], v19 offset:14336
    v_lshlrev_b32 v74, 2, v1
    v_mfma_f32_16x16x32_bf16 v[172:175], a[212:215], a[52:55], v[172:175]
    s_waitcnt vmcnt(63)
    ds_read_b64_tr_b16 a[206:207], v19 offset:20480
    v_cmp_gt_u32 vcc, 16, v1
    v_mfma_f32_16x16x32_bf16 v[164:167], a[212:215], a[48:51], v[164:167]
    s_barrier
    v_mfma_f32_16x16x32_bf16 v[132:135], a[208:211], a[48:51], v[132:135]
    s_waitcnt lgkmcnt(4)
    buffer_load_dwordx4 a[116:119], v28, s[20:23], s9 offen offset:1024 sc1
    v_add_u32 v8, 98304, v12
    v_mfma_f32_16x16x32_bf16 v[196:199], a[192:195], a[48:51], v[196:199]
    s_load_dword s72, s[86:87], s5 offset:4 glc
    ds_read_b64_tr_b16 a[208:209], v8 offset:0
    v_mov_b32 v83, 0x7ffffff0
    v_mfma_f32_16x16x32_bf16 v[228:231], a[196:199], a[48:51], v[228:231]
    ds_read_b64_tr_b16 a[210:211], v8 offset:6144
    v_cndmask_b32 v74, v83, v74, vcc
    v_mfma_f32_16x16x32_bf16 v[236:239], a[196:199], a[52:55], v[236:239]
    buffer_load_dwordx4 a[120:123], v28, s[20:23], s9 offen offset:2048 sc1
    v_mfma_f32_16x16x32_bf16 v[204:207], a[192:195], a[52:55], v[204:207]
    v_cndmask_b32 v192, v192, v193, s[78:79]
    v_mov_b32 v193, s43
    v_add_u32 v9, 98304, v13
    v_mfma_f32_16x16x32_bf16 v[212:215], a[192:195], a[56:59], v[212:215]
    ds_read_b64_tr_b16 a[212:213], v9 offset:0
    v_cmp_lt_u32 s[78:79], 1, v194
    v_mfma_f32_16x16x32_bf16 v[244:247], a[196:199], a[56:59], v[244:247]
    ds_read_b64_tr_b16 a[214:215], v9 offset:6144
    v_cndmask_b32 v192, v192, v193, s[78:79]
    v_mfma_f32_16x16x32_bf16 v[252:255], a[196:199], a[60:63], v[252:255]
    buffer_load_dwordx4 a[124:127], v28, s[20:23], s9 offen offset:3072 sc1
    v_mfma_f32_16x16x32_bf16 v[220:223], a[192:195], a[60:63], v[220:223]
    s_waitcnt lgkmcnt(4)
    v_and_b32 v193, 7, v1
    v_lshl_add_u32 v192, v193, 3, v192
    v_add_u32 v10, 98304, v14
    v_mfma_f32_16x16x32_bf16 v[44:47], a[200:203], a[60:63], v[44:47]
    s_add_u32 s9, s9, 4096
    ds_read_b64_tr_b16 a[192:193], v10 offset:0
    v_and_b32 v194, 0x7ff, v195
    v_mfma_f32_16x16x32_bf16 v[60:63], a[204:207], a[60:63], v[60:63]
    ds_read_b64_tr_b16 a[194:195], v10 offset:6144
    v_sub_u32 v194, 2047, v194
    v_mfma_f32_16x16x32_bf16 v[56:59], a[204:207], a[56:59], v[56:59]
    buffer_load_dwordx4 a[128:131], v28, s[20:23], s10 offen offset:0 sc1
    v_mfma_f32_16x16x32_bf16 v[40:43], a[200:203], a[56:59], v[40:43]
    v_mul_u32_u24 v193, 1280, v194
    v_add_u32 v193, v193, v192
    v_add_u32 v11, 98304, v15
    v_mfma_f32_16x16x32_bf16 v[36:39], a[200:203], a[52:55], v[36:39]
    ds_read_b64_tr_b16 a[196:197], v11 offset:0
    v_lshlrev_b32 v194, 3, v194
    v_mfma_f32_16x16x32_bf16 v[52:55], a[204:207], a[52:55], v[52:55]
    s_waitcnt vmcnt(16)
    ds_read_b64_tr_b16 a[198:199], v11 offset:6144
    v_add_u32 v194, 3211264, v194
    v_mfma_f32_16x16x32_bf16 v[48:51], a[204:207], a[48:51], v[48:51]
    v_xor_b32 v18, s39, v8
    v_xor_b32 v19, s39, v9
    v_mfma_f32_16x16x32_bf16 v[32:35], a[200:203], a[48:51], v[32:35]
    s_waitcnt lgkmcnt(4)
    buffer_load_dwordx4 a[132:135], v28, s[20:23], s10 offen offset:1024 sc1
    v_mfma_f32_16x16x32_bf16 a[224:227], a[208:211], a[64:67], a[224:227]
    ds_read_b64_tr_b16 a[200:201], v8 offset:1024
    v_mfma_f32_16x16x32_bf16 a[240:243], a[212:215], a[64:67], a[240:243]
    ds_read_b64_tr_b16 a[202:203], v8 offset:7168
    v_mfma_f32_16x16x32_bf16 a[244:247], a[212:215], a[68:71], a[244:247]
    v_mfma_f32_16x16x32_bf16 a[228:231], a[208:211], a[68:71], a[228:231]
    buffer_load_dwordx4 a[136:139], v28, s[20:23], s10 offen offset:2048 sc1
    v_mfma_f32_16x16x32_bf16 a[232:235], a[208:211], a[72:75], a[232:235]
    s_lshr_b32 s55, s54, 1
    ds_read_b64_tr_b16 a[204:205], v9 offset:1024
    v_bfe_u32 v224, v1, 3, 1
    v_mfma_f32_16x16x32_bf16 a[248:251], a[212:215], a[72:75], a[248:251]
    s_lshl_b32 s55, s55, 19
    ds_read_b64_tr_b16 a[206:207], v9 offset:7168
    v_bfe_u32 v225, v1, 4, 1
    v_mfma_f32_16x16x32_bf16 a[252:255], a[212:215], a[76:79], a[252:255]
    s_and_b32 s60, s54, 1
    v_xor_b32 v224, v224, v225
    v_and_b32 v225, 1, v1
    v_mfma_f32_16x16x32_bf16 a[236:239], a[208:211], a[76:79], a[236:239]
    s_waitcnt lgkmcnt(4)
    buffer_load_dwordx4 a[140:143], v28, s[20:23], s10 offen offset:3072 sc1
    v_mfma_f32_16x16x32_bf16 v[92:95], a[192:195], a[76:79], v[92:95]
    s_add_u32 s10, s10, 4096
    ds_read_b64_tr_b16 a[208:209], v10 offset:1024
    v_lshlrev_b32 v225, 4, v225
    v_mfma_f32_16x16x32_bf16 v[124:127], a[196:199], a[76:79], v[124:127]
    s_lshl_b32 s60, s60, 12
    ds_read_b64_tr_b16 a[210:211], v10 offset:7168
    v_mov_b32 v226, 0x3c80
    v_mfma_f32_16x16x32_bf16 v[116:119], a[196:199], a[72:75], v[116:119]
    s_or_b32 s55, s55, s60
    v_lshlrev_b32 v225, v225, v226
    v_bfe_u32 v226, v1, 1, 2
    v_mfma_f32_16x16x32_bf16 v[84:87], a[192:195], a[72:75], v[84:87]
    s_lshl_b32 s60, s54, 10
    v_lshl_add_u32 v226, v224, 2, v226
    v_cmp_eq_u32 s[74:75], 0, v226
    v_mfma_f32_16x16x32_bf16 v[76:79], a[192:195], a[68:71], v[76:79]
    s_and_b32 s60, s60, 0x2000
    ds_read_b64_tr_b16 a[212:213], v11 offset:1024
    v_cndmask_b32 v208, 0, v225, s[74:75]
    v_mfma_f32_16x16x32_bf16 v[108:111], a[196:199], a[68:71], v[108:111]
    s_or_b32 s55, s55, s60
    ds_read_b64_tr_b16 a[214:215], v11 offset:7168
    v_cmp_eq_u32 s[74:75], 1, v226
    v_mfma_f32_16x16x32_bf16 v[100:103], a[196:199], a[64:67], v[100:103]
    s_or_b32 s55, s55, 134217728
    v_cndmask_b32 v209, 0, v225, s[74:75]
    v_cmp_eq_u32 s[74:75], 2, v226
    v_mfma_f32_16x16x32_bf16 v[68:71], a[192:195], a[64:67], v[68:71]
    s_waitcnt lgkmcnt(4)
    v_cndmask_b32 v210, 0, v225, s[74:75]
    v_cmp_eq_u32 s[74:75], 3, v226
    v_mfma_f32_16x16x32_bf16 v[132:135], a[200:203], a[64:67], v[132:135]
    s_mul_i32 s60, s51, 81920
    ds_read_b64_tr_b16 a[192:193], v18 offset:2048
    v_cndmask_b32 v211, 0, v225, s[74:75]
    v_mfma_f32_16x16x32_bf16 v[164:167], a[204:207], a[64:67], v[164:167]
    s_add_u32 s55, s55, s60
    ds_read_b64_tr_b16 a[194:195], v18 offset:8192
    s_mul_i32 s60, s53, 8389632
    v_mfma_f32_16x16x32_bf16 v[172:175], a[204:207], a[68:71], v[172:175]
    s_bfe_u32 s88, s72, 262156
    s_cmp_lg_u32 s88, 15
    s_cbranch_scc1 spin_o3
spin_o3_ret:
    s_xor_b32 s55, s55, s60
    v_mfma_f32_16x16x32_bf16 v[140:143], a[200:203], a[68:71], v[140:143]
    s_add_u32 s60, s51, 8
    s_lshr_b32 s60, s93, s60
    s_and_b32 s60, s60, 0x2000
    v_mfma_f32_16x16x32_bf16 v[148:151], a[200:203], a[72:75], v[148:151]
    s_xor_b32 s55, s55, s60
    ds_read_b64_tr_b16 a[196:197], v19 offset:2048
    v_mfma_f32_16x16x32_bf16 v[180:183], a[204:207], a[72:75], v[180:183]
    ds_read_b64_tr_b16 a[198:199], v19 offset:8192
    v_mfma_f32_16x16x32_bf16 v[188:191], a[204:207], a[76:79], v[188:191]
    buffer_load_dwordx4 a[144:147], v28, s[20:23], s8 offen offset:0 sc1
    v_mfma_f32_16x16x32_bf16 v[156:159], a[200:203], a[76:79], v[156:159]
    s_waitcnt lgkmcnt(4)
    v_mfma_f32_16x16x32_bf16 v[220:223], a[208:211], a[76:79], v[220:223]
    ds_read_b64_tr_b16 a[200:201], v8 offset:12288
    v_mfma_f32_16x16x32_bf16 v[252:255], a[212:215], a[76:79], v[252:255]
    ds_read_b64_tr_b16 a[202:203], v8 offset:18432
    v_mfma_f32_16x16x32_bf16 v[244:247], a[212:215], a[72:75], v[244:247]
    buffer_load_dwordx2 v[24:25], v23, s[24:27], 0 offen sc1
    v_mfma_f32_16x16x32_bf16 v[212:215], a[208:211], a[72:75], v[212:215]
    buffer_load_dwordx4 a[148:151], v28, s[20:23], s8 offen offset:1024 sc1
    v_mfma_f32_16x16x32_bf16 v[204:207], a[208:211], a[68:71], v[204:207]
    ds_read_b64_tr_b16 a[204:205], v9 offset:12288
    v_mfma_f32_16x16x32_bf16 v[236:239], a[212:215], a[68:71], v[236:239]
    ds_read_b64_tr_b16 a[206:207], v9 offset:18432
    v_mfma_f32_16x16x32_bf16 v[228:231], a[212:215], a[64:67], v[228:231]
    buffer_load_dwordx2 v[200:201], v193, s[16:19], 0 offen
    v_mfma_f32_16x16x32_bf16 v[196:199], a[208:211], a[64:67], v[196:199]
    s_waitcnt lgkmcnt(4)
    buffer_load_dwordx4 a[152:155], v28, s[20:23], s8 offen offset:2048 sc1
    v_mfma_f32_16x16x32_bf16 v[32:35], a[192:195], a[64:67], v[32:35]
    ds_read_b64_tr_b16 a[208:209], v10 offset:12288
    v_mfma_f32_16x16x32_bf16 v[48:51], a[196:199], a[64:67], v[48:51]
    ds_read_b64_tr_b16 a[210:211], v10 offset:18432
    v_mfma_f32_16x16x32_bf16 v[52:55], a[196:199], a[68:71], v[52:55]
    buffer_load_dwordx2 v[202:203], v194, s[24:27], 0 offen sc1
    v_mfma_f32_16x16x32_bf16 v[36:39], a[192:195], a[68:71], v[36:39]
    buffer_load_dwordx4 a[156:159], v28, s[20:23], s8 offen offset:3072 sc1
    v_mfma_f32_16x16x32_bf16 v[40:43], a[192:195], a[72:75], v[40:43]
    s_add_u32 s8, s8, 12288
    ds_read_b64_tr_b16 a[212:213], v11 offset:12288
    v_mfma_f32_16x16x32_bf16 v[56:59], a[196:199], a[72:75], v[56:59]
    s_waitcnt vmcnt(22)
    ds_read_b64_tr_b16 a[214:215], v11 offset:18432
    v_mfma_f32_16x16x32_bf16 v[60:63], a[196:199], a[76:79], v[60:63]
    v_mfma_f32_16x16x32_bf16 v[44:47], a[192:195], a[76:79], v[44:47]
    s_waitcnt lgkmcnt(4)
    v_mfma_f32_16x16x32_bf16 a[236:239], a[200:203], a[92:95], a[236:239]
    ds_read_b64_tr_b16 a[192:193], v8 offset:13312
    v_mfma_f32_16x16x32_bf16 a[252:255], a[204:207], a[92:95], a[252:255]
    ds_read_b64_tr_b16 a[194:195], v8 offset:19456
    v_mfma_f32_16x16x32_bf16 a[248:251], a[204:207], a[88:91], a[248:251]
    v_add_u32 v8, 49152, v12
    v_mfma_f32_16x16x32_bf16 a[232:235], a[200:203], a[88:91], a[232:235]
    v_mfma_f32_16x16x32_bf16 a[228:231], a[200:203], a[84:87], a[228:231]
    ds_read_b64_tr_b16 a[196:197], v9 offset:13312
    v_lshrrev_b32 v136, 5, v192
    v_mfma_f32_16x16x32_bf16 a[244:247], a[204:207], a[84:87], a[244:247]
    ds_read_b64_tr_b16 a[198:199], v9 offset:19456
    v_lshlrev_b32 v136, 9, v136
    v_mfma_f32_16x16x32_bf16 a[240:243], a[204:207], a[80:83], a[240:243]
    v_and_b32 v192, 31, v192
    v_lshl_add_u32 v192, v192, 1, v136
    v_mfma_f32_16x16x32_bf16 a[224:227], a[200:203], a[80:83], a[224:227]
    s_waitcnt lgkmcnt(4)
    v_lshrrev_b32 v193, 5, v1
    v_lshl_add_u32 v192, v193, 8, v192
    v_mfma_f32_16x16x32_bf16 v[68:71], a[208:211], a[80:83], v[68:71]
    ds_read_b64_tr_b16 a[200:201], v10 offset:13312
    v_and_b32 v195, 0xffff0000, v195
    v_mfma_f32_16x16x32_bf16 v[100:103], a[212:215], a[80:83], v[100:103]
    ds_read_b64_tr_b16 a[202:203], v10 offset:19456
    v_ashrrev_i32 v193, 31, v195
    v_mfma_f32_16x16x32_bf16 v[108:111], a[212:215], a[84:87], v[108:111]
    buffer_load_dwordx4 a[160:163], v28, s[20:23], s9 offen offset:0 sc1
    v_mfma_f32_16x16x32_bf16 v[76:79], a[208:211], a[84:87], v[76:79]
    v_not_b32 v193, v193
    v_or_b32 v193, 0x80000000, v193
    v_mfma_f32_16x16x32_bf16 v[84:87], a[208:211], a[88:91], v[84:87]
    ds_read_b64_tr_b16 a[204:205], v11 offset:13312
    v_xor_b32 v195, v195, v193
    v_mfma_f32_16x16x32_bf16 v[116:119], a[212:215], a[88:91], v[116:119]
    ds_read_b64_tr_b16 a[206:207], v11 offset:19456
    v_and_b32 v195, 0xffff0000, v195
    v_mfma_f32_16x16x32_bf16 v[124:127], a[212:215], a[92:95], v[124:127]
    buffer_load_dwordx4 a[164:167], v28, s[20:23], s9 offen offset:1024 sc1
    v_mfma_f32_16x16x32_bf16 v[92:95], a[208:211], a[92:95], v[92:95]
    s_waitcnt lgkmcnt(4)
    v_mul_f32 v195, s92, v195
    v_add_u32 v9, 49152, v13
    v_mfma_f32_16x16x32_bf16 v[156:159], a[192:195], a[92:95], v[156:159]
    s_load_dword s72, s[86:87], s5 offset:4 glc
    ds_read_b64_tr_b16 a[208:209], v18 offset:14336
    v_add_u32 v10, 49152, v14
    v_mfma_f32_16x16x32_bf16 v[188:191], a[196:199], a[92:95], v[188:191]
    ds_read_b64_tr_b16 a[210:211], v18 offset:20480
    v_add_u32 v11, 49152, v15
    v_mfma_f32_16x16x32_bf16 v[180:183], a[196:199], a[88:91], v[180:183]
    buffer_load_dwordx4 a[168:171], v28, s[20:23], s9 offen offset:2048 sc1
    v_mfma_f32_16x16x32_bf16 v[148:151], a[192:195], a[88:91], v[148:151]
    v_exp_f32 v195, v195
    v_mfma_f32_16x16x32_bf16 v[140:143], a[192:195], a[84:87], v[140:143]
    ds_read_b64_tr_b16 a[212:213], v19 offset:14336
    v_add_f32 v195, 1.0, v195
    v_mfma_f32_16x16x32_bf16 v[172:175], a[196:199], a[84:87], v[172:175]
    s_waitcnt vmcnt(19)
    ds_read_b64_tr_b16 a[214:215], v19 offset:20480
    v_xor_b32 v18, s39, v8
    v_mfma_f32_16x16x32_bf16 v[164:167], a[196:199], a[80:83], v[164:167]
    s_barrier
    v_mfma_f32_16x16x32_bf16 v[132:135], a[192:195], a[80:83], v[132:135]
    s_waitcnt lgkmcnt(4)
    buffer_load_dwordx4 a[172:175], v28, s[20:23], s9 offen offset:3072 sc1
    v_mfma_f32_16x16x32_bf16 v[196:199], a[200:203], a[80:83], v[196:199]
    s_add_u32 s9, s9, 12288
    ds_read_b64_tr_b16 a[192:193], v8 offset:0
    v_xor_b32 v19, s39, v9
    v_mfma_f32_16x16x32_bf16 v[228:231], a[204:207], a[80:83], v[228:231]
    ds_read_b64_tr_b16 a[194:195], v8 offset:6144
    v_mfma_f32_16x16x32_bf16 v[236:239], a[204:207], a[84:87], v[236:239]
    buffer_load_dwordx4 a[176:179], v28, s[20:23], s10 offen offset:0 sc1
    v_mfma_f32_16x16x32_bf16 v[204:207], a[200:203], a[84:87], v[204:207]
    v_rcp_f32 v195, v195
    v_mfma_f32_16x16x32_bf16 v[212:215], a[200:203], a[88:91], v[212:215]
    ds_read_b64_tr_b16 a[196:197], v9 offset:0
    v_cvt_pk_bf16_f32 v195, v195, v195
    v_mfma_f32_16x16x32_bf16 v[244:247], a[204:207], a[88:91], v[244:247]
    ds_read_b64_tr_b16 a[198:199], v9 offset:6144
    v_and_b32 v195, 0xffff0000, v195
    v_mfma_f32_16x16x32_bf16 v[252:255], a[204:207], a[92:95], v[252:255]
    ds_write_b16 v80, v64
    v_mfma_f32_16x16x32_bf16 v[220:223], a[200:203], a[92:95], v[220:223]
    s_waitcnt lgkmcnt(4)
    ds_write_b16_d16_hi v80, v64 offset:128
    v_mfma_f32_16x16x32_bf16 v[44:47], a[208:211], a[92:95], v[44:47]
    ds_read_b64_tr_b16 a[200:201], v10 offset:0
    v_mfma_f32_16x16x32_bf16 v[60:63], a[212:215], a[92:95], v[60:63]
    ds_read_b64_tr_b16 a[202:203], v10 offset:6144
    v_mfma_f32_16x16x32_bf16 v[56:59], a[212:215], a[88:91], v[56:59]
    ds_read_b128 v[88:91], v81
    v_mfma_f32_16x16x32_bf16 v[40:43], a[208:211], a[88:91], v[40:43]
    buffer_load_dwordx4 a[180:183], v28, s[20:23], s10 offen offset:1024 sc1
    v_mfma_f32_16x16x32_bf16 v[36:39], a[208:211], a[84:87], v[36:39]
    ds_read_b64_tr_b16 a[204:205], v11 offset:0
    v_mfma_f32_16x16x32_bf16 v[52:55], a[212:215], a[84:87], v[52:55]
    s_waitcnt vmcnt(24)
    ds_read_b64_tr_b16 a[206:207], v11 offset:6144
    v_mfma_f32_16x16x32_bf16 v[48:51], a[212:215], a[80:83], v[48:51]
    ds_read_b128 v[96:99], v81 offset:64
    v_mfma_f32_16x16x32_bf16 v[32:35], a[208:211], a[80:83], v[32:35]
    s_waitcnt lgkmcnt(4)
    ds_read_b64_tr_b16 v[104:105], v82
    v_mfma_f32_16x16x32_bf16 a[224:227], a[192:195], a[96:99], a[224:227]
    ds_read_b64_tr_b16 a[208:209], v8 offset:1024
    v_mfma_f32_16x16x32_bf16 a[240:243], a[196:199], a[96:99], a[240:243]
    ds_read_b64_tr_b16 a[210:211], v8 offset:7168
    v_mfma_f32_16x16x32_bf16 a[244:247], a[196:199], a[100:103], a[244:247]
    ds_read_b64_tr_b16 v[106:107], v82 offset:2048
    v_mfma_f32_16x16x32_bf16 a[228:231], a[192:195], a[100:103], a[228:231]
    buffer_load_dwordx4 a[184:187], v28, s[20:23], s10 offen offset:2048 sc1
    v_mfma_f32_16x16x32_bf16 a[232:235], a[192:195], a[104:107], a[232:235]
    s_lshl1_add_u32 m0, s36, 81920
    ds_read_b64_tr_b16 a[212:213], v9 offset:1024
    s_add_u32 s38, s34, 122880
    v_mfma_f32_16x16x32_bf16 a[248:251], a[196:199], a[104:107], a[248:251]
    s_add_u32 s57, s35, 122880
    ds_read_b64_tr_b16 a[214:215], v9 offset:7168
    s_cmp_lt_u32 s3, 2
    s_cselect_b32 s38, s38, s57
    v_mfma_f32_16x16x32_bf16 a[252:255], a[196:199], a[108:111], a[252:255]
    s_waitcnt vmcnt(8)
    ds_read_b64_tr_b16 v[112:113], v82 offset:4096
    v_lshlrev_b32 v248, 16, v200
    v_mfma_f32_16x16x32_bf16 a[236:239], a[192:195], a[108:111], a[236:239]
    s_waitcnt lgkmcnt(4)
    ds_read_b64_tr_b16 v[114:115], v82 offset:6144
    v_and_b32 v249, 0xffff0000, v200
    v_mfma_f32_16x16x32_bf16 v[92:95], a[200:203], a[108:111], v[92:95]
    ds_read_b64_tr_b16 a[192:193], v10 offset:1024
    v_sub_f32 v248, v248, v202
    v_mfma_f32_16x16x32_bf16 v[124:127], a[204:207], a[108:111], v[124:127]
    ds_read_b64_tr_b16 a[194:195], v10 offset:7168
    v_sub_f32 v249, v249, v202
    v_mfma_f32_16x16x32_bf16 v[116:119], a[204:207], a[104:107], v[116:119]
    s_bfe_u32 s88, s72, 262160
    s_cmp_lg_u32 s88, 15
    s_cbranch_scc1 spin_o4
spin_o4_ret:
    v_cvt_pk_bf16_f32 v193, v248, v249
    v_mfma_f32_16x16x32_bf16 v[84:87], a[200:203], a[104:107], v[84:87]
    buffer_load_dwordx4 v4, s[12:15], s38 offen lds
    v_mfma_f32_16x16x32_bf16 v[76:79], a[200:203], a[100:103], v[76:79]
    s_lshl1_add_u32 m0, s36, 82944
    ds_read_b64_tr_b16 a[196:197], v11 offset:1024
    v_lshlrev_b32 v248, 16, v193
    v_mfma_f32_16x16x32_bf16 v[108:111], a[204:207], a[100:103], v[108:111]
    ds_read_b64_tr_b16 a[198:199], v11 offset:7168
    v_and_b32 v249, 0xffff0000, v193
    v_mfma_f32_16x16x32_bf16 v[100:103], a[204:207], a[96:99], v[100:103]
    buffer_load_dwordx4 a[0:3], v28, s[20:23], s8 offen offset:0 sc1
    v_mfma_f32_16x16x32_bf16 v[68:71], a[200:203], a[96:99], v[68:71]
    s_waitcnt lgkmcnt(4)
    v_mul_f32 v248, v248, v203
    v_mul_f32 v249, v249, v203
    v_mfma_f32_16x16x32_bf16 v[132:135], a[208:211], a[96:99], v[132:135]
    ds_read_b64_tr_b16 a[200:201], v18 offset:2048
    v_cvt_pk_bf16_f32 v193, v248, v249
    v_mfma_f32_16x16x32_bf16 v[164:167], a[212:215], a[96:99], v[164:167]
    ds_read_b64_tr_b16 a[202:203], v18 offset:8192
    v_lshlrev_b32 v248, 16, v193
    v_mfma_f32_16x16x32_bf16 v[172:175], a[212:215], a[100:103], v[172:175]
    buffer_load_dwordx4 a[4:7], v28, s[20:23], s8 offen offset:1024 sc1
    v_mfma_f32_16x16x32_bf16 v[140:143], a[208:211], a[100:103], v[140:143]
    v_and_b32 v249, 0xffff0000, v193
    v_lshlrev_b32 v250, 16, v201
    v_mfma_f32_16x16x32_bf16 v[148:151], a[208:211], a[104:107], v[148:151]
    ds_read_b64_tr_b16 a[204:205], v19 offset:2048
    v_and_b32 v251, 0xffff0000, v201
    v_mfma_f32_16x16x32_bf16 v[180:183], a[212:215], a[104:107], v[180:183]
    ds_read_b64_tr_b16 a[206:207], v19 offset:8192
    v_sub_f32 v250, v250, v202
    v_mfma_f32_16x16x32_bf16 v[188:191], a[212:215], a[108:111], v[188:191]
    v_mfma_f32_16x16x32_bf16 v[120:123], v[88:91], v[104:107], 0
    v_mfma_f32_16x16x32_bf16 v[120:123], v[96:99], v[112:115], v[120:123]
    v_mfma_f32_16x16x32_bf16 v[156:159], a[208:211], a[108:111], v[156:159]
    s_waitcnt lgkmcnt(4)
    buffer_load_dwordx4 a[8:11], v28, s[20:23], s8 offen offset:2048 sc1
    v_mfma_f32_16x16x32_bf16 v[220:223], a[192:195], a[108:111], v[220:223]
    ds_read_b64_tr_b16 a[208:209], v8 offset:12288
    v_sub_f32 v251, v251, v202
    v_mfma_f32_16x16x32_bf16 v[252:255], a[196:199], a[108:111], v[252:255]
    ds_read_b64_tr_b16 a[210:211], v8 offset:18432
    v_cvt_pk_bf16_f32 v193, v250, v251
    v_mfma_f32_16x16x32_bf16 v[244:247], a[196:199], a[104:107], v[244:247]
    v_lshlrev_b32 v250, 16, v193
    v_and_b32 v251, 0xffff0000, v193
    v_mfma_f32_16x16x32_bf16 v[212:215], a[192:195], a[104:107], v[212:215]
    buffer_load_dwordx4 a[12:15], v28, s[20:23], s8 offen offset:3072 sc1
    v_mfma_f32_16x16x32_bf16 v[204:207], a[192:195], a[100:103], v[204:207]
    s_add_u32 s8, s8, 4096
    ds_read_b64_tr_b16 a[212:213], v9 offset:12288
    v_mul_f32 v250, v250, v203
    v_mfma_f32_16x16x32_bf16 v[236:239], a[196:199], a[100:103], v[236:239]
    ds_read_b64_tr_b16 a[214:215], v9 offset:18432
    v_mul_f32 v251, v251, v203
    v_mfma_f32_16x16x32_bf16 v[228:231], a[196:199], a[96:99], v[228:231]
    buffer_atomic_add_f32 v120, v74, s[24:27], s62 offen
    v_mfma_f32_16x16x32_bf16 v[196:199], a[192:195], a[96:99], v[196:199]
    s_waitcnt lgkmcnt(4)
    buffer_load_dwordx4 v5, s[12:15], s38 offen lds
    v_mfma_f32_16x16x32_bf16 v[32:35], a[200:203], a[96:99], v[32:35]
    s_lshl1_add_u32 m0, s36, 90112
    ds_read_b64_tr_b16 a[192:193], v10 offset:12288
    v_cvt_pk_bf16_f32 v193, v250, v251
    v_mfma_f32_16x16x32_bf16 v[48:51], a[204:207], a[96:99], v[48:51]
    s_add_u32 s38, s33, 163840
    ds_read_b64_tr_b16 a[194:195], v10 offset:18432
    v_lshlrev_b32 v250, 16, v193
    v_mfma_f32_16x16x32_bf16 v[52:55], a[204:207], a[100:103], v[52:55]
    buffer_atomic_add_f32 v121, v74, s[24:27], s62 offen offset:256
    v_mfma_f32_16x16x32_bf16 v[36:39], a[200:203], a[100:103], v[36:39]
    buffer_load_dwordx4 a[188:191], v28, s[20:23], s10 offen offset:3072 sc1
    v_mfma_f32_16x16x32_bf16 v[40:43], a[200:203], a[104:107], v[40:43]
    s_add_u32 s57, s34, 163840
    ds_read_b64_tr_b16 a[196:197], v11 offset:12288
    v_and_b32 v251, 0xffff0000, v193
    v_mfma_f32_16x16x32_bf16 v[56:59], a[204:207], a[104:107], v[56:59]
    s_waitcnt vmcnt(27)
    ds_read_b64_tr_b16 a[198:199], v11 offset:18432
    v_mul_f32 v24, v24, -v25
    v_mfma_f32_16x16x32_bf16 v[60:63], a[204:207], a[108:111], v[60:63]
    s_cmp_lt_u32 s3, 2
    s_cselect_b32 s38, s38, s57
    v_lshrrev_b32 v233, 5, v1
    v_mfma_f32_16x16x32_bf16 v[44:47], a[200:203], a[108:111], v[44:47]
    s_waitcnt lgkmcnt(4)
    v_lshlrev_b32 v233, 11, v233
    v_sub_u32 v233, 81920, v233
    v_mfma_f32_16x16x32_bf16 a[236:239], a[208:211], a[124:127], a[236:239]
    s_add_u32 s10, s10, 12288
    ds_read_b64_tr_b16 a[200:201], v8 offset:13312
    v_mov_b32 v122, 1
    v_mfma_f32_16x16x32_bf16 a[252:255], a[212:215], a[124:127], a[252:255]
    ds_read_b64_tr_b16 a[202:203], v8 offset:19456
    v_min_u32 v123, 1, v1
    v_mfma_f32_16x16x32_bf16 a[248:251], a[212:215], a[120:123], a[248:251]
    buffer_load_dwordx4 v4, s[12:15], s38 offen lds
    v_mfma_f32_16x16x32_bf16 a[232:235], a[208:211], a[120:123], a[232:235]
    s_lshl1_add_u32 m0, s36, 91136
    v_lshlrev_b32 v123, 30, v123
    v_add_u32 v8, 0, v12
    v_mfma_f32_16x16x32_bf16 a[228:231], a[208:211], a[116:119], a[228:231]
    ds_read_b64_tr_b16 a[204:205], v9 offset:13312
    v_mfma_f32_16x16x32_bf16 a[244:247], a[212:215], a[116:119], a[244:247]
    ds_read_b64_tr_b16 a[206:207], v9 offset:19456
    v_mfma_f32_16x16x32_bf16 a[240:243], a[212:215], a[112:115], a[240:243]
    buffer_load_dwordx4 v5, s[12:15], s38 offen lds
    v_mfma_f32_16x16x32_bf16 a[224:227], a[208:211], a[112:115], a[224:227]
    s_waitcnt lgkmcnt(4)
    v_add_u32 v9, 0, v13
    s_lshl1_add_u32 m0, s36, 98304
    v_mfma_f32_16x16x32_bf16 v[68:71], a[192:195], a[112:115], v[68:71]
    s_add_u32 s38, s35, 163840
    ds_read_b64_tr_b16 a[208:209], v10 offset:13312
    s_add_u32 s57, s33, 204800
    v_mfma_f32_16x16x32_bf16 v[100:103], a[196:199], a[112:115], v[100:103]
    s_cmp_lt_u32 s3, 2
    s_cselect_b32 s38, s38, s57
    ds_read_b64_tr_b16 a[210:211], v10 offset:19456
    v_mfma_f32_16x16x32_bf16 v[108:111], a[196:199], a[116:119], v[108:111]
    buffer_load_dwordx4 v4, s[12:15], s38 offen lds
    v_mfma_f32_16x16x32_bf16 v[76:79], a[192:195], a[116:119], v[76:79]
    s_lshl1_add_u32 m0, s36, 99328
    v_add_u32 v10, 0, v14
    s_load_dword s72, s[86:87], s5 offset:4 glc
    v_mfma_f32_16x16x32_bf16 v[84:87], a[192:195], a[120:123], v[84:87]
    ds_read_b64_tr_b16 a[212:213], v11 offset:13312
    v_mfma_f32_16x16x32_bf16 v[116:119], a[196:199], a[120:123], v[116:119]
    ds_read_b64_tr_b16 a[214:215], v11 offset:19456
    v_mfma_f32_16x16x32_bf16 v[124:127], a[196:199], a[124:127], v[124:127]
    buffer_load_dwordx4 v5, s[12:15], s38 offen lds
    v_mfma_f32_16x16x32_bf16 v[92:95], a[192:195], a[124:127], v[92:95]
    s_waitcnt lgkmcnt(4)
    v_add_u32 v11, 0, v15
    s_lshl1_add_u32 m0, s36, 106496
    v_mfma_f32_16x16x32_bf16 v[156:159], a[200:203], a[124:127], v[156:159]
    s_add_u32 s38, s34, 204800
    ds_read_b64_tr_b16 a[192:193], v18 offset:14336
    s_add_u32 s57, s35, 204800
    v_mfma_f32_16x16x32_bf16 v[188:191], a[204:207], a[124:127], v[188:191]
    s_cmp_lt_u32 s3, 2
    s_cselect_b32 s38, s38, s57
    ds_read_b64_tr_b16 a[194:195], v18 offset:20480
    v_mfma_f32_16x16x32_bf16 v[180:183], a[204:207], a[120:123], v[180:183]
    buffer_load_dwordx4 v4, s[12:15], s38 offen lds
    v_mfma_f32_16x16x32_bf16 v[148:151], a[200:203], a[120:123], v[148:151]
    v_xor_b32 v18, s39, v8
    v_mfma_f32_16x16x32_bf16 v[140:143], a[200:203], a[116:119], v[140:143]
    s_lshl1_add_u32 m0, s36, 107520
    ds_read_b64_tr_b16 a[196:197], v19 offset:14336
    v_add_f32 v68, -0.5, v68
    v_mfma_f32_16x16x32_bf16 v[172:175], a[204:207], a[116:119], v[172:175]
    s_waitcnt vmcnt(63)
    ds_read_b64_tr_b16 a[198:199], v19 offset:20480
    v_add_f32 v69, -0.5, v69
    v_mfma_f32_16x16x32_bf16 v[164:167], a[204:207], a[112:115], v[164:167]
    s_barrier
    v_mfma_f32_16x16x32_bf16 v[132:135], a[200:203], a[112:115], v[132:135]
    s_waitcnt lgkmcnt(4)
    buffer_load_dwordx4 a[16:19], v28, s[20:23], s9 offen offset:0 sc1
    v_mfma_f32_16x16x32_bf16 v[196:199], a[208:211], a[112:115], v[196:199]
    ds_read_b64_tr_b16 a[200:201], v8 offset:0
    v_add_f32 v70, -0.5, v70
    v_mfma_f32_16x16x32_bf16 v[228:231], a[212:215], a[112:115], v[228:231]
    ds_read_b64_tr_b16 a[202:203], v8 offset:6144
    v_add_f32 v71, -0.5, v71
    v_mfma_f32_16x16x32_bf16 v[236:239], a[212:215], a[116:119], v[236:239]
    buffer_load_dwordx4 v5, s[12:15], s38 offen lds
    v_mfma_f32_16x16x32_bf16 v[204:207], a[208:211], a[116:119], v[204:207]
    v_add_f32 v100, -0.5, v100
    v_add_f32 v101, -0.5, v101
    v_mfma_f32_16x16x32_bf16 v[212:215], a[208:211], a[120:123], v[212:215]
    ds_read_b64_tr_b16 a[204:205], v9 offset:0
    v_add_f32 v102, -0.5, v102
    v_mfma_f32_16x16x32_bf16 v[244:247], a[212:215], a[120:123], v[244:247]
    ds_read_b64_tr_b16 a[206:207], v9 offset:6144
    v_add_f32 v103, -0.5, v103
    v_mfma_f32_16x16x32_bf16 v[252:255], a[212:215], a[124:127], v[252:255]
    v_add_f32 v76, -0.5, v76
    v_add_f32 v77, -0.5, v77
    v_mfma_f32_16x16x32_bf16 v[220:223], a[208:211], a[124:127], v[220:223]
    s_waitcnt lgkmcnt(4)
    buffer_load_dwordx4 a[20:23], v28, s[20:23], s9 offen offset:1024 sc1
    v_mfma_f32_16x16x32_bf16 v[44:47], a[192:195], a[124:127], v[44:47]
    ds_read_b64_tr_b16 a[208:209], v10 offset:0
    v_add_f32 v78, -0.5, v78
    v_mfma_f32_16x16x32_bf16 v[60:63], a[196:199], a[124:127], v[60:63]
    ds_read_b64_tr_b16 a[210:211], v10 offset:6144
    v_add_f32 v79, -0.5, v79
    v_mfma_f32_16x16x32_bf16 v[56:59], a[196:199], a[120:123], v[56:59]
    v_add_f32 v108, -0.5, v108
    v_add_f32 v109, -0.5, v109
    v_mfma_f32_16x16x32_bf16 v[40:43], a[192:195], a[120:123], v[40:43]
    buffer_load_dwordx4 a[24:27], v28, s[20:23], s9 offen offset:2048 sc1
    v_mfma_f32_16x16x32_bf16 v[36:39], a[192:195], a[116:119], v[36:39]
    ds_read_b64_tr_b16 a[212:213], v11 offset:0
    v_add_f32 v110, -0.5, v110
    v_mfma_f32_16x16x32_bf16 v[52:55], a[196:199], a[116:119], v[52:55]
    s_waitcnt vmcnt(32)
    ds_read_b64_tr_b16 a[214:215], v11 offset:6144
    v_add_f32 v111, -0.5, v111
    v_mfma_f32_16x16x32_bf16 v[48:51], a[196:199], a[112:115], v[48:51]
    v_add_f32 v84, -0.5, v84
    v_add_f32 v85, -0.5, v85
    v_mfma_f32_16x16x32_bf16 v[32:35], a[192:195], a[112:115], v[32:35]
    s_waitcnt lgkmcnt(4)
    buffer_load_dwordx4 a[28:31], v28, s[20:23], s9 offen offset:3072 sc1
    v_mfma_f32_16x16x32_bf16 a[224:227], a[200:203], a[128:131], a[224:227]
    s_add_u32 s9, s9, 4096
    ds_read_b64_tr_b16 a[192:193], v8 offset:1024
    v_add_f32 v86, -0.5, v86
    v_mfma_f32_16x16x32_bf16 a[240:243], a[204:207], a[128:131], a[240:243]
pg_11:
    s_cbranch_execz pg_ret2
    ds_read_b64_tr_b16 a[194:195], v8 offset:7168
    v_add_f32 v87, -0.5, v87
    v_mfma_f32_16x16x32_bf16 a[244:247], a[204:207], a[132:135], a[244:247]
    s_bfe_u32 s88, s72, 262164
    s_cmp_lg_u32 s88, 15
    s_cbranch_scc1 spin_o5
spin_o5_ret:
    v_add_f32 v116, -0.5, v116
    v_mfma_f32_16x16x32_bf16 a[228:231], a[200:203], a[132:135], a[228:231]
    buffer_load_dwordx4 a[32:35], v28, s[20:23], s10 offen offset:0 sc1
    v_mfma_f32_16x16x32_bf16 a[232:235], a[200:203], a[136:139], a[232:235]
    ds_read_b64_tr_b16 a[196:197], v9 offset:1024
    v_add_f32 v117, -0.5, v117
    v_mfma_f32_16x16x32_bf16 a[248:251], a[204:207], a[136:139], a[248:251]
    ds_read_b64_tr_b16 a[198:199], v9 offset:7168
    v_add_f32 v118, -0.5, v118
    v_add_f32 v119, -0.5, v119
    v_add_f32 v92, -0.5, v92
    v_add_f32 v93, -0.5, v93
    v_add_f32 v94, -0.5, v94
    v_add_f32 v95, -0.5, v95
    v_add_f32 v124, -0.5, v124
    v_add_f32 v125, -0.5, v125
    v_add_f32 v126, -0.5, v126
    v_add_f32 v127, -0.5, v127
    v_mfma_f32_16x16x32_bf16 a[252:255], a[204:207], a[140:143], a[252:255]
    v_xor_b32 v19, s39, v9
    v_mfma_f32_16x16x32_bf16 a[236:239], a[200:203], a[140:143], a[236:239]
    s_waitcnt lgkmcnt(4)
    v_mfma_f32_16x16x32_bf16 v[92:95], a[208:211], a[140:143], v[92:95]
    ds_read_b64_tr_b16 a[200:201], v10 offset:1024
    v_mfma_f32_16x16x32_bf16 v[124:127], a[212:215], a[140:143], v[124:127]
    ds_read_b64_tr_b16 a[202:203], v10 offset:7168
    v_mfma_f32_16x16x32_bf16 v[116:119], a[212:215], a[136:139], v[116:119]
    buffer_load_dwordx4 a[48:51], v28, s[20:23], s8 offen offset:0 sc1
    v_mfma_f32_16x16x32_bf16 v[84:87], a[208:211], a[136:139], v[84:87]
    v_mfma_f32_16x16x32_bf16 v[76:79], a[208:211], a[132:135], v[76:79]
    ds_read_b64_tr_b16 a[204:205], v11 offset:1024
    v_mfma_f32_16x16x32_bf16 v[108:111], a[212:215], a[132:135], v[108:111]
    ds_read_b64_tr_b16 a[206:207], v11 offset:7168
    v_mfma_f32_16x16x32_bf16 v[100:103], a[212:215], a[128:131], v[100:103]
    buffer_load_dwordx4 a[52:55], v28, s[20:23], s8 offen offset:1024 sc1
    v_mfma_f32_16x16x32_bf16 v[68:71], a[208:211], a[128:131], v[68:71]
    s_waitcnt lgkmcnt(4)
    v_mfma_f32_16x16x32_bf16 v[132:135], a[192:195], a[128:131], v[132:135]
    ds_read_b64_tr_b16 a[208:209], v18 offset:2048
    v_mfma_f32_16x16x32_bf16 v[164:167], a[196:199], a[128:131], v[164:167]
    ds_read_b64_tr_b16 a[210:211], v18 offset:8192
    v_mfma_f32_16x16x32_bf16 v[172:175], a[196:199], a[132:135], v[172:175]
    buffer_load_dwordx4 a[56:59], v28, s[20:23], s8 offen offset:2048 sc1
    v_mfma_f32_16x16x32_bf16 v[140:143], a[192:195], a[132:135], v[140:143]
    v_mfma_f32_16x16x32_bf16 v[148:151], a[192:195], a[136:139], v[148:151]
    ds_read_b64_tr_b16 a[212:213], v19 offset:2048
    v_mfma_f32_16x16x32_bf16 v[180:183], a[196:199], a[136:139], v[180:183]
    ds_read_b64_tr_b16 a[214:215], v19 offset:8192
    v_mfma_f32_16x16x32_bf16 v[188:191], a[196:199], a[140:143], v[188:191]
    buffer_load_dwordx4 a[60:63], v28, s[20:23], s8 offen offset:3072 sc1
    v_mfma_f32_16x16x32_bf16 v[156:159], a[192:195], a[140:143], v[156:159]
    s_waitcnt lgkmcnt(4)
    s_add_u32 s8, s8, 12288
    v_mfma_f32_16x16x32_bf16 v[220:223], a[200:203], a[140:143], v[220:223]
    ds_read_b64_tr_b16 a[192:193], v8 offset:12288
    v_mfma_f32_16x16x32_bf16 v[252:255], a[204:207], a[140:143], v[252:255]
    ds_read_b64_tr_b16 a[194:195], v8 offset:18432
    v_mfma_f32_16x16x32_bf16 v[244:247], a[204:207], a[136:139], v[244:247]
    buffer_load_dwordx4 a[36:39], v28, s[20:23], s10 offen offset:1024 sc1
    v_mfma_f32_16x16x32_bf16 v[212:215], a[200:203], a[136:139], v[212:215]
    v_mfma_f32_16x16x32_bf16 v[204:207], a[200:203], a[132:135], v[204:207]
    ds_read_b64_tr_b16 a[196:197], v9 offset:12288
    v_mfma_f32_16x16x32_bf16 v[236:239], a[204:207], a[132:135], v[236:239]
    ds_read_b64_tr_b16 a[198:199], v9 offset:18432
    v_mfma_f32_16x16x32_bf16 v[228:231], a[204:207], a[128:131], v[228:231]
    buffer_load_dwordx4 a[40:43], v28, s[20:23], s10 offen offset:2048 sc1
    v_mfma_f32_16x16x32_bf16 v[196:199], a[200:203], a[128:131], v[196:199]
    s_waitcnt lgkmcnt(4)
    v_mfma_f32_16x16x32_bf16 v[32:35], a[208:211], a[128:131], v[32:35]
    s_waitcnt vmcnt(18)
    ds_read_b64_tr_b16 a[200:201], v10 offset:12288
    v_mfma_f32_16x16x32_bf16 v[48:51], a[212:215], a[128:131], v[48:51]
    ds_read_b64_tr_b16 a[202:203], v10 offset:18432
    v_mfma_f32_16x16x32_bf16 v[52:55], a[212:215], a[132:135], v[52:55]
    buffer_atomic_add v122, v123, s[24:27], s62 offen offset:128
    v_mfma_f32_16x16x32_bf16 v[36:39], a[208:211], a[132:135], v[36:39]
    buffer_load_dwordx4 a[44:47], v28, s[20:23], s10 offen offset:3072 sc1
    v_mfma_f32_16x16x32_bf16 v[40:43], a[208:211], a[136:139], v[40:43]
    s_add_u32 s10, s10, 4096
    ds_read_b64_tr_b16 a[204:205], v11 offset:12288
    v_mfma_f32_16x16x32_bf16 v[56:59], a[212:215], a[136:139], v[56:59]
    s_waitcnt vmcnt(35)
    ds_read_b64_tr_b16 a[206:207], v11 offset:18432
    v_mfma_f32_16x16x32_bf16 v[60:63], a[212:215], a[140:143], v[60:63]
    v_mfma_f32_16x16x32_bf16 v[44:47], a[208:211], a[140:143], v[44:47]
    s_waitcnt lgkmcnt(4)
    buffer_load_dwordx4 a[64:67], v28, s[20:23], s9 offen offset:0 sc1
    v_mfma_f32_16x16x32_bf16 a[236:239], a[192:195], a[156:159], a[236:239]
    ds_read_b64_tr_b16 a[208:209], v8 offset:13312
    v_mfma_f32_16x16x32_bf16 a[252:255], a[196:199], a[156:159], a[252:255]
    ds_read_b64_tr_b16 a[210:211], v8 offset:19456
    v_mfma_f32_16x16x32_bf16 a[248:251], a[196:199], a[152:155], a[248:251]
    v_add_u32 v8, v233, v12
    v_mfma_f32_16x16x32_bf16 a[232:235], a[192:195], a[152:155], a[232:235]
    buffer_load_dwordx4 a[68:71], v28, s[20:23], s9 offen offset:1024 sc1
    v_mfma_f32_16x16x32_bf16 a[228:231], a[192:195], a[148:151], a[228:231]
    s_lshl_b32 s77, s3, 1
    s_add_u32 s77, s77, 0
    s_cmp_eq_u32 s77, s53
    s_cselect_b32 s77, 0x7ffffff0, 0
    ds_read_b64_tr_b16 a[212:213], v9 offset:13312
    v_mfma_f32_16x16x32_bf16 a[244:247], a[196:199], a[148:151], a[244:247]
    ds_read_b64_tr_b16 a[214:215], v9 offset:19456
    v_or_b32 v6, s77, v28
    v_mfma_f32_16x16x32_bf16 a[240:243], a[196:199], a[144:147], a[240:243]
    s_lshl_b32 s77, s3, 1
    v_add_u32 v9, v233, v13
    s_add_u32 s77, s77, 0
    v_mfma_f32_16x16x32_bf16 a[224:227], a[192:195], a[144:147], a[224:227]
    s_waitcnt lgkmcnt(4)
    buffer_load_dwordx4 a[72:75], v28, s[20:23], s9 offen offset:2048 sc1
    v_mfma_f32_16x16x32_bf16 v[68:71], a[200:203], a[144:147], v[68:71]
    s_lshr_b32 s77, s93, s77
    ds_read_b64_tr_b16 a[192:193], v10 offset:13312
    s_lshr_b32 s73, s93, s53
    v_mfma_f32_16x16x32_bf16 v[100:103], a[204:207], a[144:147], v[100:103]
    s_xor_b32 s77, s77, s73
    ds_read_b64_tr_b16 a[194:195], v10 offset:19456
    s_xor_b32 s77, s77, s55
    v_mfma_f32_16x16x32_bf16 v[108:111], a[204:207], a[148:151], v[108:111]
    s_and_b32 s77, s77, 0x2000
    v_or_b32 v6, s77, v6
    v_add_u32 v10, v233, v14
    v_mfma_f32_16x16x32_bf16 v[76:79], a[200:203], a[148:151], v[76:79]
    buffer_load_dwordx4 a[76:79], v28, s[20:23], s9 offen offset:3072 sc1
    v_mfma_f32_16x16x32_bf16 v[84:87], a[200:203], a[152:155], v[84:87]
    s_lshl1_add_u32 m0, s36, 114688
    ds_read_b64_tr_b16 a[196:197], v11 offset:13312
    s_add_u32 s38, s34, 123008
    v_mfma_f32_16x16x32_bf16 v[116:119], a[204:207], a[152:155], v[116:119]
    s_add_u32 s57, s35, 123008
    ds_read_b64_tr_b16 a[198:199], v11 offset:19456
    s_cmp_lt_u32 s3, 2
    s_cselect_b32 s38, s38, s57
    v_mfma_f32_16x16x32_bf16 v[124:127], a[204:207], a[156:159], v[124:127]
    s_add_u32 s9, s9, 12288
    v_add_u32 v11, v233, v15
    s_lshl_b32 s77, s3, 1
    s_add_u32 s77, s77, 1
    s_cmp_eq_u32 s77, s53
    s_cselect_b32 s77, 0x7ffffff0, 0
    v_mfma_f32_16x16x32_bf16 v[92:95], a[200:203], a[156:159], v[92:95]
    s_waitcnt lgkmcnt(4)
    v_or_b32 v7, s77, v28
    s_lshl_b32 s77, s3, 1
    v_mfma_f32_16x16x32_bf16 v[156:159], a[208:211], a[156:159], v[156:159]
    s_add_u32 s77, s77, 1
    ds_read_b64_tr_b16 a[200:201], v18 offset:14336
    s_lshr_b32 s77, s93, s77
    v_mfma_f32_16x16x32_bf16 v[188:191], a[212:215], a[156:159], v[188:191]
    s_lshr_b32 s73, s93, s53
    ds_read_b64_tr_b16 a[202:203], v18 offset:20480
    s_xor_b32 s77, s77, s73
    v_mfma_f32_16x16x32_bf16 v[180:183], a[212:215], a[152:155], v[180:183]
    buffer_load_dwordx4 a[80:83], v28, s[20:23], s10 offen offset:0 sc1
    v_mfma_f32_16x16x32_bf16 v[148:151], a[208:211], a[152:155], v[148:151]
    s_xor_b32 s77, s77, s55
    s_and_b32 s77, s77, 0x2000
    v_or_b32 v7, s77, v7
    v_mfma_f32_16x16x32_bf16 v[140:143], a[208:211], a[148:151], v[140:143]
    s_andn2_b32 s55, s55, 0x2000
    ds_read_b64_tr_b16 a[204:205], v19 offset:14336
    v_mfma_f32_16x16x32_bf16 v[172:175], a[212:215], a[148:151], v[172:175]
    s_waitcnt vmcnt(17)
    ds_read_b64_tr_b16 a[206:207], v19 offset:20480
    v_mfma_f32_16x16x32_bf16 v[164:167], a[212:215], a[144:147], v[164:167]
    s_barrier
    v_mfma_f32_16x16x32_bf16 v[132:135], a[208:211], a[144:147], v[132:135]
    s_waitcnt lgkmcnt(4)
    buffer_load_dwordx4 a[84:87], v28, s[20:23], s10 offen offset:1024 sc1
    v_mfma_f32_16x16x32_bf16 v[196:199], a[192:195], a[144:147], v[196:199]
    ds_read_b64_tr_b16 a[208:209], v8 offset:0
    v_lshrrev_b32 v2, 2, v1
    v_mfma_f32_16x16x32_bf16 v[228:231], a[196:199], a[144:147], v[228:231]
    ds_read_b64_tr_b16 a[210:211], v8 offset:2048
    v_lshlrev_b32 v18, 6, v2
    v_mfma_f32_16x16x32_bf16 v[236:239], a[196:199], a[148:151], v[236:239]
    buffer_load_dwordx4 a[88:91], v28, s[20:23], s10 offen offset:2048 sc1
    v_mfma_f32_16x16x32_bf16 v[204:207], a[192:195], a[148:151], v[204:207]
    v_mul_u32_u24 v2, 1280, v2
    v_and_b32 v19, 3, v1
    v_mfma_f32_16x16x32_bf16 v[212:215], a[192:195], a[152:155], v[212:215]
    ds_read_b64_tr_b16 a[212:213], v9 offset:0
    v_lshl_add_u32 v18, v19, 3, v18
    v_mfma_f32_16x16x32_bf16 v[244:247], a[196:199], a[152:155], v[244:247]
    ds_read_b64_tr_b16 a[214:215], v9 offset:2048
    v_lshl_add_u32 v2, v19, 4, v2
    v_mfma_f32_16x16x32_bf16 v[252:255], a[196:199], a[156:159], v[252:255]
    buffer_load_dwordx4 a[92:95], v28, s[20:23], s10 offen offset:3072 sc1
    v_mfma_f32_16x16x32_bf16 v[220:223], a[192:195], a[156:159], v[220:223]
    s_waitcnt lgkmcnt(4)
    v_and_b32 v19, 16, v1
    v_lshlrev_b32 v19, 1, v19
    v_mfma_f32_16x16x32_bf16 v[44:47], a[200:203], a[156:159], v[44:47]
    s_add_u32 s10, s10, 12288
    ds_read_b64_tr_b16 a[192:193], v8 offset:4096
    v_xor_b32 v2, v2, v19
    v_mfma_f32_16x16x32_bf16 v[60:63], a[204:207], a[156:159], v[60:63]
    ds_read_b64_tr_b16 a[194:195], v8 offset:6144
    v_or_b32 v18, v18, v19
    v_mfma_f32_16x16x32_bf16 v[56:59], a[204:207], a[152:155], v[56:59]
    buffer_load_dwordx4 v4, s[12:15], s38 offen lds
    v_mfma_f32_16x16x32_bf16 v[40:43], a[200:203], a[152:155], v[40:43]
    s_lshl1_add_u32 m0, s36, 115712
    v_xor_b32 v19, 32, v18
    v_add_u32 v2, s39, v2
    v_mfma_f32_16x16x32_bf16 v[36:39], a[200:203], a[148:151], v[36:39]
    s_and_b32 s56, s70, 0x7ff
    ds_read_b64_tr_b16 a[196:197], v9 offset:4096
    v_add_u32 v2, s63, v2
    v_mfma_f32_16x16x32_bf16 v[52:55], a[204:207], a[148:151], v[52:55]
    s_waitcnt vmcnt(40)
    ds_read_b64_tr_b16 a[198:199], v9 offset:6144
    v_add_u32 v18, 147456, v18
    v_mfma_f32_16x16x32_bf16 v[48:51], a[204:207], a[144:147], v[48:51]
    s_sub_u32 s56, 2047, s56
    v_add_u32 v19, 147456, v19
    v_cmp_eq_u32 s[78:79], s56, v20
    v_mfma_f32_16x16x32_bf16 v[32:35], a[200:203], a[144:147], v[32:35]
    s_waitcnt lgkmcnt(4)
    buffer_load_dwordx4 v5, s[12:15], s38 offen lds
    v_mfma_f32_16x16x32_bf16 a[224:227], a[208:211], a[160:163], a[224:227]
    s_lshl1_add_u32 m0, s36, 122880
    ds_read_b64_tr_b16 a[200:201], v8 offset:8192
    v_add_f32 v132, -0.5, v132
    v_mfma_f32_16x16x32_bf16 a[240:243], a[212:215], a[160:163], a[240:243]
    s_add_u32 s38, s33, 163968
    ds_read_b64_tr_b16 a[202:203], v8 offset:10240
    v_add_f32 v133, -0.5, v133
    v_mfma_f32_16x16x32_bf16 a[244:247], a[212:215], a[164:167], a[244:247]
    s_add_u32 s57, s34, 163968
    v_add_f32 v134, -0.5, v134
    v_add_f32 v135, -0.5, v135
    v_mfma_f32_16x16x32_bf16 a[228:231], a[208:211], a[164:167], a[228:231]
    s_cmp_lt_u32 s3, 2
    s_cselect_b32 s38, s38, s57
    v_add_f32 v164, -0.5, v164
    v_mfma_f32_16x16x32_bf16 a[232:235], a[208:211], a[168:171], a[232:235]
    s_and_b32 s56, s71, 0x7ff
    ds_read_b64_tr_b16 a[204:205], v9 offset:8192
    v_add_f32 v165, -0.5, v165
    v_mfma_f32_16x16x32_bf16 a[248:251], a[212:215], a[168:171], a[248:251]
    s_waitcnt vmcnt(29)
    ds_read_b64_tr_b16 a[206:207], v9 offset:10240
    v_add_f32 v166, -0.5, v166
    v_mfma_f32_16x16x32_bf16 a[252:255], a[212:215], a[172:175], a[252:255]
    buffer_load_dwordx4 v4, s[12:15], s38 offen lds
    v_mfma_f32_16x16x32_bf16 a[236:239], a[208:211], a[172:175], a[236:239]
    s_waitcnt lgkmcnt(4)
    v_add_f32 v167, -0.5, v167
    v_add_f32 v140, -0.5, v140
    v_mfma_f32_16x16x32_bf16 a[236:239], a[192:195], a[188:191], a[236:239]
    s_lshl1_add_u32 m0, s36, 123904
    ds_read_b64_tr_b16 a[208:209], v8 offset:12288
    v_add_f32 v141, -0.5, v141
    v_mfma_f32_16x16x32_bf16 a[252:255], a[196:199], a[188:191], a[252:255]
    s_sub_u32 s56, 2047, s56
    ds_read_b64_tr_b16 a[210:211], v8 offset:14336
    v_cmp_eq_u32 s[80:81], s56, v20
    v_mfma_f32_16x16x32_bf16 a[248:251], a[196:199], a[184:187], a[248:251]
    buffer_load_dwordx4 v5, s[12:15], s38 offen lds
    v_mfma_f32_16x16x32_bf16 a[232:235], a[192:195], a[184:187], a[232:235]
    s_lshl1_add_u32 m0, s36, 131072
    v_add_f32 v142, -0.5, v142
    v_add_f32 v143, -0.5, v143
    v_mfma_f32_16x16x32_bf16 a[228:231], a[192:195], a[180:183], a[228:231]
    s_add_u32 s38, s35, 163968
    ds_read_b64_tr_b16 a[212:213], v9 offset:12288
    v_add_f32 v172, -0.5, v172
    v_mfma_f32_16x16x32_bf16 a[244:247], a[196:199], a[180:183], a[244:247]
    s_waitcnt vmcnt(35)
    ds_read_b64_tr_b16 a[214:215], v9 offset:14336
    v_add_f32 v173, -0.5, v173
    v_mfma_f32_16x16x32_bf16 a[240:243], a[196:199], a[176:179], a[240:243]
    s_add_u32 s57, s33, 204928
    v_add_f32 v174, -0.5, v174
    v_add_f32 v175, -0.5, v175
    v_mfma_f32_16x16x32_bf16 a[224:227], a[192:195], a[176:179], a[224:227]
    s_waitcnt lgkmcnt(4)
    v_add_f32 v148, -0.5, v148
    v_add_f32 v149, -0.5, v149
    v_mfma_f32_16x16x32_bf16 a[224:227], a[200:203], a[0:3], a[224:227]
    s_cmp_lt_u32 s3, 2
    s_cselect_b32 s38, s38, s57
    ds_read_b64_tr_b16 a[192:193], v8 offset:16384
    v_mfma_f32_16x16x32_bf16 a[240:243], a[204:207], a[0:3], a[240:243]
    s_bitcmp0_b32 s53, 0
    s_cselect_b32 s68, 0, 0xff00
    s_lshl_b32 s69, 0x10101, s53
    s_or_b32 s68, s68, s69
    s_sub_u32 s48, s48, s47
    ds_read_b64_tr_b16 a[194:195], v8 offset:18432
    v_mfma_f32_16x16x32_bf16 a[244:247], a[204:207], a[4:7], a[244:247]
    buffer_load_dwordx4 v4, s[12:15], s38 offen lds
    v_mfma_f32_16x16x32_bf16 a[228:231], a[200:203], a[4:7], a[228:231]
    s_lshl1_add_u32 m0, s36, 132096
    v_bfe_u32 v12, v1, 3, 2
    v_mul_u32_u24 v23, s48, v12
    v_mfma_f32_16x16x32_bf16 a[232:235], a[200:203], a[8:11], a[232:235]
    ds_read_b64_tr_b16 a[196:197], v9 offset:16384
    v_add_u32 v23, s47, v23
    v_mfma_f32_16x16x32_bf16 a[248:251], a[204:207], a[8:11], a[248:251]
    s_waitcnt vmcnt(22)
    ds_read_b64_tr_b16 a[198:199], v9 offset:18432
    v_and_b32 v12, 7, v1
    v_mfma_f32_16x16x32_bf16 a[252:255], a[204:207], a[12:15], a[252:255]
    buffer_load_dwordx4 v5, s[12:15], s38 offen lds
    v_mfma_f32_16x16x32_bf16 a[236:239], a[200:203], a[12:15], a[236:239]
    s_waitcnt lgkmcnt(4)
    v_mul_u32_u24 v13, 8389632, v12
    v_xor_b32 v23, v23, v13
    v_mfma_f32_16x16x32_bf16 a[236:239], a[208:211], a[28:31], a[236:239]
    s_lshl1_add_u32 m0, s36, 139264
    ds_read_b64_tr_b16 a[200:201], v8 offset:20480
    v_mov_b32 v12, s53
    v_mfma_f32_16x16x32_bf16 a[252:255], a[212:215], a[28:31], a[252:255]
    s_add_u32 s38, s34, 204928
    ds_read_b64_tr_b16 a[202:203], v8 offset:22528
    v_lshrrev_b32 v13, v12, s93
    v_mfma_f32_16x16x32_bf16 a[248:251], a[212:215], a[24:27], a[248:251]
    s_add_u32 s57, s35, 204928
    v_and_b32 v13, 0x2000, v13
    v_xor_b32 v23, v23, v13
    v_mfma_f32_16x16x32_bf16 a[232:235], a[208:211], a[24:27], a[232:235]
    s_cmp_lt_u32 s3, 2
    s_cselect_b32 s38, s38, s57
    v_add_f32 v150, -0.5, v150
    v_mfma_f32_16x16x32_bf16 a[228:231], a[208:211], a[20:23], a[228:231]
    s_lshr_b32 s56, s2, 4
    ds_read_b64_tr_b16 a[204:205], v9 offset:20480
    v_add_f32 v151, -0.5, v151
    v_mfma_f32_16x16x32_bf16 a[244:247], a[212:215], a[20:23], a[244:247]
    s_waitcnt vmcnt(14)
    ds_read_b64_tr_b16 a[206:207], v9 offset:22528
    v_add_f32 v180, -0.5, v180
    v_mfma_f32_16x16x32_bf16 a[240:243], a[212:215], a[16:19], a[240:243]
    buffer_load_dwordx4 v4, s[12:15], s38 offen lds
    v_mfma_f32_16x16x32_bf16 a[224:227], a[208:211], a[16:19], a[224:227]
    s_waitcnt lgkmcnt(4)
    v_add_f32 v181, -0.5, v181
    v_add_f32 v182, -0.5, v182
    v_mfma_f32_16x16x32_bf16 a[224:227], a[192:195], a[32:35], a[224:227]
    s_lshl1_add_u32 m0, s36, 140288
    ds_read_b64_tr_b16 a[208:209], v8 offset:24576
    v_add_f32 v183, -0.5, v183
    v_mfma_f32_16x16x32_bf16 a[240:243], a[196:199], a[32:35], a[240:243]
    s_lshl_b32 s56, s56, 14
    ds_read_b64_tr_b16 a[210:211], v8 offset:26624
    v_add_f32 v156, -0.5, v156
    v_mfma_f32_16x16x32_bf16 a[244:247], a[196:199], a[36:39], a[244:247]
    buffer_load_dwordx4 v5, s[12:15], s38 offen lds
    v_mfma_f32_16x16x32_bf16 a[228:231], a[192:195], a[36:39], a[228:231]
    s_and_b32 s46, s2, 8
    v_add_f32 v157, -0.5, v157
    v_add_f32 v158, -0.5, v158
    v_mfma_f32_16x16x32_bf16 a[232:235], a[192:195], a[40:43], a[232:235]
    s_lshl_b32 s46, s46, 9
    ds_read_b64_tr_b16 a[212:213], v9 offset:24576
    v_add_f32 v159, -0.5, v159
    v_mfma_f32_16x16x32_bf16 a[248:251], a[196:199], a[40:43], a[248:251]
    s_waitcnt vmcnt(20)
    ds_read_b64_tr_b16 a[214:215], v9 offset:26624
    v_add_f32 v188, -0.5, v188
    v_mfma_f32_16x16x32_bf16 a[252:255], a[196:199], a[44:47], a[252:255]
    buffer_load_dwordx4 v[144:147], v22, s[16:19], s41 offen
    v_mfma_f32_16x16x32_bf16 a[236:239], a[192:195], a[44:47], a[236:239]
    s_waitcnt lgkmcnt(4)
    v_add_f32 v189, -0.5, v189
    v_add_f32 v190, -0.5, v190
    v_mfma_f32_16x16x32_bf16 a[236:239], a[200:203], a[60:63], a[236:239]
    s_add_u32 s56, s56, s46
    ds_read_b64_tr_b16 a[192:193], v8 offset:28672
    v_add_f32 v191, -0.5, v191
    v_mfma_f32_16x16x32_bf16 a[252:255], a[204:207], a[60:63], a[252:255]
    s_add_u32 s56, s56, 4456448
    ds_read_b64_tr_b16 a[194:195], v8 offset:30720
    v_add_f32 v196, -0.5, v196
    v_mfma_f32_16x16x32_bf16 a[248:251], a[204:207], a[56:59], a[248:251]
    buffer_load_dwordx4 v[160:163], v22, s[16:19], s43 offen
    v_mfma_f32_16x16x32_bf16 a[232:235], a[200:203], a[56:59], a[232:235]
    s_lshl_b32 s46, s3, 1
    v_lshrrev_b32 v12, 2, v1
    v_min_u32 v12, 1, v12
    v_mfma_f32_16x16x32_bf16 a[228:231], a[200:203], a[52:55], a[228:231]
    ds_read_b64_tr_b16 a[196:197], v9 offset:28672
    v_lshlrev_b32 v12, 30, v12
    v_mfma_f32_16x16x32_bf16 a[244:247], a[204:207], a[52:55], a[244:247]
    s_waitcnt vmcnt(14)
    ds_read_b64_tr_b16 a[198:199], v9 offset:30720
    v_lshl_or_b32 v12, v1, 7, v12
    v_mfma_f32_16x16x32_bf16 a[240:243], a[204:207], a[48:51], a[240:243]
    buffer_load_dwordx4 v[152:155], v22, s[16:19], s66 offen
    v_mfma_f32_16x16x32_bf16 a[224:227], a[200:203], a[48:51], a[224:227]
    s_waitcnt lgkmcnt(4)
    v_add_f32 v197, -0.5, v197
    v_add_f32 v198, -0.5, v198
    v_mfma_f32_16x16x32_bf16 a[224:227], a[208:211], a[64:67], a[224:227]
    s_lshl_b32 s37, s3, 10
    ds_read_b64_tr_b16 a[200:201], v10 offset:0
    v_add_f32 v199, -0.5, v199
    v_mfma_f32_16x16x32_bf16 a[240:243], a[212:215], a[64:67], a[240:243]
    s_add_u32 s56, s56, s37
    ds_read_b64_tr_b16 a[202:203], v10 offset:2048
    v_add_f32 v228, -0.5, v228
    v_mfma_f32_16x16x32_bf16 a[244:247], a[212:215], a[68:71], a[244:247]
    s_lshr_b32 s46, s93, s46
    v_add_f32 v229, -0.5, v229
    v_add_f32 v230, -0.5, v230
    v_mfma_f32_16x16x32_bf16 a[228:231], a[208:211], a[68:71], a[228:231]
    s_and_b32 s37, s46, 0x2000
    v_add_f32 v231, -0.5, v231
    v_add_f32 v204, -0.5, v204
    v_mfma_f32_16x16x32_bf16 a[232:235], a[208:211], a[72:75], a[232:235]
    s_add_u32 s37, s37, s56
    ds_read_b64_tr_b16 a[204:205], v11 offset:0
    v_add_u32 v3, s37, v12
    v_mfma_f32_16x16x32_bf16 a[248:251], a[212:215], a[72:75], a[248:251]
    s_waitcnt vmcnt(11)
    ds_read_b64_tr_b16 a[206:207], v11 offset:2048
    v_add_f32 v205, -0.5, v205
    v_mfma_f32_16x16x32_bf16 a[252:255], a[212:215], a[76:79], a[252:255]
    s_lshr_b32 s46, s46, 1
    v_add_f32 v206, -0.5, v206
    v_add_f32 v207, -0.5, v207
    v_mfma_f32_16x16x32_bf16 a[236:239], a[208:211], a[76:79], a[236:239]
    s_waitcnt lgkmcnt(4)
    v_add_f32 v236, -0.5, v236
    v_add_f32 v237, -0.5, v237
    v_mfma_f32_16x16x32_bf16 a[236:239], a[192:195], a[92:95], a[236:239]
    s_and_b32 s37, s46, 0x2000
    ds_read_b64_tr_b16 a[208:209], v10 offset:4096
    v_add_f32 v238, -0.5, v238
    v_mfma_f32_16x16x32_bf16 a[252:255], a[196:199], a[92:95], a[252:255]
    s_add_u32 s37, s37, s56
    ds_read_b64_tr_b16 a[210:211], v10 offset:6144
    v_add_u32 v131, s37, v12
    v_mfma_f32_16x16x32_bf16 a[248:251], a[196:199], a[88:91], a[248:251]
    s_lshl_b32 s56, 1, s53
    v_mov_b32 v128, s56
    v_lshlrev_b32 v129, 8, v128
    v_mfma_f32_16x16x32_bf16 a[232:235], a[192:195], a[88:91], a[232:235]
    v_lshlrev_b32 v130, 16, v128
    v_add_f32 v239, -0.5, v239
    v_mfma_f32_16x16x32_bf16 a[228:231], a[192:195], a[84:87], a[228:231]
    s_mov_b32 s67, 0
    ds_read_b64_tr_b16 a[212:213], v11 offset:4096
    v_add_f32 v212, -0.5, v212
    v_mfma_f32_16x16x32_bf16 a[244:247], a[196:199], a[84:87], a[244:247]
    s_mul_i32 s37, s3, 24576
    ds_read_b64_tr_b16 a[214:215], v11 offset:6144
    v_add_f32 v213, -0.5, v213
    v_mfma_f32_16x16x32_bf16 a[240:243], a[196:199], a[80:83], a[240:243]
    s_lshl_b32 s56, s3, 9
    v_add_f32 v214, -0.5, v214
    v_add_f32 v215, -0.5, v215
    v_mfma_f32_16x16x32_bf16 a[224:227], a[192:195], a[80:83], a[224:227]
    s_waitcnt lgkmcnt(4)
    v_add_f32 v244, -0.5, v244
    v_add_f32 v245, -0.5, v245
    v_mfma_f32_16x16x32_bf16 v[68:71], a[200:203], a[160:163], v[68:71]
    s_add_u32 s56, s56, 159744
    ds_read_b64_tr_b16 a[192:193], v10 offset:8192
    v_lshlrev_b32 v138, 3, v1
    v_mfma_f32_16x16x32_bf16 v[100:103], a[204:207], a[160:163], v[100:103]
    ds_read_b64_tr_b16 a[194:195], v10 offset:10240
    v_add_u32 v138, s56, v138
    v_mfma_f32_16x16x32_bf16 v[108:111], a[204:207], a[164:167], v[108:111]
    v_mov_b32 v139, 256
    v_cndmask_b32 v139, 0, v139, s[80:81]
    v_mfma_f32_16x16x32_bf16 v[76:79], a[200:203], a[164:167], v[76:79]
    v_lshl_add_u32 v139, v21, 4, v139
    v_add_u32 v139, s56, v139
    v_mfma_f32_16x16x32_bf16 v[84:87], a[200:203], a[168:171], v[84:87]
    s_mov_b32 s59, 3670016
    ds_read_b64_tr_b16 a[196:197], v11 offset:8192
    v_and_b32 v14, 15, v1
    v_mfma_f32_16x16x32_bf16 v[116:119], a[204:207], a[168:171], v[116:119]
    s_or_b64 s[88:89], s[78:79], s[80:81]
    s_cselect_b32 s59, s59, 0x70000000
    ds_read_b64_tr_b16 a[198:199], v11 offset:10240
    v_mfma_f32_16x16x32_bf16 v[124:127], a[204:207], a[172:175], v[124:127]
    v_accvgpr_read_b32 v64, a224
    v_accvgpr_read_b32 v65, a225
    v_mfma_f32_16x16x32_bf16 v[92:95], a[200:203], a[172:175], v[92:95]
    s_waitcnt lgkmcnt(4)
    v_accvgpr_read_b32 v66, a226
    v_accvgpr_read_b32 v67, a227
    v_mfma_f32_16x16x32_bf16 v[92:95], a[208:211], a[188:191], v[92:95]
    ds_read_b64_tr_b16 a[200:201], v10 offset:12288
    v_accvgpr_read_b32 v72, a240
    v_mfma_f32_16x16x32_bf16 v[124:127], a[212:215], a[188:191], v[124:127]
    ds_read_b64_tr_b16 a[202:203], v10 offset:14336
    v_accvgpr_read_b32 v73, a241
    v_mfma_f32_16x16x32_bf16 v[116:119], a[212:215], a[184:187], v[116:119]
    v_accvgpr_read_b32 v74, a242
    v_accvgpr_read_b32 v75, a243
    v_mfma_f32_16x16x32_bf16 v[84:87], a[208:211], a[184:187], v[84:87]
    v_add_f32 v64, -0.5, v64
    v_add_f32 v65, -0.5, v65
    v_mfma_f32_16x16x32_bf16 v[76:79], a[208:211], a[180:183], v[76:79]
    ds_read_b64_tr_b16 a[204:205], v11 offset:12288
    v_add_f32 v66, -0.5, v66
    v_mfma_f32_16x16x32_bf16 v[108:111], a[212:215], a[180:183], v[108:111]
    ds_read_b64_tr_b16 a[206:207], v11 offset:14336
    v_add_f32 v67, -0.5, v67
    v_mfma_f32_16x16x32_bf16 v[100:103], a[212:215], a[176:179], v[100:103]
    v_add_f32 v72, -0.5, v72
    v_add_f32 v73, -0.5, v73
    v_mfma_f32_16x16x32_bf16 v[68:71], a[208:211], a[176:179], v[68:71]
    s_waitcnt lgkmcnt(4)
    v_add_f32 v74, -0.5, v74
    v_add_f32 v75, -0.5, v75
    v_mfma_f32_16x16x32_bf16 v[68:71], a[192:195], a[0:3], v[68:71]
    ds_read_b64_tr_b16 a[208:209], v10 offset:16384
    v_cvt_pk_bf16_f32 v64, v64, v65
    v_mfma_f32_16x16x32_bf16 v[100:103], a[196:199], a[0:3], v[100:103]
    s_waitcnt vmcnt(2)
    ds_read_b64_tr_b16 a[210:211], v10 offset:18432
    v_cvt_pk_bf16_f32 v65, v66, v67
    v_mfma_f32_16x16x32_bf16 v[108:111], a[196:199], a[4:7], v[108:111]
    v_cvt_pk_bf16_f32 v66, v72, v73
    v_cvt_pk_bf16_f32 v67, v74, v75
    v_mfma_f32_16x16x32_bf16 v[76:79], a[192:195], a[4:7], v[76:79]
    buffer_store_dwordx4 v[64:67], v7, s[24:27], s55 offen sc1
    v_mfma_f32_16x16x32_bf16 v[84:87], a[192:195], a[8:11], v[84:87]
    s_xor_b32 s55, s55, 1024
    ds_read_b64_tr_b16 a[212:213], v11 offset:16384
    v_accvgpr_read_b32 v80, a228
    v_mfma_f32_16x16x32_bf16 v[116:119], a[196:199], a[8:11], v[116:119]
    ds_read_b64_tr_b16 a[214:215], v11 offset:18432
    v_accvgpr_read_b32 v81, a229
    v_mfma_f32_16x16x32_bf16 v[124:127], a[196:199], a[12:15], v[124:127]
    v_accvgpr_read_b32 v82, a230
    v_accvgpr_read_b32 v83, a231
    v_mfma_f32_16x16x32_bf16 v[92:95], a[192:195], a[12:15], v[92:95]
    s_waitcnt lgkmcnt(4)
    v_accvgpr_read_b32 v88, a244
    v_accvgpr_read_b32 v89, a245
    v_mfma_f32_16x16x32_bf16 v[92:95], a[200:203], a[28:31], v[92:95]
    ds_read_b64_tr_b16 a[192:193], v10 offset:20480
    v_accvgpr_read_b32 v90, a246
    v_mfma_f32_16x16x32_bf16 v[124:127], a[204:207], a[28:31], v[124:127]
    ds_read_b64_tr_b16 a[194:195], v10 offset:22528
    v_accvgpr_read_b32 v91, a247
    v_mfma_f32_16x16x32_bf16 v[116:119], a[204:207], a[24:27], v[116:119]
    v_add_f32 v80, -0.5, v80
    v_add_f32 v81, -0.5, v81
    v_mfma_f32_16x16x32_bf16 v[84:87], a[200:203], a[24:27], v[84:87]
    v_add_f32 v82, -0.5, v82
    v_add_f32 v83, -0.5, v83
    v_mfma_f32_16x16x32_bf16 v[76:79], a[200:203], a[20:23], v[76:79]
    ds_read_b64_tr_b16 a[196:197], v11 offset:20480
    v_add_f32 v88, -0.5, v88
    v_mfma_f32_16x16x32_bf16 v[108:111], a[204:207], a[20:23], v[108:111]
    ds_read_b64_tr_b16 a[198:199], v11 offset:22528
    v_add_f32 v89, -0.5, v89
    v_mfma_f32_16x16x32_bf16 v[100:103], a[204:207], a[16:19], v[100:103]
    v_add_f32 v90, -0.5, v90
    v_add_f32 v91, -0.5, v91
    v_mfma_f32_16x16x32_bf16 v[68:71], a[200:203], a[16:19], v[68:71]
    s_waitcnt lgkmcnt(4)
    v_cvt_pk_bf16_f32 v80, v80, v81
    v_cvt_pk_bf16_f32 v81, v82, v83
    v_mfma_f32_16x16x32_bf16 v[68:71], a[208:211], a[32:35], v[68:71]
    ds_read_b64_tr_b16 a[200:201], v10 offset:24576
    v_cvt_pk_bf16_f32 v82, v88, v89
    v_mfma_f32_16x16x32_bf16 v[100:103], a[212:215], a[32:35], v[100:103]
    ds_read_b64_tr_b16 a[202:203], v10 offset:26624
    v_cvt_pk_bf16_f32 v83, v90, v91
    v_mfma_f32_16x16x32_bf16 v[108:111], a[212:215], a[36:39], v[108:111]
    buffer_store_dwordx4 v[80:83], v7, s[24:27], s55 offen sc1
    v_mfma_f32_16x16x32_bf16 v[76:79], a[208:211], a[36:39], v[76:79]
    s_xor_b32 s55, s55, 3072
    v_accvgpr_read_b32 v96, a232
    v_accvgpr_read_b32 v97, a233
    v_mfma_f32_16x16x32_bf16 v[84:87], a[208:211], a[40:43], v[84:87]
    s_add_u32 m0, s36, 147456
    ds_read_b64_tr_b16 a[204:205], v11 offset:24576
    v_accvgpr_read_b32 v98, a234
    v_mfma_f32_16x16x32_bf16 v[116:119], a[212:215], a[40:43], v[116:119]
    s_add_u32 s38, s34, 123136
    ds_read_b64_tr_b16 a[206:207], v11 offset:26624
    v_accvgpr_read_b32 v99, a235
    v_mfma_f32_16x16x32_bf16 v[124:127], a[212:215], a[44:47], v[124:127]
    s_add_u32 s57, s35, 123136
    v_accvgpr_read_b32 v104, a248
    v_accvgpr_read_b32 v105, a249
    v_mfma_f32_16x16x32_bf16 v[92:95], a[208:211], a[44:47], v[92:95]
    s_waitcnt lgkmcnt(4)
    v_accvgpr_read_b32 v106, a250
    v_accvgpr_read_b32 v107, a251
    v_mfma_f32_16x16x32_bf16 v[92:95], a[192:195], a[60:63], v[92:95]
    s_cmp_lt_u32 s3, 2
    s_cselect_b32 s38, s38, s57
    ds_read_b64_tr_b16 a[208:209], v10 offset:28672
    v_mfma_f32_16x16x32_bf16 v[124:127], a[196:199], a[60:63], v[124:127]
    ds_read_b64_tr_b16 a[210:211], v10 offset:30720
    v_add_f32 v96, -0.5, v96
    v_mfma_f32_16x16x32_bf16 v[116:119], a[196:199], a[56:59], v[116:119]
    buffer_load_dwordx4 v2, s[12:15], s38 offen lds
    v_mfma_f32_16x16x32_bf16 v[84:87], a[192:195], a[56:59], v[84:87]
    s_add_u32 m0, s36, 151552
    v_add_f32 v97, -0.5, v97
    v_add_f32 v98, -0.5, v98
    v_mfma_f32_16x16x32_bf16 v[76:79], a[192:195], a[52:55], v[76:79]
    s_add_u32 s38, s33, 164096
    ds_read_b64_tr_b16 a[212:213], v11 offset:28672
    v_add_f32 v99, -0.5, v99
    v_mfma_f32_16x16x32_bf16 v[108:111], a[196:199], a[52:55], v[108:111]
    s_waitcnt vmcnt(6)
    ds_read_b64_tr_b16 a[214:215], v11 offset:30720
    v_add_f32 v104, -0.5, v104
    v_mfma_f32_16x16x32_bf16 v[100:103], a[196:199], a[48:51], v[100:103]
pg_12:
    s_cbranch_execz pg_ret2
    s_barrier
    v_mfma_f32_16x16x32_bf16 v[68:71], a[192:195], a[48:51], v[68:71]
    s_waitcnt lgkmcnt(4)
    v_add_f32 v105, -0.5, v105
    v_add_f32 v106, -0.5, v106
    v_mfma_f32_16x16x32_bf16 v[68:71], a[200:203], a[64:67], v[68:71]
    s_add_u32 s57, s34, 164096
    ds_read_b64_tr_b16 a[192:193], v8 offset:32768
    v_add_f32 v107, -0.5, v107
    v_mfma_f32_16x16x32_bf16 v[100:103], a[204:207], a[64:67], v[100:103]
    s_cmp_lt_u32 s3, 2
    s_cselect_b32 s38, s38, s57
    ds_read_b64_tr_b16 a[194:195], v8 offset:34816
    v_mfma_f32_16x16x32_bf16 v[108:111], a[204:207], a[68:71], v[108:111]
    buffer_load_dwordx4 v2, s[12:15], s38 offen lds
    v_mfma_f32_16x16x32_bf16 v[76:79], a[200:203], a[68:71], v[76:79]
    s_add_u32 m0, s36, 155648
    v_cvt_pk_bf16_f32 v96, v96, v97
    v_cvt_pk_bf16_f32 v97, v98, v99
    v_mfma_f32_16x16x32_bf16 v[84:87], a[200:203], a[72:75], v[84:87]
    s_add_u32 s38, s35, 164096
    ds_read_b64_tr_b16 a[196:197], v9 offset:32768
    v_cvt_pk_bf16_f32 v98, v104, v105
    v_mfma_f32_16x16x32_bf16 v[116:119], a[204:207], a[72:75], v[116:119]
    s_add_u32 s57, s33, 205056
    ds_read_b64_tr_b16 a[198:199], v9 offset:34816
    v_cvt_pk_bf16_f32 v99, v106, v107
    v_mfma_f32_16x16x32_bf16 v[124:127], a[204:207], a[76:79], v[124:127]
    buffer_store_dwordx4 v[96:99], v7, s[24:27], s55 offen sc1
    v_mfma_f32_16x16x32_bf16 v[92:95], a[200:203], a[76:79], v[92:95]
    s_waitcnt lgkmcnt(4)
    v_accvgpr_read_b32 v112, a236
    v_accvgpr_read_b32 v113, a237
    v_mfma_f32_16x16x32_bf16 v[92:95], a[208:211], a[92:95], v[92:95]
    s_cmp_lt_u32 s3, 2
    s_cselect_b32 s38, s38, s57
    ds_read_b64_tr_b16 a[200:201], v8 offset:36864
    v_mfma_f32_16x16x32_bf16 v[124:127], a[212:215], a[92:95], v[124:127]
    s_xor_b32 s55, s55, 1024
    ds_read_b64_tr_b16 a[202:203], v8 offset:38912
    v_accvgpr_read_b32 v114, a238
    v_mfma_f32_16x16x32_bf16 v[116:119], a[212:215], a[88:91], v[116:119]
    buffer_load_dwordx4 v2, s[12:15], s38 offen lds
    v_mfma_f32_16x16x32_bf16 v[84:87], a[208:211], a[88:91], v[84:87]
    s_add_u32 m0, s36, 159744
    v_accvgpr_read_b32 v115, a239
    v_accvgpr_read_b32 v120, a252
    v_mfma_f32_16x16x32_bf16 v[76:79], a[208:211], a[84:87], v[76:79]
    s_add_u32 s38, s34, 205056
    ds_read_b64_tr_b16 a[204:205], v9 offset:36864
    v_accvgpr_read_b32 v121, a253
    v_mfma_f32_16x16x32_bf16 v[108:111], a[212:215], a[84:87], v[108:111]
    s_add_u32 s57, s35, 205056
    ds_read_b64_tr_b16 a[206:207], v9 offset:38912
    v_accvgpr_read_b32 v122, a254
    v_mfma_f32_16x16x32_bf16 v[100:103], a[212:215], a[80:83], v[100:103]
    s_cmp_lt_u32 s3, 2
    s_cselect_b32 s38, s38, s57
    v_accvgpr_read_b32 v123, a255
    v_mfma_f32_16x16x32_bf16 v[68:71], a[208:211], a[80:83], v[68:71]
    s_waitcnt lgkmcnt(4)
    buffer_load_dwordx4 v2, s[12:15], s38 offen lds
    v_mfma_f32_16x16x32_bf16 v[132:135], a[192:195], a[160:163], v[132:135]
    ds_read_b64_tr_b16 a[208:209], v8 offset:40960
    v_add_f32 v112, -0.5, v112
    v_mfma_f32_16x16x32_bf16 v[164:167], a[196:199], a[160:163], v[164:167]
    ds_read_b64_tr_b16 a[210:211], v8 offset:43008
    v_add_f32 v113, -0.5, v113
    v_mfma_f32_16x16x32_bf16 v[172:175], a[196:199], a[164:167], v[172:175]
    v_add_f32 v114, -0.5, v114
    v_add_f32 v115, -0.5, v115
    v_mfma_f32_16x16x32_bf16 v[140:143], a[192:195], a[164:167], v[140:143]
    v_add_f32 v120, -0.5, v120
    v_add_f32 v121, -0.5, v121
    v_mfma_f32_16x16x32_bf16 v[148:151], a[192:195], a[168:171], v[148:151]
    ds_read_b64_tr_b16 a[212:213], v9 offset:40960
    v_add_f32 v122, -0.5, v122
    v_mfma_f32_16x16x32_bf16 v[180:183], a[196:199], a[168:171], v[180:183]
    ds_read_b64_tr_b16 a[214:215], v9 offset:43008
    v_add_f32 v123, -0.5, v123
    v_mfma_f32_16x16x32_bf16 v[188:191], a[196:199], a[172:175], v[188:191]
    v_cvt_pk_bf16_f32 v112, v112, v113
    v_cvt_pk_bf16_f32 v113, v114, v115
    v_mfma_f32_16x16x32_bf16 v[156:159], a[192:195], a[172:175], v[156:159]
    s_waitcnt lgkmcnt(4)
    v_cvt_pk_bf16_f32 v114, v120, v121
    v_cvt_pk_bf16_f32 v115, v122, v123
    v_mfma_f32_16x16x32_bf16 v[156:159], a[200:203], a[188:191], v[156:159]
    ds_read_b64_tr_b16 a[192:193], v8 offset:45056
    v_cvt_pk_bf16_f32 v68, v68, v69
    v_mfma_f32_16x16x32_bf16 v[188:191], a[204:207], a[188:191], v[188:191]
    ds_read_b64_tr_b16 a[194:195], v8 offset:47104
    v_cvt_pk_bf16_f32 v69, v70, v71
    v_mfma_f32_16x16x32_bf16 v[180:183], a[204:207], a[184:187], v[180:183]
    buffer_store_dwordx4 v[112:115], v7, s[24:27], s55 offen sc1
    v_mfma_f32_16x16x32_bf16 v[148:151], a[200:203], a[184:187], v[148:151]
    s_xor_b32 s55, s55, 3072
    v_cvt_pk_bf16_f32 v70, v100, v101
    v_cvt_pk_bf16_f32 v71, v102, v103
    v_mfma_f32_16x16x32_bf16 v[140:143], a[200:203], a[180:183], v[140:143]
    s_add_u32 s55, s55, 16384
    ds_read_b64_tr_b16 a[196:197], v9 offset:45056
    v_cvt_pk_bf16_f32 v76, v76, v77
    v_mfma_f32_16x16x32_bf16 v[172:175], a[204:207], a[180:183], v[172:175]
    ds_read_b64_tr_b16 a[198:199], v9 offset:47104
    v_cvt_pk_bf16_f32 v77, v78, v79
    v_mfma_f32_16x16x32_bf16 v[164:167], a[204:207], a[176:179], v[164:167]
    buffer_store_dwordx4 v[68:71], v6, s[24:27], s55 offen sc1
    v_mfma_f32_16x16x32_bf16 v[132:135], a[200:203], a[176:179], v[132:135]
    s_waitcnt lgkmcnt(4)
    v_cvt_pk_bf16_f32 v78, v108, v109
    v_cvt_pk_bf16_f32 v79, v110, v111
    v_mfma_f32_16x16x32_bf16 v[132:135], a[208:211], a[0:3], v[132:135]
    s_xor_b32 s55, s55, 1024
    ds_read_b64_tr_b16 a[200:201], v8 offset:49152
    v_cvt_pk_bf16_f32 v84, v84, v85
    v_mfma_f32_16x16x32_bf16 v[164:167], a[212:215], a[0:3], v[164:167]
    ds_read_b64_tr_b16 a[202:203], v8 offset:51200
    v_cvt_pk_bf16_f32 v85, v86, v87
    v_mfma_f32_16x16x32_bf16 v[172:175], a[212:215], a[4:7], v[172:175]
    buffer_store_dwordx4 v[76:79], v6, s[24:27], s55 offen sc1
    v_mfma_f32_16x16x32_bf16 v[140:143], a[208:211], a[4:7], v[140:143]
    s_xor_b32 s55, s55, 3072
    v_cvt_pk_bf16_f32 v86, v116, v117
    v_cvt_pk_bf16_f32 v87, v118, v119
    v_mfma_f32_16x16x32_bf16 v[148:151], a[208:211], a[8:11], v[148:151]
    ds_read_b64_tr_b16 a[204:205], v9 offset:49152
    v_cvt_pk_bf16_f32 v92, v92, v93
    v_mfma_f32_16x16x32_bf16 v[180:183], a[212:215], a[8:11], v[180:183]
    ds_read_b64_tr_b16 a[206:207], v9 offset:51200
    v_cvt_pk_bf16_f32 v93, v94, v95
    v_mfma_f32_16x16x32_bf16 v[188:191], a[212:215], a[12:15], v[188:191]
    v_cvt_pk_bf16_f32 v94, v124, v125
    v_cvt_pk_bf16_f32 v95, v126, v127
    v_mfma_f32_16x16x32_bf16 v[156:159], a[208:211], a[12:15], v[156:159]
    s_waitcnt lgkmcnt(4)
    v_lshl_add_u32 v14, s3, 4, v14
    v_lshlrev_b32 v14, 6, v14
    v_mfma_f32_16x16x32_bf16 v[156:159], a[192:195], a[28:31], v[156:159]
    ds_read_b64_tr_b16 a[208:209], v8 offset:53248
    v_lshlrev_b32 v26, 16, v144
    v_mfma_f32_16x16x32_bf16 v[188:191], a[196:199], a[28:31], v[188:191]
    ds_read_b64_tr_b16 a[210:211], v8 offset:55296
    v_and_b32 v27, 0xffff0000, v144
    v_mfma_f32_16x16x32_bf16 v[180:183], a[196:199], a[24:27], v[180:183]
    v_fma_f32 v26, v26, v25, v24
    v_fma_f32 v27, v27, v25, v24
    v_mfma_f32_16x16x32_bf16 v[148:151], a[192:195], a[24:27], v[148:151]
    v_mul_f32 v30, s92, v26
    v_mul_f32 v31, s92, v27
    v_mfma_f32_16x16x32_bf16 v[140:143], a[192:195], a[20:23], v[140:143]
    ds_read_b64_tr_b16 a[212:213], v9 offset:53248
    v_add_f32 v246, -0.5, v246
    v_mfma_f32_16x16x32_bf16 v[172:175], a[196:199], a[20:23], v[172:175]
    ds_read_b64_tr_b16 a[214:215], v9 offset:55296
    v_add_f32 v247, -0.5, v247
    v_mfma_f32_16x16x32_bf16 v[164:167], a[196:199], a[16:19], v[164:167]
    buffer_store_dwordx4 v[84:87], v6, s[24:27], s55 offen sc1
    v_mfma_f32_16x16x32_bf16 v[132:135], a[192:195], a[16:19], v[132:135]
    s_waitcnt lgkmcnt(4)
    v_exp_f32 v30, v30
    v_mfma_f32_16x16x32_bf16 v[132:135], a[200:203], a[32:35], v[132:135]
    s_xor_b32 s55, s55, 1024
    ds_read_b64_tr_b16 a[192:193], v8 offset:57344
    v_add_f32 v220, -0.5, v220
    v_mfma_f32_16x16x32_bf16 v[164:167], a[204:207], a[32:35], v[164:167]
    ds_read_b64_tr_b16 a[194:195], v8 offset:59392
    v_add_f32 v221, -0.5, v221
    v_mfma_f32_16x16x32_bf16 v[172:175], a[204:207], a[36:39], v[172:175]
    v_exp_f32 v31, v31
    v_mfma_f32_16x16x32_bf16 v[140:143], a[200:203], a[36:39], v[140:143]
    v_add_f32 v30, 1.0, v30
    v_add_f32 v31, 1.0, v31
    v_mfma_f32_16x16x32_bf16 v[148:151], a[200:203], a[40:43], v[148:151]
    s_mov_b32 s32, s84
    ds_read_b64_tr_b16 a[196:197], v9 offset:57344
    v_add_f32 v222, -0.5, v222
    v_mfma_f32_16x16x32_bf16 v[180:183], a[204:207], a[40:43], v[180:183]
    s_and_b32 s33, s85, 0xffff
    ds_read_b64_tr_b16 a[198:199], v9 offset:59392
    v_add_f32 v223, -0.5, v223
    v_mfma_f32_16x16x32_bf16 v[188:191], a[204:207], a[44:47], v[188:191]
    s_mov_b32 s34, 2621440
    v_rcp_f32 v30, v30
    v_mfma_f32_16x16x32_bf16 v[156:159], a[200:203], a[44:47], v[156:159]
    s_waitcnt lgkmcnt(4)
    v_rcp_f32 v31, v31
    v_mfma_f32_16x16x32_bf16 v[156:159], a[208:211], a[60:63], v[156:159]
    s_mov_b32 s35, 0x00020000
    ds_read_b64_tr_b16 a[200:201], v8 offset:61440
    v_mul_f32 v26, v26, v30
    v_mfma_f32_16x16x32_bf16 v[188:191], a[212:215], a[60:63], v[188:191]
    ds_read_b64_tr_b16 a[202:203], v8 offset:63488
    v_mul_f32 v27, v27, v31
    v_mfma_f32_16x16x32_bf16 v[180:183], a[212:215], a[56:59], v[180:183]
    buffer_load_dword v137, v136, s[24:27], s59 offen offset:128 sc1
    v_mfma_f32_16x16x32_bf16 v[148:151], a[208:211], a[56:59], v[148:151]
    buffer_store_dwordx4 v[92:95], v6, s[24:27], s55 offen sc1
    v_mfma_f32_16x16x32_bf16 v[140:143], a[208:211], a[52:55], v[140:143]
    s_xor_b32 s55, s55, 3072
    ds_read_b64_tr_b16 a[204:205], v9 offset:61440
    v_cvt_pk_bf16_f32 v168, v26, v27
    v_mfma_f32_16x16x32_bf16 v[172:175], a[212:215], a[52:55], v[172:175]
    s_add_u32 s55, s55, 16384
    ds_read_b64_tr_b16 a[206:207], v9 offset:63488
    v_lshlrev_b32 v26, 16, v145
    v_mfma_f32_16x16x32_bf16 v[164:167], a[212:215], a[48:51], v[164:167]
    v_and_b32 v27, 0xffff0000, v145
    v_fma_f32 v26, v26, v25, v24
    v_mfma_f32_16x16x32_bf16 v[132:135], a[208:211], a[48:51], v[132:135]
    s_waitcnt lgkmcnt(4)
    v_fma_f32 v27, v27, v25, v24
    v_mul_f32 v30, s92, v26
    v_mfma_f32_16x16x32_bf16 v[132:135], a[192:195], a[64:67], v[132:135]
    s_waitcnt vmcnt(5)
    ds_read_b64_tr_b16 a[208:209], v10 offset:32768
    v_mul_f32 v31, s92, v27
    v_mfma_f32_16x16x32_bf16 v[164:167], a[196:199], a[64:67], v[164:167]
    ds_read_b64_tr_b16 a[210:211], v10 offset:34816
    v_add_f32 v252, -0.5, v252
    v_mfma_f32_16x16x32_bf16 v[172:175], a[196:199], a[68:71], v[172:175]
    buffer_atomic_or v128, v131, s[24:27], 0 offen offset:512
    v_mfma_f32_16x16x32_bf16 v[140:143], a[192:195], a[68:71], v[140:143]
    s_load_dword s67, s[86:87], s5 glc
    v_exp_f32 v30, v30
    v_mfma_f32_16x16x32_bf16 v[148:151], a[192:195], a[72:75], v[148:151]
    ds_read_b64_tr_b16 a[212:213], v11 offset:32768
    v_add_f32 v253, -0.5, v253
    v_mfma_f32_16x16x32_bf16 v[180:183], a[196:199], a[72:75], v[180:183]
    ds_read_b64_tr_b16 a[214:215], v11 offset:34816
    v_add_f32 v254, -0.5, v254
    v_mfma_f32_16x16x32_bf16 v[188:191], a[196:199], a[76:79], v[188:191]
    v_exp_f32 v31, v31
    v_mfma_f32_16x16x32_bf16 v[156:159], a[192:195], a[76:79], v[156:159]
    s_waitcnt lgkmcnt(4)
    v_add_f32 v30, 1.0, v30
    v_add_f32 v31, 1.0, v31
    v_mfma_f32_16x16x32_bf16 v[156:159], a[200:203], a[92:95], v[156:159]
    ds_read_b64_tr_b16 a[192:193], v10 offset:36864
    v_add_f32 v255, -0.5, v255
    v_mfma_f32_16x16x32_bf16 v[188:191], a[204:207], a[92:95], v[188:191]
    ds_read_b64_tr_b16 a[194:195], v10 offset:38912
    v_add_f32 v32, -0.5, v32
    v_mfma_f32_16x16x32_bf16 v[180:183], a[204:207], a[88:91], v[180:183]
    v_rcp_f32 v30, v30
    v_mfma_f32_16x16x32_bf16 v[148:151], a[200:203], a[88:91], v[148:151]
    v_rcp_f32 v31, v31
    v_mfma_f32_16x16x32_bf16 v[140:143], a[200:203], a[84:87], v[140:143]
    ds_read_b64_tr_b16 a[196:197], v11 offset:36864
    v_mul_f32 v26, v26, v30
    v_mfma_f32_16x16x32_bf16 v[172:175], a[204:207], a[84:87], v[172:175]
    ds_read_b64_tr_b16 a[198:199], v11 offset:38912
    v_mul_f32 v27, v27, v31
    v_mfma_f32_16x16x32_bf16 v[164:167], a[204:207], a[80:83], v[164:167]
    v_cvt_pk_bf16_f32 v169, v26, v27
    v_lshlrev_b32 v26, 16, v146
    v_mfma_f32_16x16x32_bf16 v[132:135], a[200:203], a[80:83], v[132:135]
    s_waitcnt lgkmcnt(4)
    v_and_b32 v27, 0xffff0000, v146
    v_fma_f32 v26, v26, v25, v24
    v_mfma_f32_16x16x32_bf16 v[196:199], a[208:211], a[160:163], v[196:199]
    ds_read_b64_tr_b16 a[200:201], v10 offset:40960
    v_fma_f32 v27, v27, v25, v24
    v_mfma_f32_16x16x32_bf16 v[228:231], a[212:215], a[160:163], v[228:231]
    ds_read_b64_tr_b16 a[202:203], v10 offset:43008
    v_mul_f32 v30, s92, v26
    v_mfma_f32_16x16x32_bf16 v[236:239], a[212:215], a[164:167], v[236:239]
    v_mul_f32 v31, s92, v27
    v_add_f32 v33, -0.5, v33
    v_mfma_f32_16x16x32_bf16 v[204:207], a[208:211], a[164:167], v[204:207]
    v_exp_f32 v30, v30
    v_mfma_f32_16x16x32_bf16 v[212:215], a[208:211], a[168:171], v[212:215]
    ds_read_b64_tr_b16 a[204:205], v11 offset:40960
    v_add_f32 v34, -0.5, v34
    v_mfma_f32_16x16x32_bf16 v[244:247], a[212:215], a[168:171], v[244:247]
    ds_read_b64_tr_b16 a[206:207], v11 offset:43008
    v_add_f32 v35, -0.5, v35
    v_mfma_f32_16x16x32_bf16 v[252:255], a[212:215], a[172:175], v[252:255]
    v_cvt_pk_bf16_f32 v132, v132, v133
    v_cvt_pk_bf16_f32 v133, v134, v135
    v_mfma_f32_16x16x32_bf16 v[220:223], a[208:211], a[172:175], v[220:223]
    s_waitcnt lgkmcnt(4)
    v_cvt_pk_bf16_f32 v134, v164, v165
    v_cvt_pk_bf16_f32 v135, v166, v167
    v_mfma_f32_16x16x32_bf16 v[220:223], a[192:195], a[188:191], v[220:223]
    ds_read_b64_tr_b16 a[208:209], v10 offset:45056
    v_cvt_pk_bf16_f32 v140, v140, v141
    v_mfma_f32_16x16x32_bf16 v[252:255], a[196:199], a[188:191], v[252:255]
    ds_read_b64_tr_b16 a[210:211], v10 offset:47104
    v_cvt_pk_bf16_f32 v141, v142, v143
    v_mfma_f32_16x16x32_bf16 v[244:247], a[196:199], a[184:187], v[244:247]
    buffer_store_dwordx4 v[132:135], v6, s[24:27], s55 offen sc1
    v_mfma_f32_16x16x32_bf16 v[212:215], a[192:195], a[184:187], v[212:215]
    s_xor_b32 s55, s55, 1024
    v_cvt_pk_bf16_f32 v142, v172, v173
    v_cvt_pk_bf16_f32 v143, v174, v175
    v_mfma_f32_16x16x32_bf16 v[204:207], a[192:195], a[180:183], v[204:207]
    ds_read_b64_tr_b16 a[212:213], v11 offset:45056
    v_cvt_pk_bf16_f32 v148, v148, v149
    v_mfma_f32_16x16x32_bf16 v[236:239], a[196:199], a[180:183], v[236:239]
    ds_read_b64_tr_b16 a[214:215], v11 offset:47104
    v_cvt_pk_bf16_f32 v149, v150, v151
    v_mfma_f32_16x16x32_bf16 v[228:231], a[196:199], a[176:179], v[228:231]
    v_cvt_pk_bf16_f32 v150, v180, v181
    v_cvt_pk_bf16_f32 v151, v182, v183
    v_mfma_f32_16x16x32_bf16 v[196:199], a[192:195], a[176:179], v[196:199]
    s_waitcnt lgkmcnt(4)
    v_cvt_pk_bf16_f32 v156, v156, v157
    v_cvt_pk_bf16_f32 v157, v158, v159
    v_mfma_f32_16x16x32_bf16 v[196:199], a[200:203], a[0:3], v[196:199]
    ds_read_b64_tr_b16 a[192:193], v10 offset:49152
    v_cvt_pk_bf16_f32 v158, v188, v189
    v_mfma_f32_16x16x32_bf16 v[228:231], a[204:207], a[0:3], v[228:231]
    ds_read_b64_tr_b16 a[194:195], v10 offset:51200
    v_cvt_pk_bf16_f32 v159, v190, v191
    v_mfma_f32_16x16x32_bf16 v[236:239], a[204:207], a[4:7], v[236:239]
    buffer_store_dwordx4 v[140:143], v6, s[24:27], s55 offen sc1
    v_mfma_f32_16x16x32_bf16 v[204:207], a[200:203], a[4:7], v[204:207]
    s_xor_b32 s55, s55, 3072
    v_exp_f32 v31, v31
    v_mfma_f32_16x16x32_bf16 v[212:215], a[200:203], a[8:11], v[212:215]
    ds_read_b64_tr_b16 a[196:197], v11 offset:49152
    v_add_f32 v30, 1.0, v30
    v_mfma_f32_16x16x32_bf16 v[244:247], a[204:207], a[8:11], v[244:247]
    ds_read_b64_tr_b16 a[198:199], v11 offset:51200
    v_add_f32 v31, 1.0, v31
    v_mfma_f32_16x16x32_bf16 v[252:255], a[204:207], a[12:15], v[252:255]
    s_andn2_b32 s69, s67, s68
    s_and_b32 s69, s69, 255
    s_or_b32 s68, s68, s69
    v_mfma_f32_16x16x32_bf16 v[220:223], a[200:203], a[12:15], v[220:223]
    s_waitcnt lgkmcnt(4)
    v_readlane_b32 s56, v23, 0
    v_add_f32 v48, -0.5, v48
    v_mfma_f32_16x16x32_bf16 v[220:223], a[208:211], a[28:31], v[220:223]
    s_add_u32 m0, s37, 0
    ds_read_b64_tr_b16 a[200:201], v10 offset:53248
    v_add_f32 v49, -0.5, v49
    v_mfma_f32_16x16x32_bf16 v[252:255], a[212:215], a[28:31], v[252:255]
    s_bitcmp1_b32 s69, 0
    s_cselect_b32 s56, s56, 0x70000000
    s_cselect_b32 m0, m0, 0x30000
    ds_read_b64_tr_b16 a[202:203], v10 offset:55296
    v_mfma_f32_16x16x32_bf16 v[244:247], a[212:215], a[24:27], v[244:247]
    buffer_load_dwordx4 v28, s[24:27], s56 offen sc1 lds
    v_mfma_f32_16x16x32_bf16 v[212:215], a[208:211], a[24:27], v[212:215]
    v_readlane_b32 s56, v23, 1
    v_add_f32 v50, -0.5, v50
    v_mfma_f32_16x16x32_bf16 v[204:207], a[208:211], a[20:23], v[204:207]
    s_waitcnt vmcnt(5)
    ds_read_b64_tr_b16 a[204:205], v11 offset:53248
    v_cmp_ne_u32 s[78:79], 24, v137
    v_mfma_f32_16x16x32_bf16 v[236:239], a[212:215], a[20:23], v[236:239]
    s_cmp_eq_u64 s[78:79], 0
    s_cselect_b32 s44, s59, 0x70000000
    ds_read_b64_tr_b16 a[206:207], v11 offset:55296
    v_mfma_f32_16x16x32_bf16 v[228:231], a[212:215], a[16:19], v[228:231]
    buffer_load_dwordx4 v[240:243], v192, s[24:27], s44 offen sc1
    v_mfma_f32_16x16x32_bf16 v[196:199], a[208:211], a[16:19], v[196:199]
    s_waitcnt lgkmcnt(4)
    v_rcp_f32 v30, v30
    v_mfma_f32_16x16x32_bf16 v[196:199], a[192:195], a[32:35], v[196:199]
    s_add_u32 m0, s37, 1024
    ds_read_b64_tr_b16 a[208:209], v10 offset:57344
    v_add_f32 v51, -0.5, v51
    v_mfma_f32_16x16x32_bf16 v[228:231], a[196:199], a[32:35], v[228:231]
    s_bitcmp1_b32 s69, 1
    s_cselect_b32 s56, s56, 0x70000000
    s_cselect_b32 m0, m0, 0x30000
    ds_read_b64_tr_b16 a[210:211], v10 offset:59392
    v_mfma_f32_16x16x32_bf16 v[236:239], a[196:199], a[36:39], v[236:239]
    buffer_load_dwordx4 v28, s[24:27], s56 offen sc1 lds
    v_mfma_f32_16x16x32_bf16 v[204:207], a[192:195], a[36:39], v[204:207]
    v_readlane_b32 s56, v23, 2
    v_add_f32 v36, -0.5, v36
    v_mfma_f32_16x16x32_bf16 v[212:215], a[192:195], a[40:43], v[212:215]
    s_add_u32 m0, s37, 2048
    ds_read_b64_tr_b16 a[212:213], v11 offset:57344
    v_add_f32 v37, -0.5, v37
    v_mfma_f32_16x16x32_bf16 v[244:247], a[196:199], a[40:43], v[244:247]
    s_bitcmp1_b32 s69, 2
    s_cselect_b32 s56, s56, 0x70000000
    s_cselect_b32 m0, m0, 0x30000
    ds_read_b64_tr_b16 a[214:215], v11 offset:59392
    v_mfma_f32_16x16x32_bf16 v[252:255], a[196:199], a[44:47], v[252:255]
    buffer_load_dwordx4 v28, s[24:27], s56 offen sc1 lds
    v_mfma_f32_16x16x32_bf16 v[220:223], a[192:195], a[44:47], v[220:223]
    s_waitcnt lgkmcnt(4)
    v_readlane_b32 s56, v23, 3
    v_add_f32 v38, -0.5, v38
    v_mfma_f32_16x16x32_bf16 v[220:223], a[200:203], a[60:63], v[220:223]
    s_add_u32 m0, s37, 3072
    ds_read_b64_tr_b16 a[192:193], v10 offset:61440
    v_add_f32 v39, -0.5, v39
    v_mfma_f32_16x16x32_bf16 v[252:255], a[204:207], a[60:63], v[252:255]
    s_bitcmp1_b32 s69, 3
    s_cselect_b32 s56, s56, 0x70000000
    s_cselect_b32 m0, m0, 0x30000
    ds_read_b64_tr_b16 a[194:195], v10 offset:63488
    v_mfma_f32_16x16x32_bf16 v[244:247], a[204:207], a[56:59], v[244:247]
    buffer_store_dwordx4 v[148:151], v6, s[24:27], s55 offen sc1
    v_mfma_f32_16x16x32_bf16 v[212:215], a[200:203], a[56:59], v[212:215]
    s_xor_b32 s55, s55, 1024
    v_rcp_f32 v31, v31
    v_mfma_f32_16x16x32_bf16 v[204:207], a[200:203], a[52:55], v[204:207]
    ds_read_b64_tr_b16 a[196:197], v11 offset:61440
    v_mul_f32 v26, v26, v30
    v_mfma_f32_16x16x32_bf16 v[236:239], a[204:207], a[52:55], v[236:239]
    s_waitcnt vmcnt(14)
    ds_read_b64_tr_b16 a[198:199], v11 offset:63488
    v_mul_f32 v27, v27, v31
    v_mfma_f32_16x16x32_bf16 v[228:231], a[204:207], a[48:51], v[228:231]
    s_barrier
    v_mfma_f32_16x16x32_bf16 v[196:199], a[200:203], a[48:51], v[196:199]
    s_waitcnt lgkmcnt(4)
    buffer_load_dwordx4 v28, s[24:27], s56 offen sc1 lds
    v_mfma_f32_16x16x32_bf16 v[196:199], a[208:211], a[64:67], v[196:199]
    s_waitcnt vmcnt(9)
    ds_read_b64_tr_b16 a[200:201], v18 offset:0
    v_readlane_b32 s56, v23, 4
    v_mfma_f32_16x16x32_bf16 v[228:231], a[212:215], a[64:67], v[228:231]
    s_add_u32 m0, s37, 4096
    ds_read_b64_tr_b16 a[202:203], v18 offset:1024
    v_cvt_pk_bf16_f32 v170, v26, v27
    v_mfma_f32_16x16x32_bf16 v[236:239], a[212:215], a[68:71], v[236:239]
    buffer_atomic_or v128, v3, s[24:27], 0 offen offset:0
    v_mfma_f32_16x16x32_bf16 v[204:207], a[208:211], a[68:71], v[204:207]
    buffer_store_dwordx4 v[156:159], v6, s[24:27], s55 offen sc1
    v_mfma_f32_16x16x32_bf16 v[212:215], a[208:211], a[72:75], v[212:215]
    s_bitcmp1_b32 s69, 4
    s_cselect_b32 s56, s56, 0x70000000
    s_cselect_b32 m0, m0, 0x30000
    ds_read_b64_tr_b16 a[204:205], v19 offset:0
    v_mfma_f32_16x16x32_bf16 v[244:247], a[212:215], a[72:75], v[244:247]
    s_xor_b32 s55, s55, 3072
    ds_read_b64_tr_b16 a[206:207], v19 offset:1024
    v_lshlrev_b32 v26, 16, v147
    v_mfma_f32_16x16x32_bf16 v[252:255], a[212:215], a[76:79], v[252:255]
    s_add_u32 s55, s55, 16384
    v_and_b32 v27, 0xffff0000, v147
    v_fma_f32 v26, v26, v25, v24
    v_mfma_f32_16x16x32_bf16 v[220:223], a[208:211], a[76:79], v[220:223]
    s_waitcnt lgkmcnt(4)
    buffer_load_dwordx4 v28, s[24:27], s56 offen sc1 lds
    v_mfma_f32_16x16x32_bf16 v[220:223], a[192:195], a[92:95], v[220:223]
    ds_read_b64_tr_b16 a[208:209], v18 offset:2048
    v_readlane_b32 s56, v23, 5
    v_mfma_f32_16x16x32_bf16 v[252:255], a[196:199], a[92:95], v[252:255]
    s_add_u32 m0, s37, 5120
    ds_read_b64_tr_b16 a[210:211], v18 offset:3072
    v_fma_f32 v27, v27, v25, v24
    v_mfma_f32_16x16x32_bf16 v[244:247], a[196:199], a[88:91], v[244:247]
    s_bitcmp1_b32 s69, 5
    s_cselect_b32 s56, s56, 0x70000000
    s_cselect_b32 m0, m0, 0x30000
    v_mfma_f32_16x16x32_bf16 v[212:215], a[192:195], a[88:91], v[212:215]
    buffer_load_dwordx4 v28, s[24:27], s56 offen sc1 lds
    v_mfma_f32_16x16x32_bf16 v[204:207], a[192:195], a[84:87], v[204:207]
    ds_read_b64_tr_b16 a[212:213], v19 offset:2048
    v_readlane_b32 s56, v23, 6
    v_mfma_f32_16x16x32_bf16 v[236:239], a[196:199], a[84:87], v[236:239]
    s_add_u32 m0, s37, 6144
    ds_read_b64_tr_b16 a[214:215], v19 offset:3072
    v_mul_f32 v30, s92, v26
    v_add_f32 v52, -0.5, v52
    v_add_f32 v53, -0.5, v53
    v_add_f32 v54, -0.5, v54
    v_add_f32 v55, -0.5, v55
    v_add_f32 v40, -0.5, v40
    v_add_f32 v41, -0.5, v41
    v_add_f32 v42, -0.5, v42
    v_add_f32 v43, -0.5, v43
    v_add_f32 v56, -0.5, v56
    v_add_f32 v57, -0.5, v57
    v_add_f32 v58, -0.5, v58
    v_add_f32 v59, -0.5, v59
    v_add_f32 v44, -0.5, v44
    v_add_f32 v45, -0.5, v45
    v_add_f32 v46, -0.5, v46
    v_add_f32 v47, -0.5, v47
    v_add_f32 v60, -0.5, v60
    v_add_f32 v61, -0.5, v61
    v_add_f32 v62, -0.5, v62
    v_add_f32 v63, -0.5, v63
    v_mfma_f32_16x16x32_bf16 v[228:231], a[196:199], a[80:83], v[228:231]
    s_bitcmp1_b32 s69, 6
    s_cselect_b32 s56, s56, 0x70000000
    s_cselect_b32 m0, m0, 0x30000
    v_mfma_f32_16x16x32_bf16 v[196:199], a[192:195], a[80:83], v[196:199]
    s_waitcnt lgkmcnt(4)
    buffer_load_dwordx4 v28, s[24:27], s56 offen sc1 lds
    v_mfma_f32_16x16x32_bf16 v[32:35], a[200:203], a[160:163], v[32:35]
    ds_read_b64_tr_b16 a[192:193], v18 offset:4096
    v_readlane_b32 s56, v23, 7
    v_mfma_f32_16x16x32_bf16 v[48:51], a[204:207], a[160:163], v[48:51]
    s_add_u32 m0, s37, 7168
    ds_read_b64_tr_b16 a[194:195], v18 offset:5120
    v_mul_f32 v31, s92, v27
    v_mfma_f32_16x16x32_bf16 v[52:55], a[204:207], a[164:167], v[52:55]
    s_bitcmp1_b32 s69, 7
    s_cselect_b32 s56, s56, 0x70000000
    s_cselect_b32 m0, m0, 0x30000
    v_mfma_f32_16x16x32_bf16 v[36:39], a[200:203], a[164:167], v[36:39]
    buffer_load_dwordx4 v28, s[24:27], s56 offen sc1 lds
    v_mfma_f32_16x16x32_bf16 v[40:43], a[200:203], a[168:171], v[40:43]
    ds_read_b64_tr_b16 a[196:197], v19 offset:4096
    v_and_b32 v4, 0x300, v28
    v_mfma_f32_16x16x32_bf16 v[56:59], a[204:207], a[168:171], v[56:59]
    ds_read_b64_tr_b16 a[198:199], v19 offset:5120
    v_add3_u32 v4, v4, v28, s37
    v_mfma_f32_16x16x32_bf16 v[60:63], a[204:207], a[172:175], v[60:63]
    v_cvt_pk_bf16_f32 v196, v196, v197
    v_cvt_pk_bf16_f32 v197, v198, v199
    v_mfma_f32_16x16x32_bf16 v[44:47], a[200:203], a[172:175], v[44:47]
    s_waitcnt lgkmcnt(4)
    v_cvt_pk_bf16_f32 v198, v228, v229
    v_cvt_pk_bf16_f32 v199, v230, v231
    v_mfma_f32_16x16x32_bf16 v[44:47], a[208:211], a[188:191], v[44:47]
    ds_read_b64_tr_b16 a[200:201], v18 offset:6144
    v_cvt_pk_bf16_f32 v204, v204, v205
    v_mfma_f32_16x16x32_bf16 v[60:63], a[212:215], a[188:191], v[60:63]
    ds_read_b64_tr_b16 a[202:203], v18 offset:7168
    v_cvt_pk_bf16_f32 v205, v206, v207
    v_mfma_f32_16x16x32_bf16 v[56:59], a[212:215], a[184:187], v[56:59]
    buffer_store_dwordx4 v[196:199], v6, s[24:27], s55 offen sc1
    v_mfma_f32_16x16x32_bf16 v[40:43], a[208:211], a[184:187], v[40:43]
    s_xor_b32 s55, s55, 1024
    v_cvt_pk_bf16_f32 v206, v236, v237
    v_cvt_pk_bf16_f32 v207, v238, v239
    v_mfma_f32_16x16x32_bf16 v[36:39], a[208:211], a[180:183], v[36:39]
    ds_read_b64_tr_b16 a[204:205], v19 offset:6144
    v_cvt_pk_bf16_f32 v212, v212, v213
    v_mfma_f32_16x16x32_bf16 v[52:55], a[212:215], a[180:183], v[52:55]
    ds_read_b64_tr_b16 a[206:207], v19 offset:7168
    v_cvt_pk_bf16_f32 v213, v214, v215
    v_mfma_f32_16x16x32_bf16 v[48:51], a[212:215], a[176:179], v[48:51]
    v_cvt_pk_bf16_f32 v214, v244, v245
    v_cvt_pk_bf16_f32 v215, v246, v247
    v_mfma_f32_16x16x32_bf16 v[32:35], a[208:211], a[176:179], v[32:35]
    s_waitcnt lgkmcnt(4)
    v_cvt_pk_bf16_f32 v220, v220, v221
    v_cvt_pk_bf16_f32 v221, v222, v223
    v_mfma_f32_16x16x32_bf16 v[32:35], a[192:195], a[0:3], v[32:35]
    ds_read_b64_tr_b16 a[208:209], v18 offset:8192
    v_cvt_pk_bf16_f32 v222, v252, v253
    v_mfma_f32_16x16x32_bf16 v[48:51], a[196:199], a[0:3], v[48:51]
    ds_read_b64_tr_b16 a[210:211], v18 offset:9216
    v_cvt_pk_bf16_f32 v223, v254, v255
    v_mfma_f32_16x16x32_bf16 v[52:55], a[196:199], a[4:7], v[52:55]
    buffer_store_dwordx4 v[204:207], v6, s[24:27], s55 offen sc1
    v_mfma_f32_16x16x32_bf16 v[36:39], a[192:195], a[4:7], v[36:39]
    s_xor_b32 s55, s55, 3072
    v_exp_f32 v30, v30
    v_mfma_f32_16x16x32_bf16 v[40:43], a[192:195], a[8:11], v[40:43]
    ds_read_b64_tr_b16 a[212:213], v19 offset:8192
    v_mfma_f32_16x16x32_bf16 v[56:59], a[196:199], a[8:11], v[56:59]
    ds_read_b64_tr_b16 a[214:215], v19 offset:9216
    v_mfma_f32_16x16x32_bf16 v[60:63], a[196:199], a[12:15], v[60:63]
    v_exp_f32 v31, v31
    v_mfma_f32_16x16x32_bf16 v[44:47], a[192:195], a[12:15], v[44:47]
    s_waitcnt lgkmcnt(4)
    v_add_f32 v30, 1.0, v30
    v_add_f32 v31, 1.0, v31
    v_mfma_f32_16x16x32_bf16 v[44:47], a[200:203], a[28:31], v[44:47]
    ds_read_b64_tr_b16 a[192:193], v18 offset:10240
    v_mfma_f32_16x16x32_bf16 v[60:63], a[204:207], a[28:31], v[60:63]
    ds_read_b64_tr_b16 a[194:195], v18 offset:11264
    v_mfma_f32_16x16x32_bf16 v[56:59], a[204:207], a[24:27], v[56:59]
    s_waitcnt vmcnt(6)
    v_rcp_f32 v30, v30
    v_mfma_f32_16x16x32_bf16 v[40:43], a[200:203], a[24:27], v[40:43]
    buffer_atomic_or v129, v3, s[24:27], 0 offen offset:0
    v_mfma_f32_16x16x32_bf16 v[36:39], a[200:203], a[20:23], v[36:39]
    ds_read_b64_tr_b16 a[196:197], v19 offset:10240
    v_mfma_f32_16x16x32_bf16 v[52:55], a[204:207], a[20:23], v[52:55]
    ds_read_b64_tr_b16 a[198:199], v19 offset:11264
    v_mfma_f32_16x16x32_bf16 v[48:51], a[204:207], a[16:19], v[48:51]
    buffer_store_dwordx4 v[212:215], v6, s[24:27], s55 offen sc1
    v_mfma_f32_16x16x32_bf16 v[32:35], a[200:203], a[16:19], v[32:35]
    s_waitcnt lgkmcnt(4)
    v_rcp_f32 v31, v31
    v_mfma_f32_16x16x32_bf16 v[32:35], a[208:211], a[32:35], v[32:35]
    s_xor_b32 s55, s55, 1024
    ds_read_b64_tr_b16 a[200:201], v18 offset:12288
    v_mul_f32 v26, v26, v30
    v_mfma_f32_16x16x32_bf16 v[48:51], a[212:215], a[32:35], v[48:51]
pg_13:
    s_cbranch_execz pg_ret2
    ds_read_b64_tr_b16 a[202:203], v18 offset:13312
    v_mul_f32 v27, v27, v31
    v_mfma_f32_16x16x32_bf16 v[52:55], a[212:215], a[36:39], v[52:55]
    v_cvt_pk_bf16_f32 v171, v26, v27
    s_waitcnt vmcnt(33)
    v_mfma_f32_16x16x32_bf16 v[36:39], a[208:211], a[36:39], v[36:39]
    v_lshlrev_b32 v26, 16, v160
    v_and_b32 v27, 0xffff0000, v160
    v_mfma_f32_16x16x32_bf16 v[40:43], a[208:211], a[40:43], v[40:43]
    ds_read_b64_tr_b16 a[204:205], v19 offset:12288
    v_fma_f32 v26, v26, v25, v24
    v_mfma_f32_16x16x32_bf16 v[56:59], a[212:215], a[40:43], v[56:59]
    ds_read_b64_tr_b16 a[206:207], v19 offset:13312
    v_fma_f32 v27, v27, v25, v24
    v_mfma_f32_16x16x32_bf16 v[60:63], a[212:215], a[44:47], v[60:63]
    v_mul_f32 v30, s92, v26
    v_mul_f32 v31, s92, v27
    v_mfma_f32_16x16x32_bf16 v[44:47], a[208:211], a[44:47], v[44:47]
    s_waitcnt lgkmcnt(4)
    v_exp_f32 v30, v30
    v_mfma_f32_16x16x32_bf16 v[44:47], a[192:195], a[60:63], v[44:47]
    ds_read_b64_tr_b16 a[208:209], v18 offset:14336
    v_mfma_f32_16x16x32_bf16 v[60:63], a[196:199], a[60:63], v[60:63]
    ds_read_b64_tr_b16 a[210:211], v18 offset:15360
    v_mfma_f32_16x16x32_bf16 v[56:59], a[196:199], a[56:59], v[56:59]
    buffer_store_dwordx4 v[220:223], v6, s[24:27], s55 offen sc1
    v_mfma_f32_16x16x32_bf16 v[40:43], a[192:195], a[56:59], v[40:43]
    s_xor_b32 s55, s55, 3072
    v_exp_f32 v31, v31
    v_mfma_f32_16x16x32_bf16 v[36:39], a[192:195], a[52:55], v[36:39]
    s_add_u32 s55, s55, 16384
    ds_read_b64_tr_b16 a[212:213], v19 offset:14336
    v_add_f32 v30, 1.0, v30
    v_mfma_f32_16x16x32_bf16 v[52:55], a[196:199], a[52:55], v[52:55]
    ds_read_b64_tr_b16 a[214:215], v19 offset:15360
    v_add_f32 v31, 1.0, v31
    v_mfma_f32_16x16x32_bf16 v[48:51], a[196:199], a[48:51], v[48:51]
    v_rcp_f32 v30, v30
    v_mfma_f32_16x16x32_bf16 v[32:35], a[192:195], a[48:51], v[32:35]
    s_waitcnt lgkmcnt(4)
    v_rcp_f32 v31, v31
    v_mfma_f32_16x16x32_bf16 v[32:35], a[200:203], a[64:67], v[32:35]
    v_mul_f32 v26, v26, v30
    v_mul_f32 v27, v27, v31
    v_mfma_f32_16x16x32_bf16 v[48:51], a[204:207], a[64:67], v[48:51]
    v_cvt_pk_bf16_f32 v184, v26, v27
    v_lshlrev_b32 v26, 16, v161
    v_mfma_f32_16x16x32_bf16 v[52:55], a[204:207], a[68:71], v[52:55]
    v_and_b32 v27, 0xffff0000, v161
    v_fma_f32 v26, v26, v25, v24
    v_mfma_f32_16x16x32_bf16 v[36:39], a[200:203], a[68:71], v[36:39]
    v_fma_f32 v27, v27, v25, v24
    v_mul_f32 v30, s92, v26
    v_mfma_f32_16x16x32_bf16 v[40:43], a[200:203], a[72:75], v[40:43]
    v_mul_f32 v31, s92, v27
    v_mfma_f32_16x16x32_bf16 v[56:59], a[204:207], a[72:75], v[56:59]
    v_exp_f32 v30, v30
    v_mfma_f32_16x16x32_bf16 v[60:63], a[204:207], a[76:79], v[60:63]
    v_exp_f32 v31, v31
    v_mfma_f32_16x16x32_bf16 v[44:47], a[200:203], a[76:79], v[44:47]
    s_waitcnt lgkmcnt(0)
    v_add_f32 v30, 1.0, v30
    v_add_f32 v31, 1.0, v31
    v_mfma_f32_16x16x32_bf16 v[44:47], a[208:211], a[92:95], v[44:47]
    s_load_dword s67, s[86:87], s5 glc
    v_rcp_f32 v30, v30
    v_mfma_f32_16x16x32_bf16 v[60:63], a[212:215], a[92:95], v[60:63]
    v_rcp_f32 v31, v31
    v_mfma_f32_16x16x32_bf16 v[56:59], a[212:215], a[88:91], v[56:59]
    v_mul_f32 v26, v26, v30
    v_mul_f32 v27, v27, v31
    v_mfma_f32_16x16x32_bf16 v[40:43], a[208:211], a[88:91], v[40:43]
    v_cvt_pk_bf16_f32 v185, v26, v27
    v_lshlrev_b32 v26, 16, v162
    v_mfma_f32_16x16x32_bf16 v[36:39], a[208:211], a[84:87], v[36:39]
    v_and_b32 v27, 0xffff0000, v162
    v_fma_f32 v26, v26, v25, v24
    v_mfma_f32_16x16x32_bf16 v[52:55], a[212:215], a[84:87], v[52:55]
    v_fma_f32 v27, v27, v25, v24
    v_mul_f32 v30, s92, v26
    v_mfma_f32_16x16x32_bf16 v[48:51], a[212:215], a[80:83], v[48:51]
    v_mul_f32 v31, s92, v27
    v_mfma_f32_16x16x32_bf16 v[32:35], a[208:211], a[80:83], v[32:35]
    v_exp_f32 v30, v30
    s_nop 7
    v_cvt_pk_bf16_f32 v32, v32, v33
    v_cvt_pk_bf16_f32 v33, v34, v35
    v_cvt_pk_bf16_f32 v34, v48, v49
    v_cvt_pk_bf16_f32 v35, v50, v51
    buffer_store_dwordx4 v[32:35], v7, s[24:27], s55 offen sc1
    s_xor_b32 s55, s55, 1024
    v_cvt_pk_bf16_f32 v36, v36, v37
    v_cvt_pk_bf16_f32 v37, v38, v39
    v_cvt_pk_bf16_f32 v38, v52, v53
    v_cvt_pk_bf16_f32 v39, v54, v55
    buffer_store_dwordx4 v[36:39], v7, s[24:27], s55 offen sc1
    s_xor_b32 s55, s55, 3072
    v_cvt_pk_bf16_f32 v40, v40, v41
    v_cvt_pk_bf16_f32 v41, v42, v43
    v_cvt_pk_bf16_f32 v42, v56, v57
    v_cvt_pk_bf16_f32 v43, v58, v59
    buffer_store_dwordx4 v[40:43], v7, s[24:27], s55 offen sc1
    s_xor_b32 s55, s55, 1024
    v_cvt_pk_bf16_f32 v44, v44, v45
    v_cvt_pk_bf16_f32 v45, v46, v47
    v_cvt_pk_bf16_f32 v46, v60, v61
    v_cvt_pk_bf16_f32 v47, v62, v63
    buffer_store_dwordx4 v[44:47], v7, s[24:27], s55 offen sc1
    s_xor_b32 s55, s55, 3072
    s_add_u32 s55, s55, 16384
    v_exp_f32 v31, v31
    s_nop 0
    v_add_f32 v30, 1.0, v30
    v_add_f32 v31, 1.0, v31
    v_rcp_f32 v30, v30
    v_rcp_f32 v31, v31
    s_nop 0
    v_mul_f32 v26, v26, v30
    v_mul_f32 v27, v27, v31
    v_cvt_pk_bf16_f32 v186, v26, v27
    v_lshlrev_b32 v26, 16, v163
    v_and_b32 v27, 0xffff0000, v163
    v_fma_f32 v26, v26, v25, v24
    v_fma_f32 v27, v27, v25, v24
    v_mul_f32 v30, s92, v26
    v_mul_f32 v31, s92, v27
    v_exp_f32 v30, v30
    v_exp_f32 v31, v31
    s_nop 0
    v_add_f32 v30, 1.0, v30
    v_add_f32 v31, 1.0, v31
    v_rcp_f32 v30, v30
    v_rcp_f32 v31, v31
    s_nop 0
    v_mul_f32 v26, v26, v30
    v_mul_f32 v27, v27, v31
    v_cvt_pk_bf16_f32 v187, v26, v27
    s_waitcnt vmcnt(37)
post_code:
    s_mov_b32 s8, 0xff
    s_bitcmp0_b32 s53, 0
    s_cselect_b32 s8, 0xffff, s8
    s_bitcmp0_b32 s53, 0
    s_cselect_b32 s60, 0, 0xff00
    s_mov_b32 s9, 1
    s_mov_b32 s55, s68
    s_waitcnt vmcnt(4)
    buffer_atomic_or v130, v3, s[24:27], 0 offen offset:0
    s_waitcnt lgkmcnt(0)
    s_andn2_b32 s69, s67, s68
    s_load_dword s67, s[86:87], s5 glc
    s_or_b32 s68, s68, s69
    s_and_b32 s8, s69, s8
    s_andn2_b32 s69, s69, s8
    s_cmp_lg_u32 s8, 0
    s_cbranch_scc0 e0_issued
e0_iss:
    s_ff1_i32_b32 s56, s8
    v_readlane_b32 s57, v23, s56
    s_lshl_b32 s39, s56, 10
    s_add_u32 m0, s37, s39
    s_bitset0_b32 s8, s56
    s_add_u32 s9, s9, 1
    s_cmp_lg_u32 s8, 0
    buffer_load_dwordx4 v28, s[24:27], s57 offen sc1 lds
    s_cbranch_scc1 e0_iss
e0_issued:
    s_bitcmp0_b32 s53, 0
    s_cbranch_scc0 gp_skip
    v_lshlrev_b32 v26, 16, v152
    v_and_b32 v27, 0xffff0000, v152
    v_fma_f32 v26, v26, v25, v24
    v_fma_f32 v27, v27, v25, v24
    v_mul_f32 v30, s92, v26
    v_mul_f32 v31, s92, v27
    v_exp_f32 v30, v30
    v_exp_f32 v31, v31
    s_nop 0
    v_add_f32 v30, 1.0, v30
    v_add_f32 v31, 1.0, v31
    v_rcp_f32 v30, v30
    v_rcp_f32 v31, v31
    s_nop 0
    v_mul_f32 v26, v26, v30
    v_mul_f32 v27, v27, v31
    v_cvt_pk_bf16_f32 v176, v26, v27
    v_lshlrev_b32 v26, 16, v153
    v_and_b32 v27, 0xffff0000, v153
    v_fma_f32 v26, v26, v25, v24
    v_fma_f32 v27, v27, v25, v24
    v_mul_f32 v30, s92, v26
    v_mul_f32 v31, s92, v27
    v_exp_f32 v30, v30
    v_exp_f32 v31, v31
    s_nop 0
    v_add_f32 v30, 1.0, v30
    v_add_f32 v31, 1.0, v31
    v_rcp_f32 v30, v30
    v_rcp_f32 v31, v31
    s_nop 0
    v_mul_f32 v26, v26, v30
    v_mul_f32 v27, v27, v31
    v_cvt_pk_bf16_f32 v177, v26, v27
    v_lshlrev_b32 v26, 16, v154
    v_and_b32 v27, 0xffff0000, v154
    v_fma_f32 v26, v26, v25, v24
    v_fma_f32 v27, v27, v25, v24
    v_mul_f32 v30, s92, v26
    v_mul_f32 v31, s92, v27
    v_exp_f32 v30, v30
    v_exp_f32 v31, v31
    s_nop 0
    v_add_f32 v30, 1.0, v30
    v_add_f32 v31, 1.0, v31
    v_rcp_f32 v30, v30
    v_rcp_f32 v31, v31
    s_nop 0
    v_mul_f32 v26, v26, v30
    v_mul_f32 v27, v27, v31
    v_cvt_pk_bf16_f32 v178, v26, v27
    v_lshlrev_b32 v26, 16, v155
    v_and_b32 v27, 0xffff0000, v155
    v_fma_f32 v26, v26, v25, v24
    v_fma_f32 v27, v27, v25, v24
    v_mul_f32 v30, s92, v26
    v_mul_f32 v31, s92, v27
    v_exp_f32 v30, v30
    v_exp_f32 v31, v31
    s_nop 0
    v_add_f32 v30, 1.0, v30
    v_add_f32 v31, 1.0, v31
    v_rcp_f32 v30, v30
    v_rcp_f32 v31, v31
    s_nop 0
    v_mul_f32 v26, v26, v30
    v_mul_f32 v27, v27, v31
    v_cvt_pk_bf16_f32 v179, v26, v27
gp_skip:
w4:
    s_getreg_b32 s56, hwreg(HW_REG_IB_STS)
    s_bfe_u32 s57, s56, 0x20016
    s_and_b32 s56, s56, 15
    s_lshl4_add_u32 s56, s57, s56
    s_cmp_gt_u32 s56, s9
    s_cbranch_scc1 w4
    buffer_atomic_or v130, v131, s[24:27], 0 offen offset:512
    s_mov_b32 s9, 1
    s_lshr_b32 s56, s53, 1
    s_cmp_eq_u32 s56, s3
    s_cbranch_scc0 own_share_ret
    s_lshl_b32 s56, s53, 10
    v_add_u32 v8, s56, v28
    v_add_u32 v11, 73728, v8
    v_add_u32 v10, 49152, v8
    v_add_u32 v9, 24576, v8
    v_add_u32 v8, 0, v8
    s_bitcmp1_b32 s53, 0
    s_cbranch_scc1 own_odd
    ds_write_b128 v8, v[196:199] offset:16384
    ds_write_b128 v9, v[204:207] offset:16384
    ds_write_b128 v10, v[212:215] offset:16384
    ds_write_b128 v11, v[220:223] offset:16384
    ds_write_b128 v8, v[132:135] offset:8192
    ds_write_b128 v9, v[140:143] offset:8192
    ds_write_b128 v10, v[148:151] offset:8192
    ds_write_b128 v11, v[156:159] offset:8192
    ds_write_b128 v8, v[68:71] offset:0
    ds_write_b128 v9, v[76:79] offset:0
    ds_write_b128 v10, v[84:87] offset:0
    ds_write_b128 v11, v[92:95] offset:0
    s_branch own_share_ret
own_odd:
    ds_write_b128 v8, v[32:35] offset:16384
    ds_write_b128 v9, v[36:39] offset:16384
    ds_write_b128 v10, v[40:43] offset:16384
    ds_write_b128 v11, v[44:47] offset:16384
    ds_write_b128 v8, v[64:67] offset:0
    ds_write_b128 v9, v[80:83] offset:0
    ds_write_b128 v10, v[96:99] offset:0
    ds_write_b128 v11, v[112:115] offset:0
own_share_ret:
    s_cmp_lg_u32 s69, 0
    s_cbranch_scc0 e1_issued
e1_iss:
    s_ff1_i32_b32 s56, s69
    v_readlane_b32 s57, v23, s56
    s_lshl_b32 s39, s56, 10
    s_add_u32 m0, s37, s39
    s_bitset0_b32 s69, s56
    s_mov_b32 s9, 0
    s_cmp_lg_u32 s69, 0
    buffer_load_dwordx4 v28, s[24:27], s57 offen sc1 lds
    s_cbranch_scc1 e1_iss
e1_issued:
    s_waitcnt lgkmcnt(0)
    s_barrier
    s_cmp_lg_u64 s[88:89], 0
    s_cbranch_scc1 routed
routed_ret:
ev_loop:
    s_waitcnt lgkmcnt(0)
    s_getreg_b32 s56, hwreg(HW_REG_IB_STS)
    s_bfe_u32 s57, s56, 0x20016
    s_and_b32 s56, s56, 15
    s_lshl4_add_u32 s56, s57, s56
    s_cmp_gt_u32 s56, s9
    s_cselect_b32 s55, s55, s68
    s_andn2_b32 s69, s67, s68
    s_or_b32 s68, s68, s69
    s_cmp_eq_u32 s68, 0xffffff
    s_cbranch_scc1 ev_nopoll
    s_load_dword s67, s[86:87], s5 glc
ev_nopoll:
    s_cmp_lg_u32 s69, 0
    s_cbranch_scc0 ev_issued
ev_iss:
    s_ff1_i32_b32 s56, s69
    v_readlane_b32 s57, v23, s56
    s_lshl_b32 s39, s56, 10
    s_add_u32 m0, s37, s39
    s_bitset0_b32 s69, s56
    s_mov_b32 s9, 0
    s_cmp_lg_u32 s69, 0
    buffer_load_dwordx4 v28, s[24:27], s57 offen sc1 lds
    s_cbranch_scc1 ev_iss
ev_issued:
ev_sel:
    s_andn2_b32 s8, s55, s60
    s_bfe_u32 s56, s8, 524288
    s_cmp_eq_u32 s56, 0xff
    s_cbranch_scc0 ev_r0
    s_or_b32 s60, s60, 255
    s_mov_b32 s38, s41
    ds_read_b128 v[132:135], v4 offset:0
    ds_read_b128 v[140:143], v4 offset:256
    ds_read_b128 v[148:151], v4 offset:2048
    ds_read_b128 v[156:159], v4 offset:2304
    ds_read_b128 v[164:167], v4 offset:4096
    ds_read_b128 v[172:175], v4 offset:4352
    ds_read_b128 v[180:183], v4 offset:6144
    ds_read_b128 v[188:191], v4 offset:6400
    v_lshlrev_b32 v84, 16, v168
    v_and_b32 v85, 0xffff0000, v168
    v_lshlrev_b32 v100, 16, v144
    v_and_b32 v101, 0xffff0000, v144
    v_lshlrev_b32 v86, 16, v169
    v_and_b32 v87, 0xffff0000, v169
    v_lshlrev_b32 v102, 16, v145
    v_and_b32 v103, 0xffff0000, v145
    v_lshlrev_b32 v92, 16, v170
    v_and_b32 v93, 0xffff0000, v170
    v_lshlrev_b32 v108, 16, v146
    v_and_b32 v109, 0xffff0000, v146
    v_lshlrev_b32 v94, 16, v171
    v_and_b32 v95, 0xffff0000, v171
    v_lshlrev_b32 v110, 16, v147
    v_and_b32 v111, 0xffff0000, v147
    s_branch ev_go
ev_r0:
    s_bfe_u32 s56, s8, 524296
    s_cmp_eq_u32 s56, 0xff
    s_cbranch_scc0 ev_r1
    s_or_b32 s60, s60, 65280
    s_mov_b32 s38, s42
    ds_read_b128 v[132:135], v4 offset:8192
    ds_read_b128 v[140:143], v4 offset:8448
    ds_read_b128 v[148:151], v4 offset:10240
    ds_read_b128 v[156:159], v4 offset:10496
    ds_read_b128 v[164:167], v4 offset:12288
    ds_read_b128 v[172:175], v4 offset:12544
    ds_read_b128 v[180:183], v4 offset:14336
    ds_read_b128 v[188:191], v4 offset:14592
    v_lshlrev_b32 v84, 16, v176
    v_and_b32 v85, 0xffff0000, v176
    v_lshlrev_b32 v100, 16, v152
    v_and_b32 v101, 0xffff0000, v152
    v_lshlrev_b32 v86, 16, v177
    v_and_b32 v87, 0xffff0000, v177
    v_lshlrev_b32 v102, 16, v153
    v_and_b32 v103, 0xffff0000, v153
    v_lshlrev_b32 v92, 16, v178
    v_and_b32 v93, 0xffff0000, v178
    v_lshlrev_b32 v108, 16, v154
    v_and_b32 v109, 0xffff0000, v154
    v_lshlrev_b32 v94, 16, v179
    v_and_b32 v95, 0xffff0000, v179
    v_lshlrev_b32 v110, 16, v155
    v_and_b32 v111, 0xffff0000, v155
    s_branch ev_go
ev_r1:
    s_bfe_u32 s56, s8, 524304
    s_cmp_eq_u32 s56, 0xff
    s_cbranch_scc0 ev_r2
    s_or_b32 s60, s60, 16711680
    s_mov_b32 s38, s43
    ds_read_b128 v[132:135], v4 offset:16384
    ds_read_b128 v[140:143], v4 offset:16640
    ds_read_b128 v[148:151], v4 offset:18432
    ds_read_b128 v[156:159], v4 offset:18688
    ds_read_b128 v[164:167], v4 offset:20480
    ds_read_b128 v[172:175], v4 offset:20736
    ds_read_b128 v[180:183], v4 offset:22528
    ds_read_b128 v[188:191], v4 offset:22784
    v_lshlrev_b32 v84, 16, v184
    v_and_b32 v85, 0xffff0000, v184
    v_lshlrev_b32 v100, 16, v160
    v_and_b32 v101, 0xffff0000, v160
    v_lshlrev_b32 v86, 16, v185
    v_and_b32 v87, 0xffff0000, v185
    v_lshlrev_b32 v102, 16, v161
    v_and_b32 v103, 0xffff0000, v161
    v_lshlrev_b32 v92, 16, v186
    v_and_b32 v93, 0xffff0000, v186
    v_lshlrev_b32 v108, 16, v162
    v_and_b32 v109, 0xffff0000, v162
    v_lshlrev_b32 v94, 16, v187
    v_and_b32 v95, 0xffff0000, v187
    v_lshlrev_b32 v110, 16, v163
    v_and_b32 v111, 0xffff0000, v163
    s_branch ev_go
ev_r2:
    s_cmp_eq_u32 s68, 0xffffff
    s_cbranch_scc0 ev_more
w5:
    s_getreg_b32 s56, hwreg(HW_REG_IB_STS)
    s_bfe_u32 s57, s56, 0x20016
    s_and_b32 s56, s56, 15
    s_lshl4_add_u32 s56, s57, s56
    s_cmp_gt_u32 s56, s9
    s_cbranch_scc1 w5
    s_mov_b32 s55, s68
    s_branch ev_sel
ev_more:
    s_add_u32 s101, s101, 1
    s_cmp_gt_u32 s101, 0x2000000
    s_cbranch_scc0 ev_loop
    s_branch ev_done
ev_go:
    s_waitcnt lgkmcnt(7)
    v_mfma_f32_16x16x32_bf16 v[68:71], v[208:211], v[132:135], 0
    s_waitcnt lgkmcnt(6)
    v_mfma_f32_16x16x32_bf16 v[76:79], v[208:211], v[140:143], 0
    s_waitcnt lgkmcnt(5)
    v_mfma_f32_16x16x32_bf16 v[68:71], v[208:211], v[148:151], v[68:71]
    s_waitcnt lgkmcnt(4)
    v_mfma_f32_16x16x32_bf16 v[76:79], v[208:211], v[156:159], v[76:79]
    s_waitcnt lgkmcnt(3)
    v_mfma_f32_16x16x32_bf16 v[68:71], v[208:211], v[164:167], v[68:71]
    s_waitcnt lgkmcnt(2)
    v_mfma_f32_16x16x32_bf16 v[76:79], v[208:211], v[172:175], v[76:79]
    s_waitcnt lgkmcnt(1)
    v_mfma_f32_16x16x32_bf16 v[68:71], v[208:211], v[180:183], v[68:71]
    s_waitcnt lgkmcnt(0)
    v_mfma_f32_16x16x32_bf16 v[76:79], v[208:211], v[188:191], v[76:79]
    s_nop 6
    v_pk_fma_f32 v[68:69], v[68:69], v[84:85], v[100:101]
    v_pk_fma_f32 v[70:71], v[70:71], v[86:87], v[102:103]
    v_pk_fma_f32 v[76:77], v[76:77], v[92:93], v[108:109]
    v_pk_fma_f32 v[78:79], v[78:79], v[94:95], v[110:111]
    v_cvt_pk_bf16_f32 v124, v68, v69
    v_cvt_pk_bf16_f32 v125, v70, v71
    v_cvt_pk_bf16_f32 v126, v76, v77
    v_cvt_pk_bf16_f32 v127, v78, v79
    buffer_store_dwordx4 v[124:127], v22, s[32:35], s38 offen sc1
    s_add_u32 s9, s9, 1
    s_cmp_lg_u32 s60, 0xffffff
    s_cbranch_scc1 ev_sel
ev_done:
    s_or_b32 s56, s2, s3
    s_cbranch_scc1 main_fin
    v_mov_b32 v8, s7
    v_mov_b32 v9, 3203072
    s_mov_b64 exec, 1
    buffer_store_dword v8, v9, s[24:27], 0 offen
main_fin:
main_end:
    s_endpgm
spin_o0:
    s_load_dword s72, s[86:87], s5 offset:4 glc
    s_add_u32 s101, s101, 1
    s_cmp_gt_u32 s101, 0x2000000
    s_waitcnt lgkmcnt(0)
    s_cbranch_scc1 spin_o0_ret
    s_bfe_u32 s88, s72, 262144
    s_cmp_lg_u32 s88, 15
    s_cbranch_scc1 spin_o0
    s_branch spin_o0_ret
spin_o1:
    s_load_dword s72, s[86:87], s5 offset:4 glc
    s_add_u32 s101, s101, 1
    s_cmp_gt_u32 s101, 0x2000000
    s_waitcnt lgkmcnt(0)
    s_cbranch_scc1 spin_o1_ret
    s_bfe_u32 s88, s72, 262148
    s_cmp_lg_u32 s88, 15
    s_cbranch_scc1 spin_o1
    s_branch spin_o1_ret
spin_o2:
    s_load_dword s72, s[86:87], s5 offset:4 glc
    s_add_u32 s101, s101, 1
    s_cmp_gt_u32 s101, 0x2000000
    s_waitcnt lgkmcnt(0)
    s_cbranch_scc1 spin_o2_ret
    s_bfe_u32 s88, s72, 262152
    s_cmp_lg_u32 s88, 15
    s_cbranch_scc1 spin_o2
    s_branch spin_o2_ret
spin_o3:
    s_load_dword s72, s[86:87], s5 offset:4 glc
    s_add_u32 s101, s101, 1
    s_cmp_gt_u32 s101, 0x2000000
    s_waitcnt lgkmcnt(0)
    s_cbranch_scc1 spin_o3_ret
    s_bfe_u32 s88, s72, 262156
    s_cmp_lg_u32 s88, 15
    s_cbranch_scc1 spin_o3
    s_branch spin_o3_ret
spin_o4:
    s_load_dword s72, s[86:87], s5 offset:4 glc
    s_add_u32 s101, s101, 1
    s_cmp_gt_u32 s101, 0x2000000
    s_waitcnt lgkmcnt(0)
    s_cbranch_scc1 spin_o4_ret
    s_bfe_u32 s88, s72, 262160
    s_cmp_lg_u32 s88, 15
    s_cbranch_scc1 spin_o4
    s_branch spin_o4_ret
spin_o5:
    s_load_dword s72, s[86:87], s5 offset:4 glc
    s_add_u32 s101, s101, 1
    s_cmp_gt_u32 s101, 0x2000000
    s_waitcnt lgkmcnt(0)
    s_cbranch_scc1 spin_o5_ret
    s_bfe_u32 s88, s72, 262164
    s_cmp_lg_u32 s88, 15
    s_cbranch_scc1 spin_o5
    s_branch spin_o5_ret
routed:
    s_cmp_eq_u32 s44, s59
    s_cbranch_scc0 spin_y
spin_y_ret:
    v_cvt_pk_bf16_f32 v200, v240, v241
    v_cvt_pk_bf16_f32 v201, v242, v243
    v_lshlrev_b32 v240, 16, v200
    v_and_b32 v241, 0xffff0000, v200
    v_lshlrev_b32 v242, 16, v201
    v_and_b32 v243, 0xffff0000, v201
    v_mul_f32 v240, v240, v195
    v_mul_f32 v241, v241, v195
    v_mul_f32 v242, v242, v195
    v_mul_f32 v243, v243, v195
    v_cvt_pk_bf16_f32 v200, v240, v241
    v_cvt_pk_bf16_f32 v201, v242, v243
    v_lshlrev_b32 v240, 16, v200
    v_and_b32 v241, 0xffff0000, v200
    v_lshlrev_b32 v242, 16, v201
    v_and_b32 v243, 0xffff0000, v201
    v_add_f32 v240, v240, v248
    v_add_f32 v241, v241, v249
    v_add_f32 v242, v242, v250
    v_add_f32 v243, v243, v251
    v_cvt_pk_bf16_f32 v200, v240, v241
    v_cvt_pk_bf16_f32 v201, v242, v243
    v_lshlrev_b32 v240, 16, v200
    v_and_b32 v241, 0xffff0000, v200
    v_lshlrev_b32 v242, 16, v201
    v_and_b32 v243, 0xffff0000, v201
    v_mul_f32 v200, s92, v240
    v_mul_f32 v201, s92, v241
    v_mul_f32 v202, s92, v242
    v_mul_f32 v203, s92, v243
    v_exp_f32 v200, v200
    v_exp_f32 v201, v201
    v_exp_f32 v202, v202
    v_exp_f32 v203, v203
    v_add_f32 v200, 1.0, v200
    v_add_f32 v201, 1.0, v201
    v_add_f32 v202, 1.0, v202
    v_add_f32 v203, 1.0, v203
    v_rcp_f32 v200, v200
    v_rcp_f32 v201, v201
    v_rcp_f32 v202, v202
    v_rcp_f32 v203, v203
    v_mul_f32 v240, v240, v200
    v_mul_f32 v241, v241, v201
    v_mul_f32 v242, v242, v202
    v_mul_f32 v243, v243, v203
    v_cvt_pk_bf16_f32 v240, v240, v241
    v_cvt_pk_bf16_f32 v241, v242, v243
    ds_write_b64 v138, v[240:241]
    s_mov_b64 exec, s[88:89]
    ds_read_b128 v[168:171], v139 offset:0
    ds_read_b128 v[176:179], v139 offset:64
    ds_read_b128 v[184:187], v139 offset:128
    s_waitcnt lgkmcnt(0)
    s_mov_b64 exec, -1
    s_branch routed_ret
spin_y:
    s_add_u32 s101, s101, 1
    s_cmp_gt_u32 s101, 0x2000000
    s_cbranch_scc1 spin_y_x
    buffer_load_dword v137, v136, s[24:27], s59 offen offset:128 sc1
    s_waitcnt vmcnt(0)
    v_cmp_ne_u32 vcc, 24, v137
    s_cbranch_vccnz spin_y
spin_y_x:
    buffer_load_dwordx4 v[240:243], v192, s[24:27], s59 offen sc1
    s_waitcnt vmcnt(0)
    s_branch spin_y_ret
spin_rec:
    s_add_u32 s101, s101, 1
    s_cmp_gt_u32 s101, 0x2000000
    s_cbranch_scc1 spin_rec_x
    buffer_load_dwordx4 v[32:35], v17, s[24:27], s47 offen offset:0 sc1
    buffer_load_dwordx4 v[36:39], v17, s[24:27], s47 offen offset:1024 sc1
    buffer_load_dwordx4 v[40:43], v17, s[24:27], s47 offen offset:2048 sc1
    buffer_load_dwordx4 v[44:47], v17, s[24:27], s47 offen offset:3072 sc1
    s_waitcnt vmcnt(0)
    v_xor_b32 v34, s7, v34
    v_xor_b32 v38, s7, v38
    v_xor_b32 v42, s7, v42
    v_xor_b32 v46, s7, v46
    v_or3_b32 v34, v34, v38, v42
    v_or_b32 v34, v34, v46
    v_cmp_ne_u32 vcc, 0, v34
    s_cbranch_vccnz spin_rec
spin_rec_x:
    s_branch spin_rec_ret
spin_gu:
    s_add_u32 s101, s101, 1
    s_cmp_gt_u32 s101, 0x2000000
    s_cbranch_scc1 spin_gu_x
    buffer_load_dword v61, v60, s[24:27], s37 offen sc1
    s_waitcnt vmcnt(0)
    v_cmp_ne_u32 vcc, s7, v61
    s_cbranch_vccnz spin_gu
spin_gu_x:
    s_branch spin_gu_ret
rare_p:
    s_nop 7
    s_nop 7
    v_max3_f32 v56, v68, v69, v70
    v_max3_f32 v56, v56, v71, v100
    v_max3_f32 v56, v56, v101, v102
    v_max3_f32 v56, v56, v103, v56
    v_mov_b32 v58, v56
    s_nop 1
    v_permlane16_swap_b32 v56, v58
    s_nop 1
    v_max_f32 v56, v56, v58
    v_mov_b32 v58, v56
    s_nop 1
    v_permlane32_swap_b32 v56, v58
    s_nop 1
    v_max_f32 v56, v56, v58
    v_add_f32 v56, 2.0, v56
    v_sub_f32 v32, v32, v56
    v_sub_f32 v33, v33, v56
    v_sub_f32 v34, v34, v56
    v_sub_f32 v35, v35, v56
    v_sub_f32 v68, v68, v56
    v_sub_f32 v69, v69, v56
    v_sub_f32 v70, v70, v56
    v_sub_f32 v71, v71, v56
    v_sub_f32 v100, v100, v56
    v_sub_f32 v101, v101, v56
    v_sub_f32 v102, v102, v56
    v_sub_f32 v103, v103, v56
    v_sub_f32 v132, v132, v56
    v_sub_f32 v133, v133, v56
    v_sub_f32 v134, v134, v56
    v_sub_f32 v135, v135, v56
    v_sub_f32 v164, v164, v56
    v_sub_f32 v165, v165, v56
    v_sub_f32 v166, v166, v56
    v_sub_f32 v167, v167, v56
    v_exp_f32 v48, v68
    v_exp_f32 v49, v69
    v_exp_f32 v50, v70
    v_exp_f32 v51, v71
    v_exp_f32 v52, v100
    v_exp_f32 v53, v101
    v_exp_f32 v54, v102
    v_exp_f32 v55, v103
    s_nop 0
    v_cvt_pk_bf16_f32 v196, v48, v49
    v_cvt_pk_bf16_f32 v197, v50, v51
    v_cvt_pk_bf16_f32 v198, v52, v53
    v_cvt_pk_bf16_f32 v199, v54, v55
    v_add_f32 v24, v48, v49
    v_add_f32 v24, v24, v50
    v_add_f32 v24, v24, v51
    v_add_f32 v24, v24, v52
    v_add_f32 v24, v24, v53
    v_add_f32 v24, v24, v54
    v_add_f32 v24, v24, v55
    v_max3_f32 v56, v76, v77, v78
    v_max3_f32 v56, v56, v79, v108
    v_max3_f32 v56, v56, v109, v110
    v_max3_f32 v56, v56, v111, v56
    v_mov_b32 v58, v56
    s_nop 1
    v_permlane16_swap_b32 v56, v58
    s_nop 1
    v_max_f32 v56, v56, v58
    v_mov_b32 v58, v56
    s_nop 1
    v_permlane32_swap_b32 v56, v58
    s_nop 1
    v_max_f32 v56, v56, v58
    v_add_f32 v56, 2.0, v56
    v_sub_f32 v36, v36, v56
    v_sub_f32 v37, v37, v56
    v_sub_f32 v38, v38, v56
    v_sub_f32 v39, v39, v56
    v_sub_f32 v76, v76, v56
    v_sub_f32 v77, v77, v56
    v_sub_f32 v78, v78, v56
    v_sub_f32 v79, v79, v56
    v_sub_f32 v108, v108, v56
    v_sub_f32 v109, v109, v56
    v_sub_f32 v110, v110, v56
    v_sub_f32 v111, v111, v56
    v_sub_f32 v140, v140, v56
    v_sub_f32 v141, v141, v56
    v_sub_f32 v142, v142, v56
    v_sub_f32 v143, v143, v56
    v_sub_f32 v172, v172, v56
    v_sub_f32 v173, v173, v56
    v_sub_f32 v174, v174, v56
    v_sub_f32 v175, v175, v56
    v_exp_f32 v48, v76
    v_exp_f32 v49, v77
    v_exp_f32 v50, v78
    v_exp_f32 v51, v79
    v_exp_f32 v52, v108
    v_exp_f32 v53, v109
    v_exp_f32 v54, v110
    v_exp_f32 v55, v111
    s_nop 0
    v_cvt_pk_bf16_f32 v204, v48, v49
    v_cvt_pk_bf16_f32 v205, v50, v51
    v_cvt_pk_bf16_f32 v206, v52, v53
    v_cvt_pk_bf16_f32 v207, v54, v55
    v_add_f32 v25, v48, v49
    v_add_f32 v25, v25, v50
    v_add_f32 v25, v25, v51
    v_add_f32 v25, v25, v52
    v_add_f32 v25, v25, v53
    v_add_f32 v25, v25, v54
    v_add_f32 v25, v25, v55
    v_max3_f32 v56, v84, v85, v86
    v_max3_f32 v56, v56, v87, v116
    v_max3_f32 v56, v56, v117, v118
    v_max3_f32 v56, v56, v119, v56
    v_mov_b32 v58, v56
    s_nop 1
    v_permlane16_swap_b32 v56, v58
    s_nop 1
    v_max_f32 v56, v56, v58
    v_mov_b32 v58, v56
    s_nop 1
    v_permlane32_swap_b32 v56, v58
    s_nop 1
    v_max_f32 v56, v56, v58
    v_add_f32 v56, 2.0, v56
    v_sub_f32 v40, v40, v56
    v_sub_f32 v41, v41, v56
    v_sub_f32 v42, v42, v56
    v_sub_f32 v43, v43, v56
    v_sub_f32 v84, v84, v56
    v_sub_f32 v85, v85, v56
    v_sub_f32 v86, v86, v56
    v_sub_f32 v87, v87, v56
    v_sub_f32 v116, v116, v56
    v_sub_f32 v117, v117, v56
    v_sub_f32 v118, v118, v56
    v_sub_f32 v119, v119, v56
    v_sub_f32 v148, v148, v56
    v_sub_f32 v149, v149, v56
    v_sub_f32 v150, v150, v56
    v_sub_f32 v151, v151, v56
    v_sub_f32 v180, v180, v56
    v_sub_f32 v181, v181, v56
    v_sub_f32 v182, v182, v56
    v_sub_f32 v183, v183, v56
    v_exp_f32 v48, v84
    v_exp_f32 v49, v85
    v_exp_f32 v50, v86
    v_exp_f32 v51, v87
    v_exp_f32 v52, v116
    v_exp_f32 v53, v117
    v_exp_f32 v54, v118
    v_exp_f32 v55, v119
    s_nop 0
    v_cvt_pk_bf16_f32 v212, v48, v49
    v_cvt_pk_bf16_f32 v213, v50, v51
    v_cvt_pk_bf16_f32 v214, v52, v53
    v_cvt_pk_bf16_f32 v215, v54, v55
    v_add_f32 v26, v48, v49
    v_add_f32 v26, v26, v50
    v_add_f32 v26, v26, v51
    v_add_f32 v26, v26, v52
    v_add_f32 v26, v26, v53
    v_add_f32 v26, v26, v54
    v_add_f32 v26, v26, v55
    v_max3_f32 v56, v92, v93, v94
    v_max3_f32 v56, v56, v95, v124
    v_max3_f32 v56, v56, v125, v126
    v_max3_f32 v56, v56, v127, v56
    v_mov_b32 v58, v56
    s_nop 1
    v_permlane16_swap_b32 v56, v58
    s_nop 1
    v_max_f32 v56, v56, v58
    v_mov_b32 v58, v56
    s_nop 1
    v_permlane32_swap_b32 v56, v58
    s_nop 1
    v_max_f32 v56, v56, v58
    v_add_f32 v56, 2.0, v56
    v_sub_f32 v44, v44, v56
    v_sub_f32 v45, v45, v56
    v_sub_f32 v46, v46, v56
    v_sub_f32 v47, v47, v56
    v_sub_f32 v92, v92, v56
    v_sub_f32 v93, v93, v56
    v_sub_f32 v94, v94, v56
    v_sub_f32 v95, v95, v56
    v_sub_f32 v124, v124, v56
    v_sub_f32 v125, v125, v56
    v_sub_f32 v126, v126, v56
    v_sub_f32 v127, v127, v56
    v_sub_f32 v156, v156, v56
    v_sub_f32 v157, v157, v56
    v_sub_f32 v158, v158, v56
    v_sub_f32 v159, v159, v56
    v_sub_f32 v188, v188, v56
    v_sub_f32 v189, v189, v56
    v_sub_f32 v190, v190, v56
    v_sub_f32 v191, v191, v56
    v_exp_f32 v48, v92
    v_exp_f32 v49, v93
    v_exp_f32 v50, v94
    v_exp_f32 v51, v95
    v_exp_f32 v52, v124
    v_exp_f32 v53, v125
    v_exp_f32 v54, v126
    v_exp_f32 v55, v127
    s_nop 0
    v_cvt_pk_bf16_f32 v220, v48, v49
    v_cvt_pk_bf16_f32 v221, v50, v51
    v_cvt_pk_bf16_f32 v222, v52, v53
    v_cvt_pk_bf16_f32 v223, v54, v55
    v_add_f32 v27, v48, v49
    v_add_f32 v27, v27, v50
    v_add_f32 v27, v27, v51
    v_add_f32 v27, v27, v52
    v_add_f32 v27, v27, v53
    v_add_f32 v27, v27, v54
    v_add_f32 v27, v27, v55
    s_nop 1
    s_branch rare_p_ret
rare_a:
    s_nop 7
    s_nop 7
    v_max3_f32 v56, v132, v133, v134
    v_max3_f32 v56, v56, v135, v164
    v_max3_f32 v56, v56, v165, v166
    v_max3_f32 v56, v56, v167, 0
    v_mov_b32 v58, v56
    s_nop 1
    v_permlane16_swap_b32 v56, v58
    s_nop 1
    v_max_f32 v56, v56, v58
    v_mov_b32 v58, v56
    s_nop 1
    v_permlane32_swap_b32 v56, v58
    s_nop 1
    v_max_f32 v56, v56, v58
    v_exp_f32 v57, -v56
    v_sub_f32 v32, v32, v56
    v_sub_f32 v33, v33, v56
    v_sub_f32 v34, v34, v56
    v_sub_f32 v35, v35, v56
    v_mul_f32 v20, v20, v57
    v_sub_f32 v58, 1.0, v57
    v_sub_f32 v132, v132, v56
    v_sub_f32 v133, v133, v56
    v_sub_f32 v134, v134, v56
    v_sub_f32 v135, v135, v56
    v_sub_f32 v164, v164, v56
    v_sub_f32 v165, v165, v56
    v_sub_f32 v166, v166, v56
    v_sub_f32 v167, v167, v56
    v_sub_f32 v68, v68, v56
    v_sub_f32 v69, v69, v56
    v_sub_f32 v70, v70, v56
    v_sub_f32 v71, v71, v56
    v_sub_f32 v100, v100, v56
    v_sub_f32 v101, v101, v56
    v_sub_f32 v102, v102, v56
    v_sub_f32 v103, v103, v56
    v_accvgpr_read_b32 v48, a0
    v_accvgpr_read_b32 v49, a1
    v_accvgpr_read_b32 v50, a2
    v_accvgpr_read_b32 v51, a3
    v_fma_f32 v48, v48, v57, v58
    v_fma_f32 v49, v49, v57, v58
    v_fma_f32 v50, v50, v57, v58
    v_fma_f32 v51, v51, v57, v58
    v_accvgpr_write_b32 a0, v48
    v_accvgpr_write_b32 a1, v49
    v_accvgpr_write_b32 a2, v50
    v_accvgpr_write_b32 a3, v51
    v_accvgpr_read_b32 v48, a16
    v_accvgpr_read_b32 v49, a17
    v_accvgpr_read_b32 v50, a18
    v_accvgpr_read_b32 v51, a19
    v_fma_f32 v48, v48, v57, v58
    v_fma_f32 v49, v49, v57, v58
    v_fma_f32 v50, v50, v57, v58
    v_fma_f32 v51, v51, v57, v58
    v_accvgpr_write_b32 a16, v48
    v_accvgpr_write_b32 a17, v49
    v_accvgpr_write_b32 a18, v50
    v_accvgpr_write_b32 a19, v51
    v_accvgpr_read_b32 v48, a32
    v_accvgpr_read_b32 v49, a33
    v_accvgpr_read_b32 v50, a34
    v_accvgpr_read_b32 v51, a35
    v_fma_f32 v48, v48, v57, v58
    v_fma_f32 v49, v49, v57, v58
    v_fma_f32 v50, v50, v57, v58
    v_fma_f32 v51, v51, v57, v58
    v_accvgpr_write_b32 a32, v48
    v_accvgpr_write_b32 a33, v49
    v_accvgpr_write_b32 a34, v50
    v_accvgpr_write_b32 a35, v51
    v_accvgpr_read_b32 v48, a48
    v_accvgpr_read_b32 v49, a49
    v_accvgpr_read_b32 v50, a50
    v_accvgpr_read_b32 v51, a51
    v_fma_f32 v48, v48, v57, v58
    v_fma_f32 v49, v49, v57, v58
    v_fma_f32 v50, v50, v57, v58
    v_fma_f32 v51, v51, v57, v58
    v_accvgpr_write_b32 a48, v48
    v_accvgpr_write_b32 a49, v49
    v_accvgpr_write_b32 a50, v50
    v_accvgpr_write_b32 a51, v51
    v_accvgpr_read_b32 v48, a64
    v_accvgpr_read_b32 v49, a65
    v_accvgpr_read_b32 v50, a66
    v_accvgpr_read_b32 v51, a67
    v_fma_f32 v48, v48, v57, v58
    v_fma_f32 v49, v49, v57, v58
    v_fma_f32 v50, v50, v57, v58
    v_fma_f32 v51, v51, v57, v58
    v_accvgpr_write_b32 a64, v48
    v_accvgpr_write_b32 a65, v49
    v_accvgpr_write_b32 a66, v50
    v_accvgpr_write_b32 a67, v51
    v_accvgpr_read_b32 v48, a80
    v_accvgpr_read_b32 v49, a81
    v_accvgpr_read_b32 v50, a82
    v_accvgpr_read_b32 v51, a83
    v_fma_f32 v48, v48, v57, v58
    v_fma_f32 v49, v49, v57, v58
    v_fma_f32 v50, v50, v57, v58
    v_fma_f32 v51, v51, v57, v58
    v_accvgpr_write_b32 a80, v48
    v_accvgpr_write_b32 a81, v49
    v_accvgpr_write_b32 a82, v50
    v_accvgpr_write_b32 a83, v51
    v_accvgpr_read_b32 v48, a96
    v_accvgpr_read_b32 v49, a97
    v_accvgpr_read_b32 v50, a98
    v_accvgpr_read_b32 v51, a99
    v_fma_f32 v48, v48, v57, v58
    v_fma_f32 v49, v49, v57, v58
    v_fma_f32 v50, v50, v57, v58
    v_fma_f32 v51, v51, v57, v58
    v_accvgpr_write_b32 a96, v48
    v_accvgpr_write_b32 a97, v49
    v_accvgpr_write_b32 a98, v50
    v_accvgpr_write_b32 a99, v51
    v_accvgpr_read_b32 v48, a112
    v_accvgpr_read_b32 v49, a113
    v_accvgpr_read_b32 v50, a114
    v_accvgpr_read_b32 v51, a115
    v_fma_f32 v48, v48, v57, v58
    v_fma_f32 v49, v49, v57, v58
    v_fma_f32 v50, v50, v57, v58
    v_fma_f32 v51, v51, v57, v58
    v_accvgpr_write_b32 a112, v48
    v_accvgpr_write_b32 a113, v49
    v_accvgpr_write_b32 a114, v50
    v_accvgpr_write_b32 a115, v51
    v_accvgpr_read_b32 v48, a128
    v_accvgpr_read_b32 v49, a129
    v_accvgpr_read_b32 v50, a130
    v_accvgpr_read_b32 v51, a131
    v_fma_f32 v48, v48, v57, v58
    v_fma_f32 v49, v49, v57, v58
    v_fma_f32 v50, v50, v57, v58
    v_fma_f32 v51, v51, v57, v58
    v_accvgpr_write_b32 a128, v48
    v_accvgpr_write_b32 a129, v49
    v_accvgpr_write_b32 a130, v50
    v_accvgpr_write_b32 a131, v51
    v_accvgpr_read_b32 v48, a144
    v_accvgpr_read_b32 v49, a145
    v_accvgpr_read_b32 v50, a146
    v_accvgpr_read_b32 v51, a147
    v_fma_f32 v48, v48, v57, v58
    v_fma_f32 v49, v49, v57, v58
    v_fma_f32 v50, v50, v57, v58
    v_fma_f32 v51, v51, v57, v58
    v_accvgpr_write_b32 a144, v48
    v_accvgpr_write_b32 a145, v49
    v_accvgpr_write_b32 a146, v50
    v_accvgpr_write_b32 a147, v51
    v_accvgpr_read_b32 v48, a160
    v_accvgpr_read_b32 v49, a161
    v_accvgpr_read_b32 v50, a162
    v_accvgpr_read_b32 v51, a163
    v_fma_f32 v48, v48, v57, v58
    v_fma_f32 v49, v49, v57, v58
    v_fma_f32 v50, v50, v57, v58
    v_fma_f32 v51, v51, v57, v58
    v_accvgpr_write_b32 a160, v48
    v_accvgpr_write_b32 a161, v49
    v_accvgpr_write_b32 a162, v50
    v_accvgpr_write_b32 a163, v51
    v_accvgpr_read_b32 v48, a176
    v_accvgpr_read_b32 v49, a177
    v_accvgpr_read_b32 v50, a178
    v_accvgpr_read_b32 v51, a179
    v_fma_f32 v48, v48, v57, v58
    v_fma_f32 v49, v49, v57, v58
    v_fma_f32 v50, v50, v57, v58
    v_fma_f32 v51, v51, v57, v58
    v_accvgpr_write_b32 a176, v48
    v_accvgpr_write_b32 a177, v49
    v_accvgpr_write_b32 a178, v50
    v_accvgpr_write_b32 a179, v51
    v_exp_f32 v48, v132
    v_exp_f32 v49, v133
    v_exp_f32 v50, v134
    v_exp_f32 v51, v135
    v_exp_f32 v52, v164
    v_exp_f32 v53, v165
    v_exp_f32 v54, v166
    v_exp_f32 v55, v167
    s_nop 0
    v_cvt_pk_bf16_f32 v228, v48, v49
    v_cvt_pk_bf16_f32 v229, v50, v51
    v_cvt_pk_bf16_f32 v230, v52, v53
    v_cvt_pk_bf16_f32 v231, v54, v55
    v_add_f32 v24, v48, v49
    v_add_f32 v24, v24, v50
    v_add_f32 v24, v24, v51
    v_add_f32 v24, v24, v52
    v_add_f32 v24, v24, v53
    v_add_f32 v24, v24, v54
    v_add_f32 v24, v24, v55
    v_max3_f32 v56, v140, v141, v142
    v_max3_f32 v56, v56, v143, v172
    v_max3_f32 v56, v56, v173, v174
    v_max3_f32 v56, v56, v175, 0
    v_mov_b32 v58, v56
    s_nop 1
    v_permlane16_swap_b32 v56, v58
    s_nop 1
    v_max_f32 v56, v56, v58
    v_mov_b32 v58, v56
    s_nop 1
    v_permlane32_swap_b32 v56, v58
    s_nop 1
    v_max_f32 v56, v56, v58
    v_exp_f32 v57, -v56
    v_sub_f32 v36, v36, v56
    v_sub_f32 v37, v37, v56
    v_sub_f32 v38, v38, v56
    v_sub_f32 v39, v39, v56
    v_mul_f32 v21, v21, v57
    v_sub_f32 v58, 1.0, v57
    v_sub_f32 v140, v140, v56
    v_sub_f32 v141, v141, v56
    v_sub_f32 v142, v142, v56
    v_sub_f32 v143, v143, v56
    v_sub_f32 v172, v172, v56
    v_sub_f32 v173, v173, v56
    v_sub_f32 v174, v174, v56
    v_sub_f32 v175, v175, v56
    v_sub_f32 v76, v76, v56
    v_sub_f32 v77, v77, v56
    v_sub_f32 v78, v78, v56
    v_sub_f32 v79, v79, v56
    v_sub_f32 v108, v108, v56
    v_sub_f32 v109, v109, v56
    v_sub_f32 v110, v110, v56
    v_sub_f32 v111, v111, v56
    v_accvgpr_read_b32 v48, a4
    v_accvgpr_read_b32 v49, a5
    v_accvgpr_read_b32 v50, a6
    v_accvgpr_read_b32 v51, a7
    v_fma_f32 v48, v48, v57, v58
    v_fma_f32 v49, v49, v57, v58
    v_fma_f32 v50, v50, v57, v58
    v_fma_f32 v51, v51, v57, v58
    v_accvgpr_write_b32 a4, v48
    v_accvgpr_write_b32 a5, v49
    v_accvgpr_write_b32 a6, v50
    v_accvgpr_write_b32 a7, v51
    v_accvgpr_read_b32 v48, a20
    v_accvgpr_read_b32 v49, a21
    v_accvgpr_read_b32 v50, a22
    v_accvgpr_read_b32 v51, a23
    v_fma_f32 v48, v48, v57, v58
    v_fma_f32 v49, v49, v57, v58
    v_fma_f32 v50, v50, v57, v58
    v_fma_f32 v51, v51, v57, v58
    v_accvgpr_write_b32 a20, v48
    v_accvgpr_write_b32 a21, v49
    v_accvgpr_write_b32 a22, v50
    v_accvgpr_write_b32 a23, v51
    v_accvgpr_read_b32 v48, a36
    v_accvgpr_read_b32 v49, a37
    v_accvgpr_read_b32 v50, a38
    v_accvgpr_read_b32 v51, a39
    v_fma_f32 v48, v48, v57, v58
    v_fma_f32 v49, v49, v57, v58
    v_fma_f32 v50, v50, v57, v58
    v_fma_f32 v51, v51, v57, v58
    v_accvgpr_write_b32 a36, v48
    v_accvgpr_write_b32 a37, v49
    v_accvgpr_write_b32 a38, v50
    v_accvgpr_write_b32 a39, v51
    v_accvgpr_read_b32 v48, a52
    v_accvgpr_read_b32 v49, a53
    v_accvgpr_read_b32 v50, a54
    v_accvgpr_read_b32 v51, a55
    v_fma_f32 v48, v48, v57, v58
    v_fma_f32 v49, v49, v57, v58
    v_fma_f32 v50, v50, v57, v58
    v_fma_f32 v51, v51, v57, v58
    v_accvgpr_write_b32 a52, v48
    v_accvgpr_write_b32 a53, v49
    v_accvgpr_write_b32 a54, v50
    v_accvgpr_write_b32 a55, v51
    v_accvgpr_read_b32 v48, a68
    v_accvgpr_read_b32 v49, a69
    v_accvgpr_read_b32 v50, a70
    v_accvgpr_read_b32 v51, a71
    v_fma_f32 v48, v48, v57, v58
    v_fma_f32 v49, v49, v57, v58
    v_fma_f32 v50, v50, v57, v58
    v_fma_f32 v51, v51, v57, v58
    v_accvgpr_write_b32 a68, v48
    v_accvgpr_write_b32 a69, v49
    v_accvgpr_write_b32 a70, v50
    v_accvgpr_write_b32 a71, v51
    v_accvgpr_read_b32 v48, a84
    v_accvgpr_read_b32 v49, a85
    v_accvgpr_read_b32 v50, a86
    v_accvgpr_read_b32 v51, a87
    v_fma_f32 v48, v48, v57, v58
    v_fma_f32 v49, v49, v57, v58
    v_fma_f32 v50, v50, v57, v58
    v_fma_f32 v51, v51, v57, v58
    v_accvgpr_write_b32 a84, v48
    v_accvgpr_write_b32 a85, v49
    v_accvgpr_write_b32 a86, v50
    v_accvgpr_write_b32 a87, v51
    v_accvgpr_read_b32 v48, a100
    v_accvgpr_read_b32 v49, a101
    v_accvgpr_read_b32 v50, a102
    v_accvgpr_read_b32 v51, a103
    v_fma_f32 v48, v48, v57, v58
    v_fma_f32 v49, v49, v57, v58
    v_fma_f32 v50, v50, v57, v58
    v_fma_f32 v51, v51, v57, v58
    v_accvgpr_write_b32 a100, v48
    v_accvgpr_write_b32 a101, v49
    v_accvgpr_write_b32 a102, v50
    v_accvgpr_write_b32 a103, v51
    v_accvgpr_read_b32 v48, a116
    v_accvgpr_read_b32 v49, a117
    v_accvgpr_read_b32 v50, a118
    v_accvgpr_read_b32 v51, a119
    v_fma_f32 v48, v48, v57, v58
    v_fma_f32 v49, v49, v57, v58
    v_fma_f32 v50, v50, v57, v58
    v_fma_f32 v51, v51, v57, v58
    v_accvgpr_write_b32 a116, v48
    v_accvgpr_write_b32 a117, v49
    v_accvgpr_write_b32 a118, v50
    v_accvgpr_write_b32 a119, v51
    v_accvgpr_read_b32 v48, a132
    v_accvgpr_read_b32 v49, a133
    v_accvgpr_read_b32 v50, a134
    v_accvgpr_read_b32 v51, a135
    v_fma_f32 v48, v48, v57, v58
    v_fma_f32 v49, v49, v57, v58
    v_fma_f32 v50, v50, v57, v58
    v_fma_f32 v51, v51, v57, v58
    v_accvgpr_write_b32 a132, v48
    v_accvgpr_write_b32 a133, v49
    v_accvgpr_write_b32 a134, v50
    v_accvgpr_write_b32 a135, v51
    v_accvgpr_read_b32 v48, a148
    v_accvgpr_read_b32 v49, a149
    v_accvgpr_read_b32 v50, a150
    v_accvgpr_read_b32 v51, a151
    v_fma_f32 v48, v48, v57, v58
    v_fma_f32 v49, v49, v57, v58
    v_fma_f32 v50, v50, v57, v58
    v_fma_f32 v51, v51, v57, v58
    v_accvgpr_write_b32 a148, v48
    v_accvgpr_write_b32 a149, v49
    v_accvgpr_write_b32 a150, v50
    v_accvgpr_write_b32 a151, v51
    v_accvgpr_read_b32 v48, a164
    v_accvgpr_read_b32 v49, a165
    v_accvgpr_read_b32 v50, a166
    v_accvgpr_read_b32 v51, a167
    v_fma_f32 v48, v48, v57, v58
    v_fma_f32 v49, v49, v57, v58
    v_fma_f32 v50, v50, v57, v58
    v_fma_f32 v51, v51, v57, v58
    v_accvgpr_write_b32 a164, v48
    v_accvgpr_write_b32 a165, v49
    v_accvgpr_write_b32 a166, v50
    v_accvgpr_write_b32 a167, v51
    v_accvgpr_read_b32 v48, a180
    v_accvgpr_read_b32 v49, a181
    v_accvgpr_read_b32 v50, a182
    v_accvgpr_read_b32 v51, a183
    v_fma_f32 v48, v48, v57, v58
    v_fma_f32 v49, v49, v57, v58
    v_fma_f32 v50, v50, v57, v58
    v_fma_f32 v51, v51, v57, v58
    v_accvgpr_write_b32 a180, v48
    v_accvgpr_write_b32 a181, v49
    v_accvgpr_write_b32 a182, v50
    v_accvgpr_write_b32 a183, v51
    v_exp_f32 v48, v140
    v_exp_f32 v49, v141
    v_exp_f32 v50, v142
    v_exp_f32 v51, v143
    v_exp_f32 v52, v172
    v_exp_f32 v53, v173
    v_exp_f32 v54, v174
    v_exp_f32 v55, v175
    s_nop 0
    v_cvt_pk_bf16_f32 v236, v48, v49
    v_cvt_pk_bf16_f32 v237, v50, v51
    v_cvt_pk_bf16_f32 v238, v52, v53
    v_cvt_pk_bf16_f32 v239, v54, v55
    v_add_f32 v25, v48, v49
    v_add_f32 v25, v25, v50
    v_add_f32 v25, v25, v51
    v_add_f32 v25, v25, v52
    v_add_f32 v25, v25, v53
    v_add_f32 v25, v25, v54
    v_add_f32 v25, v25, v55
    v_max3_f32 v56, v148, v149, v150
    v_max3_f32 v56, v56, v151, v180
    v_max3_f32 v56, v56, v181, v182
    v_max3_f32 v56, v56, v183, 0
    v_mov_b32 v58, v56
    s_nop 1
    v_permlane16_swap_b32 v56, v58
    s_nop 1
    v_max_f32 v56, v56, v58
    v_mov_b32 v58, v56
    s_nop 1
    v_permlane32_swap_b32 v56, v58
    s_nop 1
    v_max_f32 v56, v56, v58
    v_exp_f32 v57, -v56
    v_sub_f32 v40, v40, v56
    v_sub_f32 v41, v41, v56
    v_sub_f32 v42, v42, v56
    v_sub_f32 v43, v43, v56
    v_mul_f32 v22, v22, v57
    v_sub_f32 v58, 1.0, v57
    v_sub_f32 v148, v148, v56
    v_sub_f32 v149, v149, v56
    v_sub_f32 v150, v150, v56
    v_sub_f32 v151, v151, v56
    v_sub_f32 v180, v180, v56
    v_sub_f32 v181, v181, v56
    v_sub_f32 v182, v182, v56
    v_sub_f32 v183, v183, v56
    v_sub_f32 v84, v84, v56
    v_sub_f32 v85, v85, v56
    v_sub_f32 v86, v86, v56
    v_sub_f32 v87, v87, v56
    v_sub_f32 v116, v116, v56
    v_sub_f32 v117, v117, v56
    v_sub_f32 v118, v118, v56
    v_sub_f32 v119, v119, v56
    v_accvgpr_read_b32 v48, a8
    v_accvgpr_read_b32 v49, a9
    v_accvgpr_read_b32 v50, a10
    v_accvgpr_read_b32 v51, a11
    v_fma_f32 v48, v48, v57, v58
    v_fma_f32 v49, v49, v57, v58
    v_fma_f32 v50, v50, v57, v58
    v_fma_f32 v51, v51, v57, v58
    v_accvgpr_write_b32 a8, v48
    v_accvgpr_write_b32 a9, v49
    v_accvgpr_write_b32 a10, v50
    v_accvgpr_write_b32 a11, v51
    v_accvgpr_read_b32 v48, a24
    v_accvgpr_read_b32 v49, a25
    v_accvgpr_read_b32 v50, a26
    v_accvgpr_read_b32 v51, a27
    v_fma_f32 v48, v48, v57, v58
    v_fma_f32 v49, v49, v57, v58
    v_fma_f32 v50, v50, v57, v58
    v_fma_f32 v51, v51, v57, v58
    v_accvgpr_write_b32 a24, v48
    v_accvgpr_write_b32 a25, v49
    v_accvgpr_write_b32 a26, v50
    v_accvgpr_write_b32 a27, v51
    v_accvgpr_read_b32 v48, a40
    v_accvgpr_read_b32 v49, a41
    v_accvgpr_read_b32 v50, a42
    v_accvgpr_read_b32 v51, a43
    v_fma_f32 v48, v48, v57, v58
    v_fma_f32 v49, v49, v57, v58
    v_fma_f32 v50, v50, v57, v58
    v_fma_f32 v51, v51, v57, v58
    v_accvgpr_write_b32 a40, v48
    v_accvgpr_write_b32 a41, v49
    v_accvgpr_write_b32 a42, v50
    v_accvgpr_write_b32 a43, v51
    v_accvgpr_read_b32 v48, a56
    v_accvgpr_read_b32 v49, a57
    v_accvgpr_read_b32 v50, a58
    v_accvgpr_read_b32 v51, a59
    v_fma_f32 v48, v48, v57, v58
    v_fma_f32 v49, v49, v57, v58
    v_fma_f32 v50, v50, v57, v58
    v_fma_f32 v51, v51, v57, v58
    v_accvgpr_write_b32 a56, v48
    v_accvgpr_write_b32 a57, v49
    v_accvgpr_write_b32 a58, v50
    v_accvgpr_write_b32 a59, v51
    v_accvgpr_read_b32 v48, a72
    v_accvgpr_read_b32 v49, a73
    v_accvgpr_read_b32 v50, a74
    v_accvgpr_read_b32 v51, a75
    v_fma_f32 v48, v48, v57, v58
    v_fma_f32 v49, v49, v57, v58
    v_fma_f32 v50, v50, v57, v58
    v_fma_f32 v51, v51, v57, v58
    v_accvgpr_write_b32 a72, v48
    v_accvgpr_write_b32 a73, v49
    v_accvgpr_write_b32 a74, v50
    v_accvgpr_write_b32 a75, v51
    v_accvgpr_read_b32 v48, a88
    v_accvgpr_read_b32 v49, a89
    v_accvgpr_read_b32 v50, a90
    v_accvgpr_read_b32 v51, a91
    v_fma_f32 v48, v48, v57, v58
    v_fma_f32 v49, v49, v57, v58
    v_fma_f32 v50, v50, v57, v58
    v_fma_f32 v51, v51, v57, v58
    v_accvgpr_write_b32 a88, v48
    v_accvgpr_write_b32 a89, v49
    v_accvgpr_write_b32 a90, v50
    v_accvgpr_write_b32 a91, v51
    v_accvgpr_read_b32 v48, a104
    v_accvgpr_read_b32 v49, a105
    v_accvgpr_read_b32 v50, a106
    v_accvgpr_read_b32 v51, a107
    v_fma_f32 v48, v48, v57, v58
    v_fma_f32 v49, v49, v57, v58
    v_fma_f32 v50, v50, v57, v58
    v_fma_f32 v51, v51, v57, v58
    v_accvgpr_write_b32 a104, v48
    v_accvgpr_write_b32 a105, v49
    v_accvgpr_write_b32 a106, v50
    v_accvgpr_write_b32 a107, v51
    v_accvgpr_read_b32 v48, a120
    v_accvgpr_read_b32 v49, a121
    v_accvgpr_read_b32 v50, a122
    v_accvgpr_read_b32 v51, a123
    v_fma_f32 v48, v48, v57, v58
    v_fma_f32 v49, v49, v57, v58
    v_fma_f32 v50, v50, v57, v58
    v_fma_f32 v51, v51, v57, v58
    v_accvgpr_write_b32 a120, v48
    v_accvgpr_write_b32 a121, v49
    v_accvgpr_write_b32 a122, v50
    v_accvgpr_write_b32 a123, v51
    v_accvgpr_read_b32 v48, a136
    v_accvgpr_read_b32 v49, a137
    v_accvgpr_read_b32 v50, a138
    v_accvgpr_read_b32 v51, a139
    v_fma_f32 v48, v48, v57, v58
    v_fma_f32 v49, v49, v57, v58
    v_fma_f32 v50, v50, v57, v58
    v_fma_f32 v51, v51, v57, v58
    v_accvgpr_write_b32 a136, v48
    v_accvgpr_write_b32 a137, v49
    v_accvgpr_write_b32 a138, v50
    v_accvgpr_write_b32 a139, v51
    v_accvgpr_read_b32 v48, a152
    v_accvgpr_read_b32 v49, a153
    v_accvgpr_read_b32 v50, a154
    v_accvgpr_read_b32 v51, a155
    v_fma_f32 v48, v48, v57, v58
    v_fma_f32 v49, v49, v57, v58
    v_fma_f32 v50, v50, v57, v58
    v_fma_f32 v51, v51, v57, v58
    v_accvgpr_write_b32 a152, v48
    v_accvgpr_write_b32 a153, v49
    v_accvgpr_write_b32 a154, v50
    v_accvgpr_write_b32 a155, v51
    v_accvgpr_read_b32 v48, a168
    v_accvgpr_read_b32 v49, a169
    v_accvgpr_read_b32 v50, a170
    v_accvgpr_read_b32 v51, a171
    v_fma_f32 v48, v48, v57, v58
    v_fma_f32 v49, v49, v57, v58
    v_fma_f32 v50, v50, v57, v58
    v_fma_f32 v51, v51, v57, v58
    v_accvgpr_write_b32 a168, v48
    v_accvgpr_write_b32 a169, v49
    v_accvgpr_write_b32 a170, v50
    v_accvgpr_write_b32 a171, v51
    v_accvgpr_read_b32 v48, a184
    v_accvgpr_read_b32 v49, a185
    v_accvgpr_read_b32 v50, a186
    v_accvgpr_read_b32 v51, a187
    v_fma_f32 v48, v48, v57, v58
    v_fma_f32 v49, v49, v57, v58
    v_fma_f32 v50, v50, v57, v58
    v_fma_f32 v51, v51, v57, v58
    v_accvgpr_write_b32 a184, v48
    v_accvgpr_write_b32 a185, v49
    v_accvgpr_write_b32 a186, v50
    v_accvgpr_write_b32 a187, v51
    v_exp_f32 v48, v148
    v_exp_f32 v49, v149
    v_exp_f32 v50, v150
    v_exp_f32 v51, v151
    v_exp_f32 v52, v180
    v_exp_f32 v53, v181
    v_exp_f32 v54, v182
    v_exp_f32 v55, v183
    s_nop 0
    v_cvt_pk_bf16_f32 v244, v48, v49
    v_cvt_pk_bf16_f32 v245, v50, v51
    v_cvt_pk_bf16_f32 v246, v52, v53
    v_cvt_pk_bf16_f32 v247, v54, v55
    v_add_f32 v26, v48, v49
    v_add_f32 v26, v26, v50
    v_add_f32 v26, v26, v51
    v_add_f32 v26, v26, v52
    v_add_f32 v26, v26, v53
    v_add_f32 v26, v26, v54
    v_add_f32 v26, v26, v55
    v_max3_f32 v56, v156, v157, v158
    v_max3_f32 v56, v56, v159, v188
    v_max3_f32 v56, v56, v189, v190
    v_max3_f32 v56, v56, v191, 0
    v_mov_b32 v58, v56
    s_nop 1
    v_permlane16_swap_b32 v56, v58
    s_nop 1
    v_max_f32 v56, v56, v58
    v_mov_b32 v58, v56
    s_nop 1
    v_permlane32_swap_b32 v56, v58
    s_nop 1
    v_max_f32 v56, v56, v58
    v_exp_f32 v57, -v56
    v_sub_f32 v44, v44, v56
    v_sub_f32 v45, v45, v56
    v_sub_f32 v46, v46, v56
    v_sub_f32 v47, v47, v56
    v_mul_f32 v23, v23, v57
    v_sub_f32 v58, 1.0, v57
    v_sub_f32 v156, v156, v56
    v_sub_f32 v157, v157, v56
    v_sub_f32 v158, v158, v56
    v_sub_f32 v159, v159, v56
    v_sub_f32 v188, v188, v56
    v_sub_f32 v189, v189, v56
    v_sub_f32 v190, v190, v56
    v_sub_f32 v191, v191, v56
    v_sub_f32 v92, v92, v56
    v_sub_f32 v93, v93, v56
    v_sub_f32 v94, v94, v56
    v_sub_f32 v95, v95, v56
    v_sub_f32 v124, v124, v56
    v_sub_f32 v125, v125, v56
    v_sub_f32 v126, v126, v56
    v_sub_f32 v127, v127, v56
    v_accvgpr_read_b32 v48, a12
    v_accvgpr_read_b32 v49, a13
    v_accvgpr_read_b32 v50, a14
    v_accvgpr_read_b32 v51, a15
    v_fma_f32 v48, v48, v57, v58
    v_fma_f32 v49, v49, v57, v58
    v_fma_f32 v50, v50, v57, v58
    v_fma_f32 v51, v51, v57, v58
    v_accvgpr_write_b32 a12, v48
    v_accvgpr_write_b32 a13, v49
    v_accvgpr_write_b32 a14, v50
    v_accvgpr_write_b32 a15, v51
    v_accvgpr_read_b32 v48, a28
    v_accvgpr_read_b32 v49, a29
    v_accvgpr_read_b32 v50, a30
    v_accvgpr_read_b32 v51, a31
    v_fma_f32 v48, v48, v57, v58
    v_fma_f32 v49, v49, v57, v58
    v_fma_f32 v50, v50, v57, v58
    v_fma_f32 v51, v51, v57, v58
    v_accvgpr_write_b32 a28, v48
    v_accvgpr_write_b32 a29, v49
    v_accvgpr_write_b32 a30, v50
    v_accvgpr_write_b32 a31, v51
    v_accvgpr_read_b32 v48, a44
    v_accvgpr_read_b32 v49, a45
    v_accvgpr_read_b32 v50, a46
    v_accvgpr_read_b32 v51, a47
    v_fma_f32 v48, v48, v57, v58
    v_fma_f32 v49, v49, v57, v58
    v_fma_f32 v50, v50, v57, v58
    v_fma_f32 v51, v51, v57, v58
    v_accvgpr_write_b32 a44, v48
    v_accvgpr_write_b32 a45, v49
    v_accvgpr_write_b32 a46, v50
    v_accvgpr_write_b32 a47, v51
    v_accvgpr_read_b32 v48, a60
    v_accvgpr_read_b32 v49, a61
    v_accvgpr_read_b32 v50, a62
    v_accvgpr_read_b32 v51, a63
    v_fma_f32 v48, v48, v57, v58
    v_fma_f32 v49, v49, v57, v58
    v_fma_f32 v50, v50, v57, v58
    v_fma_f32 v51, v51, v57, v58
    v_accvgpr_write_b32 a60, v48
    v_accvgpr_write_b32 a61, v49
    v_accvgpr_write_b32 a62, v50
    v_accvgpr_write_b32 a63, v51
    v_accvgpr_read_b32 v48, a76
    v_accvgpr_read_b32 v49, a77
    v_accvgpr_read_b32 v50, a78
    v_accvgpr_read_b32 v51, a79
    v_fma_f32 v48, v48, v57, v58
    v_fma_f32 v49, v49, v57, v58
    v_fma_f32 v50, v50, v57, v58
    v_fma_f32 v51, v51, v57, v58
    v_accvgpr_write_b32 a76, v48
    v_accvgpr_write_b32 a77, v49
    v_accvgpr_write_b32 a78, v50
    v_accvgpr_write_b32 a79, v51
    v_accvgpr_read_b32 v48, a92
    v_accvgpr_read_b32 v49, a93
    v_accvgpr_read_b32 v50, a94
    v_accvgpr_read_b32 v51, a95
    v_fma_f32 v48, v48, v57, v58
    v_fma_f32 v49, v49, v57, v58
    v_fma_f32 v50, v50, v57, v58
    v_fma_f32 v51, v51, v57, v58
    v_accvgpr_write_b32 a92, v48
    v_accvgpr_write_b32 a93, v49
    v_accvgpr_write_b32 a94, v50
    v_accvgpr_write_b32 a95, v51
    v_accvgpr_read_b32 v48, a108
    v_accvgpr_read_b32 v49, a109
    v_accvgpr_read_b32 v50, a110
    v_accvgpr_read_b32 v51, a111
    v_fma_f32 v48, v48, v57, v58
    v_fma_f32 v49, v49, v57, v58
    v_fma_f32 v50, v50, v57, v58
    v_fma_f32 v51, v51, v57, v58
    v_accvgpr_write_b32 a108, v48
    v_accvgpr_write_b32 a109, v49
    v_accvgpr_write_b32 a110, v50
    v_accvgpr_write_b32 a111, v51
    v_accvgpr_read_b32 v48, a124
    v_accvgpr_read_b32 v49, a125
    v_accvgpr_read_b32 v50, a126
    v_accvgpr_read_b32 v51, a127
    v_fma_f32 v48, v48, v57, v58
    v_fma_f32 v49, v49, v57, v58
    v_fma_f32 v50, v50, v57, v58
    v_fma_f32 v51, v51, v57, v58
    v_accvgpr_write_b32 a124, v48
    v_accvgpr_write_b32 a125, v49
    v_accvgpr_write_b32 a126, v50
    v_accvgpr_write_b32 a127, v51
    v_accvgpr_read_b32 v48, a140
    v_accvgpr_read_b32 v49, a141
    v_accvgpr_read_b32 v50, a142
    v_accvgpr_read_b32 v51, a143
    v_fma_f32 v48, v48, v57, v58
    v_fma_f32 v49, v49, v57, v58
    v_fma_f32 v50, v50, v57, v58
    v_fma_f32 v51, v51, v57, v58
    v_accvgpr_write_b32 a140, v48
    v_accvgpr_write_b32 a141, v49
    v_accvgpr_write_b32 a142, v50
    v_accvgpr_write_b32 a143, v51
    v_accvgpr_read_b32 v48, a156
    v_accvgpr_read_b32 v49, a157
    v_accvgpr_read_b32 v50, a158
    v_accvgpr_read_b32 v51, a159
    v_fma_f32 v48, v48, v57, v58
    v_fma_f32 v49, v49, v57, v58
    v_fma_f32 v50, v50, v57, v58
    v_fma_f32 v51, v51, v57, v58
    v_accvgpr_write_b32 a156, v48
    v_accvgpr_write_b32 a157, v49
    v_accvgpr_write_b32 a158, v50
    v_accvgpr_write_b32 a159, v51
    v_accvgpr_read_b32 v48, a172
    v_accvgpr_read_b32 v49, a173
    v_accvgpr_read_b32 v50, a174
    v_accvgpr_read_b32 v51, a175
    v_fma_f32 v48, v48, v57, v58
    v_fma_f32 v49, v49, v57, v58
    v_fma_f32 v50, v50, v57, v58
    v_fma_f32 v51, v51, v57, v58
    v_accvgpr_write_b32 a172, v48
    v_accvgpr_write_b32 a173, v49
    v_accvgpr_write_b32 a174, v50
    v_accvgpr_write_b32 a175, v51
    v_accvgpr_read_b32 v48, a188
    v_accvgpr_read_b32 v49, a189
    v_accvgpr_read_b32 v50, a190
    v_accvgpr_read_b32 v51, a191
    v_fma_f32 v48, v48, v57, v58
    v_fma_f32 v49, v49, v57, v58
    v_fma_f32 v50, v50, v57, v58
    v_fma_f32 v51, v51, v57, v58
    v_accvgpr_write_b32 a188, v48
    v_accvgpr_write_b32 a189, v49
    v_accvgpr_write_b32 a190, v50
    v_accvgpr_write_b32 a191, v51
    v_exp_f32 v48, v156
    v_exp_f32 v49, v157
    v_exp_f32 v50, v158
    v_exp_f32 v51, v159
    v_exp_f32 v52, v188
    v_exp_f32 v53, v189
    v_exp_f32 v54, v190
    v_exp_f32 v55, v191
    s_nop 0
    v_cvt_pk_bf16_f32 v252, v48, v49
    v_cvt_pk_bf16_f32 v253, v50, v51
    v_cvt_pk_bf16_f32 v254, v52, v53
    v_cvt_pk_bf16_f32 v255, v54, v55
    v_add_f32 v27, v48, v49
    v_add_f32 v27, v27, v50
    v_add_f32 v27, v27, v51
    v_add_f32 v27, v27, v52
    v_add_f32 v27, v27, v53
    v_add_f32 v27, v27, v54
    v_add_f32 v27, v27, v55
    s_nop 1
    s_branch rare_a_ret
rare_b:
    s_nop 7
    s_nop 7
    v_max3_f32 v56, v68, v69, v70
    v_max3_f32 v56, v56, v71, v100
    v_max3_f32 v56, v56, v101, v102
    v_max3_f32 v56, v56, v103, 0
    v_mov_b32 v58, v56
    s_nop 1
    v_permlane16_swap_b32 v56, v58
    s_nop 1
    v_max_f32 v56, v56, v58
    v_mov_b32 v58, v56
    s_nop 1
    v_permlane32_swap_b32 v56, v58
    s_nop 1
    v_max_f32 v56, v56, v58
    v_exp_f32 v57, -v56
    v_sub_f32 v32, v32, v56
    v_sub_f32 v33, v33, v56
    v_sub_f32 v34, v34, v56
    v_sub_f32 v35, v35, v56
    v_mul_f32 v20, v20, v57
    v_sub_f32 v58, 1.0, v57
    v_sub_f32 v68, v68, v56
    v_sub_f32 v69, v69, v56
    v_sub_f32 v70, v70, v56
    v_sub_f32 v71, v71, v56
    v_sub_f32 v100, v100, v56
    v_sub_f32 v101, v101, v56
    v_sub_f32 v102, v102, v56
    v_sub_f32 v103, v103, v56
    v_sub_f32 v132, v132, v56
    v_sub_f32 v133, v133, v56
    v_sub_f32 v134, v134, v56
    v_sub_f32 v135, v135, v56
    v_sub_f32 v164, v164, v56
    v_sub_f32 v165, v165, v56
    v_sub_f32 v166, v166, v56
    v_sub_f32 v167, v167, v56
    v_accvgpr_read_b32 v48, a0
    v_accvgpr_read_b32 v49, a1
    v_accvgpr_read_b32 v50, a2
    v_accvgpr_read_b32 v51, a3
    v_fma_f32 v48, v48, v57, v58
    v_fma_f32 v49, v49, v57, v58
    v_fma_f32 v50, v50, v57, v58
    v_fma_f32 v51, v51, v57, v58
    v_accvgpr_write_b32 a0, v48
    v_accvgpr_write_b32 a1, v49
    v_accvgpr_write_b32 a2, v50
    v_accvgpr_write_b32 a3, v51
    v_accvgpr_read_b32 v48, a16
    v_accvgpr_read_b32 v49, a17
    v_accvgpr_read_b32 v50, a18
    v_accvgpr_read_b32 v51, a19
    v_fma_f32 v48, v48, v57, v58
    v_fma_f32 v49, v49, v57, v58
    v_fma_f32 v50, v50, v57, v58
    v_fma_f32 v51, v51, v57, v58
    v_accvgpr_write_b32 a16, v48
    v_accvgpr_write_b32 a17, v49
    v_accvgpr_write_b32 a18, v50
    v_accvgpr_write_b32 a19, v51
    v_accvgpr_read_b32 v48, a32
    v_accvgpr_read_b32 v49, a33
    v_accvgpr_read_b32 v50, a34
    v_accvgpr_read_b32 v51, a35
    v_fma_f32 v48, v48, v57, v58
    v_fma_f32 v49, v49, v57, v58
    v_fma_f32 v50, v50, v57, v58
    v_fma_f32 v51, v51, v57, v58
    v_accvgpr_write_b32 a32, v48
    v_accvgpr_write_b32 a33, v49
    v_accvgpr_write_b32 a34, v50
    v_accvgpr_write_b32 a35, v51
    v_accvgpr_read_b32 v48, a48
    v_accvgpr_read_b32 v49, a49
    v_accvgpr_read_b32 v50, a50
    v_accvgpr_read_b32 v51, a51
    v_fma_f32 v48, v48, v57, v58
    v_fma_f32 v49, v49, v57, v58
    v_fma_f32 v50, v50, v57, v58
    v_fma_f32 v51, v51, v57, v58
    v_accvgpr_write_b32 a48, v48
    v_accvgpr_write_b32 a49, v49
    v_accvgpr_write_b32 a50, v50
    v_accvgpr_write_b32 a51, v51
    v_accvgpr_read_b32 v48, a64
    v_accvgpr_read_b32 v49, a65
    v_accvgpr_read_b32 v50, a66
    v_accvgpr_read_b32 v51, a67
    v_fma_f32 v48, v48, v57, v58
    v_fma_f32 v49, v49, v57, v58
    v_fma_f32 v50, v50, v57, v58
    v_fma_f32 v51, v51, v57, v58
    v_accvgpr_write_b32 a64, v48
    v_accvgpr_write_b32 a65, v49
    v_accvgpr_write_b32 a66, v50
    v_accvgpr_write_b32 a67, v51
    v_accvgpr_read_b32 v48, a80
    v_accvgpr_read_b32 v49, a81
    v_accvgpr_read_b32 v50, a82
    v_accvgpr_read_b32 v51, a83
    v_fma_f32 v48, v48, v57, v58
    v_fma_f32 v49, v49, v57, v58
    v_fma_f32 v50, v50, v57, v58
    v_fma_f32 v51, v51, v57, v58
    v_accvgpr_write_b32 a80, v48
    v_accvgpr_write_b32 a81, v49
    v_accvgpr_write_b32 a82, v50
    v_accvgpr_write_b32 a83, v51
    v_accvgpr_read_b32 v48, a96
    v_accvgpr_read_b32 v49, a97
    v_accvgpr_read_b32 v50, a98
    v_accvgpr_read_b32 v51, a99
    v_fma_f32 v48, v48, v57, v58
    v_fma_f32 v49, v49, v57, v58
    v_fma_f32 v50, v50, v57, v58
    v_fma_f32 v51, v51, v57, v58
    v_accvgpr_write_b32 a96, v48
    v_accvgpr_write_b32 a97, v49
    v_accvgpr_write_b32 a98, v50
    v_accvgpr_write_b32 a99, v51
    v_accvgpr_read_b32 v48, a112
    v_accvgpr_read_b32 v49, a113
    v_accvgpr_read_b32 v50, a114
    v_accvgpr_read_b32 v51, a115
    v_fma_f32 v48, v48, v57, v58
    v_fma_f32 v49, v49, v57, v58
    v_fma_f32 v50, v50, v57, v58
    v_fma_f32 v51, v51, v57, v58
    v_accvgpr_write_b32 a112, v48
    v_accvgpr_write_b32 a113, v49
    v_accvgpr_write_b32 a114, v50
    v_accvgpr_write_b32 a115, v51
    v_accvgpr_read_b32 v48, a128
    v_accvgpr_read_b32 v49, a129
    v_accvgpr_read_b32 v50, a130
    v_accvgpr_read_b32 v51, a131
    v_fma_f32 v48, v48, v57, v58
    v_fma_f32 v49, v49, v57, v58
    v_fma_f32 v50, v50, v57, v58
    v_fma_f32 v51, v51, v57, v58
    v_accvgpr_write_b32 a128, v48
    v_accvgpr_write_b32 a129, v49
    v_accvgpr_write_b32 a130, v50
    v_accvgpr_write_b32 a131, v51
    v_accvgpr_read_b32 v48, a144
    v_accvgpr_read_b32 v49, a145
    v_accvgpr_read_b32 v50, a146
    v_accvgpr_read_b32 v51, a147
    v_fma_f32 v48, v48, v57, v58
    v_fma_f32 v49, v49, v57, v58
    v_fma_f32 v50, v50, v57, v58
    v_fma_f32 v51, v51, v57, v58
    v_accvgpr_write_b32 a144, v48
    v_accvgpr_write_b32 a145, v49
    v_accvgpr_write_b32 a146, v50
    v_accvgpr_write_b32 a147, v51
    v_accvgpr_read_b32 v48, a160
    v_accvgpr_read_b32 v49, a161
    v_accvgpr_read_b32 v50, a162
    v_accvgpr_read_b32 v51, a163
    v_fma_f32 v48, v48, v57, v58
    v_fma_f32 v49, v49, v57, v58
    v_fma_f32 v50, v50, v57, v58
    v_fma_f32 v51, v51, v57, v58
    v_accvgpr_write_b32 a160, v48
    v_accvgpr_write_b32 a161, v49
    v_accvgpr_write_b32 a162, v50
    v_accvgpr_write_b32 a163, v51
    v_accvgpr_read_b32 v48, a176
    v_accvgpr_read_b32 v49, a177
    v_accvgpr_read_b32 v50, a178
    v_accvgpr_read_b32 v51, a179
    v_fma_f32 v48, v48, v57, v58
    v_fma_f32 v49, v49, v57, v58
    v_fma_f32 v50, v50, v57, v58
    v_fma_f32 v51, v51, v57, v58
    v_accvgpr_write_b32 a176, v48
    v_accvgpr_write_b32 a177, v49
    v_accvgpr_write_b32 a178, v50
    v_accvgpr_write_b32 a179, v51
    v_exp_f32 v48, v68
    v_exp_f32 v49, v69
    v_exp_f32 v50, v70
    v_exp_f32 v51, v71
    v_exp_f32 v52, v100
    v_exp_f32 v53, v101
    v_exp_f32 v54, v102
    v_exp_f32 v55, v103
    s_nop 0
    v_cvt_pk_bf16_f32 v196, v48, v49
    v_cvt_pk_bf16_f32 v197, v50, v51
    v_cvt_pk_bf16_f32 v198, v52, v53
    v_cvt_pk_bf16_f32 v199, v54, v55
    v_add_f32 v24, v48, v49
    v_add_f32 v24, v24, v50
    v_add_f32 v24, v24, v51
    v_add_f32 v24, v24, v52
    v_add_f32 v24, v24, v53
    v_add_f32 v24, v24, v54
    v_add_f32 v24, v24, v55
    v_max3_f32 v56, v76, v77, v78
    v_max3_f32 v56, v56, v79, v108
    v_max3_f32 v56, v56, v109, v110
    v_max3_f32 v56, v56, v111, 0
    v_mov_b32 v58, v56
    s_nop 1
    v_permlane16_swap_b32 v56, v58
    s_nop 1
    v_max_f32 v56, v56, v58
    v_mov_b32 v58, v56
    s_nop 1
    v_permlane32_swap_b32 v56, v58
    s_nop 1
    v_max_f32 v56, v56, v58
    v_exp_f32 v57, -v56
    v_sub_f32 v36, v36, v56
    v_sub_f32 v37, v37, v56
    v_sub_f32 v38, v38, v56
    v_sub_f32 v39, v39, v56
    v_mul_f32 v21, v21, v57
    v_sub_f32 v58, 1.0, v57
    v_sub_f32 v76, v76, v56
    v_sub_f32 v77, v77, v56
    v_sub_f32 v78, v78, v56
    v_sub_f32 v79, v79, v56
    v_sub_f32 v108, v108, v56
    v_sub_f32 v109, v109, v56
    v_sub_f32 v110, v110, v56
    v_sub_f32 v111, v111, v56
    v_sub_f32 v140, v140, v56
    v_sub_f32 v141, v141, v56
    v_sub_f32 v142, v142, v56
    v_sub_f32 v143, v143, v56
    v_sub_f32 v172, v172, v56
    v_sub_f32 v173, v173, v56
    v_sub_f32 v174, v174, v56
    v_sub_f32 v175, v175, v56
    v_accvgpr_read_b32 v48, a4
    v_accvgpr_read_b32 v49, a5
    v_accvgpr_read_b32 v50, a6
    v_accvgpr_read_b32 v51, a7
    v_fma_f32 v48, v48, v57, v58
    v_fma_f32 v49, v49, v57, v58
    v_fma_f32 v50, v50, v57, v58
    v_fma_f32 v51, v51, v57, v58
    v_accvgpr_write_b32 a4, v48
    v_accvgpr_write_b32 a5, v49
    v_accvgpr_write_b32 a6, v50
    v_accvgpr_write_b32 a7, v51
    v_accvgpr_read_b32 v48, a20
    v_accvgpr_read_b32 v49, a21
    v_accvgpr_read_b32 v50, a22
    v_accvgpr_read_b32 v51, a23
    v_fma_f32 v48, v48, v57, v58
    v_fma_f32 v49, v49, v57, v58
    v_fma_f32 v50, v50, v57, v58
    v_fma_f32 v51, v51, v57, v58
    v_accvgpr_write_b32 a20, v48
    v_accvgpr_write_b32 a21, v49
    v_accvgpr_write_b32 a22, v50
    v_accvgpr_write_b32 a23, v51
    v_accvgpr_read_b32 v48, a36
    v_accvgpr_read_b32 v49, a37
    v_accvgpr_read_b32 v50, a38
    v_accvgpr_read_b32 v51, a39
    v_fma_f32 v48, v48, v57, v58
    v_fma_f32 v49, v49, v57, v58
    v_fma_f32 v50, v50, v57, v58
    v_fma_f32 v51, v51, v57, v58
    v_accvgpr_write_b32 a36, v48
    v_accvgpr_write_b32 a37, v49
    v_accvgpr_write_b32 a38, v50
    v_accvgpr_write_b32 a39, v51
    v_accvgpr_read_b32 v48, a52
    v_accvgpr_read_b32 v49, a53
    v_accvgpr_read_b32 v50, a54
    v_accvgpr_read_b32 v51, a55
    v_fma_f32 v48, v48, v57, v58
    v_fma_f32 v49, v49, v57, v58
    v_fma_f32 v50, v50, v57, v58
    v_fma_f32 v51, v51, v57, v58
    v_accvgpr_write_b32 a52, v48
    v_accvgpr_write_b32 a53, v49
    v_accvgpr_write_b32 a54, v50
    v_accvgpr_write_b32 a55, v51
    v_accvgpr_read_b32 v48, a68
    v_accvgpr_read_b32 v49, a69
    v_accvgpr_read_b32 v50, a70
    v_accvgpr_read_b32 v51, a71
    v_fma_f32 v48, v48, v57, v58
    v_fma_f32 v49, v49, v57, v58
    v_fma_f32 v50, v50, v57, v58
    v_fma_f32 v51, v51, v57, v58
    v_accvgpr_write_b32 a68, v48
    v_accvgpr_write_b32 a69, v49
    v_accvgpr_write_b32 a70, v50
    v_accvgpr_write_b32 a71, v51
    v_accvgpr_read_b32 v48, a84
    v_accvgpr_read_b32 v49, a85
    v_accvgpr_read_b32 v50, a86
    v_accvgpr_read_b32 v51, a87
    v_fma_f32 v48, v48, v57, v58
    v_fma_f32 v49, v49, v57, v58
    v_fma_f32 v50, v50, v57, v58
    v_fma_f32 v51, v51, v57, v58
    v_accvgpr_write_b32 a84, v48
    v_accvgpr_write_b32 a85, v49
    v_accvgpr_write_b32 a86, v50
    v_accvgpr_write_b32 a87, v51
    v_accvgpr_read_b32 v48, a100
    v_accvgpr_read_b32 v49, a101
    v_accvgpr_read_b32 v50, a102
    v_accvgpr_read_b32 v51, a103
    v_fma_f32 v48, v48, v57, v58
    v_fma_f32 v49, v49, v57, v58
    v_fma_f32 v50, v50, v57, v58
    v_fma_f32 v51, v51, v57, v58
    v_accvgpr_write_b32 a100, v48
    v_accvgpr_write_b32 a101, v49
    v_accvgpr_write_b32 a102, v50
    v_accvgpr_write_b32 a103, v51
    v_accvgpr_read_b32 v48, a116
    v_accvgpr_read_b32 v49, a117
    v_accvgpr_read_b32 v50, a118
    v_accvgpr_read_b32 v51, a119
    v_fma_f32 v48, v48, v57, v58
    v_fma_f32 v49, v49, v57, v58
    v_fma_f32 v50, v50, v57, v58
    v_fma_f32 v51, v51, v57, v58
    v_accvgpr_write_b32 a116, v48
    v_accvgpr_write_b32 a117, v49
    v_accvgpr_write_b32 a118, v50
    v_accvgpr_write_b32 a119, v51
    v_accvgpr_read_b32 v48, a132
    v_accvgpr_read_b32 v49, a133
    v_accvgpr_read_b32 v50, a134
    v_accvgpr_read_b32 v51, a135
    v_fma_f32 v48, v48, v57, v58
    v_fma_f32 v49, v49, v57, v58
    v_fma_f32 v50, v50, v57, v58
    v_fma_f32 v51, v51, v57, v58
    v_accvgpr_write_b32 a132, v48
    v_accvgpr_write_b32 a133, v49
    v_accvgpr_write_b32 a134, v50
    v_accvgpr_write_b32 a135, v51
    v_accvgpr_read_b32 v48, a148
    v_accvgpr_read_b32 v49, a149
    v_accvgpr_read_b32 v50, a150
    v_accvgpr_read_b32 v51, a151
    v_fma_f32 v48, v48, v57, v58
    v_fma_f32 v49, v49, v57, v58
    v_fma_f32 v50, v50, v57, v58
    v_fma_f32 v51, v51, v57, v58
    v_accvgpr_write_b32 a148, v48
    v_accvgpr_write_b32 a149, v49
    v_accvgpr_write_b32 a150, v50
    v_accvgpr_write_b32 a151, v51
    v_accvgpr_read_b32 v48, a164
    v_accvgpr_read_b32 v49, a165
    v_accvgpr_read_b32 v50, a166
    v_accvgpr_read_b32 v51, a167
    v_fma_f32 v48, v48, v57, v58
    v_fma_f32 v49, v49, v57, v58
    v_fma_f32 v50, v50, v57, v58
    v_fma_f32 v51, v51, v57, v58
    v_accvgpr_write_b32 a164, v48
    v_accvgpr_write_b32 a165, v49
    v_accvgpr_write_b32 a166, v50
    v_accvgpr_write_b32 a167, v51
    v_accvgpr_read_b32 v48, a180
    v_accvgpr_read_b32 v49, a181
    v_accvgpr_read_b32 v50, a182
    v_accvgpr_read_b32 v51, a183
    v_fma_f32 v48, v48, v57, v58
    v_fma_f32 v49, v49, v57, v58
    v_fma_f32 v50, v50, v57, v58
    v_fma_f32 v51, v51, v57, v58
    v_accvgpr_write_b32 a180, v48
    v_accvgpr_write_b32 a181, v49
    v_accvgpr_write_b32 a182, v50
    v_accvgpr_write_b32 a183, v51
    v_exp_f32 v48, v76
    v_exp_f32 v49, v77
    v_exp_f32 v50, v78
    v_exp_f32 v51, v79
    v_exp_f32 v52, v108
    v_exp_f32 v53, v109
    v_exp_f32 v54, v110
    v_exp_f32 v55, v111
    s_nop 0
    v_cvt_pk_bf16_f32 v204, v48, v49
    v_cvt_pk_bf16_f32 v205, v50, v51
    v_cvt_pk_bf16_f32 v206, v52, v53
    v_cvt_pk_bf16_f32 v207, v54, v55
    v_add_f32 v25, v48, v49
    v_add_f32 v25, v25, v50
    v_add_f32 v25, v25, v51
    v_add_f32 v25, v25, v52
    v_add_f32 v25, v25, v53
    v_add_f32 v25, v25, v54
    v_add_f32 v25, v25, v55
    v_max3_f32 v56, v84, v85, v86
    v_max3_f32 v56, v56, v87, v116
    v_max3_f32 v56, v56, v117, v118
    v_max3_f32 v56, v56, v119, 0
    v_mov_b32 v58, v56
    s_nop 1
    v_permlane16_swap_b32 v56, v58
    s_nop 1
    v_max_f32 v56, v56, v58
    v_mov_b32 v58, v56
    s_nop 1
    v_permlane32_swap_b32 v56, v58
    s_nop 1
    v_max_f32 v56, v56, v58
    v_exp_f32 v57, -v56
    v_sub_f32 v40, v40, v56
    v_sub_f32 v41, v41, v56
    v_sub_f32 v42, v42, v56
    v_sub_f32 v43, v43, v56
    v_mul_f32 v22, v22, v57
    v_sub_f32 v58, 1.0, v57
    v_sub_f32 v84, v84, v56
    v_sub_f32 v85, v85, v56
    v_sub_f32 v86, v86, v56
    v_sub_f32 v87, v87, v56
    v_sub_f32 v116, v116, v56
    v_sub_f32 v117, v117, v56
    v_sub_f32 v118, v118, v56
    v_sub_f32 v119, v119, v56
    v_sub_f32 v148, v148, v56
    v_sub_f32 v149, v149, v56
    v_sub_f32 v150, v150, v56
    v_sub_f32 v151, v151, v56
    v_sub_f32 v180, v180, v56
    v_sub_f32 v181, v181, v56
    v_sub_f32 v182, v182, v56
    v_sub_f32 v183, v183, v56
    v_accvgpr_read_b32 v48, a8
    v_accvgpr_read_b32 v49, a9
    v_accvgpr_read_b32 v50, a10
    v_accvgpr_read_b32 v51, a11
    v_fma_f32 v48, v48, v57, v58
    v_fma_f32 v49, v49, v57, v58
    v_fma_f32 v50, v50, v57, v58
    v_fma_f32 v51, v51, v57, v58
    v_accvgpr_write_b32 a8, v48
    v_accvgpr_write_b32 a9, v49
    v_accvgpr_write_b32 a10, v50
    v_accvgpr_write_b32 a11, v51
    v_accvgpr_read_b32 v48, a24
    v_accvgpr_read_b32 v49, a25
    v_accvgpr_read_b32 v50, a26
    v_accvgpr_read_b32 v51, a27
    v_fma_f32 v48, v48, v57, v58
    v_fma_f32 v49, v49, v57, v58
    v_fma_f32 v50, v50, v57, v58
    v_fma_f32 v51, v51, v57, v58
    v_accvgpr_write_b32 a24, v48
    v_accvgpr_write_b32 a25, v49
    v_accvgpr_write_b32 a26, v50
    v_accvgpr_write_b32 a27, v51
    v_accvgpr_read_b32 v48, a40
    v_accvgpr_read_b32 v49, a41
    v_accvgpr_read_b32 v50, a42
    v_accvgpr_read_b32 v51, a43
    v_fma_f32 v48, v48, v57, v58
    v_fma_f32 v49, v49, v57, v58
    v_fma_f32 v50, v50, v57, v58
    v_fma_f32 v51, v51, v57, v58
    v_accvgpr_write_b32 a40, v48
    v_accvgpr_write_b32 a41, v49
    v_accvgpr_write_b32 a42, v50
    v_accvgpr_write_b32 a43, v51
    v_accvgpr_read_b32 v48, a56
    v_accvgpr_read_b32 v49, a57
    v_accvgpr_read_b32 v50, a58
    v_accvgpr_read_b32 v51, a59
    v_fma_f32 v48, v48, v57, v58
    v_fma_f32 v49, v49, v57, v58
    v_fma_f32 v50, v50, v57, v58
    v_fma_f32 v51, v51, v57, v58
    v_accvgpr_write_b32 a56, v48
    v_accvgpr_write_b32 a57, v49
    v_accvgpr_write_b32 a58, v50
    v_accvgpr_write_b32 a59, v51
    v_accvgpr_read_b32 v48, a72
    v_accvgpr_read_b32 v49, a73
    v_accvgpr_read_b32 v50, a74
    v_accvgpr_read_b32 v51, a75
    v_fma_f32 v48, v48, v57, v58
    v_fma_f32 v49, v49, v57, v58
    v_fma_f32 v50, v50, v57, v58
    v_fma_f32 v51, v51, v57, v58
    v_accvgpr_write_b32 a72, v48
    v_accvgpr_write_b32 a73, v49
    v_accvgpr_write_b32 a74, v50
    v_accvgpr_write_b32 a75, v51
    v_accvgpr_read_b32 v48, a88
    v_accvgpr_read_b32 v49, a89
    v_accvgpr_read_b32 v50, a90
    v_accvgpr_read_b32 v51, a91
    v_fma_f32 v48, v48, v57, v58
    v_fma_f32 v49, v49, v57, v58
    v_fma_f32 v50, v50, v57, v58
    v_fma_f32 v51, v51, v57, v58
    v_accvgpr_write_b32 a88, v48
    v_accvgpr_write_b32 a89, v49
    v_accvgpr_write_b32 a90, v50
    v_accvgpr_write_b32 a91, v51
    v_accvgpr_read_b32 v48, a104
    v_accvgpr_read_b32 v49, a105
    v_accvgpr_read_b32 v50, a106
    v_accvgpr_read_b32 v51, a107
    v_fma_f32 v48, v48, v57, v58
    v_fma_f32 v49, v49, v57, v58
    v_fma_f32 v50, v50, v57, v58
    v_fma_f32 v51, v51, v57, v58
    v_accvgpr_write_b32 a104, v48
    v_accvgpr_write_b32 a105, v49
    v_accvgpr_write_b32 a106, v50
    v_accvgpr_write_b32 a107, v51
    v_accvgpr_read_b32 v48, a120
    v_accvgpr_read_b32 v49, a121
    v_accvgpr_read_b32 v50, a122
    v_accvgpr_read_b32 v51, a123
    v_fma_f32 v48, v48, v57, v58
    v_fma_f32 v49, v49, v57, v58
    v_fma_f32 v50, v50, v57, v58
    v_fma_f32 v51, v51, v57, v58
    v_accvgpr_write_b32 a120, v48
    v_accvgpr_write_b32 a121, v49
    v_accvgpr_write_b32 a122, v50
    v_accvgpr_write_b32 a123, v51
    v_accvgpr_read_b32 v48, a136
    v_accvgpr_read_b32 v49, a137
    v_accvgpr_read_b32 v50, a138
    v_accvgpr_read_b32 v51, a139
    v_fma_f32 v48, v48, v57, v58
    v_fma_f32 v49, v49, v57, v58
    v_fma_f32 v50, v50, v57, v58
    v_fma_f32 v51, v51, v57, v58
    v_accvgpr_write_b32 a136, v48
    v_accvgpr_write_b32 a137, v49
    v_accvgpr_write_b32 a138, v50
    v_accvgpr_write_b32 a139, v51
    v_accvgpr_read_b32 v48, a152
    v_accvgpr_read_b32 v49, a153
    v_accvgpr_read_b32 v50, a154
    v_accvgpr_read_b32 v51, a155
    v_fma_f32 v48, v48, v57, v58
    v_fma_f32 v49, v49, v57, v58
    v_fma_f32 v50, v50, v57, v58
    v_fma_f32 v51, v51, v57, v58
    v_accvgpr_write_b32 a152, v48
    v_accvgpr_write_b32 a153, v49
    v_accvgpr_write_b32 a154, v50
    v_accvgpr_write_b32 a155, v51
    v_accvgpr_read_b32 v48, a168
    v_accvgpr_read_b32 v49, a169
    v_accvgpr_read_b32 v50, a170
    v_accvgpr_read_b32 v51, a171
    v_fma_f32 v48, v48, v57, v58
    v_fma_f32 v49, v49, v57, v58
    v_fma_f32 v50, v50, v57, v58
    v_fma_f32 v51, v51, v57, v58
    v_accvgpr_write_b32 a168, v48
    v_accvgpr_write_b32 a169, v49
    v_accvgpr_write_b32 a170, v50
    v_accvgpr_write_b32 a171, v51
    v_accvgpr_read_b32 v48, a184
    v_accvgpr_read_b32 v49, a185
    v_accvgpr_read_b32 v50, a186
    v_accvgpr_read_b32 v51, a187
    v_fma_f32 v48, v48, v57, v58
    v_fma_f32 v49, v49, v57, v58
    v_fma_f32 v50, v50, v57, v58
    v_fma_f32 v51, v51, v57, v58
    v_accvgpr_write_b32 a184, v48
    v_accvgpr_write_b32 a185, v49
    v_accvgpr_write_b32 a186, v50
    v_accvgpr_write_b32 a187, v51
    v_exp_f32 v48, v84
    v_exp_f32 v49, v85
    v_exp_f32 v50, v86
    v_exp_f32 v51, v87
    v_exp_f32 v52, v116
    v_exp_f32 v53, v117
    v_exp_f32 v54, v118
    v_exp_f32 v55, v119
    s_nop 0
    v_cvt_pk_bf16_f32 v212, v48, v49
    v_cvt_pk_bf16_f32 v213, v50, v51
    v_cvt_pk_bf16_f32 v214, v52, v53
    v_cvt_pk_bf16_f32 v215, v54, v55
    v_add_f32 v26, v48, v49
    v_add_f32 v26, v26, v50
    v_add_f32 v26, v26, v51
    v_add_f32 v26, v26, v52
    v_add_f32 v26, v26, v53
    v_add_f32 v26, v26, v54
    v_add_f32 v26, v26, v55
    v_max3_f32 v56, v92, v93, v94
    v_max3_f32 v56, v56, v95, v124
    v_max3_f32 v56, v56, v125, v126
    v_max3_f32 v56, v56, v127, 0
    v_mov_b32 v58, v56
    s_nop 1
    v_permlane16_swap_b32 v56, v58
    s_nop 1
    v_max_f32 v56, v56, v58
    v_mov_b32 v58, v56
    s_nop 1
    v_permlane32_swap_b32 v56, v58
    s_nop 1
    v_max_f32 v56, v56, v58
    v_exp_f32 v57, -v56
    v_sub_f32 v44, v44, v56
    v_sub_f32 v45, v45, v56
    v_sub_f32 v46, v46, v56
    v_sub_f32 v47, v47, v56
    v_mul_f32 v23, v23, v57
    v_sub_f32 v58, 1.0, v57
    v_sub_f32 v92, v92, v56
    v_sub_f32 v93, v93, v56
    v_sub_f32 v94, v94, v56
    v_sub_f32 v95, v95, v56
    v_sub_f32 v124, v124, v56
    v_sub_f32 v125, v125, v56
    v_sub_f32 v126, v126, v56
    v_sub_f32 v127, v127, v56
    v_sub_f32 v156, v156, v56
    v_sub_f32 v157, v157, v56
    v_sub_f32 v158, v158, v56
    v_sub_f32 v159, v159, v56
    v_sub_f32 v188, v188, v56
    v_sub_f32 v189, v189, v56
    v_sub_f32 v190, v190, v56
    v_sub_f32 v191, v191, v56
    v_accvgpr_read_b32 v48, a12
    v_accvgpr_read_b32 v49, a13
    v_accvgpr_read_b32 v50, a14
    v_accvgpr_read_b32 v51, a15
    v_fma_f32 v48, v48, v57, v58
    v_fma_f32 v49, v49, v57, v58
    v_fma_f32 v50, v50, v57, v58
    v_fma_f32 v51, v51, v57, v58
    v_accvgpr_write_b32 a12, v48
    v_accvgpr_write_b32 a13, v49
    v_accvgpr_write_b32 a14, v50
    v_accvgpr_write_b32 a15, v51
    v_accvgpr_read_b32 v48, a28
    v_accvgpr_read_b32 v49, a29
    v_accvgpr_read_b32 v50, a30
    v_accvgpr_read_b32 v51, a31
    v_fma_f32 v48, v48, v57, v58
    v_fma_f32 v49, v49, v57, v58
    v_fma_f32 v50, v50, v57, v58
    v_fma_f32 v51, v51, v57, v58
    v_accvgpr_write_b32 a28, v48
    v_accvgpr_write_b32 a29, v49
    v_accvgpr_write_b32 a30, v50
    v_accvgpr_write_b32 a31, v51
    v_accvgpr_read_b32 v48, a44
    v_accvgpr_read_b32 v49, a45
    v_accvgpr_read_b32 v50, a46
    v_accvgpr_read_b32 v51, a47
    v_fma_f32 v48, v48, v57, v58
    v_fma_f32 v49, v49, v57, v58
    v_fma_f32 v50, v50, v57, v58
    v_fma_f32 v51, v51, v57, v58
    v_accvgpr_write_b32 a44, v48
    v_accvgpr_write_b32 a45, v49
    v_accvgpr_write_b32 a46, v50
    v_accvgpr_write_b32 a47, v51
    v_accvgpr_read_b32 v48, a60
    v_accvgpr_read_b32 v49, a61
    v_accvgpr_read_b32 v50, a62
    v_accvgpr_read_b32 v51, a63
    v_fma_f32 v48, v48, v57, v58
    v_fma_f32 v49, v49, v57, v58
    v_fma_f32 v50, v50, v57, v58
    v_fma_f32 v51, v51, v57, v58
    v_accvgpr_write_b32 a60, v48
    v_accvgpr_write_b32 a61, v49
    v_accvgpr_write_b32 a62, v50
    v_accvgpr_write_b32 a63, v51
    v_accvgpr_read_b32 v48, a76
    v_accvgpr_read_b32 v49, a77
    v_accvgpr_read_b32 v50, a78
    v_accvgpr_read_b32 v51, a79
    v_fma_f32 v48, v48, v57, v58
    v_fma_f32 v49, v49, v57, v58
    v_fma_f32 v50, v50, v57, v58
    v_fma_f32 v51, v51, v57, v58
    v_accvgpr_write_b32 a76, v48
    v_accvgpr_write_b32 a77, v49
    v_accvgpr_write_b32 a78, v50
    v_accvgpr_write_b32 a79, v51
    v_accvgpr_read_b32 v48, a92
    v_accvgpr_read_b32 v49, a93
    v_accvgpr_read_b32 v50, a94
    v_accvgpr_read_b32 v51, a95
    v_fma_f32 v48, v48, v57, v58
    v_fma_f32 v49, v49, v57, v58
    v_fma_f32 v50, v50, v57, v58
    v_fma_f32 v51, v51, v57, v58
    v_accvgpr_write_b32 a92, v48
    v_accvgpr_write_b32 a93, v49
    v_accvgpr_write_b32 a94, v50
    v_accvgpr_write_b32 a95, v51
    v_accvgpr_read_b32 v48, a108
    v_accvgpr_read_b32 v49, a109
    v_accvgpr_read_b32 v50, a110
    v_accvgpr_read_b32 v51, a111
    v_fma_f32 v48, v48, v57, v58
    v_fma_f32 v49, v49, v57, v58
    v_fma_f32 v50, v50, v57, v58
    v_fma_f32 v51, v51, v57, v58
    v_accvgpr_write_b32 a108, v48
    v_accvgpr_write_b32 a109, v49
    v_accvgpr_write_b32 a110, v50
    v_accvgpr_write_b32 a111, v51
    v_accvgpr_read_b32 v48, a124
    v_accvgpr_read_b32 v49, a125
    v_accvgpr_read_b32 v50, a126
    v_accvgpr_read_b32 v51, a127
    v_fma_f32 v48, v48, v57, v58
    v_fma_f32 v49, v49, v57, v58
    v_fma_f32 v50, v50, v57, v58
    v_fma_f32 v51, v51, v57, v58
    v_accvgpr_write_b32 a124, v48
    v_accvgpr_write_b32 a125, v49
    v_accvgpr_write_b32 a126, v50
    v_accvgpr_write_b32 a127, v51
    v_accvgpr_read_b32 v48, a140
    v_accvgpr_read_b32 v49, a141
    v_accvgpr_read_b32 v50, a142
    v_accvgpr_read_b32 v51, a143
    v_fma_f32 v48, v48, v57, v58
    v_fma_f32 v49, v49, v57, v58
    v_fma_f32 v50, v50, v57, v58
    v_fma_f32 v51, v51, v57, v58
    v_accvgpr_write_b32 a140, v48
    v_accvgpr_write_b32 a141, v49
    v_accvgpr_write_b32 a142, v50
    v_accvgpr_write_b32 a143, v51
    v_accvgpr_read_b32 v48, a156
    v_accvgpr_read_b32 v49, a157
    v_accvgpr_read_b32 v50, a158
    v_accvgpr_read_b32 v51, a159
    v_fma_f32 v48, v48, v57, v58
    v_fma_f32 v49, v49, v57, v58
    v_fma_f32 v50, v50, v57, v58
    v_fma_f32 v51, v51, v57, v58
    v_accvgpr_write_b32 a156, v48
    v_accvgpr_write_b32 a157, v49
    v_accvgpr_write_b32 a158, v50
    v_accvgpr_write_b32 a159, v51
    v_accvgpr_read_b32 v48, a172
    v_accvgpr_read_b32 v49, a173
    v_accvgpr_read_b32 v50, a174
    v_accvgpr_read_b32 v51, a175
    v_fma_f32 v48, v48, v57, v58
    v_fma_f32 v49, v49, v57, v58
    v_fma_f32 v50, v50, v57, v58
    v_fma_f32 v51, v51, v57, v58
    v_accvgpr_write_b32 a172, v48
    v_accvgpr_write_b32 a173, v49
    v_accvgpr_write_b32 a174, v50
    v_accvgpr_write_b32 a175, v51
    v_accvgpr_read_b32 v48, a188
    v_accvgpr_read_b32 v49, a189
    v_accvgpr_read_b32 v50, a190
    v_accvgpr_read_b32 v51, a191
    v_fma_f32 v48, v48, v57, v58
    v_fma_f32 v49, v49, v57, v58
    v_fma_f32 v50, v50, v57, v58
    v_fma_f32 v51, v51, v57, v58
    v_accvgpr_write_b32 a188, v48
    v_accvgpr_write_b32 a189, v49
    v_accvgpr_write_b32 a190, v50
    v_accvgpr_write_b32 a191, v51
    v_exp_f32 v48, v92
    v_exp_f32 v49, v93
    v_exp_f32 v50, v94
    v_exp_f32 v51, v95
    v_exp_f32 v52, v124
    v_exp_f32 v53, v125
    v_exp_f32 v54, v126
    v_exp_f32 v55, v127
    s_nop 0
    v_cvt_pk_bf16_f32 v220, v48, v49
    v_cvt_pk_bf16_f32 v221, v50, v51
    v_cvt_pk_bf16_f32 v222, v52, v53
    v_cvt_pk_bf16_f32 v223, v54, v55
    v_add_f32 v27, v48, v49
    v_add_f32 v27, v27, v50
    v_add_f32 v27, v27, v51
    v_add_f32 v27, v27, v52
    v_add_f32 v27, v27, v53
    v_add_f32 v27, v27, v54
    v_add_f32 v27, v27, v55
    s_nop 1
    s_branch rare_b_ret
rare_e:
    s_nop 7
    s_nop 7
    v_max3_f32 v56, v132, v133, v134
    v_max3_f32 v56, v56, v135, v164
    v_max3_f32 v56, v56, v165, v166
    v_max3_f32 v56, v56, v167, 0
    v_mov_b32 v58, v56
    s_nop 1
    v_permlane16_swap_b32 v56, v58
    s_nop 1
    v_max_f32 v56, v56, v58
    v_mov_b32 v58, v56
    s_nop 1
    v_permlane32_swap_b32 v56, v58
    s_nop 1
    v_max_f32 v56, v56, v58
    v_exp_f32 v57, -v56
    v_sub_f32 v32, v32, v56
    v_sub_f32 v33, v33, v56
    v_sub_f32 v34, v34, v56
    v_sub_f32 v35, v35, v56
    v_mul_f32 v20, v20, v57
    v_sub_f32 v58, 1.0, v57
    v_sub_f32 v132, v132, v56
    v_sub_f32 v133, v133, v56
    v_sub_f32 v134, v134, v56
    v_sub_f32 v135, v135, v56
    v_sub_f32 v164, v164, v56
    v_sub_f32 v165, v165, v56
    v_sub_f32 v166, v166, v56
    v_sub_f32 v167, v167, v56
    v_accvgpr_read_b32 v48, a0
    v_accvgpr_read_b32 v49, a1
    v_accvgpr_read_b32 v50, a2
    v_accvgpr_read_b32 v51, a3
    v_fma_f32 v48, v48, v57, v58
    v_fma_f32 v49, v49, v57, v58
    v_fma_f32 v50, v50, v57, v58
    v_fma_f32 v51, v51, v57, v58
    v_accvgpr_write_b32 a0, v48
    v_accvgpr_write_b32 a1, v49
    v_accvgpr_write_b32 a2, v50
    v_accvgpr_write_b32 a3, v51
    v_accvgpr_read_b32 v48, a16
    v_accvgpr_read_b32 v49, a17
    v_accvgpr_read_b32 v50, a18
    v_accvgpr_read_b32 v51, a19
    v_fma_f32 v48, v48, v57, v58
    v_fma_f32 v49, v49, v57, v58
    v_fma_f32 v50, v50, v57, v58
    v_fma_f32 v51, v51, v57, v58
    v_accvgpr_write_b32 a16, v48
    v_accvgpr_write_b32 a17, v49
    v_accvgpr_write_b32 a18, v50
    v_accvgpr_write_b32 a19, v51
    v_accvgpr_read_b32 v48, a32
    v_accvgpr_read_b32 v49, a33
    v_accvgpr_read_b32 v50, a34
    v_accvgpr_read_b32 v51, a35
    v_fma_f32 v48, v48, v57, v58
    v_fma_f32 v49, v49, v57, v58
    v_fma_f32 v50, v50, v57, v58
    v_fma_f32 v51, v51, v57, v58
    v_accvgpr_write_b32 a32, v48
    v_accvgpr_write_b32 a33, v49
    v_accvgpr_write_b32 a34, v50
    v_accvgpr_write_b32 a35, v51
    v_accvgpr_read_b32 v48, a48
    v_accvgpr_read_b32 v49, a49
    v_accvgpr_read_b32 v50, a50
    v_accvgpr_read_b32 v51, a51
    v_fma_f32 v48, v48, v57, v58
    v_fma_f32 v49, v49, v57, v58
    v_fma_f32 v50, v50, v57, v58
    v_fma_f32 v51, v51, v57, v58
    v_accvgpr_write_b32 a48, v48
    v_accvgpr_write_b32 a49, v49
    v_accvgpr_write_b32 a50, v50
    v_accvgpr_write_b32 a51, v51
    v_accvgpr_read_b32 v48, a64
    v_accvgpr_read_b32 v49, a65
    v_accvgpr_read_b32 v50, a66
    v_accvgpr_read_b32 v51, a67
    v_fma_f32 v48, v48, v57, v58
    v_fma_f32 v49, v49, v57, v58
    v_fma_f32 v50, v50, v57, v58
    v_fma_f32 v51, v51, v57, v58
    v_accvgpr_write_b32 a64, v48
    v_accvgpr_write_b32 a65, v49
    v_accvgpr_write_b32 a66, v50
    v_accvgpr_write_b32 a67, v51
    v_accvgpr_read_b32 v48, a80
    v_accvgpr_read_b32 v49, a81
    v_accvgpr_read_b32 v50, a82
    v_accvgpr_read_b32 v51, a83
    v_fma_f32 v48, v48, v57, v58
    v_fma_f32 v49, v49, v57, v58
    v_fma_f32 v50, v50, v57, v58
    v_fma_f32 v51, v51, v57, v58
    v_accvgpr_write_b32 a80, v48
    v_accvgpr_write_b32 a81, v49
    v_accvgpr_write_b32 a82, v50
    v_accvgpr_write_b32 a83, v51
    v_accvgpr_read_b32 v48, a96
    v_accvgpr_read_b32 v49, a97
    v_accvgpr_read_b32 v50, a98
    v_accvgpr_read_b32 v51, a99
    v_fma_f32 v48, v48, v57, v58
    v_fma_f32 v49, v49, v57, v58
    v_fma_f32 v50, v50, v57, v58
    v_fma_f32 v51, v51, v57, v58
    v_accvgpr_write_b32 a96, v48
    v_accvgpr_write_b32 a97, v49
    v_accvgpr_write_b32 a98, v50
    v_accvgpr_write_b32 a99, v51
    v_accvgpr_read_b32 v48, a112
    v_accvgpr_read_b32 v49, a113
    v_accvgpr_read_b32 v50, a114
    v_accvgpr_read_b32 v51, a115
    v_fma_f32 v48, v48, v57, v58
    v_fma_f32 v49, v49, v57, v58
    v_fma_f32 v50, v50, v57, v58
    v_fma_f32 v51, v51, v57, v58
    v_accvgpr_write_b32 a112, v48
    v_accvgpr_write_b32 a113, v49
    v_accvgpr_write_b32 a114, v50
    v_accvgpr_write_b32 a115, v51
    v_accvgpr_read_b32 v48, a128
    v_accvgpr_read_b32 v49, a129
    v_accvgpr_read_b32 v50, a130
    v_accvgpr_read_b32 v51, a131
    v_fma_f32 v48, v48, v57, v58
    v_fma_f32 v49, v49, v57, v58
    v_fma_f32 v50, v50, v57, v58
    v_fma_f32 v51, v51, v57, v58
    v_accvgpr_write_b32 a128, v48
    v_accvgpr_write_b32 a129, v49
    v_accvgpr_write_b32 a130, v50
    v_accvgpr_write_b32 a131, v51
    v_accvgpr_read_b32 v48, a144
    v_accvgpr_read_b32 v49, a145
    v_accvgpr_read_b32 v50, a146
    v_accvgpr_read_b32 v51, a147
    v_fma_f32 v48, v48, v57, v58
    v_fma_f32 v49, v49, v57, v58
    v_fma_f32 v50, v50, v57, v58
    v_fma_f32 v51, v51, v57, v58
    v_accvgpr_write_b32 a144, v48
    v_accvgpr_write_b32 a145, v49
    v_accvgpr_write_b32 a146, v50
    v_accvgpr_write_b32 a147, v51
    v_accvgpr_read_b32 v48, a160
    v_accvgpr_read_b32 v49, a161
    v_accvgpr_read_b32 v50, a162
    v_accvgpr_read_b32 v51, a163
    v_fma_f32 v48, v48, v57, v58
    v_fma_f32 v49, v49, v57, v58
    v_fma_f32 v50, v50, v57, v58
    v_fma_f32 v51, v51, v57, v58
    v_accvgpr_write_b32 a160, v48
    v_accvgpr_write_b32 a161, v49
    v_accvgpr_write_b32 a162, v50
    v_accvgpr_write_b32 a163, v51
    v_accvgpr_read_b32 v48, a176
    v_accvgpr_read_b32 v49, a177
    v_accvgpr_read_b32 v50, a178
    v_accvgpr_read_b32 v51, a179
    v_fma_f32 v48, v48, v57, v58
    v_fma_f32 v49, v49, v57, v58
    v_fma_f32 v50, v50, v57, v58
    v_fma_f32 v51, v51, v57, v58
    v_accvgpr_write_b32 a176, v48
    v_accvgpr_write_b32 a177, v49
    v_accvgpr_write_b32 a178, v50
    v_accvgpr_write_b32 a179, v51
    v_exp_f32 v48, v132
    v_exp_f32 v49, v133
    v_exp_f32 v50, v134
    v_exp_f32 v51, v135
    v_exp_f32 v52, v164
    v_exp_f32 v53, v165
    v_exp_f32 v54, v166
    v_exp_f32 v55, v167
    s_nop 0
    v_cvt_pk_bf16_f32 v228, v48, v49
    v_cvt_pk_bf16_f32 v229, v50, v51
    v_cvt_pk_bf16_f32 v230, v52, v53
    v_cvt_pk_bf16_f32 v231, v54, v55
    v_add_f32 v24, v48, v49
    v_add_f32 v24, v24, v50
    v_add_f32 v24, v24, v51
    v_add_f32 v24, v24, v52
    v_add_f32 v24, v24, v53
    v_add_f32 v24, v24, v54
    v_add_f32 v24, v24, v55
    v_max3_f32 v56, v140, v141, v142
    v_max3_f32 v56, v56, v143, v172
    v_max3_f32 v56, v56, v173, v174
    v_max3_f32 v56, v56, v175, 0
    v_mov_b32 v58, v56
    s_nop 1
    v_permlane16_swap_b32 v56, v58
    s_nop 1
    v_max_f32 v56, v56, v58
    v_mov_b32 v58, v56
    s_nop 1
    v_permlane32_swap_b32 v56, v58
    s_nop 1
    v_max_f32 v56, v56, v58
    v_exp_f32 v57, -v56
    v_sub_f32 v36, v36, v56
    v_sub_f32 v37, v37, v56
    v_sub_f32 v38, v38, v56
    v_sub_f32 v39, v39, v56
    v_mul_f32 v21, v21, v57
    v_sub_f32 v58, 1.0, v57
    v_sub_f32 v140, v140, v56
    v_sub_f32 v141, v141, v56
    v_sub_f32 v142, v142, v56
    v_sub_f32 v143, v143, v56
    v_sub_f32 v172, v172, v56
    v_sub_f32 v173, v173, v56
    v_sub_f32 v174, v174, v56
    v_sub_f32 v175, v175, v56
    v_accvgpr_read_b32 v48, a4
    v_accvgpr_read_b32 v49, a5
    v_accvgpr_read_b32 v50, a6
    v_accvgpr_read_b32 v51, a7
    v_fma_f32 v48, v48, v57, v58
    v_fma_f32 v49, v49, v57, v58
    v_fma_f32 v50, v50, v57, v58
    v_fma_f32 v51, v51, v57, v58
    v_accvgpr_write_b32 a4, v48
    v_accvgpr_write_b32 a5, v49
    v_accvgpr_write_b32 a6, v50
    v_accvgpr_write_b32 a7, v51
    v_accvgpr_read_b32 v48, a20
    v_accvgpr_read_b32 v49, a21
    v_accvgpr_read_b32 v50, a22
    v_accvgpr_read_b32 v51, a23
    v_fma_f32 v48, v48, v57, v58
    v_fma_f32 v49, v49, v57, v58
    v_fma_f32 v50, v50, v57, v58
    v_fma_f32 v51, v51, v57, v58
    v_accvgpr_write_b32 a20, v48
    v_accvgpr_write_b32 a21, v49
    v_accvgpr_write_b32 a22, v50
    v_accvgpr_write_b32 a23, v51
    v_accvgpr_read_b32 v48, a36
    v_accvgpr_read_b32 v49, a37
    v_accvgpr_read_b32 v50, a38
    v_accvgpr_read_b32 v51, a39
    v_fma_f32 v48, v48, v57, v58
    v_fma_f32 v49, v49, v57, v58
    v_fma_f32 v50, v50, v57, v58
    v_fma_f32 v51, v51, v57, v58
    v_accvgpr_write_b32 a36, v48
    v_accvgpr_write_b32 a37, v49
    v_accvgpr_write_b32 a38, v50
    v_accvgpr_write_b32 a39, v51
    v_accvgpr_read_b32 v48, a52
    v_accvgpr_read_b32 v49, a53
    v_accvgpr_read_b32 v50, a54
    v_accvgpr_read_b32 v51, a55
    v_fma_f32 v48, v48, v57, v58
    v_fma_f32 v49, v49, v57, v58
    v_fma_f32 v50, v50, v57, v58
    v_fma_f32 v51, v51, v57, v58
    v_accvgpr_write_b32 a52, v48
    v_accvgpr_write_b32 a53, v49
    v_accvgpr_write_b32 a54, v50
    v_accvgpr_write_b32 a55, v51
    v_accvgpr_read_b32 v48, a68
    v_accvgpr_read_b32 v49, a69
    v_accvgpr_read_b32 v50, a70
    v_accvgpr_read_b32 v51, a71
    v_fma_f32 v48, v48, v57, v58
    v_fma_f32 v49, v49, v57, v58
    v_fma_f32 v50, v50, v57, v58
    v_fma_f32 v51, v51, v57, v58
    v_accvgpr_write_b32 a68, v48
    v_accvgpr_write_b32 a69, v49
    v_accvgpr_write_b32 a70, v50
    v_accvgpr_write_b32 a71, v51
    v_accvgpr_read_b32 v48, a84
    v_accvgpr_read_b32 v49, a85
    v_accvgpr_read_b32 v50, a86
    v_accvgpr_read_b32 v51, a87
    v_fma_f32 v48, v48, v57, v58
    v_fma_f32 v49, v49, v57, v58
    v_fma_f32 v50, v50, v57, v58
    v_fma_f32 v51, v51, v57, v58
    v_accvgpr_write_b32 a84, v48
    v_accvgpr_write_b32 a85, v49
    v_accvgpr_write_b32 a86, v50
    v_accvgpr_write_b32 a87, v51
    v_accvgpr_read_b32 v48, a100
    v_accvgpr_read_b32 v49, a101
    v_accvgpr_read_b32 v50, a102
    v_accvgpr_read_b32 v51, a103
    v_fma_f32 v48, v48, v57, v58
    v_fma_f32 v49, v49, v57, v58
    v_fma_f32 v50, v50, v57, v58
    v_fma_f32 v51, v51, v57, v58
    v_accvgpr_write_b32 a100, v48
    v_accvgpr_write_b32 a101, v49
    v_accvgpr_write_b32 a102, v50
    v_accvgpr_write_b32 a103, v51
    v_accvgpr_read_b32 v48, a116
    v_accvgpr_read_b32 v49, a117
    v_accvgpr_read_b32 v50, a118
    v_accvgpr_read_b32 v51, a119
    v_fma_f32 v48, v48, v57, v58
    v_fma_f32 v49, v49, v57, v58
    v_fma_f32 v50, v50, v57, v58
    v_fma_f32 v51, v51, v57, v58
    v_accvgpr_write_b32 a116, v48
    v_accvgpr_write_b32 a117, v49
    v_accvgpr_write_b32 a118, v50
    v_accvgpr_write_b32 a119, v51
    v_accvgpr_read_b32 v48, a132
    v_accvgpr_read_b32 v49, a133
    v_accvgpr_read_b32 v50, a134
    v_accvgpr_read_b32 v51, a135
    v_fma_f32 v48, v48, v57, v58
    v_fma_f32 v49, v49, v57, v58
    v_fma_f32 v50, v50, v57, v58
    v_fma_f32 v51, v51, v57, v58
    v_accvgpr_write_b32 a132, v48
    v_accvgpr_write_b32 a133, v49
    v_accvgpr_write_b32 a134, v50
    v_accvgpr_write_b32 a135, v51
    v_accvgpr_read_b32 v48, a148
    v_accvgpr_read_b32 v49, a149
    v_accvgpr_read_b32 v50, a150
    v_accvgpr_read_b32 v51, a151
    v_fma_f32 v48, v48, v57, v58
    v_fma_f32 v49, v49, v57, v58
    v_fma_f32 v50, v50, v57, v58
    v_fma_f32 v51, v51, v57, v58
    v_accvgpr_write_b32 a148, v48
    v_accvgpr_write_b32 a149, v49
    v_accvgpr_write_b32 a150, v50
    v_accvgpr_write_b32 a151, v51
    v_accvgpr_read_b32 v48, a164
    v_accvgpr_read_b32 v49, a165
    v_accvgpr_read_b32 v50, a166
    v_accvgpr_read_b32 v51, a167
    v_fma_f32 v48, v48, v57, v58
    v_fma_f32 v49, v49, v57, v58
    v_fma_f32 v50, v50, v57, v58
    v_fma_f32 v51, v51, v57, v58
    v_accvgpr_write_b32 a164, v48
    v_accvgpr_write_b32 a165, v49
    v_accvgpr_write_b32 a166, v50
    v_accvgpr_write_b32 a167, v51
    v_accvgpr_read_b32 v48, a180
    v_accvgpr_read_b32 v49, a181
    v_accvgpr_read_b32 v50, a182
    v_accvgpr_read_b32 v51, a183
    v_fma_f32 v48, v48, v57, v58
    v_fma_f32 v49, v49, v57, v58
    v_fma_f32 v50, v50, v57, v58
    v_fma_f32 v51, v51, v57, v58
    v_accvgpr_write_b32 a180, v48
    v_accvgpr_write_b32 a181, v49
    v_accvgpr_write_b32 a182, v50
    v_accvgpr_write_b32 a183, v51
    v_exp_f32 v48, v140
    v_exp_f32 v49, v141
    v_exp_f32 v50, v142
    v_exp_f32 v51, v143
    v_exp_f32 v52, v172
    v_exp_f32 v53, v173
    v_exp_f32 v54, v174
    v_exp_f32 v55, v175
    s_nop 0
    v_cvt_pk_bf16_f32 v236, v48, v49
    v_cvt_pk_bf16_f32 v237, v50, v51
    v_cvt_pk_bf16_f32 v238, v52, v53
    v_cvt_pk_bf16_f32 v239, v54, v55
    v_add_f32 v25, v48, v49
    v_add_f32 v25, v25, v50
    v_add_f32 v25, v25, v51
    v_add_f32 v25, v25, v52
    v_add_f32 v25, v25, v53
    v_add_f32 v25, v25, v54
    v_add_f32 v25, v25, v55
    v_max3_f32 v56, v148, v149, v150
    v_max3_f32 v56, v56, v151, v180
    v_max3_f32 v56, v56, v181, v182
    v_max3_f32 v56, v56, v183, 0
    v_mov_b32 v58, v56
    s_nop 1
    v_permlane16_swap_b32 v56, v58
    s_nop 1
    v_max_f32 v56, v56, v58
    v_mov_b32 v58, v56
    s_nop 1
    v_permlane32_swap_b32 v56, v58
    s_nop 1
    v_max_f32 v56, v56, v58
    v_exp_f32 v57, -v56
    v_sub_f32 v40, v40, v56
    v_sub_f32 v41, v41, v56
    v_sub_f32 v42, v42, v56
    v_sub_f32 v43, v43, v56
    v_mul_f32 v22, v22, v57
    v_sub_f32 v58, 1.0, v57
    v_sub_f32 v148, v148, v56
    v_sub_f32 v149, v149, v56
    v_sub_f32 v150, v150, v56
    v_sub_f32 v151, v151, v56
    v_sub_f32 v180, v180, v56
    v_sub_f32 v181, v181, v56
    v_sub_f32 v182, v182, v56
    v_sub_f32 v183, v183, v56
    v_accvgpr_read_b32 v48, a8
    v_accvgpr_read_b32 v49, a9
    v_accvgpr_read_b32 v50, a10
    v_accvgpr_read_b32 v51, a11
    v_fma_f32 v48, v48, v57, v58
    v_fma_f32 v49, v49, v57, v58
    v_fma_f32 v50, v50, v57, v58
    v_fma_f32 v51, v51, v57, v58
    v_accvgpr_write_b32 a8, v48
    v_accvgpr_write_b32 a9, v49
    v_accvgpr_write_b32 a10, v50
    v_accvgpr_write_b32 a11, v51
    v_accvgpr_read_b32 v48, a24
    v_accvgpr_read_b32 v49, a25
    v_accvgpr_read_b32 v50, a26
    v_accvgpr_read_b32 v51, a27
    v_fma_f32 v48, v48, v57, v58
    v_fma_f32 v49, v49, v57, v58
    v_fma_f32 v50, v50, v57, v58
    v_fma_f32 v51, v51, v57, v58
    v_accvgpr_write_b32 a24, v48
    v_accvgpr_write_b32 a25, v49
    v_accvgpr_write_b32 a26, v50
    v_accvgpr_write_b32 a27, v51
    v_accvgpr_read_b32 v48, a40
    v_accvgpr_read_b32 v49, a41
    v_accvgpr_read_b32 v50, a42
    v_accvgpr_read_b32 v51, a43
    v_fma_f32 v48, v48, v57, v58
    v_fma_f32 v49, v49, v57, v58
    v_fma_f32 v50, v50, v57, v58
    v_fma_f32 v51, v51, v57, v58
    v_accvgpr_write_b32 a40, v48
    v_accvgpr_write_b32 a41, v49
    v_accvgpr_write_b32 a42, v50
    v_accvgpr_write_b32 a43, v51
    v_accvgpr_read_b32 v48, a56
    v_accvgpr_read_b32 v49, a57
    v_accvgpr_read_b32 v50, a58
    v_accvgpr_read_b32 v51, a59
    v_fma_f32 v48, v48, v57, v58
    v_fma_f32 v49, v49, v57, v58
    v_fma_f32 v50, v50, v57, v58
    v_fma_f32 v51, v51, v57, v58
    v_accvgpr_write_b32 a56, v48
    v_accvgpr_write_b32 a57, v49
    v_accvgpr_write_b32 a58, v50
    v_accvgpr_write_b32 a59, v51
    v_accvgpr_read_b32 v48, a72
    v_accvgpr_read_b32 v49, a73
    v_accvgpr_read_b32 v50, a74
    v_accvgpr_read_b32 v51, a75
    v_fma_f32 v48, v48, v57, v58
    v_fma_f32 v49, v49, v57, v58
    v_fma_f32 v50, v50, v57, v58
    v_fma_f32 v51, v51, v57, v58
    v_accvgpr_write_b32 a72, v48
    v_accvgpr_write_b32 a73, v49
    v_accvgpr_write_b32 a74, v50
    v_accvgpr_write_b32 a75, v51
    v_accvgpr_read_b32 v48, a88
    v_accvgpr_read_b32 v49, a89
    v_accvgpr_read_b32 v50, a90
    v_accvgpr_read_b32 v51, a91
    v_fma_f32 v48, v48, v57, v58
    v_fma_f32 v49, v49, v57, v58
    v_fma_f32 v50, v50, v57, v58
    v_fma_f32 v51, v51, v57, v58
    v_accvgpr_write_b32 a88, v48
    v_accvgpr_write_b32 a89, v49
    v_accvgpr_write_b32 a90, v50
    v_accvgpr_write_b32 a91, v51
    v_accvgpr_read_b32 v48, a104
    v_accvgpr_read_b32 v49, a105
    v_accvgpr_read_b32 v50, a106
    v_accvgpr_read_b32 v51, a107
    v_fma_f32 v48, v48, v57, v58
    v_fma_f32 v49, v49, v57, v58
    v_fma_f32 v50, v50, v57, v58
    v_fma_f32 v51, v51, v57, v58
    v_accvgpr_write_b32 a104, v48
    v_accvgpr_write_b32 a105, v49
    v_accvgpr_write_b32 a106, v50
    v_accvgpr_write_b32 a107, v51
    v_accvgpr_read_b32 v48, a120
    v_accvgpr_read_b32 v49, a121
    v_accvgpr_read_b32 v50, a122
    v_accvgpr_read_b32 v51, a123
    v_fma_f32 v48, v48, v57, v58
    v_fma_f32 v49, v49, v57, v58
    v_fma_f32 v50, v50, v57, v58
    v_fma_f32 v51, v51, v57, v58
    v_accvgpr_write_b32 a120, v48
    v_accvgpr_write_b32 a121, v49
    v_accvgpr_write_b32 a122, v50
    v_accvgpr_write_b32 a123, v51
    v_accvgpr_read_b32 v48, a136
    v_accvgpr_read_b32 v49, a137
    v_accvgpr_read_b32 v50, a138
    v_accvgpr_read_b32 v51, a139
    v_fma_f32 v48, v48, v57, v58
    v_fma_f32 v49, v49, v57, v58
    v_fma_f32 v50, v50, v57, v58
    v_fma_f32 v51, v51, v57, v58
    v_accvgpr_write_b32 a136, v48
    v_accvgpr_write_b32 a137, v49
    v_accvgpr_write_b32 a138, v50
    v_accvgpr_write_b32 a139, v51
    v_accvgpr_read_b32 v48, a152
    v_accvgpr_read_b32 v49, a153
    v_accvgpr_read_b32 v50, a154
    v_accvgpr_read_b32 v51, a155
    v_fma_f32 v48, v48, v57, v58
    v_fma_f32 v49, v49, v57, v58
    v_fma_f32 v50, v50, v57, v58
    v_fma_f32 v51, v51, v57, v58
    v_accvgpr_write_b32 a152, v48
    v_accvgpr_write_b32 a153, v49
    v_accvgpr_write_b32 a154, v50
    v_accvgpr_write_b32 a155, v51
    v_accvgpr_read_b32 v48, a168
    v_accvgpr_read_b32 v49, a169
    v_accvgpr_read_b32 v50, a170
    v_accvgpr_read_b32 v51, a171
    v_fma_f32 v48, v48, v57, v58
    v_fma_f32 v49, v49, v57, v58
    v_fma_f32 v50, v50, v57, v58
    v_fma_f32 v51, v51, v57, v58
    v_accvgpr_write_b32 a168, v48
    v_accvgpr_write_b32 a169, v49
    v_accvgpr_write_b32 a170, v50
    v_accvgpr_write_b32 a171, v51
    v_accvgpr_read_b32 v48, a184
    v_accvgpr_read_b32 v49, a185
    v_accvgpr_read_b32 v50, a186
    v_accvgpr_read_b32 v51, a187
    v_fma_f32 v48, v48, v57, v58
    v_fma_f32 v49, v49, v57, v58
    v_fma_f32 v50, v50, v57, v58
    v_fma_f32 v51, v51, v57, v58
    v_accvgpr_write_b32 a184, v48
    v_accvgpr_write_b32 a185, v49
    v_accvgpr_write_b32 a186, v50
    v_accvgpr_write_b32 a187, v51
    v_exp_f32 v48, v148
    v_exp_f32 v49, v149
    v_exp_f32 v50, v150
    v_exp_f32 v51, v151
    v_exp_f32 v52, v180
    v_exp_f32 v53, v181
    v_exp_f32 v54, v182
    v_exp_f32 v55, v183
    s_nop 0
    v_cvt_pk_bf16_f32 v244, v48, v49
    v_cvt_pk_bf16_f32 v245, v50, v51
    v_cvt_pk_bf16_f32 v246, v52, v53
    v_cvt_pk_bf16_f32 v247, v54, v55
    v_add_f32 v26, v48, v49
    v_add_f32 v26, v26, v50
    v_add_f32 v26, v26, v51
    v_add_f32 v26, v26, v52
    v_add_f32 v26, v26, v53
    v_add_f32 v26, v26, v54
    v_add_f32 v26, v26, v55
    v_max3_f32 v56, v156, v157, v158
    v_max3_f32 v56, v56, v159, v188
    v_max3_f32 v56, v56, v189, v190
    v_max3_f32 v56, v56, v191, 0
    v_mov_b32 v58, v56
    s_nop 1
    v_permlane16_swap_b32 v56, v58
    s_nop 1
    v_max_f32 v56, v56, v58
    v_mov_b32 v58, v56
    s_nop 1
    v_permlane32_swap_b32 v56, v58
    s_nop 1
    v_max_f32 v56, v56, v58
    v_exp_f32 v57, -v56
    v_sub_f32 v44, v44, v56
    v_sub_f32 v45, v45, v56
    v_sub_f32 v46, v46, v56
    v_sub_f32 v47, v47, v56
    v_mul_f32 v23, v23, v57
    v_sub_f32 v58, 1.0, v57
    v_sub_f32 v156, v156, v56
    v_sub_f32 v157, v157, v56
    v_sub_f32 v158, v158, v56
    v_sub_f32 v159, v159, v56
    v_sub_f32 v188, v188, v56
    v_sub_f32 v189, v189, v56
    v_sub_f32 v190, v190, v56
    v_sub_f32 v191, v191, v56
    v_accvgpr_read_b32 v48, a12
    v_accvgpr_read_b32 v49, a13
    v_accvgpr_read_b32 v50, a14
    v_accvgpr_read_b32 v51, a15
    v_fma_f32 v48, v48, v57, v58
    v_fma_f32 v49, v49, v57, v58
    v_fma_f32 v50, v50, v57, v58
    v_fma_f32 v51, v51, v57, v58
    v_accvgpr_write_b32 a12, v48
    v_accvgpr_write_b32 a13, v49
    v_accvgpr_write_b32 a14, v50
    v_accvgpr_write_b32 a15, v51
    v_accvgpr_read_b32 v48, a28
    v_accvgpr_read_b32 v49, a29
    v_accvgpr_read_b32 v50, a30
    v_accvgpr_read_b32 v51, a31
    v_fma_f32 v48, v48, v57, v58
    v_fma_f32 v49, v49, v57, v58
    v_fma_f32 v50, v50, v57, v58
    v_fma_f32 v51, v51, v57, v58
    v_accvgpr_write_b32 a28, v48
    v_accvgpr_write_b32 a29, v49
    v_accvgpr_write_b32 a30, v50
    v_accvgpr_write_b32 a31, v51
    v_accvgpr_read_b32 v48, a44
    v_accvgpr_read_b32 v49, a45
    v_accvgpr_read_b32 v50, a46
    v_accvgpr_read_b32 v51, a47
    v_fma_f32 v48, v48, v57, v58
    v_fma_f32 v49, v49, v57, v58
    v_fma_f32 v50, v50, v57, v58
    v_fma_f32 v51, v51, v57, v58
    v_accvgpr_write_b32 a44, v48
    v_accvgpr_write_b32 a45, v49
    v_accvgpr_write_b32 a46, v50
    v_accvgpr_write_b32 a47, v51
    v_accvgpr_read_b32 v48, a60
    v_accvgpr_read_b32 v49, a61
    v_accvgpr_read_b32 v50, a62
    v_accvgpr_read_b32 v51, a63
    v_fma_f32 v48, v48, v57, v58
    v_fma_f32 v49, v49, v57, v58
    v_fma_f32 v50, v50, v57, v58
    v_fma_f32 v51, v51, v57, v58
    v_accvgpr_write_b32 a60, v48
    v_accvgpr_write_b32 a61, v49
    v_accvgpr_write_b32 a62, v50
    v_accvgpr_write_b32 a63, v51
    v_accvgpr_read_b32 v48, a76
    v_accvgpr_read_b32 v49, a77
    v_accvgpr_read_b32 v50, a78
    v_accvgpr_read_b32 v51, a79
    v_fma_f32 v48, v48, v57, v58
    v_fma_f32 v49, v49, v57, v58
    v_fma_f32 v50, v50, v57, v58
    v_fma_f32 v51, v51, v57, v58
    v_accvgpr_write_b32 a76, v48
    v_accvgpr_write_b32 a77, v49
    v_accvgpr_write_b32 a78, v50
    v_accvgpr_write_b32 a79, v51
    v_accvgpr_read_b32 v48, a92
    v_accvgpr_read_b32 v49, a93
    v_accvgpr_read_b32 v50, a94
    v_accvgpr_read_b32 v51, a95
    v_fma_f32 v48, v48, v57, v58
    v_fma_f32 v49, v49, v57, v58
    v_fma_f32 v50, v50, v57, v58
    v_fma_f32 v51, v51, v57, v58
    v_accvgpr_write_b32 a92, v48
    v_accvgpr_write_b32 a93, v49
    v_accvgpr_write_b32 a94, v50
    v_accvgpr_write_b32 a95, v51
    v_accvgpr_read_b32 v48, a108
    v_accvgpr_read_b32 v49, a109
    v_accvgpr_read_b32 v50, a110
    v_accvgpr_read_b32 v51, a111
    v_fma_f32 v48, v48, v57, v58
    v_fma_f32 v49, v49, v57, v58
    v_fma_f32 v50, v50, v57, v58
    v_fma_f32 v51, v51, v57, v58
    v_accvgpr_write_b32 a108, v48
    v_accvgpr_write_b32 a109, v49
    v_accvgpr_write_b32 a110, v50
    v_accvgpr_write_b32 a111, v51
    v_accvgpr_read_b32 v48, a124
    v_accvgpr_read_b32 v49, a125
    v_accvgpr_read_b32 v50, a126
    v_accvgpr_read_b32 v51, a127
    v_fma_f32 v48, v48, v57, v58
    v_fma_f32 v49, v49, v57, v58
    v_fma_f32 v50, v50, v57, v58
    v_fma_f32 v51, v51, v57, v58
    v_accvgpr_write_b32 a124, v48
    v_accvgpr_write_b32 a125, v49
    v_accvgpr_write_b32 a126, v50
    v_accvgpr_write_b32 a127, v51
    v_accvgpr_read_b32 v48, a140
    v_accvgpr_read_b32 v49, a141
    v_accvgpr_read_b32 v50, a142
    v_accvgpr_read_b32 v51, a143
    v_fma_f32 v48, v48, v57, v58
    v_fma_f32 v49, v49, v57, v58
    v_fma_f32 v50, v50, v57, v58
    v_fma_f32 v51, v51, v57, v58
    v_accvgpr_write_b32 a140, v48
    v_accvgpr_write_b32 a141, v49
    v_accvgpr_write_b32 a142, v50
    v_accvgpr_write_b32 a143, v51
    v_accvgpr_read_b32 v48, a156
    v_accvgpr_read_b32 v49, a157
    v_accvgpr_read_b32 v50, a158
    v_accvgpr_read_b32 v51, a159
    v_fma_f32 v48, v48, v57, v58
    v_fma_f32 v49, v49, v57, v58
    v_fma_f32 v50, v50, v57, v58
    v_fma_f32 v51, v51, v57, v58
    v_accvgpr_write_b32 a156, v48
    v_accvgpr_write_b32 a157, v49
    v_accvgpr_write_b32 a158, v50
    v_accvgpr_write_b32 a159, v51
    v_accvgpr_read_b32 v48, a172
    v_accvgpr_read_b32 v49, a173
    v_accvgpr_read_b32 v50, a174
    v_accvgpr_read_b32 v51, a175
    v_fma_f32 v48, v48, v57, v58
    v_fma_f32 v49, v49, v57, v58
    v_fma_f32 v50, v50, v57, v58
    v_fma_f32 v51, v51, v57, v58
    v_accvgpr_write_b32 a172, v48
    v_accvgpr_write_b32 a173, v49
    v_accvgpr_write_b32 a174, v50
    v_accvgpr_write_b32 a175, v51
    v_accvgpr_read_b32 v48, a188
    v_accvgpr_read_b32 v49, a189
    v_accvgpr_read_b32 v50, a190
    v_accvgpr_read_b32 v51, a191
    v_fma_f32 v48, v48, v57, v58
    v_fma_f32 v49, v49, v57, v58
    v_fma_f32 v50, v50, v57, v58
    v_fma_f32 v51, v51, v57, v58
    v_accvgpr_write_b32 a188, v48
    v_accvgpr_write_b32 a189, v49
    v_accvgpr_write_b32 a190, v50
    v_accvgpr_write_b32 a191, v51
    v_exp_f32 v48, v156
    v_exp_f32 v49, v157
    v_exp_f32 v50, v158
    v_exp_f32 v51, v159
    v_exp_f32 v52, v188
    v_exp_f32 v53, v189
    v_exp_f32 v54, v190
    v_exp_f32 v55, v191
    s_nop 0
    v_cvt_pk_bf16_f32 v252, v48, v49
    v_cvt_pk_bf16_f32 v253, v50, v51
    v_cvt_pk_bf16_f32 v254, v52, v53
    v_cvt_pk_bf16_f32 v255, v54, v55
    v_add_f32 v27, v48, v49
    v_add_f32 v27, v27, v50
    v_add_f32 v27, v27, v51
    v_add_f32 v27, v27, v52
    v_add_f32 v27, v27, v53
    v_add_f32 v27, v27, v54
    v_add_f32 v27, v27, v55
    s_nop 1
    s_branch rare_e_ret
.section .rodata,"a"
.p2align 6
.amdhsa_kernel recurrent_scan__sliding_block_cached__moe_arch_mod__prompt_kernel
  .amdhsa_next_free_vgpr 512
  .amdhsa_next_free_sgpr 102
  .amdhsa_accum_offset 256
  .amdhsa_group_segment_fixed_size 0
  .amdhsa_kernarg_size 104
  .amdhsa_user_sgpr_count 2
  .amdhsa_user_sgpr_kernarg_segment_ptr 1
  .amdhsa_system_sgpr_workgroup_id_x 1
  .amdhsa_float_denorm_mode_32 3
.end_amdhsa_kernel
```

```asm
; @launch grid=(256,1,1) block=(256,1,1) lds=163840
.amdgcn_target "amdgcn-amd-amdhsa--gfx950"
.text
.globl recurrent_scan__sliding_block_cached__moe_arch_mod__prompt_kernel
.p2align 8
.type recurrent_scan__sliding_block_cached__moe_arch_mod__prompt_kernel,@function
recurrent_scan__sliding_block_cached__moe_arch_mod__prompt_kernel:
    s_cmp_ge_u32 s2, 256
    s_cbranch_scc1 main_end
    s_load_dwordx16 s[64:79], s[0:1], 0
    s_load_dwordx4 s[80:83], s[0:1], 64
    s_load_dwordx2 s[84:85], s[0:1], 80
    s_load_dwordx2 s[86:87], s[0:1], 96
    s_bfe_u32 s30, s2, 0x20003
    s_lshl_b32 s30, s30, 3
    s_lshr_b32 s30, 0x18183060, s30
    s_and_b32 s30, s30, 0xff
    s_load_dwordx2 s[28:29], s[0:1], s30
    s_bfe_u32 s30, s2, 0x10003
    s_bfe_u32 s31, s2, 0x10005
    s_lshl1_add_u32 s30, s30, s31
    s_lshl_b32 s30, s30, 21
    s_bitcmp1_b32 s2, 3
    s_cselect_b32 s31, 0, 0x300000
    s_bitcmp1_b32 s2, 4
    s_cselect_b32 s30, s30, s31
    s_lshr_b32 s56, s2, 3
    s_lshl_b32 s56, s56, 11
    v_lshrrev_b32 v17, 4, v0
    v_lshlrev_b32 v17, 7, v17
    v_add_u32 v17, s56, v17
    s_getpc_b64 s[88:89]
    global_load_dword a220, v17, s[88:89]
    v_lshrrev_b32 v17, 6, v0
    v_lshlrev_b32 v17, 12, v17
    v_and_b32 v1, 63, v0
    v_lshl_add_u32 v17, v1, 4, v17
    v_and_b32 v1, 63, v0
    v_lshrrev_b32 v29, 6, v0
    v_mov_b32 v16, v0
    v_readfirstlane_b32 s3, v29
    s_and_b32 s53, s2, 7
    s_lshr_b32 s52, s2, 5
    s_bfe_u32 s51, s2, 0x20003
    s_lshl_b32 s50, s53, 2
    s_add_u32 s50, s50, s51
    s_lshr_b32 s60, s2, 3
    s_and_b32 s60, s60, 7
    s_xor_b32 s60, s60, s2
    s_lshl_b32 s60, s60, 3
    s_lshl_b32 s56, s3, 1
    s_add_u32 s60, s60, s56
    v_bfe_u32 v240, v1, 2, 1
    v_add_u32 v240, s60, v240
    v_lshrrev_b32 v241, 3, v1
    v_lshlrev_b32 v241, 6, v241
    v_and_b32 v29, 3, v1
    v_lshl_add_u32 v241, v29, 4, v241
    v_mul_u32_u24 v242, 1280, v240
    v_add_u32 v242, v242, v241
    v_lshrrev_b32 v29, 4, v1
    v_lshlrev_b32 v29, 1, v29
    v_and_b32 v7, 7, v1
    v_xor_b32 v7, v7, v29
    v_lshlrev_b32 v7, 4, v7
    v_lshrrev_b32 v29, 5, v1
    v_lshlrev_b32 v29, 3, v29
    v_bfe_u32 v5, v1, 3, 2
    v_add_u32 v5, v5, v29
    v_mul_u32_u24 v2, 12288, v5
    v_add_u32 v2, v2, v7
    v_add_u32 v3, 196608, v2
    s_lshl_b32 s54, s52, 2
    s_add_u32 s54, s54, s3
    s_mul_i32 s49, s3, 6144
    s_lshr_b32 s59, s3, 1
    s_lshl_b32 s59, s59, 5
    s_and_b32 s56, s3, 1
    s_lshl_b32 s56, s56, 2
    s_add_u32 s59, s59, s56
    s_mul_i32 s36, s59, 12288
    s_mov_b32 s37, 786432
    s_add_u32 s45, s51, s52
    s_and_b32 s45, s45, 3
    s_lshl_b32 s45, s45, 2
    s_lshr_b32 s45, 0x5050, s45
    s_and_b32 s45, s45, 15
    s_mul_i32 s56, s45, 786432
    s_add_u32 s36, s36, s56
    s_lshl_b32 s45, s45, 13
    s_lshr_b32 s56, s2, 3
    s_lshl_b32 s56, s56, 8
    v_add_u32 v22, s56, v16
    s_mov_b32 s56, 357913942
    v_mul_hi_u32 v23, s56, v22
    v_mul_u32_u24 v24, 12, v23
    v_sub_u32 v24, v22, v24
    v_mul_u32_u24 v23, 12288, v23
    v_lshl_add_u32 v23, v24, 7, v23
    s_mul_i32 s40, s51, 384
    s_sub_u32 s40, 1572864, s40
    v_lshlrev_b32 v24, 7, v1
    s_mul_i32 s47, s50, 786432
    s_add_u32 s47, s47, 589824
    s_lshl_b32 s48, s52, 13
    s_mul_i32 s56, s50, 384
    s_sub_u32 s57, 7864320, s56
    s_waitcnt lgkmcnt(0)
k_in:
    s_load_dword s4, s[28:29], s30 offset:1024
    s_mov_b32 s12, s64
    s_and_b32 s13, s65, 0xffff
    s_mov_b32 s14, 2621440
    s_mov_b32 s15, 0x00020000
    s_mov_b32 s16, s76
    s_and_b32 s17, s77, 0xffff
    s_mov_b32 s18, 1280
    s_mov_b32 s19, 0x00020000
    buffer_load_dwordx4 v[64:67], v242, s[12:15], 0 offen
    buffer_load_dwordx4 v[68:71], v242, s[12:15], 0 offen offset:512
    buffer_load_dwordx4 v[72:75], v242, s[12:15], 0 offen offset:1024
    v_mov_b32 v25, 3203072
    global_load_dword v26, v25, s[86:87] sc1
    s_lshr_b32 s44, s2, 3
    s_lshl_b32 s44, s44, 7
    s_add_u32 s44, s44, 4784128
    s_load_dword s92, s[86:87], s44 glc
    s_lshr_b32 s58, s2, 4
    s_lshl_b32 s58, s58, 14
    s_and_b32 s44, s2, 15
    s_lshl_b32 s44, s44, 2
    s_add_u32 s44, s44, s3
    s_lshl_b32 s44, s44, 7
    s_add_u32 s58, s58, s44
    s_add_u32 s58, s58, 4456448
    v_and_b32 v27, 31, v1
    v_lshlrev_b32 v27, 2, v27
    v_lshrrev_b32 v25, 5, v1
    v_lshl_add_u32 v27, v25, 13, v27
    v_add_u32 v27, s58, v27
    v_mov_b32 v25, 0
    global_store_dword v27, v25, s[86:87] sc1
    buffer_load_dwordx4 v[76:79], v241, s[16:19], 0 offen offset:0
    buffer_load_dwordx4 v[80:83], v241, s[16:19], 0 offen offset:512
    buffer_load_dwordx4 v[84:87], v241, s[16:19], 0 offen offset:1024
    s_add_u32 s8, s70, s56
    s_addc_u32 s9, s71, 0
    s_and_b32 s9, s9, 0xffff
    s_mov_b32 s10, s57
    s_mov_b32 s11, 0x00020000
    s_add_u32 m0, s49, 49152
    s_nop 0
    buffer_load_dwordx4 v2, s[8:11], s36 offen offset:0 lds
    s_add_u32 m0, s49, 50048
    s_nop 0
    buffer_load_dwordx4 v2, s[8:11], s36 offen offset:128 lds
    s_add_u32 m0, s49, 50944
    s_nop 0
    buffer_load_dwordx4 v2, s[8:11], s36 offen offset:256 lds
    s_add_u32 m0, s49, 52224
    s_nop 0
    buffer_load_dwordx4 v3, s[8:11], s36 offen offset:0 lds
    s_add_u32 m0, s49, 53120
    s_nop 0
    buffer_load_dwordx4 v3, s[8:11], s36 offen offset:128 lds
    s_add_u32 m0, s49, 54016
    s_nop 0
    buffer_load_dwordx4 v3, s[8:11], s36 offen offset:256 lds
    s_add_u32 s36, s36, s37
    s_sub_u32 s55, s36, 7864320
    s_min_u32 s36, s36, s55
    s_mov_b32 s24, s86
    s_and_b32 s25, s87, 0xffff
    s_mov_b32 s26, 268435456
    s_mov_b32 s27, 0x00020000
    s_lshl_b32 s56, s2, 2
    s_add_u32 s56, s56, s3
    s_cmp_lt_u32 s56, 20
    s_cselect_b32 s57, 0, 0x70000000
    s_add_u32 s57, s57, 3670016
    s_lshl_b32 s56, s56, 10
    s_add_u32 s56, s56, s57
    v_mov_b32 v160, 0
    v_mov_b32 v161, 0
    v_mov_b32 v162, 0
    v_mov_b32 v163, 0
    v_lshlrev_b32 v164, 4, v1
    buffer_store_dwordx4 v[160:163], v164, s[24:27], s56 offen sc1
    v_lshrrev_b32 v243, 6, v240
    v_mul_u32_u24 v243, 81920, v243
    v_bfe_u32 v29, v240, 4, 2
    v_lshl_add_u32 v243, v29, 10, v243
    v_and_b32 v29, 15, v240
    v_lshl_add_u32 v243, v29, 6, v243
    v_lshrrev_b32 v29, 3, v1
    v_lshl_add_u32 v243, v29, 12, v243
    v_and_b32 v29, 3, v1
    v_lshl_add_u32 v243, v29, 4, v243
    s_mov_b32 s38, 0x3acccccd
    s_mov_b32 s39, 0x3727c5ac
    s_mov_b32 s41, 0
    s_mov_b32 s42, 32768
    s_mov_b32 s43, 65536
    v_bfe_u32 v29, v1, 2, 3
    v_lshlrev_b32 v12, 7, v29
    v_lshrrev_b32 v29, 1, v29
    v_xor_b32 v29, 0, v29
    v_lshl_add_u32 v12, v29, 5, v12
    v_and_b32 v29, 3, v1
    v_lshl_add_u32 v12, v29, 3, v12
    v_lshrrev_b32 v29, 5, v1
    v_mul_u32_u24 v29, 3072, v29
    v_add_u32 v12, v12, v29
    v_xor_b32 v13, 32, v12
    v_xor_b32 v14, 64, v12
    v_xor_b32 v15, 96, v12
    v_add_u32 v8, 49152, v12
    v_add_u32 v9, 49152, v13
    v_add_u32 v10, 49152, v14
    v_add_u32 v11, 49152, v15
    v_and_b32 v28, 15, v1
    v_lshlrev_b32 v28, 6, v28
    v_lshrrev_b32 v29, 4, v1
    v_lshl_add_u32 v28, v29, 4, v28
    s_mul_i32 s56, s54, 81920
    s_add_u32 s56, s56, 0
    s_add_u32 s20, s86, s56
    s_addc_u32 s21, s87, 0
    s_and_b32 s21, s21, 0xffff
    s_mov_b32 s22, 81920
    s_mov_b32 s23, 0x00020000
    s_lshl_b32 s46, s54, 7
    s_add_u32 s46, s46, 4784128
    s_mov_b32 s101, 0
    s_lshl_b32 s56, s53, 12
    s_add_u32 s46, s46, s56
    s_load_dword s47, s[86:87], s46 glc
    s_lshr_b32 s6, s2, 3
    s_lshl_b32 s6, s6, 7
    s_lshl_b32 s56, s53, 2
    s_add_u32 s6, s6, s56
    s_add_u32 s6, s6, 4784128
    s_cmp_eq_u32 s3, 0
    s_cselect_b32 s6, s6, 0x70000000
    v_lshlrev_b32 v20, 12, v1
    s_mov_b64 exec, 0
pg_ret:
    s_mov_b64 exec, -1
    s_waitcnt vmcnt(12)
x_in:
    v_lshlrev_b32 v96, 16, v64
    v_and_b32 v97, 0xffff0000, v64
    v_lshlrev_b32 v98, 16, v65
    v_and_b32 v99, 0xffff0000, v65
    v_lshlrev_b32 v100, 16, v66
    v_and_b32 v101, 0xffff0000, v66
    v_lshlrev_b32 v102, 16, v67
    v_and_b32 v103, 0xffff0000, v67
    v_lshlrev_b32 v104, 16, v68
    v_and_b32 v105, 0xffff0000, v68
    v_lshlrev_b32 v106, 16, v69
    v_and_b32 v107, 0xffff0000, v69
    v_lshlrev_b32 v108, 16, v70
    v_and_b32 v109, 0xffff0000, v70
    v_lshlrev_b32 v110, 16, v71
    v_and_b32 v111, 0xffff0000, v71
    v_lshlrev_b32 v112, 16, v72
    v_and_b32 v113, 0xffff0000, v72
    v_lshlrev_b32 v114, 16, v73
    v_and_b32 v115, 0xffff0000, v73
    v_lshlrev_b32 v116, 16, v74
    v_and_b32 v117, 0xffff0000, v74
    v_lshlrev_b32 v118, 16, v75
    v_and_b32 v119, 0xffff0000, v75
    v_pk_add_f32 v[120:121], v[96:97], v[98:99]
    v_pk_add_f32 v[122:123], v[100:101], v[102:103]
    v_pk_add_f32 v[120:121], v[120:121], v[104:105]
    v_pk_add_f32 v[122:123], v[122:123], v[106:107]
    v_pk_add_f32 v[120:121], v[120:121], v[108:109]
    v_pk_add_f32 v[122:123], v[122:123], v[110:111]
    s_mov_b32 exec_hi, 0
    v_pk_add_f32 v[120:121], v[120:121], v[112:113]
    v_pk_add_f32 v[122:123], v[122:123], v[114:115]
    v_pk_add_f32 v[120:121], v[120:121], v[116:117]
    v_pk_add_f32 v[122:123], v[122:123], v[118:119]
    s_mov_b64 exec, -1
    v_pk_add_f32 v[120:121], v[120:121], v[122:123]
    v_add_f32 v120, v120, v121
    s_nop 1
    v_add_f32_dpp v120, v120, v120 quad_perm:[1,0,3,2] row_mask:0xf bank_mask:0xf
    s_nop 1
    v_add_f32_dpp v120, v120, v120 quad_perm:[2,3,0,1] row_mask:0xf bank_mask:0xf
    s_nop 1
    v_add_f32_dpp v120, v120, v120 row_ror:8 row_mask:0xf bank_mask:0xf
    v_mov_b32 v124, v120
    s_nop 1
    v_permlane16_swap_b32 v120, v124
    s_nop 1
    v_add_f32 v120, v120, v124
    v_mov_b32 v124, v120
    s_nop 1
    v_permlane32_swap_b32 v120, v124
    s_nop 1
    v_add_f32 v120, v120, v124
    v_mul_f32 v126, s38, v120
    v_mul_f32 v128, s38, -v120
    v_mul_f32 v129, s38, -v120
    v_pk_add_f32 v[132:133], v[96:97], v[128:129]
    v_pk_mul_f32 v[120:121], v[132:133], v[132:133]
    v_pk_add_f32 v[134:135], v[98:99], v[128:129]
    v_pk_mul_f32 v[122:123], v[134:135], v[134:135]
    v_pk_add_f32 v[136:137], v[100:101], v[128:129]
    v_pk_fma_f32 v[120:121], v[136:137], v[136:137], v[120:121]
    v_pk_add_f32 v[138:139], v[102:103], v[128:129]
    v_pk_fma_f32 v[122:123], v[138:139], v[138:139], v[122:123]
    v_pk_add_f32 v[132:133], v[104:105], v[128:129]
    v_pk_fma_f32 v[120:121], v[132:133], v[132:133], v[120:121]
    v_pk_add_f32 v[134:135], v[106:107], v[128:129]
    v_pk_fma_f32 v[122:123], v[134:135], v[134:135], v[122:123]
    v_pk_add_f32 v[136:137], v[108:109], v[128:129]
    v_pk_fma_f32 v[120:121], v[136:137], v[136:137], v[120:121]
    v_pk_add_f32 v[138:139], v[110:111], v[128:129]
    v_pk_fma_f32 v[122:123], v[138:139], v[138:139], v[122:123]
    s_mov_b32 exec_hi, 0
    v_pk_add_f32 v[132:133], v[112:113], v[128:129]
    v_pk_fma_f32 v[120:121], v[132:133], v[132:133], v[120:121]
    v_pk_add_f32 v[134:135], v[114:115], v[128:129]
    v_pk_fma_f32 v[122:123], v[134:135], v[134:135], v[122:123]
    v_pk_add_f32 v[136:137], v[116:117], v[128:129]
    v_pk_fma_f32 v[120:121], v[136:137], v[136:137], v[120:121]
    v_pk_add_f32 v[138:139], v[118:119], v[128:129]
    v_pk_fma_f32 v[122:123], v[138:139], v[138:139], v[122:123]
    s_mov_b64 exec, -1
    v_pk_add_f32 v[120:121], v[120:121], v[122:123]
    v_add_f32 v120, v120, v121
    s_nop 1
    v_add_f32_dpp v120, v120, v120 quad_perm:[1,0,3,2] row_mask:0xf bank_mask:0xf
    s_nop 1
    v_add_f32_dpp v120, v120, v120 quad_perm:[2,3,0,1] row_mask:0xf bank_mask:0xf
    s_nop 1
    v_add_f32_dpp v120, v120, v120 row_ror:8 row_mask:0xf bank_mask:0xf
    v_mov_b32 v124, v120
    s_nop 1
    v_permlane16_swap_b32 v120, v124
    s_nop 1
    v_add_f32 v120, v120, v124
    v_mov_b32 v124, v120
    s_nop 1
    v_permlane32_swap_b32 v120, v124
    s_nop 1
    v_add_f32 v120, v120, v124
    v_mul_f32 v130, s38, v120
    v_cvt_pk_bf16_f32 v126, v126, v126
    v_and_b32 v126, 0xffff0000, v126
    v_cvt_pk_bf16_f32 v130, v130, v130
    v_and_b32 v130, 0xffff0000, v130
    v_add_f32 v130, s39, v130
    v_cvt_pk_bf16_f32 v130, v130, v130
    v_and_b32 v130, 0xffff0000, v130
    v_sqrt_f32 v130, v130
    v_sub_f32 v128, 0, v126
    v_cvt_pk_bf16_f32 v130, v130, v130
    v_and_b32 v130, 0xffff0000, v130
    v_rcp_f32 v127, v130
    v_sub_f32 v129, 0, v126
    v_mul_f32 v120, 0x3dd53b95, v127
    v_mul_f32 v121, 0x3dd53b95, v127
    v_mov_b32 v130, v127
    v_mov_b32 v131, v127
    v_pk_add_f32 v[96:97], v[96:97], v[128:129]
    v_pk_mul_f32 v[132:133], v[96:97], v[120:121]
    v_cvt_pk_bf16_f32 v144, v132, v133
    v_pk_add_f32 v[98:99], v[98:99], v[128:129]
    v_pk_mul_f32 v[134:135], v[98:99], v[120:121]
    v_cvt_pk_bf16_f32 v145, v134, v135
    v_pk_add_f32 v[100:101], v[100:101], v[128:129]
    v_pk_mul_f32 v[136:137], v[100:101], v[120:121]
    v_cvt_pk_bf16_f32 v146, v136, v137
    v_pk_add_f32 v[102:103], v[102:103], v[128:129]
    v_pk_mul_f32 v[138:139], v[102:103], v[120:121]
    v_cvt_pk_bf16_f32 v147, v138, v139
    buffer_store_dwordx4 v[144:147], v243, s[24:27], s41 offen sc1
    v_pk_add_f32 v[104:105], v[104:105], v[128:129]
    v_pk_mul_f32 v[132:133], v[104:105], v[120:121]
    v_cvt_pk_bf16_f32 v148, v132, v133
    v_pk_add_f32 v[106:107], v[106:107], v[128:129]
    v_pk_mul_f32 v[134:135], v[106:107], v[120:121]
    v_cvt_pk_bf16_f32 v149, v134, v135
    v_pk_add_f32 v[108:109], v[108:109], v[128:129]
    v_pk_mul_f32 v[136:137], v[108:109], v[120:121]
    v_cvt_pk_bf16_f32 v150, v136, v137
    v_pk_add_f32 v[110:111], v[110:111], v[128:129]
    v_pk_mul_f32 v[138:139], v[110:111], v[120:121]
    v_cvt_pk_bf16_f32 v151, v138, v139
    buffer_store_dwordx4 v[148:151], v243, s[24:27], s42 offen sc1
    v_pk_add_f32 v[112:113], v[112:113], v[128:129]
    v_pk_mul_f32 v[132:133], v[112:113], v[120:121]
    v_cvt_pk_bf16_f32 v152, v132, v133
    v_pk_add_f32 v[114:115], v[114:115], v[128:129]
    v_pk_mul_f32 v[134:135], v[114:115], v[120:121]
    v_cvt_pk_bf16_f32 v153, v134, v135
    v_pk_add_f32 v[116:117], v[116:117], v[128:129]
    v_pk_mul_f32 v[136:137], v[116:117], v[120:121]
    v_cvt_pk_bf16_f32 v154, v136, v137
    v_pk_add_f32 v[118:119], v[118:119], v[128:129]
    v_pk_mul_f32 v[138:139], v[118:119], v[120:121]
    v_cvt_pk_bf16_f32 v155, v138, v139
    s_mov_b32 exec_hi, 0
    buffer_store_dwordx4 v[152:155], v243, s[24:27], s43 offen sc1
    s_mov_b64 exec, -1
    s_branch pg_start
    .p2align 12
pg_0:
    s_cbranch_execz pg_4
pg_start:
    s_waitcnt vmcnt(10)
    v_readfirstlane_b32 s7, v26
    v_cvt_pk_bf16_f32 v64, v96, v97
    v_lshlrev_b32 v96, 16, v64
    v_and_b32 v97, 0xffff0000, v64
    v_pk_mul_f32 v[96:97], v[96:97], v[130:131]
    v_cvt_pk_bf16_f32 v64, v96, v97
    v_lshlrev_b32 v96, 16, v64
    v_and_b32 v97, 0xffff0000, v64
    v_lshlrev_b32 v132, 16, v76
    v_and_b32 v133, 0xffff0000, v76
    v_pk_mul_f32 v[120:121], v[96:97], v[132:133]
    s_add_u32 m0, s49, 73728
    s_nop 0
    buffer_load_dwordx4 v2, s[8:11], s36 offen offset:0 lds
    s_add_u32 m0, s49, 74624
    s_nop 0
    buffer_load_dwordx4 v2, s[8:11], s36 offen offset:128 lds
    v_cvt_pk_bf16_f32 v65, v98, v99
    v_lshlrev_b32 v98, 16, v65
    v_and_b32 v99, 0xffff0000, v65
    v_pk_mul_f32 v[98:99], v[98:99], v[130:131]
    v_cvt_pk_bf16_f32 v65, v98, v99
    v_lshlrev_b32 v98, 16, v65
    v_and_b32 v99, 0xffff0000, v65
    v_lshlrev_b32 v134, 16, v77
    v_and_b32 v135, 0xffff0000, v77
    v_pk_mul_f32 v[122:123], v[98:99], v[134:135]
    s_add_u32 m0, s49, 75520
    s_nop 0
    buffer_load_dwordx4 v2, s[8:11], s36 offen offset:256 lds
    s_add_u32 m0, s49, 76800
    s_nop 0
    buffer_load_dwordx4 v3, s[8:11], s36 offen offset:0 lds
    v_cvt_pk_bf16_f32 v66, v100, v101
    v_lshlrev_b32 v100, 16, v66
    v_and_b32 v101, 0xffff0000, v66
    v_pk_mul_f32 v[100:101], v[100:101], v[130:131]
    v_cvt_pk_bf16_f32 v66, v100, v101
    v_lshlrev_b32 v100, 16, v66
    v_and_b32 v101, 0xffff0000, v66
    v_lshlrev_b32 v136, 16, v78
    v_and_b32 v137, 0xffff0000, v78
    v_pk_fma_f32 v[120:121], v[100:101], v[136:137], v[120:121]
    s_add_u32 m0, s49, 77696
    s_nop 0
    buffer_load_dwordx4 v3, s[8:11], s36 offen offset:128 lds
    s_add_u32 m0, s49, 78592
    s_nop 0
    buffer_load_dwordx4 v3, s[8:11], s36 offen offset:256 lds
    s_add_u32 s36, s36, s37
    s_sub_u32 s55, s36, 7864320
    s_min_u32 s36, s36, s55
    v_cvt_pk_bf16_f32 v67, v102, v103
    v_lshlrev_b32 v102, 16, v67
    v_and_b32 v103, 0xffff0000, v67
    v_pk_mul_f32 v[102:103], v[102:103], v[130:131]
    v_cvt_pk_bf16_f32 v67, v102, v103
    v_lshlrev_b32 v102, 16, v67
    v_and_b32 v103, 0xffff0000, v67
    v_lshlrev_b32 v138, 16, v79
    v_and_b32 v139, 0xffff0000, v79
    v_pk_fma_f32 v[122:123], v[102:103], v[138:139], v[122:123]
    s_add_u32 m0, s49, 98304
    s_nop 0
    buffer_load_dwordx4 v2, s[8:11], s36 offen offset:0 lds
    s_add_u32 m0, s49, 99200
    s_nop 0
    buffer_load_dwordx4 v2, s[8:11], s36 offen offset:128 lds
    v_cvt_pk_bf16_f32 v68, v104, v105
    v_lshlrev_b32 v104, 16, v68
    v_and_b32 v105, 0xffff0000, v68
    v_pk_mul_f32 v[104:105], v[104:105], v[130:131]
    v_cvt_pk_bf16_f32 v68, v104, v105
    v_lshlrev_b32 v104, 16, v68
    v_and_b32 v105, 0xffff0000, v68
    v_lshlrev_b32 v132, 16, v80
    v_and_b32 v133, 0xffff0000, v80
    v_pk_fma_f32 v[120:121], v[104:105], v[132:133], v[120:121]
    s_add_u32 m0, s49, 100096
    s_nop 0
    buffer_load_dwordx4 v2, s[8:11], s36 offen offset:256 lds
    s_add_u32 m0, s49, 101376
    s_nop 0
    buffer_load_dwordx4 v3, s[8:11], s36 offen offset:0 lds
    s_waitcnt vmcnt(10) lgkmcnt(0)
    s_lshr_b32 s7, s7, 4
    s_mul_i32 s7, s7, 0x2c9277b5
    s_add_u32 s7, s7, 0x6c564b05
    s_lshl_b32 s7, s7, 4
    s_barrier
    v_mov_b32 v21, s7
    s_mov_b64 exec, 255
    buffer_store_dword v21, v20, s[24:27], s6 offen sc1
    s_mov_b64 exec, 0x11
    v_lshlrev_b32 v29, 3, v240
    s_mov_b32 s56, 3211264
    buffer_store_dwordx2 v[126:127], v29, s[24:27], s56 offen sc1
    s_mov_b64 exec, -1
    s_mov_b32 s63, -1
    s_lshr_b32 s61, s2, 6
    s_or_b32 s61, s61, s3
    s_cbranch_scc1 race_skip
    s_waitcnt lgkmcnt(0)
    s_mov_b32 s63, -1
    s_load_dword s4, s[86:87], s58 offset:0x2000 glc
    s_load_dword s63, s[86:87], s58 glc
    s_waitcnt lgkmcnt(1)
race_skip:
    v_cvt_pk_bf16_f32 v69, v106, v107
    v_lshlrev_b32 v106, 16, v69
    v_and_b32 v107, 0xffff0000, v69
    v_pk_mul_f32 v[106:107], v[106:107], v[130:131]
    v_cvt_pk_bf16_f32 v69, v106, v107
    v_lshlrev_b32 v106, 16, v69
    v_and_b32 v107, 0xffff0000, v69
    v_lshlrev_b32 v134, 16, v81
    v_and_b32 v135, 0xffff0000, v81
    v_pk_fma_f32 v[122:123], v[106:107], v[134:135], v[122:123]
    s_and_b32 s93, s63, 0x2000
    s_getreg_b32 s61, hwreg(HW_REG_XCC_ID, 2, 1)
    s_mul_i32 s61, s61, 0x6000
    s_lshl_b32 s93, s93, 1
    s_xor_b32 s93, s93, s61
    s_add_u32 m0, s49, 102272
    s_nop 0
    buffer_load_dwordx4 v3, s[8:11], s36 offen offset:128 lds
    s_add_u32 m0, s49, 103168
    s_nop 0
    buffer_load_dwordx4 v3, s[8:11], s36 offen offset:256 lds
    s_add_u32 s36, s36, s37
    s_sub_u32 s55, s36, 7864320
    s_min_u32 s36, s36, s55
    s_mov_b64 exec, -1
    s_add_u32 m0, s49, 122880
    s_nop 0
    buffer_load_dwordx4 v2, s[8:11], s36 offen offset:0 lds
    s_add_u32 m0, s49, 123776
    s_nop 0
    buffer_load_dwordx4 v2, s[8:11], s36 offen offset:128 lds
    s_add_u32 m0, s49, 124672
    s_nop 0
    buffer_load_dwordx4 v2, s[8:11], s36 offen offset:256 lds
    s_add_u32 m0, s49, 125952
    s_nop 0
    buffer_load_dwordx4 v3, s[8:11], s36 offen offset:0 lds
    s_add_u32 m0, s49, 126848
    s_nop 0
    buffer_load_dwordx4 v3, s[8:11], s36 offen offset:128 lds
    s_add_u32 m0, s49, 127744
    s_nop 0
    buffer_load_dwordx4 v3, s[8:11], s36 offen offset:256 lds
    s_add_u32 s36, s36, s37
    s_sub_u32 s55, s36, 7864320
    s_min_u32 s36, s36, s55
    s_mov_b64 exec, 0
    s_cmp_eq_u32 s3, 0
    s_cbranch_scc1 pg_0
    s_cmp_eq_u32 s3, 1
    s_cbranch_scc1 pg_1
    s_cmp_eq_u32 s3, 2
    s_cbranch_scc1 pg_2
    s_cmp_eq_u32 s3, 3
    s_cbranch_scc1 pg_3
pg_ret2:
    s_mov_b64 exec, -1
    ds_read_b64_tr_b16 a[192:193], v8 offset:0
    ds_read_b64_tr_b16 a[194:195], v8 offset:6144
    ds_read_b64_tr_b16 a[196:197], v9 offset:0
    ds_read_b64_tr_b16 a[198:199], v9 offset:6144
    ds_read_b64_tr_b16 a[200:201], v10 offset:0
    ds_read_b64_tr_b16 a[202:203], v10 offset:6144
    ds_read_b64_tr_b16 a[204:205], v11 offset:0
    ds_read_b64_tr_b16 a[206:207], v11 offset:6144
spin_ln:
    s_load_dwordx8 s[28:35], s[86:87], s46 glc
    s_add_u32 s101, s101, 1
    s_cmp_gt_u32 s101, 0x2000000
    s_cselect_b32 s57, 0, -1
    s_waitcnt lgkmcnt(0)
    s_xor_b32 s56, s28, s7
    s_xor_b32 s29, s29, s7
    s_or_b32 s56, s56, s29
    s_xor_b32 s30, s30, s7
    s_or_b32 s56, s56, s30
    s_xor_b32 s31, s31, s7
    s_or_b32 s56, s56, s31
    s_xor_b32 s32, s32, s7
    s_or_b32 s56, s56, s32
    s_xor_b32 s33, s33, s7
    s_or_b32 s56, s56, s33
    s_xor_b32 s34, s34, s7
    s_or_b32 s56, s56, s34
    s_xor_b32 s35, s35, s7
    s_or_b32 s56, s56, s35
    s_and_b32 s56, s56, s57
    s_cbranch_scc1 spin_ln
z_skip:
    s_add_u32 s46, s45, 0
    s_sub_u32 s5, s46, 81920
    s_min_u32 s46, s46, s5
    buffer_load_dwordx4 a[0:3], v28, s[20:23], s46 offen offset:0 sc1
    buffer_load_dwordx4 a[4:7], v28, s[20:23], s46 offen offset:1024 sc1
    buffer_load_dwordx4 a[8:11], v28, s[20:23], s46 offen offset:2048 sc1
    buffer_load_dwordx4 a[12:15], v28, s[20:23], s46 offen offset:3072 sc1
    s_add_u32 s46, s45, 4096
    s_sub_u32 s5, s46, 81920
    s_min_u32 s46, s46, s5
    buffer_load_dwordx4 a[16:19], v28, s[20:23], s46 offen offset:0 sc1
    buffer_load_dwordx4 a[20:23], v28, s[20:23], s46 offen offset:1024 sc1
    buffer_load_dwordx4 a[24:27], v28, s[20:23], s46 offen offset:2048 sc1
    buffer_load_dwordx4 a[28:31], v28, s[20:23], s46 offen offset:3072 sc1
    v_cvt_pk_bf16_f32 v70, v108, v109
    v_lshlrev_b32 v108, 16, v70
    v_and_b32 v109, 0xffff0000, v70
    v_pk_mul_f32 v[108:109], v[108:109], v[130:131]
    v_cvt_pk_bf16_f32 v70, v108, v109
    v_lshlrev_b32 v108, 16, v70
    v_and_b32 v109, 0xffff0000, v70
    v_lshlrev_b32 v136, 16, v82
    v_and_b32 v137, 0xffff0000, v82
    v_pk_fma_f32 v[120:121], v[108:109], v[136:137], v[120:121]
    v_cvt_pk_bf16_f32 v71, v110, v111
    v_lshlrev_b32 v110, 16, v71
    v_and_b32 v111, 0xffff0000, v71
    v_pk_mul_f32 v[110:111], v[110:111], v[130:131]
    v_cvt_pk_bf16_f32 v71, v110, v111
    v_lshlrev_b32 v110, 16, v71
    v_and_b32 v111, 0xffff0000, v71
    v_lshlrev_b32 v138, 16, v83
    v_and_b32 v139, 0xffff0000, v83
    v_pk_fma_f32 v[122:123], v[110:111], v[138:139], v[122:123]
    s_mov_b32 exec_hi, 0
    v_cvt_pk_bf16_f32 v72, v112, v113
    v_lshlrev_b32 v112, 16, v72
    v_and_b32 v113, 0xffff0000, v72
    v_pk_mul_f32 v[112:113], v[112:113], v[130:131]
    v_cvt_pk_bf16_f32 v72, v112, v113
    v_lshlrev_b32 v112, 16, v72
    v_and_b32 v113, 0xffff0000, v72
    v_lshlrev_b32 v132, 16, v84
    v_and_b32 v133, 0xffff0000, v84
    v_pk_fma_f32 v[120:121], v[112:113], v[132:133], v[120:121]
    v_cvt_pk_bf16_f32 v73, v114, v115
    v_lshlrev_b32 v114, 16, v73
    v_and_b32 v115, 0xffff0000, v73
    v_pk_mul_f32 v[114:115], v[114:115], v[130:131]
    v_cvt_pk_bf16_f32 v73, v114, v115
    v_lshlrev_b32 v114, 16, v73
    v_and_b32 v115, 0xffff0000, v73
    v_lshlrev_b32 v134, 16, v85
    v_and_b32 v135, 0xffff0000, v85
    v_pk_fma_f32 v[122:123], v[114:115], v[134:135], v[122:123]
    v_cvt_pk_bf16_f32 v74, v116, v117
    v_lshlrev_b32 v116, 16, v74
    v_and_b32 v117, 0xffff0000, v74
    v_pk_mul_f32 v[116:117], v[116:117], v[130:131]
    v_cvt_pk_bf16_f32 v74, v116, v117
    v_lshlrev_b32 v116, 16, v74
    v_and_b32 v117, 0xffff0000, v74
    v_lshlrev_b32 v136, 16, v86
    v_and_b32 v137, 0xffff0000, v86
    v_pk_fma_f32 v[120:121], v[116:117], v[136:137], v[120:121]
    v_cvt_pk_bf16_f32 v75, v118, v119
    v_lshlrev_b32 v118, 16, v75
    v_and_b32 v119, 0xffff0000, v75
    v_pk_mul_f32 v[118:119], v[118:119], v[130:131]
    v_cvt_pk_bf16_f32 v75, v118, v119
    v_lshlrev_b32 v118, 16, v75
    v_and_b32 v119, 0xffff0000, v75
    v_lshlrev_b32 v138, 16, v87
    v_and_b32 v139, 0xffff0000, v87
    v_pk_fma_f32 v[122:123], v[118:119], v[138:139], v[122:123]
    s_mov_b64 exec, -1
    v_pk_add_f32 v[120:121], v[120:121], v[122:123]
    v_add_f32 v120, v120, v121
    s_nop 1
    v_add_f32_dpp v120, v120, v120 quad_perm:[1,0,3,2] row_mask:0xf bank_mask:0xf
    s_nop 1
    v_add_f32_dpp v120, v120, v120 quad_perm:[2,3,0,1] row_mask:0xf bank_mask:0xf
    s_nop 1
    v_add_f32_dpp v120, v120, v120 row_ror:8 row_mask:0xf bank_mask:0xf
    v_mov_b32 v124, v120
    s_nop 1
    v_permlane16_swap_b32 v120, v124
    s_nop 1
    v_add_f32 v120, v120, v124
    v_mov_b32 v124, v120
    s_nop 1
    v_permlane32_swap_b32 v120, v124
    s_nop 1
    v_add_f32 v120, v120, v124
    v_cvt_pk_bf16_f32 v120, v120, v120
    v_and_b32 v120, 0xffff0000, v120
    v_ashrrev_i32 v122, 31, v120
    v_or_b32 v122, 0x80000000, v122
    v_xor_b32 v120, v120, v122
    v_and_b32 v120, 0xffff0000, v120
    v_sub_u32 v122, 2047, v240
    v_or_b32 v120, v120, v122
    s_nop 1
    v_mov_b32_dpp v121, v120 row_ror:4 row_mask:0xf bank_mask:0xf
    v_mov_b32 v122, s7
    v_mov_b32 v123, s93
    s_lshl_b32 s56, s2, 2
    s_add_u32 s56, s56, s3
    s_lshl_b32 s56, s56, 4
    s_add_u32 s56, s56, 3162112
    v_mov_b32 v29, 0
    s_mov_b64 s[74:75], s[66:67]
    s_mul_i32 s57, s50, 786432
    s_add_u32 s57, s57, 688128
    s_cmp_eq_u32 s3, 1
    s_cselect_b64 s[74:75], s[68:69], s[74:75]
    s_cmp_eq_u32 s3, 2
    s_cselect_b64 s[74:75], s[78:79], s[74:75]
    s_cselect_b32 s57, 0, s57
    s_cmp_eq_u32 s3, 3
    s_cselect_b64 s[74:75], s[80:81], s[74:75]
    s_cselect_b32 s57, 0, s57
    s_load_dword s76, s[74:75], s57
    s_mov_b64 s[74:75], s[72:73]
    s_mul_i32 s57, s50, 245760
    s_cmp_eq_u32 s3, 1
    s_cselect_b64 s[74:75], s[82:83], s[74:75]
    s_cselect_b32 s57, 0, s57
    s_mul_i32 s77, s2, 10240
    s_cmp_eq_u32 s3, 2
    s_cselect_b64 s[74:75], s[84:85], s[74:75]
    s_cselect_b32 s57, s77, s57
    s_lshr_b32 s77, s2, 3
    s_lshl_b32 s77, s77, 22
    s_add_u32 s77, s77, 67563520
    s_cmp_eq_u32 s3, 3
    s_cselect_b64 s[74:75], s[86:87], s[74:75]
    s_cselect_b32 s57, s77, s57
    s_load_dword s76, s[74:75], s57
    s_waitcnt vmcnt(4)
    s_mov_b64 exec, 1
    s_waitcnt vmcnt(16)
    buffer_store_dwordx4 v[120:123], v29, s[24:27], s56 offen sc1
    s_mov_b64 exec, -1
head_code:
    v_mfma_f32_16x16x32_bf16 v[64:67], a[192:195], a[0:3], 0
    s_add_u32 s46, s45, 8192
    ds_read_b64_tr_b16 a[208:209], v8 offset:1024
    s_sub_u32 s77, s46, 81920
    v_mfma_f32_16x16x32_bf16 v[68:71], a[196:199], a[0:3], 0
    s_min_u32 s46, s46, s77
    ds_read_b64_tr_b16 a[210:211], v8 offset:7168
    v_mfma_f32_16x16x32_bf16 v[76:79], a[196:199], a[4:7], 0
    buffer_load_dwordx4 a[32:35], v28, s[20:23], s46 offen offset:0 sc1
    v_mfma_f32_16x16x32_bf16 v[72:75], a[192:195], a[4:7], 0
    v_mfma_f32_16x16x32_bf16 v[80:83], a[192:195], a[8:11], 0
    ds_read_b64_tr_b16 a[212:213], v9 offset:1024
    v_mfma_f32_16x16x32_bf16 v[84:87], a[196:199], a[8:11], 0
    ds_read_b64_tr_b16 a[214:215], v9 offset:7168
    v_mfma_f32_16x16x32_bf16 v[92:95], a[196:199], a[12:15], 0
    v_mfma_f32_16x16x32_bf16 v[88:91], a[192:195], a[12:15], 0
    s_waitcnt lgkmcnt(4)
    v_mfma_f32_16x16x32_bf16 v[120:123], a[200:203], a[12:15], 0
    ds_read_b64_tr_b16 a[192:193], v10 offset:1024
    v_mul_u32_u24 v56, 3072, v5
    v_mfma_f32_16x16x32_bf16 v[124:127], a[204:207], a[12:15], 0
    ds_read_b64_tr_b16 a[194:195], v10 offset:7168
    v_add_u32 v56, v56, v7
    v_mfma_f32_16x16x32_bf16 v[116:119], a[204:207], a[8:11], 0
    buffer_load_dwordx4 a[36:39], v28, s[20:23], s46 offen offset:1024 sc1
    v_mfma_f32_16x16x32_bf16 v[112:115], a[200:203], a[8:11], 0
    v_add_u32 v57, 49152, v56
    v_lshrrev_b32 v29, 3, v1
    v_mfma_f32_16x16x32_bf16 v[104:107], a[200:203], a[4:7], 0
    ds_read_b64_tr_b16 a[196:197], v11 offset:1024
    v_mul_u32_u24 v62, 1280, v29
    v_mfma_f32_16x16x32_bf16 v[108:111], a[204:207], a[4:7], 0
    ds_read_b64_tr_b16 a[198:199], v11 offset:7168
    v_add_u32 v62, v62, v7
    v_mfma_f32_16x16x32_bf16 v[100:103], a[204:207], a[0:3], 0
    v_add_u32 v63, 10240, v62
    v_mul_u32_u24 v31, 384, v29
    v_mfma_f32_16x16x32_bf16 v[96:99], a[200:203], a[0:3], 0
    s_waitcnt lgkmcnt(4)
    v_add_u32 v6, v31, v7
    v_add_u32 v7, 3072, v6
    v_mfma_f32_16x16x32_bf16 v[128:131], a[208:211], a[0:3], 0
    ds_read_b64_tr_b16 a[200:201], v8 offset:2048
    v_bfe_u32 v29, v1, 4, 1
    v_mfma_f32_16x16x32_bf16 v[132:135], a[212:215], a[0:3], 0
    ds_read_b64_tr_b16 a[202:203], v8 offset:8192
    v_bfe_u32 v30, v1, 5, 1
    v_mfma_f32_16x16x32_bf16 v[140:143], a[212:215], a[4:7], 0
    buffer_load_dwordx4 a[40:43], v28, s[20:23], s46 offen offset:2048 sc1
    v_mfma_f32_16x16x32_bf16 v[136:139], a[208:211], a[4:7], 0
    v_lshl_add_u32 v29, v29, 1, v30
    v_and_b32 v30, 7, v1
    v_mfma_f32_16x16x32_bf16 v[144:147], a[208:211], a[8:11], 0
    ds_read_b64_tr_b16 a[204:205], v9 offset:2048
    v_xor_b32 v30, v30, v29
    v_mfma_f32_16x16x32_bf16 v[148:151], a[212:215], a[8:11], 0
    ds_read_b64_tr_b16 a[206:207], v9 offset:8192
    v_lshl_add_u32 v4, v30, 4, v31
    v_mfma_f32_16x16x32_bf16 v[156:159], a[212:215], a[12:15], 0
    buffer_load_dwordx4 a[44:47], v28, s[20:23], s46 offen offset:3072 sc1
    v_mfma_f32_16x16x32_bf16 v[152:155], a[208:211], a[12:15], 0
    s_waitcnt lgkmcnt(4)
    v_xor_b32 v30, 4, v30
    v_lshl_add_u32 v5, v30, 4, v31
    v_mfma_f32_16x16x32_bf16 v[184:187], a[192:195], a[12:15], 0
    s_add_u32 s46, s45, 12288
    ds_read_b64_tr_b16 a[208:209], v10 offset:2048
    v_add_u32 v5, 3072, v5
    v_mfma_f32_16x16x32_bf16 v[188:191], a[196:199], a[12:15], 0
    s_sub_u32 s77, s46, 81920
    ds_read_b64_tr_b16 a[210:211], v10 offset:8192
    v_bfe_u32 v30, v1, 1, 1
    v_mfma_f32_16x16x32_bf16 v[180:183], a[196:199], a[8:11], 0
    s_min_u32 s46, s46, s77
    v_bfe_u32 v31, v1, 2, 1
    v_lshl_add_u32 v30, v30, 1, v31
    v_mfma_f32_16x16x32_bf16 v[176:179], a[192:195], a[8:11], 0
    v_bfe_u32 v31, v1, 3, 1
    v_lshl_add_u32 v30, v31, 2, v30
    v_mfma_f32_16x16x32_bf16 v[168:171], a[192:195], a[4:7], 0
    ds_read_b64_tr_b16 a[212:213], v11 offset:2048
    v_xor_b32 v30, v30, v29
    v_mfma_f32_16x16x32_bf16 v[172:175], a[196:199], a[4:7], 0
    ds_read_b64_tr_b16 a[214:215], v11 offset:8192
    v_lshlrev_b32 v30, 4, v30
    v_mfma_f32_16x16x32_bf16 v[164:167], a[196:199], a[0:3], 0
    buffer_load_dwordx4 a[48:51], v28, s[20:23], s46 offen offset:0 sc1
    v_mfma_f32_16x16x32_bf16 v[160:163], a[192:195], a[0:3], 0
    s_waitcnt lgkmcnt(4)
    v_mul_u32_u24 v31, 3072, v31
    v_and_b32 v29, 7, v1
    v_mfma_f32_16x16x32_bf16 v[192:195], a[200:203], a[0:3], 0
    ds_read_b64_tr_b16 a[192:193], v8 offset:12288
    v_lshl_add_u32 v31, v29, 7, v31
    v_mfma_f32_16x16x32_bf16 v[196:199], a[204:207], a[0:3], 0
    ds_read_b64_tr_b16 a[194:195], v8 offset:18432
    v_subrev_u32 v31, s49, v31
    v_mfma_f32_16x16x32_bf16 v[204:207], a[204:207], a[4:7], 0
    buffer_load_dwordx4 a[52:55], v28, s[20:23], s46 offen offset:1024 sc1
    v_mfma_f32_16x16x32_bf16 v[200:203], a[200:203], a[4:7], 0
    v_add_u32 v18, v31, v30
    v_xor_b32 v30, 64, v30
    v_mfma_f32_16x16x32_bf16 v[208:211], a[200:203], a[8:11], 0
    ds_read_b64_tr_b16 a[196:197], v9 offset:12288
    v_add_u32 v19, v31, v30
    v_mfma_f32_16x16x32_bf16 v[212:215], a[204:207], a[8:11], 0
    s_mul_i32 s56, s50, 786432
    ds_read_b64_tr_b16 a[198:199], v9 offset:18432
    s_add_u32 s56, s56, 589824
    v_mfma_f32_16x16x32_bf16 v[220:223], a[204:207], a[12:15], 0
    s_add_u32 s12, s66, s56
    s_addc_u32 s13, s67, 0
    s_and_b32 s13, s13, 0xffff
    v_mfma_f32_16x16x32_bf16 v[216:219], a[200:203], a[12:15], 0
    s_waitcnt lgkmcnt(4)
    s_mov_b32 s14, 196608
    s_mov_b32 s15, 0x00020000
    v_mfma_f32_16x16x32_bf16 v[248:251], a[208:211], a[12:15], 0
    s_add_u32 s16, s68, s56
    s_addc_u32 s17, s69, 0
    ds_read_b64_tr_b16 a[200:201], v10 offset:12288
    v_mfma_f32_16x16x32_bf16 v[252:255], a[212:215], a[12:15], 0
    s_and_b32 s17, s17, 0xffff
    ds_read_b64_tr_b16 a[202:203], v10 offset:18432
    s_mov_b32 s18, 196608
    v_mfma_f32_16x16x32_bf16 v[244:247], a[212:215], a[8:11], 0
    buffer_load_dwordx4 a[56:59], v28, s[20:23], s46 offen offset:2048 sc1
    v_mfma_f32_16x16x32_bf16 v[240:243], a[208:211], a[8:11], 0
    s_mov_b32 s19, 0x00020000
    s_mov_b32 s28, s78
    s_and_b32 s29, s79, 0xffff
    v_mfma_f32_16x16x32_bf16 v[232:235], a[208:211], a[4:7], 0
    s_mov_b32 s30, 1966080
    ds_read_b64_tr_b16 a[204:205], v11 offset:12288
    s_mov_b32 s31, 0x00020000
    v_mfma_f32_16x16x32_bf16 v[236:239], a[212:215], a[4:7], 0
    s_waitcnt vmcnt(8)
    ds_read_b64_tr_b16 a[206:207], v11 offset:18432
    s_mov_b32 s32, s80
    v_mfma_f32_16x16x32_bf16 v[228:231], a[212:215], a[0:3], 0
    s_and_b32 s33, s81, 0xffff
    s_mov_b32 s34, 1966080
    s_mov_b32 s35, 0x00020000
    v_mfma_f32_16x16x32_bf16 v[224:227], a[208:211], a[0:3], 0
    s_waitcnt lgkmcnt(4)
    s_mov_b32 s5, s58
    s_min_u32 s58, s2, 239
    v_mfma_f32_16x16x32_bf16 v[64:67], a[192:195], a[16:19], v[64:67]
    s_mul_hi_u32 s56, s58, 178956971
    ds_read_b64_tr_b16 a[208:209], v8 offset:13312
    s_mul_i32 s57, s56, 24
    v_mfma_f32_16x16x32_bf16 v[68:71], a[196:199], a[16:19], v[68:71]
    s_sub_u32 s57, s58, s57
    ds_read_b64_tr_b16 a[210:211], v8 offset:19456
    s_lshl_b32 s60, s56, 6
    v_mfma_f32_16x16x32_bf16 v[76:79], a[196:199], a[20:23], v[76:79]
    buffer_load_dwordx4 a[60:63], v28, s[20:23], s46 offen offset:3072 sc1
    v_mfma_f32_16x16x32_bf16 v[72:75], a[192:195], a[20:23], v[72:75]
    s_add_u32 s46, s45, 16384
    s_sub_u32 s77, s46, 81920
    s_min_u32 s46, s46, s77
    v_mfma_f32_16x16x32_bf16 v[80:83], a[192:195], a[24:27], v[80:83]
    s_add_u32 s60, s60, s59
    ds_read_b64_tr_b16 a[212:213], v9 offset:13312
    s_mul_i32 s60, s60, 3072
    v_mfma_f32_16x16x32_bf16 v[84:87], a[196:199], a[24:27], v[84:87]
    s_lshl_b32 s44, s57, 7
    ds_read_b64_tr_b16 a[214:215], v9 offset:19456
    s_add_u32 s60, s60, s44
    v_mfma_f32_16x16x32_bf16 v[92:95], a[196:199], a[28:31], v[92:95]
    buffer_load_dwordx4 a[64:67], v28, s[20:23], s46 offen offset:0 sc1
    v_mfma_f32_16x16x32_bf16 v[88:91], a[192:195], a[28:31], v[88:91]
    s_waitcnt lgkmcnt(4)
    s_lshl_b32 s61, s56, 7
    s_mul_i32 s62, s56, 1536
    v_mfma_f32_16x16x32_bf16 v[120:123], a[200:203], a[28:31], v[120:123]
    s_lshl_b32 s44, s57, 6
    ds_read_b64_tr_b16 a[192:193], v10 offset:13312
    s_add_u32 s62, s62, s44
    v_mfma_f32_16x16x32_bf16 v[124:127], a[204:207], a[28:31], v[124:127]
    s_lshl_b32 s44, s3, 4
    ds_read_b64_tr_b16 a[194:195], v10 offset:19456
    s_add_u32 s62, s62, s44
    v_mfma_f32_16x16x32_bf16 v[116:119], a[204:207], a[24:27], v[116:119]
    s_lshl_b32 s62, s62, 4
    s_add_u32 s62, s62, 3276800
    s_lshl_b32 s4, s2, 8
    v_mfma_f32_16x16x32_bf16 v[112:115], a[200:203], a[24:27], v[112:115]
    s_lshl_b32 s44, s3, 2
    s_add_u32 s4, s4, s44
    s_add_u32 s4, s4, 4718592
    v_mfma_f32_16x16x32_bf16 v[104:107], a[200:203], a[20:23], v[104:107]
    s_mov_b32 s92, 0xbfb8aa3b
    ds_read_b64_tr_b16 a[196:197], v11 offset:13312
    s_lshl_b32 s44, s3, 12
    v_mfma_f32_16x16x32_bf16 v[108:111], a[204:207], a[20:23], v[108:111]
    s_mov_b32 s38, s49
    ds_read_b64_tr_b16 a[198:199], v11 offset:19456
    s_mov_b32 s40, s49
    v_mfma_f32_16x16x32_bf16 v[100:103], a[204:207], a[16:19], v[100:103]
    buffer_load_dwordx4 a[68:71], v28, s[20:23], s46 offen offset:1024 sc1
    v_mfma_f32_16x16x32_bf16 v[96:99], a[200:203], a[16:19], v[96:99]
    s_waitcnt lgkmcnt(4)
    s_mov_b32 s39, 24576
    s_mov_b32 s47, 3162112
    v_mfma_f32_16x16x32_bf16 v[128:131], a[208:211], a[16:19], v[128:131]
    s_mov_b32 s88, 0xaaaaaaaa
    ds_read_b64_tr_b16 a[200:201], v8 offset:14336
    s_mov_b32 s89, 0xaaaaaaaa
    v_mfma_f32_16x16x32_bf16 v[132:135], a[212:215], a[16:19], v[132:135]
    ds_read_b64_tr_b16 a[202:203], v8 offset:20480
    v_mfma_f32_16x16x32_bf16 v[140:143], a[212:215], a[20:23], v[140:143]
    v_add_u32 v8, 73728, v12
    v_mfma_f32_16x16x32_bf16 v[136:139], a[208:211], a[20:23], v[136:139]
    buffer_load_dwordx4 a[72:75], v28, s[20:23], s46 offen offset:2048 sc1
    v_mfma_f32_16x16x32_bf16 v[144:147], a[208:211], a[24:27], v[144:147]
    ds_read_b64_tr_b16 a[204:205], v9 offset:14336
    v_mfma_f32_16x16x32_bf16 v[148:151], a[212:215], a[24:27], v[148:151]
    ds_read_b64_tr_b16 a[206:207], v9 offset:20480
    v_mfma_f32_16x16x32_bf16 v[156:159], a[212:215], a[28:31], v[156:159]
    v_add_u32 v9, 73728, v13
    v_mfma_f32_16x16x32_bf16 v[152:155], a[208:211], a[28:31], v[152:155]
    s_waitcnt lgkmcnt(4)
    v_mfma_f32_16x16x32_bf16 v[184:187], a[192:195], a[28:31], v[184:187]
    ds_read_b64_tr_b16 a[208:209], v10 offset:14336
    v_mfma_f32_16x16x32_bf16 v[188:191], a[196:199], a[28:31], v[188:191]
    ds_read_b64_tr_b16 a[210:211], v10 offset:20480
    v_mfma_f32_16x16x32_bf16 v[180:183], a[196:199], a[24:27], v[180:183]
    buffer_load_dwordx4 a[76:79], v28, s[20:23], s46 offen offset:3072 sc1
    v_mfma_f32_16x16x32_bf16 v[176:179], a[192:195], a[24:27], v[176:179]
    v_add_u32 v10, 73728, v14
    v_mfma_f32_16x16x32_bf16 v[168:171], a[192:195], a[20:23], v[168:171]
    s_add_u32 s46, s45, 20480
    ds_read_b64_tr_b16 a[212:213], v11 offset:14336
    s_sub_u32 s77, s46, 81920
    v_mfma_f32_16x16x32_bf16 v[172:175], a[196:199], a[20:23], v[172:175]
    s_waitcnt vmcnt(35)
    ds_read_b64_tr_b16 a[214:215], v11 offset:20480
    s_min_u32 s46, s46, s77
    v_mfma_f32_16x16x32_bf16 v[164:167], a[196:199], a[16:19], v[164:167]
    s_barrier
    v_mfma_f32_16x16x32_bf16 v[160:163], a[192:195], a[16:19], v[160:163]
    s_waitcnt lgkmcnt(4)
    v_add_u32 v11, 73728, v15
    v_mfma_f32_16x16x32_bf16 v[192:195], a[200:203], a[16:19], v[192:195]
    ds_read_b64_tr_b16 a[192:193], v8 offset:0
    v_mfma_f32_16x16x32_bf16 v[196:199], a[204:207], a[16:19], v[196:199]
    ds_read_b64_tr_b16 a[194:195], v8 offset:6144
    v_mfma_f32_16x16x32_bf16 v[204:207], a[204:207], a[20:23], v[204:207]
    buffer_load_dwordx4 a[80:83], v28, s[20:23], s46 offen offset:0 sc1
    v_mfma_f32_16x16x32_bf16 v[200:203], a[200:203], a[20:23], v[200:203]
    v_mfma_f32_16x16x32_bf16 v[208:211], a[200:203], a[24:27], v[208:211]
    ds_read_b64_tr_b16 a[196:197], v8 offset:12288
    v_mfma_f32_16x16x32_bf16 v[212:215], a[204:207], a[24:27], v[212:215]
    ds_read_b64_tr_b16 a[198:199], v8 offset:18432
    v_mfma_f32_16x16x32_bf16 v[220:223], a[204:207], a[28:31], v[220:223]
    buffer_load_dwordx4 a[84:87], v28, s[20:23], s46 offen offset:1024 sc1
    v_mfma_f32_16x16x32_bf16 v[216:219], a[200:203], a[28:31], v[216:219]
    s_waitcnt lgkmcnt(4)
    v_mfma_f32_16x16x32_bf16 v[248:251], a[208:211], a[28:31], v[248:251]
    ds_read_b64_tr_b16 a[200:201], v9 offset:0
    v_mfma_f32_16x16x32_bf16 v[252:255], a[212:215], a[28:31], v[252:255]
    ds_read_b64_tr_b16 a[202:203], v9 offset:6144
    v_mfma_f32_16x16x32_bf16 v[244:247], a[212:215], a[24:27], v[244:247]
    v_mfma_f32_16x16x32_bf16 v[240:243], a[208:211], a[24:27], v[240:243]
    v_mfma_f32_16x16x32_bf16 v[232:235], a[208:211], a[20:23], v[232:235]
    ds_read_b64_tr_b16 a[204:205], v9 offset:12288
    v_mfma_f32_16x16x32_bf16 v[236:239], a[212:215], a[20:23], v[236:239]
    s_waitcnt vmcnt(10)
    s_waitcnt vmcnt(6)
    ds_read_b64_tr_b16 a[206:207], v9 offset:18432
    v_mfma_f32_16x16x32_bf16 v[228:231], a[212:215], a[16:19], v[228:231]
    buffer_load_dwordx4 a[88:91], v28, s[20:23], s46 offen offset:2048 sc1
    v_mfma_f32_16x16x32_bf16 v[224:227], a[208:211], a[16:19], v[224:227]
    s_waitcnt lgkmcnt(4)
    v_mfma_f32_16x16x32_bf16 v[64:67], a[192:195], a[32:35], v[64:67]
    ds_read_b64_tr_b16 a[208:209], v10 offset:0
    v_mfma_f32_16x16x32_bf16 v[64:67], a[196:199], a[48:51], v[64:67]
    ds_read_b64_tr_b16 a[210:211], v10 offset:6144
    v_mfma_f32_16x16x32_bf16 v[72:75], a[196:199], a[52:55], v[72:75]
    v_mfma_f32_16x16x32_bf16 v[72:75], a[192:195], a[36:39], v[72:75]
    buffer_load_dwordx4 a[92:95], v28, s[20:23], s46 offen offset:3072 sc1
    v_mfma_f32_16x16x32_bf16 v[80:83], a[192:195], a[40:43], v[80:83]
    ds_read_b64_tr_b16 a[212:213], v10 offset:12288
    v_mfma_f32_16x16x32_bf16 v[80:83], a[196:199], a[56:59], v[80:83]
    ds_read_b64_tr_b16 a[214:215], v10 offset:18432
    v_mfma_f32_16x16x32_bf16 v[88:91], a[196:199], a[60:63], v[88:91]
    s_add_u32 s46, s45, 24576
    s_sub_u32 s77, s46, 81920
    s_min_u32 s46, s46, s77
    v_mfma_f32_16x16x32_bf16 v[88:91], a[192:195], a[44:47], v[88:91]
pg_1:
    s_cbranch_execz pg_5
    s_waitcnt lgkmcnt(4)
    v_mfma_f32_16x16x32_bf16 v[92:95], a[200:203], a[44:47], v[92:95]
    ds_read_b64_tr_b16 a[192:193], v11 offset:0
    v_mfma_f32_16x16x32_bf16 v[92:95], a[204:207], a[60:63], v[92:95]
    ds_read_b64_tr_b16 a[194:195], v11 offset:6144
    v_mfma_f32_16x16x32_bf16 v[84:87], a[204:207], a[56:59], v[84:87]
    buffer_load_dwordx4 a[96:99], v28, s[20:23], s46 offen offset:0 sc1
    v_mfma_f32_16x16x32_bf16 v[84:87], a[200:203], a[40:43], v[84:87]
    v_mfma_f32_16x16x32_bf16 v[76:79], a[200:203], a[36:39], v[76:79]
    ds_read_b64_tr_b16 a[196:197], v11 offset:12288
    v_mfma_f32_16x16x32_bf16 v[76:79], a[204:207], a[52:55], v[76:79]
    ds_read_b64_tr_b16 a[198:199], v11 offset:18432
    v_mfma_f32_16x16x32_bf16 v[68:71], a[204:207], a[48:51], v[68:71]
    v_mfma_f32_16x16x32_bf16 v[68:71], a[200:203], a[32:35], v[68:71]
    s_waitcnt lgkmcnt(4)
    v_mfma_f32_16x16x32_bf16 v[96:99], a[208:211], a[32:35], v[96:99]
    ds_read_b64_tr_b16 a[200:201], v8 offset:1024
    v_mfma_f32_16x16x32_bf16 v[96:99], a[212:215], a[48:51], v[96:99]
    ds_read_b64_tr_b16 a[202:203], v8 offset:7168
    v_mfma_f32_16x16x32_bf16 v[104:107], a[212:215], a[52:55], v[104:107]
    buffer_load_dwordx4 a[100:103], v28, s[20:23], s46 offen offset:1024 sc1
    v_mfma_f32_16x16x32_bf16 v[104:107], a[208:211], a[36:39], v[104:107]
    v_mfma_f32_16x16x32_bf16 v[112:115], a[208:211], a[40:43], v[112:115]
    ds_read_b64_tr_b16 a[204:205], v8 offset:13312
    v_mfma_f32_16x16x32_bf16 v[112:115], a[212:215], a[56:59], v[112:115]
    ds_read_b64_tr_b16 a[206:207], v8 offset:19456
    v_mfma_f32_16x16x32_bf16 v[120:123], a[212:215], a[60:63], v[120:123]
    v_mfma_f32_16x16x32_bf16 v[120:123], a[208:211], a[44:47], v[120:123]
    s_waitcnt lgkmcnt(4)
    v_mfma_f32_16x16x32_bf16 v[124:127], a[192:195], a[44:47], v[124:127]
    ds_read_b64_tr_b16 a[208:209], v9 offset:1024
    v_mfma_f32_16x16x32_bf16 v[124:127], a[196:199], a[60:63], v[124:127]
    ds_read_b64_tr_b16 a[210:211], v9 offset:7168
    v_mfma_f32_16x16x32_bf16 v[116:119], a[196:199], a[56:59], v[116:119]
    buffer_load_dwordx4 a[104:107], v28, s[20:23], s46 offen offset:2048 sc1
    v_mfma_f32_16x16x32_bf16 v[116:119], a[192:195], a[40:43], v[116:119]
    v_mfma_f32_16x16x32_bf16 v[108:111], a[192:195], a[36:39], v[108:111]
    ds_read_b64_tr_b16 a[212:213], v9 offset:13312
    v_mfma_f32_16x16x32_bf16 v[108:111], a[196:199], a[52:55], v[108:111]
    ds_read_b64_tr_b16 a[214:215], v9 offset:19456
    v_mfma_f32_16x16x32_bf16 v[100:103], a[196:199], a[48:51], v[100:103]
    buffer_load_dwordx4 a[108:111], v28, s[20:23], s46 offen offset:3072 sc1
    v_mfma_f32_16x16x32_bf16 v[100:103], a[192:195], a[32:35], v[100:103]
    s_waitcnt lgkmcnt(4)
    v_mfma_f32_16x16x32_bf16 v[128:131], a[200:203], a[32:35], v[128:131]
    ds_read_b64_tr_b16 a[192:193], v10 offset:1024
    v_mfma_f32_16x16x32_bf16 v[128:131], a[204:207], a[48:51], v[128:131]
    ds_read_b64_tr_b16 a[194:195], v10 offset:7168
    v_mfma_f32_16x16x32_bf16 v[136:139], a[204:207], a[52:55], v[136:139]
    v_mfma_f32_16x16x32_bf16 v[136:139], a[200:203], a[36:39], v[136:139]
    s_add_u32 m0, s49, 0
    v_mfma_f32_16x16x32_bf16 v[144:147], a[200:203], a[40:43], v[144:147]
    ds_read_b64_tr_b16 a[196:197], v10 offset:13312
    v_mfma_f32_16x16x32_bf16 v[144:147], a[204:207], a[56:59], v[144:147]
    ds_read_b64_tr_b16 a[198:199], v10 offset:19456
    v_mfma_f32_16x16x32_bf16 v[152:155], a[204:207], a[60:63], v[152:155]
    buffer_load_dwordx4 v2, s[8:11], s36 offen offset:0 lds
    v_mfma_f32_16x16x32_bf16 v[152:155], a[200:203], a[44:47], v[152:155]
    s_waitcnt lgkmcnt(4)
    v_mfma_f32_16x16x32_bf16 v[156:159], a[208:211], a[44:47], v[156:159]
    ds_read_b64_tr_b16 a[200:201], v11 offset:1024
    v_mfma_f32_16x16x32_bf16 v[156:159], a[212:215], a[60:63], v[156:159]
    s_add_u32 m0, s49, 896
    ds_read_b64_tr_b16 a[202:203], v11 offset:7168
    v_mfma_f32_16x16x32_bf16 v[148:151], a[212:215], a[56:59], v[148:151]
    buffer_load_dwordx4 v2, s[8:11], s36 offen offset:128 lds
    v_mfma_f32_16x16x32_bf16 v[148:151], a[208:211], a[40:43], v[148:151]
    v_mfma_f32_16x16x32_bf16 v[140:143], a[208:211], a[36:39], v[140:143]
    ds_read_b64_tr_b16 a[204:205], v11 offset:13312
    v_mfma_f32_16x16x32_bf16 v[140:143], a[212:215], a[52:55], v[140:143]
    ds_read_b64_tr_b16 a[206:207], v11 offset:19456
    v_mfma_f32_16x16x32_bf16 v[132:135], a[212:215], a[48:51], v[132:135]
    v_mfma_f32_16x16x32_bf16 v[132:135], a[208:211], a[32:35], v[132:135]
    s_waitcnt lgkmcnt(4)
    v_mfma_f32_16x16x32_bf16 v[160:163], a[192:195], a[32:35], v[160:163]
    s_add_u32 m0, s49, 1792
    ds_read_b64_tr_b16 a[208:209], v8 offset:2048
    v_mfma_f32_16x16x32_bf16 v[160:163], a[196:199], a[48:51], v[160:163]
    ds_read_b64_tr_b16 a[210:211], v8 offset:8192
    v_mfma_f32_16x16x32_bf16 v[168:171], a[196:199], a[52:55], v[168:171]
    buffer_load_dwordx4 v2, s[8:11], s36 offen offset:256 lds
    v_mfma_f32_16x16x32_bf16 v[168:171], a[192:195], a[36:39], v[168:171]
    v_mfma_f32_16x16x32_bf16 v[176:179], a[192:195], a[40:43], v[176:179]
    ds_read_b64_tr_b16 a[212:213], v8 offset:14336
    v_mfma_f32_16x16x32_bf16 v[176:179], a[196:199], a[56:59], v[176:179]
    ds_read_b64_tr_b16 a[214:215], v8 offset:20480
    v_mfma_f32_16x16x32_bf16 v[184:187], a[196:199], a[60:63], v[184:187]
    s_add_u32 m0, s49, 3072
    v_add_u32 v8, 98304, v12
    v_mfma_f32_16x16x32_bf16 v[184:187], a[192:195], a[44:47], v[184:187]
    s_waitcnt lgkmcnt(4)
    v_mfma_f32_16x16x32_bf16 v[188:191], a[200:203], a[44:47], v[188:191]
    ds_read_b64_tr_b16 a[192:193], v9 offset:2048
    v_mfma_f32_16x16x32_bf16 v[188:191], a[204:207], a[60:63], v[188:191]
    ds_read_b64_tr_b16 a[194:195], v9 offset:8192
    v_mfma_f32_16x16x32_bf16 v[180:183], a[204:207], a[56:59], v[180:183]
    buffer_load_dwordx4 v3, s[8:11], s36 offen offset:0 lds
    v_mfma_f32_16x16x32_bf16 v[180:183], a[200:203], a[40:43], v[180:183]
    v_mfma_f32_16x16x32_bf16 v[172:175], a[200:203], a[36:39], v[172:175]
    ds_read_b64_tr_b16 a[196:197], v9 offset:14336
    v_mfma_f32_16x16x32_bf16 v[172:175], a[204:207], a[52:55], v[172:175]
    s_add_u32 m0, s49, 3968
    ds_read_b64_tr_b16 a[198:199], v9 offset:20480
    v_mfma_f32_16x16x32_bf16 v[164:167], a[204:207], a[48:51], v[164:167]
    buffer_load_dwordx4 v3, s[8:11], s36 offen offset:128 lds
    v_mfma_f32_16x16x32_bf16 v[164:167], a[200:203], a[32:35], v[164:167]
    s_waitcnt lgkmcnt(4)
    v_add_u32 v9, 98304, v13
    v_mfma_f32_16x16x32_bf16 v[192:195], a[208:211], a[32:35], v[192:195]
    ds_read_b64_tr_b16 a[200:201], v10 offset:2048
    v_mfma_f32_16x16x32_bf16 v[192:195], a[212:215], a[48:51], v[192:195]
    ds_read_b64_tr_b16 a[202:203], v10 offset:8192
    v_mfma_f32_16x16x32_bf16 v[200:203], a[212:215], a[52:55], v[200:203]
    v_mfma_f32_16x16x32_bf16 v[200:203], a[208:211], a[36:39], v[200:203]
    s_add_u32 m0, s49, 4864
    v_mfma_f32_16x16x32_bf16 v[208:211], a[208:211], a[40:43], v[208:211]
    ds_read_b64_tr_b16 a[204:205], v10 offset:14336
    v_mfma_f32_16x16x32_bf16 v[208:211], a[212:215], a[56:59], v[208:211]
    ds_read_b64_tr_b16 a[206:207], v10 offset:20480
    v_mfma_f32_16x16x32_bf16 v[216:219], a[212:215], a[60:63], v[216:219]
    buffer_load_dwordx4 v3, s[8:11], s36 offen offset:256 lds
    v_mfma_f32_16x16x32_bf16 v[216:219], a[208:211], a[44:47], v[216:219]
    s_waitcnt lgkmcnt(4)
    v_add_u32 v10, 98304, v14
    s_add_u32 s36, s36, s37
    v_mfma_f32_16x16x32_bf16 v[220:223], a[192:195], a[44:47], v[220:223]
    s_sub_u32 s55, s36, 7864320
    ds_read_b64_tr_b16 a[208:209], v11 offset:2048
    s_min_u32 s36, s36, s55
    v_mfma_f32_16x16x32_bf16 v[220:223], a[196:199], a[60:63], v[220:223]
    s_add_u32 s46, s45, 28672
    ds_read_b64_tr_b16 a[210:211], v11 offset:8192
    s_sub_u32 s77, s46, 81920
    v_mfma_f32_16x16x32_bf16 v[212:215], a[196:199], a[56:59], v[212:215]
    s_min_u32 s46, s46, s77
    v_mfma_f32_16x16x32_bf16 v[212:215], a[192:195], a[40:43], v[212:215]
    buffer_load_dwordx4 a[112:115], v28, s[20:23], s46 offen offset:0 sc1
    v_mfma_f32_16x16x32_bf16 v[204:207], a[192:195], a[36:39], v[204:207]
    ds_read_b64_tr_b16 a[212:213], v11 offset:14336
    v_mfma_f32_16x16x32_bf16 v[204:207], a[196:199], a[52:55], v[204:207]
    s_waitcnt vmcnt(42)
    ds_read_b64_tr_b16 a[214:215], v11 offset:20480
    v_mfma_f32_16x16x32_bf16 v[196:199], a[196:199], a[48:51], v[196:199]
    s_barrier
    v_mfma_f32_16x16x32_bf16 v[196:199], a[192:195], a[32:35], v[196:199]
    s_waitcnt lgkmcnt(4)
    v_add_u32 v11, 98304, v15
    v_mfma_f32_16x16x32_bf16 v[224:227], a[200:203], a[32:35], v[224:227]
    ds_read_b64_tr_b16 a[192:193], v8 offset:0
    v_mfma_f32_16x16x32_bf16 v[224:227], a[204:207], a[48:51], v[224:227]
    ds_read_b64_tr_b16 a[194:195], v8 offset:6144
    v_mfma_f32_16x16x32_bf16 v[232:235], a[204:207], a[52:55], v[232:235]
    buffer_load_dwordx4 a[116:119], v28, s[20:23], s46 offen offset:1024 sc1
    v_mfma_f32_16x16x32_bf16 v[232:235], a[200:203], a[36:39], v[232:235]
    v_mfma_f32_16x16x32_bf16 v[240:243], a[200:203], a[40:43], v[240:243]
    ds_read_b64_tr_b16 a[196:197], v8 offset:12288
    v_mov_b32 v23, 0
    v_mfma_f32_16x16x32_bf16 v[240:243], a[204:207], a[56:59], v[240:243]
    ds_read_b64_tr_b16 a[198:199], v8 offset:18432
    v_mfma_f32_16x16x32_bf16 v[248:251], a[204:207], a[60:63], v[248:251]
    buffer_load_dword a218, v23, s[24:27], s4 offen offset:128 sc1
    v_mfma_f32_16x16x32_bf16 v[248:251], a[200:203], a[44:47], v[248:251]
    s_waitcnt lgkmcnt(4)
    v_mfma_f32_16x16x32_bf16 v[252:255], a[208:211], a[44:47], v[252:255]
    ds_read_b64_tr_b16 a[200:201], v9 offset:0
    v_mfma_f32_16x16x32_bf16 v[252:255], a[212:215], a[60:63], v[252:255]
    ds_read_b64_tr_b16 a[202:203], v9 offset:6144
    v_mfma_f32_16x16x32_bf16 v[244:247], a[212:215], a[56:59], v[244:247]
    buffer_load_dwordx4 a[120:123], v28, s[20:23], s46 offen offset:2048 sc1
    v_mfma_f32_16x16x32_bf16 v[244:247], a[208:211], a[40:43], v[244:247]
    v_mfma_f32_16x16x32_bf16 v[236:239], a[208:211], a[36:39], v[236:239]
    ds_read_b64_tr_b16 a[204:205], v9 offset:12288
    v_mfma_f32_16x16x32_bf16 v[236:239], a[212:215], a[52:55], v[236:239]
    s_waitcnt vmcnt(18)
    s_waitcnt vmcnt(14)
    ds_read_b64_tr_b16 a[206:207], v9 offset:18432
    v_mfma_f32_16x16x32_bf16 v[228:231], a[212:215], a[48:51], v[228:231]
    buffer_load_dwordx4 a[124:127], v28, s[20:23], s46 offen offset:3072 sc1
    v_mfma_f32_16x16x32_bf16 v[228:231], a[208:211], a[32:35], v[228:231]
    s_waitcnt lgkmcnt(4)
    v_mfma_f32_16x16x32_bf16 v[64:67], a[192:195], a[64:67], v[64:67]
    ds_read_b64_tr_b16 a[208:209], v10 offset:0
    v_mfma_f32_16x16x32_bf16 v[64:67], a[196:199], a[80:83], v[64:67]
    s_add_u32 s46, s45, 32768
    ds_read_b64_tr_b16 a[210:211], v10 offset:6144
    s_sub_u32 s77, s46, 81920
    v_mfma_f32_16x16x32_bf16 v[72:75], a[196:199], a[84:87], v[72:75]
    s_min_u32 s46, s46, s77
    v_mfma_f32_16x16x32_bf16 v[72:75], a[192:195], a[68:71], v[72:75]
    v_mfma_f32_16x16x32_bf16 v[80:83], a[192:195], a[72:75], v[80:83]
    ds_read_b64_tr_b16 a[212:213], v10 offset:12288
    v_mfma_f32_16x16x32_bf16 v[80:83], a[196:199], a[88:91], v[80:83]
    ds_read_b64_tr_b16 a[214:215], v10 offset:18432
    v_mfma_f32_16x16x32_bf16 v[88:91], a[196:199], a[92:95], v[88:91]
    buffer_load_dwordx4 a[128:131], v28, s[20:23], s46 offen offset:0 sc1
    v_mfma_f32_16x16x32_bf16 v[88:91], a[192:195], a[76:79], v[88:91]
    s_waitcnt lgkmcnt(4)
    v_mfma_f32_16x16x32_bf16 v[92:95], a[200:203], a[76:79], v[92:95]
    ds_read_b64_tr_b16 a[192:193], v11 offset:0
    v_mfma_f32_16x16x32_bf16 v[92:95], a[204:207], a[92:95], v[92:95]
    ds_read_b64_tr_b16 a[194:195], v11 offset:6144
    v_mfma_f32_16x16x32_bf16 v[84:87], a[204:207], a[88:91], v[84:87]
    v_mfma_f32_16x16x32_bf16 v[84:87], a[200:203], a[72:75], v[84:87]
    buffer_load_dwordx4 a[132:135], v28, s[20:23], s46 offen offset:1024 sc1
    v_mfma_f32_16x16x32_bf16 v[76:79], a[200:203], a[68:71], v[76:79]
    ds_read_b64_tr_b16 a[196:197], v11 offset:12288
    v_mfma_f32_16x16x32_bf16 v[76:79], a[204:207], a[84:87], v[76:79]
    ds_read_b64_tr_b16 a[198:199], v11 offset:18432
    v_mfma_f32_16x16x32_bf16 v[68:71], a[204:207], a[80:83], v[68:71]
    v_mfma_f32_16x16x32_bf16 v[68:71], a[200:203], a[64:67], v[68:71]
    s_waitcnt lgkmcnt(4)
    v_mfma_f32_16x16x32_bf16 v[96:99], a[208:211], a[64:67], v[96:99]
    ds_read_b64_tr_b16 a[200:201], v8 offset:1024
    v_mfma_f32_16x16x32_bf16 v[96:99], a[212:215], a[80:83], v[96:99]
    ds_read_b64_tr_b16 a[202:203], v8 offset:7168
    v_mfma_f32_16x16x32_bf16 v[104:107], a[212:215], a[84:87], v[104:107]
    buffer_load_dwordx4 a[136:139], v28, s[20:23], s46 offen offset:2048 sc1
    v_mfma_f32_16x16x32_bf16 v[104:107], a[208:211], a[68:71], v[104:107]
    v_mfma_f32_16x16x32_bf16 v[112:115], a[208:211], a[72:75], v[112:115]
    ds_read_b64_tr_b16 a[204:205], v8 offset:13312
    v_mfma_f32_16x16x32_bf16 v[112:115], a[212:215], a[88:91], v[112:115]
    ds_read_b64_tr_b16 a[206:207], v8 offset:19456
    v_mfma_f32_16x16x32_bf16 v[120:123], a[212:215], a[92:95], v[120:123]
    v_mfma_f32_16x16x32_bf16 v[120:123], a[208:211], a[76:79], v[120:123]
    s_waitcnt lgkmcnt(4)
    v_mfma_f32_16x16x32_bf16 v[124:127], a[192:195], a[76:79], v[124:127]
    ds_read_b64_tr_b16 a[208:209], v9 offset:1024
    v_mfma_f32_16x16x32_bf16 v[124:127], a[196:199], a[92:95], v[124:127]
    ds_read_b64_tr_b16 a[210:211], v9 offset:7168
    v_mfma_f32_16x16x32_bf16 v[116:119], a[196:199], a[88:91], v[116:119]
    buffer_load_dwordx4 a[140:143], v28, s[20:23], s46 offen offset:3072 sc1
    v_mfma_f32_16x16x32_bf16 v[116:119], a[192:195], a[72:75], v[116:119]
    v_mfma_f32_16x16x32_bf16 v[108:111], a[192:195], a[68:71], v[108:111]
    ds_read_b64_tr_b16 a[212:213], v9 offset:13312
    v_mfma_f32_16x16x32_bf16 v[108:111], a[196:199], a[84:87], v[108:111]
    ds_read_b64_tr_b16 a[214:215], v9 offset:19456
    v_mfma_f32_16x16x32_bf16 v[100:103], a[196:199], a[80:83], v[100:103]
    s_add_u32 m0, s49, 24576
    v_mfma_f32_16x16x32_bf16 v[100:103], a[192:195], a[64:67], v[100:103]
    s_waitcnt lgkmcnt(4)
    v_mfma_f32_16x16x32_bf16 v[128:131], a[200:203], a[64:67], v[128:131]
    ds_read_b64_tr_b16 a[192:193], v10 offset:1024
    v_mfma_f32_16x16x32_bf16 v[128:131], a[204:207], a[80:83], v[128:131]
    ds_read_b64_tr_b16 a[194:195], v10 offset:7168
    v_mfma_f32_16x16x32_bf16 v[136:139], a[204:207], a[84:87], v[136:139]
    buffer_load_dwordx4 v2, s[8:11], s36 offen offset:0 lds
    v_mfma_f32_16x16x32_bf16 v[136:139], a[200:203], a[68:71], v[136:139]
    v_mfma_f32_16x16x32_bf16 v[144:147], a[200:203], a[72:75], v[144:147]
    s_add_u32 m0, s49, 25472
    ds_read_b64_tr_b16 a[196:197], v10 offset:13312
    v_mfma_f32_16x16x32_bf16 v[144:147], a[204:207], a[88:91], v[144:147]
    ds_read_b64_tr_b16 a[198:199], v10 offset:19456
    v_mfma_f32_16x16x32_bf16 v[152:155], a[204:207], a[92:95], v[152:155]
    buffer_load_dwordx4 v2, s[8:11], s36 offen offset:128 lds
    v_mfma_f32_16x16x32_bf16 v[152:155], a[200:203], a[76:79], v[152:155]
    s_waitcnt lgkmcnt(4)
    v_mfma_f32_16x16x32_bf16 v[156:159], a[208:211], a[76:79], v[156:159]
    ds_read_b64_tr_b16 a[200:201], v11 offset:1024
    v_mfma_f32_16x16x32_bf16 v[156:159], a[212:215], a[92:95], v[156:159]
    ds_read_b64_tr_b16 a[202:203], v11 offset:7168
    v_mfma_f32_16x16x32_bf16 v[148:151], a[212:215], a[88:91], v[148:151]
    buffer_load_dwordx4 v[32:35], v17, s[24:27], s47 offen offset:0 sc1
    v_mfma_f32_16x16x32_bf16 v[148:151], a[208:211], a[72:75], v[148:151]
    s_add_u32 m0, s49, 26368
    v_mfma_f32_16x16x32_bf16 v[140:143], a[208:211], a[68:71], v[140:143]
    ds_read_b64_tr_b16 a[204:205], v11 offset:13312
    v_mfma_f32_16x16x32_bf16 v[140:143], a[212:215], a[84:87], v[140:143]
    ds_read_b64_tr_b16 a[206:207], v11 offset:19456
    v_mfma_f32_16x16x32_bf16 v[132:135], a[212:215], a[80:83], v[132:135]
    buffer_load_dwordx4 v2, s[8:11], s36 offen offset:256 lds
    v_mfma_f32_16x16x32_bf16 v[132:135], a[208:211], a[64:67], v[132:135]
    s_waitcnt lgkmcnt(4)
    v_mfma_f32_16x16x32_bf16 v[160:163], a[192:195], a[64:67], v[160:163]
    ds_read_b64_tr_b16 a[208:209], v8 offset:2048
    v_mfma_f32_16x16x32_bf16 v[160:163], a[196:199], a[80:83], v[160:163]
    s_add_u32 m0, s49, 27648
    ds_read_b64_tr_b16 a[210:211], v8 offset:8192
    v_mfma_f32_16x16x32_bf16 v[168:171], a[196:199], a[84:87], v[168:171]
    buffer_load_dwordx4 v3, s[8:11], s36 offen offset:0 lds
    v_mfma_f32_16x16x32_bf16 v[168:171], a[192:195], a[68:71], v[168:171]
    v_mfma_f32_16x16x32_bf16 v[176:179], a[192:195], a[72:75], v[176:179]
    ds_read_b64_tr_b16 a[212:213], v8 offset:14336
    v_mfma_f32_16x16x32_bf16 v[176:179], a[196:199], a[88:91], v[176:179]
    ds_read_b64_tr_b16 a[214:215], v8 offset:20480
    v_mfma_f32_16x16x32_bf16 v[184:187], a[196:199], a[92:95], v[184:187]
    buffer_load_dwordx4 v[36:39], v17, s[24:27], s47 offen offset:1024 sc1
    v_mfma_f32_16x16x32_bf16 v[184:187], a[192:195], a[76:79], v[184:187]
    s_waitcnt lgkmcnt(4)
    v_add_u32 v8, 122880, v12
    v_mfma_f32_16x16x32_bf16 v[188:191], a[200:203], a[76:79], v[188:191]
    s_add_u32 m0, s49, 28544
    ds_read_b64_tr_b16 a[192:193], v9 offset:2048
    v_mfma_f32_16x16x32_bf16 v[188:191], a[204:207], a[92:95], v[188:191]
    ds_read_b64_tr_b16 a[194:195], v9 offset:8192
    v_mfma_f32_16x16x32_bf16 v[180:183], a[204:207], a[88:91], v[180:183]
    buffer_load_dwordx4 v3, s[8:11], s36 offen offset:128 lds
    v_mfma_f32_16x16x32_bf16 v[180:183], a[200:203], a[72:75], v[180:183]
    v_mfma_f32_16x16x32_bf16 v[172:175], a[200:203], a[68:71], v[172:175]
    ds_read_b64_tr_b16 a[196:197], v9 offset:14336
    v_mfma_f32_16x16x32_bf16 v[172:175], a[204:207], a[84:87], v[172:175]
    ds_read_b64_tr_b16 a[198:199], v9 offset:20480
    v_mfma_f32_16x16x32_bf16 v[164:167], a[204:207], a[80:83], v[164:167]
    s_add_u32 m0, s49, 29440
    v_add_u32 v9, 122880, v13
    v_mfma_f32_16x16x32_bf16 v[164:167], a[200:203], a[64:67], v[164:167]
    s_waitcnt lgkmcnt(4)
    v_mfma_f32_16x16x32_bf16 v[192:195], a[208:211], a[64:67], v[192:195]
    ds_read_b64_tr_b16 a[200:201], v10 offset:2048
    v_mfma_f32_16x16x32_bf16 v[192:195], a[212:215], a[80:83], v[192:195]
    ds_read_b64_tr_b16 a[202:203], v10 offset:8192
    v_mfma_f32_16x16x32_bf16 v[200:203], a[212:215], a[84:87], v[200:203]
    buffer_load_dwordx4 v3, s[8:11], s36 offen offset:256 lds
    v_mfma_f32_16x16x32_bf16 v[200:203], a[208:211], a[68:71], v[200:203]
    buffer_load_dwordx4 v[40:43], v17, s[24:27], s47 offen offset:2048 sc1
    v_mfma_f32_16x16x32_bf16 v[208:211], a[208:211], a[72:75], v[208:211]
    s_add_u32 s36, s36, s37
    ds_read_b64_tr_b16 a[204:205], v10 offset:14336
    s_sub_u32 s55, s36, 7864320
    v_mfma_f32_16x16x32_bf16 v[208:211], a[212:215], a[88:91], v[208:211]
    s_min_u32 s36, s36, s55
    ds_read_b64_tr_b16 a[206:207], v10 offset:20480
    s_add_u32 s46, s45, 36864
    v_mfma_f32_16x16x32_bf16 v[216:219], a[212:215], a[92:95], v[216:219]
    s_sub_u32 s77, s46, 81920
    v_add_u32 v10, 122880, v14
    s_min_u32 s46, s46, s77
    v_mfma_f32_16x16x32_bf16 v[216:219], a[208:211], a[76:79], v[216:219]
    s_waitcnt lgkmcnt(4)
    v_mfma_f32_16x16x32_bf16 v[220:223], a[192:195], a[76:79], v[220:223]
    ds_read_b64_tr_b16 a[208:209], v11 offset:2048
    v_mfma_f32_16x16x32_bf16 v[220:223], a[196:199], a[92:95], v[220:223]
    ds_read_b64_tr_b16 a[210:211], v11 offset:8192
    v_mfma_f32_16x16x32_bf16 v[212:215], a[196:199], a[88:91], v[212:215]
    buffer_load_dwordx4 a[144:147], v28, s[20:23], s46 offen offset:0 sc1
    v_mfma_f32_16x16x32_bf16 v[212:215], a[192:195], a[72:75], v[212:215]
    v_mfma_f32_16x16x32_bf16 v[204:207], a[192:195], a[68:71], v[204:207]
    ds_read_b64_tr_b16 a[212:213], v11 offset:14336
    v_mfma_f32_16x16x32_bf16 v[204:207], a[196:199], a[84:87], v[204:207]
    s_waitcnt vmcnt(54)
    ds_read_b64_tr_b16 a[214:215], v11 offset:20480
    v_mfma_f32_16x16x32_bf16 v[196:199], a[196:199], a[80:83], v[196:199]
    s_barrier
    v_mfma_f32_16x16x32_bf16 v[196:199], a[192:195], a[64:67], v[196:199]
    s_waitcnt lgkmcnt(4)
    buffer_load_dwordx4 a[148:151], v28, s[20:23], s46 offen offset:1024 sc1
    v_mfma_f32_16x16x32_bf16 v[224:227], a[200:203], a[64:67], v[224:227]
    ds_read_b64_tr_b16 a[192:193], v8 offset:0
    v_add_u32 v11, 122880, v15
    v_mfma_f32_16x16x32_bf16 v[224:227], a[204:207], a[80:83], v[224:227]
    ds_read_b64_tr_b16 a[194:195], v8 offset:6144
    v_mfma_f32_16x16x32_bf16 v[232:235], a[204:207], a[84:87], v[232:235]
    buffer_load_dwordx4 v[44:47], v17, s[24:27], s47 offen offset:3072 sc1
    v_mfma_f32_16x16x32_bf16 v[232:235], a[200:203], a[68:71], v[232:235]
    buffer_load_dwordx4 a[152:155], v28, s[20:23], s46 offen offset:2048 sc1
    v_mfma_f32_16x16x32_bf16 v[240:243], a[200:203], a[72:75], v[240:243]
    ds_read_b64_tr_b16 a[196:197], v8 offset:12288
    v_mfma_f32_16x16x32_bf16 v[240:243], a[204:207], a[88:91], v[240:243]
    ds_read_b64_tr_b16 a[198:199], v8 offset:18432
    v_mfma_f32_16x16x32_bf16 v[248:251], a[204:207], a[92:95], v[248:251]
    v_mfma_f32_16x16x32_bf16 v[248:251], a[200:203], a[76:79], v[248:251]
    s_waitcnt lgkmcnt(4)
    v_mfma_f32_16x16x32_bf16 v[252:255], a[208:211], a[76:79], v[252:255]
    ds_read_b64_tr_b16 a[200:201], v9 offset:0
    v_mfma_f32_16x16x32_bf16 v[252:255], a[212:215], a[92:95], v[252:255]
    ds_read_b64_tr_b16 a[202:203], v9 offset:6144
    v_mfma_f32_16x16x32_bf16 v[244:247], a[212:215], a[88:91], v[244:247]
    buffer_load_dwordx4 a[156:159], v28, s[20:23], s46 offen offset:3072 sc1
    v_mfma_f32_16x16x32_bf16 v[244:247], a[208:211], a[72:75], v[244:247]
    v_mfma_f32_16x16x32_bf16 v[236:239], a[208:211], a[68:71], v[236:239]
    s_add_u32 s46, s45, 40960
    ds_read_b64_tr_b16 a[204:205], v9 offset:12288
    s_sub_u32 s77, s46, 81920
    v_mfma_f32_16x16x32_bf16 v[236:239], a[212:215], a[84:87], v[236:239]
    s_waitcnt vmcnt(29)
    s_waitcnt vmcnt(18)
    ds_read_b64_tr_b16 a[206:207], v9 offset:18432
    v_mfma_f32_16x16x32_bf16 v[228:231], a[212:215], a[80:83], v[228:231]
    s_min_u32 s46, s46, s77
    v_mfma_f32_16x16x32_bf16 v[228:231], a[208:211], a[64:67], v[228:231]
    s_waitcnt lgkmcnt(4)
    v_mfma_f32_16x16x32_bf16 v[64:67], a[192:195], a[96:99], v[64:67]
    ds_read_b64_tr_b16 a[208:209], v10 offset:0
    v_mfma_f32_16x16x32_bf16 v[64:67], a[196:199], a[112:115], v[64:67]
    ds_read_b64_tr_b16 a[210:211], v10 offset:6144
    v_mfma_f32_16x16x32_bf16 v[72:75], a[196:199], a[116:119], v[72:75]
    buffer_load_dwordx4 a[160:163], v28, s[20:23], s46 offen offset:0 sc1
    v_mfma_f32_16x16x32_bf16 v[72:75], a[192:195], a[100:103], v[72:75]
    v_mfma_f32_16x16x32_bf16 v[80:83], a[192:195], a[104:107], v[80:83]
    ds_read_b64_tr_b16 a[212:213], v10 offset:12288
    v_mfma_f32_16x16x32_bf16 v[80:83], a[196:199], a[120:123], v[80:83]
    ds_read_b64_tr_b16 a[214:215], v10 offset:18432
    v_mfma_f32_16x16x32_bf16 v[88:91], a[196:199], a[124:127], v[88:91]
    buffer_load_dwordx4 a[164:167], v28, s[20:23], s46 offen offset:1024 sc1
    v_mfma_f32_16x16x32_bf16 v[88:91], a[192:195], a[108:111], v[88:91]
    s_waitcnt lgkmcnt(4)
    v_mfma_f32_16x16x32_bf16 v[92:95], a[200:203], a[108:111], v[92:95]
    ds_read_b64_tr_b16 a[192:193], v11 offset:0
    v_mfma_f32_16x16x32_bf16 v[92:95], a[204:207], a[124:127], v[92:95]
    ds_read_b64_tr_b16 a[194:195], v11 offset:6144
    v_mfma_f32_16x16x32_bf16 v[84:87], a[204:207], a[120:123], v[84:87]
    v_mfma_f32_16x16x32_bf16 v[84:87], a[200:203], a[104:107], v[84:87]
    v_mfma_f32_16x16x32_bf16 v[76:79], a[200:203], a[100:103], v[76:79]
    ds_read_b64_tr_b16 a[196:197], v11 offset:12288
    v_mfma_f32_16x16x32_bf16 v[76:79], a[204:207], a[116:119], v[76:79]
    ds_read_b64_tr_b16 a[198:199], v11 offset:18432
    v_mfma_f32_16x16x32_bf16 v[68:71], a[204:207], a[112:115], v[68:71]
    buffer_load_dwordx4 a[168:171], v28, s[20:23], s46 offen offset:2048 sc1
    v_mfma_f32_16x16x32_bf16 v[68:71], a[200:203], a[96:99], v[68:71]
    s_waitcnt lgkmcnt(4)
    v_mfma_f32_16x16x32_bf16 v[96:99], a[208:211], a[96:99], v[96:99]
    ds_read_b64_tr_b16 a[200:201], v8 offset:1024
    v_mfma_f32_16x16x32_bf16 v[96:99], a[212:215], a[112:115], v[96:99]
    ds_read_b64_tr_b16 a[202:203], v8 offset:7168
    v_mfma_f32_16x16x32_bf16 v[104:107], a[212:215], a[116:119], v[104:107]
    v_mfma_f32_16x16x32_bf16 v[104:107], a[208:211], a[100:103], v[104:107]
    buffer_load_dwordx4 a[172:175], v28, s[20:23], s46 offen offset:3072 sc1
    v_mfma_f32_16x16x32_bf16 v[112:115], a[208:211], a[104:107], v[112:115]
    ds_read_b64_tr_b16 a[204:205], v8 offset:13312
    v_mfma_f32_16x16x32_bf16 v[112:115], a[212:215], a[120:123], v[112:115]
    ds_read_b64_tr_b16 a[206:207], v8 offset:19456
    v_mfma_f32_16x16x32_bf16 v[120:123], a[212:215], a[124:127], v[120:123]
    v_mfma_f32_16x16x32_bf16 v[120:123], a[208:211], a[108:111], v[120:123]
    s_waitcnt lgkmcnt(4)
    v_mfma_f32_16x16x32_bf16 v[124:127], a[192:195], a[108:111], v[124:127]
    ds_read_b64_tr_b16 a[208:209], v9 offset:1024
    v_mfma_f32_16x16x32_bf16 v[124:127], a[196:199], a[124:127], v[124:127]
    s_add_u32 m0, s49, 49152
    ds_read_b64_tr_b16 a[210:211], v9 offset:7168
    v_mfma_f32_16x16x32_bf16 v[116:119], a[196:199], a[120:123], v[116:119]
    buffer_load_dwordx4 v2, s[8:11], s36 offen offset:0 lds
    v_mfma_f32_16x16x32_bf16 v[116:119], a[192:195], a[104:107], v[116:119]
    v_mfma_f32_16x16x32_bf16 v[108:111], a[192:195], a[100:103], v[108:111]
    ds_read_b64_tr_b16 a[212:213], v9 offset:13312
    v_mfma_f32_16x16x32_bf16 v[108:111], a[196:199], a[116:119], v[108:111]
    ds_read_b64_tr_b16 a[214:215], v9 offset:19456
    v_mfma_f32_16x16x32_bf16 v[100:103], a[196:199], a[112:115], v[100:103]
    v_mfma_f32_16x16x32_bf16 v[100:103], a[192:195], a[96:99], v[100:103]
    s_waitcnt lgkmcnt(4)
    s_add_u32 m0, s49, 50048
    v_mfma_f32_16x16x32_bf16 v[128:131], a[200:203], a[96:99], v[128:131]
    ds_read_b64_tr_b16 a[192:193], v10 offset:1024
    v_mfma_f32_16x16x32_bf16 v[128:131], a[204:207], a[112:115], v[128:131]
    ds_read_b64_tr_b16 a[194:195], v10 offset:7168
    v_mfma_f32_16x16x32_bf16 v[136:139], a[204:207], a[116:119], v[136:139]
    buffer_load_dwordx4 v2, s[8:11], s36 offen offset:128 lds
    v_mfma_f32_16x16x32_bf16 v[136:139], a[200:203], a[100:103], v[136:139]
    v_mfma_f32_16x16x32_bf16 v[144:147], a[200:203], a[104:107], v[144:147]
    ds_read_b64_tr_b16 a[196:197], v10 offset:13312
    v_mfma_f32_16x16x32_bf16 v[144:147], a[204:207], a[120:123], v[144:147]
    ds_read_b64_tr_b16 a[198:199], v10 offset:19456
    v_mfma_f32_16x16x32_bf16 v[152:155], a[204:207], a[124:127], v[152:155]
    s_add_u32 m0, s49, 50944
    v_mfma_f32_16x16x32_bf16 v[152:155], a[200:203], a[108:111], v[152:155]
    s_waitcnt lgkmcnt(4)
    v_mfma_f32_16x16x32_bf16 v[156:159], a[208:211], a[108:111], v[156:159]
    ds_read_b64_tr_b16 a[200:201], v11 offset:1024
    v_mfma_f32_16x16x32_bf16 v[156:159], a[212:215], a[124:127], v[156:159]
    ds_read_b64_tr_b16 a[202:203], v11 offset:7168
    v_mfma_f32_16x16x32_bf16 v[148:151], a[212:215], a[120:123], v[148:151]
    buffer_load_dwordx4 v2, s[8:11], s36 offen offset:256 lds
    v_mfma_f32_16x16x32_bf16 v[148:151], a[208:211], a[104:107], v[148:151]
    v_mfma_f32_16x16x32_bf16 v[140:143], a[208:211], a[100:103], v[140:143]
    s_add_u32 m0, s49, 52224
    ds_read_b64_tr_b16 a[204:205], v11 offset:13312
    v_mfma_f32_16x16x32_bf16 v[140:143], a[212:215], a[116:119], v[140:143]
    ds_read_b64_tr_b16 a[206:207], v11 offset:19456
    v_mfma_f32_16x16x32_bf16 v[132:135], a[212:215], a[112:115], v[132:135]
    buffer_load_dwordx4 v3, s[8:11], s36 offen offset:0 lds
    v_mfma_f32_16x16x32_bf16 v[132:135], a[208:211], a[96:99], v[132:135]
    s_waitcnt lgkmcnt(4)
    v_mfma_f32_16x16x32_bf16 v[160:163], a[192:195], a[96:99], v[160:163]
    ds_read_b64_tr_b16 a[208:209], v8 offset:2048
    v_mfma_f32_16x16x32_bf16 v[160:163], a[196:199], a[112:115], v[160:163]
    ds_read_b64_tr_b16 a[210:211], v8 offset:8192
    v_mfma_f32_16x16x32_bf16 v[168:171], a[196:199], a[116:119], v[168:171]
    v_mfma_f32_16x16x32_bf16 v[168:171], a[192:195], a[100:103], v[168:171]
    s_add_u32 m0, s49, 53120
    v_mfma_f32_16x16x32_bf16 v[176:179], a[192:195], a[104:107], v[176:179]
    ds_read_b64_tr_b16 a[212:213], v8 offset:14336
    v_mfma_f32_16x16x32_bf16 v[176:179], a[196:199], a[120:123], v[176:179]
    ds_read_b64_tr_b16 a[214:215], v8 offset:20480
    v_mfma_f32_16x16x32_bf16 v[184:187], a[196:199], a[124:127], v[184:187]
    buffer_load_dwordx4 v3, s[8:11], s36 offen offset:128 lds
    v_mfma_f32_16x16x32_bf16 v[184:187], a[192:195], a[108:111], v[184:187]
    s_waitcnt lgkmcnt(4)
    v_add_u32 v8, 0, v12
    v_mfma_f32_16x16x32_bf16 v[188:191], a[200:203], a[108:111], v[188:191]
    ds_read_b64_tr_b16 a[192:193], v9 offset:2048
    v_mfma_f32_16x16x32_bf16 v[188:191], a[204:207], a[124:127], v[188:191]
    s_add_u32 m0, s49, 54016
    ds_read_b64_tr_b16 a[194:195], v9 offset:8192
    v_mfma_f32_16x16x32_bf16 v[180:183], a[204:207], a[120:123], v[180:183]
    buffer_load_dwordx4 v3, s[8:11], s36 offen offset:256 lds
    v_mfma_f32_16x16x32_bf16 v[180:183], a[200:203], a[104:107], v[180:183]
    s_add_u32 s36, s36, s37
    s_sub_u32 s55, s36, 7864320
    s_min_u32 s36, s36, s55
    v_mfma_f32_16x16x32_bf16 v[172:175], a[200:203], a[100:103], v[172:175]
    ds_read_b64_tr_b16 a[196:197], v9 offset:14336
    v_mfma_f32_16x16x32_bf16 v[172:175], a[204:207], a[116:119], v[172:175]
    s_add_u32 s46, s45, 45056
    ds_read_b64_tr_b16 a[198:199], v9 offset:20480
    s_sub_u32 s77, s46, 81920
    v_mfma_f32_16x16x32_bf16 v[164:167], a[204:207], a[112:115], v[164:167]
    s_min_u32 s46, s46, s77
    v_add_u32 v9, 0, v13
    v_mfma_f32_16x16x32_bf16 v[164:167], a[200:203], a[96:99], v[164:167]
    s_waitcnt lgkmcnt(4)
    v_mfma_f32_16x16x32_bf16 v[192:195], a[208:211], a[96:99], v[192:195]
    ds_read_b64_tr_b16 a[200:201], v10 offset:2048
    v_mfma_f32_16x16x32_bf16 v[192:195], a[212:215], a[112:115], v[192:195]
    ds_read_b64_tr_b16 a[202:203], v10 offset:8192
    v_mfma_f32_16x16x32_bf16 v[200:203], a[212:215], a[116:119], v[200:203]
    buffer_load_dwordx4 a[176:179], v28, s[20:23], s46 offen offset:0 sc1
    v_mfma_f32_16x16x32_bf16 v[200:203], a[208:211], a[100:103], v[200:203]
    v_mfma_f32_16x16x32_bf16 v[208:211], a[208:211], a[104:107], v[208:211]
    ds_read_b64_tr_b16 a[204:205], v10 offset:14336
    v_mfma_f32_16x16x32_bf16 v[208:211], a[212:215], a[120:123], v[208:211]
    ds_read_b64_tr_b16 a[206:207], v10 offset:20480
    v_mfma_f32_16x16x32_bf16 v[216:219], a[212:215], a[124:127], v[216:219]
    v_add_u32 v10, 0, v14
    v_mfma_f32_16x16x32_bf16 v[216:219], a[208:211], a[108:111], v[216:219]
    s_waitcnt lgkmcnt(4)
    v_mfma_f32_16x16x32_bf16 v[220:223], a[192:195], a[108:111], v[220:223]
    s_waitcnt vmcnt(13)
    ds_read_b64_tr_b16 a[208:209], v11 offset:2048
    v_xor_b32 v34, s7, v34
    v_mfma_f32_16x16x32_bf16 v[220:223], a[196:199], a[124:127], v[220:223]
    ds_read_b64_tr_b16 a[210:211], v11 offset:8192
    v_xor_b32 v38, s7, v38
    v_mfma_f32_16x16x32_bf16 v[212:215], a[196:199], a[120:123], v[212:215]
    buffer_load_dwordx4 a[180:183], v28, s[20:23], s46 offen offset:1024 sc1
    v_mfma_f32_16x16x32_bf16 v[212:215], a[192:195], a[104:107], v[212:215]
    v_xor_b32 v42, s7, v42
    v_xor_b32 v46, s7, v46
    v_mfma_f32_16x16x32_bf16 v[204:207], a[192:195], a[100:103], v[204:207]
    ds_read_b64_tr_b16 a[212:213], v11 offset:14336
    v_or3_b32 v34, v34, v38, v42
    v_mfma_f32_16x16x32_bf16 v[204:207], a[196:199], a[116:119], v[204:207]
    s_waitcnt vmcnt(35)
    ds_read_b64_tr_b16 a[214:215], v11 offset:20480
    v_or_b32 v34, v34, v46
    v_mfma_f32_16x16x32_bf16 v[196:199], a[196:199], a[112:115], v[196:199]
pg_2:
    s_cbranch_execz pg_6
    s_barrier
    v_mfma_f32_16x16x32_bf16 v[196:199], a[192:195], a[96:99], v[196:199]
    s_waitcnt lgkmcnt(4)
    v_cmp_ne_u32 vcc, 0, v34
    v_add_u32 v11, 0, v15
    v_mfma_f32_16x16x32_bf16 v[224:227], a[200:203], a[96:99], v[224:227]
    ds_read_b64_tr_b16 a[192:193], v8 offset:0
    v_mfma_f32_16x16x32_bf16 v[224:227], a[204:207], a[112:115], v[224:227]
    ds_read_b64_tr_b16 a[194:195], v8 offset:6144
    v_mfma_f32_16x16x32_bf16 v[232:235], a[204:207], a[116:119], v[232:235]
    s_cbranch_vccnz spin_rec
spin_rec_ret:
    v_max_u32 v20, v32, v33
    v_mfma_f32_16x16x32_bf16 v[232:235], a[200:203], a[100:103], v[232:235]
    buffer_load_dwordx4 a[184:187], v28, s[20:23], s46 offen offset:2048 sc1
    v_mfma_f32_16x16x32_bf16 v[240:243], a[200:203], a[104:107], v[240:243]
    ds_read_b64_tr_b16 a[196:197], v8 offset:12288
    v_min_u32 v21, v32, v33
    v_mfma_f32_16x16x32_bf16 v[240:243], a[204:207], a[120:123], v[240:243]
    ds_read_b64_tr_b16 a[198:199], v8 offset:18432
    v_med3_u32 v21, v20, v21, v36
    v_mfma_f32_16x16x32_bf16 v[248:251], a[204:207], a[124:127], v[248:251]
    buffer_load_dwordx4 a[188:191], v28, s[20:23], s46 offen offset:3072 sc1
    v_mfma_f32_16x16x32_bf16 v[248:251], a[200:203], a[108:111], v[248:251]
    s_waitcnt lgkmcnt(4)
    v_max_u32 v20, v20, v36
    v_med3_u32 v21, v20, v21, v37
    v_mfma_f32_16x16x32_bf16 v[252:255], a[208:211], a[108:111], v[252:255]
    s_add_u32 s46, s45, 49152
    ds_read_b64_tr_b16 a[200:201], v9 offset:0
    v_max_u32 v20, v20, v37
    v_mfma_f32_16x16x32_bf16 v[252:255], a[212:215], a[124:127], v[252:255]
    s_sub_u32 s77, s46, 81920
    ds_read_b64_tr_b16 a[202:203], v9 offset:6144
    v_med3_u32 v21, v20, v21, v40
    v_mfma_f32_16x16x32_bf16 v[244:247], a[212:215], a[120:123], v[244:247]
    s_min_u32 s46, s46, s77
    v_max_u32 v20, v20, v40
    v_med3_u32 v21, v20, v21, v41
    v_mfma_f32_16x16x32_bf16 v[244:247], a[208:211], a[104:107], v[244:247]
    buffer_load_dwordx4 a[0:3], v28, s[20:23], s46 offen offset:0 sc1
    v_mfma_f32_16x16x32_bf16 v[236:239], a[208:211], a[100:103], v[236:239]
    ds_read_b64_tr_b16 a[204:205], v9 offset:12288
    v_max_u32 v20, v20, v41
    v_mfma_f32_16x16x32_bf16 v[236:239], a[212:215], a[116:119], v[236:239]
    s_waitcnt vmcnt(29)
    s_waitcnt vmcnt(15)
    ds_read_b64_tr_b16 a[206:207], v9 offset:18432
    v_mfma_f32_16x16x32_bf16 v[228:231], a[212:215], a[112:115], v[228:231]
    v_med3_u32 v21, v20, v21, v44
    v_max_u32 v20, v20, v44
    v_mfma_f32_16x16x32_bf16 v[228:231], a[208:211], a[96:99], v[228:231]
    s_waitcnt lgkmcnt(4)
    v_med3_u32 v21, v20, v21, v45
    v_max_u32 v20, v20, v45
    v_mfma_f32_16x16x32_bf16 v[64:67], a[192:195], a[128:131], v[64:67]
    ds_read_b64_tr_b16 a[208:209], v10 offset:0
    v_mov_b32_dpp v22, v20 row_ror:8 row_mask:0xf bank_mask:0xf
    v_mfma_f32_16x16x32_bf16 v[64:67], a[196:199], a[144:147], v[64:67]
    ds_read_b64_tr_b16 a[210:211], v10 offset:6144
    v_mov_b32_dpp v23, v21 row_ror:8 row_mask:0xf bank_mask:0xf
    v_mfma_f32_16x16x32_bf16 v[72:75], a[196:199], a[148:151], v[72:75]
    buffer_load_dwordx4 a[4:7], v28, s[20:23], s46 offen offset:1024 sc1
    v_mfma_f32_16x16x32_bf16 v[72:75], a[192:195], a[132:135], v[72:75]
    v_min_u32 v24, v20, v22
    v_max_u32 v20, v20, v22
    v_mfma_f32_16x16x32_bf16 v[80:83], a[192:195], a[136:139], v[80:83]
    ds_read_b64_tr_b16 a[212:213], v10 offset:12288
    v_max3_u32 v21, v24, v21, v23
    v_mfma_f32_16x16x32_bf16 v[80:83], a[196:199], a[152:155], v[80:83]
    ds_read_b64_tr_b16 a[214:215], v10 offset:18432
    v_mov_b32_dpp v22, v20 row_ror:4 row_mask:0xf bank_mask:0xf
    v_mfma_f32_16x16x32_bf16 v[88:91], a[196:199], a[156:159], v[88:91]
    v_mov_b32_dpp v23, v21 row_ror:4 row_mask:0xf bank_mask:0xf
    v_min_u32 v24, v20, v22
    v_mfma_f32_16x16x32_bf16 v[88:91], a[192:195], a[140:143], v[88:91]
    s_waitcnt lgkmcnt(4)
    v_max_u32 v20, v20, v22
    v_max3_u32 v21, v24, v21, v23
    v_mfma_f32_16x16x32_bf16 v[92:95], a[200:203], a[140:143], v[92:95]
    ds_read_b64_tr_b16 a[192:193], v11 offset:0
    v_mov_b32_dpp v22, v20 row_ror:2 row_mask:0xf bank_mask:0xf
    v_mfma_f32_16x16x32_bf16 v[92:95], a[204:207], a[156:159], v[92:95]
    ds_read_b64_tr_b16 a[194:195], v11 offset:6144
    v_mov_b32_dpp v23, v21 row_ror:2 row_mask:0xf bank_mask:0xf
    v_mfma_f32_16x16x32_bf16 v[84:87], a[204:207], a[152:155], v[84:87]
    buffer_load_dwordx4 a[8:11], v28, s[20:23], s46 offen offset:2048 sc1
    v_mfma_f32_16x16x32_bf16 v[84:87], a[200:203], a[136:139], v[84:87]
    v_min_u32 v24, v20, v22
    v_max_u32 v20, v20, v22
    v_mfma_f32_16x16x32_bf16 v[76:79], a[200:203], a[132:135], v[76:79]
    ds_read_b64_tr_b16 a[196:197], v11 offset:12288
    v_max3_u32 v21, v24, v21, v23
    v_mfma_f32_16x16x32_bf16 v[76:79], a[204:207], a[148:151], v[76:79]
    ds_read_b64_tr_b16 a[198:199], v11 offset:18432
    v_mov_b32_dpp v22, v20 row_ror:1 row_mask:0xf bank_mask:0xf
    v_mfma_f32_16x16x32_bf16 v[68:71], a[204:207], a[144:147], v[68:71]
    buffer_load_dwordx4 a[12:15], v28, s[20:23], s46 offen offset:3072 sc1
    v_mfma_f32_16x16x32_bf16 v[68:71], a[200:203], a[128:131], v[68:71]
    s_waitcnt lgkmcnt(4)
    v_mov_b32_dpp v23, v21 row_ror:1 row_mask:0xf bank_mask:0xf
    v_min_u32 v24, v20, v22
    v_mfma_f32_16x16x32_bf16 v[96:99], a[208:211], a[128:131], v[96:99]
    s_andn2_b32 s88, s2, 7
    ds_read_b64_tr_b16 a[200:201], v8 offset:1024
    v_max_u32 v20, v20, v22
    v_mfma_f32_16x16x32_bf16 v[96:99], a[212:215], a[144:147], v[96:99]
    s_lshl_b32 s88, s88, 2
    ds_read_b64_tr_b16 a[202:203], v8 offset:7168
    v_max3_u32 v21, v24, v21, v23
    v_mfma_f32_16x16x32_bf16 v[104:107], a[212:215], a[148:151], v[104:107]
    s_lshr_b32 s89, s53, 1
    v_mov_b32 v22, v20
    v_mov_b32 v23, v21
    v_mfma_f32_16x16x32_bf16 v[104:107], a[208:211], a[132:135], v[104:107]
    s_add_u32 s88, s88, s89
    v_permlane16_swap_b32 v20, v22
    v_mfma_f32_16x16x32_bf16 v[112:115], a[208:211], a[136:139], v[112:115]
    s_add_u32 m0, s49, 73728
    ds_read_b64_tr_b16 a[204:205], v8 offset:13312
    v_lshl_add_u32 v60, v1, 2, s88
    v_mfma_f32_16x16x32_bf16 v[112:115], a[212:215], a[152:155], v[112:115]
    s_andn2_b32 s88, s2, 0x18
    ds_read_b64_tr_b16 a[206:207], v8 offset:19456
    v_accvgpr_write_b32 a96, 1.0
    v_mfma_f32_16x16x32_bf16 v[120:123], a[212:215], a[156:159], v[120:123]
    buffer_load_dwordx4 v2, s[8:11], s36 offen offset:0 lds
    v_mfma_f32_16x16x32_bf16 v[120:123], a[208:211], a[140:143], v[120:123]
    s_waitcnt lgkmcnt(4)
    v_permlane16_swap_b32 v21, v23
    v_mfma_f32_16x16x32_bf16 v[124:127], a[192:195], a[140:143], v[124:127]
    s_lshl_b32 s88, s88, 2
    ds_read_b64_tr_b16 a[208:209], v9 offset:1024
    v_min_u32 v24, v20, v22
    v_mfma_f32_16x16x32_bf16 v[124:127], a[196:199], a[156:159], v[124:127]
    s_add_u32 s88, s88, s3
    ds_read_b64_tr_b16 a[210:211], v9 offset:7168
    v_max_u32 v20, v20, v22
    v_mfma_f32_16x16x32_bf16 v[116:119], a[196:199], a[152:155], v[116:119]
    s_add_u32 m0, s49, 74624
    v_max3_u32 v21, v24, v21, v23
    v_mov_b32 v22, v20
    v_mfma_f32_16x16x32_bf16 v[116:119], a[192:195], a[136:139], v[116:119]
    buffer_load_dwordx4 v2, s[8:11], s36 offen offset:128 lds
    v_mfma_f32_16x16x32_bf16 v[108:111], a[192:195], a[132:135], v[108:111]
    ds_read_b64_tr_b16 a[212:213], v9 offset:13312
    v_mov_b32 v23, v21
    v_mfma_f32_16x16x32_bf16 v[108:111], a[196:199], a[148:151], v[108:111]
    ds_read_b64_tr_b16 a[214:215], v9 offset:19456
    v_and_b32 v61, 3, v1
    v_mfma_f32_16x16x32_bf16 v[100:103], a[196:199], a[144:147], v[100:103]
    v_permlane32_swap_b32 v20, v22
    v_mfma_f32_16x16x32_bf16 v[100:103], a[192:195], a[128:131], v[100:103]
    s_waitcnt lgkmcnt(4)
    v_permlane32_swap_b32 v21, v23
    v_mfma_f32_16x16x32_bf16 v[128:131], a[200:203], a[128:131], v[128:131]
    ds_read_b64_tr_b16 a[192:193], v10 offset:1024
    v_min_u32 v24, v20, v22
    v_mfma_f32_16x16x32_bf16 v[128:131], a[204:207], a[144:147], v[128:131]
    s_add_u32 m0, s49, 75520
    ds_read_b64_tr_b16 a[194:195], v10 offset:7168
    v_max_u32 v20, v20, v22
    v_mfma_f32_16x16x32_bf16 v[136:139], a[204:207], a[148:151], v[136:139]
    buffer_load_dwordx4 v2, s[8:11], s36 offen offset:256 lds
    v_mfma_f32_16x16x32_bf16 v[136:139], a[200:203], a[132:135], v[136:139]
    v_max3_u32 v21, v24, v21, v23
    v_lshl_add_u32 v61, v61, 5, s88
    v_mfma_f32_16x16x32_bf16 v[144:147], a[200:203], a[136:139], v[144:147]
    s_lshl_b32 s56, s3, 3
    ds_read_b64_tr_b16 a[196:197], v10 offset:13312
    v_cmp_gt_u32 s[88:89], 8, v1
    v_mfma_f32_16x16x32_bf16 v[144:147], a[204:207], a[152:155], v[144:147]
    s_add_u32 s56, s56, 147456
    ds_read_b64_tr_b16 a[198:199], v10 offset:19456
    v_mov_b32 v22, s56
    v_mfma_f32_16x16x32_bf16 v[152:155], a[204:207], a[156:159], v[152:155]
    v_mov_b32 v23, 147456
    v_cndmask_b32 v60, v61, v60, s[88:89]
    v_mfma_f32_16x16x32_bf16 v[152:155], a[200:203], a[140:143], v[152:155]
    s_waitcnt lgkmcnt(4)
    v_lshlrev_b32 v61, 2, v1
    v_cmp_gt_u32 s[88:89], 12, v1
    v_mfma_f32_16x16x32_bf16 v[156:159], a[208:211], a[140:143], v[156:159]
    s_add_u32 m0, s49, 76800
    ds_read_b64_tr_b16 a[200:201], v11 offset:1024
    v_cndmask_b32 v60, v61, v60, s[88:89]
    v_mfma_f32_16x16x32_bf16 v[156:159], a[212:215], a[156:159], v[156:159]
    ds_read_b64_tr_b16 a[202:203], v11 offset:7168
    v_lshlrev_b32 v60, 4, v60
    v_mfma_f32_16x16x32_bf16 v[148:151], a[212:215], a[152:155], v[148:151]
    buffer_load_dwordx4 v3, s[8:11], s36 offen offset:0 lds
    v_mfma_f32_16x16x32_bf16 v[148:151], a[208:211], a[136:139], v[148:151]
    v_accvgpr_write_b32 a97, 1.0
    v_accvgpr_write_b32 a98, 1.0
    v_mfma_f32_16x16x32_bf16 v[140:143], a[208:211], a[132:135], v[140:143]
    ds_read_b64_tr_b16 a[204:205], v11 offset:13312
    v_accvgpr_write_b32 a99, 1.0
    v_mfma_f32_16x16x32_bf16 v[140:143], a[212:215], a[148:151], v[140:143]
    ds_read_b64_tr_b16 a[206:207], v11 offset:19456
    v_accvgpr_write_b32 a100, 1.0
    v_mfma_f32_16x16x32_bf16 v[132:135], a[212:215], a[144:147], v[132:135]
    s_add_u32 m0, s49, 77696
    v_accvgpr_write_b32 a101, 1.0
    v_accvgpr_write_b32 a102, 1.0
    v_mfma_f32_16x16x32_bf16 v[132:135], a[208:211], a[128:131], v[132:135]
    s_waitcnt lgkmcnt(4)
    v_accvgpr_write_b32 a103, 1.0
    v_accvgpr_write_b32 a104, 1.0
    v_mfma_f32_16x16x32_bf16 v[160:163], a[192:195], a[128:131], v[160:163]
    ds_read_b64_tr_b16 a[208:209], v8 offset:2048
    v_accvgpr_write_b32 a105, 1.0
    v_mfma_f32_16x16x32_bf16 v[160:163], a[196:199], a[144:147], v[160:163]
    ds_read_b64_tr_b16 a[210:211], v8 offset:8192
    v_accvgpr_write_b32 a106, 1.0
    v_mfma_f32_16x16x32_bf16 v[168:171], a[196:199], a[148:151], v[168:171]
    buffer_load_dwordx4 v3, s[8:11], s36 offen offset:128 lds
    v_mfma_f32_16x16x32_bf16 v[168:171], a[192:195], a[132:135], v[168:171]
    v_accvgpr_write_b32 a107, 1.0
    v_accvgpr_write_b32 a108, 1.0
    v_mfma_f32_16x16x32_bf16 v[176:179], a[192:195], a[136:139], v[176:179]
    s_add_u32 m0, s49, 78592
    ds_read_b64_tr_b16 a[212:213], v8 offset:14336
    v_accvgpr_write_b32 a109, 1.0
    v_mfma_f32_16x16x32_bf16 v[176:179], a[196:199], a[152:155], v[176:179]
    ds_read_b64_tr_b16 a[214:215], v8 offset:20480
    v_accvgpr_write_b32 a110, 1.0
    v_mfma_f32_16x16x32_bf16 v[184:187], a[196:199], a[156:159], v[184:187]
    buffer_load_dwordx4 v3, s[8:11], s36 offen offset:256 lds
    v_mfma_f32_16x16x32_bf16 v[184:187], a[192:195], a[140:143], v[184:187]
    s_waitcnt lgkmcnt(4)
    v_accvgpr_write_b32 a111, 1.0
    v_accvgpr_write_b32 a112, 1.0
    v_mfma_f32_16x16x32_bf16 v[188:191], a[200:203], a[140:143], v[188:191]
    s_add_u32 s36, s36, s37
    ds_read_b64_tr_b16 a[192:193], v9 offset:2048
    v_accvgpr_write_b32 a113, 1.0
    v_mfma_f32_16x16x32_bf16 v[188:191], a[204:207], a[156:159], v[188:191]
    s_sub_u32 s55, s36, 7864320
    ds_read_b64_tr_b16 a[194:195], v9 offset:8192
    v_accvgpr_write_b32 a114, 1.0
    v_mfma_f32_16x16x32_bf16 v[180:183], a[204:207], a[152:155], v[180:183]
    s_min_u32 s36, s36, s55
    ds_write_b64 v22, v[20:21]
    v_accvgpr_write_b32 a115, 1.0
    v_mfma_f32_16x16x32_bf16 v[180:183], a[200:203], a[136:139], v[180:183]
    s_add_u32 s46, s45, 53248
    v_accvgpr_write_b32 a116, 1.0
    v_accvgpr_write_b32 a117, 1.0
    v_mfma_f32_16x16x32_bf16 v[172:175], a[200:203], a[132:135], v[172:175]
    s_sub_u32 s77, s46, 81920
    ds_read_b64_tr_b16 a[196:197], v9 offset:14336
    v_accvgpr_write_b32 a118, 1.0
    v_mfma_f32_16x16x32_bf16 v[172:175], a[204:207], a[148:151], v[172:175]
    s_min_u32 s46, s46, s77
    ds_read_b64_tr_b16 a[198:199], v9 offset:20480
    v_accvgpr_write_b32 a119, 1.0
    v_mfma_f32_16x16x32_bf16 v[164:167], a[204:207], a[144:147], v[164:167]
    buffer_load_dwordx4 a[16:19], v28, s[20:23], s46 offen offset:0 sc1
    v_mfma_f32_16x16x32_bf16 v[164:167], a[200:203], a[128:131], v[164:167]
    s_waitcnt lgkmcnt(4)
    v_accvgpr_write_b32 a120, 1.0
    v_accvgpr_write_b32 a121, 1.0
    v_mfma_f32_16x16x32_bf16 v[192:195], a[208:211], a[128:131], v[192:195]
    ds_read_b64_tr_b16 a[200:201], v10 offset:2048
    v_accvgpr_write_b32 a122, 1.0
    v_mfma_f32_16x16x32_bf16 v[192:195], a[212:215], a[144:147], v[192:195]
    ds_read_b64_tr_b16 a[202:203], v10 offset:8192
    v_accvgpr_write_b32 a123, 1.0
    v_mfma_f32_16x16x32_bf16 v[200:203], a[212:215], a[148:151], v[200:203]
    buffer_load_dwordx4 a[20:23], v28, s[20:23], s46 offen offset:1024 sc1
    v_mfma_f32_16x16x32_bf16 v[200:203], a[208:211], a[132:135], v[200:203]
    v_accvgpr_write_b32 a124, 1.0
    v_accvgpr_write_b32 a125, 1.0
    v_mfma_f32_16x16x32_bf16 v[208:211], a[208:211], a[136:139], v[208:211]
    ds_read_b64_tr_b16 a[204:205], v10 offset:14336
    v_accvgpr_write_b32 a126, 1.0
    v_mfma_f32_16x16x32_bf16 v[208:211], a[212:215], a[152:155], v[208:211]
    ds_read_b64_tr_b16 a[206:207], v10 offset:20480
    v_accvgpr_write_b32 a127, 1.0
    v_mfma_f32_16x16x32_bf16 v[216:219], a[212:215], a[156:159], v[216:219]
    v_add_u32 v8, 24576, v12
    v_add_u32 v9, 24576, v13
    v_mfma_f32_16x16x32_bf16 v[216:219], a[208:211], a[140:143], v[216:219]
    s_waitcnt lgkmcnt(4)
    v_add_u32 v10, 24576, v14
    v_mfma_f32_16x16x32_bf16 v[220:223], a[192:195], a[140:143], v[220:223]
    ds_read_b64_tr_b16 a[208:209], v11 offset:2048
    v_mfma_f32_16x16x32_bf16 v[220:223], a[196:199], a[156:159], v[220:223]
    ds_read_b64_tr_b16 a[210:211], v11 offset:8192
    v_mfma_f32_16x16x32_bf16 v[212:215], a[196:199], a[152:155], v[212:215]
    buffer_load_dwordx4 a[24:27], v28, s[20:23], s46 offen offset:2048 sc1
    v_mfma_f32_16x16x32_bf16 v[212:215], a[192:195], a[136:139], v[212:215]
    v_mfma_f32_16x16x32_bf16 v[204:207], a[192:195], a[132:135], v[204:207]
    ds_read_b64_tr_b16 a[212:213], v11 offset:14336
    v_mfma_f32_16x16x32_bf16 v[204:207], a[196:199], a[148:151], v[204:207]
    s_waitcnt vmcnt(33)
    ds_read_b64_tr_b16 a[214:215], v11 offset:20480
    v_mfma_f32_16x16x32_bf16 v[196:199], a[196:199], a[144:147], v[196:199]
    s_barrier
    v_mfma_f32_16x16x32_bf16 v[196:199], a[192:195], a[128:131], v[196:199]
    s_waitcnt lgkmcnt(4)
    v_add_u32 v11, 24576, v15
    v_mfma_f32_16x16x32_bf16 v[224:227], a[200:203], a[128:131], v[224:227]
    ds_read_b64_tr_b16 a[192:193], v8 offset:0
    v_mfma_f32_16x16x32_bf16 v[224:227], a[204:207], a[144:147], v[224:227]
    ds_read_b64_tr_b16 a[194:195], v8 offset:6144
    v_mfma_f32_16x16x32_bf16 v[232:235], a[204:207], a[148:151], v[232:235]
    ds_read_b128 v[32:35], v23
    v_mfma_f32_16x16x32_bf16 v[232:235], a[200:203], a[132:135], v[232:235]
    ds_read_b128 v[36:39], v23 offset:16
    v_mfma_f32_16x16x32_bf16 v[240:243], a[200:203], a[136:139], v[240:243]
    ds_read_b64_tr_b16 a[196:197], v8 offset:12288
    v_mfma_f32_16x16x32_bf16 v[240:243], a[204:207], a[152:155], v[240:243]
    ds_read_b64_tr_b16 a[198:199], v8 offset:18432
    v_mfma_f32_16x16x32_bf16 v[248:251], a[204:207], a[156:159], v[248:251]
    buffer_load_dwordx4 a[28:31], v28, s[20:23], s46 offen offset:3072 sc1
    v_mfma_f32_16x16x32_bf16 v[248:251], a[200:203], a[140:143], v[248:251]
    s_waitcnt lgkmcnt(4)
    s_add_u32 s46, s45, 57344
    s_sub_u32 s77, s46, 81920
    v_mfma_f32_16x16x32_bf16 v[252:255], a[208:211], a[140:143], v[252:255]
    s_min_u32 s46, s46, s77
    ds_read_b64_tr_b16 a[200:201], v9 offset:0
    v_mfma_f32_16x16x32_bf16 v[252:255], a[212:215], a[156:159], v[252:255]
    ds_read_b64_tr_b16 a[202:203], v9 offset:6144
    v_mfma_f32_16x16x32_bf16 v[244:247], a[212:215], a[152:155], v[244:247]
    buffer_load_dwordx4 a[32:35], v28, s[20:23], s46 offen offset:0 sc1
    v_mfma_f32_16x16x32_bf16 v[244:247], a[208:211], a[136:139], v[244:247]
    v_mfma_f32_16x16x32_bf16 v[236:239], a[208:211], a[132:135], v[236:239]
    ds_read_b64_tr_b16 a[204:205], v9 offset:12288
    v_mfma_f32_16x16x32_bf16 v[236:239], a[212:215], a[148:151], v[236:239]
    s_waitcnt vmcnt(25)
    s_waitcnt vmcnt(15)
    ds_read_b64_tr_b16 a[206:207], v9 offset:18432
    v_mfma_f32_16x16x32_bf16 v[228:231], a[212:215], a[144:147], v[228:231]
    buffer_load_dwordx4 a[36:39], v28, s[20:23], s46 offen offset:1024 sc1
    v_mfma_f32_16x16x32_bf16 v[228:231], a[208:211], a[128:131], v[228:231]
    s_waitcnt lgkmcnt(4)
    v_mfma_f32_16x16x32_bf16 v[64:67], a[192:195], a[160:163], v[64:67]
    ds_read_b64_tr_b16 a[208:209], v10 offset:0
    v_mfma_f32_16x16x32_bf16 v[64:67], a[196:199], a[176:179], v[64:67]
    ds_read_b64_tr_b16 a[210:211], v10 offset:6144
    v_accvgpr_write_b32 a128, 1.0
    v_mfma_f32_16x16x32_bf16 v[72:75], a[196:199], a[180:183], v[72:75]
    v_accvgpr_write_b32 a129, 1.0
    v_mfma_f32_16x16x32_bf16 v[72:75], a[192:195], a[164:167], v[72:75]
    buffer_load_dwordx4 a[40:43], v28, s[20:23], s46 offen offset:2048 sc1
    v_mfma_f32_16x16x32_bf16 v[80:83], a[192:195], a[168:171], v[80:83]
    ds_read_b64_tr_b16 a[212:213], v10 offset:12288
    v_max_u32 v20, v32, v33
    v_mfma_f32_16x16x32_bf16 v[80:83], a[196:199], a[184:187], v[80:83]
    ds_read_b64_tr_b16 a[214:215], v10 offset:18432
    v_min_u32 v21, v32, v33
    v_mfma_f32_16x16x32_bf16 v[88:91], a[196:199], a[188:191], v[88:91]
    v_med3_u32 v21, v20, v21, v34
    v_max_u32 v20, v20, v34
    v_mfma_f32_16x16x32_bf16 v[88:91], a[192:195], a[172:175], v[88:91]
    s_waitcnt lgkmcnt(4)
    v_med3_u32 v21, v20, v21, v35
    v_max_u32 v20, v20, v35
    v_mfma_f32_16x16x32_bf16 v[92:95], a[200:203], a[172:175], v[92:95]
    ds_read_b64_tr_b16 a[192:193], v11 offset:0
    v_med3_u32 v21, v20, v21, v36
    v_mfma_f32_16x16x32_bf16 v[92:95], a[204:207], a[188:191], v[92:95]
    ds_read_b64_tr_b16 a[194:195], v11 offset:6144
    v_max_u32 v20, v20, v36
    v_mfma_f32_16x16x32_bf16 v[84:87], a[204:207], a[184:187], v[84:87]
    buffer_load_dwordx4 a[44:47], v28, s[20:23], s46 offen offset:3072 sc1
    v_mfma_f32_16x16x32_bf16 v[84:87], a[200:203], a[168:171], v[84:87]
    v_med3_u32 v21, v20, v21, v37
    v_max_u32 v20, v20, v37
    v_mfma_f32_16x16x32_bf16 v[76:79], a[200:203], a[164:167], v[76:79]
    ds_read_b64_tr_b16 a[196:197], v11 offset:12288
    v_med3_u32 v21, v20, v21, v38
    v_mfma_f32_16x16x32_bf16 v[76:79], a[204:207], a[180:183], v[76:79]
    ds_read_b64_tr_b16 a[198:199], v11 offset:18432
    v_max_u32 v20, v20, v38
    v_mfma_f32_16x16x32_bf16 v[68:71], a[204:207], a[176:179], v[68:71]
    v_med3_u32 v21, v20, v21, v39
    v_max_u32 v20, v20, v39
    v_mfma_f32_16x16x32_bf16 v[68:71], a[200:203], a[160:163], v[68:71]
    s_waitcnt lgkmcnt(4)
    v_and_b32 v22, 1, v1
    v_cmp_eq_u32 vcc, 1, v22
    v_mfma_f32_16x16x32_bf16 v[96:99], a[208:211], a[160:163], v[96:99]
    s_add_u32 m0, s49, 98304
    ds_read_b64_tr_b16 a[200:201], v8 offset:1024
    v_readfirstlane_b32 s70, v20
    v_mfma_f32_16x16x32_bf16 v[96:99], a[212:215], a[176:179], v[96:99]
    ds_read_b64_tr_b16 a[202:203], v8 offset:7168
    v_readfirstlane_b32 s71, v21
    v_mfma_f32_16x16x32_bf16 v[104:107], a[212:215], a[180:183], v[104:107]
    buffer_load_dwordx4 v2, s[8:11], s36 offen offset:0 lds
    v_mfma_f32_16x16x32_bf16 v[104:107], a[208:211], a[164:167], v[104:107]
    v_cndmask_b32 v22, v20, v21, vcc
    v_and_b32 v22, 0x7ff, v22
    v_mfma_f32_16x16x32_bf16 v[112:115], a[208:211], a[168:171], v[112:115]
    ds_read_b64_tr_b16 a[204:205], v8 offset:13312
    v_sub_u32 v22, 2047, v22
    v_mfma_f32_16x16x32_bf16 v[112:115], a[212:215], a[184:187], v[112:115]
    s_add_u32 m0, s49, 99200
    ds_read_b64_tr_b16 a[206:207], v8 offset:19456
    v_mul_u32_u24 v23, 1280, v22
    v_mfma_f32_16x16x32_bf16 v[120:123], a[212:215], a[188:191], v[120:123]
    buffer_load_dwordx4 v2, s[8:11], s36 offen offset:128 lds
    v_mfma_f32_16x16x32_bf16 v[120:123], a[208:211], a[172:175], v[120:123]
    s_waitcnt lgkmcnt(4)
    v_lshrrev_b32 v24, 4, v1
    v_lshl_add_u32 v23, v24, 4, v23
    v_mfma_f32_16x16x32_bf16 v[124:127], a[192:195], a[172:175], v[124:127]
    ds_read_b64_tr_b16 a[208:209], v9 offset:1024
    v_add_u32 v23, s61, v23
    v_mfma_f32_16x16x32_bf16 v[124:127], a[196:199], a[188:191], v[124:127]
    ds_read_b64_tr_b16 a[210:211], v9 offset:7168
    v_lshlrev_b32 v24, 3, v22
    v_mfma_f32_16x16x32_bf16 v[116:119], a[196:199], a[184:187], v[116:119]
    s_mov_b32 s56, 3211264
    v_accvgpr_write_b32 a130, 1.0
    v_accvgpr_write_b32 a131, 1.0
    v_mfma_f32_16x16x32_bf16 v[116:119], a[192:195], a[168:171], v[116:119]
    v_accvgpr_write_b32 a132, 1.0
    v_accvgpr_write_b32 a133, 1.0
    v_mfma_f32_16x16x32_bf16 v[108:111], a[192:195], a[164:167], v[108:111]
    s_add_u32 m0, s49, 100096
    ds_read_b64_tr_b16 a[212:213], v9 offset:13312
    v_accvgpr_write_b32 a134, 1.0
    v_mfma_f32_16x16x32_bf16 v[108:111], a[196:199], a[180:183], v[108:111]
    ds_read_b64_tr_b16 a[214:215], v9 offset:19456
    v_accvgpr_write_b32 a135, 1.0
    v_mfma_f32_16x16x32_bf16 v[100:103], a[196:199], a[176:179], v[100:103]
    buffer_load_dwordx4 v2, s[8:11], s36 offen offset:256 lds
    v_mfma_f32_16x16x32_bf16 v[100:103], a[192:195], a[160:163], v[100:103]
    s_waitcnt lgkmcnt(4)
    v_accvgpr_write_b32 a136, 1.0
    v_accvgpr_write_b32 a137, 1.0
    v_mfma_f32_16x16x32_bf16 v[128:131], a[200:203], a[160:163], v[128:131]
    ds_read_b64_tr_b16 a[192:193], v10 offset:1024
    v_accvgpr_write_b32 a138, 1.0
    v_mfma_f32_16x16x32_bf16 v[128:131], a[204:207], a[176:179], v[128:131]
    ds_read_b64_tr_b16 a[194:195], v10 offset:7168
    v_accvgpr_write_b32 a139, 1.0
    v_mfma_f32_16x16x32_bf16 v[136:139], a[204:207], a[180:183], v[136:139]
    s_add_u32 m0, s49, 101376
    v_accvgpr_write_b32 a140, 1.0
    v_accvgpr_write_b32 a141, 1.0
    v_mfma_f32_16x16x32_bf16 v[136:139], a[200:203], a[164:167], v[136:139]
    buffer_load_dwordx4 v3, s[8:11], s36 offen offset:0 lds
    v_mfma_f32_16x16x32_bf16 v[144:147], a[200:203], a[168:171], v[144:147]
    ds_read_b64_tr_b16 a[196:197], v10 offset:13312
    v_accvgpr_write_b32 a142, 1.0
    v_mfma_f32_16x16x32_bf16 v[144:147], a[204:207], a[184:187], v[144:147]
    ds_read_b64_tr_b16 a[198:199], v10 offset:19456
    v_accvgpr_write_b32 a143, 1.0
    v_mfma_f32_16x16x32_bf16 v[152:155], a[204:207], a[188:191], v[152:155]
    v_accvgpr_write_b32 a144, 1.0
    v_accvgpr_write_b32 a145, 1.0
    v_mfma_f32_16x16x32_bf16 v[152:155], a[200:203], a[172:175], v[152:155]
    s_waitcnt lgkmcnt(4)
    v_accvgpr_write_b32 a146, 1.0
    v_accvgpr_write_b32 a147, 1.0
    v_mfma_f32_16x16x32_bf16 v[156:159], a[208:211], a[172:175], v[156:159]
    ds_read_b64_tr_b16 a[200:201], v11 offset:1024
    v_accvgpr_write_b32 a148, 1.0
    v_mfma_f32_16x16x32_bf16 v[156:159], a[212:215], a[188:191], v[156:159]
    s_add_u32 m0, s49, 102272
    ds_read_b64_tr_b16 a[202:203], v11 offset:7168
    v_accvgpr_write_b32 a149, 1.0
    v_mfma_f32_16x16x32_bf16 v[148:151], a[212:215], a[184:187], v[148:151]
    buffer_load_dwordx4 v3, s[8:11], s36 offen offset:128 lds
    v_mfma_f32_16x16x32_bf16 v[148:151], a[208:211], a[168:171], v[148:151]
    v_accvgpr_write_b32 a150, 1.0
    v_accvgpr_write_b32 a151, 1.0
    v_mfma_f32_16x16x32_bf16 v[140:143], a[208:211], a[164:167], v[140:143]
    ds_read_b64_tr_b16 a[204:205], v11 offset:13312
    v_accvgpr_write_b32 a152, 1.0
    v_mfma_f32_16x16x32_bf16 v[140:143], a[212:215], a[180:183], v[140:143]
    ds_read_b64_tr_b16 a[206:207], v11 offset:19456
    v_accvgpr_write_b32 a153, 1.0
    v_mfma_f32_16x16x32_bf16 v[132:135], a[212:215], a[176:179], v[132:135]
    v_accvgpr_write_b32 a154, 1.0
    v_accvgpr_write_b32 a155, 1.0
    v_mfma_f32_16x16x32_bf16 v[132:135], a[208:211], a[160:163], v[132:135]
    s_waitcnt lgkmcnt(4)
    v_accvgpr_write_b32 a156, 1.0
    v_accvgpr_write_b32 a157, 1.0
    v_mfma_f32_16x16x32_bf16 v[160:163], a[192:195], a[160:163], v[160:163]
    s_add_u32 m0, s49, 103168
    ds_read_b64_tr_b16 a[208:209], v8 offset:2048
    v_accvgpr_write_b32 a158, 1.0
    v_mfma_f32_16x16x32_bf16 v[160:163], a[196:199], a[176:179], v[160:163]
    ds_read_b64_tr_b16 a[210:211], v8 offset:8192
    v_accvgpr_write_b32 a159, 1.0
    v_mfma_f32_16x16x32_bf16 v[168:171], a[196:199], a[180:183], v[168:171]
    buffer_load_dwordx4 v3, s[8:11], s36 offen offset:256 lds
    v_mfma_f32_16x16x32_bf16 v[168:171], a[192:195], a[164:167], v[168:171]
    s_add_u32 s36, s36, s37
    s_sub_u32 s55, s36, 7864320
    s_min_u32 s36, s36, s55
    v_mfma_f32_16x16x32_bf16 v[176:179], a[192:195], a[168:171], v[176:179]
    s_add_u32 s46, s45, 61440
    ds_read_b64_tr_b16 a[212:213], v8 offset:14336
    s_sub_u32 s77, s46, 81920
    v_mfma_f32_16x16x32_bf16 v[176:179], a[196:199], a[184:187], v[176:179]
    s_min_u32 s46, s46, s77
    ds_read_b64_tr_b16 a[214:215], v8 offset:20480
    v_mfma_f32_16x16x32_bf16 v[184:187], a[196:199], a[188:191], v[184:187]
    v_add_u32 v8, 49152, v12
    v_mfma_f32_16x16x32_bf16 v[184:187], a[192:195], a[172:175], v[184:187]
    s_waitcnt lgkmcnt(4)
    v_mfma_f32_16x16x32_bf16 v[188:191], a[200:203], a[172:175], v[188:191]
    ds_read_b64_tr_b16 a[192:193], v9 offset:2048
    v_mfma_f32_16x16x32_bf16 v[188:191], a[204:207], a[188:191], v[188:191]
    ds_read_b64_tr_b16 a[194:195], v9 offset:8192
    v_mfma_f32_16x16x32_bf16 v[180:183], a[204:207], a[184:187], v[180:183]
    buffer_load_dwordx4 a[48:51], v28, s[20:23], s46 offen offset:0 sc1
    v_mfma_f32_16x16x32_bf16 v[180:183], a[200:203], a[168:171], v[180:183]
    v_mfma_f32_16x16x32_bf16 v[172:175], a[200:203], a[164:167], v[172:175]
    ds_read_b64_tr_b16 a[196:197], v9 offset:14336
    v_mfma_f32_16x16x32_bf16 v[172:175], a[204:207], a[180:183], v[172:175]
    ds_read_b64_tr_b16 a[198:199], v9 offset:20480
    v_mfma_f32_16x16x32_bf16 v[164:167], a[204:207], a[176:179], v[164:167]
    buffer_load_dwordx4 a[52:55], v28, s[20:23], s46 offen offset:1024 sc1
    v_mfma_f32_16x16x32_bf16 v[164:167], a[200:203], a[160:163], v[164:167]
    s_waitcnt lgkmcnt(4)
    v_add_u32 v9, 49152, v13
    v_mfma_f32_16x16x32_bf16 v[192:195], a[208:211], a[160:163], v[192:195]
    ds_read_b64_tr_b16 a[200:201], v10 offset:2048
    v_mfma_f32_16x16x32_bf16 v[192:195], a[212:215], a[176:179], v[192:195]
    ds_read_b64_tr_b16 a[202:203], v10 offset:8192
    v_mfma_f32_16x16x32_bf16 v[200:203], a[212:215], a[180:183], v[200:203]
    v_mfma_f32_16x16x32_bf16 v[200:203], a[208:211], a[164:167], v[200:203]
    v_mfma_f32_16x16x32_bf16 v[208:211], a[208:211], a[168:171], v[208:211]
    ds_read_b64_tr_b16 a[204:205], v10 offset:14336
    v_mfma_f32_16x16x32_bf16 v[208:211], a[212:215], a[184:187], v[208:211]
    ds_read_b64_tr_b16 a[206:207], v10 offset:20480
    v_mfma_f32_16x16x32_bf16 v[216:219], a[212:215], a[188:191], v[216:219]
    buffer_load_dwordx4 a[56:59], v28, s[20:23], s46 offen offset:2048 sc1
    v_mfma_f32_16x16x32_bf16 v[216:219], a[208:211], a[172:175], v[216:219]
    s_waitcnt lgkmcnt(4)
    v_add_u32 v10, 49152, v14
    v_mfma_f32_16x16x32_bf16 v[220:223], a[192:195], a[172:175], v[220:223]
    ds_read_b64_tr_b16 a[208:209], v11 offset:2048
    v_mfma_f32_16x16x32_bf16 v[220:223], a[196:199], a[188:191], v[220:223]
    ds_read_b64_tr_b16 a[210:211], v11 offset:8192
    v_mfma_f32_16x16x32_bf16 v[212:215], a[196:199], a[184:187], v[212:215]
    buffer_load_dwordx4 a[60:63], v28, s[20:23], s46 offen offset:3072 sc1
    v_mfma_f32_16x16x32_bf16 v[212:215], a[192:195], a[168:171], v[212:215]
    v_mfma_f32_16x16x32_bf16 v[204:207], a[192:195], a[164:167], v[204:207]
    ds_read_b64_tr_b16 a[212:213], v11 offset:14336
    v_mfma_f32_16x16x32_bf16 v[204:207], a[196:199], a[180:183], v[204:207]
    s_waitcnt vmcnt(32)
    ds_read_b64_tr_b16 a[214:215], v11 offset:20480
    v_mfma_f32_16x16x32_bf16 v[196:199], a[196:199], a[176:179], v[196:199]
    s_barrier
    v_mfma_f32_16x16x32_bf16 v[196:199], a[192:195], a[160:163], v[196:199]
    s_waitcnt lgkmcnt(4)
    global_load_dwordx4 v[48:51], v23, s[64:65]
    v_mfma_f32_16x16x32_bf16 v[224:227], a[200:203], a[160:163], v[224:227]
    ds_read_b64_tr_b16 a[192:193], v8 offset:0
    v_add_u32 v11, 49152, v15
    v_mfma_f32_16x16x32_bf16 v[224:227], a[204:207], a[176:179], v[224:227]
    s_add_u32 m0, s44, 147456
    ds_read_b64_tr_b16 a[194:195], v8 offset:6144
    v_mfma_f32_16x16x32_bf16 v[232:235], a[204:207], a[180:183], v[232:235]
pg_3:
    s_cbranch_execz pg_7
    global_load_dwordx4 v[52:55], v23, s[64:65] offset:64
    v_mfma_f32_16x16x32_bf16 v[232:235], a[200:203], a[164:167], v[232:235]
    buffer_load_dwordx2 v[40:41], v24, s[24:27], s56 offen sc1
    v_mfma_f32_16x16x32_bf16 v[240:243], a[200:203], a[168:171], v[240:243]
    ds_read_b64_tr_b16 a[196:197], v8 offset:12288
    v_bfe_u32 v26, v1, 2, 3
    v_mfma_f32_16x16x32_bf16 v[240:243], a[204:207], a[184:187], v[240:243]
    ds_read_b64_tr_b16 a[198:199], v8 offset:18432
    v_lshlrev_b32 v25, 7, v26
    v_mfma_f32_16x16x32_bf16 v[248:251], a[204:207], a[188:191], v[248:251]
    buffer_load_dword v61, v60, s[24:27], s47 offen offset:12 sc1
    v_mfma_f32_16x16x32_bf16 v[248:251], a[200:203], a[172:175], v[248:251]
    s_waitcnt lgkmcnt(4)
    buffer_load_dwordx4 v56, s[28:31], s60 offen lds
    v_mfma_f32_16x16x32_bf16 v[252:255], a[208:211], a[172:175], v[252:255]
    s_add_u32 m0, s44, 148480
    ds_read_b64_tr_b16 a[200:201], v9 offset:0
    v_lshrrev_b32 v26, 1, v26
    v_mfma_f32_16x16x32_bf16 v[252:255], a[212:215], a[188:191], v[252:255]
    ds_read_b64_tr_b16 a[202:203], v9 offset:6144
    v_xor_b32 v26, s3, v26
    v_mfma_f32_16x16x32_bf16 v[244:247], a[212:215], a[184:187], v[244:247]
    buffer_load_dwordx4 v56, s[32:35], s60 offen lds
    v_mfma_f32_16x16x32_bf16 v[244:247], a[208:211], a[168:171], v[244:247]
    s_add_u32 m0, s44, 149504
    v_lshl_add_u32 v25, v26, 5, v25
    v_and_b32 v26, 3, v1
    v_mfma_f32_16x16x32_bf16 v[236:239], a[208:211], a[164:167], v[236:239]
    ds_read_b64_tr_b16 a[204:205], v9 offset:12288
    v_lshl_add_u32 v25, v26, 3, v25
    v_mfma_f32_16x16x32_bf16 v[236:239], a[212:215], a[180:183], v[236:239]
    s_waitcnt vmcnt(30)
    s_waitcnt vmcnt(20)
    ds_read_b64_tr_b16 a[206:207], v9 offset:18432
    v_mfma_f32_16x16x32_bf16 v[228:231], a[212:215], a[176:179], v[228:231]
    buffer_load_dwordx4 v57, s[28:31], s60 offen lds
    v_mfma_f32_16x16x32_bf16 v[228:231], a[208:211], a[160:163], v[228:231]
    s_waitcnt lgkmcnt(4)
    v_lshrrev_b32 v26, 5, v1
    v_mul_u32_u24 v26, 2048, v26
    v_mfma_f32_16x16x32_bf16 v[64:67], a[192:195], a[0:3], v[64:67]
    s_add_u32 m0, s44, 150528
    ds_read_b64_tr_b16 a[208:209], v10 offset:0
    v_add_u32 v25, v25, v26
    v_mfma_f32_16x16x32_bf16 v[64:67], a[196:199], a[16:19], v[64:67]
    ds_read_b64_tr_b16 a[210:211], v10 offset:6144
    v_add_u32 v25, 147456, v25
    v_mfma_f32_16x16x32_bf16 v[72:75], a[196:199], a[20:23], v[72:75]
    buffer_load_dwordx4 v57, s[32:35], s60 offen lds
    v_mfma_f32_16x16x32_bf16 v[72:75], a[192:195], a[4:7], v[72:75]
    v_lshlrev_b32 v26, 4, v1
    v_cmp_gt_u32 vcc, 16, v1
    v_mfma_f32_16x16x32_bf16 v[80:83], a[192:195], a[8:11], v[80:83]
    ds_read_b64_tr_b16 a[212:213], v10 offset:12288
    v_mov_b32 v27, 0x7ffffff0
    v_mfma_f32_16x16x32_bf16 v[80:83], a[196:199], a[24:27], v[80:83]
    ds_read_b64_tr_b16 a[214:215], v10 offset:18432
    v_cndmask_b32 v26, v27, v26, vcc
    v_mfma_f32_16x16x32_bf16 v[88:91], a[196:199], a[28:31], v[88:91]
    v_accvgpr_write_b32 a160, 1.0
    v_mfma_f32_16x16x32_bf16 v[88:91], a[192:195], a[12:15], v[88:91]
    s_waitcnt lgkmcnt(4)
    v_accvgpr_write_b32 a161, 1.0
    v_mfma_f32_16x16x32_bf16 v[92:95], a[200:203], a[12:15], v[92:95]
    s_add_u32 s46, s45, 65536
    ds_read_b64_tr_b16 a[192:193], v11 offset:0
    v_accvgpr_write_b32 a162, 1.0
    v_mfma_f32_16x16x32_bf16 v[92:95], a[204:207], a[28:31], v[92:95]
    s_sub_u32 s77, s46, 81920
    ds_read_b64_tr_b16 a[194:195], v11 offset:6144
    v_accvgpr_write_b32 a163, 1.0
    v_mfma_f32_16x16x32_bf16 v[84:87], a[204:207], a[24:27], v[84:87]
    s_min_u32 s46, s46, s77
    v_accvgpr_write_b32 a164, 1.0
    v_mfma_f32_16x16x32_bf16 v[84:87], a[200:203], a[8:11], v[84:87]
    buffer_load_dwordx4 a[64:67], v28, s[20:23], s46 offen offset:0 sc1
    v_mfma_f32_16x16x32_bf16 v[76:79], a[200:203], a[4:7], v[76:79]
    ds_read_b64_tr_b16 a[196:197], v11 offset:12288
    v_accvgpr_write_b32 a165, 1.0
    v_mfma_f32_16x16x32_bf16 v[76:79], a[204:207], a[20:23], v[76:79]
    ds_read_b64_tr_b16 a[198:199], v11 offset:18432
    v_accvgpr_write_b32 a166, 1.0
    v_mfma_f32_16x16x32_bf16 v[68:71], a[204:207], a[16:19], v[68:71]
    v_accvgpr_write_b32 a167, 1.0
    v_mfma_f32_16x16x32_bf16 v[68:71], a[200:203], a[0:3], v[68:71]
    s_waitcnt lgkmcnt(4)
    v_accvgpr_write_b32 a168, 1.0
    v_mfma_f32_16x16x32_bf16 v[96:99], a[208:211], a[0:3], v[96:99]
    ds_read_b64_tr_b16 a[200:201], v8 offset:1024
    v_accvgpr_write_b32 a169, 1.0
    v_mfma_f32_16x16x32_bf16 v[96:99], a[212:215], a[16:19], v[96:99]
    ds_read_b64_tr_b16 a[202:203], v8 offset:7168
    v_accvgpr_write_b32 a170, 1.0
    v_mfma_f32_16x16x32_bf16 v[104:107], a[212:215], a[20:23], v[104:107]
    buffer_load_dwordx4 a[68:71], v28, s[20:23], s46 offen offset:1024 sc1
    v_mfma_f32_16x16x32_bf16 v[104:107], a[208:211], a[4:7], v[104:107]
    v_accvgpr_write_b32 a171, 1.0
    v_accvgpr_write_b32 a172, 1.0
    v_mfma_f32_16x16x32_bf16 v[112:115], a[208:211], a[8:11], v[112:115]
    ds_read_b64_tr_b16 a[204:205], v8 offset:13312
    v_accvgpr_write_b32 a173, 1.0
    v_mfma_f32_16x16x32_bf16 v[112:115], a[212:215], a[24:27], v[112:115]
    ds_read_b64_tr_b16 a[206:207], v8 offset:19456
    v_accvgpr_write_b32 a174, 1.0
    v_mfma_f32_16x16x32_bf16 v[120:123], a[212:215], a[28:31], v[120:123]
    v_accvgpr_write_b32 a175, 1.0
    v_accvgpr_write_b32 a176, 1.0
    v_mfma_f32_16x16x32_bf16 v[120:123], a[208:211], a[12:15], v[120:123]
    s_waitcnt lgkmcnt(4)
    v_accvgpr_write_b32 a177, 1.0
    v_accvgpr_write_b32 a178, 1.0
    v_mfma_f32_16x16x32_bf16 v[124:127], a[192:195], a[12:15], v[124:127]
    ds_read_b64_tr_b16 a[208:209], v9 offset:1024
    v_accvgpr_write_b32 a179, 1.0
    v_mfma_f32_16x16x32_bf16 v[124:127], a[196:199], a[28:31], v[124:127]
    ds_read_b64_tr_b16 a[210:211], v9 offset:7168
    v_accvgpr_write_b32 a180, 1.0
    v_mfma_f32_16x16x32_bf16 v[116:119], a[196:199], a[24:27], v[116:119]
    buffer_load_dwordx4 a[72:75], v28, s[20:23], s46 offen offset:2048 sc1
    v_mfma_f32_16x16x32_bf16 v[116:119], a[192:195], a[8:11], v[116:119]
    v_accvgpr_write_b32 a181, 1.0
    v_accvgpr_write_b32 a182, 1.0
    v_mfma_f32_16x16x32_bf16 v[108:111], a[192:195], a[4:7], v[108:111]
    ds_read_b64_tr_b16 a[212:213], v9 offset:13312
    v_accvgpr_write_b32 a183, 1.0
    v_mfma_f32_16x16x32_bf16 v[108:111], a[196:199], a[20:23], v[108:111]
    ds_read_b64_tr_b16 a[214:215], v9 offset:19456
    v_accvgpr_write_b32 a184, 1.0
    v_mfma_f32_16x16x32_bf16 v[100:103], a[196:199], a[16:19], v[100:103]
    buffer_load_dwordx4 a[76:79], v28, s[20:23], s46 offen offset:3072 sc1
    v_mfma_f32_16x16x32_bf16 v[100:103], a[192:195], a[0:3], v[100:103]
    s_waitcnt lgkmcnt(4)
    v_accvgpr_write_b32 a185, 1.0
    v_accvgpr_write_b32 a186, 1.0
    v_mfma_f32_16x16x32_bf16 v[128:131], a[200:203], a[0:3], v[128:131]
    ds_read_b64_tr_b16 a[192:193], v10 offset:1024
    v_accvgpr_write_b32 a187, 1.0
    v_mfma_f32_16x16x32_bf16 v[128:131], a[204:207], a[16:19], v[128:131]
    ds_read_b64_tr_b16 a[194:195], v10 offset:7168
    v_accvgpr_write_b32 a188, 1.0
    v_mfma_f32_16x16x32_bf16 v[136:139], a[204:207], a[20:23], v[136:139]
    v_accvgpr_write_b32 a189, 1.0
    v_accvgpr_write_b32 a190, 1.0
    v_mfma_f32_16x16x32_bf16 v[136:139], a[200:203], a[4:7], v[136:139]
    v_accvgpr_write_b32 a191, 1.0
    v_mfma_f32_16x16x32_bf16 v[144:147], a[200:203], a[8:11], v[144:147]
    s_add_u32 m0, s49, 122880
    ds_read_b64_tr_b16 a[196:197], v10 offset:13312
    v_mfma_f32_16x16x32_bf16 v[144:147], a[204:207], a[24:27], v[144:147]
    ds_read_b64_tr_b16 a[198:199], v10 offset:19456
    v_mfma_f32_16x16x32_bf16 v[152:155], a[204:207], a[28:31], v[152:155]
    buffer_load_dwordx4 v2, s[8:11], s36 offen offset:0 lds
    v_mfma_f32_16x16x32_bf16 v[152:155], a[200:203], a[12:15], v[152:155]
    s_waitcnt lgkmcnt(4)
    v_mfma_f32_16x16x32_bf16 v[156:159], a[208:211], a[12:15], v[156:159]
    ds_read_b64_tr_b16 a[200:201], v11 offset:1024
    v_mfma_f32_16x16x32_bf16 v[156:159], a[212:215], a[28:31], v[156:159]
    ds_read_b64_tr_b16 a[202:203], v11 offset:7168
    v_mfma_f32_16x16x32_bf16 v[148:151], a[212:215], a[24:27], v[148:151]
    s_add_u32 m0, s49, 123776
    v_mfma_f32_16x16x32_bf16 v[148:151], a[208:211], a[8:11], v[148:151]
    buffer_load_dwordx4 v2, s[8:11], s36 offen offset:128 lds
    v_mfma_f32_16x16x32_bf16 v[140:143], a[208:211], a[4:7], v[140:143]
    ds_read_b64_tr_b16 a[204:205], v11 offset:13312
    v_mfma_f32_16x16x32_bf16 v[140:143], a[212:215], a[20:23], v[140:143]
    ds_read_b64_tr_b16 a[206:207], v11 offset:19456
    v_mfma_f32_16x16x32_bf16 v[132:135], a[212:215], a[16:19], v[132:135]
    v_mfma_f32_16x16x32_bf16 v[132:135], a[208:211], a[0:3], v[132:135]
    s_waitcnt lgkmcnt(4)
    v_mfma_f32_16x16x32_bf16 v[160:163], a[192:195], a[0:3], v[160:163]
    ds_read_b64_tr_b16 a[208:209], v8 offset:2048
    v_mfma_f32_16x16x32_bf16 v[160:163], a[196:199], a[16:19], v[160:163]
    s_add_u32 m0, s49, 124672
    ds_read_b64_tr_b16 a[210:211], v8 offset:8192
    v_mfma_f32_16x16x32_bf16 v[168:171], a[196:199], a[20:23], v[168:171]
    buffer_load_dwordx4 v2, s[8:11], s36 offen offset:256 lds
    v_mfma_f32_16x16x32_bf16 v[168:171], a[192:195], a[4:7], v[168:171]
    v_mfma_f32_16x16x32_bf16 v[176:179], a[192:195], a[8:11], v[176:179]
    ds_read_b64_tr_b16 a[212:213], v8 offset:14336
    v_mfma_f32_16x16x32_bf16 v[176:179], a[196:199], a[24:27], v[176:179]
    ds_read_b64_tr_b16 a[214:215], v8 offset:20480
    v_mfma_f32_16x16x32_bf16 v[184:187], a[196:199], a[28:31], v[184:187]
    v_add_u32 v8, 73728, v12
    v_mfma_f32_16x16x32_bf16 v[184:187], a[192:195], a[12:15], v[184:187]
    s_waitcnt lgkmcnt(4)
    s_add_u32 m0, s49, 125952
    v_mfma_f32_16x16x32_bf16 v[188:191], a[200:203], a[12:15], v[188:191]
    ds_read_b64_tr_b16 a[192:193], v9 offset:2048
    v_mfma_f32_16x16x32_bf16 v[188:191], a[204:207], a[28:31], v[188:191]
    ds_read_b64_tr_b16 a[194:195], v9 offset:8192
    v_mfma_f32_16x16x32_bf16 v[180:183], a[204:207], a[24:27], v[180:183]
    buffer_load_dwordx4 v3, s[8:11], s36 offen offset:0 lds
    v_mfma_f32_16x16x32_bf16 v[180:183], a[200:203], a[8:11], v[180:183]
    v_mfma_f32_16x16x32_bf16 v[172:175], a[200:203], a[4:7], v[172:175]
    ds_read_b64_tr_b16 a[196:197], v9 offset:14336
    v_mfma_f32_16x16x32_bf16 v[172:175], a[204:207], a[20:23], v[172:175]
    ds_read_b64_tr_b16 a[198:199], v9 offset:20480
    v_mfma_f32_16x16x32_bf16 v[164:167], a[204:207], a[16:19], v[164:167]
    s_add_u32 m0, s49, 126848
    v_add_u32 v9, 73728, v13
    v_mfma_f32_16x16x32_bf16 v[164:167], a[200:203], a[0:3], v[164:167]
    s_waitcnt lgkmcnt(4)
    v_mfma_f32_16x16x32_bf16 v[192:195], a[208:211], a[0:3], v[192:195]
    ds_read_b64_tr_b16 a[200:201], v10 offset:2048
    v_mfma_f32_16x16x32_bf16 v[192:195], a[212:215], a[16:19], v[192:195]
    ds_read_b64_tr_b16 a[202:203], v10 offset:8192
    v_mfma_f32_16x16x32_bf16 v[200:203], a[212:215], a[20:23], v[200:203]
    buffer_load_dwordx4 v3, s[8:11], s36 offen offset:128 lds
    v_mfma_f32_16x16x32_bf16 v[200:203], a[208:211], a[4:7], v[200:203]
    v_mfma_f32_16x16x32_bf16 v[208:211], a[208:211], a[8:11], v[208:211]
    s_add_u32 m0, s49, 127744
    ds_read_b64_tr_b16 a[204:205], v10 offset:14336
    v_mfma_f32_16x16x32_bf16 v[208:211], a[212:215], a[24:27], v[208:211]
    ds_read_b64_tr_b16 a[206:207], v10 offset:20480
    v_mfma_f32_16x16x32_bf16 v[216:219], a[212:215], a[28:31], v[216:219]
    buffer_load_dwordx4 v3, s[8:11], s36 offen offset:256 lds
    v_mfma_f32_16x16x32_bf16 v[216:219], a[208:211], a[12:15], v[216:219]
    s_waitcnt lgkmcnt(4)
    v_add_u32 v10, 73728, v14
    s_add_u32 s36, s36, s37
    v_mfma_f32_16x16x32_bf16 v[220:223], a[192:195], a[12:15], v[220:223]
    s_sub_u32 s55, s36, 7864320
    ds_read_b64_tr_b16 a[208:209], v11 offset:2048
    s_min_u32 s36, s36, s55
    v_mfma_f32_16x16x32_bf16 v[220:223], a[196:199], a[28:31], v[220:223]
    s_add_u32 s46, s45, 69632
    ds_read_b64_tr_b16 a[210:211], v11 offset:8192
    s_sub_u32 s77, s46, 81920
    v_mfma_f32_16x16x32_bf16 v[212:215], a[196:199], a[24:27], v[212:215]
    s_min_u32 s46, s46, s77
    v_mfma_f32_16x16x32_bf16 v[212:215], a[192:195], a[8:11], v[212:215]
    v_mfma_f32_16x16x32_bf16 v[204:207], a[192:195], a[4:7], v[204:207]
    ds_read_b64_tr_b16 a[212:213], v11 offset:14336
    v_mfma_f32_16x16x32_bf16 v[204:207], a[196:199], a[20:23], v[204:207]
    s_waitcnt vmcnt(36)
    ds_read_b64_tr_b16 a[214:215], v11 offset:20480
    v_mfma_f32_16x16x32_bf16 v[196:199], a[196:199], a[16:19], v[196:199]
    s_barrier
    v_mfma_f32_16x16x32_bf16 v[196:199], a[192:195], a[0:3], v[196:199]
    s_waitcnt lgkmcnt(4)
    buffer_load_dwordx4 a[80:83], v28, s[20:23], s46 offen offset:0 sc1
    v_mfma_f32_16x16x32_bf16 v[224:227], a[200:203], a[0:3], v[224:227]
    ds_read_b64_tr_b16 a[192:193], v8 offset:0
    v_add_u32 v11, 73728, v15
    v_mfma_f32_16x16x32_bf16 v[224:227], a[204:207], a[16:19], v[224:227]
    ds_read_b64_tr_b16 a[194:195], v8 offset:6144
    v_mfma_f32_16x16x32_bf16 v[232:235], a[204:207], a[20:23], v[232:235]
    buffer_load_dwordx4 a[84:87], v28, s[20:23], s46 offen offset:1024 sc1
    v_mfma_f32_16x16x32_bf16 v[232:235], a[200:203], a[4:7], v[232:235]
    v_mfma_f32_16x16x32_bf16 v[240:243], a[200:203], a[8:11], v[240:243]
    ds_read_b64_tr_b16 a[196:197], v8 offset:12288
    v_mfma_f32_16x16x32_bf16 v[240:243], a[204:207], a[24:27], v[240:243]
    ds_read_b64_tr_b16 a[198:199], v8 offset:18432
    v_mfma_f32_16x16x32_bf16 v[248:251], a[204:207], a[28:31], v[248:251]
    v_mfma_f32_16x16x32_bf16 v[248:251], a[200:203], a[12:15], v[248:251]
    s_waitcnt lgkmcnt(4)
    v_mfma_f32_16x16x32_bf16 v[252:255], a[208:211], a[12:15], v[252:255]
    ds_read_b64_tr_b16 a[200:201], v9 offset:0
    v_mfma_f32_16x16x32_bf16 v[252:255], a[212:215], a[28:31], v[252:255]
    ds_read_b64_tr_b16 a[202:203], v9 offset:6144
    v_mfma_f32_16x16x32_bf16 v[244:247], a[212:215], a[24:27], v[244:247]
    buffer_load_dwordx4 a[88:91], v28, s[20:23], s46 offen offset:2048 sc1
    v_mfma_f32_16x16x32_bf16 v[244:247], a[208:211], a[8:11], v[244:247]
    v_mfma_f32_16x16x32_bf16 v[236:239], a[208:211], a[4:7], v[236:239]
    ds_read_b64_tr_b16 a[204:205], v9 offset:12288
    v_mfma_f32_16x16x32_bf16 v[236:239], a[212:215], a[20:23], v[236:239]
    s_waitcnt vmcnt(31)
    s_waitcnt vmcnt(21)
    ds_read_b64_tr_b16 a[206:207], v9 offset:18432
    v_mfma_f32_16x16x32_bf16 v[228:231], a[212:215], a[16:19], v[228:231]
    v_mfma_f32_16x16x32_bf16 v[228:231], a[208:211], a[0:3], v[228:231]
    s_waitcnt lgkmcnt(4)
    v_mfma_f32_16x16x32_bf16 v[64:67], a[192:195], a[32:35], v[64:67]
    ds_read_b64_tr_b16 a[208:209], v10 offset:0
    v_mfma_f32_16x16x32_bf16 v[64:67], a[196:199], a[48:51], v[64:67]
    ds_read_b64_tr_b16 a[210:211], v10 offset:6144
    v_accvgpr_write_b32 a0, 1.0
    v_mfma_f32_16x16x32_bf16 v[72:75], a[196:199], a[52:55], v[72:75]
    buffer_load_dwordx4 a[92:95], v28, s[20:23], s46 offen offset:3072 sc1
    v_mfma_f32_16x16x32_bf16 v[72:75], a[192:195], a[36:39], v[72:75]
    s_add_u32 s46, s45, 73728
    v_accvgpr_write_b32 a1, 1.0
    v_mfma_f32_16x16x32_bf16 v[80:83], a[192:195], a[40:43], v[80:83]
    s_sub_u32 s77, s46, 81920
    ds_read_b64_tr_b16 a[212:213], v10 offset:12288
    v_accvgpr_write_b32 a2, 1.0
    v_mfma_f32_16x16x32_bf16 v[80:83], a[196:199], a[56:59], v[80:83]
    s_min_u32 s46, s46, s77
    ds_read_b64_tr_b16 a[214:215], v10 offset:18432
    v_accvgpr_write_b32 a3, 1.0
    v_mfma_f32_16x16x32_bf16 v[88:91], a[196:199], a[60:63], v[88:91]
    buffer_load_dwordx4 a[224:227], v28, s[20:23], s46 offen offset:0 sc1
    v_mfma_f32_16x16x32_bf16 v[88:91], a[192:195], a[44:47], v[88:91]
    s_waitcnt lgkmcnt(4)
    v_accvgpr_write_b32 a4, 1.0
    v_mfma_f32_16x16x32_bf16 v[92:95], a[200:203], a[44:47], v[92:95]
    s_waitcnt vmcnt(20)
    ds_read_b64_tr_b16 a[192:193], v11 offset:0
    v_lshlrev_b32 v42, 16, v48
    v_mfma_f32_16x16x32_bf16 v[92:95], a[204:207], a[60:63], v[92:95]
    ds_read_b64_tr_b16 a[194:195], v11 offset:6144
    v_and_b32 v43, 0xffff0000, v48
    v_mfma_f32_16x16x32_bf16 v[84:87], a[204:207], a[56:59], v[84:87]
    v_sub_f32 v42, v42, v40
    v_sub_f32 v43, v43, v40
    v_mfma_f32_16x16x32_bf16 v[84:87], a[200:203], a[40:43], v[84:87]
    v_cvt_pk_bf16_f32 v44, v42, v43
    v_lshlrev_b32 v42, 16, v44
    v_mfma_f32_16x16x32_bf16 v[76:79], a[200:203], a[36:39], v[76:79]
    ds_read_b64_tr_b16 a[196:197], v11 offset:12288
    v_and_b32 v43, 0xffff0000, v44
    v_mfma_f32_16x16x32_bf16 v[76:79], a[204:207], a[52:55], v[76:79]
    ds_read_b64_tr_b16 a[198:199], v11 offset:18432
    v_mul_f32 v42, v42, v41
    v_mfma_f32_16x16x32_bf16 v[68:71], a[204:207], a[48:51], v[68:71]
    buffer_load_dwordx4 a[228:231], v28, s[20:23], s46 offen offset:1024 sc1
    v_mfma_f32_16x16x32_bf16 v[68:71], a[200:203], a[32:35], v[68:71]
    s_waitcnt lgkmcnt(4)
    v_mul_f32 v43, v43, v41
    v_cvt_pk_bf16_f32 v48, v42, v43
    v_mfma_f32_16x16x32_bf16 v[96:99], a[208:211], a[32:35], v[96:99]
    ds_read_b64_tr_b16 a[200:201], v8 offset:1024
    v_lshlrev_b32 v42, 16, v49
    v_mfma_f32_16x16x32_bf16 v[96:99], a[212:215], a[48:51], v[96:99]
    ds_read_b64_tr_b16 a[202:203], v8 offset:7168
    v_and_b32 v43, 0xffff0000, v49
    v_mfma_f32_16x16x32_bf16 v[104:107], a[212:215], a[52:55], v[104:107]
    s_waitcnt vmcnt(20)
    v_sub_f32 v42, v42, v40
    v_sub_f32 v43, v43, v40
    v_mfma_f32_16x16x32_bf16 v[104:107], a[208:211], a[36:39], v[104:107]
    buffer_load_dwordx4 a[232:235], v28, s[20:23], s46 offen offset:2048 sc1
    v_mfma_f32_16x16x32_bf16 v[112:115], a[208:211], a[40:43], v[112:115]
    ds_read_b64_tr_b16 a[204:205], v8 offset:13312
    v_cvt_pk_bf16_f32 v44, v42, v43
    v_mfma_f32_16x16x32_bf16 v[112:115], a[212:215], a[56:59], v[112:115]
    ds_read_b64_tr_b16 a[206:207], v8 offset:19456
    v_lshlrev_b32 v42, 16, v44
    v_mfma_f32_16x16x32_bf16 v[120:123], a[212:215], a[60:63], v[120:123]
    v_and_b32 v43, 0xffff0000, v44
    v_mul_f32 v42, v42, v41
    v_mfma_f32_16x16x32_bf16 v[120:123], a[208:211], a[44:47], v[120:123]
    s_waitcnt lgkmcnt(4)
    v_mul_f32 v43, v43, v41
    v_cvt_pk_bf16_f32 v49, v42, v43
    v_mfma_f32_16x16x32_bf16 v[124:127], a[192:195], a[44:47], v[124:127]
    ds_read_b64_tr_b16 a[208:209], v9 offset:1024
    v_lshlrev_b32 v42, 16, v50
    v_mfma_f32_16x16x32_bf16 v[124:127], a[196:199], a[60:63], v[124:127]
    ds_read_b64_tr_b16 a[210:211], v9 offset:7168
    v_and_b32 v43, 0xffff0000, v50
    v_mfma_f32_16x16x32_bf16 v[116:119], a[196:199], a[56:59], v[116:119]
    buffer_load_dwordx4 a[236:239], v28, s[20:23], s46 offen offset:3072 sc1
    v_mfma_f32_16x16x32_bf16 v[116:119], a[192:195], a[40:43], v[116:119]
    v_sub_f32 v42, v42, v40
    v_sub_f32 v43, v43, v40
    v_mfma_f32_16x16x32_bf16 v[108:111], a[192:195], a[36:39], v[108:111]
    s_add_u32 s46, s45, 77824
    ds_read_b64_tr_b16 a[212:213], v9 offset:13312
    v_cvt_pk_bf16_f32 v44, v42, v43
    v_mfma_f32_16x16x32_bf16 v[108:111], a[196:199], a[52:55], v[108:111]
    s_sub_u32 s77, s46, 81920
    ds_read_b64_tr_b16 a[214:215], v9 offset:19456
    v_lshlrev_b32 v42, 16, v44
    v_mfma_f32_16x16x32_bf16 v[100:103], a[196:199], a[48:51], v[100:103]
    s_min_u32 s46, s46, s77
    v_and_b32 v43, 0xffff0000, v44
    v_mul_f32 v42, v42, v41
    v_mfma_f32_16x16x32_bf16 v[100:103], a[192:195], a[32:35], v[100:103]
    s_waitcnt lgkmcnt(4)
    v_mul_f32 v43, v43, v41
    v_cvt_pk_bf16_f32 v50, v42, v43
    v_mfma_f32_16x16x32_bf16 v[128:131], a[200:203], a[32:35], v[128:131]
    ds_read_b64_tr_b16 a[192:193], v10 offset:1024
    v_lshlrev_b32 v42, 16, v51
    v_mfma_f32_16x16x32_bf16 v[128:131], a[204:207], a[48:51], v[128:131]
    ds_read_b64_tr_b16 a[194:195], v10 offset:7168
    v_and_b32 v43, 0xffff0000, v51
    v_mfma_f32_16x16x32_bf16 v[136:139], a[204:207], a[52:55], v[136:139]
    buffer_load_dwordx4 a[240:243], v28, s[20:23], s46 offen offset:0 sc1
    v_mfma_f32_16x16x32_bf16 v[136:139], a[200:203], a[36:39], v[136:139]
    v_sub_f32 v42, v42, v40
    v_sub_f32 v43, v43, v40
    v_mfma_f32_16x16x32_bf16 v[144:147], a[200:203], a[40:43], v[144:147]
    ds_read_b64_tr_b16 a[196:197], v10 offset:13312
    v_cvt_pk_bf16_f32 v44, v42, v43
    v_mfma_f32_16x16x32_bf16 v[144:147], a[204:207], a[56:59], v[144:147]
    ds_read_b64_tr_b16 a[198:199], v10 offset:19456
    v_lshlrev_b32 v42, 16, v44
    v_mfma_f32_16x16x32_bf16 v[152:155], a[204:207], a[60:63], v[152:155]
    buffer_load_dwordx4 a[244:247], v28, s[20:23], s46 offen offset:1024 sc1
    v_mfma_f32_16x16x32_bf16 v[152:155], a[200:203], a[44:47], v[152:155]
    s_waitcnt lgkmcnt(4)
    v_and_b32 v43, 0xffff0000, v44
    v_mul_f32 v42, v42, v41
    v_mfma_f32_16x16x32_bf16 v[156:159], a[208:211], a[44:47], v[156:159]
    ds_read_b64_tr_b16 a[200:201], v11 offset:1024
    v_mul_f32 v43, v43, v41
    v_mfma_f32_16x16x32_bf16 v[156:159], a[212:215], a[60:63], v[156:159]
    ds_read_b64_tr_b16 a[202:203], v11 offset:7168
    v_cvt_pk_bf16_f32 v51, v42, v43
    v_mfma_f32_16x16x32_bf16 v[148:151], a[212:215], a[56:59], v[148:151]
    v_lshlrev_b32 v42, 16, v52
    v_and_b32 v43, 0xffff0000, v52
    v_mfma_f32_16x16x32_bf16 v[148:151], a[208:211], a[40:43], v[148:151]
    v_sub_f32 v42, v42, v40
    v_sub_f32 v43, v43, v40
    v_mfma_f32_16x16x32_bf16 v[140:143], a[208:211], a[36:39], v[140:143]
    ds_read_b64_tr_b16 a[204:205], v11 offset:13312
    v_cvt_pk_bf16_f32 v44, v42, v43
    v_mfma_f32_16x16x32_bf16 v[140:143], a[212:215], a[52:55], v[140:143]
    ds_read_b64_tr_b16 a[206:207], v11 offset:19456
    v_lshlrev_b32 v42, 16, v44
    v_mfma_f32_16x16x32_bf16 v[132:135], a[212:215], a[48:51], v[132:135]
    buffer_load_dwordx4 a[248:251], v28, s[20:23], s46 offen offset:2048 sc1
    v_mfma_f32_16x16x32_bf16 v[132:135], a[208:211], a[32:35], v[132:135]
    s_waitcnt lgkmcnt(4)
    v_and_b32 v43, 0xffff0000, v44
    v_mul_f32 v42, v42, v41
    v_mfma_f32_16x16x32_bf16 v[160:163], a[192:195], a[32:35], v[160:163]
    ds_read_b64_tr_b16 a[208:209], v8 offset:2048
    v_mul_f32 v43, v43, v41
    v_mfma_f32_16x16x32_bf16 v[160:163], a[196:199], a[48:51], v[160:163]
    ds_read_b64_tr_b16 a[210:211], v8 offset:8192
    v_cvt_pk_bf16_f32 v52, v42, v43
    v_mfma_f32_16x16x32_bf16 v[168:171], a[196:199], a[52:55], v[168:171]
    v_lshlrev_b32 v42, 16, v53
    v_and_b32 v43, 0xffff0000, v53
    v_mfma_f32_16x16x32_bf16 v[168:171], a[192:195], a[36:39], v[168:171]
    buffer_load_dwordx4 a[252:255], v28, s[20:23], s46 offen offset:3072 sc1
    v_mfma_f32_16x16x32_bf16 v[176:179], a[192:195], a[40:43], v[176:179]
    ds_read_b64_tr_b16 a[212:213], v8 offset:14336
    v_sub_f32 v42, v42, v40
    v_mfma_f32_16x16x32_bf16 v[176:179], a[196:199], a[56:59], v[176:179]
    ds_read_b64_tr_b16 a[214:215], v8 offset:20480
    v_sub_f32 v43, v43, v40
    v_mfma_f32_16x16x32_bf16 v[184:187], a[196:199], a[60:63], v[184:187]
    v_cvt_pk_bf16_f32 v44, v42, v43
    v_lshlrev_b32 v42, 16, v44
    v_mfma_f32_16x16x32_bf16 v[184:187], a[192:195], a[44:47], v[184:187]
    s_waitcnt lgkmcnt(4)
    v_and_b32 v43, 0xffff0000, v44
    v_mul_f32 v42, v42, v41
    v_mfma_f32_16x16x32_bf16 v[188:191], a[200:203], a[44:47], v[188:191]
    ds_read_b64_tr_b16 a[192:193], v9 offset:2048
    v_mul_f32 v43, v43, v41
    v_mfma_f32_16x16x32_bf16 v[188:191], a[204:207], a[60:63], v[188:191]
    s_add_u32 m0, s49, 0
    ds_read_b64_tr_b16 a[194:195], v9 offset:8192
    v_cvt_pk_bf16_f32 v53, v42, v43
    v_mfma_f32_16x16x32_bf16 v[180:183], a[204:207], a[56:59], v[180:183]
    buffer_load_dwordx4 v4, s[12:15], s38 offen offset:0 lds
    v_mfma_f32_16x16x32_bf16 v[180:183], a[200:203], a[40:43], v[180:183]
    v_lshlrev_b32 v42, 16, v54
    v_and_b32 v43, 0xffff0000, v54
    v_mfma_f32_16x16x32_bf16 v[172:175], a[200:203], a[36:39], v[172:175]
    ds_read_b64_tr_b16 a[196:197], v9 offset:14336
    v_sub_f32 v42, v42, v40
    v_mfma_f32_16x16x32_bf16 v[172:175], a[204:207], a[52:55], v[172:175]
    ds_read_b64_tr_b16 a[198:199], v9 offset:20480
    v_sub_f32 v43, v43, v40
    v_mfma_f32_16x16x32_bf16 v[164:167], a[204:207], a[48:51], v[164:167]
    v_cvt_pk_bf16_f32 v44, v42, v43
    v_lshlrev_b32 v42, 16, v44
    v_mfma_f32_16x16x32_bf16 v[164:167], a[200:203], a[32:35], v[164:167]
    s_waitcnt lgkmcnt(4)
    v_and_b32 v43, 0xffff0000, v44
    v_mul_f32 v42, v42, v41
    v_mfma_f32_16x16x32_bf16 v[192:195], a[208:211], a[32:35], v[192:195]
    s_add_u32 m0, s49, 896
    ds_read_b64_tr_b16 a[200:201], v10 offset:2048
    v_mul_f32 v43, v43, v41
    v_mfma_f32_16x16x32_bf16 v[192:195], a[212:215], a[48:51], v[192:195]
    ds_read_b64_tr_b16 a[202:203], v10 offset:8192
    v_cvt_pk_bf16_f32 v54, v42, v43
    v_mfma_f32_16x16x32_bf16 v[200:203], a[212:215], a[52:55], v[200:203]
    buffer_load_dwordx4 v4, s[12:15], s38 offen offset:128 lds
    v_mfma_f32_16x16x32_bf16 v[200:203], a[208:211], a[36:39], v[200:203]
    v_lshlrev_b32 v42, 16, v55
    v_and_b32 v43, 0xffff0000, v55
    v_mfma_f32_16x16x32_bf16 v[208:211], a[208:211], a[40:43], v[208:211]
    ds_read_b64_tr_b16 a[204:205], v10 offset:14336
    v_sub_f32 v42, v42, v40
    v_mfma_f32_16x16x32_bf16 v[208:211], a[212:215], a[56:59], v[208:211]
    ds_read_b64_tr_b16 a[206:207], v10 offset:20480
    v_sub_f32 v43, v43, v40
    v_mfma_f32_16x16x32_bf16 v[216:219], a[212:215], a[60:63], v[216:219]
    s_add_u32 m0, s49, 1792
    v_cvt_pk_bf16_f32 v44, v42, v43
    v_lshlrev_b32 v42, 16, v44
    v_mfma_f32_16x16x32_bf16 v[216:219], a[208:211], a[44:47], v[216:219]
    s_waitcnt lgkmcnt(4)
    v_and_b32 v43, 0xffff0000, v44
    v_mul_f32 v42, v42, v41
    v_mfma_f32_16x16x32_bf16 v[220:223], a[192:195], a[44:47], v[220:223]
    ds_read_b64_tr_b16 a[208:209], v11 offset:2048
    v_mul_f32 v43, v43, v41
    v_mfma_f32_16x16x32_bf16 v[220:223], a[196:199], a[60:63], v[220:223]
    ds_read_b64_tr_b16 a[210:211], v11 offset:8192
    v_cvt_pk_bf16_f32 v55, v42, v43
    v_mfma_f32_16x16x32_bf16 v[212:215], a[196:199], a[56:59], v[212:215]
    buffer_load_dwordx4 v4, s[12:15], s38 offen offset:256 lds
    v_mfma_f32_16x16x32_bf16 v[212:215], a[192:195], a[40:43], v[212:215]
    v_lshrrev_b32 v60, 14, v61
    v_and_b32 v61, 0x2000, v61
    v_mfma_f32_16x16x32_bf16 v[204:207], a[192:195], a[36:39], v[204:207]
    s_add_u32 m0, s49, 3072
    ds_read_b64_tr_b16 a[212:213], v11 offset:14336
    v_cmp_ne_u32 s[88:89], 0, v60
    v_mfma_f32_16x16x32_bf16 v[204:207], a[196:199], a[52:55], v[204:207]
    s_waitcnt vmcnt(25)
    ds_read_b64_tr_b16 a[214:215], v11 offset:20480
    v_accvgpr_write_b32 a5, 1.0
    v_mfma_f32_16x16x32_bf16 v[196:199], a[196:199], a[48:51], v[196:199]
    s_barrier
    v_mfma_f32_16x16x32_bf16 v[196:199], a[192:195], a[32:35], v[196:199]
    s_waitcnt lgkmcnt(4)
    buffer_load_dwordx4 v5, s[12:15], s38 offen offset:0 lds
    v_add_u32 v8, 98304, v12
    v_mfma_f32_16x16x32_bf16 v[224:227], a[200:203], a[32:35], v[224:227]
    s_lshr_b64 s[88:89], s[88:89], 12
    ds_read_b64_tr_b16 a[192:193], v8 offset:0
    v_accvgpr_write_b32 a6, 1.0
    v_mfma_f32_16x16x32_bf16 v[224:227], a[204:207], a[48:51], v[224:227]
    s_bcnt1_i32_b64 s93, s[88:89]
    ds_read_b64_tr_b16 a[194:195], v8 offset:6144
    v_cmp_ne_u32 s[88:89], 0, v61
    v_mfma_f32_16x16x32_bf16 v[232:235], a[204:207], a[52:55], v[232:235]
    s_cmp_gt_u32 s93, 26
    s_cselect_b32 s93, -1, 0
    v_accvgpr_write_b32 a7, 1.0
    v_mfma_f32_16x16x32_bf16 v[232:235], a[200:203], a[36:39], v[232:235]
    s_add_u32 m0, s49, 3968
    v_accvgpr_write_b32 a8, 1.0
    v_accvgpr_write_b32 a9, 1.0
    v_mfma_f32_16x16x32_bf16 v[240:243], a[200:203], a[40:43], v[240:243]
    s_xor_b32 s88, s88, s93
    ds_read_b64_tr_b16 a[196:197], v8 offset:12288
    v_accvgpr_write_b32 a10, 1.0
    v_mfma_f32_16x16x32_bf16 v[240:243], a[204:207], a[56:59], v[240:243]
    s_and_b32 s88, s88, 0xfff
    ds_read_b64_tr_b16 a[198:199], v8 offset:18432
    v_accvgpr_write_b32 a11, 1.0
    v_mfma_f32_16x16x32_bf16 v[248:251], a[204:207], a[60:63], v[248:251]
    buffer_load_dwordx4 v5, s[12:15], s38 offen offset:128 lds
    v_mfma_f32_16x16x32_bf16 v[248:251], a[200:203], a[44:47], v[248:251]
    s_waitcnt lgkmcnt(4)
    v_accvgpr_write_b32 a12, 1.0
    v_accvgpr_write_b32 a13, 1.0
    v_add_u32 v9, 98304, v13
    v_mfma_f32_16x16x32_bf16 v[252:255], a[208:211], a[44:47], v[252:255]
    s_lshl_b32 s93, s88, 13
    ds_read_b64_tr_b16 a[200:201], v9 offset:0
    v_accvgpr_write_b32 a14, 1.0
    v_mfma_f32_16x16x32_bf16 v[252:255], a[212:215], a[60:63], v[252:255]
    s_add_u32 m0, s49, 4864
    ds_read_b64_tr_b16 a[202:203], v9 offset:6144
    v_accvgpr_write_b32 a15, 1.0
    v_mfma_f32_16x16x32_bf16 v[244:247], a[212:215], a[56:59], v[244:247]
    buffer_load_dwordx4 v5, s[12:15], s38 offen offset:256 lds
    v_mfma_f32_16x16x32_bf16 v[244:247], a[208:211], a[40:43], v[244:247]
pg_4:
    s_cbranch_execz pg_8
    s_add_u32 s38, s38, 24576
    v_accvgpr_write_b32 a16, 1.0
    v_accvgpr_write_b32 a17, 1.0
    v_mfma_f32_16x16x32_bf16 v[236:239], a[208:211], a[36:39], v[236:239]
    s_add_u32 s88, s51, 8
    ds_read_b64_tr_b16 a[204:205], v9 offset:12288
    v_accvgpr_write_b32 a18, 1.0
    v_mfma_f32_16x16x32_bf16 v[236:239], a[212:215], a[52:55], v[236:239]
    s_waitcnt vmcnt(24)
    s_waitcnt vmcnt(14)
    ds_read_b64_tr_b16 a[206:207], v9 offset:18432
    v_mfma_f32_16x16x32_bf16 v[228:231], a[212:215], a[48:51], v[228:231]
    s_lshr_b32 s88, s93, s88
    v_accvgpr_write_b32 a19, 1.0
    v_accvgpr_write_b32 a20, 1.0
    v_mfma_f32_16x16x32_bf16 v[228:231], a[208:211], a[32:35], v[228:231]
    s_waitcnt lgkmcnt(4)
    v_accvgpr_write_b32 a21, 1.0
    v_accvgpr_write_b32 a22, 1.0
    v_add_u32 v10, 98304, v14
    v_mfma_f32_16x16x32_bf16 v[64:67], a[192:195], a[64:67], v[64:67]
    s_add_u32 m0, s49, 24576
    ds_read_b64_tr_b16 a[208:209], v10 offset:0
    v_accvgpr_write_b32 a23, 1.0
    v_mfma_f32_16x16x32_bf16 v[64:67], a[196:199], a[80:83], v[64:67]
    s_and_b32 s88, s88, 0x2000
    ds_read_b64_tr_b16 a[210:211], v10 offset:6144
    v_accvgpr_write_b32 a24, 1.0
    v_mfma_f32_16x16x32_bf16 v[72:75], a[196:199], a[84:87], v[72:75]
    s_add_u32 s5, s5, s88
    ds_read_b64_tr_b16 v[32:33], v25 offset:0
    v_accvgpr_write_b32 a25, 1.0
    v_mfma_f32_16x16x32_bf16 v[72:75], a[192:195], a[68:71], v[72:75]
    s_lshl_b32 s88, s52, 15
    ds_read_b64_tr_b16 v[34:35], v25 offset:4096
    v_accvgpr_write_b32 a26, 1.0
    v_mfma_f32_16x16x32_bf16 v[80:83], a[192:195], a[72:75], v[80:83]
    s_lshl_b32 s89, s53, 9
    ds_read_b64_tr_b16 a[212:213], v10 offset:12288
    v_accvgpr_write_b32 a27, 1.0
    v_mfma_f32_16x16x32_bf16 v[80:83], a[196:199], a[88:91], v[80:83]
    s_add_u32 s88, s88, s89
    ds_read_b64_tr_b16 a[214:215], v10 offset:18432
    v_accvgpr_write_b32 a28, 1.0
    v_mfma_f32_16x16x32_bf16 v[88:91], a[196:199], a[92:95], v[88:91]
    s_lshl_b32 s89, s3, 7
    ds_read_b64_tr_b16 v[36:37], v25 offset:1024
    v_accvgpr_write_b32 a29, 1.0
    v_mfma_f32_16x16x32_bf16 v[88:91], a[192:195], a[76:79], v[88:91]
    s_waitcnt lgkmcnt(4)
    buffer_load_dwordx4 v4, s[12:15], s38 offen offset:0 lds
    v_add_u32 v11, 98304, v15
    v_mfma_f32_16x16x32_bf16 v[92:95], a[200:203], a[76:79], v[92:95]
    s_add_u32 m0, s49, 25472
    ds_read_b64_tr_b16 a[192:193], v11 offset:0
    v_accvgpr_write_b32 a30, 1.0
    v_mfma_f32_16x16x32_bf16 v[92:95], a[204:207], a[92:95], v[92:95]
    s_add_u32 s88, s88, s89
    ds_read_b64_tr_b16 a[194:195], v11 offset:6144
    v_accvgpr_write_b32 a31, 1.0
    v_mfma_f32_16x16x32_bf16 v[84:87], a[204:207], a[88:91], v[84:87]
    s_add_u32 s88, s88, 4456452
    ds_read_b64_tr_b16 v[38:39], v25 offset:5120
    v_accvgpr_write_b32 a32, 1.0
    v_mfma_f32_16x16x32_bf16 v[84:87], a[200:203], a[72:75], v[84:87]
    s_lshr_b32 s89, s93, 8
    ds_read_b64_tr_b16 v[40:41], v25 offset:8192
    v_lshrrev_b32 v60, v1, s89
    v_mfma_f32_16x16x32_bf16 v[76:79], a[200:203], a[68:71], v[76:79]
    ds_read_b64_tr_b16 a[196:197], v11 offset:12288
    v_and_b32 v60, 0x2000, v60
    v_mfma_f32_16x16x32_bf16 v[76:79], a[204:207], a[84:87], v[76:79]
    ds_read_b64_tr_b16 a[198:199], v11 offset:18432
    v_add_u32 v60, s88, v60
    v_mfma_f32_16x16x32_bf16 v[68:71], a[204:207], a[80:83], v[68:71]
    ds_read_b64_tr_b16 v[42:43], v25 offset:12288
    v_bfe_u32 v61, v1, 1, 1
    v_mfma_f32_16x16x32_bf16 v[68:71], a[200:203], a[64:67], v[68:71]
    s_waitcnt lgkmcnt(4)
    buffer_load_dwordx4 v4, s[12:15], s38 offen offset:128 lds
    v_mfma_f32_16x16x32_bf16 v[96:99], a[208:211], a[64:67], v[96:99]
    s_add_u32 m0, s49, 26368
    ds_read_b64_tr_b16 a[200:201], v8 offset:1024
    v_lshl_add_u32 v60, v61, 14, v60
    v_mfma_f32_16x16x32_bf16 v[96:99], a[212:215], a[80:83], v[96:99]
    ds_read_b64_tr_b16 a[202:203], v8 offset:7168
    v_and_b32 v61, 1, v1
    v_mfma_f32_16x16x32_bf16 v[104:107], a[212:215], a[84:87], v[104:107]
    ds_read_b64_tr_b16 v[44:45], v25 offset:9216
    v_lshl_add_u32 v60, v61, 12, v60
    v_mfma_f32_16x16x32_bf16 v[104:107], a[208:211], a[68:71], v[104:107]
    ds_read_b64_tr_b16 v[46:47], v25 offset:13312
    v_lshrrev_b32 v61, 2, v1
    v_mfma_f32_16x16x32_bf16 v[112:115], a[208:211], a[72:75], v[112:115]
    ds_read_b64_tr_b16 a[204:205], v8 offset:13312
    v_min_u32 v61, 1, v61
    v_mfma_f32_16x16x32_bf16 v[112:115], a[212:215], a[88:91], v[112:115]
    ds_read_b64_tr_b16 a[206:207], v8 offset:19456
    v_lshl_or_b32 v60, v61, 30, v60
    v_mfma_f32_16x16x32_bf16 v[120:123], a[212:215], a[92:95], v[120:123]
    buffer_load_dwordx4 v4, s[12:15], s38 offen offset:256 lds
    v_accvgpr_write_b32 a223, v60
    v_mfma_f32_16x16x32_bf16 v[120:123], a[208:211], a[76:79], v[120:123]
    s_waitcnt lgkmcnt(4)
    v_accvgpr_write_b32 a33, 1.0
    v_accvgpr_write_b32 a34, 1.0
    v_mfma_f32_16x16x32_bf16 v[124:127], a[192:195], a[76:79], v[124:127]
    s_add_u32 m0, s49, 27648
    ds_read_b64_tr_b16 a[208:209], v9 offset:1024
    v_accvgpr_write_b32 a35, 1.0
    v_mfma_f32_16x16x32_bf16 v[124:127], a[196:199], a[92:95], v[124:127]
    s_mul_hi_u32 s47, s58, 429496730
    ds_read_b64_tr_b16 a[210:211], v9 offset:7168
    v_accvgpr_write_b32 a36, 1.0
    v_mfma_f32_16x16x32_bf16 v[116:119], a[196:199], a[88:91], v[116:119]
    buffer_load_dwordx4 v5, s[12:15], s38 offen offset:0 lds
    v_mfma_f32_16x16x32_bf16 v[116:119], a[192:195], a[72:75], v[116:119]
    s_add_u32 m0, s49, 28544
    v_accvgpr_write_b32 a37, 1.0
    v_accvgpr_write_b32 a38, 1.0
    v_mfma_f32_16x16x32_bf16 v[108:111], a[192:195], a[68:71], v[108:111]
    s_lshl_b32 s37, s47, 8
    ds_read_b64_tr_b16 a[212:213], v9 offset:13312
    v_accvgpr_write_b32 a39, 1.0
    v_mfma_f32_16x16x32_bf16 v[108:111], a[196:199], a[84:87], v[108:111]
    s_add_u32 s37, s37, 4718736
    ds_read_b64_tr_b16 a[214:215], v9 offset:19456
    v_accvgpr_write_b32 a40, 1.0
    v_mfma_f32_16x16x32_bf16 v[100:103], a[196:199], a[80:83], v[100:103]
    buffer_load_dwordx4 v5, s[12:15], s38 offen offset:128 lds
    v_mfma_f32_16x16x32_bf16 v[100:103], a[192:195], a[64:67], v[100:103]
    s_waitcnt lgkmcnt(4)
    v_accvgpr_write_b32 a41, 1.0
    v_accvgpr_write_b32 a42, 1.0
    v_mfma_f32_16x16x32_bf16 v[128:131], a[200:203], a[64:67], v[128:131]
    s_add_u32 m0, s49, 29440
    ds_read_b64_tr_b16 a[192:193], v10 offset:1024
    v_accvgpr_write_b32 a43, 1.0
    v_mfma_f32_16x16x32_bf16 v[128:131], a[204:207], a[80:83], v[128:131]
    s_mov_b32 s32, s82
    ds_read_b64_tr_b16 a[194:195], v10 offset:7168
    v_accvgpr_write_b32 a44, 1.0
    v_mfma_f32_16x16x32_bf16 v[136:139], a[204:207], a[84:87], v[136:139]
    v_mfma_f32_16x16x32_bf16 v[20:23], v[48:51], v[32:35], 0
    v_mfma_f32_16x16x32_bf16 v[58:61], v[48:51], v[36:39], 0
    v_mfma_f32_16x16x32_bf16 v[20:23], v[52:55], v[40:43], v[20:23]
    v_mfma_f32_16x16x32_bf16 v[58:61], v[52:55], v[44:47], v[58:61]
    v_mfma_f32_16x16x32_bf16 v[136:139], a[200:203], a[68:71], v[136:139]
    buffer_load_dwordx4 v5, s[12:15], s38 offen offset:256 lds
    v_mfma_f32_16x16x32_bf16 v[144:147], a[200:203], a[72:75], v[144:147]
    s_add_u32 s38, s38, 24576
    ds_read_b64_tr_b16 a[196:197], v10 offset:13312
    v_accvgpr_write_b32 a45, 1.0
    v_mfma_f32_16x16x32_bf16 v[144:147], a[204:207], a[88:91], v[144:147]
    s_and_b32 s33, s83, 0xffff
    ds_read_b64_tr_b16 a[198:199], v10 offset:19456
    v_accvgpr_write_b32 a46, 1.0
    v_mfma_f32_16x16x32_bf16 v[152:155], a[204:207], a[92:95], v[152:155]
    s_mov_b32 s34, 1966080
    v_accvgpr_write_b32 a47, 1.0
    v_accvgpr_write_b32 a48, 1.0
    v_mfma_f32_16x16x32_bf16 v[152:155], a[200:203], a[76:79], v[152:155]
    s_waitcnt lgkmcnt(4)
    v_accvgpr_write_b32 a49, 1.0
    v_accvgpr_write_b32 a50, 1.0
    v_mfma_f32_16x16x32_bf16 v[156:159], a[208:211], a[76:79], v[156:159]
    s_add_u32 m0, s49, 73728
    ds_read_b64_tr_b16 a[200:201], v11 offset:1024
    v_accvgpr_write_b32 a51, 1.0
    v_mfma_f32_16x16x32_bf16 v[156:159], a[212:215], a[92:95], v[156:159]
    s_mov_b32 s35, 0x00020000
    ds_read_b64_tr_b16 a[202:203], v11 offset:7168
    v_accvgpr_write_b32 a52, 1.0
    v_mfma_f32_16x16x32_bf16 v[148:151], a[212:215], a[88:91], v[148:151]
    buffer_load_dwordx4 v6, s[16:19], s40 offen offset:0 lds
    v_mfma_f32_16x16x32_bf16 v[148:151], a[208:211], a[72:75], v[148:151]
    s_mul_i32 s60, s47, 80640
    v_accvgpr_write_b32 a53, 1.0
    v_accvgpr_write_b32 a54, 1.0
    v_mfma_f32_16x16x32_bf16 v[140:143], a[208:211], a[68:71], v[140:143]
    s_lshl_b32 s56, s58, 7
    ds_read_b64_tr_b16 a[204:205], v11 offset:13312
    v_accvgpr_write_b32 a55, 1.0
    v_mfma_f32_16x16x32_bf16 v[140:143], a[212:215], a[84:87], v[140:143]
    s_add_u32 m0, s49, 74624
    ds_read_b64_tr_b16 a[206:207], v11 offset:19456
    v_accvgpr_write_b32 a56, 1.0
    v_mfma_f32_16x16x32_bf16 v[132:135], a[212:215], a[80:83], v[132:135]
    buffer_load_dwordx4 v6, s[16:19], s40 offen offset:128 lds
    v_mfma_f32_16x16x32_bf16 v[132:135], a[208:211], a[64:67], v[132:135]
    s_waitcnt lgkmcnt(4)
    v_accvgpr_write_b32 a57, 1.0
    v_accvgpr_write_b32 a58, 1.0
    v_mfma_f32_16x16x32_bf16 v[160:163], a[192:195], a[64:67], v[160:163]
    s_add_u32 s60, s60, s56
    ds_read_b64_tr_b16 a[208:209], v8 offset:2048
    v_accvgpr_write_b32 a59, 1.0
    v_mfma_f32_16x16x32_bf16 v[160:163], a[196:199], a[80:83], v[160:163]
    s_mul_i32 s56, s53, 983040
    ds_read_b64_tr_b16 a[210:211], v8 offset:8192
    v_accvgpr_write_b32 a60, 1.0
    v_mfma_f32_16x16x32_bf16 v[168:171], a[196:199], a[84:87], v[168:171]
    s_add_u32 s28, s72, s56
    s_addc_u32 s29, s73, 0
    v_accvgpr_write_b32 a61, 1.0
    v_mfma_f32_16x16x32_bf16 v[168:171], a[192:195], a[68:71], v[168:171]
    s_and_b32 s29, s29, 0xffff
    v_accvgpr_write_b32 a62, 1.0
    v_accvgpr_write_b32 a63, 1.0
    v_mfma_f32_16x16x32_bf16 v[176:179], a[192:195], a[72:75], v[176:179]
    s_add_u32 m0, s49, 75520
    ds_read_b64_tr_b16 a[212:213], v8 offset:14336
    v_mov_b32 v22, v58
    v_mfma_f32_16x16x32_bf16 v[176:179], a[196:199], a[88:91], v[176:179]
    s_mov_b32 s30, 983040
    ds_read_b64_tr_b16 a[214:215], v8 offset:20480
    v_mov_b32 v23, v59
    v_mfma_f32_16x16x32_bf16 v[184:187], a[196:199], a[92:95], v[184:187]
    buffer_store_dwordx4 v[20:23], v26, s[24:27], s62 offen sc1
    v_mfma_f32_16x16x32_bf16 v[184:187], a[192:195], a[76:79], v[184:187]
    s_waitcnt lgkmcnt(4)
    buffer_load_dwordx4 v6, s[16:19], s40 offen offset:256 lds
    v_mfma_f32_16x16x32_bf16 v[188:191], a[200:203], a[76:79], v[188:191]
    s_mov_b32 s31, 0x00020000
    ds_read_b64_tr_b16 a[192:193], v9 offset:2048
    v_mov_b32 v32, 0xc0933333
    v_mfma_f32_16x16x32_bf16 v[188:191], a[204:207], a[92:95], v[188:191]
    s_lshr_b32 s48, s2, 3
    ds_read_b64_tr_b16 a[194:195], v9 offset:8192
    v_mov_b32 v33, 0xc0933333
    v_mfma_f32_16x16x32_bf16 v[180:183], a[204:207], a[88:91], v[180:183]
    s_add_u32 m0, s49, 76800
    v_mov_b32 v34, 0xc0933333
    v_mov_b32 v35, 0xc0933333
    v_mfma_f32_16x16x32_bf16 v[180:183], a[200:203], a[72:75], v[180:183]
    buffer_load_dwordx4 v7, s[16:19], s40 offen offset:0 lds
    v_mfma_f32_16x16x32_bf16 v[172:175], a[200:203], a[68:71], v[172:175]
    s_lshl_b32 s48, s48, 2
    ds_read_b64_tr_b16 a[196:197], v9 offset:14336
    v_mov_b32 v36, 0xc0933333
    v_mfma_f32_16x16x32_bf16 v[172:175], a[204:207], a[84:87], v[172:175]
    s_add_u32 s48, s48, s3
    ds_read_b64_tr_b16 a[198:199], v9 offset:20480
    v_mov_b32 v37, 0xc0933333
    v_mfma_f32_16x16x32_bf16 v[164:167], a[204:207], a[80:83], v[164:167]
    s_mul_i32 s6, s48, 7680
    v_lshlrev_b32 v16, 7, v16
    v_mov_b32 v38, 0xc0933333
    v_mfma_f32_16x16x32_bf16 v[164:167], a[200:203], a[64:67], v[164:167]
    s_waitcnt lgkmcnt(4)
    v_mov_b32 v39, 0xc0933333
    v_mov_b32 v40, 0xc0933333
    v_mfma_f32_16x16x32_bf16 v[192:195], a[208:211], a[64:67], v[192:195]
    s_lshl_b32 s57, s51, 8
    ds_read_b64_tr_b16 a[200:201], v10 offset:2048
    v_mov_b32 v41, 0xc0933333
    v_mfma_f32_16x16x32_bf16 v[192:195], a[212:215], a[80:83], v[192:195]
    s_add_u32 m0, s49, 77696
    ds_read_b64_tr_b16 a[202:203], v10 offset:8192
    v_mov_b32 v42, 0xc0933333
    v_mfma_f32_16x16x32_bf16 v[200:203], a[212:215], a[84:87], v[200:203]
    buffer_load_dwordx4 v7, s[16:19], s40 offen offset:128 lds
    v_mfma_f32_16x16x32_bf16 v[200:203], a[208:211], a[68:71], v[200:203]
    s_add_u32 s56, s56, s57
    v_mov_b32 v43, 0xc0933333
    v_mov_b32 v44, 0xc0933333
    v_mfma_f32_16x16x32_bf16 v[208:211], a[208:211], a[72:75], v[208:211]
    s_lshr_b32 s63, s51, 1
    ds_read_b64_tr_b16 a[204:205], v10 offset:14336
    v_mov_b32 v45, 0xc0933333
    v_mfma_f32_16x16x32_bf16 v[208:211], a[212:215], a[88:91], v[208:211]
    s_lshl_b32 s63, s63, 7
    ds_read_b64_tr_b16 a[206:207], v10 offset:20480
    v_mov_b32 v46, 0xc0933333
    v_mfma_f32_16x16x32_bf16 v[216:219], a[212:215], a[92:95], v[216:219]
    s_add_u32 s63, s63, 768
    v_mov_b32 v47, 0xc0933333
    v_add_u32 v8, 122880, v12
    v_mfma_f32_16x16x32_bf16 v[216:219], a[208:211], a[76:79], v[216:219]
    s_waitcnt lgkmcnt(4)
    v_add_u32 v9, 122880, v13
    v_lshrrev_b32 v60, 2, v1
    v_mfma_f32_16x16x32_bf16 v[220:223], a[192:195], a[76:79], v[220:223]
    s_add_u32 m0, s49, 78592
    ds_read_b64_tr_b16 a[208:209], v11 offset:2048
    v_min_u32 v60, 9, v60
    v_mfma_f32_16x16x32_bf16 v[220:223], a[196:199], a[92:95], v[220:223]
    s_sub_u32 s63, s63, s57
    ds_read_b64_tr_b16 a[210:211], v11 offset:8192
    v_mul_u32_u24 v60, 6144, v60
    v_mfma_f32_16x16x32_bf16 v[212:215], a[196:199], a[88:91], v[212:215]
    buffer_load_dwordx4 v7, s[16:19], s40 offen offset:256 lds
    v_mfma_f32_16x16x32_bf16 v[212:215], a[192:195], a[72:75], v[212:215]
    s_add_u32 s40, s40, 24576
    v_and_b32 v61, 3, v1
    v_lshl_add_u32 v60, v61, 2, v60
    v_mfma_f32_16x16x32_bf16 v[204:207], a[192:195], a[68:71], v[204:207]
    s_mov_b32 s66, 0
    ds_read_b64_tr_b16 a[212:213], v11 offset:14336
    v_add_u32 v10, 122880, v14
    v_mfma_f32_16x16x32_bf16 v[204:207], a[196:199], a[84:87], v[204:207]
    s_waitcnt vmcnt(31)
    ds_read_b64_tr_b16 a[214:215], v11 offset:20480
    s_sub_u32 s57, 7864320, s56
    v_mfma_f32_16x16x32_bf16 v[196:199], a[196:199], a[80:83], v[196:199]
    s_barrier
    v_mfma_f32_16x16x32_bf16 v[196:199], a[192:195], a[64:67], v[196:199]
    s_waitcnt lgkmcnt(4)
    v_add_u32 v11, 122880, v15
    s_add_u32 s8, s72, s56
    s_addc_u32 s9, s73, 0
    v_mfma_f32_16x16x32_bf16 v[224:227], a[200:203], a[64:67], v[224:227]
    s_and_b32 s9, s9, 0xffff
    ds_read_b64_tr_b16 a[192:193], v8 offset:0
    s_mov_b32 s10, s57
    v_mfma_f32_16x16x32_bf16 v[224:227], a[204:207], a[80:83], v[224:227]
    s_mov_b32 s11, 0x00020000
    ds_read_b64_tr_b16 a[194:195], v8 offset:6144
    s_mul_i32 s36, s51, 245760
    v_mfma_f32_16x16x32_bf16 v[232:235], a[204:207], a[84:87], v[232:235]
    s_mul_i32 s56, s3, 20480
    s_add_u32 s36, s36, s56
    s_lshl_b32 s59, s53, 23
    v_mfma_f32_16x16x32_bf16 v[232:235], a[200:203], a[68:71], v[232:235]
    s_add_u32 s59, s59, 67108864
    s_add_u32 s20, s86, s59
    s_addc_u32 s21, s87, 0
    v_mfma_f32_16x16x32_bf16 v[240:243], a[200:203], a[72:75], v[240:243]
    s_and_b32 s21, s21, 0xffff
    ds_read_b64_tr_b16 a[196:197], v8 offset:12288
    s_mov_b32 s22, 8388608
    v_mfma_f32_16x16x32_bf16 v[240:243], a[204:207], a[88:91], v[240:243]
    s_mov_b32 s23, 0x00020000
    ds_read_b64_tr_b16 a[198:199], v8 offset:18432
    s_add_u32 s55, s51, 8
    v_mfma_f32_16x16x32_bf16 v[248:251], a[204:207], a[92:95], v[248:251]
    s_lshr_b32 s55, s93, s55
    s_and_b32 s55, s55, 0x2000
    s_lshl_b32 s59, s54, 16
    v_mfma_f32_16x16x32_bf16 v[248:251], a[200:203], a[76:79], v[248:251]
    s_waitcnt lgkmcnt(4)
    s_or_b32 s55, s55, s59
    s_and_b32 s59, s3, 1
    v_mfma_f32_16x16x32_bf16 v[252:255], a[208:211], a[76:79], v[252:255]
    s_lshl_b32 s59, s59, 14
    ds_read_b64_tr_b16 a[200:201], v9 offset:0
    s_or_b32 s55, s55, s59
    v_mfma_f32_16x16x32_bf16 v[252:255], a[212:215], a[92:95], v[252:255]
    s_mul_i32 s59, s51, 0x202000
    ds_read_b64_tr_b16 a[202:203], v9 offset:6144
    s_and_b32 s59, s59, 6299648
    v_mfma_f32_16x16x32_bf16 v[244:247], a[212:215], a[88:91], v[244:247]
    s_xor_b32 s55, s55, s59
    v_lshlrev_b32 v2, 7, v1
    v_and_b32 v3, 3, v1
    v_mfma_f32_16x16x32_bf16 v[244:247], a[208:211], a[72:75], v[244:247]
    v_lshlrev_b32 v3, 11, v3
    v_lshlrev_b32 v28, 4, v1
    v_mfma_f32_16x16x32_bf16 v[236:239], a[208:211], a[68:71], v[236:239]
    ds_read_b64_tr_b16 a[204:205], v9 offset:12288
    v_mov_b32 v31, v16
    v_mfma_f32_16x16x32_bf16 v[236:239], a[212:215], a[84:87], v[236:239]
    s_waitcnt vmcnt(23)
    s_waitcnt vmcnt(19)
    ds_read_b64_tr_b16 a[206:207], v9 offset:18432
    v_mfma_f32_16x16x32_bf16 v[228:231], a[212:215], a[80:83], v[228:231]
    s_mov_b32 s41, s49
    s_add_u32 s42, s49, 24576
    s_add_u32 s43, s49, 49152
    v_mfma_f32_16x16x32_bf16 v[228:231], a[208:211], a[64:67], v[228:231]
    s_waitcnt lgkmcnt(4)
    s_mov_b32 s45, 6
    s_sub_u32 s56, 73728, s49
    v_mfma_f32_16x16x32_bf16 v[64:67], a[192:195], a[224:227], v[64:67]
    ds_read_b64_tr_b16 a[208:209], v10 offset:0
    v_add_u32 v16, s49, v18
    v_mfma_f32_16x16x32_bf16 v[64:67], a[196:199], a[240:243], v[64:67]
    ds_read_b64_tr_b16 a[210:211], v10 offset:6144
    v_add_u32 v17, s49, v19
    v_mfma_f32_16x16x32_bf16 v[72:75], a[196:199], a[244:247], v[72:75]
    v_add_u32 v12, s56, v12
    v_add_u32 v13, s56, v13
    v_mfma_f32_16x16x32_bf16 v[72:75], a[192:195], a[228:231], v[72:75]
    v_add_u32 v14, s56, v14
    v_add_u32 v15, s56, v15
    v_mfma_f32_16x16x32_bf16 v[80:83], a[192:195], a[232:235], v[80:83]
    ds_read_b64_tr_b16 a[212:213], v10 offset:12288
    v_mov_b32 v30, 0x47800000
    v_mfma_f32_16x16x32_bf16 v[80:83], a[196:199], a[248:251], v[80:83]
    ds_read_b64_tr_b16 a[214:215], v10 offset:18432
    v_mov_b32 v20, 0
    v_mfma_f32_16x16x32_bf16 v[88:91], a[196:199], a[252:255], v[88:91]
    v_mov_b32 v21, 0
    v_mov_b32 v22, 0
    v_mfma_f32_16x16x32_bf16 v[88:91], a[192:195], a[236:239], v[88:91]
    s_waitcnt lgkmcnt(4)
    v_mov_b32 v23, 0
    v_mov_b32 v56, 0x3c000000
    v_mfma_f32_16x16x32_bf16 v[92:95], a[200:203], a[236:239], v[92:95]
    ds_read_b64_tr_b16 a[192:193], v11 offset:0
    v_accvgpr_write_b32 a64, 1.0
    v_mfma_f32_16x16x32_bf16 v[92:95], a[204:207], a[252:255], v[92:95]
    ds_read_b64_tr_b16 a[194:195], v11 offset:6144
    v_accvgpr_write_b32 a65, 1.0
    v_mfma_f32_16x16x32_bf16 v[84:87], a[204:207], a[248:251], v[84:87]
    s_getpc_b64 s[74:75]
ct3:
    s_add_u32 s74, s74, at_switch-ct3
    s_addc_u32 s75, s75, 0
    global_load_dword a222, v2, s[74:75]
    v_mfma_f32_16x16x32_bf16 v[84:87], a[200:203], a[232:235], v[84:87]
    v_min_u32 v2, 15, v1
    v_mfma_f32_16x16x32_bf16 v[76:79], a[200:203], a[228:231], v[76:79]
    s_lshl_b32 s59, s3, 4
    ds_read_b64_tr_b16 a[196:197], v11 offset:12288
    v_add_u32 v2, s59, v2
    v_mfma_f32_16x16x32_bf16 v[76:79], a[204:207], a[244:247], v[76:79]
    ds_read_b64_tr_b16 a[198:199], v11 offset:18432
    v_mul_u32_u24 v2, 1280, v2
    v_mfma_f32_16x16x32_bf16 v[68:71], a[204:207], a[240:243], v[68:71]
    buffer_load_dword a217, v2, s[32:35], s60 offen
    v_mfma_f32_16x16x32_bf16 v[68:71], a[200:203], a[224:227], v[68:71]
    s_waitcnt lgkmcnt(4)
    v_and_b32 v2, 1, v1
    v_lshlrev_b32 v2, 7, v2
    v_mfma_f32_16x16x32_bf16 v[96:99], a[208:211], a[224:227], v[96:99]
    s_lshl_b32 s59, s48, 8
    ds_read_b64_tr_b16 a[200:201], v8 offset:1024
    v_add_u32 v2, s59, v2
    v_mfma_f32_16x16x32_bf16 v[96:99], a[212:215], a[240:243], v[96:99]
    ds_read_b64_tr_b16 a[202:203], v8 offset:7168
    v_accvgpr_write_b32 a66, 1.0
    v_mfma_f32_16x16x32_bf16 v[104:107], a[212:215], a[244:247], v[104:107]
    v_accvgpr_write_b32 a67, 1.0
    v_mfma_f32_16x16x32_bf16 v[104:107], a[208:211], a[228:231], v[104:107]
    v_accvgpr_write_b32 a68, 1.0
    v_mfma_f32_16x16x32_bf16 v[112:115], a[208:211], a[232:235], v[112:115]
    ds_read_b64_tr_b16 a[204:205], v8 offset:13312
    v_accvgpr_write_b32 a69, 1.0
    v_mfma_f32_16x16x32_bf16 v[112:115], a[212:215], a[248:251], v[112:115]
    ds_read_b64_tr_b16 a[206:207], v8 offset:19456
    v_cvt_pk_bf16_f32 v64, v64, v65
    v_mfma_f32_16x16x32_bf16 v[120:123], a[212:215], a[252:255], v[120:123]
    s_getpc_b64 s[74:75]
ct4:
    s_add_u32 s74, s74, tail_code-ct4
    s_addc_u32 s75, s75, 0
    global_load_dword a218, v2, s[74:75]
    v_mfma_f32_16x16x32_bf16 v[120:123], a[208:211], a[236:239], v[120:123]
    s_waitcnt lgkmcnt(4)
    v_and_b32 v31, 3, v1
    v_lshlrev_b32 v31, 7, v31
    v_mfma_f32_16x16x32_bf16 v[124:127], a[192:195], a[236:239], v[124:127]
    s_lshl_b32 s59, s48, 9
    ds_read_b64_tr_b16 a[208:209], v9 offset:1024
    v_cvt_pk_bf16_f32 v65, v66, v67
    v_mfma_f32_16x16x32_bf16 v[124:127], a[196:199], a[252:255], v[124:127]
    s_and_b32 s59, s59, 0x7fff
    ds_read_b64_tr_b16 a[210:211], v9 offset:7168
    v_add_u32 v31, s59, v31
    v_mfma_f32_16x16x32_bf16 v[116:119], a[196:199], a[248:251], v[116:119]
    v_min_u32 v2, 11, v1
    v_lshlrev_b32 v2, 7, v2
    v_mfma_f32_16x16x32_bf16 v[116:119], a[192:195], a[232:235], v[116:119]
    v_cvt_pk_bf16_f32 v66, v68, v69
    v_cvt_pk_bf16_f32 v67, v70, v71
    v_mfma_f32_16x16x32_bf16 v[108:111], a[192:195], a[228:231], v[108:111]
    ds_read_b64_tr_b16 a[212:213], v9 offset:13312
    v_cvt_pk_bf16_f32 v72, v72, v73
    v_mfma_f32_16x16x32_bf16 v[108:111], a[196:199], a[244:247], v[108:111]
    ds_read_b64_tr_b16 a[214:215], v9 offset:19456
    v_cvt_pk_bf16_f32 v73, v74, v75
    v_mfma_f32_16x16x32_bf16 v[100:103], a[196:199], a[240:243], v[100:103]
    s_and_b32 s88, s3, 1
    v_permlane16_swap_b32 v64, v66
    v_mfma_f32_16x16x32_bf16 v[100:103], a[192:195], a[224:227], v[100:103]
    s_waitcnt lgkmcnt(4)
    v_permlane16_swap_b32 v65, v67
    v_mfma_f32_16x16x32_bf16 v[128:131], a[200:203], a[224:227], v[128:131]
    s_mul_i32 s88, s88, 20480
    ds_read_b64_tr_b16 a[192:193], v10 offset:1024
    v_cvt_pk_bf16_f32 v74, v76, v77
    v_mfma_f32_16x16x32_bf16 v[128:131], a[204:207], a[240:243], v[128:131]
    s_add_u32 s89, s51, 0
    ds_read_b64_tr_b16 a[194:195], v10 offset:7168
    v_cvt_pk_bf16_f32 v75, v78, v79
    v_mfma_f32_16x16x32_bf16 v[136:139], a[204:207], a[244:247], v[136:139]
    s_and_b32 s89, s89, 3
    v_permlane16_swap_b32 v72, v74
    v_mfma_f32_16x16x32_bf16 v[136:139], a[200:203], a[228:231], v[136:139]
    s_mul_i32 s89, s89, 245760
    v_permlane16_swap_b32 v73, v75
    v_mfma_f32_16x16x32_bf16 v[144:147], a[200:203], a[232:235], v[144:147]
    s_add_u32 s32, s89, s88
    ds_read_b64_tr_b16 a[196:197], v10 offset:13312
    v_cvt_pk_bf16_f32 v80, v80, v81
    v_mfma_f32_16x16x32_bf16 v[144:147], a[204:207], a[248:251], v[144:147]
    s_add_u32 s89, s51, 1
    ds_read_b64_tr_b16 a[198:199], v10 offset:19456
    v_cvt_pk_bf16_f32 v81, v82, v83
    v_mfma_f32_16x16x32_bf16 v[152:155], a[204:207], a[252:255], v[152:155]
    s_and_b32 s89, s89, 3
    v_cvt_pk_bf16_f32 v82, v84, v85
    v_cvt_pk_bf16_f32 v83, v86, v87
    v_mfma_f32_16x16x32_bf16 v[152:155], a[200:203], a[236:239], v[152:155]
    s_waitcnt lgkmcnt(4)
    v_permlane16_swap_b32 v80, v82
    v_mfma_f32_16x16x32_bf16 v[156:159], a[208:211], a[236:239], v[156:159]
    s_mul_i32 s89, s89, 245760
    ds_read_b64_tr_b16 a[200:201], v11 offset:1024
    v_cvt_pk_bf16_f32 v88, v88, v89
    v_mfma_f32_16x16x32_bf16 v[156:159], a[212:215], a[252:255], v[156:159]
    s_add_u32 s33, s89, s88
    ds_read_b64_tr_b16 a[202:203], v11 offset:7168
    v_cvt_pk_bf16_f32 v89, v90, v91
    v_mfma_f32_16x16x32_bf16 v[148:151], a[212:215], a[248:251], v[148:151]
    s_add_u32 s89, s51, 2
    v_permlane16_swap_b32 v81, v83
    v_mfma_f32_16x16x32_bf16 v[148:151], a[208:211], a[232:235], v[148:151]
    s_and_b32 s89, s89, 3
    v_cvt_pk_bf16_f32 v90, v92, v93
    v_cvt_pk_bf16_f32 v91, v94, v95
    v_mfma_f32_16x16x32_bf16 v[140:143], a[208:211], a[228:231], v[140:143]
    s_mul_i32 s89, s89, 245760
    ds_read_b64_tr_b16 a[204:205], v11 offset:13312
    v_cvt_pk_bf16_f32 v96, v96, v97
    v_mfma_f32_16x16x32_bf16 v[140:143], a[212:215], a[244:247], v[140:143]
    s_add_u32 s34, s89, s88
    ds_read_b64_tr_b16 a[206:207], v11 offset:19456
    v_cvt_pk_bf16_f32 v97, v98, v99
    v_mfma_f32_16x16x32_bf16 v[132:135], a[212:215], a[240:243], v[132:135]
    s_add_u32 s89, s51, 3
    v_permlane16_swap_b32 v88, v90
    v_mfma_f32_16x16x32_bf16 v[132:135], a[208:211], a[224:227], v[132:135]
    s_waitcnt lgkmcnt(4)
    v_permlane16_swap_b32 v89, v91
    v_mfma_f32_16x16x32_bf16 v[160:163], a[192:195], a[224:227], v[160:163]
    s_and_b32 s89, s89, 3
    ds_read_b64_tr_b16 a[208:209], v8 offset:2048
    v_cvt_pk_bf16_f32 v98, v100, v101
    v_mfma_f32_16x16x32_bf16 v[160:163], a[196:199], a[240:243], v[160:163]
    s_mul_i32 s89, s89, 245760
    ds_read_b64_tr_b16 a[210:211], v8 offset:8192
    v_cvt_pk_bf16_f32 v99, v102, v103
    v_mfma_f32_16x16x32_bf16 v[168:171], a[196:199], a[244:247], v[168:171]
    s_add_u32 s35, s89, s88
    v_permlane16_swap_b32 v96, v98
    v_mfma_f32_16x16x32_bf16 v[168:171], a[192:195], a[228:231], v[168:171]
    v_permlane16_swap_b32 v97, v99
    v_mfma_f32_16x16x32_bf16 v[176:179], a[192:195], a[232:235], v[176:179]
    ds_read_b64_tr_b16 a[212:213], v8 offset:14336
    v_cvt_pk_bf16_f32 v104, v104, v105
    v_mfma_f32_16x16x32_bf16 v[176:179], a[196:199], a[248:251], v[176:179]
    ds_read_b64_tr_b16 a[214:215], v8 offset:20480
    v_cvt_pk_bf16_f32 v105, v106, v107
    v_mfma_f32_16x16x32_bf16 v[184:187], a[196:199], a[252:255], v[184:187]
    v_cvt_pk_bf16_f32 v106, v108, v109
    v_cvt_pk_bf16_f32 v107, v110, v111
    v_mfma_f32_16x16x32_bf16 v[184:187], a[192:195], a[236:239], v[184:187]
    s_waitcnt lgkmcnt(4)
    v_permlane16_swap_b32 v104, v106
    v_mfma_f32_16x16x32_bf16 v[188:191], a[200:203], a[236:239], v[188:191]
    ds_read_b64_tr_b16 a[192:193], v9 offset:2048
    v_cvt_pk_bf16_f32 v112, v112, v113
    v_mfma_f32_16x16x32_bf16 v[188:191], a[204:207], a[252:255], v[188:191]
    ds_read_b64_tr_b16 a[194:195], v9 offset:8192
    v_cvt_pk_bf16_f32 v113, v114, v115
    v_mfma_f32_16x16x32_bf16 v[180:183], a[204:207], a[248:251], v[180:183]
    v_permlane16_swap_b32 v105, v107
    v_mfma_f32_16x16x32_bf16 v[180:183], a[200:203], a[232:235], v[180:183]
    v_cvt_pk_bf16_f32 v114, v116, v117
    v_cvt_pk_bf16_f32 v115, v118, v119
    v_mfma_f32_16x16x32_bf16 v[172:175], a[200:203], a[228:231], v[172:175]
    ds_read_b64_tr_b16 a[196:197], v9 offset:14336
    v_cvt_pk_bf16_f32 v120, v120, v121
    v_mfma_f32_16x16x32_bf16 v[172:175], a[204:207], a[244:247], v[172:175]
    ds_read_b64_tr_b16 a[198:199], v9 offset:20480
    v_cvt_pk_bf16_f32 v121, v122, v123
    v_mfma_f32_16x16x32_bf16 v[164:167], a[204:207], a[240:243], v[164:167]
pg_5:
    s_cbranch_execz pg_9
    v_permlane16_swap_b32 v112, v114
    v_mfma_f32_16x16x32_bf16 v[164:167], a[200:203], a[224:227], v[164:167]
    s_waitcnt lgkmcnt(4)
    v_permlane16_swap_b32 v113, v115
    v_mfma_f32_16x16x32_bf16 v[192:195], a[208:211], a[224:227], v[192:195]
    ds_read_b64_tr_b16 a[200:201], v10 offset:2048
    v_cvt_pk_bf16_f32 v122, v124, v125
    v_mfma_f32_16x16x32_bf16 v[192:195], a[212:215], a[240:243], v[192:195]
    ds_read_b64_tr_b16 a[202:203], v10 offset:8192
    v_cvt_pk_bf16_f32 v123, v126, v127
    v_mfma_f32_16x16x32_bf16 v[200:203], a[212:215], a[244:247], v[200:203]
    v_permlane16_swap_b32 v120, v122
    v_mfma_f32_16x16x32_bf16 v[200:203], a[208:211], a[228:231], v[200:203]
    v_permlane16_swap_b32 v121, v123
    v_mfma_f32_16x16x32_bf16 v[208:211], a[208:211], a[232:235], v[208:211]
    ds_read_b64_tr_b16 a[204:205], v10 offset:14336
    v_cvt_pk_bf16_f32 v128, v128, v129
    v_mfma_f32_16x16x32_bf16 v[208:211], a[212:215], a[248:251], v[208:211]
    ds_read_b64_tr_b16 a[206:207], v10 offset:20480
    v_cvt_pk_bf16_f32 v129, v130, v131
    v_mfma_f32_16x16x32_bf16 v[216:219], a[212:215], a[252:255], v[216:219]
    v_cvt_pk_bf16_f32 v130, v132, v133
    v_cvt_pk_bf16_f32 v131, v134, v135
    v_mfma_f32_16x16x32_bf16 v[216:219], a[208:211], a[236:239], v[216:219]
    s_waitcnt lgkmcnt(4)
    v_permlane16_swap_b32 v128, v130
    v_mfma_f32_16x16x32_bf16 v[220:223], a[192:195], a[236:239], v[220:223]
    ds_read_b64_tr_b16 a[208:209], v11 offset:2048
    v_cvt_pk_bf16_f32 v136, v136, v137
    v_mfma_f32_16x16x32_bf16 v[220:223], a[196:199], a[252:255], v[220:223]
    ds_read_b64_tr_b16 a[210:211], v11 offset:8192
    v_cvt_pk_bf16_f32 v137, v138, v139
    v_mfma_f32_16x16x32_bf16 v[212:215], a[196:199], a[248:251], v[212:215]
    v_permlane16_swap_b32 v129, v131
    v_mfma_f32_16x16x32_bf16 v[212:215], a[192:195], a[232:235], v[212:215]
    v_cvt_pk_bf16_f32 v138, v140, v141
    v_cvt_pk_bf16_f32 v139, v142, v143
    v_mfma_f32_16x16x32_bf16 v[204:207], a[192:195], a[228:231], v[204:207]
    ds_read_b64_tr_b16 a[212:213], v11 offset:14336
    v_cvt_pk_bf16_f32 v144, v144, v145
    v_mfma_f32_16x16x32_bf16 v[204:207], a[196:199], a[244:247], v[204:207]
    s_waitcnt vmcnt(16)
    ds_read_b64_tr_b16 a[214:215], v11 offset:20480
    v_cvt_pk_bf16_f32 v145, v146, v147
    v_mfma_f32_16x16x32_bf16 v[196:199], a[196:199], a[240:243], v[196:199]
    s_barrier
    v_mfma_f32_16x16x32_bf16 v[196:199], a[192:195], a[224:227], v[196:199]
    s_waitcnt lgkmcnt(4)
    v_permlane16_swap_b32 v136, v138
    v_mfma_f32_16x16x32_bf16 v[224:227], a[200:203], a[224:227], v[224:227]
    ds_read_b128 a[192:195], v16 offset:0
    v_cvt_pk_bf16_f32 v146, v148, v149
    v_mfma_f32_16x16x32_bf16 v[224:227], a[204:207], a[240:243], v[224:227]
    v_permlane16_swap_b32 v137, v139
    v_mfma_f32_16x16x32_bf16 v[232:235], a[204:207], a[244:247], v[232:235]
    v_permlane16_swap_b32 v144, v146
    v_mfma_f32_16x16x32_bf16 v[232:235], a[200:203], a[228:231], v[232:235]
    v_cvt_pk_bf16_f32 v147, v150, v151
    v_cvt_pk_bf16_f32 v152, v152, v153
    v_mfma_f32_16x16x32_bf16 v[240:243], a[200:203], a[232:235], v[240:243]
    ds_read_b128 a[196:199], v17 offset:0
    v_cvt_pk_bf16_f32 v153, v154, v155
    v_mfma_f32_16x16x32_bf16 v[240:243], a[204:207], a[248:251], v[240:243]
    v_permlane16_swap_b32 v145, v147
    v_mfma_f32_16x16x32_bf16 v[248:251], a[204:207], a[252:255], v[248:251]
    v_cvt_pk_bf16_f32 v154, v156, v157
    v_cvt_pk_bf16_f32 v155, v158, v159
    v_mfma_f32_16x16x32_bf16 v[248:251], a[200:203], a[236:239], v[248:251]
    s_waitcnt lgkmcnt(2)
    v_permlane16_swap_b32 v152, v154
    v_mfma_f32_16x16x32_bf16 v[252:255], a[208:211], a[236:239], v[252:255]
    ds_read_b128 a[200:203], v16 offset:1024
    v_mov_b32 v26, s7
    v_mfma_f32_16x16x32_bf16 v[252:255], a[212:215], a[252:255], v[252:255]
    v_permlane16_swap_b32 v153, v155
    v_mfma_f32_16x16x32_bf16 v[244:247], a[212:215], a[248:251], v[244:247]
    v_min_u32 v27, 1, v1
    v_lshlrev_b32 v27, 30, v27
    v_mfma_f32_16x16x32_bf16 v[244:247], a[208:211], a[232:235], v[244:247]
    s_waitcnt vmcnt(7)
    v_cvt_pk_bf16_f32 v160, v160, v161
    v_cvt_pk_bf16_f32 v161, v162, v163
    v_mfma_f32_16x16x32_bf16 v[236:239], a[208:211], a[228:231], v[236:239]
    ds_read_b128 a[204:207], v17 offset:1024
    v_cvt_pk_bf16_f32 v162, v164, v165
    v_mfma_f32_16x16x32_bf16 v[236:239], a[212:215], a[244:247], v[236:239]
    buffer_store_dword v26, v27, s[24:27], s4 offen offset:144 sc1
    v_mfma_f32_16x16x32_bf16 v[228:231], a[212:215], a[240:243], v[228:231]
    v_permlane16_swap_b32 v160, v162
    v_mfma_f32_16x16x32_bf16 v[228:231], a[208:211], a[224:227], v[228:231]
    s_waitcnt lgkmcnt(2)
    v_cvt_pk_bf16_f32 v163, v166, v167
    v_cvt_pk_bf16_f32 v168, v168, v169
    v_mfma_f32_16x16x32_bf16 v[68:71], a[192:195], v[64:67], v[32:35]
    ds_read_b128 a[208:211], v16 offset:2048
    v_cvt_pk_bf16_f32 v169, v170, v171
    v_mfma_f32_16x16x32_bf16 v[68:71], a[196:199], v[96:99], v[68:71]
    v_permlane16_swap_b32 v161, v163
    v_mfma_f32_16x16x32_bf16 v[76:79], a[196:199], v[104:107], v[36:39]
    v_cvt_pk_bf16_f32 v170, v172, v173
    v_cvt_pk_bf16_f32 v171, v174, v175
    v_mfma_f32_16x16x32_bf16 v[76:79], a[192:195], v[72:75], v[76:79]
    v_permlane16_swap_b32 v168, v170
    v_mfma_f32_16x16x32_bf16 v[84:87], a[192:195], v[80:83], v[40:43]
    ds_read_b128 a[212:215], v17 offset:2048
    v_cvt_pk_bf16_f32 v176, v176, v177
    v_mfma_f32_16x16x32_bf16 v[84:87], a[196:199], v[112:115], v[84:87]
    v_permlane16_swap_b32 v169, v171
    v_cvt_pk_bf16_f32 v177, v178, v179
    v_cvt_pk_bf16_f32 v178, v180, v181
    v_cvt_pk_bf16_f32 v179, v182, v183
    v_cvt_pk_bf16_f32 v184, v184, v185
    v_permlane16_swap_b32 v176, v178
    v_permlane16_swap_b32 v177, v179
    v_cvt_pk_bf16_f32 v185, v186, v187
    v_cvt_pk_bf16_f32 v186, v188, v189
    v_cvt_pk_bf16_f32 v187, v190, v191
    v_cvt_pk_bf16_f32 v192, v192, v193
    v_permlane16_swap_b32 v184, v186
    v_permlane16_swap_b32 v185, v187
    v_mfma_f32_16x16x32_bf16 v[92:95], a[196:199], v[120:123], v[44:47]
    v_cvt_pk_bf16_f32 v193, v194, v195
    v_cvt_pk_bf16_f32 v194, v196, v197
    v_mfma_f32_16x16x32_bf16 v[92:95], a[192:195], v[88:91], v[92:95]
    s_waitcnt lgkmcnt(2)
    v_permlane16_swap_b32 v192, v194
    v_mfma_f32_16x16x32_bf16 v[92:95], a[200:203], v[152:155], v[92:95]
    ds_read_b128 a[192:195], v16 offset:6144
    v_cvt_pk_bf16_f32 v195, v198, v199
    v_mfma_f32_16x16x32_bf16 v[92:95], a[204:207], v[184:187], v[92:95]
    v_cvt_pk_bf16_f32 v200, v200, v201
    v_cvt_pk_bf16_f32 v201, v202, v203
    v_mfma_f32_16x16x32_bf16 v[84:87], a[204:207], v[176:179], v[84:87]
    v_permlane16_swap_b32 v193, v195
    v_mfma_f32_16x16x32_bf16 v[84:87], a[200:203], v[144:147], v[84:87]
    v_cvt_pk_bf16_f32 v202, v204, v205
    v_cvt_pk_bf16_f32 v203, v206, v207
    v_mfma_f32_16x16x32_bf16 v[76:79], a[200:203], v[136:139], v[76:79]
    ds_read_b128 a[196:199], v17 offset:6144
    v_cvt_pk_bf16_f32 v208, v208, v209
    v_mfma_f32_16x16x32_bf16 v[76:79], a[204:207], v[168:171], v[76:79]
    s_add_u32 m0, s49, 49152
    v_permlane16_swap_b32 v200, v202
    v_permlane16_swap_b32 v201, v203
    v_cvt_pk_bf16_f32 v209, v210, v211
    v_cvt_pk_bf16_f32 v210, v212, v213
    v_cvt_pk_bf16_f32 v211, v214, v215
    v_cvt_pk_bf16_f32 v216, v216, v217
    v_permlane16_swap_b32 v208, v210
    v_permlane16_swap_b32 v209, v211
    v_cvt_pk_bf16_f32 v217, v218, v219
    v_cvt_pk_bf16_f32 v218, v220, v221
    v_cvt_pk_bf16_f32 v219, v222, v223
    v_cvt_pk_bf16_f32 v224, v224, v225
    v_permlane16_swap_b32 v216, v218
    v_permlane16_swap_b32 v217, v219
    v_cvt_pk_bf16_f32 v225, v226, v227
    v_cvt_pk_bf16_f32 v226, v228, v229
    v_cvt_pk_bf16_f32 v227, v230, v231
    v_cvt_pk_bf16_f32 v232, v232, v233
    v_permlane16_swap_b32 v224, v226
    v_permlane16_swap_b32 v225, v227
    v_cvt_pk_bf16_f32 v233, v234, v235
    v_cvt_pk_bf16_f32 v234, v236, v237
    v_cvt_pk_bf16_f32 v235, v238, v239
    v_cvt_pk_bf16_f32 v240, v240, v241
    v_permlane16_swap_b32 v232, v234
    v_permlane16_swap_b32 v233, v235
    v_cvt_pk_bf16_f32 v241, v242, v243
    v_cvt_pk_bf16_f32 v242, v244, v245
    v_cvt_pk_bf16_f32 v243, v246, v247
    v_cvt_pk_bf16_f32 v248, v248, v249
    v_permlane16_swap_b32 v240, v242
    v_permlane16_swap_b32 v241, v243
    v_cvt_pk_bf16_f32 v249, v250, v251
    v_cvt_pk_bf16_f32 v250, v252, v253
    v_cvt_pk_bf16_f32 v251, v254, v255
    v_accvgpr_write_b32 a70, 1.0
    v_permlane16_swap_b32 v248, v250
    v_permlane16_swap_b32 v249, v251
    v_mfma_f32_16x16x32_bf16 v[68:71], a[204:207], v[160:163], v[68:71]
    buffer_load_dwordx4 v4, s[12:15], s38 offen offset:0 lds
    v_mfma_f32_16x16x32_bf16 v[68:71], a[200:203], v[128:131], v[68:71]
    s_waitcnt lgkmcnt(2)
    v_accvgpr_write_b32 a71, 1.0
    v_accvgpr_write_b32 a72, 1.0
    v_mfma_f32_16x16x32_bf16 v[68:71], a[208:211], v[192:195], v[68:71]
    ds_read_b128 a[200:203], v16 offset:7168
    v_accvgpr_write_b32 a73, 1.0
    v_mfma_f32_16x16x32_bf16 v[68:71], a[212:215], v[224:227], v[68:71]
    v_accvgpr_write_b32 a74, 1.0
    v_accvgpr_write_b32 a75, 1.0
    v_mfma_f32_16x16x32_bf16 v[76:79], a[212:215], v[232:235], v[76:79]
    v_accvgpr_write_b32 a76, 1.0
    v_accvgpr_write_b32 a77, 1.0
    v_mfma_f32_16x16x32_bf16 v[76:79], a[208:211], v[200:203], v[76:79]
    s_add_u32 m0, s49, 50048
    v_accvgpr_write_b32 a78, 1.0
    v_accvgpr_write_b32 a79, 1.0
    v_mfma_f32_16x16x32_bf16 v[84:87], a[208:211], v[208:211], v[84:87]
    ds_read_b128 a[204:207], v17 offset:7168
    v_accvgpr_write_b32 a80, 1.0
    v_mfma_f32_16x16x32_bf16 v[84:87], a[212:215], v[240:243], v[84:87]
    buffer_load_dwordx4 v4, s[12:15], s38 offen offset:128 lds
    v_mfma_f32_16x16x32_bf16 v[92:95], a[212:215], v[248:251], v[92:95]
    v_accvgpr_write_b32 a81, 1.0
    v_accvgpr_write_b32 a82, 1.0
    v_mfma_f32_16x16x32_bf16 v[92:95], a[208:211], v[216:219], v[92:95]
    s_waitcnt lgkmcnt(2)
    v_accvgpr_write_b32 a83, 1.0
    v_accvgpr_write_b32 a84, 1.0
    v_mfma_f32_16x16x32_bf16 v[124:127], a[192:195], v[88:91], v[44:47]
    ds_read_b128 a[208:211], v16 offset:8192
    v_accvgpr_write_b32 a85, 1.0
    v_mfma_f32_16x16x32_bf16 v[124:127], a[196:199], v[120:123], v[124:127]
    v_accvgpr_write_b32 a86, 1.0
    v_accvgpr_write_b32 a87, 1.0
    v_mfma_f32_16x16x32_bf16 v[116:119], a[196:199], v[112:115], v[40:43]
    s_add_u32 m0, s49, 50944
    v_accvgpr_write_b32 a88, 1.0
    v_accvgpr_write_b32 a89, 1.0
    v_mfma_f32_16x16x32_bf16 v[116:119], a[192:195], v[80:83], v[116:119]
    buffer_load_dwordx4 v4, s[12:15], s38 offen offset:256 lds
    v_mfma_f32_16x16x32_bf16 v[108:111], a[192:195], v[72:75], v[36:39]
    ds_read_b128 a[212:215], v17 offset:8192
    v_accvgpr_write_b32 a90, 1.0
    v_mfma_f32_16x16x32_bf16 v[108:111], a[196:199], v[104:107], v[108:111]
    v_accvgpr_write_b32 a91, 1.0
    v_accvgpr_write_b32 a92, 1.0
    v_mfma_f32_16x16x32_bf16 v[100:103], a[196:199], v[96:99], v[32:35]
    v_accvgpr_write_b32 a93, 1.0
    v_accvgpr_write_b32 a94, 1.0
    v_mfma_f32_16x16x32_bf16 v[100:103], a[192:195], v[64:67], v[100:103]
    s_waitcnt lgkmcnt(2)
    v_accvgpr_write_b32 a95, 1.0
    v_mfma_f32_16x16x32_bf16 v[100:103], a[200:203], v[128:131], v[100:103]
    s_add_u32 m0, s49, 52224
    ds_read_b128 a[192:195], v16 offset:12288
    v_mfma_f32_16x16x32_bf16 v[100:103], a[204:207], v[160:163], v[100:103]
    buffer_load_dwordx4 v5, s[12:15], s38 offen offset:0 lds
    v_mfma_f32_16x16x32_bf16 v[108:111], a[204:207], v[168:171], v[108:111]
    v_exp_f32 v48, v68
    v_mfma_f32_16x16x32_bf16 v[108:111], a[200:203], v[136:139], v[108:111]
    v_exp_f32 v49, v69
    v_mfma_f32_16x16x32_bf16 v[116:119], a[200:203], v[144:147], v[116:119]
    ds_read_b128 a[196:199], v17 offset:12288
    v_cvt_pk_bf16_f32 v196, v48, v49
    v_mfma_f32_16x16x32_bf16 v[116:119], a[204:207], v[176:179], v[116:119]
    v_exp_f32 v50, v70
    v_mfma_f32_16x16x32_bf16 v[124:127], a[204:207], v[184:187], v[124:127]
    v_exp_f32 v51, v71
    v_mfma_f32_16x16x32_bf16 v[124:127], a[200:203], v[152:155], v[124:127]
    s_waitcnt lgkmcnt(2)
    v_add_f32 v24, v48, v49
    v_add_f32 v24, v24, v50
    v_mfma_f32_16x16x32_bf16 v[124:127], a[208:211], v[216:219], v[124:127]
    s_add_u32 m0, s49, 53120
    ds_read_b128 a[200:203], v16 offset:13312
    v_cvt_pk_bf16_f32 v197, v50, v51
    v_mfma_f32_16x16x32_bf16 v[124:127], a[212:215], v[248:251], v[124:127]
    buffer_load_dwordx4 v5, s[12:15], s38 offen offset:128 lds
    v_mfma_f32_16x16x32_bf16 v[116:119], a[212:215], v[240:243], v[116:119]
    v_exp_f32 v48, v76
    v_mfma_f32_16x16x32_bf16 v[116:119], a[208:211], v[208:211], v[116:119]
    v_add_f32 v24, v24, v51
    v_mfma_f32_16x16x32_bf16 v[108:111], a[208:211], v[200:203], v[108:111]
    ds_read_b128 a[204:207], v17 offset:13312
    v_mfma_f32_16x16x32_bf16 v[108:111], a[212:215], v[232:235], v[108:111]
    s_add_u32 m0, s49, 54016
    v_exp_f32 v49, v77
    v_mfma_f32_16x16x32_bf16 v[100:103], a[212:215], v[224:227], v[100:103]
    buffer_load_dwordx4 v5, s[12:15], s38 offen offset:256 lds
    v_mfma_f32_16x16x32_bf16 v[100:103], a[208:211], v[192:195], v[100:103]
    s_waitcnt lgkmcnt(2)
    v_exp_f32 v50, v78
    v_mfma_f32_16x16x32_bf16 v[132:135], a[192:195], v[64:67], v[32:35]
    s_add_u32 s38, s38, 24576
    ds_read_b128 a[208:211], v16 offset:14336
    v_cvt_pk_bf16_f32 v204, v48, v49
    v_mfma_f32_16x16x32_bf16 v[132:135], a[196:199], v[96:99], v[132:135]
    v_exp_f32 v51, v79
    v_mfma_f32_16x16x32_bf16 v[140:143], a[196:199], v[104:107], v[36:39]
    v_add_f32 v25, v48, v49
    v_add_f32 v25, v25, v50
    v_mfma_f32_16x16x32_bf16 v[140:143], a[192:195], v[72:75], v[140:143]
    v_exp_f32 v48, v84
    v_mfma_f32_16x16x32_bf16 v[148:151], a[192:195], v[80:83], v[40:43]
    s_add_u32 m0, s49, 98304
    ds_read_b128 a[212:215], v17 offset:14336
    v_cvt_pk_bf16_f32 v205, v50, v51
    v_mfma_f32_16x16x32_bf16 v[148:151], a[196:199], v[112:115], v[148:151]
    buffer_load_dwordx4 v6, s[16:19], s40 offen offset:0 lds
    v_mfma_f32_16x16x32_bf16 v[156:159], a[196:199], v[120:123], v[44:47]
    v_exp_f32 v52, v100
    v_mfma_f32_16x16x32_bf16 v[156:159], a[192:195], v[88:91], v[156:159]
    s_waitcnt lgkmcnt(2)
    v_exp_f32 v53, v101
    v_mfma_f32_16x16x32_bf16 v[156:159], a[200:203], v[152:155], v[156:159]
    ds_read_b128 a[192:195], v16 offset:18432
    v_add_f32 v24, v24, v52
    v_mfma_f32_16x16x32_bf16 v[156:159], a[204:207], v[184:187], v[156:159]
    v_exp_f32 v54, v102
    v_mfma_f32_16x16x32_bf16 v[148:151], a[204:207], v[176:179], v[148:151]
    s_add_u32 m0, s49, 99200
    v_exp_f32 v55, v103
    v_mfma_f32_16x16x32_bf16 v[148:151], a[200:203], v[144:147], v[148:151]
    buffer_load_dwordx4 v6, s[16:19], s40 offen offset:128 lds
    v_mfma_f32_16x16x32_bf16 v[140:143], a[200:203], v[136:139], v[140:143]
    ds_read_b128 a[196:199], v17 offset:18432
    v_cvt_pk_bf16_f32 v198, v52, v53
    v_mfma_f32_16x16x32_bf16 v[140:143], a[204:207], v[168:171], v[140:143]
    v_add_f32 v24, v24, v53
    v_add_f32 v24, v24, v54
    v_mfma_f32_16x16x32_bf16 v[132:135], a[204:207], v[160:163], v[132:135]
    v_exp_f32 v52, v108
    v_mfma_f32_16x16x32_bf16 v[132:135], a[200:203], v[128:131], v[132:135]
    s_waitcnt lgkmcnt(2)
    v_cvt_pk_bf16_f32 v199, v54, v55
    v_add_f32 v24, v24, v55
    v_mfma_f32_16x16x32_bf16 v[132:135], a[208:211], v[192:195], v[132:135]
    ds_read_b128 a[200:203], v16 offset:19456
    v_add_f32 v25, v25, v51
    v_mfma_f32_16x16x32_bf16 v[132:135], a[212:215], v[224:227], v[132:135]
    s_add_u32 m0, s49, 100096
    v_exp_f32 v53, v109
    v_mfma_f32_16x16x32_bf16 v[140:143], a[212:215], v[232:235], v[140:143]
    buffer_load_dwordx4 v6, s[16:19], s40 offen offset:256 lds
    v_mfma_f32_16x16x32_bf16 v[140:143], a[208:211], v[200:203], v[140:143]
    v_exp_f32 v54, v110
    v_mfma_f32_16x16x32_bf16 v[148:151], a[208:211], v[208:211], v[148:151]
    ds_read_b128 a[204:207], v17 offset:19456
    v_add_f32 v25, v25, v52
    v_mfma_f32_16x16x32_bf16 v[148:151], a[212:215], v[240:243], v[148:151]
    v_exp_f32 v55, v111
    v_mfma_f32_16x16x32_bf16 v[156:159], a[212:215], v[248:251], v[156:159]
    v_exp_f32 v49, v85
    v_mfma_f32_16x16x32_bf16 v[156:159], a[208:211], v[216:219], v[156:159]
    s_waitcnt lgkmcnt(2)
    v_exp_f32 v50, v86
    v_mfma_f32_16x16x32_bf16 v[188:191], a[192:195], v[88:91], v[44:47]
    s_add_u32 m0, s49, 101376
    ds_read_b128 a[208:211], v16 offset:20480
    v_cvt_pk_bf16_f32 v206, v52, v53
    v_mfma_f32_16x16x32_bf16 v[188:191], a[196:199], v[120:123], v[188:191]
    buffer_load_dwordx4 v7, s[16:19], s40 offen offset:0 lds
    v_mfma_f32_16x16x32_bf16 v[180:183], a[196:199], v[112:115], v[40:43]
    v_add_f32 v25, v25, v53
    v_add_f32 v25, v25, v54
    v_mfma_f32_16x16x32_bf16 v[180:183], a[192:195], v[80:83], v[180:183]
    v_exp_f32 v51, v87
    v_mfma_f32_16x16x32_bf16 v[172:175], a[192:195], v[72:75], v[36:39]
    ds_read_b128 a[212:215], v17 offset:20480
    v_cvt_pk_bf16_f32 v207, v54, v55
    v_mfma_f32_16x16x32_bf16 v[172:175], a[196:199], v[104:107], v[172:175]
    s_waitcnt vmcnt(14)
    v_exp_f32 v52, v116
    v_mfma_f32_16x16x32_bf16 v[164:167], a[196:199], v[96:99], v[32:35]
    s_barrier
    v_mfma_f32_16x16x32_bf16 v[164:167], a[192:195], v[64:67], v[164:167]
    s_waitcnt lgkmcnt(2)
    v_add_f32 v25, v25, v55
    v_cvt_pk_bf16_f32 v212, v48, v49
    v_add_u32 v16, s42, v18
    v_mfma_f32_16x16x32_bf16 v[164:167], a[200:203], v[128:131], v[164:167]
    s_add_u32 m0, s49, 102272
    ds_read_b128 a[224:227], v16 offset:0
    v_add_f32 v26, v48, v49
    v_mfma_f32_16x16x32_bf16 v[164:167], a[204:207], v[160:163], v[164:167]
    buffer_load_dwordx4 v7, s[16:19], s40 offen offset:128 lds
    v_add_u32 v17, s42, v19
    v_mfma_f32_16x16x32_bf16 v[172:175], a[204:207], v[168:171], v[172:175]
    ds_read_b128 a[228:231], v17 offset:0
    v_add_f32 v26, v26, v50
    v_mfma_f32_16x16x32_bf16 v[172:175], a[200:203], v[136:139], v[172:175]
    v_exp_f32 v53, v117
    v_mfma_f32_16x16x32_bf16 v[180:183], a[200:203], v[144:147], v[180:183]
    s_add_u32 m0, s49, 103168
    ds_read_b128 a[232:235], v16 offset:1024
    v_cvt_pk_bf16_f32 v213, v50, v51
    v_mfma_f32_16x16x32_bf16 v[180:183], a[204:207], v[176:179], v[180:183]
    buffer_load_dwordx4 v7, s[16:19], s40 offen offset:256 lds
    v_mfma_f32_16x16x32_bf16 v[188:191], a[204:207], v[184:187], v[188:191]
    s_add_u32 s40, s40, 24576
    ds_read_b128 a[236:239], v17 offset:1024
    v_add_f32 v26, v26, v51
    v_mfma_f32_16x16x32_bf16 v[188:191], a[200:203], v[152:155], v[188:191]
    s_waitcnt lgkmcnt(4)
    v_exp_f32 v54, v118
    v_mfma_f32_16x16x32_bf16 v[188:191], a[208:211], v[216:219], v[188:191]
    ds_read_b128 a[240:243], v16 offset:2048
    v_add_f32 v26, v26, v52
    v_mfma_f32_16x16x32_bf16 v[188:191], a[212:215], v[248:251], v[188:191]
    v_exp_f32 v55, v119
    v_mfma_f32_16x16x32_bf16 v[180:183], a[212:215], v[240:243], v[180:183]
    ds_read_b128 a[244:247], v17 offset:2048
    v_cvt_pk_bf16_f32 v214, v52, v53
    v_mfma_f32_16x16x32_bf16 v[180:183], a[208:211], v[208:211], v[180:183]
    v_exp_f32 v48, v92
    v_mfma_f32_16x16x32_bf16 v[172:175], a[208:211], v[200:203], v[172:175]
    v_exp_f32 v49, v93
    v_mfma_f32_16x16x32_bf16 v[172:175], a[212:215], v[232:235], v[172:175]
    v_exp_f32 v50, v94
    v_mfma_f32_16x16x32_bf16 v[164:167], a[212:215], v[224:227], v[164:167]
    v_add_f32 v26, v26, v53
    v_add_f32 v26, v26, v54
    v_mfma_f32_16x16x32_bf16 v[164:167], a[208:211], v[192:195], v[164:167]
    v_cvt_pk_bf16_f32 v215, v54, v55
    v_add_f32 v26, v26, v55
    v_max3_f32 v29, v24, v25, v26
    v_cvt_pk_bf16_f32 v220, v48, v49
    v_exp_f32 v51, v95
    v_add_f32 v27, v48, v49
    v_cvt_pk_bf16_f32 v221, v50, v51
    v_exp_f32 v52, v124
    v_exp_f32 v53, v125
    v_add_f32 v27, v27, v50
    v_cvt_pk_bf16_f32 v222, v52, v53
    v_exp_f32 v54, v126
    v_exp_f32 v55, v127
    v_add_f32 v27, v27, v51
    v_cvt_pk_bf16_f32 v223, v54, v55
    v_add_f32 v27, v27, v52
    v_add_f32 v27, v27, v53
    v_add_f32 v27, v27, v54
    v_add_f32 v27, v27, v55
    v_max_f32 v29, v29, v27
    v_cmp_nle_f32 vcc, v29, v30
    v_min3_f32 v29, v24, v25, v26
    v_min_f32 v29, v29, v27
    v_cmp_gt_f32 s[88:89], v56, v29
    s_or_b64 vcc, vcc, s[88:89]
    s_cbranch_vccnz rare_p
rare_p_ret:
    s_waitcnt lgkmcnt(0)
at_switch:
at_dry:
    s_mov_b32 s76, 0
    s_branch at_loop
    .p2align 12
pg_6:
    s_cbranch_execz pg_10
at_loop:
    v_mfma_f32_16x16x32_bf16 v[68:71], a[224:227], v[64:67], v[32:35]
    ds_read_b128 a[192:195], v16 offset:6144
    v_add_f32 v20, v20, v24
    v_mfma_f32_16x16x32_bf16 v[68:71], a[228:231], v[96:99], v[68:71]
    s_add_u32 s77, s38, s76
    v_add_f32 v21, v21, v25
    v_add_f32 v22, v22, v26
    v_mfma_f32_16x16x32_bf16 v[68:71], a[232:235], v[128:131], v[68:71]
    v_add_f32 v23, v23, v27
    v_add_u32 v8, s41, v12
    v_mfma_f32_16x16x32_bf16 v[68:71], a[236:239], v[160:163], v[68:71]
    ds_read_b128 a[196:199], v17 offset:6144
    v_add_u32 v9, s41, v13
    v_mfma_f32_16x16x32_bf16 v[68:71], a[240:243], v[192:195], v[68:71]
    v_exp_f32 v48, v132
    v_mfma_f32_16x16x32_bf16 v[68:71], a[244:247], v[224:227], v[68:71]
    s_add_u32 m0, s41, 0
    v_exp_f32 v49, v133
    v_mfma_f32_16x16x32_bf16 v[76:79], a[244:247], v[232:235], v[36:39]
    ds_read_b128 a[200:203], v16 offset:7168
    v_cvt_pk_bf16_f32 v228, v48, v49
    v_mfma_f32_16x16x32_bf16 v[76:79], a[240:243], v[200:203], v[76:79]
    buffer_load_dwordx4 v4, s[12:15], s38 offen offset:0 lds
    v_mfma_f32_16x16x32_bf16 v[76:79], a[236:239], v[168:171], v[76:79]
    v_exp_f32 v50, v134
    v_mfma_f32_16x16x32_bf16 v[76:79], a[232:235], v[136:139], v[76:79]
    ds_read_b128 a[204:207], v17 offset:7168
    v_add_f32 v24, v48, v49
    v_mfma_f32_16x16x32_bf16 v[76:79], a[228:231], v[104:107], v[76:79]
    v_exp_f32 v51, v135
    v_mfma_f32_16x16x32_bf16 v[76:79], a[224:227], v[72:75], v[76:79]
    v_exp_f32 v52, v164
    v_mfma_f32_16x16x32_bf16 v[84:87], a[224:227], v[80:83], v[40:43]
    ds_read_b128 a[208:211], v16 offset:8192
    v_add_f32 v24, v24, v50
    v_mfma_f32_16x16x32_bf16 v[84:87], a[228:231], v[112:115], v[84:87]
    v_exp_f32 v53, v165
    v_mfma_f32_16x16x32_bf16 v[84:87], a[232:235], v[144:147], v[84:87]
    v_exp_f32 v54, v166
    v_mfma_f32_16x16x32_bf16 v[84:87], a[236:239], v[176:179], v[84:87]
    ds_read_b128 a[212:215], v17 offset:8192
    v_add_u32 v10, s41, v14
    v_mfma_f32_16x16x32_bf16 v[84:87], a[240:243], v[208:211], v[84:87]
    v_exp_f32 v55, v167
    v_mfma_f32_16x16x32_bf16 v[84:87], a[244:247], v[240:243], v[84:87]
    s_add_u32 m0, s41, 896
    v_cvt_pk_bf16_f32 v229, v50, v51
    v_add_f32 v24, v24, v51
    v_mfma_f32_16x16x32_bf16 v[92:95], a[244:247], v[248:251], v[44:47]
    buffer_load_dwordx4 v4, s[12:15], s38 offen offset:128 lds
    v_mfma_f32_16x16x32_bf16 v[92:95], a[240:243], v[216:219], v[92:95]
    v_exp_f32 v48, v140
    v_mfma_f32_16x16x32_bf16 v[92:95], a[236:239], v[184:187], v[92:95]
    v_add_u32 v11, s41, v15
    v_add_f32 v24, v24, v52
    v_mfma_f32_16x16x32_bf16 v[92:95], a[232:235], v[152:155], v[92:95]
    v_exp_f32 v49, v141
    v_mfma_f32_16x16x32_bf16 v[92:95], a[228:231], v[120:123], v[92:95]
    v_cvt_pk_bf16_f32 v230, v52, v53
    v_add_f32 v24, v24, v53
    v_mfma_f32_16x16x32_bf16 v[92:95], a[224:227], v[88:91], v[92:95]
    s_waitcnt lgkmcnt(0)
    v_exp_f32 v50, v142
    v_mfma_f32_16x16x32_bf16 v[124:127], a[192:195], v[88:91], v[44:47]
    ds_read_b64_tr_b16 a[224:225], v8 offset:0
    v_add_f32 v24, v24, v54
    v_mfma_f32_16x16x32_bf16 v[124:127], a[196:199], v[120:123], v[124:127]
    ds_read_b64_tr_b16 a[226:227], v8 offset:6144
    v_cvt_pk_bf16_f32 v231, v54, v55
    v_mfma_f32_16x16x32_bf16 v[124:127], a[200:203], v[152:155], v[124:127]
    v_exp_f32 v51, v143
    v_mfma_f32_16x16x32_bf16 v[124:127], a[204:207], v[184:187], v[124:127]
    ds_read_b64_tr_b16 a[228:229], v9 offset:0
    v_add_f32 v24, v24, v55
    v_mfma_f32_16x16x32_bf16 v[124:127], a[208:211], v[216:219], v[124:127]
    ds_read_b64_tr_b16 a[230:231], v9 offset:6144
    v_cvt_pk_bf16_f32 v236, v48, v49
    v_mfma_f32_16x16x32_bf16 v[124:127], a[212:215], v[248:251], v[124:127]
    v_exp_f32 v52, v172
    v_mfma_f32_16x16x32_bf16 v[116:119], a[212:215], v[240:243], v[40:43]
    ds_read_b64_tr_b16 a[232:233], v10 offset:0
    v_add_f32 v25, v48, v49
    v_mfma_f32_16x16x32_bf16 v[116:119], a[208:211], v[208:211], v[116:119]
    s_add_u32 m0, s41, 1792
    ds_read_b64_tr_b16 a[234:235], v10 offset:6144
    v_add_f32 v25, v25, v50
    v_mfma_f32_16x16x32_bf16 v[116:119], a[204:207], v[176:179], v[116:119]
    buffer_load_dwordx4 v4, s[12:15], s77 offen offset:256 lds
    v_mfma_f32_16x16x32_bf16 v[116:119], a[200:203], v[144:147], v[116:119]
    ds_read_b64_tr_b16 a[236:237], v11 offset:0
    v_cvt_pk_bf16_f32 v237, v50, v51
    v_mfma_f32_16x16x32_bf16 v[116:119], a[196:199], v[112:115], v[116:119]
    ds_read_b64_tr_b16 a[238:239], v11 offset:6144
    v_add_f32 v25, v25, v51
    v_mfma_f32_16x16x32_bf16 v[116:119], a[192:195], v[80:83], v[116:119]
    v_exp_f32 v53, v173
    v_mfma_f32_16x16x32_bf16 v[108:111], a[192:195], v[72:75], v[36:39]
    ds_read_b64_tr_b16 a[240:241], v8 offset:1024
    v_add_f32 v25, v25, v52
    v_mfma_f32_16x16x32_bf16 v[108:111], a[196:199], v[104:107], v[108:111]
    ds_read_b64_tr_b16 a[242:243], v8 offset:7168
    v_cvt_pk_bf16_f32 v238, v52, v53
    v_mfma_f32_16x16x32_bf16 v[108:111], a[200:203], v[136:139], v[108:111]
    v_exp_f32 v54, v174
    v_mfma_f32_16x16x32_bf16 v[108:111], a[204:207], v[168:171], v[108:111]
    ds_read_b64_tr_b16 a[244:245], v9 offset:1024
    v_add_f32 v25, v25, v53
    v_mfma_f32_16x16x32_bf16 v[108:111], a[208:211], v[200:203], v[108:111]
    ds_read_b64_tr_b16 a[246:247], v9 offset:7168
    v_add_f32 v25, v25, v54
    v_mfma_f32_16x16x32_bf16 v[108:111], a[212:215], v[232:235], v[108:111]
    v_exp_f32 v55, v175
    v_mfma_f32_16x16x32_bf16 v[100:103], a[212:215], v[224:227], v[32:35]
    v_exp_f32 v48, v148
    v_mfma_f32_16x16x32_bf16 v[100:103], a[208:211], v[192:195], v[100:103]
    v_exp_f32 v49, v149
    v_mfma_f32_16x16x32_bf16 v[100:103], a[204:207], v[160:163], v[100:103]
    v_exp_f32 v50, v150
    v_mfma_f32_16x16x32_bf16 v[100:103], a[200:203], v[128:131], v[100:103]
    s_add_u32 m0, s41, 3072
    v_exp_f32 v51, v151
    v_mfma_f32_16x16x32_bf16 v[100:103], a[196:199], v[96:99], v[100:103]
    buffer_load_dwordx4 v5, s[12:15], s38 offen offset:0 lds
    v_mfma_f32_16x16x32_bf16 v[100:103], a[192:195], v[64:67], v[100:103]
    s_waitcnt lgkmcnt(0)
    v_cvt_pk_bf16_f32 v239, v54, v55
    v_add_f32 v25, v25, v55
    v_mfma_f32_16x16x32_bf16 a[0:3], a[224:227], v[196:199], a[0:3]
    ds_read_b64_tr_b16 a[192:193], v10 offset:1024
    v_cvt_pk_bf16_f32 v244, v48, v49
    v_mfma_f32_16x16x32_bf16 a[16:19], a[228:231], v[196:199], a[16:19]
    ds_read_b64_tr_b16 a[194:195], v10 offset:7168
    v_add_f32 v26, v48, v49
    v_mfma_f32_16x16x32_bf16 a[32:35], a[232:235], v[196:199], a[32:35]
    v_exp_f32 v52, v180
    v_mfma_f32_16x16x32_bf16 a[48:51], a[236:239], v[196:199], a[48:51]
    ds_read_b64_tr_b16 a[196:197], v11 offset:1024
    v_add_f32 v26, v26, v50
    v_mfma_f32_16x16x32_bf16 a[64:67], a[240:243], v[196:199], a[64:67]
    ds_read_b64_tr_b16 a[198:199], v11 offset:7168
    v_cvt_pk_bf16_f32 v245, v50, v51
    v_mfma_f32_16x16x32_bf16 a[80:83], a[244:247], v[196:199], a[80:83]
    v_exp_f32 v53, v181
    v_mfma_f32_16x16x32_bf16 a[84:87], a[244:247], v[204:207], a[84:87]
    ds_read_b64_tr_b16 a[200:201], v8 offset:2048
    v_add_f32 v26, v26, v51
    v_mfma_f32_16x16x32_bf16 a[68:71], a[240:243], v[204:207], a[68:71]
    ds_read_b64_tr_b16 a[202:203], v8 offset:8192
    v_add_f32 v26, v26, v52
    v_mfma_f32_16x16x32_bf16 a[52:55], a[236:239], v[204:207], a[52:55]
    v_exp_f32 v54, v182
    v_mfma_f32_16x16x32_bf16 a[36:39], a[232:235], v[204:207], a[36:39]
    ds_read_b64_tr_b16 a[204:205], v9 offset:2048
    v_cvt_pk_bf16_f32 v246, v52, v53
    v_mfma_f32_16x16x32_bf16 a[20:23], a[228:231], v[204:207], a[20:23]
    ds_read_b64_tr_b16 a[206:207], v9 offset:8192
    v_add_f32 v26, v26, v53
    v_mfma_f32_16x16x32_bf16 a[4:7], a[224:227], v[204:207], a[4:7]
    s_add_u32 m0, s41, 3968
    v_exp_f32 v55, v183
    v_mfma_f32_16x16x32_bf16 a[8:11], a[224:227], v[212:215], a[8:11]
    ds_read_b64_tr_b16 a[208:209], v10 offset:2048
    v_add_f32 v26, v26, v54
    v_mfma_f32_16x16x32_bf16 a[24:27], a[228:231], v[212:215], a[24:27]
    ds_read_b64_tr_b16 a[210:211], v10 offset:8192
    v_cvt_pk_bf16_f32 v247, v54, v55
    v_mfma_f32_16x16x32_bf16 a[40:43], a[232:235], v[212:215], a[40:43]
    buffer_load_dwordx4 v5, s[12:15], s38 offen offset:128 lds
    v_mfma_f32_16x16x32_bf16 a[56:59], a[236:239], v[212:215], a[56:59]
    ds_read_b64_tr_b16 a[212:213], v11 offset:2048
    v_add_f32 v26, v26, v55
    v_mfma_f32_16x16x32_bf16 a[72:75], a[240:243], v[212:215], a[72:75]
    ds_read_b64_tr_b16 a[214:215], v11 offset:8192
    v_max3_f32 v29, v24, v25, v26
    v_mfma_f32_16x16x32_bf16 a[88:91], a[244:247], v[212:215], a[88:91]
    v_exp_f32 v48, v156
    v_mfma_f32_16x16x32_bf16 a[92:95], a[244:247], v[220:223], a[92:95]
    v_exp_f32 v49, v157
    v_mfma_f32_16x16x32_bf16 a[76:79], a[240:243], v[220:223], a[76:79]
    v_exp_f32 v50, v158
    v_mfma_f32_16x16x32_bf16 a[60:63], a[236:239], v[220:223], a[60:63]
    v_exp_f32 v51, v159
    v_mfma_f32_16x16x32_bf16 a[44:47], a[232:235], v[220:223], a[44:47]
    v_exp_f32 v52, v188
    v_mfma_f32_16x16x32_bf16 a[28:31], a[228:231], v[220:223], a[28:31]
    v_exp_f32 v53, v189
    v_mfma_f32_16x16x32_bf16 a[12:15], a[224:227], v[220:223], a[12:15]
    s_waitcnt lgkmcnt(0)
    v_cvt_pk_bf16_f32 v252, v48, v49
    v_add_f32 v27, v48, v49
    v_mfma_f32_16x16x32_bf16 a[108:111], a[192:195], v[220:223], a[108:111]
    ds_read_b128 a[224:227], v16 offset:12288
    v_add_f32 v27, v27, v50
    v_mfma_f32_16x16x32_bf16 a[124:127], a[196:199], v[220:223], a[124:127]
    s_add_u32 m0, s41, 4864
    v_exp_f32 v54, v190
    v_mfma_f32_16x16x32_bf16 a[140:143], a[200:203], v[220:223], a[140:143]
    buffer_load_dwordx4 v5, s[12:15], s77 offen offset:256 lds
    v_mfma_f32_16x16x32_bf16 a[156:159], a[204:207], v[220:223], a[156:159]
    ds_read_b128 a[228:231], v17 offset:12288
    v_cvt_pk_bf16_f32 v253, v50, v51
    v_mfma_f32_16x16x32_bf16 a[172:175], a[208:211], v[220:223], a[172:175]
    s_add_u32 s38, s38, s39
    v_exp_f32 v55, v191
    v_mfma_f32_16x16x32_bf16 a[188:191], a[212:215], v[220:223], a[188:191]
    s_add_u32 s77, s40, s66
    v_add_f32 v27, v27, v51
    v_mfma_f32_16x16x32_bf16 a[184:187], a[212:215], v[212:215], a[184:187]
    ds_read_b128 a[232:235], v16 offset:13312
    v_add_f32 v27, v27, v52
    v_mfma_f32_16x16x32_bf16 a[168:171], a[208:211], v[212:215], a[168:171]
    v_cvt_pk_bf16_f32 v254, v52, v53
    v_mfma_f32_16x16x32_bf16 a[152:155], a[204:207], v[212:215], a[152:155]
    v_add_f32 v27, v27, v53
    v_mfma_f32_16x16x32_bf16 a[136:139], a[200:203], v[212:215], a[136:139]
    ds_read_b128 a[236:239], v17 offset:13312
    v_add_f32 v27, v27, v54
    v_mfma_f32_16x16x32_bf16 a[120:123], a[196:199], v[212:215], a[120:123]
    v_cvt_pk_bf16_f32 v255, v54, v55
    v_mfma_f32_16x16x32_bf16 a[104:107], a[192:195], v[212:215], a[104:107]
    v_add_f32 v27, v27, v55
    v_mfma_f32_16x16x32_bf16 a[100:103], a[192:195], v[204:207], a[100:103]
    ds_read_b128 a[240:243], v16 offset:14336
    v_max_f32 v29, v29, v27
    v_mfma_f32_16x16x32_bf16 a[116:119], a[196:199], v[204:207], a[116:119]
    v_cmp_nle_f32 vcc, v29, v30
    v_mfma_f32_16x16x32_bf16 a[132:135], a[200:203], v[204:207], a[132:135]
    v_mfma_f32_16x16x32_bf16 a[148:151], a[204:207], v[204:207], a[148:151]
    s_add_u32 m0, s43, 73728
    ds_read_b128 a[244:247], v17 offset:14336
    v_mfma_f32_16x16x32_bf16 a[164:167], a[208:211], v[204:207], a[164:167]
    buffer_load_dwordx4 v6, s[16:19], s40 offen offset:0 lds
    v_mfma_f32_16x16x32_bf16 a[180:183], a[212:215], v[204:207], a[180:183]
    v_mfma_f32_16x16x32_bf16 a[176:179], a[212:215], v[196:199], a[176:179]
    s_cmp_eq_u32 s45, 2
    s_cselect_b64 s[88:89], -1, 0
    s_cselect_b64 s[12:13], s[8:9], s[12:13]
    v_mfma_f32_16x16x32_bf16 a[160:163], a[208:211], v[196:199], a[160:163]
    s_cmp_eq_u32 s45, 2
    s_cselect_b32 s14, s10, s14
    s_cselect_b32 s38, s36, s38
    v_mfma_f32_16x16x32_bf16 a[144:147], a[204:207], v[196:199], a[144:147]
    s_cmp_eq_u32 s45, 2
    s_cselect_b32 s39, 81920, s39
    s_cselect_b32 s76, s63, s76
    v_mfma_f32_16x16x32_bf16 a[128:131], a[200:203], v[196:199], a[128:131]
    v_cndmask_b32 v4, v4, v62, s[88:89]
    v_cndmask_b32 v5, v5, v63, s[88:89]
    v_mfma_f32_16x16x32_bf16 a[112:115], a[196:199], v[196:199], a[112:115]
    v_mfma_f32_16x16x32_bf16 a[96:99], a[192:195], v[196:199], a[96:99]
    s_waitcnt lgkmcnt(0)
    s_cbranch_vccnz rare_a
rare_a_ret:
    v_mfma_f32_16x16x32_bf16 v[132:135], a[224:227], v[64:67], v[32:35]
    ds_read_b128 a[192:195], v16 offset:18432
    v_add_f32 v20, v20, v24
    v_mfma_f32_16x16x32_bf16 v[132:135], a[228:231], v[96:99], v[132:135]
    v_add_f32 v21, v21, v25
    v_add_f32 v22, v22, v26
    v_mfma_f32_16x16x32_bf16 v[132:135], a[232:235], v[128:131], v[132:135]
    v_add_f32 v23, v23, v27
    v_mfma_f32_16x16x32_bf16 v[132:135], a[236:239], v[160:163], v[132:135]
    ds_read_b128 a[196:199], v17 offset:18432
    v_mfma_f32_16x16x32_bf16 v[132:135], a[240:243], v[192:195], v[132:135]
    v_exp_f32 v48, v68
    v_mfma_f32_16x16x32_bf16 v[132:135], a[244:247], v[224:227], v[132:135]
    s_add_u32 m0, s43, 74624
    v_exp_f32 v49, v69
    v_mfma_f32_16x16x32_bf16 v[140:143], a[244:247], v[232:235], v[36:39]
    ds_read_b128 a[200:203], v16 offset:19456
    v_cvt_pk_bf16_f32 v196, v48, v49
    v_mfma_f32_16x16x32_bf16 v[140:143], a[240:243], v[200:203], v[140:143]
    buffer_load_dwordx4 v6, s[16:19], s40 offen offset:128 lds
    v_mfma_f32_16x16x32_bf16 v[140:143], a[236:239], v[168:171], v[140:143]
    v_exp_f32 v50, v70
    v_mfma_f32_16x16x32_bf16 v[140:143], a[232:235], v[136:139], v[140:143]
    ds_read_b128 a[204:207], v17 offset:19456
    v_add_f32 v24, v48, v49
    v_mfma_f32_16x16x32_bf16 v[140:143], a[228:231], v[104:107], v[140:143]
    v_exp_f32 v51, v71
    v_mfma_f32_16x16x32_bf16 v[140:143], a[224:227], v[72:75], v[140:143]
    v_exp_f32 v52, v100
    v_mfma_f32_16x16x32_bf16 v[148:151], a[224:227], v[80:83], v[40:43]
    ds_read_b128 a[208:211], v16 offset:20480
    v_add_f32 v24, v24, v50
    v_mfma_f32_16x16x32_bf16 v[148:151], a[228:231], v[112:115], v[148:151]
    v_exp_f32 v53, v101
    v_mfma_f32_16x16x32_bf16 v[148:151], a[232:235], v[144:147], v[148:151]
    v_exp_f32 v54, v102
    v_mfma_f32_16x16x32_bf16 v[148:151], a[236:239], v[176:179], v[148:151]
    ds_read_b128 a[212:215], v17 offset:20480
    v_cvt_pk_bf16_f32 v197, v50, v51
    v_mfma_f32_16x16x32_bf16 v[148:151], a[240:243], v[208:211], v[148:151]
    v_exp_f32 v55, v103
    v_mfma_f32_16x16x32_bf16 v[148:151], a[244:247], v[240:243], v[148:151]
    v_add_f32 v24, v24, v51
    v_add_f32 v24, v24, v52
    v_mfma_f32_16x16x32_bf16 v[156:159], a[244:247], v[248:251], v[44:47]
    v_exp_f32 v48, v76
    v_mfma_f32_16x16x32_bf16 v[156:159], a[240:243], v[216:219], v[156:159]
    s_add_u32 m0, s43, 75520
    v_exp_f32 v49, v77
    v_mfma_f32_16x16x32_bf16 v[156:159], a[236:239], v[184:187], v[156:159]
    buffer_load_dwordx4 v6, s[16:19], s77 offen offset:256 lds
    v_mfma_f32_16x16x32_bf16 v[156:159], a[232:235], v[152:155], v[156:159]
    v_cvt_pk_bf16_f32 v198, v52, v53
    v_add_f32 v24, v24, v53
    v_mfma_f32_16x16x32_bf16 v[156:159], a[228:231], v[120:123], v[156:159]
    v_exp_f32 v50, v78
    v_mfma_f32_16x16x32_bf16 v[156:159], a[224:227], v[88:91], v[156:159]
    s_waitcnt lgkmcnt(0)
    v_add_f32 v24, v24, v54
    v_cvt_pk_bf16_f32 v199, v54, v55
    v_mfma_f32_16x16x32_bf16 v[188:191], a[192:195], v[88:91], v[44:47]
    ds_read_b64_tr_b16 a[224:225], v8 offset:12288
    v_add_f32 v24, v24, v55
    v_mfma_f32_16x16x32_bf16 v[188:191], a[196:199], v[120:123], v[188:191]
    ds_read_b64_tr_b16 a[226:227], v8 offset:18432
    v_cvt_pk_bf16_f32 v204, v48, v49
    v_mfma_f32_16x16x32_bf16 v[188:191], a[200:203], v[152:155], v[188:191]
    v_exp_f32 v51, v79
    v_mfma_f32_16x16x32_bf16 v[188:191], a[204:207], v[184:187], v[188:191]
    ds_read_b64_tr_b16 a[228:229], v9 offset:12288
    v_add_f32 v25, v48, v49
    v_mfma_f32_16x16x32_bf16 v[188:191], a[208:211], v[216:219], v[188:191]
    ds_read_b64_tr_b16 a[230:231], v9 offset:18432
    v_add_f32 v25, v25, v50
    v_mfma_f32_16x16x32_bf16 v[188:191], a[212:215], v[248:251], v[188:191]
    v_exp_f32 v52, v108
    v_mfma_f32_16x16x32_bf16 v[180:183], a[212:215], v[240:243], v[40:43]
    ds_read_b64_tr_b16 a[232:233], v10 offset:12288
    v_cvt_pk_bf16_f32 v205, v50, v51
    v_mfma_f32_16x16x32_bf16 v[180:183], a[208:211], v[208:211], v[180:183]
    ds_read_b64_tr_b16 a[234:235], v10 offset:18432
    v_add_f32 v25, v25, v51
    v_mfma_f32_16x16x32_bf16 v[180:183], a[204:207], v[176:179], v[180:183]
    v_exp_f32 v53, v109
    v_mfma_f32_16x16x32_bf16 v[180:183], a[200:203], v[144:147], v[180:183]
    s_add_u32 m0, s43, 76800
    ds_read_b64_tr_b16 a[236:237], v11 offset:12288
    v_add_f32 v25, v25, v52
    v_mfma_f32_16x16x32_bf16 v[180:183], a[196:199], v[112:115], v[180:183]
    ds_read_b64_tr_b16 a[238:239], v11 offset:18432
    v_cvt_pk_bf16_f32 v206, v52, v53
    v_mfma_f32_16x16x32_bf16 v[180:183], a[192:195], v[80:83], v[180:183]
    buffer_load_dwordx4 v7, s[16:19], s40 offen offset:0 lds
    v_mfma_f32_16x16x32_bf16 v[172:175], a[192:195], v[72:75], v[36:39]
    ds_read_b64_tr_b16 a[240:241], v8 offset:13312
    v_add_f32 v25, v25, v53
    v_mfma_f32_16x16x32_bf16 v[172:175], a[196:199], v[104:107], v[172:175]
    ds_read_b64_tr_b16 a[242:243], v8 offset:19456
    v_add_u32 v16, s43, v18
    v_mfma_f32_16x16x32_bf16 v[172:175], a[200:203], v[136:139], v[172:175]
    v_exp_f32 v54, v110
    v_mfma_f32_16x16x32_bf16 v[172:175], a[204:207], v[168:171], v[172:175]
    ds_read_b64_tr_b16 a[244:245], v9 offset:13312
    v_add_f32 v25, v25, v54
    v_mfma_f32_16x16x32_bf16 v[172:175], a[208:211], v[200:203], v[172:175]
    ds_read_b64_tr_b16 a[246:247], v9 offset:19456
    v_add_u32 v17, s43, v19
    v_mfma_f32_16x16x32_bf16 v[172:175], a[212:215], v[232:235], v[172:175]
    v_exp_f32 v55, v111
    v_mfma_f32_16x16x32_bf16 v[164:167], a[212:215], v[224:227], v[32:35]
    v_exp_f32 v48, v84
    v_mfma_f32_16x16x32_bf16 v[164:167], a[208:211], v[192:195], v[164:167]
    v_exp_f32 v49, v85
    v_mfma_f32_16x16x32_bf16 v[164:167], a[204:207], v[160:163], v[164:167]
    v_exp_f32 v50, v86
    v_mfma_f32_16x16x32_bf16 v[164:167], a[200:203], v[128:131], v[164:167]
    v_exp_f32 v51, v87
    v_mfma_f32_16x16x32_bf16 v[164:167], a[196:199], v[96:99], v[164:167]
    v_cvt_pk_bf16_f32 v207, v54, v55
    v_add_f32 v25, v25, v55
    v_mfma_f32_16x16x32_bf16 v[164:167], a[192:195], v[64:67], v[164:167]
    s_waitcnt lgkmcnt(0)
    v_exp_f32 v52, v116
    v_mfma_f32_16x16x32_bf16 a[0:3], a[224:227], v[228:231], a[0:3]
    s_add_u32 m0, s43, 77696
    ds_read_b64_tr_b16 a[192:193], v10 offset:13312
    v_cvt_pk_bf16_f32 v212, v48, v49
    v_mfma_f32_16x16x32_bf16 a[16:19], a[228:231], v[228:231], a[16:19]
    ds_read_b64_tr_b16 a[194:195], v10 offset:19456
    v_add_f32 v26, v48, v49
    v_mfma_f32_16x16x32_bf16 a[32:35], a[232:235], v[228:231], a[32:35]
    buffer_load_dwordx4 v7, s[16:19], s40 offen offset:128 lds
    v_mfma_f32_16x16x32_bf16 a[48:51], a[236:239], v[228:231], a[48:51]
    ds_read_b64_tr_b16 a[196:197], v11 offset:13312
    v_add_f32 v26, v26, v50
    v_mfma_f32_16x16x32_bf16 a[64:67], a[240:243], v[228:231], a[64:67]
    ds_read_b64_tr_b16 a[198:199], v11 offset:19456
    v_cvt_pk_bf16_f32 v213, v50, v51
    v_mfma_f32_16x16x32_bf16 a[80:83], a[244:247], v[228:231], a[80:83]
    v_exp_f32 v53, v117
    v_mfma_f32_16x16x32_bf16 a[84:87], a[244:247], v[236:239], a[84:87]
    ds_read_b64_tr_b16 a[200:201], v8 offset:14336
    v_add_f32 v26, v26, v51
    v_mfma_f32_16x16x32_bf16 a[68:71], a[240:243], v[236:239], a[68:71]
    ds_read_b64_tr_b16 a[202:203], v8 offset:20480
    v_add_f32 v26, v26, v52
    v_mfma_f32_16x16x32_bf16 a[52:55], a[236:239], v[236:239], a[52:55]
    v_exp_f32 v54, v118
    v_mfma_f32_16x16x32_bf16 a[36:39], a[232:235], v[236:239], a[36:39]
    ds_read_b64_tr_b16 a[204:205], v9 offset:14336
    v_cvt_pk_bf16_f32 v214, v52, v53
    v_mfma_f32_16x16x32_bf16 a[20:23], a[228:231], v[236:239], a[20:23]
    ds_read_b64_tr_b16 a[206:207], v9 offset:20480
    v_add_f32 v26, v26, v53
    v_mfma_f32_16x16x32_bf16 a[4:7], a[224:227], v[236:239], a[4:7]
    v_exp_f32 v55, v119
    v_mfma_f32_16x16x32_bf16 a[8:11], a[224:227], v[244:247], a[8:11]
    ds_read_b64_tr_b16 a[208:209], v10 offset:14336
    v_add_f32 v26, v26, v54
    v_mfma_f32_16x16x32_bf16 a[24:27], a[228:231], v[244:247], a[24:27]
    s_add_u32 m0, s43, 78592
    ds_read_b64_tr_b16 a[210:211], v10 offset:20480
    v_cvt_pk_bf16_f32 v215, v54, v55
    v_mfma_f32_16x16x32_bf16 a[40:43], a[232:235], v[244:247], a[40:43]
    buffer_load_dwordx4 v7, s[16:19], s77 offen offset:256 lds
    v_mfma_f32_16x16x32_bf16 a[56:59], a[236:239], v[244:247], a[56:59]
    ds_read_b64_tr_b16 a[212:213], v11 offset:14336
    v_add_f32 v26, v26, v55
    v_mfma_f32_16x16x32_bf16 a[72:75], a[240:243], v[244:247], a[72:75]
    s_add_u32 s40, s40, 24576
    ds_read_b64_tr_b16 a[214:215], v11 offset:20480
    v_max3_f32 v29, v24, v25, v26
    v_mfma_f32_16x16x32_bf16 a[88:91], a[244:247], v[244:247], a[88:91]
    s_add_u32 s77, s38, s39
    v_exp_f32 v48, v92
    v_mfma_f32_16x16x32_bf16 a[92:95], a[244:247], v[252:255], a[92:95]
    v_exp_f32 v49, v93
    v_mfma_f32_16x16x32_bf16 a[76:79], a[240:243], v[252:255], a[76:79]
    v_exp_f32 v50, v94
    v_mfma_f32_16x16x32_bf16 a[60:63], a[236:239], v[252:255], a[60:63]
    v_exp_f32 v51, v95
    v_mfma_f32_16x16x32_bf16 a[44:47], a[232:235], v[252:255], a[44:47]
    s_waitcnt vmcnt(12)
    v_exp_f32 v52, v124
    v_mfma_f32_16x16x32_bf16 a[28:31], a[228:231], v[252:255], a[28:31]
    s_barrier
    v_mfma_f32_16x16x32_bf16 a[12:15], a[224:227], v[252:255], a[12:15]
    s_waitcnt lgkmcnt(0)
    v_exp_f32 v53, v125
    v_mfma_f32_16x16x32_bf16 a[108:111], a[192:195], v[252:255], a[108:111]
    ds_read_b128 a[224:227], v16 offset:0
    v_cvt_pk_bf16_f32 v220, v48, v49
    v_mfma_f32_16x16x32_bf16 a[124:127], a[196:199], v[252:255], a[124:127]
    v_add_f32 v27, v48, v49
    v_mfma_f32_16x16x32_bf16 a[140:143], a[200:203], v[252:255], a[140:143]
    v_exp_f32 v54, v126
    v_mfma_f32_16x16x32_bf16 a[156:159], a[204:207], v[252:255], a[156:159]
    ds_read_b128 a[228:231], v17 offset:0
    v_add_f32 v27, v27, v50
    v_mfma_f32_16x16x32_bf16 a[172:175], a[208:211], v[252:255], a[172:175]
    v_exp_f32 v55, v127
    v_mfma_f32_16x16x32_bf16 a[188:191], a[212:215], v[252:255], a[188:191]
    v_cvt_pk_bf16_f32 v221, v50, v51
    v_add_f32 v27, v27, v51
    v_mfma_f32_16x16x32_bf16 a[184:187], a[212:215], v[244:247], a[184:187]
    ds_read_b128 a[232:235], v16 offset:1024
    v_add_f32 v27, v27, v52
    v_mfma_f32_16x16x32_bf16 a[168:171], a[208:211], v[244:247], a[168:171]
    v_cvt_pk_bf16_f32 v222, v52, v53
    v_mfma_f32_16x16x32_bf16 a[152:155], a[204:207], v[244:247], a[152:155]
    v_add_f32 v27, v27, v53
    v_mfma_f32_16x16x32_bf16 a[136:139], a[200:203], v[244:247], a[136:139]
    ds_read_b128 a[236:239], v17 offset:1024
    v_add_f32 v27, v27, v54
    v_mfma_f32_16x16x32_bf16 a[120:123], a[196:199], v[244:247], a[120:123]
    buffer_load_dword a216, v2, s[28:31], s6 offen
    v_mfma_f32_16x16x32_bf16 a[104:107], a[192:195], v[244:247], a[104:107]
    s_add_u32 s6, s6, 1536
    v_cvt_pk_bf16_f32 v223, v54, v55
    v_mfma_f32_16x16x32_bf16 a[100:103], a[192:195], v[236:239], a[100:103]
    s_mov_b32 s44, s41
    ds_read_b128 a[240:243], v16 offset:2048
    v_add_f32 v27, v27, v55
    v_mfma_f32_16x16x32_bf16 a[116:119], a[196:199], v[236:239], a[116:119]
    s_mov_b32 s41, s42
    v_max_f32 v29, v29, v27
    v_mfma_f32_16x16x32_bf16 a[132:135], a[200:203], v[236:239], a[132:135]
    s_mov_b32 s42, s43
    v_cmp_nle_f32 vcc, v29, v30
    s_mov_b32 s43, s44
    v_mfma_f32_16x16x32_bf16 a[148:151], a[204:207], v[236:239], a[148:151]
    ds_read_b128 a[244:247], v17 offset:2048
    v_mfma_f32_16x16x32_bf16 a[164:167], a[208:211], v[236:239], a[164:167]
    s_cmp_eq_u32 s45, 1
    s_cselect_b64 s[88:89], -1, 0
    s_cselect_b64 s[16:17], s[8:9], s[16:17]
    v_mfma_f32_16x16x32_bf16 a[180:183], a[212:215], v[236:239], a[180:183]
    s_cmp_eq_u32 s45, 1
    s_cselect_b32 s18, s10, s18
    s_cselect_b32 s40, s77, s40
    v_mfma_f32_16x16x32_bf16 a[176:179], a[212:215], v[228:231], a[176:179]
    s_cmp_eq_u32 s45, 1
    s_cselect_b32 s66, s63, s66
    v_mfma_f32_16x16x32_bf16 a[160:163], a[208:211], v[228:231], a[160:163]
    v_cndmask_b32 v6, v6, v62, s[88:89]
    v_cndmask_b32 v7, v7, v63, s[88:89]
    v_mfma_f32_16x16x32_bf16 a[144:147], a[204:207], v[228:231], a[144:147]
    s_sub_u32 s45, s45, 1
    v_mfma_f32_16x16x32_bf16 a[128:131], a[200:203], v[228:231], a[128:131]
    v_mfma_f32_16x16x32_bf16 a[112:115], a[196:199], v[228:231], a[112:115]
    s_waitcnt lgkmcnt(0)
    v_mfma_f32_16x16x32_bf16 a[96:99], a[192:195], v[228:231], a[96:99]
    s_cbranch_vccnz rare_b
rare_b_ret:
    s_cbranch_scc0 at_loop
tail_code:
    v_add_u32 v8, s41, v12
    v_add_u32 v9, s41, v13
    v_add_u32 v10, s41, v14
    v_add_u32 v11, s41, v15
    s_waitcnt lgkmcnt(0)
    ds_read_b64_tr_b16 a[192:193], v8 offset:0
    ds_read_b64_tr_b16 a[194:195], v8 offset:6144
    ds_read_b64_tr_b16 a[196:197], v9 offset:0
    ds_read_b64_tr_b16 a[198:199], v9 offset:6144
    ds_read_b64_tr_b16 a[200:201], v10 offset:0
    ds_read_b64_tr_b16 a[202:203], v10 offset:6144
    ds_read_b64_tr_b16 a[204:205], v11 offset:0
    ds_read_b64_tr_b16 a[206:207], v11 offset:6144
    s_waitcnt lgkmcnt(4)
    v_mfma_f32_16x16x32_bf16 a[0:3], a[192:195], v[196:199], a[0:3]
    s_add_u32 s38, s33, 0
    ds_read_b64_tr_b16 a[208:209], v8 offset:1024
    v_add_f32 v20, v20, v24
    v_mfma_f32_16x16x32_bf16 a[16:19], a[196:199], v[196:199], a[16:19]
    s_add_u32 s57, s34, 0
    ds_read_b64_tr_b16 a[210:211], v8 offset:7168
    v_add_f32 v21, v21, v25
    v_mfma_f32_16x16x32_bf16 a[20:23], a[196:199], v[204:207], a[20:23]
    buffer_load_dword v61, v60, s[24:27], s37 offen sc1
    v_mfma_f32_16x16x32_bf16 a[4:7], a[192:195], v[204:207], a[4:7]
    s_cmp_lt_u32 s3, 2
    s_cselect_b32 s38, s38, s57
    v_add_f32 v22, v22, v26
    v_mfma_f32_16x16x32_bf16 a[8:11], a[192:195], v[212:215], a[8:11]
    s_add_u32 s76, s38, s63
    ds_read_b64_tr_b16 a[212:213], v9 offset:1024
    v_add_f32 v23, v23, v27
    v_mfma_f32_16x16x32_bf16 a[24:27], a[196:199], v[212:215], a[24:27]
    s_add_u32 m0, s49, 24576
    ds_read_b64_tr_b16 a[214:215], v9 offset:7168
    s_and_b32 s59, s51, 1
    v_mfma_f32_16x16x32_bf16 a[28:31], a[196:199], v[220:223], a[28:31]
    buffer_load_dwordx4 v4, s[12:15], s38 offen offset:0 lds
    v_mfma_f32_16x16x32_bf16 a[12:15], a[192:195], v[220:223], a[12:15]
    s_waitcnt lgkmcnt(4)
    v_exp_f32 v48, v132
    v_mfma_f32_16x16x32_bf16 a[44:47], a[200:203], v[220:223], a[44:47]
    s_lshl_b32 s59, s59, 6
    ds_read_b64_tr_b16 a[192:193], v10 offset:1024
    s_sub_u32 s44, s49, 73728
    v_mfma_f32_16x16x32_bf16 a[60:63], a[204:207], v[220:223], a[60:63]
    s_add_u32 m0, s49, 25472
    ds_read_b64_tr_b16 a[194:195], v10 offset:7168
    v_add_u32 v12, s44, v12
    v_mfma_f32_16x16x32_bf16 a[56:59], a[204:207], v[212:215], a[56:59]
    buffer_load_dwordx4 v4, s[12:15], s38 offen offset:128 lds
    v_mfma_f32_16x16x32_bf16 a[40:43], a[200:203], v[212:215], a[40:43]
    v_add_u32 v13, s44, v13
    v_add_u32 v14, s44, v14
    v_mfma_f32_16x16x32_bf16 a[36:39], a[200:203], v[204:207], a[36:39]
    ds_read_b64_tr_b16 a[196:197], v11 offset:1024
    v_add_u32 v15, s44, v15
    v_mfma_f32_16x16x32_bf16 a[52:55], a[204:207], v[204:207], a[52:55]
    s_add_u32 m0, s49, 26368
    ds_read_b64_tr_b16 a[198:199], v11 offset:7168
    s_mov_b32 s39, s59
    v_mfma_f32_16x16x32_bf16 a[48:51], a[204:207], v[196:199], a[48:51]
    buffer_load_dwordx4 v4, s[12:15], s76 offen offset:256 lds
    v_mfma_f32_16x16x32_bf16 a[32:35], a[200:203], v[196:199], a[32:35]
    s_waitcnt lgkmcnt(4)
    v_exp_f32 v49, v133
    v_mfma_f32_16x16x32_bf16 a[64:67], a[208:211], v[196:199], a[64:67]
    s_lshl_b32 s36, s3, 10
    ds_read_b64_tr_b16 a[200:201], v8 offset:2048
    v_cvt_pk_bf16_f32 v228, v48, v49
    v_mfma_f32_16x16x32_bf16 a[80:83], a[212:215], v[196:199], a[80:83]
    s_add_u32 m0, s49, 27648
    ds_read_b64_tr_b16 a[202:203], v8 offset:8192
    v_add_f32 v24, v48, v49
    v_mfma_f32_16x16x32_bf16 a[84:87], a[212:215], v[204:207], a[84:87]
    buffer_load_dwordx4 v5, s[12:15], s38 offen offset:0 lds
    v_mfma_f32_16x16x32_bf16 a[68:71], a[208:211], v[204:207], a[68:71]
    v_exp_f32 v50, v134
    v_mfma_f32_16x16x32_bf16 a[72:75], a[208:211], v[212:215], a[72:75]
    ds_read_b64_tr_b16 a[204:205], v9 offset:2048
    v_add_f32 v24, v24, v50
    v_mfma_f32_16x16x32_bf16 a[88:91], a[212:215], v[212:215], a[88:91]
    s_add_u32 m0, s49, 28544
    ds_read_b64_tr_b16 a[206:207], v9 offset:8192
    v_mfma_f32_16x16x32_bf16 a[92:95], a[212:215], v[220:223], a[92:95]
    buffer_load_dwordx4 v5, s[12:15], s38 offen offset:128 lds
    v_mfma_f32_16x16x32_bf16 a[76:79], a[208:211], v[220:223], a[76:79]
    s_waitcnt lgkmcnt(4)
    v_exp_f32 v51, v135
    v_mfma_f32_16x16x32_bf16 a[108:111], a[192:195], v[220:223], a[108:111]
    ds_read_b64_tr_b16 a[208:209], v10 offset:2048
    v_cvt_pk_bf16_f32 v229, v50, v51
    v_mfma_f32_16x16x32_bf16 a[124:127], a[196:199], v[220:223], a[124:127]
    s_add_u32 m0, s49, 29440
    ds_read_b64_tr_b16 a[210:211], v10 offset:8192
    v_add_f32 v24, v24, v51
    v_mfma_f32_16x16x32_bf16 a[120:123], a[196:199], v[212:215], a[120:123]
    buffer_load_dwordx4 v5, s[12:15], s76 offen offset:256 lds
    v_mfma_f32_16x16x32_bf16 a[104:107], a[192:195], v[212:215], a[104:107]
    s_add_u32 s38, s35, 0
    v_exp_f32 v52, v164
    v_mfma_f32_16x16x32_bf16 a[100:103], a[192:195], v[204:207], a[100:103]
    s_add_u32 s57, s33, 40960
    ds_read_b64_tr_b16 a[212:213], v11 offset:2048
    v_add_f32 v24, v24, v52
    v_mfma_f32_16x16x32_bf16 a[116:119], a[196:199], v[204:207], a[116:119]
    s_cmp_lt_u32 s3, 2
    s_cselect_b32 s38, s38, s57
    ds_read_b64_tr_b16 a[214:215], v11 offset:8192
    v_mfma_f32_16x16x32_bf16 a[112:115], a[196:199], v[196:199], a[112:115]
    s_add_u32 s76, s38, s63
    v_exp_f32 v53, v165
    v_mfma_f32_16x16x32_bf16 a[96:99], a[192:195], v[196:199], a[96:99]
    s_waitcnt lgkmcnt(4)
    v_exp_f32 v54, v166
    v_mfma_f32_16x16x32_bf16 a[128:131], a[200:203], v[196:199], a[128:131]
    s_add_u32 m0, s49, 73728
    ds_read_b64_tr_b16 a[192:193], v8 offset:12288
    v_cvt_pk_bf16_f32 v230, v52, v53
    v_mfma_f32_16x16x32_bf16 a[144:147], a[204:207], v[196:199], a[144:147]
pg_7:
    s_cbranch_execz pg_11
    ds_read_b64_tr_b16 a[194:195], v8 offset:18432
    v_add_f32 v24, v24, v53
    v_mfma_f32_16x16x32_bf16 a[148:151], a[204:207], v[204:207], a[148:151]
    buffer_load_dwordx4 v4, s[12:15], s38 offen offset:0 lds
    v_mfma_f32_16x16x32_bf16 a[132:135], a[200:203], v[204:207], a[132:135]
    v_exp_f32 v55, v167
    v_mfma_f32_16x16x32_bf16 a[136:139], a[200:203], v[212:215], a[136:139]
    s_add_u32 m0, s49, 74624
    ds_read_b64_tr_b16 a[196:197], v9 offset:12288
    v_add_f32 v24, v24, v54
    v_mfma_f32_16x16x32_bf16 a[152:155], a[204:207], v[212:215], a[152:155]
    ds_read_b64_tr_b16 a[198:199], v9 offset:18432
    v_cvt_pk_bf16_f32 v231, v54, v55
    v_mfma_f32_16x16x32_bf16 a[156:159], a[204:207], v[220:223], a[156:159]
    buffer_load_dwordx4 v4, s[12:15], s38 offen offset:128 lds
    v_mfma_f32_16x16x32_bf16 a[140:143], a[200:203], v[220:223], a[140:143]
    s_waitcnt lgkmcnt(4)
    v_exp_f32 v48, v140
    v_mfma_f32_16x16x32_bf16 a[172:175], a[208:211], v[220:223], a[172:175]
    ds_read_b64_tr_b16 a[200:201], v10 offset:12288
    v_add_f32 v24, v24, v55
    v_mfma_f32_16x16x32_bf16 a[188:191], a[212:215], v[220:223], a[188:191]
    s_add_u32 m0, s49, 75520
    ds_read_b64_tr_b16 a[202:203], v10 offset:18432
    v_mfma_f32_16x16x32_bf16 a[184:187], a[212:215], v[212:215], a[184:187]
    buffer_load_dwordx4 v4, s[12:15], s76 offen offset:256 lds
    v_mfma_f32_16x16x32_bf16 a[168:171], a[208:211], v[212:215], a[168:171]
    v_exp_f32 v49, v141
    v_mfma_f32_16x16x32_bf16 a[164:167], a[208:211], v[204:207], a[164:167]
    ds_read_b64_tr_b16 a[204:205], v11 offset:12288
    v_cvt_pk_bf16_f32 v236, v48, v49
    v_mfma_f32_16x16x32_bf16 a[180:183], a[212:215], v[204:207], a[180:183]
    ds_read_b64_tr_b16 a[206:207], v11 offset:18432
    v_add_f32 v25, v48, v49
    v_mfma_f32_16x16x32_bf16 a[176:179], a[212:215], v[196:199], a[176:179]
    s_add_u32 m0, s49, 76800
    v_exp_f32 v50, v142
    v_mfma_f32_16x16x32_bf16 a[160:163], a[208:211], v[196:199], a[160:163]
    s_waitcnt lgkmcnt(4)
    v_exp_f32 v51, v143
    v_add_f32 v25, v25, v50
    v_cvt_pk_bf16_f32 v237, v50, v51
    v_exp_f32 v52, v172
    v_exp_f32 v53, v173
    v_add_f32 v25, v25, v51
    v_cvt_pk_bf16_f32 v238, v52, v53
    v_exp_f32 v54, v174
    v_exp_f32 v55, v175
    v_add_f32 v25, v25, v52
    v_cvt_pk_bf16_f32 v239, v54, v55
    v_add_f32 v25, v25, v53
    v_add_f32 v25, v25, v54
    v_add_f32 v25, v25, v55
    v_exp_f32 v48, v148
    v_exp_f32 v49, v149
    v_exp_f32 v50, v150
    v_cvt_pk_bf16_f32 v244, v48, v49
    v_exp_f32 v51, v151
    v_add_f32 v26, v48, v49
    v_cvt_pk_bf16_f32 v245, v50, v51
    v_exp_f32 v52, v180
    v_exp_f32 v53, v181
    v_add_f32 v26, v26, v50
    v_cvt_pk_bf16_f32 v246, v52, v53
    v_exp_f32 v54, v182
    v_exp_f32 v55, v183
    v_add_f32 v26, v26, v51
    v_cvt_pk_bf16_f32 v247, v54, v55
    v_add_f32 v26, v26, v52
    v_add_f32 v26, v26, v53
    v_add_f32 v26, v26, v54
    v_add_f32 v26, v26, v55
    v_max3_f32 v29, v24, v25, v26
    v_exp_f32 v48, v156
    v_exp_f32 v49, v157
    v_exp_f32 v50, v158
    v_cvt_pk_bf16_f32 v252, v48, v49
    v_exp_f32 v51, v159
    v_add_f32 v27, v48, v49
    v_cvt_pk_bf16_f32 v253, v50, v51
    v_exp_f32 v52, v188
    v_exp_f32 v53, v189
    v_add_f32 v27, v27, v50
    v_cvt_pk_bf16_f32 v254, v52, v53
    v_exp_f32 v54, v190
    v_exp_f32 v55, v191
    v_add_f32 v27, v27, v51
    v_cvt_pk_bf16_f32 v255, v54, v55
    v_add_f32 v27, v27, v52
    v_add_f32 v27, v27, v53
    v_add_f32 v27, v27, v54
    v_add_f32 v27, v27, v55
    v_max_f32 v29, v29, v27
    v_cmp_nle_f32 vcc, v29, v30
    s_cbranch_vccnz rare_e
rare_e_ret:
    v_mfma_f32_16x16x32_bf16 a[0:3], a[192:195], v[228:231], a[0:3]
    ds_read_b64_tr_b16 a[208:209], v8 offset:13312
    v_add_f32 v20, v20, v24
    v_mfma_f32_16x16x32_bf16 a[16:19], a[196:199], v[228:231], a[16:19]
    ds_read_b64_tr_b16 a[210:211], v8 offset:19456
    v_add_f32 v21, v21, v25
    v_mfma_f32_16x16x32_bf16 a[20:23], a[196:199], v[236:239], a[20:23]
    buffer_load_dwordx4 v5, s[12:15], s38 offen offset:0 lds
    v_mfma_f32_16x16x32_bf16 a[4:7], a[192:195], v[236:239], a[4:7]
    s_add_u32 m0, s49, 77696
    v_add_f32 v22, v22, v26
    v_add_f32 v23, v23, v27
    v_mfma_f32_16x16x32_bf16 a[8:11], a[192:195], v[244:247], a[8:11]
    ds_read_b64_tr_b16 a[212:213], v9 offset:13312
    v_mov_b32 v56, v20
    v_mfma_f32_16x16x32_bf16 a[24:27], a[196:199], v[244:247], a[24:27]
    ds_read_b64_tr_b16 a[214:215], v9 offset:19456
    v_mov_b32 v57, v21
    v_mfma_f32_16x16x32_bf16 a[28:31], a[196:199], v[252:255], a[28:31]
    buffer_load_dwordx4 v5, s[12:15], s38 offen offset:128 lds
    v_mfma_f32_16x16x32_bf16 a[12:15], a[192:195], v[252:255], a[12:15]
    s_waitcnt lgkmcnt(4)
    v_permlane16_swap_b32 v20, v56
    v_mfma_f32_16x16x32_bf16 a[44:47], a[200:203], v[252:255], a[44:47]
    s_add_u32 m0, s49, 78592
    ds_read_b64_tr_b16 a[192:193], v10 offset:13312
    v_add_f32 v20, v20, v56
    v_mfma_f32_16x16x32_bf16 a[60:63], a[204:207], v[252:255], a[60:63]
    ds_read_b64_tr_b16 a[194:195], v10 offset:19456
    v_mov_b32 v56, v20
    v_mfma_f32_16x16x32_bf16 a[56:59], a[204:207], v[244:247], a[56:59]
    buffer_load_dwordx4 v5, s[12:15], s76 offen offset:256 lds
    v_mfma_f32_16x16x32_bf16 a[40:43], a[200:203], v[244:247], a[40:43]
    v_permlane32_swap_b32 v20, v56
    v_mfma_f32_16x16x32_bf16 a[36:39], a[200:203], v[236:239], a[36:39]
    s_waitcnt vmcnt(12)
    ds_read_b64_tr_b16 a[196:197], v11 offset:13312
    v_cmp_ne_u32 vcc, s7, v61
    v_mfma_f32_16x16x32_bf16 a[52:55], a[204:207], v[236:239], a[52:55]
    s_lshl_b32 s11, s54, 16
    ds_read_b64_tr_b16 a[198:199], v11 offset:19456
    v_add_f32 v20, v20, v56
    v_mfma_f32_16x16x32_bf16 a[48:51], a[204:207], v[228:231], a[48:51]
    s_cbranch_vccnz spin_gu
spin_gu_ret:
    v_mul_f32 v20, 0x3c800000, v20
    v_mfma_f32_16x16x32_bf16 a[32:35], a[200:203], v[228:231], a[32:35]
    s_waitcnt lgkmcnt(4)
    v_rcp_f32 v20, v20
    v_mfma_f32_16x16x32_bf16 a[64:67], a[208:211], v[228:231], a[64:67]
    s_nop 0
    ds_read_b64_tr_b16 a[200:201], v8 offset:14336
    v_mov_b32 v58, v22
    v_mfma_f32_16x16x32_bf16 a[80:83], a[212:215], v[228:231], a[80:83]
    s_lshl_b32 s61, s47, 10
    ds_read_b64_tr_b16 a[202:203], v8 offset:20480
    v_mov_b32 v59, v23
    v_mfma_f32_16x16x32_bf16 a[84:87], a[212:215], v[236:239], a[84:87]
    s_add_u32 s61, s61, 3276800
    v_permlane16_swap_b32 v21, v57
    v_mfma_f32_16x16x32_bf16 a[68:71], a[208:211], v[236:239], a[68:71]
    s_add_u32 s56, s3, 0
    v_permlane16_swap_b32 v22, v58
    v_mfma_f32_16x16x32_bf16 a[72:75], a[208:211], v[244:247], a[72:75]
    s_min_u32 s56, s56, 9
    ds_read_b64_tr_b16 a[204:205], v9 offset:14336
    v_add_f32 v21, v21, v57
    v_mfma_f32_16x16x32_bf16 a[88:91], a[212:215], v[244:247], a[88:91]
    s_mul_i32 s57, s56, 24576
    ds_read_b64_tr_b16 a[206:207], v9 offset:20480
    v_mov_b32 v57, v21
    v_mfma_f32_16x16x32_bf16 a[92:95], a[212:215], v[252:255], a[92:95]
    s_add_u32 s57, s57, s61
    v_permlane32_swap_b32 v21, v57
    v_mfma_f32_16x16x32_bf16 a[76:79], a[208:211], v[252:255], a[76:79]
    s_waitcnt lgkmcnt(4)
    v_permlane16_swap_b32 v23, v59
    v_mfma_f32_16x16x32_bf16 a[108:111], a[192:195], v[252:255], a[108:111]
    s_lshl_b32 s56, s56, 10
    ds_read_b64_tr_b16 a[208:209], v10 offset:14336
    v_add_f32 v21, v21, v57
    v_mfma_f32_16x16x32_bf16 a[124:127], a[196:199], v[252:255], a[124:127]
    s_add_u32 m0, s56, 147456
    ds_read_b64_tr_b16 a[210:211], v10 offset:20480
    v_mul_f32 v21, 0x3c800000, v21
    v_mfma_f32_16x16x32_bf16 a[120:123], a[196:199], v[244:247], a[120:123]
    buffer_load_dwordx4 v28, s[24:27], s57 offen sc1 lds
    v_mfma_f32_16x16x32_bf16 a[104:107], a[192:195], v[244:247], a[104:107]
    s_add_u32 s56, s3, 4
    v_rcp_f32 v21, v21
    v_mfma_f32_16x16x32_bf16 a[100:103], a[192:195], v[236:239], a[100:103]
    s_min_u32 s56, s56, 9
    ds_read_b64_tr_b16 a[212:213], v11 offset:14336
    v_add_f32 v22, v22, v58
    v_mfma_f32_16x16x32_bf16 a[116:119], a[196:199], v[236:239], a[116:119]
    s_waitcnt vmcnt(34)
    ds_read_b64_tr_b16 a[214:215], v11 offset:20480
    v_mov_b32 v58, v22
    v_mfma_f32_16x16x32_bf16 a[112:115], a[196:199], v[228:231], a[112:115]
    s_barrier
    v_mfma_f32_16x16x32_bf16 a[96:99], a[192:195], v[228:231], a[96:99]
    s_waitcnt lgkmcnt(4)
    v_permlane32_swap_b32 v22, v58
    v_add_u32 v8, 49152, v12
    v_mfma_f32_16x16x32_bf16 a[128:131], a[200:203], v[228:231], a[128:131]
    s_mul_i32 s57, s56, 24576
    ds_read_b64_tr_b16 a[192:193], v8 offset:0
    v_add_f32 v22, v22, v58
    v_mfma_f32_16x16x32_bf16 a[144:147], a[204:207], v[228:231], a[144:147]
    s_add_u32 s57, s57, s61
    ds_read_b64_tr_b16 a[194:195], v8 offset:6144
    v_mul_f32 v22, 0x3c800000, v22
    v_mfma_f32_16x16x32_bf16 a[148:151], a[204:207], v[236:239], a[148:151]
    s_lshl_b32 s56, s56, 10
    v_rcp_f32 v22, v22
    v_mfma_f32_16x16x32_bf16 a[132:135], a[200:203], v[236:239], a[132:135]
    s_add_u32 m0, s56, 147456
    v_add_f32 v23, v23, v59
    v_mov_b32 v59, v23
    v_add_u32 v9, 49152, v13
    v_mfma_f32_16x16x32_bf16 a[136:139], a[200:203], v[244:247], a[136:139]
    s_and_b32 s72, s3, 1
    ds_read_b64_tr_b16 a[196:197], v9 offset:0
    v_add_u32 v10, 49152, v14
    v_mfma_f32_16x16x32_bf16 a[152:155], a[204:207], v[244:247], a[152:155]
    s_lshl_b32 s72, s72, 14
    ds_read_b64_tr_b16 a[198:199], v9 offset:6144
    v_add_u32 v11, 49152, v15
    v_mfma_f32_16x16x32_bf16 a[156:159], a[204:207], v[252:255], a[156:159]
    buffer_load_dwordx4 v28, s[24:27], s57 offen sc1 lds
    v_mfma_f32_16x16x32_bf16 a[140:143], a[200:203], v[252:255], a[140:143]
    s_waitcnt lgkmcnt(4)
    v_permlane32_swap_b32 v23, v59
    v_mfma_f32_16x16x32_bf16 a[172:175], a[208:211], v[252:255], a[172:175]
    s_add_u32 s56, s3, 8
    ds_read_b64_tr_b16 a[200:201], v10 offset:0
    v_add_f32 v23, v23, v59
    v_mfma_f32_16x16x32_bf16 a[188:191], a[212:215], v[252:255], a[188:191]
    s_min_u32 s56, s56, 9
    ds_read_b64_tr_b16 a[202:203], v10 offset:6144
    v_mul_f32 v23, 0x3c800000, v23
    v_mfma_f32_16x16x32_bf16 a[184:187], a[212:215], v[244:247], a[184:187]
    s_mul_i32 s57, s56, 24576
    v_rcp_f32 v23, v23
    v_mfma_f32_16x16x32_bf16 a[168:171], a[208:211], v[244:247], a[168:171]
    s_add_u32 s57, s57, s61
    v_xor_b32 v18, s39, v8
    v_xor_b32 v19, s39, v9
    v_mfma_f32_16x16x32_bf16 a[164:167], a[208:211], v[236:239], a[164:167]
    s_lshl_b32 s56, s56, 10
    ds_read_b64_tr_b16 a[204:205], v11 offset:0
    v_accvgpr_read_b32 v64, a0
    v_mfma_f32_16x16x32_bf16 a[180:183], a[212:215], v[236:239], a[180:183]
    s_add_u32 m0, s56, 147456
    ds_read_b64_tr_b16 a[206:207], v11 offset:6144
    v_accvgpr_read_b32 v65, a1
    v_accvgpr_read_b32 v24, a18
    v_fma_f32 v24, v24, v20, -v20
    v_accvgpr_read_b32 v25, a19
    v_fma_f32 v25, v25, v20, -v20
    v_accvgpr_read_b32 v66, a2
    v_fma_f32 v66, v66, v20, -v20
    v_accvgpr_read_b32 v67, a3
    v_fma_f32 v67, v67, v20, -v20
    v_fma_f32 v64, v64, v20, -v20
    v_fma_f32 v65, v65, v20, -v20
    v_cvt_pk_bf16_f32 v64, v64, v65
    v_cvt_pk_bf16_f32 v65, v66, v67
    v_accvgpr_read_b32 v66, a16
    v_fma_f32 v66, v66, v20, -v20
    v_accvgpr_read_b32 v67, a17
    v_fma_f32 v67, v67, v20, -v20
    v_cvt_pk_bf16_f32 v66, v66, v67
    v_cvt_pk_bf16_f32 v67, v24, v25
    v_accvgpr_read_b32 v26, a22
    v_fma_f32 v26, v26, v21, -v21
    v_accvgpr_read_b32 v27, a23
    v_fma_f32 v27, v27, v21, -v21
    v_accvgpr_read_b32 v74, a6
    v_fma_f32 v74, v74, v21, -v21
    v_accvgpr_read_b32 v75, a7
    v_fma_f32 v75, v75, v21, -v21
    v_accvgpr_read_b32 v72, a4
    v_fma_f32 v72, v72, v21, -v21
    v_accvgpr_read_b32 v73, a5
    v_fma_f32 v73, v73, v21, -v21
    v_cvt_pk_bf16_f32 v72, v72, v73
    v_cvt_pk_bf16_f32 v73, v74, v75
    v_accvgpr_read_b32 v74, a20
    v_fma_f32 v74, v74, v21, -v21
    v_accvgpr_read_b32 v75, a21
    v_fma_f32 v75, v75, v21, -v21
    v_cvt_pk_bf16_f32 v74, v74, v75
    v_cvt_pk_bf16_f32 v75, v26, v27
    v_accvgpr_read_b32 v30, a26
    v_fma_f32 v30, v30, v22, -v22
    v_accvgpr_read_b32 v31, a27
    v_fma_f32 v31, v31, v22, -v22
    v_accvgpr_read_b32 v82, a10
    v_fma_f32 v82, v82, v22, -v22
    v_accvgpr_read_b32 v83, a11
    v_fma_f32 v83, v83, v22, -v22
    v_accvgpr_read_b32 v80, a8
    v_fma_f32 v80, v80, v22, -v22
    v_accvgpr_read_b32 v81, a9
    v_fma_f32 v81, v81, v22, -v22
    v_cvt_pk_bf16_f32 v80, v80, v81
    v_cvt_pk_bf16_f32 v81, v82, v83
    v_accvgpr_read_b32 v82, a24
    v_fma_f32 v82, v82, v22, -v22
    v_accvgpr_read_b32 v83, a25
    v_fma_f32 v83, v83, v22, -v22
    v_cvt_pk_bf16_f32 v82, v82, v83
    v_cvt_pk_bf16_f32 v83, v30, v31
    v_accvgpr_read_b32 v24, a30
    v_fma_f32 v24, v24, v23, -v23
    v_accvgpr_read_b32 v25, a31
    v_fma_f32 v25, v25, v23, -v23
    v_accvgpr_read_b32 v90, a14
    v_fma_f32 v90, v90, v23, -v23
    v_accvgpr_read_b32 v91, a15
    v_fma_f32 v91, v91, v23, -v23
    v_accvgpr_read_b32 v88, a12
    v_fma_f32 v88, v88, v23, -v23
    v_accvgpr_read_b32 v89, a13
    v_fma_f32 v89, v89, v23, -v23
    v_cvt_pk_bf16_f32 v88, v88, v89
    v_cvt_pk_bf16_f32 v89, v90, v91
    v_accvgpr_read_b32 v90, a28
    v_fma_f32 v90, v90, v23, -v23
    v_accvgpr_read_b32 v91, a29
    v_fma_f32 v91, v91, v23, -v23
    v_cvt_pk_bf16_f32 v90, v90, v91
    v_cvt_pk_bf16_f32 v91, v24, v25
    v_mfma_f32_16x16x32_bf16 a[176:179], a[212:215], v[228:231], a[176:179]
    buffer_load_dwordx4 v28, s[24:27], s57 offen sc1 lds
    v_mfma_f32_16x16x32_bf16 a[160:163], a[208:211], v[228:231], a[160:163]
    s_waitcnt lgkmcnt(4)
    v_accvgpr_read_b32 v96, a32
    v_accvgpr_read_b32 v97, a33
    v_mfma_f32_16x16x32_bf16 a[224:227], a[192:195], v[64:67], 0.5
    s_add_u32 s38, s34, 40960
    ds_read_b64_tr_b16 a[208:209], v8 offset:1024
    v_accvgpr_read_b32 v98, a34
    v_mfma_f32_16x16x32_bf16 a[240:243], a[196:199], v[64:67], 0.5
    s_add_u32 s57, s35, 40960
    ds_read_b64_tr_b16 a[210:211], v8 offset:7168
    v_accvgpr_read_b32 v99, a35
    v_mfma_f32_16x16x32_bf16 a[244:247], a[196:199], v[72:75], 0.5
    buffer_store_dwordx4 v[64:67], v28, s[20:23], s55 offen offset:0 sc1
    v_mfma_f32_16x16x32_bf16 a[228:231], a[192:195], v[72:75], 0.5
    s_cmp_lt_u32 s3, 2
    s_cselect_b32 s38, s38, s57
    v_fma_f32 v96, v96, v20, -v20
    v_mfma_f32_16x16x32_bf16 a[232:235], a[192:195], v[80:83], 0.5
    s_add_u32 s76, s38, s63
    ds_read_b64_tr_b16 a[212:213], v9 offset:1024
    v_fma_f32 v97, v97, v20, -v20
    v_mfma_f32_16x16x32_bf16 a[248:251], a[196:199], v[80:83], 0.5
    s_add_u32 m0, s49, 98304
    ds_read_b64_tr_b16 a[214:215], v9 offset:7168
    v_fma_f32 v98, v98, v20, -v20
    v_mfma_f32_16x16x32_bf16 a[252:255], a[196:199], v[88:91], 0.5
    buffer_store_dwordx4 v[72:75], v28, s[20:23], s55 offen offset:1024 sc1
    v_mfma_f32_16x16x32_bf16 a[236:239], a[192:195], v[88:91], 0.5
    s_waitcnt lgkmcnt(4)
    v_fma_f32 v99, v99, v20, -v20
    v_cvt_pk_bf16_f32 v96, v96, v97
    buffer_store_dwordx4 v[80:83], v28, s[20:23], s55 offen offset:2048 sc1
    buffer_store_dwordx4 v[88:91], v28, s[20:23], s55 offen offset:3072 sc1
    v_accvgpr_read_b32 v26, a50
    v_fma_f32 v26, v26, v20, -v20
    v_accvgpr_read_b32 v27, a51
    v_fma_f32 v27, v27, v20, -v20
    v_cvt_pk_bf16_f32 v97, v98, v99
    v_accvgpr_read_b32 v98, a48
    v_fma_f32 v98, v98, v20, -v20
    v_accvgpr_read_b32 v99, a49
    v_fma_f32 v99, v99, v20, -v20
    v_cvt_pk_bf16_f32 v98, v98, v99
    v_cvt_pk_bf16_f32 v99, v26, v27
    v_mfma_f32_16x16x32_bf16 v[92:95], a[200:203], v[88:91], 0.5
    s_add_u32 s55, s55, 4096
    ds_read_b64_tr_b16 a[192:193], v10 offset:1024
    v_accvgpr_read_b32 v104, a36
    v_mfma_f32_16x16x32_bf16 v[124:127], a[204:207], v[88:91], 0.5
    s_or_b32 s11, s11, s72
    ds_read_b64_tr_b16 a[194:195], v10 offset:7168
    v_accvgpr_read_b32 v105, a37
    v_mfma_f32_16x16x32_bf16 v[116:119], a[204:207], v[80:83], 0.5
    s_lshr_b32 s73, s93, 8
    v_accvgpr_read_b32 v106, a38
    v_accvgpr_read_b32 v107, a39
    v_mfma_f32_16x16x32_bf16 v[84:87], a[200:203], v[80:83], 0.5
    s_add_u32 s8, s51, 1
    v_fma_f32 v104, v104, v21, -v21
    v_fma_f32 v105, v105, v21, -v21
    v_mfma_f32_16x16x32_bf16 v[76:79], a[200:203], v[72:75], 0.5
    s_and_b32 s8, s8, 3
    ds_read_b64_tr_b16 a[196:197], v11 offset:1024
    v_fma_f32 v106, v106, v21, -v21
    v_mfma_f32_16x16x32_bf16 v[108:111], a[204:207], v[72:75], 0.5
    s_lshr_b32 s72, s73, s8
    ds_read_b64_tr_b16 a[198:199], v11 offset:7168
    v_fma_f32 v107, v107, v21, -v21
    v_mfma_f32_16x16x32_bf16 v[100:103], a[204:207], v[64:67], 0.5
    s_and_b32 s72, s72, 0x2000
    v_cvt_pk_bf16_f32 v104, v104, v105
    v_cvt_pk_bf16_f32 v105, v106, v107
    v_mfma_f32_16x16x32_bf16 v[68:71], a[200:203], v[64:67], 0.5
    s_waitcnt lgkmcnt(4)
    v_accvgpr_read_b32 v106, a52
    v_accvgpr_read_b32 v107, a53
    v_mfma_f32_16x16x32_bf16 v[132:135], a[208:211], v[64:67], 0.5
    s_mul_i32 s8, s8, 0x202000
    ds_read_b64_tr_b16 a[200:201], v18 offset:2048
    v_accvgpr_read_b32 v30, a54
    v_mfma_f32_16x16x32_bf16 v[164:167], a[212:215], v[64:67], 0.5
    s_xor_b32 s8, s8, s72
    ds_read_b64_tr_b16 a[202:203], v18 offset:8192
    v_accvgpr_read_b32 v31, a55
    v_fma_f32 v30, v30, v21, -v21
    v_fma_f32 v31, v31, v21, -v21
    v_fma_f32 v106, v106, v21, -v21
    v_fma_f32 v107, v107, v21, -v21
    v_cvt_pk_bf16_f32 v106, v106, v107
    v_cvt_pk_bf16_f32 v107, v30, v31
    v_mfma_f32_16x16x32_bf16 v[172:175], a[212:215], v[72:75], 0.5
    buffer_load_dwordx4 v4, s[12:15], s38 offen offset:0 lds
    v_mfma_f32_16x16x32_bf16 v[140:143], a[208:211], v[72:75], 0.5
    s_add_u32 m0, s49, 99200
    v_accvgpr_read_b32 v112, a40
    v_accvgpr_read_b32 v113, a41
    v_mfma_f32_16x16x32_bf16 v[148:151], a[208:211], v[80:83], 0.5
    s_and_b32 s8, s8, 6299648
    ds_read_b64_tr_b16 a[204:205], v19 offset:2048
    v_accvgpr_read_b32 v114, a42
    v_mfma_f32_16x16x32_bf16 v[180:183], a[212:215], v[80:83], 0.5
    s_xor_b32 s8, s8, s11
    ds_read_b64_tr_b16 a[206:207], v19 offset:8192
    v_accvgpr_read_b32 v115, a43
    v_mfma_f32_16x16x32_bf16 v[188:191], a[212:215], v[88:91], 0.5
    buffer_load_dwordx4 v4, s[12:15], s38 offen offset:128 lds
    v_mfma_f32_16x16x32_bf16 v[156:159], a[208:211], v[88:91], 0.5
    s_waitcnt lgkmcnt(4)
    v_fma_f32 v112, v112, v22, -v22
    v_fma_f32 v113, v113, v22, -v22
    v_mfma_f32_16x16x32_bf16 v[220:223], a[192:195], v[88:91], 0.5
    s_add_u32 m0, s49, 100096
    ds_read_b64_tr_b16 a[208:209], v8 offset:12288
    v_fma_f32 v114, v114, v22, -v22
    v_mfma_f32_16x16x32_bf16 v[252:255], a[196:199], v[88:91], 0.5
    s_add_u32 s9, s51, 2
    ds_read_b64_tr_b16 a[210:211], v8 offset:18432
    v_fma_f32 v115, v115, v22, -v22
    v_mfma_f32_16x16x32_bf16 v[244:247], a[196:199], v[80:83], 0.5
    s_and_b32 s9, s9, 3
    v_cvt_pk_bf16_f32 v112, v112, v113
    v_cvt_pk_bf16_f32 v113, v114, v115
    v_mfma_f32_16x16x32_bf16 v[212:215], a[192:195], v[80:83], 0.5
    buffer_store_dwordx4 v[96:99], v28, s[20:23], s55 offen offset:0 sc1
    v_accvgpr_read_b32 v24, a58
    v_fma_f32 v24, v24, v22, -v22
    v_accvgpr_read_b32 v25, a59
    v_fma_f32 v25, v25, v22, -v22
    v_accvgpr_read_b32 v114, a56
    v_fma_f32 v114, v114, v22, -v22
    v_accvgpr_read_b32 v115, a57
    v_fma_f32 v115, v115, v22, -v22
    v_cvt_pk_bf16_f32 v114, v114, v115
    v_cvt_pk_bf16_f32 v115, v24, v25
    v_mfma_f32_16x16x32_bf16 v[204:207], a[192:195], v[72:75], 0.5
    s_lshr_b32 s72, s73, s9
    ds_read_b64_tr_b16 a[212:213], v9 offset:12288
    v_accvgpr_read_b32 v120, a44
    v_mfma_f32_16x16x32_bf16 v[236:239], a[196:199], v[72:75], 0.5
    s_and_b32 s72, s72, 0x2000
    ds_read_b64_tr_b16 a[214:215], v9 offset:18432
    v_accvgpr_read_b32 v121, a45
    v_mfma_f32_16x16x32_bf16 v[228:231], a[196:199], v[64:67], 0.5
    s_mul_i32 s9, s9, 0x202000
    v_accvgpr_read_b32 v122, a46
    v_accvgpr_read_b32 v123, a47
    v_mfma_f32_16x16x32_bf16 v[196:199], a[192:195], v[64:67], 0.5
    s_waitcnt lgkmcnt(4)
    buffer_load_dwordx4 v4, s[12:15], s76 offen offset:256 lds
    v_mfma_f32_16x16x32_bf16 v[32:35], a[200:203], v[64:67], 0.5
    s_add_u32 m0, s49, 101376
    ds_read_b64_tr_b16 a[192:193], v10 offset:12288
    v_fma_f32 v120, v120, v23, -v23
    v_mfma_f32_16x16x32_bf16 v[48:51], a[204:207], v[64:67], 0.5
    s_xor_b32 s9, s9, s72
    ds_read_b64_tr_b16 a[194:195], v10 offset:18432
    v_fma_f32 v121, v121, v23, -v23
    v_mfma_f32_16x16x32_bf16 v[52:55], a[204:207], v[72:75], 0.5
    s_and_b32 s9, s9, 6299648
    v_fma_f32 v122, v122, v23, -v23
    v_fma_f32 v123, v123, v23, -v23
    v_mfma_f32_16x16x32_bf16 v[36:39], a[200:203], v[72:75], 0.5
    buffer_load_dwordx4 v5, s[12:15], s38 offen offset:0 lds
    v_mfma_f32_16x16x32_bf16 v[40:43], a[200:203], v[80:83], 0.5
    s_add_u32 m0, s49, 102272
    ds_read_b64_tr_b16 a[196:197], v11 offset:12288
    v_cvt_pk_bf16_f32 v120, v120, v121
    v_mfma_f32_16x16x32_bf16 v[56:59], a[204:207], v[80:83], 0.5
    s_xor_b32 s9, s9, s11
    ds_read_b64_tr_b16 a[198:199], v11 offset:18432
    v_cvt_pk_bf16_f32 v121, v122, v123
    v_accvgpr_read_b32 v26, a62
    v_fma_f32 v26, v26, v23, -v23
    v_accvgpr_read_b32 v27, a63
    v_fma_f32 v27, v27, v23, -v23
    v_accvgpr_read_b32 v122, a60
    v_fma_f32 v122, v122, v23, -v23
    v_accvgpr_read_b32 v123, a61
    v_fma_f32 v123, v123, v23, -v23
    v_cvt_pk_bf16_f32 v122, v122, v123
    v_cvt_pk_bf16_f32 v123, v26, v27
    v_mfma_f32_16x16x32_bf16 v[60:63], a[204:207], v[88:91], 0.5
    s_add_u32 s10, s51, 3
    v_accvgpr_read_b32 v128, a64
    v_accvgpr_read_b32 v129, a65
    v_mfma_f32_16x16x32_bf16 v[44:47], a[200:203], v[88:91], 0.5
    s_waitcnt lgkmcnt(4)
    buffer_load_dwordx4 v5, s[12:15], s38 offen offset:128 lds
    v_mfma_f32_16x16x32_bf16 a[236:239], a[208:211], v[120:123], a[236:239]
    s_add_u32 m0, s49, 103168
    ds_read_b64_tr_b16 a[200:201], v8 offset:13312
    v_accvgpr_read_b32 v130, a66
    v_mfma_f32_16x16x32_bf16 a[252:255], a[212:215], v[120:123], a[252:255]
    s_and_b32 s10, s10, 3
    ds_read_b64_tr_b16 a[202:203], v8 offset:19456
    v_accvgpr_read_b32 v131, a67
    v_mfma_f32_16x16x32_bf16 a[248:251], a[212:215], v[112:115], a[248:251]
    s_lshr_b32 s72, s73, s10
    v_fma_f32 v128, v128, v20, -v20
    v_fma_f32 v129, v129, v20, -v20
    v_mfma_f32_16x16x32_bf16 a[232:235], a[208:211], v[112:115], a[232:235]
    s_and_b32 s72, s72, 0x2000
    v_fma_f32 v130, v130, v20, -v20
    v_fma_f32 v131, v131, v20, -v20
    v_mfma_f32_16x16x32_bf16 a[228:231], a[208:211], v[104:107], a[228:231]
    s_mul_i32 s10, s10, 0x202000
    ds_read_b64_tr_b16 a[204:205], v9 offset:13312
    v_cvt_pk_bf16_f32 v128, v128, v129
    v_mfma_f32_16x16x32_bf16 a[244:247], a[212:215], v[104:107], a[244:247]
    s_xor_b32 s10, s10, s72
    ds_read_b64_tr_b16 a[206:207], v9 offset:19456
    v_cvt_pk_bf16_f32 v129, v130, v131
    v_mfma_f32_16x16x32_bf16 a[240:243], a[212:215], v[96:99], a[240:243]
    buffer_store_dwordx4 v[104:107], v28, s[20:23], s55 offen offset:1024 sc1
    v_mfma_f32_16x16x32_bf16 a[224:227], a[208:211], v[96:99], a[224:227]
    s_waitcnt lgkmcnt(4)
    v_accvgpr_read_b32 v130, a80
    v_accvgpr_read_b32 v131, a81
    v_accvgpr_read_b32 v30, a82
    v_fma_f32 v30, v30, v20, -v20
    v_accvgpr_read_b32 v31, a83
    v_fma_f32 v31, v31, v20, -v20
    v_fma_f32 v130, v130, v20, -v20
    v_fma_f32 v131, v131, v20, -v20
    v_cvt_pk_bf16_f32 v130, v130, v131
    v_cvt_pk_bf16_f32 v131, v30, v31
    v_mfma_f32_16x16x32_bf16 v[68:71], a[192:195], v[96:99], v[68:71]
    s_and_b32 s10, s10, 6299648
    ds_read_b64_tr_b16 a[208:209], v10 offset:13312
    v_add_u32 v8, 0, v12
    v_mfma_f32_16x16x32_bf16 v[100:103], a[196:199], v[96:99], v[100:103]
    s_xor_b32 s10, s10, s11
    ds_read_b64_tr_b16 a[210:211], v10 offset:19456
    v_accvgpr_read_b32 v136, a68
    v_mfma_f32_16x16x32_bf16 v[108:111], a[196:199], v[104:107], v[108:111]
    buffer_load_dwordx4 v5, s[12:15], s76 offen offset:256 lds
    v_mfma_f32_16x16x32_bf16 v[76:79], a[192:195], v[104:107], v[76:79]
    s_lshl_b32 s72, 1, s51
    v_mov_b32 v16, s72
    v_accvgpr_read_b32 v17, a223
    v_mfma_f32_16x16x32_bf16 v[84:87], a[192:195], v[112:115], v[84:87]
    s_mov_b32 s72, 0
    ds_read_b64_tr_b16 a[212:213], v11 offset:13312
    v_accvgpr_read_b32 v137, a69
    v_mfma_f32_16x16x32_bf16 v[116:119], a[196:199], v[112:115], v[116:119]
    ds_read_b64_tr_b16 a[214:215], v11 offset:19456
    v_accvgpr_read_b32 v138, a70
    v_mfma_f32_16x16x32_bf16 v[124:127], a[196:199], v[120:123], v[124:127]
    v_accvgpr_read_b32 v139, a71
    v_fma_f32 v136, v136, v21, -v21
    v_mfma_f32_16x16x32_bf16 v[92:95], a[192:195], v[120:123], v[92:95]
    s_waitcnt lgkmcnt(4)
    v_fma_f32 v137, v137, v21, -v21
    v_fma_f32 v138, v138, v21, -v21
    v_mfma_f32_16x16x32_bf16 v[156:159], a[200:203], v[120:123], v[156:159]
pg_8:
    s_cbranch_execz pg_12
    ds_read_b64_tr_b16 a[192:193], v18 offset:14336
    v_fma_f32 v139, v139, v21, -v21
    v_mfma_f32_16x16x32_bf16 v[188:191], a[204:207], v[120:123], v[188:191]
    ds_read_b64_tr_b16 a[194:195], v18 offset:20480
    v_cvt_pk_bf16_f32 v136, v136, v137
    v_accvgpr_read_b32 v24, a86
    v_fma_f32 v24, v24, v21, -v21
    v_accvgpr_read_b32 v25, a87
    v_fma_f32 v25, v25, v21, -v21
    v_cvt_pk_bf16_f32 v137, v138, v139
    v_accvgpr_read_b32 v138, a84
    v_fma_f32 v138, v138, v21, -v21
    v_accvgpr_read_b32 v139, a85
    v_fma_f32 v139, v139, v21, -v21
    v_cvt_pk_bf16_f32 v138, v138, v139
    v_cvt_pk_bf16_f32 v139, v24, v25
    v_mfma_f32_16x16x32_bf16 v[180:183], a[204:207], v[112:115], v[180:183]
    s_add_u32 s38, s33, 81920
    v_add_u32 v9, 0, v13
    v_add_u32 v10, 0, v14
    v_mfma_f32_16x16x32_bf16 v[148:151], a[200:203], v[112:115], v[148:151]
    s_add_u32 s57, s34, 81920
    v_accvgpr_read_b32 v144, a72
    v_accvgpr_read_b32 v145, a73
    v_mfma_f32_16x16x32_bf16 v[140:143], a[200:203], v[104:107], v[140:143]
    s_cmp_lt_u32 s3, 2
    s_cselect_b32 s38, s38, s57
    ds_read_b64_tr_b16 a[196:197], v19 offset:14336
    v_mfma_f32_16x16x32_bf16 v[172:175], a[204:207], v[104:107], v[172:175]
    s_waitcnt vmcnt(35)
    ds_read_b64_tr_b16 a[198:199], v19 offset:20480
    v_accvgpr_read_b32 v146, a74
    v_mfma_f32_16x16x32_bf16 v[164:167], a[204:207], v[96:99], v[164:167]
    s_barrier
    v_mfma_f32_16x16x32_bf16 v[132:135], a[200:203], v[96:99], v[132:135]
    s_waitcnt lgkmcnt(4)
    v_accvgpr_read_b32 v147, a75
    v_fma_f32 v144, v144, v22, -v22
    v_mfma_f32_16x16x32_bf16 v[196:199], a[208:211], v[96:99], v[196:199]
    s_add_u32 s76, s38, s63
    ds_read_b64_tr_b16 a[200:201], v8 offset:0
    v_fma_f32 v145, v145, v22, -v22
    v_mfma_f32_16x16x32_bf16 v[228:231], a[212:215], v[96:99], v[228:231]
    s_add_u32 m0, s49, 49152
    ds_read_b64_tr_b16 a[202:203], v8 offset:6144
    v_fma_f32 v146, v146, v22, -v22
    v_mfma_f32_16x16x32_bf16 v[236:239], a[212:215], v[104:107], v[236:239]
    buffer_store_dwordx4 v[112:115], v28, s[20:23], s55 offen offset:2048 sc1
    v_mfma_f32_16x16x32_bf16 v[204:207], a[208:211], v[104:107], v[204:207]
    s_waitcnt vmcnt(9)
    v_fma_f32 v147, v147, v22, -v22
    v_cvt_pk_bf16_f32 v144, v144, v145
    v_accvgpr_read_b32 v26, a90
    v_fma_f32 v26, v26, v22, -v22
    v_accvgpr_read_b32 v27, a91
    v_fma_f32 v27, v27, v22, -v22
    v_cvt_pk_bf16_f32 v145, v146, v147
    v_accvgpr_read_b32 v146, a88
    v_fma_f32 v146, v146, v22, -v22
    v_accvgpr_read_b32 v147, a89
    v_fma_f32 v147, v147, v22, -v22
    v_cvt_pk_bf16_f32 v146, v146, v147
    v_cvt_pk_bf16_f32 v147, v26, v27
    v_mfma_f32_16x16x32_bf16 v[212:215], a[208:211], v[112:115], v[212:215]
    ds_read_b64_tr_b16 a[204:205], v9 offset:0
    v_add_u32 v11, 0, v15
    v_mfma_f32_16x16x32_bf16 v[244:247], a[212:215], v[112:115], v[244:247]
    ds_read_b64_tr_b16 a[206:207], v9 offset:6144
    v_xor_b32 v18, s39, v8
    v_mfma_f32_16x16x32_bf16 v[252:255], a[212:215], v[120:123], v[252:255]
    buffer_atomic_or v16, v17, s[24:27], 0 offen
    v_mfma_f32_16x16x32_bf16 v[220:223], a[208:211], v[120:123], v[220:223]
    s_waitcnt lgkmcnt(4)
    buffer_load_dwordx4 v4, s[12:15], s38 offen offset:0 lds
    v_mfma_f32_16x16x32_bf16 v[44:47], a[192:195], v[120:123], v[44:47]
    s_add_u32 m0, s49, 50048
    ds_read_b64_tr_b16 a[208:209], v10 offset:0
    v_xor_b32 v19, s39, v9
    v_mfma_f32_16x16x32_bf16 v[60:63], a[196:199], v[120:123], v[60:63]
    ds_read_b64_tr_b16 a[210:211], v10 offset:6144
    v_accvgpr_read_b32 v152, a76
    v_mfma_f32_16x16x32_bf16 v[56:59], a[196:199], v[112:115], v[56:59]
    buffer_load_dwordx4 v4, s[12:15], s38 offen offset:128 lds
    v_mfma_f32_16x16x32_bf16 v[40:43], a[192:195], v[112:115], v[40:43]
    s_add_u32 m0, s49, 50944
    v_accvgpr_read_b32 v153, a77
    v_accvgpr_read_b32 v154, a78
    v_mfma_f32_16x16x32_bf16 v[36:39], a[192:195], v[104:107], v[36:39]
    ds_read_b64_tr_b16 a[212:213], v11 offset:0
    v_accvgpr_read_b32 v155, a79
    v_mfma_f32_16x16x32_bf16 v[52:55], a[196:199], v[104:107], v[52:55]
    ds_read_b64_tr_b16 a[214:215], v11 offset:6144
    v_fma_f32 v152, v152, v23, -v23
    v_accvgpr_read_b32 v30, a94
    v_fma_f32 v30, v30, v23, -v23
    v_accvgpr_read_b32 v31, a95
    v_fma_f32 v31, v31, v23, -v23
    v_fma_f32 v154, v154, v23, -v23
    v_fma_f32 v155, v155, v23, -v23
    v_fma_f32 v153, v153, v23, -v23
    v_cvt_pk_bf16_f32 v152, v152, v153
    v_cvt_pk_bf16_f32 v153, v154, v155
    v_accvgpr_read_b32 v154, a92
    v_fma_f32 v154, v154, v23, -v23
    v_accvgpr_read_b32 v155, a93
    v_fma_f32 v155, v155, v23, -v23
    v_cvt_pk_bf16_f32 v154, v154, v155
    v_cvt_pk_bf16_f32 v155, v30, v31
    v_mfma_f32_16x16x32_bf16 v[48:51], a[196:199], v[96:99], v[48:51]
    buffer_load_dwordx4 v4, s[12:15], s76 offen offset:256 lds
    v_mfma_f32_16x16x32_bf16 v[32:35], a[192:195], v[96:99], v[32:35]
    s_waitcnt lgkmcnt(4)
    v_accvgpr_read_b32 v160, a96
    v_accvgpr_read_b32 v161, a97
    v_mfma_f32_16x16x32_bf16 a[224:227], a[200:203], v[128:131], a[224:227]
    s_add_u32 m0, s49, 52224
    ds_read_b64_tr_b16 a[192:193], v8 offset:1024
    v_accvgpr_read_b32 v162, a98
    v_mfma_f32_16x16x32_bf16 a[240:243], a[204:207], v[128:131], a[240:243]
    ds_read_b64_tr_b16 a[194:195], v8 offset:7168
    v_accvgpr_read_b32 v163, a99
    v_mfma_f32_16x16x32_bf16 a[244:247], a[204:207], v[136:139], a[244:247]
    buffer_load_dwordx4 v5, s[12:15], s38 offen offset:0 lds
    v_mfma_f32_16x16x32_bf16 a[228:231], a[200:203], v[136:139], a[228:231]
    s_add_u32 m0, s49, 53120
    v_fma_f32 v160, v160, v20, -v20
    v_fma_f32 v161, v161, v20, -v20
    v_mfma_f32_16x16x32_bf16 a[232:235], a[200:203], v[144:147], a[232:235]
    ds_read_b64_tr_b16 a[196:197], v9 offset:1024
    v_fma_f32 v162, v162, v20, -v20
    v_mfma_f32_16x16x32_bf16 a[248:251], a[204:207], v[144:147], a[248:251]
    ds_read_b64_tr_b16 a[198:199], v9 offset:7168
    v_fma_f32 v163, v163, v20, -v20
    v_mfma_f32_16x16x32_bf16 a[252:255], a[204:207], v[152:155], a[252:255]
    v_cvt_pk_bf16_f32 v160, v160, v161
    v_cvt_pk_bf16_f32 v161, v162, v163
    v_mfma_f32_16x16x32_bf16 a[236:239], a[200:203], v[152:155], a[236:239]
    s_waitcnt lgkmcnt(4)
    buffer_load_dwordx4 v5, s[12:15], s38 offen offset:128 lds
    v_accvgpr_read_b32 v24, a114
    v_fma_f32 v24, v24, v20, -v20
    v_accvgpr_read_b32 v25, a115
    v_fma_f32 v25, v25, v20, -v20
    v_accvgpr_read_b32 v162, a112
    v_fma_f32 v162, v162, v20, -v20
    v_accvgpr_read_b32 v163, a113
    v_fma_f32 v163, v163, v20, -v20
    v_cvt_pk_bf16_f32 v162, v162, v163
    v_cvt_pk_bf16_f32 v163, v24, v25
    v_mfma_f32_16x16x32_bf16 v[92:95], a[208:211], v[152:155], v[92:95]
    s_add_u32 m0, s49, 54016
    ds_read_b64_tr_b16 a[200:201], v10 offset:1024
    v_accvgpr_read_b32 v168, a100
    v_mfma_f32_16x16x32_bf16 v[124:127], a[212:215], v[152:155], v[124:127]
    ds_read_b64_tr_b16 a[202:203], v10 offset:7168
    v_accvgpr_read_b32 v169, a101
    v_mfma_f32_16x16x32_bf16 v[116:119], a[212:215], v[144:147], v[116:119]
    v_accvgpr_read_b32 v170, a102
    v_accvgpr_read_b32 v171, a103
    v_mfma_f32_16x16x32_bf16 v[84:87], a[208:211], v[144:147], v[84:87]
    buffer_store_dwordx4 v[120:123], v28, s[20:23], s55 offen offset:3072 sc1
    v_mfma_f32_16x16x32_bf16 v[76:79], a[208:211], v[136:139], v[76:79]
    s_add_u32 s55, s55, 12288
    ds_read_b64_tr_b16 a[204:205], v11 offset:1024
    v_fma_f32 v168, v168, v21, -v21
    v_mfma_f32_16x16x32_bf16 v[108:111], a[212:215], v[136:139], v[108:111]
    ds_read_b64_tr_b16 a[206:207], v11 offset:7168
    v_fma_f32 v169, v169, v21, -v21
    v_mfma_f32_16x16x32_bf16 v[100:103], a[212:215], v[128:131], v[100:103]
    v_fma_f32 v170, v170, v21, -v21
    v_fma_f32 v171, v171, v21, -v21
    v_mfma_f32_16x16x32_bf16 v[68:71], a[208:211], v[128:131], v[68:71]
    s_waitcnt lgkmcnt(4)
    buffer_load_dwordx4 v5, s[12:15], s76 offen offset:256 lds
    v_mfma_f32_16x16x32_bf16 v[132:135], a[192:195], v[128:131], v[132:135]
    ds_read_b64_tr_b16 a[208:209], v18 offset:2048
    v_cvt_pk_bf16_f32 v168, v168, v169
    v_mfma_f32_16x16x32_bf16 v[164:167], a[196:199], v[128:131], v[164:167]
    ds_read_b64_tr_b16 a[210:211], v18 offset:8192
    v_cvt_pk_bf16_f32 v169, v170, v171
    v_accvgpr_read_b32 v26, a118
    v_fma_f32 v26, v26, v21, -v21
    v_accvgpr_read_b32 v27, a119
    v_fma_f32 v27, v27, v21, -v21
    v_accvgpr_read_b32 v170, a116
    v_fma_f32 v170, v170, v21, -v21
    v_accvgpr_read_b32 v171, a117
    v_fma_f32 v171, v171, v21, -v21
    v_cvt_pk_bf16_f32 v170, v170, v171
    v_cvt_pk_bf16_f32 v171, v26, v27
    v_mfma_f32_16x16x32_bf16 v[172:175], a[196:199], v[136:139], v[172:175]
    v_accvgpr_read_b32 v176, a104
    v_accvgpr_read_b32 v177, a105
    v_mfma_f32_16x16x32_bf16 v[140:143], a[192:195], v[136:139], v[140:143]
    v_accvgpr_read_b32 v178, a106
    v_accvgpr_read_b32 v179, a107
    v_mfma_f32_16x16x32_bf16 v[148:151], a[192:195], v[144:147], v[148:151]
    ds_read_b64_tr_b16 a[212:213], v19 offset:2048
    v_fma_f32 v176, v176, v22, -v22
    v_mfma_f32_16x16x32_bf16 v[180:183], a[196:199], v[144:147], v[180:183]
    ds_read_b64_tr_b16 a[214:215], v19 offset:8192
    v_fma_f32 v177, v177, v22, -v22
    v_mfma_f32_16x16x32_bf16 v[188:191], a[196:199], v[152:155], v[188:191]
    buffer_store_dwordx4 v[128:131], v28, s[20:23], s55 offen offset:0 sc1
    v_mfma_f32_16x16x32_bf16 v[156:159], a[192:195], v[152:155], v[156:159]
    s_waitcnt lgkmcnt(4)
    v_fma_f32 v178, v178, v22, -v22
    v_fma_f32 v179, v179, v22, -v22
    v_mfma_f32_16x16x32_bf16 v[220:223], a[200:203], v[152:155], v[220:223]
    ds_read_b64_tr_b16 a[192:193], v8 offset:12288
    v_cvt_pk_bf16_f32 v176, v176, v177
    v_mfma_f32_16x16x32_bf16 v[252:255], a[204:207], v[152:155], v[252:255]
    ds_read_b64_tr_b16 a[194:195], v8 offset:18432
    v_cvt_pk_bf16_f32 v177, v178, v179
    v_mfma_f32_16x16x32_bf16 v[244:247], a[204:207], v[144:147], v[244:247]
    v_accvgpr_read_b32 v178, a120
    v_accvgpr_read_b32 v179, a121
    v_mfma_f32_16x16x32_bf16 v[212:215], a[200:203], v[144:147], v[212:215]
    v_accvgpr_read_b32 v30, a122
    v_accvgpr_read_b32 v31, a123
    v_fma_f32 v30, v30, v22, -v22
    v_fma_f32 v31, v31, v22, -v22
    v_fma_f32 v178, v178, v22, -v22
    v_fma_f32 v179, v179, v22, -v22
    v_cvt_pk_bf16_f32 v178, v178, v179
    v_cvt_pk_bf16_f32 v179, v30, v31
    v_mfma_f32_16x16x32_bf16 v[204:207], a[200:203], v[136:139], v[204:207]
    ds_read_b64_tr_b16 a[196:197], v9 offset:12288
    v_accvgpr_read_b32 v184, a108
    v_mfma_f32_16x16x32_bf16 v[236:239], a[204:207], v[136:139], v[236:239]
    ds_read_b64_tr_b16 a[198:199], v9 offset:18432
    v_accvgpr_read_b32 v185, a109
    v_mfma_f32_16x16x32_bf16 v[228:231], a[204:207], v[128:131], v[228:231]
    v_accvgpr_read_b32 v186, a110
    v_accvgpr_read_b32 v187, a111
    v_mfma_f32_16x16x32_bf16 v[196:199], a[200:203], v[128:131], v[196:199]
    s_waitcnt lgkmcnt(4)
    v_fma_f32 v184, v184, v23, -v23
    v_fma_f32 v185, v185, v23, -v23
    v_mfma_f32_16x16x32_bf16 v[32:35], a[208:211], v[128:131], v[32:35]
    ds_read_b64_tr_b16 a[200:201], v10 offset:12288
    v_fma_f32 v186, v186, v23, -v23
    v_mfma_f32_16x16x32_bf16 v[48:51], a[212:215], v[128:131], v[48:51]
    ds_read_b64_tr_b16 a[202:203], v10 offset:18432
    v_fma_f32 v187, v187, v23, -v23
    v_mfma_f32_16x16x32_bf16 v[52:55], a[212:215], v[136:139], v[52:55]
    v_cvt_pk_bf16_f32 v184, v184, v185
    v_cvt_pk_bf16_f32 v185, v186, v187
    v_mfma_f32_16x16x32_bf16 v[36:39], a[208:211], v[136:139], v[36:39]
    buffer_store_dwordx4 v[136:139], v28, s[20:23], s55 offen offset:1024 sc1
    v_mfma_f32_16x16x32_bf16 v[40:43], a[208:211], v[144:147], v[40:43]
    ds_read_b64_tr_b16 a[204:205], v11 offset:12288
    v_accvgpr_read_b32 v186, a124
    v_mfma_f32_16x16x32_bf16 v[56:59], a[212:215], v[144:147], v[56:59]
    ds_read_b64_tr_b16 a[206:207], v11 offset:18432
    v_accvgpr_read_b32 v187, a125
    v_accvgpr_read_b32 v24, a126
    v_fma_f32 v24, v24, v23, -v23
    v_accvgpr_read_b32 v25, a127
    v_fma_f32 v25, v25, v23, -v23
    v_fma_f32 v186, v186, v23, -v23
    v_fma_f32 v187, v187, v23, -v23
    v_cvt_pk_bf16_f32 v186, v186, v187
    v_cvt_pk_bf16_f32 v187, v24, v25
    v_mfma_f32_16x16x32_bf16 v[60:63], a[212:215], v[152:155], v[60:63]
    v_accvgpr_read_b32 v192, a128
    v_accvgpr_read_b32 v193, a129
    v_mfma_f32_16x16x32_bf16 v[44:47], a[208:211], v[152:155], v[44:47]
    s_waitcnt lgkmcnt(4)
    v_accvgpr_read_b32 v194, a130
    v_accvgpr_read_b32 v195, a131
    v_mfma_f32_16x16x32_bf16 a[236:239], a[192:195], v[184:187], a[236:239]
    ds_read_b64_tr_b16 a[208:209], v8 offset:13312
    v_fma_f32 v192, v192, v20, -v20
    v_mfma_f32_16x16x32_bf16 a[252:255], a[196:199], v[184:187], a[252:255]
    ds_read_b64_tr_b16 a[210:211], v8 offset:19456
    v_fma_f32 v193, v193, v20, -v20
    v_mfma_f32_16x16x32_bf16 a[248:251], a[196:199], v[176:179], a[248:251]
    v_fma_f32 v194, v194, v20, -v20
    v_fma_f32 v195, v195, v20, -v20
    v_mfma_f32_16x16x32_bf16 a[232:235], a[192:195], v[176:179], a[232:235]
    v_cvt_pk_bf16_f32 v192, v192, v193
    v_cvt_pk_bf16_f32 v193, v194, v195
    v_mfma_f32_16x16x32_bf16 a[228:231], a[192:195], v[168:171], a[228:231]
    ds_read_b64_tr_b16 a[212:213], v9 offset:13312
    v_accvgpr_read_b32 v194, a144
    v_mfma_f32_16x16x32_bf16 a[244:247], a[196:199], v[168:171], a[244:247]
    ds_read_b64_tr_b16 a[214:215], v9 offset:19456
    v_accvgpr_read_b32 v195, a145
    v_mfma_f32_16x16x32_bf16 a[240:243], a[196:199], v[160:163], a[240:243]
    v_accvgpr_read_b32 v26, a146
    v_accvgpr_read_b32 v27, a147
    v_mfma_f32_16x16x32_bf16 a[224:227], a[192:195], v[160:163], a[224:227]
    s_waitcnt lgkmcnt(4)
    v_fma_f32 v194, v194, v20, -v20
    v_fma_f32 v195, v195, v20, -v20
    v_fma_f32 v26, v26, v20, -v20
    v_fma_f32 v27, v27, v20, -v20
    v_cvt_pk_bf16_f32 v194, v194, v195
    v_cvt_pk_bf16_f32 v195, v26, v27
    v_mfma_f32_16x16x32_bf16 v[68:71], a[200:203], v[160:163], v[68:71]
    ds_read_b64_tr_b16 a[192:193], v10 offset:13312
    v_add_u32 v8, 122880, v12
    v_mfma_f32_16x16x32_bf16 v[100:103], a[204:207], v[160:163], v[100:103]
    ds_read_b64_tr_b16 a[194:195], v10 offset:19456
    v_accvgpr_read_b32 v200, a132
    v_mfma_f32_16x16x32_bf16 v[108:111], a[204:207], v[168:171], v[108:111]
    buffer_store_dwordx4 v[144:147], v28, s[20:23], s55 offen offset:2048 sc1
    v_mfma_f32_16x16x32_bf16 v[76:79], a[200:203], v[168:171], v[76:79]
    v_accvgpr_read_b32 v201, a133
    v_accvgpr_read_b32 v202, a134
    v_mfma_f32_16x16x32_bf16 v[84:87], a[200:203], v[176:179], v[84:87]
    ds_read_b64_tr_b16 a[196:197], v11 offset:13312
    v_accvgpr_read_b32 v203, a135
    v_mfma_f32_16x16x32_bf16 v[116:119], a[204:207], v[176:179], v[116:119]
    ds_read_b64_tr_b16 a[198:199], v11 offset:19456
    v_fma_f32 v200, v200, v21, -v21
    v_mfma_f32_16x16x32_bf16 v[124:127], a[204:207], v[184:187], v[124:127]
    v_fma_f32 v201, v201, v21, -v21
    v_fma_f32 v202, v202, v21, -v21
    v_mfma_f32_16x16x32_bf16 v[92:95], a[200:203], v[184:187], v[92:95]
    s_waitcnt lgkmcnt(4)
    v_fma_f32 v203, v203, v21, -v21
    v_cvt_pk_bf16_f32 v200, v200, v201
    v_mfma_f32_16x16x32_bf16 v[156:159], a[208:211], v[184:187], v[156:159]
    ds_read_b64_tr_b16 a[200:201], v18 offset:14336
    v_cvt_pk_bf16_f32 v201, v202, v203
    v_mfma_f32_16x16x32_bf16 v[188:191], a[212:215], v[184:187], v[188:191]
    ds_read_b64_tr_b16 a[202:203], v18 offset:20480
    v_accvgpr_read_b32 v202, a148
    v_accvgpr_read_b32 v30, a150
    v_fma_f32 v30, v30, v21, -v21
    v_accvgpr_read_b32 v31, a151
    v_fma_f32 v31, v31, v21, -v21
    v_fma_f32 v202, v202, v21, -v21
    v_accvgpr_read_b32 v203, a149
    v_fma_f32 v203, v203, v21, -v21
    v_cvt_pk_bf16_f32 v202, v202, v203
    v_cvt_pk_bf16_f32 v203, v30, v31
    v_mfma_f32_16x16x32_bf16 v[180:183], a[212:215], v[176:179], v[180:183]
    s_add_u32 s38, s35, 81920
    v_add_u32 v9, 122880, v13
    v_add_u32 v10, 122880, v14
    v_mfma_f32_16x16x32_bf16 v[148:151], a[208:211], v[176:179], v[148:151]
    s_add_u32 s57, s33, 122880
    v_accvgpr_read_b32 v208, a136
    v_accvgpr_read_b32 v209, a137
    v_mfma_f32_16x16x32_bf16 v[140:143], a[208:211], v[168:171], v[140:143]
    s_cmp_lt_u32 s3, 2
    s_cselect_b32 s38, s38, s57
    ds_read_b64_tr_b16 a[204:205], v19 offset:14336
    v_mfma_f32_16x16x32_bf16 v[172:175], a[212:215], v[168:171], v[172:175]
    s_waitcnt vmcnt(24)
    ds_read_b64_tr_b16 a[206:207], v19 offset:20480
    v_lshlrev_b32 v16, 4, v16
    v_mfma_f32_16x16x32_bf16 v[164:167], a[212:215], v[160:163], v[164:167]
    s_barrier
    v_mfma_f32_16x16x32_bf16 v[132:135], a[208:211], v[160:163], v[132:135]
    s_waitcnt lgkmcnt(4)
    v_accvgpr_read_b32 v210, a138
    v_accvgpr_read_b32 v211, a139
    v_mfma_f32_16x16x32_bf16 v[196:199], a[192:195], v[160:163], v[196:199]
    s_add_u32 s76, s38, s63
    ds_read_b64_tr_b16 a[208:209], v8 offset:0
    v_fma_f32 v208, v208, v22, -v22
    v_mfma_f32_16x16x32_bf16 v[228:231], a[196:199], v[160:163], v[228:231]
    s_add_u32 m0, s49, 0
    ds_read_b64_tr_b16 a[210:211], v8 offset:6144
    v_fma_f32 v209, v209, v22, -v22
    v_mfma_f32_16x16x32_bf16 v[236:239], a[196:199], v[168:171], v[236:239]
    buffer_store_dwordx4 v[152:155], v28, s[20:23], s55 offen offset:3072 sc1
    v_mfma_f32_16x16x32_bf16 v[204:207], a[192:195], v[168:171], v[204:207]
    s_add_u32 s55, s55, 4096
    v_fma_f32 v210, v210, v22, -v22
    v_fma_f32 v211, v211, v22, -v22
    v_accvgpr_read_b32 v24, a154
    v_fma_f32 v24, v24, v22, -v22
    v_accvgpr_read_b32 v25, a155
    v_fma_f32 v25, v25, v22, -v22
    v_cvt_pk_bf16_f32 v208, v208, v209
    v_cvt_pk_bf16_f32 v209, v210, v211
    v_accvgpr_read_b32 v210, a152
    v_fma_f32 v210, v210, v22, -v22
    v_accvgpr_read_b32 v211, a153
    v_fma_f32 v211, v211, v22, -v22
    v_cvt_pk_bf16_f32 v210, v210, v211
    v_cvt_pk_bf16_f32 v211, v24, v25
    v_mfma_f32_16x16x32_bf16 v[212:215], a[192:195], v[176:179], v[212:215]
    s_load_dword s72, s[86:87], s5 offset:4 glc
    ds_read_b64_tr_b16 a[212:213], v9 offset:0
    v_add_u32 v11, 122880, v15
    v_mfma_f32_16x16x32_bf16 v[244:247], a[196:199], v[176:179], v[244:247]
    s_waitcnt vmcnt(5)
    ds_read_b64_tr_b16 a[214:215], v9 offset:6144
    v_xor_b32 v18, s39, v8
    v_mfma_f32_16x16x32_bf16 v[252:255], a[196:199], v[184:187], v[252:255]
    buffer_atomic_or v16, v17, s[24:27], 0 offen
    v_mfma_f32_16x16x32_bf16 v[220:223], a[192:195], v[184:187], v[220:223]
    s_waitcnt lgkmcnt(4)
    buffer_load_dwordx4 v4, s[12:15], s38 offen offset:0 lds
    v_mfma_f32_16x16x32_bf16 v[44:47], a[200:203], v[184:187], v[44:47]
    s_add_u32 m0, s49, 896
    ds_read_b64_tr_b16 a[192:193], v10 offset:0
    v_xor_b32 v19, s39, v9
    v_mfma_f32_16x16x32_bf16 v[60:63], a[204:207], v[184:187], v[60:63]
    ds_read_b64_tr_b16 a[194:195], v10 offset:6144
    v_accvgpr_read_b32 v216, a140
    v_mfma_f32_16x16x32_bf16 v[56:59], a[204:207], v[176:179], v[56:59]
    buffer_load_dwordx4 v4, s[12:15], s38 offen offset:128 lds
    v_mfma_f32_16x16x32_bf16 v[40:43], a[200:203], v[176:179], v[40:43]
    s_add_u32 m0, s49, 1792
    v_accvgpr_read_b32 v217, a141
    v_accvgpr_read_b32 v218, a142
    v_mfma_f32_16x16x32_bf16 v[36:39], a[200:203], v[168:171], v[36:39]
    s_mov_b32 s28, s82
    ds_read_b64_tr_b16 a[196:197], v11 offset:0
    v_accvgpr_read_b32 v219, a143
    v_mfma_f32_16x16x32_bf16 v[52:55], a[204:207], v[168:171], v[52:55]
    s_and_b32 s29, s83, 0xffff
    ds_read_b64_tr_b16 a[198:199], v11 offset:6144
    v_fma_f32 v216, v216, v23, -v23
    v_accvgpr_read_b32 v26, a158
    v_fma_f32 v26, v26, v23, -v23
    v_accvgpr_read_b32 v27, a159
    v_fma_f32 v27, v27, v23, -v23
    v_fma_f32 v218, v218, v23, -v23
    v_fma_f32 v219, v219, v23, -v23
    v_fma_f32 v217, v217, v23, -v23
    v_cvt_pk_bf16_f32 v216, v216, v217
    v_cvt_pk_bf16_f32 v217, v218, v219
    v_accvgpr_read_b32 v218, a156
    v_fma_f32 v218, v218, v23, -v23
    v_accvgpr_read_b32 v219, a157
    v_fma_f32 v219, v219, v23, -v23
    v_cvt_pk_bf16_f32 v218, v218, v219
    v_cvt_pk_bf16_f32 v219, v26, v27
    v_mfma_f32_16x16x32_bf16 v[48:51], a[204:207], v[160:163], v[48:51]
    buffer_store_dwordx4 v[160:163], v28, s[20:23], s55 offen offset:0 sc1
    v_mfma_f32_16x16x32_bf16 v[32:35], a[200:203], v[160:163], v[32:35]
    s_waitcnt lgkmcnt(4)
    v_accvgpr_read_b32 v224, a160
    v_accvgpr_read_b32 v225, a161
    v_mfma_f32_16x16x32_bf16 a[224:227], a[208:211], v[192:195], a[224:227]
    s_mov_b32 s30, 1966080
    ds_read_b64_tr_b16 a[200:201], v8 offset:1024
    v_accvgpr_read_b32 v226, a162
    v_mfma_f32_16x16x32_bf16 a[240:243], a[212:215], v[192:195], a[240:243]
    s_mov_b32 s31, 0x00020000
    ds_read_b64_tr_b16 a[202:203], v8 offset:7168
    v_accvgpr_read_b32 v227, a163
    v_mfma_f32_16x16x32_bf16 a[244:247], a[212:215], v[200:203], a[244:247]
    buffer_load_dwordx4 v4, s[12:15], s76 offen offset:256 lds
    v_mfma_f32_16x16x32_bf16 a[228:231], a[208:211], v[200:203], a[228:231]
    s_add_u32 m0, s49, 3072
    v_fma_f32 v224, v224, v20, -v20
    v_fma_f32 v225, v225, v20, -v20
    v_mfma_f32_16x16x32_bf16 a[232:235], a[208:211], v[208:211], a[232:235]
    s_mul_i32 s44, s47, 10
    ds_read_b64_tr_b16 a[204:205], v9 offset:1024
    v_fma_f32 v226, v226, v20, -v20
    v_mfma_f32_16x16x32_bf16 a[248:251], a[212:215], v[208:211], a[248:251]
    s_sub_u32 s44, s58, s44
    ds_read_b64_tr_b16 a[206:207], v9 offset:7168
    v_fma_f32 v227, v227, v20, -v20
    v_mfma_f32_16x16x32_bf16 a[252:255], a[212:215], v[216:219], a[252:255]
    s_lshl_b32 s62, s44, 2
    v_cvt_pk_bf16_f32 v224, v224, v225
    v_cvt_pk_bf16_f32 v225, v226, v227
    v_mfma_f32_16x16x32_bf16 a[236:239], a[208:211], v[216:219], a[236:239]
    s_waitcnt lgkmcnt(4)
    buffer_load_dwordx4 v5, s[12:15], s38 offen offset:0 lds
    v_accvgpr_read_b32 v30, a178
    v_fma_f32 v30, v30, v20, -v20
    v_accvgpr_read_b32 v31, a179
    v_fma_f32 v31, v31, v20, -v20
    v_accvgpr_read_b32 v226, a176
    v_fma_f32 v226, v226, v20, -v20
    v_accvgpr_read_b32 v227, a177
    v_fma_f32 v227, v227, v20, -v20
    v_cvt_pk_bf16_f32 v226, v226, v227
    v_cvt_pk_bf16_f32 v227, v30, v31
    v_mfma_f32_16x16x32_bf16 v[92:95], a[192:195], v[216:219], v[92:95]
    s_add_u32 m0, s49, 3968
    ds_read_b64_tr_b16 a[208:209], v10 offset:1024
    v_accvgpr_read_b32 v232, a164
    v_mfma_f32_16x16x32_bf16 v[124:127], a[196:199], v[216:219], v[124:127]
    s_add_u32 s62, s62, s3
    ds_read_b64_tr_b16 a[210:211], v10 offset:7168
    v_accvgpr_read_b32 v233, a165
    v_mfma_f32_16x16x32_bf16 v[116:119], a[196:199], v[208:211], v[116:119]
    s_lshl_b32 s62, s62, 9
    v_accvgpr_read_b32 v234, a166
    v_accvgpr_read_b32 v235, a167
    v_mfma_f32_16x16x32_bf16 v[84:87], a[192:195], v[208:211], v[84:87]
    buffer_load_dwordx4 v5, s[12:15], s38 offen offset:128 lds
    v_mfma_f32_16x16x32_bf16 v[76:79], a[192:195], v[200:203], v[76:79]
    s_add_u32 m0, s49, 4864
    ds_read_b64_tr_b16 a[212:213], v11 offset:1024
    v_fma_f32 v232, v232, v21, -v21
    v_mfma_f32_16x16x32_bf16 v[108:111], a[196:199], v[200:203], v[108:111]
    s_add_u32 s62, s62, 3670016
    ds_read_b64_tr_b16 a[214:215], v11 offset:7168
    v_fma_f32 v233, v233, v21, -v21
    v_mfma_f32_16x16x32_bf16 v[100:103], a[196:199], v[192:195], v[100:103]
    s_cmp_lt_u32 s2, 240
    s_cselect_b32 s62, s62, 0x70000000
    v_fma_f32 v234, v234, v21, -v21
    v_mfma_f32_16x16x32_bf16 v[68:71], a[192:195], v[192:195], v[68:71]
    s_waitcnt lgkmcnt(4)
    buffer_store_dwordx4 v[168:171], v28, s[20:23], s55 offen offset:1024 sc1
    v_mfma_f32_16x16x32_bf16 v[132:135], a[200:203], v[192:195], v[132:135]
    s_lshl_b32 s59, s47, 6
    ds_read_b64_tr_b16 a[192:193], v18 offset:2048
    v_fma_f32 v235, v235, v21, -v21
    v_mfma_f32_16x16x32_bf16 v[164:167], a[204:207], v[192:195], v[164:167]
    s_lshr_b32 s56, s3, 1
    ds_read_b64_tr_b16 a[194:195], v18 offset:8192
    v_cvt_pk_bf16_f32 v232, v232, v233
    v_accvgpr_read_b32 v24, a182
    v_fma_f32 v24, v24, v21, -v21
    v_accvgpr_read_b32 v25, a183
    v_fma_f32 v25, v25, v21, -v21
    v_cvt_pk_bf16_f32 v233, v234, v235
    v_accvgpr_read_b32 v234, a180
    v_fma_f32 v234, v234, v21, -v21
    v_accvgpr_read_b32 v235, a181
    v_fma_f32 v235, v235, v21, -v21
    v_cvt_pk_bf16_f32 v234, v234, v235
    v_cvt_pk_bf16_f32 v235, v24, v25
    v_mfma_f32_16x16x32_bf16 v[172:175], a[204:207], v[200:203], v[172:175]
pg_9:
    s_cbranch_execz pg_13
    s_lshl_b32 s56, s56, 5
    v_accvgpr_read_b32 v240, a168
    v_accvgpr_read_b32 v241, a169
    v_mfma_f32_16x16x32_bf16 v[140:143], a[200:203], v[200:203], v[140:143]
    s_add_u32 s59, s59, s56
    v_accvgpr_read_b32 v242, a170
    v_accvgpr_read_b32 v243, a171
    v_mfma_f32_16x16x32_bf16 v[148:151], a[200:203], v[208:211], v[148:151]
    s_and_b32 s56, s3, 1
    ds_read_b64_tr_b16 a[196:197], v19 offset:2048
    v_fma_f32 v240, v240, v22, -v22
    v_mfma_f32_16x16x32_bf16 v[180:183], a[204:207], v[208:211], v[180:183]
    s_lshl_b32 s56, s56, 2
    ds_read_b64_tr_b16 a[198:199], v19 offset:8192
    v_fma_f32 v241, v241, v22, -v22
    v_mfma_f32_16x16x32_bf16 v[188:191], a[204:207], v[216:219], v[188:191]
    s_bfe_u32 s88, s72, 262144
    s_cmp_lg_u32 s88, 15
    s_cbranch_scc1 spin_o0
spin_o0_ret:
    v_fma_f32 v242, v242, v22, -v22
    v_mfma_f32_16x16x32_bf16 v[156:159], a[200:203], v[216:219], v[156:159]
    s_waitcnt lgkmcnt(4)
    buffer_load_dwordx4 v5, s[12:15], s76 offen offset:256 lds
    v_mfma_f32_16x16x32_bf16 v[220:223], a[208:211], v[216:219], v[220:223]
    s_add_u32 s59, s59, s56
    ds_read_b64_tr_b16 a[200:201], v8 offset:12288
    v_fma_f32 v243, v243, v22, -v22
    v_mfma_f32_16x16x32_bf16 v[252:255], a[212:215], v[216:219], v[252:255]
    s_mul_i32 s59, s59, 1280
    ds_read_b64_tr_b16 a[202:203], v8 offset:18432
    v_cvt_pk_bf16_f32 v240, v240, v241
    v_mfma_f32_16x16x32_bf16 v[244:247], a[212:215], v[208:211], v[244:247]
    buffer_load_dwordx4 a[0:3], v28, s[20:23], s8 offen offset:0 sc1
    v_mfma_f32_16x16x32_bf16 v[212:215], a[208:211], v[208:211], v[212:215]
    s_lshl_b32 s44, s44, 7
    v_cvt_pk_bf16_f32 v241, v242, v243
    v_accvgpr_read_b32 v242, a184
    v_accvgpr_read_b32 v26, a186
    v_fma_f32 v26, v26, v22, -v22
    v_accvgpr_read_b32 v27, a187
    v_fma_f32 v27, v27, v22, -v22
    v_fma_f32 v242, v242, v22, -v22
    v_accvgpr_read_b32 v243, a185
    v_fma_f32 v243, v243, v22, -v22
    v_cvt_pk_bf16_f32 v242, v242, v243
    v_cvt_pk_bf16_f32 v243, v26, v27
    v_mfma_f32_16x16x32_bf16 v[204:207], a[208:211], v[200:203], v[204:207]
    s_add_u32 s59, s59, s44
    ds_read_b64_tr_b16 a[204:205], v9 offset:12288
    v_accvgpr_read_b32 v248, a172
    v_mfma_f32_16x16x32_bf16 v[236:239], a[212:215], v[200:203], v[236:239]
    s_lshl_b32 s44, s3, 11
    ds_read_b64_tr_b16 a[206:207], v9 offset:18432
    v_lshrrev_b32 v29, 5, v1
    v_mfma_f32_16x16x32_bf16 v[228:231], a[212:215], v[192:195], v[228:231]
    buffer_load_dwordx4 a[4:7], v28, s[20:23], s8 offen offset:1024 sc1
    v_mfma_f32_16x16x32_bf16 v[196:199], a[208:211], v[192:195], v[196:199]
    s_waitcnt lgkmcnt(4)
    v_lshlrev_b32 v29, 3, v29
    v_bfe_u32 v6, v1, 3, 2
    v_mfma_f32_16x16x32_bf16 v[32:35], a[192:195], v[192:195], v[32:35]
    ds_read_b64_tr_b16 a[208:209], v10 offset:12288
    v_add_u32 v6, v6, v29
    v_mfma_f32_16x16x32_bf16 v[48:51], a[196:199], v[192:195], v[48:51]
    ds_read_b64_tr_b16 a[210:211], v10 offset:18432
    v_mul_u32_u24 v6, 1280, v6
    v_mfma_f32_16x16x32_bf16 v[52:55], a[196:199], v[200:203], v[52:55]
    buffer_load_dwordx4 a[8:11], v28, s[20:23], s8 offen offset:2048 sc1
    v_mfma_f32_16x16x32_bf16 v[36:39], a[192:195], v[200:203], v[36:39]
    v_lshrrev_b32 v29, 4, v1
    v_lshlrev_b32 v29, 1, v29
    v_mfma_f32_16x16x32_bf16 v[40:43], a[192:195], v[208:211], v[40:43]
    ds_read_b64_tr_b16 a[212:213], v11 offset:12288
    v_and_b32 v7, 7, v1
    v_mfma_f32_16x16x32_bf16 v[56:59], a[196:199], v[208:211], v[56:59]
    ds_read_b64_tr_b16 a[214:215], v11 offset:18432
    v_xor_b32 v7, v7, v29
    buffer_store_dwordx4 v[176:179], v28, s[20:23], s55 offen offset:2048 sc1
    v_accvgpr_read_b32 v30, a190
    v_fma_f32 v30, v30, v23, -v23
    v_accvgpr_read_b32 v31, a191
    v_fma_f32 v31, v31, v23, -v23
    v_accvgpr_read_b32 v250, a174
    v_fma_f32 v250, v250, v23, -v23
    v_accvgpr_read_b32 v251, a175
    v_fma_f32 v251, v251, v23, -v23
    v_fma_f32 v248, v248, v23, -v23
    v_accvgpr_read_b32 v249, a173
    v_fma_f32 v249, v249, v23, -v23
    v_cvt_pk_bf16_f32 v248, v248, v249
    v_cvt_pk_bf16_f32 v249, v250, v251
    v_accvgpr_read_b32 v250, a188
    v_fma_f32 v250, v250, v23, -v23
    v_accvgpr_read_b32 v251, a189
    v_fma_f32 v251, v251, v23, -v23
    v_cvt_pk_bf16_f32 v250, v250, v251
    v_cvt_pk_bf16_f32 v251, v30, v31
    v_mfma_f32_16x16x32_bf16 v[60:63], a[196:199], v[216:219], v[60:63]
    v_lshlrev_b32 v16, 4, v16
    v_lshlrev_b32 v7, 4, v7
    v_mfma_f32_16x16x32_bf16 v[44:47], a[192:195], v[216:219], v[44:47]
    s_waitcnt lgkmcnt(4)
    v_add_u32 v6, v6, v7
    v_add_u32 v7, 20480, v6
    v_mfma_f32_16x16x32_bf16 a[236:239], a[200:203], v[248:251], a[236:239]
    s_waitcnt vmcnt(13)
    ds_read_b64_tr_b16 a[192:193], v8 offset:13312
    v_add_u32 v29, 147456, v28
    v_mfma_f32_16x16x32_bf16 a[252:255], a[204:207], v[248:251], a[252:255]
    ds_read_b64_tr_b16 a[194:195], v8 offset:19456
    v_mfma_f32_16x16x32_bf16 a[248:251], a[204:207], v[240:243], a[248:251]
    buffer_atomic_or v16, v17, s[24:27], 0 offen
    v_mfma_f32_16x16x32_bf16 a[232:235], a[200:203], v[240:243], a[232:235]
    buffer_load_dwordx4 a[12:15], v28, s[20:23], s8 offen offset:3072 sc1
    v_mfma_f32_16x16x32_bf16 a[228:231], a[200:203], v[232:235], a[228:231]
    s_add_u32 s8, s8, 4096
    ds_read_b64_tr_b16 a[196:197], v9 offset:13312
    v_add_u32 v8, 24576, v12
    v_mfma_f32_16x16x32_bf16 a[244:247], a[204:207], v[232:235], a[244:247]
    ds_read_b64_tr_b16 a[198:199], v9 offset:19456
    v_mfma_f32_16x16x32_bf16 a[240:243], a[204:207], v[224:227], a[240:243]
    v_add_u32 v9, 24576, v13
    v_mfma_f32_16x16x32_bf16 a[224:227], a[200:203], v[224:227], a[224:227]
    s_waitcnt lgkmcnt(4)
    buffer_store_dwordx4 v[184:187], v28, s[20:23], s55 offen offset:3072 sc1
    v_mfma_f32_16x16x32_bf16 v[68:71], a[208:211], v[224:227], v[68:71]
    s_add_u32 s55, s55, 12288
    ds_read_b64_tr_b16 a[200:201], v10 offset:13312
    s_mov_b32 s16, s64
    v_mfma_f32_16x16x32_bf16 v[100:103], a[212:215], v[224:227], v[100:103]
    s_and_b32 s17, s65, 0xffff
    ds_read_b64_tr_b16 a[202:203], v10 offset:19456
    s_mov_b32 s18, 2621440
    v_mfma_f32_16x16x32_bf16 v[108:111], a[212:215], v[232:235], v[108:111]
    s_mov_b32 s19, 0x00020000
    v_add_u32 v10, 24576, v14
    s_lshl_b32 s45, s52, 4
    v_mfma_f32_16x16x32_bf16 v[76:79], a[208:211], v[232:235], v[76:79]
    s_lshr_b32 s56, s53, 1
    s_lshl2_add_u32 s45, s56, s45
    s_add_u32 s45, s45, s3
    v_mfma_f32_16x16x32_bf16 v[84:87], a[208:211], v[240:243], v[84:87]
    s_lshl_b32 s56, s45, 4
    ds_read_b64_tr_b16 a[204:205], v11 offset:13312
    v_and_b32 v20, 15, v1
    v_mfma_f32_16x16x32_bf16 v[116:119], a[212:215], v[240:243], v[116:119]
    ds_read_b64_tr_b16 a[206:207], v11 offset:19456
    v_add_u32 v20, s56, v20
    v_mfma_f32_16x16x32_bf16 v[124:127], a[212:215], v[248:251], v[124:127]
    buffer_load_dwordx4 a[16:19], v28, s[20:23], s9 offen offset:0 sc1
    v_mfma_f32_16x16x32_bf16 v[92:95], a[208:211], v[248:251], v[92:95]
    s_waitcnt lgkmcnt(4)
    v_bfe_u32 v21, v1, 4, 1
    v_bfe_u32 v22, v1, 5, 1
    v_mfma_f32_16x16x32_bf16 v[156:159], a[192:195], v[248:251], v[156:159]
    ds_read_b64_tr_b16 a[208:209], v18 offset:14336
    v_lshl_add_u32 v21, v21, 1, v22
    v_mfma_f32_16x16x32_bf16 v[188:191], a[196:199], v[248:251], v[188:191]
    ds_read_b64_tr_b16 a[210:211], v18 offset:20480
    v_mul_u32_u24 v22, 1280, v20
    v_mfma_f32_16x16x32_bf16 v[180:183], a[196:199], v[240:243], v[180:183]
    buffer_load_dwordx4 a[20:23], v28, s[20:23], s9 offen offset:1024 sc1
    v_mfma_f32_16x16x32_bf16 v[148:151], a[192:195], v[240:243], v[148:151]
    v_lshl_add_u32 v22, v21, 4, v22
    v_lshlrev_b32 v23, 3, v20
    v_mfma_f32_16x16x32_bf16 v[140:143], a[192:195], v[232:235], v[140:143]
    s_lshr_b32 s48, s45, 2
    ds_read_b64_tr_b16 a[212:213], v19 offset:14336
    v_add_u32 v11, 24576, v15
    v_mfma_f32_16x16x32_bf16 v[172:175], a[196:199], v[232:235], v[172:175]
    s_waitcnt vmcnt(52)
    ds_read_b64_tr_b16 a[214:215], v19 offset:20480
    v_xor_b32 v18, s39, v8
    v_mfma_f32_16x16x32_bf16 v[164:167], a[196:199], v[224:227], v[164:167]
    s_barrier
    v_mfma_f32_16x16x32_bf16 v[132:135], a[192:195], v[224:227], v[132:135]
    s_waitcnt lgkmcnt(4)
    buffer_load_dwordx4 a[24:27], v28, s[20:23], s9 offen offset:2048 sc1
    v_mfma_f32_16x16x32_bf16 v[196:199], a[200:203], v[224:227], v[196:199]
    s_lshr_b32 s56, s48, 1
    ds_read_b64_tr_b16 a[192:193], v8 offset:0
    v_xor_b32 v19, s39, v9
    v_mfma_f32_16x16x32_bf16 v[228:231], a[204:207], v[224:227], v[228:231]
    s_lshl_b32 s56, s56, 19
    ds_read_b64_tr_b16 a[194:195], v8 offset:6144
    s_and_b32 s40, s48, 1
    v_mfma_f32_16x16x32_bf16 v[236:239], a[204:207], v[232:235], v[236:239]
    buffer_load_dwordx4 a[28:31], v28, s[20:23], s9 offen offset:3072 sc1
    buffer_store_dwordx4 v[192:195], v28, s[20:23], s55 offen offset:0 sc1
    v_mfma_f32_16x16x32_bf16 v[204:207], a[200:203], v[232:235], v[204:207]
    s_add_u32 s9, s9, 4096
    s_lshl_b32 s40, s40, 12
    s_or_b32 s56, s56, s40
    v_mfma_f32_16x16x32_bf16 v[212:215], a[200:203], v[240:243], v[212:215]
    s_lshl_b32 s40, s48, 10
    ds_read_b64_tr_b16 a[196:197], v8 offset:12288
    s_and_b32 s40, s40, 0x2000
    v_mfma_f32_16x16x32_bf16 v[244:247], a[204:207], v[240:243], v[244:247]
    s_or_b32 s56, s56, s40
    ds_read_b64_tr_b16 a[198:199], v8 offset:18432
    s_or_b32 s56, s56, 134217728
    v_mfma_f32_16x16x32_bf16 v[252:255], a[204:207], v[248:251], v[252:255]
    s_lshl_b32 s45, s3, 10
    s_add_u32 s45, s45, s56
    s_mul_i32 s56, s51, 81920
    v_mfma_f32_16x16x32_bf16 v[220:223], a[200:203], v[248:251], v[220:223]
    s_waitcnt lgkmcnt(4)
    s_add_u32 s45, s45, s56
    s_bitcmp0_b32 s53, 0
    s_cselect_b32 s47, 2, 0
    v_mfma_f32_16x16x32_bf16 v[44:47], a[208:211], v[248:251], v[44:47]
    s_lshl_b32 s47, s47, 13
    ds_read_b64_tr_b16 a[200:201], v9 offset:0
    s_add_u32 s47, s47, s45
    v_mfma_f32_16x16x32_bf16 v[60:63], a[212:215], v[248:251], v[60:63]
    s_bitcmp0_b32 s53, 0
    s_cselect_b32 s48, 4, 4
    ds_read_b64_tr_b16 a[202:203], v9 offset:6144
    v_mfma_f32_16x16x32_bf16 v[56:59], a[212:215], v[240:243], v[56:59]
    buffer_store_dwordx4 v[200:203], v28, s[20:23], s55 offen offset:1024 sc1
    v_mfma_f32_16x16x32_bf16 v[40:43], a[208:211], v[240:243], v[40:43]
    s_lshl_b32 s48, s48, 13
    s_add_u32 s48, s48, s45
    s_lshl_b32 s56, s51, 2
    v_mfma_f32_16x16x32_bf16 v[36:39], a[208:211], v[232:235], v[36:39]
    s_add_u32 s6, s51, 16
    ds_read_b64_tr_b16 a[204:205], v9 offset:12288
    s_bitcmp0_b32 s53, 0
    s_cselect_b32 s41, 1, 0
    v_mfma_f32_16x16x32_bf16 v[52:55], a[212:215], v[232:235], v[52:55]
    s_waitcnt vmcnt(7)
    s_waitcnt vmcnt(2)
    ds_read_b64_tr_b16 a[206:207], v9 offset:18432
    v_mfma_f32_16x16x32_bf16 v[48:51], a[212:215], v[224:227], v[48:51]
    s_add_u32 s41, s41, s56
    s_bitcmp0_b32 s53, 0
    s_cselect_b32 s42, 2, 2
    v_mfma_f32_16x16x32_bf16 v[32:35], a[208:211], v[224:227], v[32:35]
    s_waitcnt lgkmcnt(4)
    buffer_load_dwordx4 a[32:35], v28, s[20:23], s10 offen offset:0 sc1
    v_mfma_f32_16x16x32_bf16 a[224:227], a[192:195], a[0:3], a[224:227]
    s_load_dword s72, s[86:87], s5 offset:4 glc
    ds_read_b64_tr_b16 a[208:209], v10 offset:0
    s_add_u32 s42, s42, s56
    v_mfma_f32_16x16x32_bf16 a[224:227], a[196:199], a[16:19], a[224:227]
    s_bitcmp0_b32 s53, 0
    s_cselect_b32 s43, 3, 4
    ds_read_b64_tr_b16 a[210:211], v10 offset:6144
    v_mfma_f32_16x16x32_bf16 a[228:231], a[196:199], a[20:23], a[228:231]
    s_add_u32 s43, s43, s56
    ds_read_b128 v[64:67], v29 offset:0
    s_bitcmp0_b32 s53, 0
    s_cselect_b32 s43, s43, s6
    v_mfma_f32_16x16x32_bf16 a[228:231], a[192:195], a[4:7], a[228:231]
    s_lshl_b32 s41, s41, 6
    ds_read_b128 v[72:75], v29 offset:1024
    s_lshl_b32 s42, s42, 6
    v_mfma_f32_16x16x32_bf16 a[232:235], a[192:195], a[8:11], a[232:235]
    s_lshl_b32 s43, s43, 6
    ds_read_b64_tr_b16 a[212:213], v10 offset:12288
    s_bitcmp0_b32 s53, 0
    s_cselect_b32 s66, s42, 0x70000000
    v_mfma_f32_16x16x32_bf16 a[232:235], a[196:199], a[24:27], a[232:235]
    ds_read_b64_tr_b16 a[214:215], v10 offset:18432
    v_add_u32 v23, 3211264, v23
    v_mfma_f32_16x16x32_bf16 a[236:239], a[196:199], a[28:31], a[236:239]
    ds_read_b128 v[80:83], v29 offset:2048
    v_mfma_f32_16x16x32_bf16 a[236:239], a[192:195], a[12:15], a[236:239]
    s_waitcnt lgkmcnt(4)
    buffer_store_dwordx4 v[208:211], v28, s[20:23], s55 offen offset:2048 sc1
    v_mfma_f32_16x16x32_bf16 a[252:255], a[200:203], a[12:15], a[252:255]
    ds_read_b64_tr_b16 a[192:193], v11 offset:0
    v_mfma_f32_16x16x32_bf16 a[252:255], a[204:207], a[28:31], a[252:255]
    ds_read_b64_tr_b16 a[194:195], v11 offset:6144
    v_mfma_f32_16x16x32_bf16 a[248:251], a[204:207], a[24:27], a[248:251]
    ds_read_b128 v[88:91], v29 offset:3072
    v_mfma_f32_16x16x32_bf16 a[248:251], a[200:203], a[8:11], a[248:251]
    ds_read_b128 v[96:99], v29 offset:4096
    v_mfma_f32_16x16x32_bf16 a[244:247], a[200:203], a[4:7], a[244:247]
    ds_read_b64_tr_b16 a[196:197], v11 offset:12288
    v_mfma_f32_16x16x32_bf16 a[244:247], a[204:207], a[20:23], a[244:247]
    ds_read_b64_tr_b16 a[198:199], v11 offset:18432
    v_mfma_f32_16x16x32_bf16 a[240:243], a[204:207], a[16:19], a[240:243]
    ds_read_b128 v[104:107], v29 offset:5120
    v_mfma_f32_16x16x32_bf16 a[240:243], a[200:203], a[0:3], a[240:243]
    s_waitcnt lgkmcnt(4)
    buffer_load_dwordx4 a[36:39], v28, s[20:23], s10 offen offset:1024 sc1
    v_mfma_f32_16x16x32_bf16 v[68:71], a[208:211], a[0:3], v[68:71]
    ds_read_b64_tr_b16 a[200:201], v8 offset:1024
    v_lshlrev_b32 v16, 4, v16
    v_mfma_f32_16x16x32_bf16 v[68:71], a[212:215], a[16:19], v[68:71]
    s_waitcnt vmcnt(9)
    ds_read_b64_tr_b16 a[202:203], v8 offset:7168
    v_mfma_f32_16x16x32_bf16 v[76:79], a[212:215], a[20:23], v[76:79]
    ds_read_b128 v[112:115], v29 offset:6144
    v_mfma_f32_16x16x32_bf16 v[76:79], a[208:211], a[4:7], v[76:79]
    ds_read_b128 v[120:123], v29 offset:7168
    v_mfma_f32_16x16x32_bf16 v[84:87], a[208:211], a[8:11], v[84:87]
    ds_read_b64_tr_b16 a[204:205], v8 offset:13312
    v_mfma_f32_16x16x32_bf16 v[84:87], a[212:215], a[24:27], v[84:87]
    ds_read_b64_tr_b16 a[206:207], v8 offset:19456
    v_mfma_f32_16x16x32_bf16 v[92:95], a[212:215], a[28:31], v[92:95]
    ds_read_b128 v[128:131], v29 offset:8192
    v_add_u32 v8, 73728, v12
    v_mfma_f32_16x16x32_bf16 v[92:95], a[208:211], a[12:15], v[92:95]
    s_waitcnt lgkmcnt(4)
    buffer_atomic_or v16, v17, s[24:27], 0 offen
    v_mfma_f32_16x16x32_bf16 v[124:127], a[192:195], a[12:15], v[124:127]
    ds_read_b64_tr_b16 a[208:209], v9 offset:1024
    v_mfma_f32_16x16x32_bf16 v[124:127], a[196:199], a[28:31], v[124:127]
    ds_read_b64_tr_b16 a[210:211], v9 offset:7168
    v_mfma_f32_16x16x32_bf16 v[116:119], a[196:199], a[24:27], v[116:119]
    ds_read_b128 v[136:139], v29 offset:9216
    v_mfma_f32_16x16x32_bf16 v[116:119], a[192:195], a[8:11], v[116:119]
    buffer_store_dwordx4 v[216:219], v28, s[20:23], s55 offen offset:3072 sc1
    v_mfma_f32_16x16x32_bf16 v[108:111], a[192:195], a[4:7], v[108:111]
    s_add_u32 s55, s55, 4096
    ds_read_b64_tr_b16 a[212:213], v9 offset:13312
    v_mfma_f32_16x16x32_bf16 v[108:111], a[196:199], a[20:23], v[108:111]
    ds_read_b64_tr_b16 a[214:215], v9 offset:19456
    v_mfma_f32_16x16x32_bf16 v[100:103], a[196:199], a[16:19], v[100:103]
    buffer_load_dwordx4 a[40:43], v28, s[20:23], s10 offen offset:2048 sc1
    v_mfma_f32_16x16x32_bf16 v[100:103], a[192:195], a[0:3], v[100:103]
    s_waitcnt lgkmcnt(4)
    v_add_u32 v9, 73728, v13
    v_mfma_f32_16x16x32_bf16 v[132:135], a[200:203], a[0:3], v[132:135]
    ds_read_b64_tr_b16 a[192:193], v10 offset:1024
    v_mfma_f32_16x16x32_bf16 v[132:135], a[204:207], a[16:19], v[132:135]
    ds_read_b64_tr_b16 a[194:195], v10 offset:7168
    v_mfma_f32_16x16x32_bf16 v[140:143], a[204:207], a[20:23], v[140:143]
    s_bfe_u32 s88, s72, 262148
    s_cmp_lg_u32 s88, 15
    s_cbranch_scc1 spin_o1
spin_o1_ret:
    v_mfma_f32_16x16x32_bf16 v[140:143], a[200:203], a[4:7], v[140:143]
    buffer_load_dwordx4 a[44:47], v28, s[20:23], s10 offen offset:3072 sc1
    v_mfma_f32_16x16x32_bf16 v[148:151], a[200:203], a[8:11], v[148:151]
    s_add_u32 s10, s10, 4096
    ds_read_b64_tr_b16 a[196:197], v10 offset:13312
    v_mfma_f32_16x16x32_bf16 v[148:151], a[204:207], a[24:27], v[148:151]
    ds_read_b64_tr_b16 a[198:199], v10 offset:19456
    v_mfma_f32_16x16x32_bf16 v[156:159], a[204:207], a[28:31], v[156:159]
    buffer_load_dwordx4 a[48:51], v28, s[20:23], s8 offen offset:0 sc1
    v_mfma_f32_16x16x32_bf16 v[156:159], a[200:203], a[12:15], v[156:159]
    s_waitcnt lgkmcnt(4)
    v_add_u32 v10, 73728, v14
    v_mfma_f32_16x16x32_bf16 v[188:191], a[208:211], a[12:15], v[188:191]
    ds_read_b64_tr_b16 a[200:201], v11 offset:1024
    v_mfma_f32_16x16x32_bf16 v[188:191], a[212:215], a[28:31], v[188:191]
    ds_read_b64_tr_b16 a[202:203], v11 offset:7168
    v_mfma_f32_16x16x32_bf16 v[180:183], a[212:215], a[24:27], v[180:183]
    v_mfma_f32_16x16x32_bf16 v[180:183], a[208:211], a[8:11], v[180:183]
    buffer_load_dwordx4 a[52:55], v28, s[20:23], s8 offen offset:1024 sc1
    v_mfma_f32_16x16x32_bf16 v[172:175], a[208:211], a[4:7], v[172:175]
    ds_read_b64_tr_b16 a[204:205], v11 offset:13312
    v_add_f32 v64, v64, v72
    buffer_store_dwordx4 v[224:227], v28, s[20:23], s55 offen offset:0 sc1
    v_mfma_f32_16x16x32_bf16 v[172:175], a[212:215], a[20:23], v[172:175]
    ds_read_b64_tr_b16 a[206:207], v11 offset:19456
    v_add_f32 v65, v65, v73
    v_mfma_f32_16x16x32_bf16 v[164:167], a[212:215], a[16:19], v[164:167]
    v_add_f32 v66, v66, v74
    v_add_f32 v67, v67, v75
    v_mfma_f32_16x16x32_bf16 v[164:167], a[208:211], a[0:3], v[164:167]
    s_waitcnt lgkmcnt(4)
    v_add_f32 v64, v64, v80
    v_add_f32 v65, v65, v81
    v_mfma_f32_16x16x32_bf16 v[196:199], a[192:195], a[0:3], v[196:199]
    ds_read_b64_tr_b16 a[208:209], v18 offset:2048
    v_add_f32 v66, v66, v82
    v_mfma_f32_16x16x32_bf16 v[196:199], a[196:199], a[16:19], v[196:199]
    ds_read_b64_tr_b16 a[210:211], v18 offset:8192
    v_add_f32 v67, v67, v83
    v_mfma_f32_16x16x32_bf16 v[204:207], a[196:199], a[20:23], v[204:207]
    v_add_f32 v64, v64, v88
    v_add_f32 v65, v65, v89
    v_mfma_f32_16x16x32_bf16 v[204:207], a[192:195], a[4:7], v[204:207]
    buffer_load_dwordx4 a[56:59], v28, s[20:23], s8 offen offset:2048 sc1
    v_mfma_f32_16x16x32_bf16 v[212:215], a[192:195], a[8:11], v[212:215]
    ds_read_b64_tr_b16 a[212:213], v18 offset:14336
    v_add_f32 v66, v66, v90
    v_mfma_f32_16x16x32_bf16 v[212:215], a[196:199], a[24:27], v[212:215]
    ds_read_b64_tr_b16 a[214:215], v18 offset:20480
    v_add_f32 v67, v67, v91
    v_mfma_f32_16x16x32_bf16 v[220:223], a[196:199], a[28:31], v[220:223]
    v_add_f32 v64, v64, v96
    v_add_f32 v65, v65, v97
    v_mfma_f32_16x16x32_bf16 v[220:223], a[192:195], a[12:15], v[220:223]
    s_waitcnt lgkmcnt(4)
    v_add_f32 v66, v66, v98
    v_add_f32 v67, v67, v99
    v_mfma_f32_16x16x32_bf16 v[252:255], a[200:203], a[12:15], v[252:255]
    ds_read_b64_tr_b16 a[192:193], v19 offset:2048
    v_add_f32 v64, v64, v104
    v_mfma_f32_16x16x32_bf16 v[252:255], a[204:207], a[28:31], v[252:255]
    ds_read_b64_tr_b16 a[194:195], v19 offset:8192
    v_add_f32 v65, v65, v105
    v_mfma_f32_16x16x32_bf16 v[244:247], a[204:207], a[24:27], v[244:247]
    buffer_load_dwordx4 a[60:63], v28, s[20:23], s8 offen offset:3072 sc1
    v_mfma_f32_16x16x32_bf16 v[244:247], a[200:203], a[8:11], v[244:247]
    s_add_u32 s8, s8, 12288
    v_add_f32 v66, v66, v106
    v_add_f32 v67, v67, v107
    buffer_store_dwordx4 v[232:235], v28, s[20:23], s55 offen offset:1024 sc1
    v_mfma_f32_16x16x32_bf16 v[236:239], a[200:203], a[4:7], v[236:239]
    ds_read_b64_tr_b16 a[196:197], v19 offset:14336
    v_add_f32 v64, v64, v112
    v_mfma_f32_16x16x32_bf16 v[236:239], a[204:207], a[20:23], v[236:239]
    s_waitcnt vmcnt(63)
    ds_read_b64_tr_b16 a[198:199], v19 offset:20480
    v_add_f32 v65, v65, v113
    v_mfma_f32_16x16x32_bf16 v[228:231], a[204:207], a[16:19], v[228:231]
    s_barrier
    v_mfma_f32_16x16x32_bf16 v[228:231], a[200:203], a[0:3], v[228:231]
    s_waitcnt lgkmcnt(4)
    v_add_f32 v66, v66, v114
    v_add_f32 v67, v67, v115
    v_mfma_f32_16x16x32_bf16 v[32:35], a[208:211], a[0:3], v[32:35]
    ds_read_b64_tr_b16 a[200:201], v8 offset:0
    v_add_f32 v64, v64, v120
    v_mfma_f32_16x16x32_bf16 v[32:35], a[212:215], a[16:19], v[32:35]
    ds_read_b64_tr_b16 a[202:203], v8 offset:6144
    v_add_f32 v65, v65, v121
    v_mfma_f32_16x16x32_bf16 v[36:39], a[212:215], a[20:23], v[36:39]
    buffer_store_dwordx4 v[240:243], v28, s[20:23], s55 offen offset:2048 sc1
    v_mfma_f32_16x16x32_bf16 v[36:39], a[208:211], a[4:7], v[36:39]
    v_add_f32 v66, v66, v122
    v_add_f32 v67, v67, v123
    v_mfma_f32_16x16x32_bf16 v[40:43], a[208:211], a[8:11], v[40:43]
    ds_read_b64_tr_b16 a[204:205], v8 offset:12288
    v_add_f32 v64, v64, v128
    v_mfma_f32_16x16x32_bf16 v[40:43], a[212:215], a[24:27], v[40:43]
    ds_read_b64_tr_b16 a[206:207], v8 offset:18432
    v_add_f32 v65, v65, v129
    v_mfma_f32_16x16x32_bf16 v[44:47], a[212:215], a[28:31], v[44:47]
    buffer_load_dwordx4 a[64:67], v28, s[20:23], s9 offen offset:0 sc1
    v_mfma_f32_16x16x32_bf16 v[44:47], a[208:211], a[12:15], v[44:47]
    s_waitcnt lgkmcnt(4)
    v_add_f32 v66, v66, v130
    v_add_f32 v67, v67, v131
    v_mfma_f32_16x16x32_bf16 v[60:63], a[192:195], a[12:15], v[60:63]
    s_load_dword s72, s[86:87], s5 offset:4 glc
    ds_read_b64_tr_b16 a[208:209], v9 offset:0
    v_add_f32 v64, v64, v136
    v_mfma_f32_16x16x32_bf16 v[60:63], a[196:199], a[28:31], v[60:63]
    ds_read_b64_tr_b16 a[210:211], v9 offset:6144
    v_add_f32 v65, v65, v137
    v_mfma_f32_16x16x32_bf16 v[56:59], a[196:199], a[24:27], v[56:59]
    buffer_load_dwordx4 a[68:71], v28, s[20:23], s9 offen offset:1024 sc1
    v_mfma_f32_16x16x32_bf16 v[56:59], a[192:195], a[8:11], v[56:59]
    v_lshlrev_b32 v16, 4, v16
    v_add_f32 v66, v66, v138
    v_mfma_f32_16x16x32_bf16 v[52:55], a[192:195], a[4:7], v[52:55]
    s_waitcnt vmcnt(11)
    ds_read_b64_tr_b16 a[212:213], v9 offset:12288
    v_add_f32 v67, v67, v139
    v_mfma_f32_16x16x32_bf16 v[52:55], a[196:199], a[20:23], v[52:55]
    s_waitcnt vmcnt(9)
    s_waitcnt vmcnt(4)
    ds_read_b64_tr_b16 a[214:215], v9 offset:18432
    v_mfma_f32_16x16x32_bf16 v[48:51], a[196:199], a[16:19], v[48:51]
    buffer_atomic_or v16, v17, s[24:27], 0 offen
    v_mfma_f32_16x16x32_bf16 v[48:51], a[192:195], a[0:3], v[48:51]
    s_waitcnt lgkmcnt(4)
    buffer_load_dwordx4 a[72:75], v28, s[20:23], s9 offen offset:2048 sc1
    v_mfma_f32_16x16x32_bf16 a[224:227], a[200:203], a[32:35], a[224:227]
    ds_read_b64_tr_b16 a[192:193], v10 offset:0
    v_cvt_pk_bf16_f32 v64, v64, v64
    v_mfma_f32_16x16x32_bf16 a[224:227], a[204:207], a[48:51], a[224:227]
    ds_read_b64_tr_b16 a[194:195], v10 offset:6144
    v_and_b32 v64, 0xffff0000, v64
    v_mfma_f32_16x16x32_bf16 a[228:231], a[204:207], a[52:55], a[228:231]
    buffer_store_dwordx4 v[248:251], v28, s[20:23], s55 offen offset:3072 sc1
    v_mfma_f32_16x16x32_bf16 a[228:231], a[200:203], a[36:39], a[228:231]
    s_add_u32 s55, s55, 12288
    v_cvt_pk_bf16_f32 v65, v65, v65
    v_and_b32 v65, 0xffff0000, v65
    v_mfma_f32_16x16x32_bf16 a[232:235], a[200:203], a[40:43], a[232:235]
    ds_read_b64_tr_b16 a[196:197], v10 offset:12288
    v_cvt_pk_bf16_f32 v66, v66, v66
    v_mfma_f32_16x16x32_bf16 a[232:235], a[204:207], a[56:59], a[232:235]
    ds_read_b64_tr_b16 a[198:199], v10 offset:18432
    v_and_b32 v66, 0xffff0000, v66
    v_mfma_f32_16x16x32_bf16 a[236:239], a[204:207], a[60:63], a[236:239]
    v_cvt_pk_bf16_f32 v67, v67, v67
    v_and_b32 v67, 0xffff0000, v67
    v_mfma_f32_16x16x32_bf16 a[236:239], a[200:203], a[44:47], a[236:239]
    s_waitcnt lgkmcnt(4)
    buffer_load_dwordx4 a[76:79], v28, s[20:23], s9 offen offset:3072 sc1
    v_add_u32 v11, 73728, v15
    v_mfma_f32_16x16x32_bf16 a[252:255], a[208:211], a[44:47], a[252:255]
    s_add_u32 s9, s9, 12288
    ds_read_b64_tr_b16 a[200:201], v11 offset:0
    v_mul_f32 v72, s92, v64
    v_mfma_f32_16x16x32_bf16 a[252:255], a[212:215], a[60:63], a[252:255]
    ds_read_b64_tr_b16 a[202:203], v11 offset:6144
    v_xor_b32 v18, s39, v8
    v_mfma_f32_16x16x32_bf16 a[248:251], a[212:215], a[56:59], a[248:251]
    v_exp_f32 v72, v72
    v_mfma_f32_16x16x32_bf16 a[248:251], a[208:211], a[40:43], a[248:251]
    buffer_load_dwordx4 a[80:83], v28, s[20:23], s10 offen offset:0 sc1
    v_mfma_f32_16x16x32_bf16 a[244:247], a[208:211], a[36:39], a[244:247]
    ds_read_b64_tr_b16 a[204:205], v11 offset:12288
    v_add_f32 v72, 1.0, v72
    v_mfma_f32_16x16x32_bf16 a[244:247], a[212:215], a[52:55], a[244:247]
    ds_read_b64_tr_b16 a[206:207], v11 offset:18432
    v_xor_b32 v19, s39, v9
    v_mfma_f32_16x16x32_bf16 a[240:243], a[212:215], a[48:51], a[240:243]
    v_rcp_f32 v72, v72
    v_mfma_f32_16x16x32_bf16 a[240:243], a[208:211], a[32:35], a[240:243]
    s_waitcnt lgkmcnt(4)
    buffer_load_dwordx4 a[84:87], v28, s[20:23], s10 offen offset:1024 sc1
    v_mfma_f32_16x16x32_bf16 v[68:71], a[192:195], a[32:35], v[68:71]
    ds_read_b64_tr_b16 a[208:209], v8 offset:1024
    v_mul_f32 v64, v64, v72
    v_mfma_f32_16x16x32_bf16 v[68:71], a[196:199], a[48:51], v[68:71]
    ds_read_b64_tr_b16 a[210:211], v8 offset:7168
    v_cvt_pk_bf16_f32 v64, v64, v64
    v_mfma_f32_16x16x32_bf16 v[76:79], a[196:199], a[52:55], v[76:79]
    v_and_b32 v64, 0xffff0000, v64
    v_mul_f32 v64, v64, v66
    v_mfma_f32_16x16x32_bf16 v[76:79], a[192:195], a[36:39], v[76:79]
    v_mul_f32 v73, s92, v65
    v_mfma_f32_16x16x32_bf16 v[84:87], a[192:195], a[40:43], v[84:87]
    ds_read_b64_tr_b16 a[212:213], v8 offset:13312
    v_mfma_f32_16x16x32_bf16 v[84:87], a[196:199], a[56:59], v[84:87]
    ds_read_b64_tr_b16 a[214:215], v8 offset:19456
    v_mfma_f32_16x16x32_bf16 v[92:95], a[196:199], a[60:63], v[92:95]
    buffer_load_dwordx4 a[88:91], v28, s[20:23], s10 offen offset:2048 sc1
    v_mfma_f32_16x16x32_bf16 v[92:95], a[192:195], a[44:47], v[92:95]
    s_waitcnt lgkmcnt(4)
    v_exp_f32 v73, v73
    v_mfma_f32_16x16x32_bf16 v[124:127], a[200:203], a[44:47], v[124:127]
    ds_read_b64_tr_b16 a[192:193], v9 offset:1024
    v_add_f32 v73, 1.0, v73
    v_mfma_f32_16x16x32_bf16 v[124:127], a[204:207], a[60:63], v[124:127]
    ds_read_b64_tr_b16 a[194:195], v9 offset:7168
    v_add_u32 v8, 98304, v12
    v_mfma_f32_16x16x32_bf16 v[116:119], a[204:207], a[56:59], v[116:119]
    s_bfe_u32 s88, s72, 262152
    s_cmp_lg_u32 s88, 15
    s_cbranch_scc1 spin_o2
spin_o2_ret:
    v_cmp_lt_u32 s[78:79], 31, v1
    v_mfma_f32_16x16x32_bf16 v[116:119], a[200:203], a[40:43], v[116:119]
    buffer_load_dwordx4 a[92:95], v28, s[20:23], s10 offen offset:3072 sc1
    v_mfma_f32_16x16x32_bf16 v[108:111], a[200:203], a[36:39], v[108:111]
    s_add_u32 s10, s10, 12288
    ds_read_b64_tr_b16 a[196:197], v9 offset:13312
    v_mov_b32 v195, s70
    v_mfma_f32_16x16x32_bf16 v[108:111], a[204:207], a[52:55], v[108:111]
    ds_read_b64_tr_b16 a[198:199], v9 offset:19456
    v_mov_b32 v192, s71
    v_mfma_f32_16x16x32_bf16 v[100:103], a[204:207], a[48:51], v[100:103]
    buffer_load_dwordx4 a[96:99], v28, s[20:23], s8 offen offset:0 sc1
    v_mfma_f32_16x16x32_bf16 v[100:103], a[200:203], a[32:35], v[100:103]
    s_waitcnt lgkmcnt(4)
    v_rcp_f32 v73, v73
    v_mfma_f32_16x16x32_bf16 v[132:135], a[208:211], a[32:35], v[132:135]
    ds_read_b64_tr_b16 a[200:201], v10 offset:1024
    v_mul_f32 v65, v65, v73
    v_mfma_f32_16x16x32_bf16 v[132:135], a[212:215], a[48:51], v[132:135]
    ds_read_b64_tr_b16 a[202:203], v10 offset:7168
    v_cvt_pk_bf16_f32 v65, v65, v65
    v_mfma_f32_16x16x32_bf16 v[140:143], a[212:215], a[52:55], v[140:143]
    buffer_load_dwordx4 a[100:103], v28, s[20:23], s8 offen offset:1024 sc1
    v_mfma_f32_16x16x32_bf16 v[140:143], a[208:211], a[36:39], v[140:143]
    v_and_b32 v65, 0xffff0000, v65
    v_mul_f32 v65, v65, v67
    v_mfma_f32_16x16x32_bf16 v[148:151], a[208:211], a[40:43], v[148:151]
    ds_read_b64_tr_b16 a[204:205], v10 offset:13312
    v_cvt_pk_bf16_f32 v64, v64, v65
    v_mfma_f32_16x16x32_bf16 v[148:151], a[212:215], a[56:59], v[148:151]
    s_lshl_b32 s61, s3, 8
    ds_read_b64_tr_b16 a[206:207], v10 offset:19456
    v_cndmask_b32 v195, v195, v192, s[78:79]
    v_mfma_f32_16x16x32_bf16 v[156:159], a[212:215], a[60:63], v[156:159]
    buffer_load_dwordx4 a[104:107], v28, s[20:23], s8 offen offset:2048 sc1
    v_mfma_f32_16x16x32_bf16 v[156:159], a[208:211], a[44:47], v[156:159]
    s_waitcnt lgkmcnt(4)
    v_bfe_u32 v194, v1, 3, 2
    v_mov_b32 v192, s41
    v_mfma_f32_16x16x32_bf16 v[188:191], a[192:195], a[44:47], v[188:191]
    s_add_u32 s61, s61, 157696
    ds_read_b64_tr_b16 a[208:209], v11 offset:1024
    v_lshlrev_b32 v80, 1, v1
    v_mfma_f32_16x16x32_bf16 v[188:191], a[196:199], a[60:63], v[188:191]
    ds_read_b64_tr_b16 a[210:211], v11 offset:7168
    v_add_u32 v80, s61, v80
    v_mfma_f32_16x16x32_bf16 v[180:183], a[196:199], a[56:59], v[180:183]
    v_and_b32 v81, 1, v1
    v_lshlrev_b32 v81, 7, v81
    v_mfma_f32_16x16x32_bf16 v[180:183], a[192:195], a[40:43], v[180:183]
    buffer_load_dwordx4 a[108:111], v28, s[20:23], s8 offen offset:3072 sc1
    v_mfma_f32_16x16x32_bf16 v[172:175], a[192:195], a[36:39], v[172:175]
pg_10:
    s_cbranch_execz pg_ret2
    s_add_u32 s8, s8, 4096
    ds_read_b64_tr_b16 a[212:213], v11 offset:13312
    v_lshrrev_b32 v83, 4, v1
    v_mfma_f32_16x16x32_bf16 v[172:175], a[196:199], a[52:55], v[172:175]
    s_add_u32 m0, s44, 147456
    ds_read_b64_tr_b16 a[214:215], v11 offset:19456
    v_lshl_add_u32 v81, v83, 4, v81
    v_mfma_f32_16x16x32_bf16 v[164:167], a[196:199], a[48:51], v[164:167]
    v_add_u32 v81, s61, v81
    v_bfe_u32 v83, v1, 2, 3
    v_mfma_f32_16x16x32_bf16 v[164:167], a[192:195], a[32:35], v[164:167]
    s_waitcnt lgkmcnt(4)
    buffer_load_dwordx4 v6, s[28:31], s59 offen lds
    v_mfma_f32_16x16x32_bf16 v[196:199], a[200:203], a[32:35], v[196:199]
    s_add_u32 m0, s44, 148480
    ds_read_b64_tr_b16 a[192:193], v18 offset:2048
    v_lshlrev_b32 v82, 7, v83
    v_mfma_f32_16x16x32_bf16 v[196:199], a[204:207], a[48:51], v[196:199]
    ds_read_b64_tr_b16 a[194:195], v18 offset:8192
    v_lshrrev_b32 v83, 1, v83
    v_mfma_f32_16x16x32_bf16 v[204:207], a[204:207], a[52:55], v[204:207]
    v_xor_b32 v83, s3, v83
    v_lshl_add_u32 v82, v83, 5, v82
    v_mfma_f32_16x16x32_bf16 v[204:207], a[200:203], a[36:39], v[204:207]
    buffer_load_dwordx4 v7, s[28:31], s59 offen lds
    v_mfma_f32_16x16x32_bf16 v[212:215], a[200:203], a[40:43], v[212:215]
    ds_read_b64_tr_b16 a[196:197], v18 offset:14336
    v_lshlrev_b32 v16, 4, v16
    v_mfma_f32_16x16x32_bf16 v[212:215], a[204:207], a[56:59], v[212:215]
    s_waitcnt vmcnt(11)
    ds_read_b64_tr_b16 a[198:199], v18 offset:20480
    v_and_b32 v83, 3, v1
    v_mfma_f32_16x16x32_bf16 v[220:223], a[204:207], a[60:63], v[220:223]
    buffer_atomic_or v16, v17, s[24:27], 0 offen
    v_mfma_f32_16x16x32_bf16 v[220:223], a[200:203], a[44:47], v[220:223]
    s_waitcnt lgkmcnt(4)
    v_lshl_add_u32 v82, v83, 3, v82
    v_lshrrev_b32 v83, 5, v1
    v_mfma_f32_16x16x32_bf16 v[252:255], a[208:211], a[44:47], v[252:255]
    ds_read_b64_tr_b16 a[200:201], v19 offset:2048
    v_mul_u32_u24 v83, 1024, v83
    v_mfma_f32_16x16x32_bf16 v[252:255], a[212:215], a[60:63], v[252:255]
    ds_read_b64_tr_b16 a[202:203], v19 offset:8192
    v_add_u32 v82, v82, v83
    v_mfma_f32_16x16x32_bf16 v[244:247], a[212:215], a[56:59], v[244:247]
    buffer_load_dwordx4 a[112:115], v28, s[20:23], s9 offen offset:0 sc1
    v_mfma_f32_16x16x32_bf16 v[244:247], a[208:211], a[40:43], v[244:247]
    v_add_u32 v82, 147456, v82
    v_lshlrev_b32 v74, 2, v1
    v_mfma_f32_16x16x32_bf16 v[236:239], a[208:211], a[36:39], v[236:239]
    ds_read_b64_tr_b16 a[204:205], v19 offset:14336
    v_cmp_gt_u32 vcc, 16, v1
    v_mfma_f32_16x16x32_bf16 v[236:239], a[212:215], a[52:55], v[236:239]
    s_waitcnt vmcnt(63)
    ds_read_b64_tr_b16 a[206:207], v19 offset:20480
    v_mov_b32 v83, 0x7ffffff0
    v_mfma_f32_16x16x32_bf16 v[228:231], a[212:215], a[48:51], v[228:231]
    s_barrier
    v_mfma_f32_16x16x32_bf16 v[228:231], a[208:211], a[32:35], v[228:231]
    s_waitcnt lgkmcnt(4)
    buffer_load_dwordx4 a[116:119], v28, s[20:23], s9 offen offset:1024 sc1
    v_mfma_f32_16x16x32_bf16 v[32:35], a[192:195], a[32:35], v[32:35]
    s_load_dword s72, s[86:87], s5 offset:4 glc
    ds_read_b64_tr_b16 a[208:209], v8 offset:0
    v_cndmask_b32 v74, v83, v74, vcc
    v_mfma_f32_16x16x32_bf16 v[32:35], a[196:199], a[48:51], v[32:35]
    ds_read_b64_tr_b16 a[210:211], v8 offset:6144
    v_mov_b32 v193, s42
    v_mfma_f32_16x16x32_bf16 v[36:39], a[196:199], a[52:55], v[36:39]
    buffer_load_dwordx4 a[120:123], v28, s[20:23], s9 offen offset:2048 sc1
    v_mfma_f32_16x16x32_bf16 v[36:39], a[192:195], a[36:39], v[36:39]
    v_cmp_eq_u32 s[78:79], 1, v194
    v_add_u32 v9, 98304, v13
    v_mfma_f32_16x16x32_bf16 v[40:43], a[192:195], a[40:43], v[40:43]
    ds_read_b64_tr_b16 a[212:213], v8 offset:12288
    v_cndmask_b32 v192, v192, v193, s[78:79]
    v_mfma_f32_16x16x32_bf16 v[40:43], a[196:199], a[56:59], v[40:43]
    ds_read_b64_tr_b16 a[214:215], v8 offset:18432
    v_mov_b32 v193, s43
    v_mfma_f32_16x16x32_bf16 v[44:47], a[196:199], a[60:63], v[44:47]
    buffer_load_dwordx4 a[124:127], v28, s[20:23], s9 offen offset:3072 sc1
    v_mfma_f32_16x16x32_bf16 v[44:47], a[192:195], a[44:47], v[44:47]
    s_waitcnt lgkmcnt(4)
    v_cmp_lt_u32 s[78:79], 1, v194
    v_add_u32 v10, 98304, v14
    v_mfma_f32_16x16x32_bf16 v[60:63], a[200:203], a[44:47], v[60:63]
    s_add_u32 s9, s9, 4096
    ds_read_b64_tr_b16 a[192:193], v9 offset:0
    v_cndmask_b32 v192, v192, v193, s[78:79]
    v_mfma_f32_16x16x32_bf16 v[60:63], a[204:207], a[60:63], v[60:63]
    ds_read_b64_tr_b16 a[194:195], v9 offset:6144
    v_and_b32 v193, 7, v1
    v_mfma_f32_16x16x32_bf16 v[56:59], a[204:207], a[56:59], v[56:59]
    buffer_load_dwordx4 a[128:131], v28, s[20:23], s10 offen offset:0 sc1
    v_mfma_f32_16x16x32_bf16 v[56:59], a[200:203], a[40:43], v[56:59]
    v_lshl_add_u32 v192, v193, 3, v192
    v_and_b32 v194, 0x7ff, v195
    v_mfma_f32_16x16x32_bf16 v[52:55], a[200:203], a[36:39], v[52:55]
    ds_read_b64_tr_b16 a[196:197], v9 offset:12288
    v_sub_u32 v194, 2047, v194
    v_mfma_f32_16x16x32_bf16 v[52:55], a[204:207], a[52:55], v[52:55]
    s_waitcnt vmcnt(16)
    s_waitcnt vmcnt(12)
    ds_read_b64_tr_b16 a[198:199], v9 offset:18432
    v_mfma_f32_16x16x32_bf16 v[48:51], a[204:207], a[48:51], v[48:51]
    v_mul_u32_u24 v193, 1280, v194
    v_add_u32 v193, v193, v192
    v_mfma_f32_16x16x32_bf16 v[48:51], a[200:203], a[32:35], v[48:51]
    s_waitcnt lgkmcnt(4)
    buffer_load_dwordx4 a[132:135], v28, s[20:23], s10 offen offset:1024 sc1
    v_mfma_f32_16x16x32_bf16 a[224:227], a[208:211], a[64:67], a[224:227]
    ds_read_b64_tr_b16 a[200:201], v10 offset:0
    v_lshlrev_b32 v194, 3, v194
    v_mfma_f32_16x16x32_bf16 a[224:227], a[212:215], a[80:83], a[224:227]
    ds_read_b64_tr_b16 a[202:203], v10 offset:6144
    v_add_u32 v194, 3211264, v194
    v_mfma_f32_16x16x32_bf16 a[228:231], a[212:215], a[84:87], a[228:231]
    v_add_u32 v11, 98304, v15
    v_xor_b32 v18, s39, v8
    v_mfma_f32_16x16x32_bf16 a[228:231], a[208:211], a[68:71], a[228:231]
    buffer_load_dwordx4 a[136:139], v28, s[20:23], s10 offen offset:2048 sc1
    v_mfma_f32_16x16x32_bf16 a[232:235], a[208:211], a[72:75], a[232:235]
    s_lshr_b32 s55, s54, 1
    ds_read_b64_tr_b16 a[204:205], v10 offset:12288
    v_xor_b32 v19, s39, v9
    v_mfma_f32_16x16x32_bf16 a[232:235], a[212:215], a[88:91], a[232:235]
    s_lshl_b32 s55, s55, 19
    ds_read_b64_tr_b16 a[206:207], v10 offset:18432
    v_bfe_u32 v224, v1, 3, 1
    v_mfma_f32_16x16x32_bf16 a[236:239], a[212:215], a[92:95], a[236:239]
    s_and_b32 s60, s54, 1
    v_bfe_u32 v225, v1, 4, 1
    v_xor_b32 v224, v224, v225
    v_mfma_f32_16x16x32_bf16 a[236:239], a[208:211], a[76:79], a[236:239]
    s_waitcnt lgkmcnt(4)
    buffer_load_dwordx4 a[140:143], v28, s[20:23], s10 offen offset:3072 sc1
    v_mfma_f32_16x16x32_bf16 a[252:255], a[192:195], a[76:79], a[252:255]
    s_add_u32 s10, s10, 4096
    ds_read_b64_tr_b16 a[208:209], v11 offset:0
    v_and_b32 v225, 1, v1
    v_mfma_f32_16x16x32_bf16 a[252:255], a[196:199], a[92:95], a[252:255]
    s_lshl_b32 s60, s60, 12
    ds_read_b64_tr_b16 a[210:211], v11 offset:6144
    v_lshlrev_b32 v225, 4, v225
    v_mfma_f32_16x16x32_bf16 a[248:251], a[196:199], a[88:91], a[248:251]
    s_or_b32 s55, s55, s60
    v_mov_b32 v226, 0x3c80
    v_lshlrev_b32 v225, v225, v226
    v_mfma_f32_16x16x32_bf16 a[248:251], a[192:195], a[72:75], a[248:251]
    s_lshl_b32 s60, s54, 10
    v_bfe_u32 v226, v1, 1, 2
    v_lshl_add_u32 v226, v224, 2, v226
    v_mfma_f32_16x16x32_bf16 a[244:247], a[192:195], a[68:71], a[244:247]
    s_and_b32 s60, s60, 0x2000
    ds_read_b64_tr_b16 a[212:213], v11 offset:12288
    v_cmp_eq_u32 s[74:75], 0, v226
    v_mfma_f32_16x16x32_bf16 a[244:247], a[196:199], a[84:87], a[244:247]
    s_or_b32 s55, s55, s60
    ds_read_b64_tr_b16 a[214:215], v11 offset:18432
    v_cndmask_b32 v208, 0, v225, s[74:75]
    v_mfma_f32_16x16x32_bf16 a[240:243], a[196:199], a[80:83], a[240:243]
    s_or_b32 s55, s55, 134217728
    v_cmp_eq_u32 s[74:75], 1, v226
    s_mul_i32 s60, s51, 81920
    v_mfma_f32_16x16x32_bf16 a[240:243], a[192:195], a[64:67], a[240:243]
    s_waitcnt lgkmcnt(4)
    v_cndmask_b32 v209, 0, v225, s[74:75]
    v_cmp_eq_u32 s[74:75], 2, v226
    v_mfma_f32_16x16x32_bf16 v[68:71], a[200:203], a[64:67], v[68:71]
    s_add_u32 s55, s55, s60
    ds_read_b64_tr_b16 a[192:193], v8 offset:1024
    v_cndmask_b32 v210, 0, v225, s[74:75]
    v_mfma_f32_16x16x32_bf16 v[68:71], a[204:207], a[80:83], v[68:71]
    s_mul_i32 s60, s53, 8389632
    ds_read_b64_tr_b16 a[194:195], v8 offset:7168
    v_cmp_eq_u32 s[74:75], 3, v226
    v_mfma_f32_16x16x32_bf16 v[76:79], a[204:207], a[84:87], v[76:79]
    s_bfe_u32 s88, s72, 262156
    s_cmp_lg_u32 s88, 15
    s_cbranch_scc1 spin_o3
spin_o3_ret:
    v_cndmask_b32 v211, 0, v225, s[74:75]
    v_mfma_f32_16x16x32_bf16 v[76:79], a[200:203], a[68:71], v[76:79]
    s_xor_b32 s55, s55, s60
    s_add_u32 s60, s51, 8
    s_lshr_b32 s60, s93, s60
    v_mfma_f32_16x16x32_bf16 v[84:87], a[200:203], a[72:75], v[84:87]
    s_and_b32 s60, s60, 0x2000
    ds_read_b64_tr_b16 a[196:197], v8 offset:13312
    s_xor_b32 s55, s55, s60
    v_mfma_f32_16x16x32_bf16 v[84:87], a[204:207], a[88:91], v[84:87]
    ds_read_b64_tr_b16 a[198:199], v8 offset:19456
    v_mfma_f32_16x16x32_bf16 v[92:95], a[204:207], a[92:95], v[92:95]
    buffer_load_dwordx4 a[144:147], v28, s[20:23], s8 offen offset:0 sc1
    v_mfma_f32_16x16x32_bf16 v[92:95], a[200:203], a[76:79], v[92:95]
    s_waitcnt lgkmcnt(4)
    v_add_u32 v8, 49152, v12
    v_mfma_f32_16x16x32_bf16 v[124:127], a[208:211], a[76:79], v[124:127]
    ds_read_b64_tr_b16 a[200:201], v9 offset:1024
    v_mfma_f32_16x16x32_bf16 v[124:127], a[212:215], a[92:95], v[124:127]
    ds_read_b64_tr_b16 a[202:203], v9 offset:7168
    v_mfma_f32_16x16x32_bf16 v[116:119], a[212:215], a[88:91], v[116:119]
    buffer_load_dwordx2 v[24:25], v23, s[24:27], 0 offen sc1
    v_mfma_f32_16x16x32_bf16 v[116:119], a[208:211], a[72:75], v[116:119]
    buffer_load_dwordx4 a[148:151], v28, s[20:23], s8 offen offset:1024 sc1
    v_mfma_f32_16x16x32_bf16 v[108:111], a[208:211], a[68:71], v[108:111]
    ds_read_b64_tr_b16 a[204:205], v9 offset:13312
    v_mfma_f32_16x16x32_bf16 v[108:111], a[212:215], a[84:87], v[108:111]
    ds_read_b64_tr_b16 a[206:207], v9 offset:19456
    v_mfma_f32_16x16x32_bf16 v[100:103], a[212:215], a[80:83], v[100:103]
    buffer_load_dwordx2 v[200:201], v193, s[16:19], 0 offen
    v_mfma_f32_16x16x32_bf16 v[100:103], a[208:211], a[64:67], v[100:103]
    s_waitcnt lgkmcnt(4)
    buffer_load_dwordx4 a[152:155], v28, s[20:23], s8 offen offset:2048 sc1
    v_mfma_f32_16x16x32_bf16 v[132:135], a[192:195], a[64:67], v[132:135]
    ds_read_b64_tr_b16 a[208:209], v10 offset:1024
    v_add_u32 v9, 49152, v13
    v_mfma_f32_16x16x32_bf16 v[132:135], a[196:199], a[80:83], v[132:135]
    ds_read_b64_tr_b16 a[210:211], v10 offset:7168
    v_mfma_f32_16x16x32_bf16 v[140:143], a[196:199], a[84:87], v[140:143]
    buffer_load_dwordx2 v[202:203], v194, s[24:27], 0 offen sc1
    v_mfma_f32_16x16x32_bf16 v[140:143], a[192:195], a[68:71], v[140:143]
    buffer_load_dwordx4 a[156:159], v28, s[20:23], s8 offen offset:3072 sc1
    v_mfma_f32_16x16x32_bf16 v[148:151], a[192:195], a[72:75], v[148:151]
    s_add_u32 s8, s8, 12288
    ds_read_b64_tr_b16 a[212:213], v10 offset:13312
    v_mfma_f32_16x16x32_bf16 v[148:151], a[196:199], a[88:91], v[148:151]
    ds_read_b64_tr_b16 a[214:215], v10 offset:19456
    v_mfma_f32_16x16x32_bf16 v[156:159], a[196:199], a[92:95], v[156:159]
    v_add_u32 v10, 49152, v14
    v_mfma_f32_16x16x32_bf16 v[156:159], a[192:195], a[76:79], v[156:159]
    s_waitcnt lgkmcnt(4)
    v_mfma_f32_16x16x32_bf16 v[188:191], a[200:203], a[76:79], v[188:191]
    ds_read_b64_tr_b16 a[192:193], v11 offset:1024
    v_mfma_f32_16x16x32_bf16 v[188:191], a[204:207], a[92:95], v[188:191]
    ds_read_b64_tr_b16 a[194:195], v11 offset:7168
    v_mfma_f32_16x16x32_bf16 v[180:183], a[204:207], a[88:91], v[180:183]
    v_mfma_f32_16x16x32_bf16 v[180:183], a[200:203], a[72:75], v[180:183]
    v_mfma_f32_16x16x32_bf16 v[172:175], a[200:203], a[68:71], v[172:175]
    ds_read_b64_tr_b16 a[196:197], v11 offset:13312
    v_lshrrev_b32 v136, 5, v192
    v_mfma_f32_16x16x32_bf16 v[172:175], a[204:207], a[84:87], v[172:175]
    ds_read_b64_tr_b16 a[198:199], v11 offset:19456
    v_lshlrev_b32 v136, 9, v136
    v_mfma_f32_16x16x32_bf16 v[164:167], a[204:207], a[80:83], v[164:167]
    v_and_b32 v192, 31, v192
    v_lshl_add_u32 v192, v192, 1, v136
    v_mfma_f32_16x16x32_bf16 v[164:167], a[200:203], a[64:67], v[164:167]
    s_waitcnt lgkmcnt(4)
    v_lshrrev_b32 v193, 5, v1
    v_lshl_add_u32 v192, v193, 8, v192
    v_mfma_f32_16x16x32_bf16 v[196:199], a[208:211], a[64:67], v[196:199]
    ds_read_b64_tr_b16 a[200:201], v18 offset:2048
    v_and_b32 v195, 0xffff0000, v195
    v_mfma_f32_16x16x32_bf16 v[196:199], a[212:215], a[80:83], v[196:199]
    ds_read_b64_tr_b16 a[202:203], v18 offset:8192
    v_ashrrev_i32 v193, 31, v195
    v_mfma_f32_16x16x32_bf16 v[204:207], a[212:215], a[84:87], v[204:207]
    buffer_load_dwordx4 a[160:163], v28, s[20:23], s9 offen offset:0 sc1
    v_mfma_f32_16x16x32_bf16 v[204:207], a[208:211], a[68:71], v[204:207]
    v_not_b32 v193, v193
    v_or_b32 v193, 0x80000000, v193
    v_mfma_f32_16x16x32_bf16 v[212:215], a[208:211], a[72:75], v[212:215]
    ds_read_b64_tr_b16 a[204:205], v18 offset:14336
    v_xor_b32 v195, v195, v193
    v_mfma_f32_16x16x32_bf16 v[212:215], a[212:215], a[88:91], v[212:215]
    ds_read_b64_tr_b16 a[206:207], v18 offset:20480
    v_and_b32 v195, 0xffff0000, v195
    v_mfma_f32_16x16x32_bf16 v[220:223], a[212:215], a[92:95], v[220:223]
    buffer_load_dwordx4 a[164:167], v28, s[20:23], s9 offen offset:1024 sc1
    v_mfma_f32_16x16x32_bf16 v[220:223], a[208:211], a[76:79], v[220:223]
    s_waitcnt lgkmcnt(4)
    v_mul_f32 v195, s92, v195
    v_add_u32 v11, 49152, v15
    v_mfma_f32_16x16x32_bf16 v[252:255], a[192:195], a[76:79], v[252:255]
    s_load_dword s72, s[86:87], s5 offset:4 glc
    ds_read_b64_tr_b16 a[208:209], v19 offset:2048
    v_xor_b32 v18, s39, v8
    v_mfma_f32_16x16x32_bf16 v[252:255], a[196:199], a[92:95], v[252:255]
    ds_read_b64_tr_b16 a[210:211], v19 offset:8192
    v_mfma_f32_16x16x32_bf16 v[244:247], a[196:199], a[88:91], v[244:247]
    buffer_load_dwordx4 a[168:171], v28, s[20:23], s9 offen offset:2048 sc1
    v_mfma_f32_16x16x32_bf16 v[244:247], a[192:195], a[72:75], v[244:247]
    v_exp_f32 v195, v195
    v_mfma_f32_16x16x32_bf16 v[236:239], a[192:195], a[68:71], v[236:239]
    ds_read_b64_tr_b16 a[212:213], v19 offset:14336
    v_add_f32 v195, 1.0, v195
    v_mfma_f32_16x16x32_bf16 v[236:239], a[196:199], a[84:87], v[236:239]
    s_waitcnt vmcnt(19)
    ds_read_b64_tr_b16 a[214:215], v19 offset:20480
    v_mfma_f32_16x16x32_bf16 v[228:231], a[196:199], a[80:83], v[228:231]
    s_barrier
    v_mfma_f32_16x16x32_bf16 v[228:231], a[192:195], a[64:67], v[228:231]
    s_waitcnt lgkmcnt(4)
    buffer_load_dwordx4 a[172:175], v28, s[20:23], s9 offen offset:3072 sc1
    v_mfma_f32_16x16x32_bf16 v[32:35], a[200:203], a[64:67], v[32:35]
    s_add_u32 s9, s9, 12288
    ds_read_b64_tr_b16 a[192:193], v8 offset:0
    v_xor_b32 v19, s39, v9
    v_mfma_f32_16x16x32_bf16 v[32:35], a[204:207], a[80:83], v[32:35]
    ds_read_b64_tr_b16 a[194:195], v8 offset:6144
    v_mfma_f32_16x16x32_bf16 v[36:39], a[204:207], a[84:87], v[36:39]
    buffer_load_dwordx4 a[176:179], v28, s[20:23], s10 offen offset:0 sc1
    v_mfma_f32_16x16x32_bf16 v[36:39], a[200:203], a[68:71], v[36:39]
    v_rcp_f32 v195, v195
    v_mfma_f32_16x16x32_bf16 v[40:43], a[200:203], a[72:75], v[40:43]
    ds_read_b64_tr_b16 a[196:197], v8 offset:12288
    v_cvt_pk_bf16_f32 v195, v195, v195
    v_mfma_f32_16x16x32_bf16 v[40:43], a[204:207], a[88:91], v[40:43]
    ds_read_b64_tr_b16 a[198:199], v8 offset:18432
    v_and_b32 v195, 0xffff0000, v195
    v_mfma_f32_16x16x32_bf16 v[44:47], a[204:207], a[92:95], v[44:47]
    ds_write_b16 v80, v64
    v_mfma_f32_16x16x32_bf16 v[44:47], a[200:203], a[76:79], v[44:47]
    s_waitcnt lgkmcnt(4)
    ds_write_b16_d16_hi v80, v64 offset:128
    v_mfma_f32_16x16x32_bf16 v[60:63], a[208:211], a[76:79], v[60:63]
    ds_read_b64_tr_b16 a[200:201], v9 offset:0
    v_mfma_f32_16x16x32_bf16 v[60:63], a[212:215], a[92:95], v[60:63]
    ds_read_b64_tr_b16 a[202:203], v9 offset:6144
    v_mfma_f32_16x16x32_bf16 v[56:59], a[212:215], a[88:91], v[56:59]
    ds_read_b128 v[88:91], v81
    v_mfma_f32_16x16x32_bf16 v[56:59], a[208:211], a[72:75], v[56:59]
    buffer_load_dwordx4 a[180:183], v28, s[20:23], s10 offen offset:1024 sc1
    v_mfma_f32_16x16x32_bf16 v[52:55], a[208:211], a[68:71], v[52:55]
    ds_read_b64_tr_b16 a[204:205], v9 offset:12288
    v_mfma_f32_16x16x32_bf16 v[52:55], a[212:215], a[84:87], v[52:55]
    s_waitcnt vmcnt(24)
    s_waitcnt vmcnt(17)
    ds_read_b64_tr_b16 a[206:207], v9 offset:18432
    v_mfma_f32_16x16x32_bf16 v[48:51], a[212:215], a[80:83], v[48:51]
    ds_read_b128 v[96:99], v81 offset:64
    v_mfma_f32_16x16x32_bf16 v[48:51], a[208:211], a[64:67], v[48:51]
    s_waitcnt lgkmcnt(4)
    ds_read_b64_tr_b16 v[104:105], v82
    v_mfma_f32_16x16x32_bf16 a[224:227], a[192:195], a[96:99], a[224:227]
    ds_read_b64_tr_b16 a[208:209], v10 offset:0
    v_mfma_f32_16x16x32_bf16 a[224:227], a[196:199], a[112:115], a[224:227]
    ds_read_b64_tr_b16 a[210:211], v10 offset:6144
    v_mfma_f32_16x16x32_bf16 a[228:231], a[196:199], a[116:119], a[228:231]
    ds_read_b64_tr_b16 v[106:107], v82 offset:2048
    v_mfma_f32_16x16x32_bf16 a[228:231], a[192:195], a[100:103], a[228:231]
    buffer_load_dwordx4 a[184:187], v28, s[20:23], s10 offen offset:2048 sc1
    v_mfma_f32_16x16x32_bf16 a[232:235], a[192:195], a[104:107], a[232:235]
    s_lshl1_add_u32 m0, s36, 81920
    ds_read_b64_tr_b16 a[212:213], v10 offset:12288
    s_add_u32 s38, s34, 122880
    v_mfma_f32_16x16x32_bf16 a[232:235], a[196:199], a[120:123], a[232:235]
    s_add_u32 s57, s35, 122880
    ds_read_b64_tr_b16 a[214:215], v10 offset:18432
    s_cmp_lt_u32 s3, 2
    s_cselect_b32 s38, s38, s57
    v_mfma_f32_16x16x32_bf16 a[236:239], a[196:199], a[124:127], a[236:239]
    s_waitcnt vmcnt(8)
    ds_read_b64_tr_b16 v[112:113], v82 offset:4096
    v_lshlrev_b32 v248, 16, v200
    v_mfma_f32_16x16x32_bf16 a[236:239], a[192:195], a[108:111], a[236:239]
    s_waitcnt lgkmcnt(4)
    ds_read_b64_tr_b16 v[114:115], v82 offset:6144
    v_and_b32 v249, 0xffff0000, v200
    v_mfma_f32_16x16x32_bf16 a[252:255], a[200:203], a[108:111], a[252:255]
    ds_read_b64_tr_b16 a[192:193], v11 offset:0
    v_sub_f32 v248, v248, v202
    v_mfma_f32_16x16x32_bf16 a[252:255], a[204:207], a[124:127], a[252:255]
    ds_read_b64_tr_b16 a[194:195], v11 offset:6144
    v_sub_f32 v249, v249, v202
    v_mfma_f32_16x16x32_bf16 a[248:251], a[204:207], a[120:123], a[248:251]
    s_bfe_u32 s88, s72, 262160
    s_cmp_lg_u32 s88, 15
    s_cbranch_scc1 spin_o4
spin_o4_ret:
    v_cvt_pk_bf16_f32 v193, v248, v249
    v_mfma_f32_16x16x32_bf16 a[248:251], a[200:203], a[104:107], a[248:251]
    buffer_load_dwordx4 v4, s[12:15], s38 offen lds
    v_mfma_f32_16x16x32_bf16 a[244:247], a[200:203], a[100:103], a[244:247]
    s_lshl1_add_u32 m0, s36, 82944
    ds_read_b64_tr_b16 a[196:197], v11 offset:12288
    v_lshlrev_b32 v248, 16, v193
    v_mfma_f32_16x16x32_bf16 a[244:247], a[204:207], a[116:119], a[244:247]
    ds_read_b64_tr_b16 a[198:199], v11 offset:18432
    v_and_b32 v249, 0xffff0000, v193
    v_mfma_f32_16x16x32_bf16 a[240:243], a[204:207], a[112:115], a[240:243]
    buffer_load_dwordx4 a[0:3], v28, s[20:23], s8 offen offset:0 sc1
    v_mfma_f32_16x16x32_bf16 a[240:243], a[200:203], a[96:99], a[240:243]
    s_waitcnt lgkmcnt(4)
    v_mul_f32 v248, v248, v203
    v_mul_f32 v249, v249, v203
    v_mfma_f32_16x16x32_bf16 v[68:71], a[208:211], a[96:99], v[68:71]
    ds_read_b64_tr_b16 a[200:201], v8 offset:1024
    v_cvt_pk_bf16_f32 v193, v248, v249
    v_mfma_f32_16x16x32_bf16 v[68:71], a[212:215], a[112:115], v[68:71]
    ds_read_b64_tr_b16 a[202:203], v8 offset:7168
    v_lshlrev_b32 v248, 16, v193
    v_mfma_f32_16x16x32_bf16 v[76:79], a[212:215], a[116:119], v[76:79]
    buffer_load_dwordx4 a[4:7], v28, s[20:23], s8 offen offset:1024 sc1
    v_mfma_f32_16x16x32_bf16 v[76:79], a[208:211], a[100:103], v[76:79]
    v_and_b32 v249, 0xffff0000, v193
    v_lshlrev_b32 v250, 16, v201
    v_mfma_f32_16x16x32_bf16 v[84:87], a[208:211], a[104:107], v[84:87]
    ds_read_b64_tr_b16 a[204:205], v8 offset:13312
    v_and_b32 v251, 0xffff0000, v201
    v_mfma_f32_16x16x32_bf16 v[84:87], a[212:215], a[120:123], v[84:87]
    ds_read_b64_tr_b16 a[206:207], v8 offset:19456
    v_sub_f32 v250, v250, v202
    v_mfma_f32_16x16x32_bf16 v[92:95], a[212:215], a[124:127], v[92:95]
    v_mfma_f32_16x16x32_bf16 v[120:123], v[88:91], v[104:107], 0
    v_mfma_f32_16x16x32_bf16 v[120:123], v[96:99], v[112:115], v[120:123]
    v_mfma_f32_16x16x32_bf16 v[92:95], a[208:211], a[108:111], v[92:95]
    s_waitcnt lgkmcnt(4)
    buffer_load_dwordx4 a[8:11], v28, s[20:23], s8 offen offset:2048 sc1
    v_mfma_f32_16x16x32_bf16 v[124:127], a[192:195], a[108:111], v[124:127]
    ds_read_b64_tr_b16 a[208:209], v9 offset:1024
    v_sub_f32 v251, v251, v202
    v_mfma_f32_16x16x32_bf16 v[124:127], a[196:199], a[124:127], v[124:127]
    ds_read_b64_tr_b16 a[210:211], v9 offset:7168
    v_cvt_pk_bf16_f32 v193, v250, v251
    v_mfma_f32_16x16x32_bf16 v[116:119], a[196:199], a[120:123], v[116:119]
    v_lshlrev_b32 v250, 16, v193
    v_and_b32 v251, 0xffff0000, v193
    v_mfma_f32_16x16x32_bf16 v[116:119], a[192:195], a[104:107], v[116:119]
    buffer_load_dwordx4 a[12:15], v28, s[20:23], s8 offen offset:3072 sc1
    v_mfma_f32_16x16x32_bf16 v[108:111], a[192:195], a[100:103], v[108:111]
    s_add_u32 s8, s8, 4096
    ds_read_b64_tr_b16 a[212:213], v9 offset:13312
    v_mul_f32 v250, v250, v203
    v_mfma_f32_16x16x32_bf16 v[108:111], a[196:199], a[116:119], v[108:111]
    ds_read_b64_tr_b16 a[214:215], v9 offset:19456
    v_mul_f32 v251, v251, v203
    v_mfma_f32_16x16x32_bf16 v[100:103], a[196:199], a[112:115], v[100:103]
    buffer_atomic_add_f32 v120, v74, s[24:27], s62 offen
    v_mfma_f32_16x16x32_bf16 v[100:103], a[192:195], a[96:99], v[100:103]
    s_waitcnt lgkmcnt(4)
    buffer_load_dwordx4 v5, s[12:15], s38 offen lds
    v_mfma_f32_16x16x32_bf16 v[132:135], a[200:203], a[96:99], v[132:135]
    s_lshl1_add_u32 m0, s36, 90112
    ds_read_b64_tr_b16 a[192:193], v10 offset:1024
    v_cvt_pk_bf16_f32 v193, v250, v251
    v_mfma_f32_16x16x32_bf16 v[132:135], a[204:207], a[112:115], v[132:135]
    s_add_u32 s38, s33, 163840
    ds_read_b64_tr_b16 a[194:195], v10 offset:7168
    v_lshlrev_b32 v250, 16, v193
    v_mfma_f32_16x16x32_bf16 v[140:143], a[204:207], a[116:119], v[140:143]
    buffer_atomic_add_f32 v121, v74, s[24:27], s62 offen offset:256
    v_mfma_f32_16x16x32_bf16 v[140:143], a[200:203], a[100:103], v[140:143]
    buffer_load_dwordx4 a[188:191], v28, s[20:23], s10 offen offset:3072 sc1
    v_mfma_f32_16x16x32_bf16 v[148:151], a[200:203], a[104:107], v[148:151]
    s_add_u32 s57, s34, 163840
    ds_read_b64_tr_b16 a[196:197], v10 offset:13312
    v_and_b32 v251, 0xffff0000, v193
    v_mfma_f32_16x16x32_bf16 v[148:151], a[204:207], a[120:123], v[148:151]
    s_cmp_lt_u32 s3, 2
    s_cselect_b32 s38, s38, s57
    ds_read_b64_tr_b16 a[198:199], v10 offset:19456
    v_mfma_f32_16x16x32_bf16 v[156:159], a[204:207], a[124:127], v[156:159]
    s_add_u32 s10, s10, 12288
    v_mul_f32 v24, v24, -v25
    v_add_u32 v8, 0, v12
    v_mfma_f32_16x16x32_bf16 v[156:159], a[200:203], a[108:111], v[156:159]
    s_waitcnt lgkmcnt(4)
    v_lshrrev_b32 v233, 5, v1
    v_lshlrev_b32 v233, 11, v233
    v_mfma_f32_16x16x32_bf16 v[188:191], a[208:211], a[108:111], v[188:191]
    ds_read_b64_tr_b16 a[200:201], v11 offset:1024
    v_sub_u32 v233, 81920, v233
    v_mfma_f32_16x16x32_bf16 v[188:191], a[212:215], a[124:127], v[188:191]
    ds_read_b64_tr_b16 a[202:203], v11 offset:7168
    v_add_u32 v9, 0, v13
    v_mfma_f32_16x16x32_bf16 v[180:183], a[212:215], a[120:123], v[180:183]
    buffer_load_dwordx4 v4, s[12:15], s38 offen lds
    v_mfma_f32_16x16x32_bf16 v[180:183], a[208:211], a[104:107], v[180:183]
    s_lshl1_add_u32 m0, s36, 91136
    v_mov_b32 v122, 1
    v_min_u32 v123, 1, v1
    v_mfma_f32_16x16x32_bf16 v[172:175], a[208:211], a[100:103], v[172:175]
    ds_read_b64_tr_b16 a[204:205], v11 offset:13312
    v_lshlrev_b32 v123, 30, v123
    v_mfma_f32_16x16x32_bf16 v[172:175], a[212:215], a[116:119], v[172:175]
    ds_read_b64_tr_b16 a[206:207], v11 offset:19456
    v_add_u32 v10, 0, v14
    v_mfma_f32_16x16x32_bf16 v[164:167], a[212:215], a[112:115], v[164:167]
    buffer_load_dwordx4 v5, s[12:15], s38 offen lds
    v_mfma_f32_16x16x32_bf16 v[164:167], a[208:211], a[96:99], v[164:167]
    s_waitcnt lgkmcnt(4)
    v_add_u32 v11, 0, v15
    s_lshl1_add_u32 m0, s36, 98304
    v_mfma_f32_16x16x32_bf16 v[196:199], a[192:195], a[96:99], v[196:199]
    s_add_u32 s38, s35, 163840
    ds_read_b64_tr_b16 a[208:209], v18 offset:2048
    s_add_u32 s57, s33, 204800
    v_mfma_f32_16x16x32_bf16 v[196:199], a[196:199], a[112:115], v[196:199]
    s_cmp_lt_u32 s3, 2
    s_cselect_b32 s38, s38, s57
    ds_read_b64_tr_b16 a[210:211], v18 offset:8192
    v_mfma_f32_16x16x32_bf16 v[204:207], a[196:199], a[116:119], v[204:207]
    buffer_load_dwordx4 v4, s[12:15], s38 offen lds
    v_mfma_f32_16x16x32_bf16 v[204:207], a[192:195], a[100:103], v[204:207]
    s_lshl1_add_u32 m0, s36, 99328
    s_load_dword s72, s[86:87], s5 offset:4 glc
    v_mfma_f32_16x16x32_bf16 v[212:215], a[192:195], a[104:107], v[212:215]
    ds_read_b64_tr_b16 a[212:213], v18 offset:14336
    v_mfma_f32_16x16x32_bf16 v[212:215], a[196:199], a[120:123], v[212:215]
    ds_read_b64_tr_b16 a[214:215], v18 offset:20480
    v_mfma_f32_16x16x32_bf16 v[220:223], a[196:199], a[124:127], v[220:223]
    buffer_load_dwordx4 v5, s[12:15], s38 offen lds
    v_mfma_f32_16x16x32_bf16 v[220:223], a[192:195], a[108:111], v[220:223]
    s_waitcnt lgkmcnt(4)
    v_xor_b32 v18, s39, v8
    s_lshl1_add_u32 m0, s36, 106496
    v_mfma_f32_16x16x32_bf16 v[252:255], a[200:203], a[108:111], v[252:255]
    s_add_u32 s38, s34, 204800
    ds_read_b64_tr_b16 a[192:193], v19 offset:2048
    s_add_u32 s57, s35, 204800
    v_mfma_f32_16x16x32_bf16 v[252:255], a[204:207], a[124:127], v[252:255]
    s_cmp_lt_u32 s3, 2
    s_cselect_b32 s38, s38, s57
    ds_read_b64_tr_b16 a[194:195], v19 offset:8192
    v_mfma_f32_16x16x32_bf16 v[244:247], a[204:207], a[120:123], v[244:247]
    buffer_load_dwordx4 v4, s[12:15], s38 offen lds
    v_mfma_f32_16x16x32_bf16 v[244:247], a[200:203], a[104:107], v[244:247]
    v_mfma_f32_16x16x32_bf16 v[236:239], a[200:203], a[100:103], v[236:239]
    s_lshl1_add_u32 m0, s36, 107520
    ds_read_b64_tr_b16 a[196:197], v19 offset:14336
    v_mfma_f32_16x16x32_bf16 v[236:239], a[204:207], a[116:119], v[236:239]
    s_waitcnt vmcnt(63)
    ds_read_b64_tr_b16 a[198:199], v19 offset:20480
    v_mfma_f32_16x16x32_bf16 v[228:231], a[204:207], a[112:115], v[228:231]
    s_barrier
    v_mfma_f32_16x16x32_bf16 v[228:231], a[200:203], a[96:99], v[228:231]
    s_waitcnt lgkmcnt(4)
    buffer_load_dwordx4 a[16:19], v28, s[20:23], s9 offen offset:0 sc1
    v_mfma_f32_16x16x32_bf16 v[32:35], a[208:211], a[96:99], v[32:35]
    s_lshl_b32 s77, s3, 1
    s_add_u32 s77, s77, 0
    s_cmp_eq_u32 s77, s53
    s_cselect_b32 s77, 0x7ffffff0, 0
    ds_read_b64_tr_b16 a[200:201], v8 offset:0
    v_mfma_f32_16x16x32_bf16 v[32:35], a[212:215], a[112:115], v[32:35]
    ds_read_b64_tr_b16 a[202:203], v8 offset:6144
    v_or_b32 v6, s77, v28
    v_mfma_f32_16x16x32_bf16 v[36:39], a[212:215], a[116:119], v[36:39]
    buffer_load_dwordx4 v5, s[12:15], s38 offen lds
    v_mfma_f32_16x16x32_bf16 v[36:39], a[208:211], a[100:103], v[36:39]
    s_lshl_b32 s77, s3, 1
    v_xor_b32 v19, s39, v9
    s_add_u32 s77, s77, 0
    v_mfma_f32_16x16x32_bf16 v[40:43], a[208:211], a[104:107], v[40:43]
    s_lshr_b32 s77, s93, s77
    ds_read_b64_tr_b16 a[204:205], v8 offset:12288
    s_lshr_b32 s73, s93, s53
    v_mfma_f32_16x16x32_bf16 v[40:43], a[212:215], a[120:123], v[40:43]
    s_xor_b32 s77, s77, s73
    ds_read_b64_tr_b16 a[206:207], v8 offset:18432
    s_xor_b32 s77, s77, s55
    v_mfma_f32_16x16x32_bf16 v[44:47], a[212:215], a[124:127], v[44:47]
    s_and_b32 s77, s77, 0x2000
    v_or_b32 v6, s77, v6
    s_lshl_b32 s77, s3, 1
    s_add_u32 s77, s77, 1
    s_cmp_eq_u32 s77, s53
    s_cselect_b32 s77, 0x7ffffff0, 0
    v_mfma_f32_16x16x32_bf16 v[44:47], a[208:211], a[108:111], v[44:47]
    s_waitcnt lgkmcnt(4)
    buffer_load_dwordx4 a[20:23], v28, s[20:23], s9 offen offset:1024 sc1
    v_mfma_f32_16x16x32_bf16 v[60:63], a[192:195], a[108:111], v[60:63]
    ds_read_b64_tr_b16 a[208:209], v9 offset:0
    v_or_b32 v7, s77, v28
    v_mfma_f32_16x16x32_bf16 v[60:63], a[196:199], a[124:127], v[60:63]
    s_lshl_b32 s77, s3, 1
    ds_read_b64_tr_b16 a[210:211], v9 offset:6144
    s_add_u32 s77, s77, 1
    v_mfma_f32_16x16x32_bf16 v[56:59], a[196:199], a[120:123], v[56:59]
    s_lshr_b32 s77, s93, s77
    s_lshr_b32 s73, s93, s53
    s_xor_b32 s77, s77, s73
    v_mfma_f32_16x16x32_bf16 v[56:59], a[192:195], a[104:107], v[56:59]
    buffer_load_dwordx4 a[24:27], v28, s[20:23], s9 offen offset:2048 sc1
    v_mfma_f32_16x16x32_bf16 v[52:55], a[192:195], a[100:103], v[52:55]
    s_xor_b32 s77, s77, s55
    ds_read_b64_tr_b16 a[212:213], v9 offset:12288
    s_and_b32 s77, s77, 0x2000
    v_mfma_f32_16x16x32_bf16 v[52:55], a[196:199], a[116:119], v[52:55]
    s_waitcnt vmcnt(32)
    s_waitcnt vmcnt(25)
    ds_read_b64_tr_b16 a[214:215], v9 offset:18432
    v_mfma_f32_16x16x32_bf16 v[48:51], a[196:199], a[112:115], v[48:51]
pg_11:
    s_cbranch_execz pg_ret2
    v_or_b32 v7, s77, v7
    s_andn2_b32 s55, s55, 0x2000
    v_mfma_f32_16x16x32_bf16 v[48:51], a[192:195], a[96:99], v[48:51]
    s_waitcnt lgkmcnt(4)
    buffer_load_dwordx4 a[28:31], v28, s[20:23], s9 offen offset:3072 sc1
    v_mfma_f32_16x16x32_bf16 a[224:227], a[200:203], a[128:131], a[224:227]
    s_add_u32 s9, s9, 4096
    ds_read_b64_tr_b16 a[192:193], v10 offset:0
    v_mfma_f32_16x16x32_bf16 a[224:227], a[204:207], a[144:147], a[224:227]
    ds_read_b64_tr_b16 a[194:195], v10 offset:6144
    v_mfma_f32_16x16x32_bf16 a[228:231], a[204:207], a[148:151], a[228:231]
    s_bfe_u32 s88, s72, 262164
    s_cmp_lg_u32 s88, 15
    s_cbranch_scc1 spin_o5
spin_o5_ret:
    v_mfma_f32_16x16x32_bf16 a[228:231], a[200:203], a[132:135], a[228:231]
    buffer_load_dwordx4 a[32:35], v28, s[20:23], s10 offen offset:0 sc1
    v_mfma_f32_16x16x32_bf16 a[232:235], a[200:203], a[136:139], a[232:235]
    ds_read_b64_tr_b16 a[196:197], v10 offset:12288
    v_mfma_f32_16x16x32_bf16 a[232:235], a[204:207], a[152:155], a[232:235]
    ds_read_b64_tr_b16 a[198:199], v10 offset:18432
    v_mfma_f32_16x16x32_bf16 a[236:239], a[204:207], a[156:159], a[236:239]
    v_mfma_f32_16x16x32_bf16 a[236:239], a[200:203], a[140:143], a[236:239]
    s_waitcnt lgkmcnt(4)
    v_mfma_f32_16x16x32_bf16 a[252:255], a[208:211], a[140:143], a[252:255]
    ds_read_b64_tr_b16 a[200:201], v11 offset:0
    v_mfma_f32_16x16x32_bf16 a[252:255], a[212:215], a[156:159], a[252:255]
    ds_read_b64_tr_b16 a[202:203], v11 offset:6144
    v_mfma_f32_16x16x32_bf16 a[248:251], a[212:215], a[152:155], a[248:251]
    buffer_load_dwordx4 a[48:51], v28, s[20:23], s8 offen offset:0 sc1
    v_mfma_f32_16x16x32_bf16 a[248:251], a[208:211], a[136:139], a[248:251]
    v_mfma_f32_16x16x32_bf16 a[244:247], a[208:211], a[132:135], a[244:247]
    ds_read_b64_tr_b16 a[204:205], v11 offset:12288
    v_mfma_f32_16x16x32_bf16 a[244:247], a[212:215], a[148:151], a[244:247]
    ds_read_b64_tr_b16 a[206:207], v11 offset:18432
    v_mfma_f32_16x16x32_bf16 a[240:243], a[212:215], a[144:147], a[240:243]
    buffer_load_dwordx4 a[52:55], v28, s[20:23], s8 offen offset:1024 sc1
    v_mfma_f32_16x16x32_bf16 a[240:243], a[208:211], a[128:131], a[240:243]
    s_waitcnt lgkmcnt(4)
    v_mfma_f32_16x16x32_bf16 v[68:71], a[192:195], a[128:131], v[68:71]
    ds_read_b64_tr_b16 a[208:209], v8 offset:1024
    v_mfma_f32_16x16x32_bf16 v[68:71], a[196:199], a[144:147], v[68:71]
    ds_read_b64_tr_b16 a[210:211], v8 offset:7168
    v_mfma_f32_16x16x32_bf16 v[76:79], a[196:199], a[148:151], v[76:79]
    buffer_load_dwordx4 a[56:59], v28, s[20:23], s8 offen offset:2048 sc1
    v_mfma_f32_16x16x32_bf16 v[76:79], a[192:195], a[132:135], v[76:79]
    v_mfma_f32_16x16x32_bf16 v[84:87], a[192:195], a[136:139], v[84:87]
    ds_read_b64_tr_b16 a[212:213], v8 offset:13312
    v_mfma_f32_16x16x32_bf16 v[84:87], a[196:199], a[152:155], v[84:87]
    ds_read_b64_tr_b16 a[214:215], v8 offset:19456
    v_mfma_f32_16x16x32_bf16 v[92:95], a[196:199], a[156:159], v[92:95]
    buffer_load_dwordx4 a[60:63], v28, s[20:23], s8 offen offset:3072 sc1
    v_mfma_f32_16x16x32_bf16 v[92:95], a[192:195], a[140:143], v[92:95]
    s_waitcnt lgkmcnt(4)
    v_add_u32 v8, v233, v12
    s_add_u32 s8, s8, 12288
    v_mfma_f32_16x16x32_bf16 v[124:127], a[200:203], a[140:143], v[124:127]
    ds_read_b64_tr_b16 a[192:193], v9 offset:1024
    v_mfma_f32_16x16x32_bf16 v[124:127], a[204:207], a[156:159], v[124:127]
    ds_read_b64_tr_b16 a[194:195], v9 offset:7168
    v_mfma_f32_16x16x32_bf16 v[116:119], a[204:207], a[152:155], v[116:119]
    buffer_load_dwordx4 a[36:39], v28, s[20:23], s10 offen offset:1024 sc1
    v_mfma_f32_16x16x32_bf16 v[116:119], a[200:203], a[136:139], v[116:119]
    v_mfma_f32_16x16x32_bf16 v[108:111], a[200:203], a[132:135], v[108:111]
    ds_read_b64_tr_b16 a[196:197], v9 offset:13312
    v_mfma_f32_16x16x32_bf16 v[108:111], a[204:207], a[148:151], v[108:111]
    ds_read_b64_tr_b16 a[198:199], v9 offset:19456
    v_mfma_f32_16x16x32_bf16 v[100:103], a[204:207], a[144:147], v[100:103]
    buffer_load_dwordx4 a[40:43], v28, s[20:23], s10 offen offset:2048 sc1
    v_mfma_f32_16x16x32_bf16 v[100:103], a[200:203], a[128:131], v[100:103]
    s_waitcnt lgkmcnt(4)
    v_add_u32 v9, v233, v13
    v_mfma_f32_16x16x32_bf16 v[132:135], a[208:211], a[128:131], v[132:135]
    s_waitcnt vmcnt(18)
    ds_read_b64_tr_b16 a[200:201], v10 offset:1024
    v_mfma_f32_16x16x32_bf16 v[132:135], a[212:215], a[144:147], v[132:135]
    ds_read_b64_tr_b16 a[202:203], v10 offset:7168
    v_mfma_f32_16x16x32_bf16 v[140:143], a[212:215], a[148:151], v[140:143]
    buffer_atomic_add v122, v123, s[24:27], s62 offen offset:128
    v_mfma_f32_16x16x32_bf16 v[140:143], a[208:211], a[132:135], v[140:143]
    buffer_load_dwordx4 a[44:47], v28, s[20:23], s10 offen offset:3072 sc1
    v_mfma_f32_16x16x32_bf16 v[148:151], a[208:211], a[136:139], v[148:151]
    s_add_u32 s10, s10, 4096
    ds_read_b64_tr_b16 a[204:205], v10 offset:13312
    v_mfma_f32_16x16x32_bf16 v[148:151], a[212:215], a[152:155], v[148:151]
    ds_read_b64_tr_b16 a[206:207], v10 offset:19456
    v_add_f32 v68, -0.5, v68
    v_mfma_f32_16x16x32_bf16 v[156:159], a[212:215], a[156:159], v[156:159]
    v_add_f32 v69, -0.5, v69
    v_add_f32 v70, -0.5, v70
    v_mfma_f32_16x16x32_bf16 v[156:159], a[208:211], a[140:143], v[156:159]
    s_waitcnt lgkmcnt(4)
    buffer_load_dwordx4 a[64:67], v28, s[20:23], s9 offen offset:0 sc1
    v_mfma_f32_16x16x32_bf16 v[188:191], a[192:195], a[140:143], v[188:191]
    ds_read_b64_tr_b16 a[208:209], v11 offset:1024
    v_add_f32 v71, -0.5, v71
    v_mfma_f32_16x16x32_bf16 v[188:191], a[196:199], a[156:159], v[188:191]
    ds_read_b64_tr_b16 a[210:211], v11 offset:7168
    v_add_f32 v100, -0.5, v100
    v_mfma_f32_16x16x32_bf16 v[180:183], a[196:199], a[152:155], v[180:183]
    v_add_f32 v101, -0.5, v101
    v_add_f32 v102, -0.5, v102
    v_mfma_f32_16x16x32_bf16 v[180:183], a[192:195], a[136:139], v[180:183]
    buffer_load_dwordx4 a[68:71], v28, s[20:23], s9 offen offset:1024 sc1
    v_mfma_f32_16x16x32_bf16 v[172:175], a[192:195], a[132:135], v[172:175]
    ds_read_b64_tr_b16 a[212:213], v11 offset:13312
    v_add_f32 v103, -0.5, v103
    v_mfma_f32_16x16x32_bf16 v[172:175], a[196:199], a[148:151], v[172:175]
    ds_read_b64_tr_b16 a[214:215], v11 offset:19456
    v_add_f32 v76, -0.5, v76
    v_mfma_f32_16x16x32_bf16 v[164:167], a[196:199], a[144:147], v[164:167]
    v_add_f32 v77, -0.5, v77
    v_add_f32 v78, -0.5, v78
    v_mfma_f32_16x16x32_bf16 v[164:167], a[192:195], a[128:131], v[164:167]
    s_waitcnt lgkmcnt(4)
    buffer_load_dwordx4 a[72:75], v28, s[20:23], s9 offen offset:2048 sc1
    v_mfma_f32_16x16x32_bf16 v[196:199], a[200:203], a[128:131], v[196:199]
    ds_read_b64_tr_b16 a[192:193], v18 offset:2048
    v_add_f32 v79, -0.5, v79
    v_mfma_f32_16x16x32_bf16 v[196:199], a[204:207], a[144:147], v[196:199]
    ds_read_b64_tr_b16 a[194:195], v18 offset:8192
    v_add_f32 v108, -0.5, v108
    v_mfma_f32_16x16x32_bf16 v[204:207], a[204:207], a[148:151], v[204:207]
    v_add_f32 v109, -0.5, v109
    v_add_f32 v110, -0.5, v110
    v_mfma_f32_16x16x32_bf16 v[204:207], a[200:203], a[132:135], v[204:207]
    buffer_load_dwordx4 a[76:79], v28, s[20:23], s9 offen offset:3072 sc1
    v_mfma_f32_16x16x32_bf16 v[212:215], a[200:203], a[136:139], v[212:215]
    s_lshl1_add_u32 m0, s36, 114688
    ds_read_b64_tr_b16 a[196:197], v18 offset:14336
    v_add_f32 v111, -0.5, v111
    v_mfma_f32_16x16x32_bf16 v[212:215], a[204:207], a[152:155], v[212:215]
    s_add_u32 s38, s34, 123008
    ds_read_b64_tr_b16 a[198:199], v18 offset:20480
    v_add_f32 v84, -0.5, v84
    v_mfma_f32_16x16x32_bf16 v[220:223], a[204:207], a[156:159], v[220:223]
    s_add_u32 s57, s35, 123008
    v_add_f32 v85, -0.5, v85
    v_add_f32 v86, -0.5, v86
    v_mfma_f32_16x16x32_bf16 v[220:223], a[200:203], a[140:143], v[220:223]
    s_waitcnt lgkmcnt(4)
    v_add_f32 v87, -0.5, v87
    v_add_f32 v116, -0.5, v116
    v_mfma_f32_16x16x32_bf16 v[252:255], a[208:211], a[140:143], v[252:255]
    s_cmp_lt_u32 s3, 2
    s_cselect_b32 s38, s38, s57
    ds_read_b64_tr_b16 a[200:201], v19 offset:2048
    v_mfma_f32_16x16x32_bf16 v[252:255], a[212:215], a[156:159], v[252:255]
    s_add_u32 s9, s9, 12288
    ds_read_b64_tr_b16 a[202:203], v19 offset:8192
    v_add_f32 v117, -0.5, v117
    v_mfma_f32_16x16x32_bf16 v[244:247], a[212:215], a[152:155], v[244:247]
    buffer_load_dwordx4 a[80:83], v28, s[20:23], s10 offen offset:0 sc1
    v_mfma_f32_16x16x32_bf16 v[244:247], a[208:211], a[136:139], v[244:247]
    v_add_f32 v118, -0.5, v118
    v_add_f32 v119, -0.5, v119
    v_mfma_f32_16x16x32_bf16 v[236:239], a[208:211], a[132:135], v[236:239]
    ds_read_b64_tr_b16 a[204:205], v19 offset:14336
    v_add_f32 v92, -0.5, v92
    v_mfma_f32_16x16x32_bf16 v[236:239], a[212:215], a[148:151], v[236:239]
    s_waitcnt vmcnt(17)
    ds_read_b64_tr_b16 a[206:207], v19 offset:20480
    v_add_f32 v93, -0.5, v93
    v_mfma_f32_16x16x32_bf16 v[228:231], a[212:215], a[144:147], v[228:231]
    s_barrier
    v_mfma_f32_16x16x32_bf16 v[228:231], a[208:211], a[128:131], v[228:231]
    s_waitcnt lgkmcnt(4)
    buffer_load_dwordx4 a[84:87], v28, s[20:23], s10 offen offset:1024 sc1
    v_mfma_f32_16x16x32_bf16 v[32:35], a[192:195], a[128:131], v[32:35]
    ds_read_b64_tr_b16 a[208:209], v8 offset:0
    v_lshrrev_b32 v2, 2, v1
    v_mfma_f32_16x16x32_bf16 v[32:35], a[196:199], a[144:147], v[32:35]
    ds_read_b64_tr_b16 a[210:211], v8 offset:2048
    v_lshlrev_b32 v18, 6, v2
    v_mfma_f32_16x16x32_bf16 v[36:39], a[196:199], a[148:151], v[36:39]
    buffer_load_dwordx4 a[88:91], v28, s[20:23], s10 offen offset:2048 sc1
    v_mfma_f32_16x16x32_bf16 v[36:39], a[192:195], a[132:135], v[36:39]
    v_mul_u32_u24 v2, 1280, v2
    v_and_b32 v19, 3, v1
    v_mfma_f32_16x16x32_bf16 v[40:43], a[192:195], a[136:139], v[40:43]
    ds_read_b64_tr_b16 a[212:213], v8 offset:4096
    v_lshl_add_u32 v18, v19, 3, v18
    v_mfma_f32_16x16x32_bf16 v[40:43], a[196:199], a[152:155], v[40:43]
    ds_read_b64_tr_b16 a[214:215], v8 offset:6144
    v_lshl_add_u32 v2, v19, 4, v2
    v_mfma_f32_16x16x32_bf16 v[44:47], a[196:199], a[156:159], v[44:47]
    buffer_load_dwordx4 a[92:95], v28, s[20:23], s10 offen offset:3072 sc1
    v_mfma_f32_16x16x32_bf16 v[44:47], a[192:195], a[140:143], v[44:47]
    s_waitcnt lgkmcnt(4)
    v_and_b32 v19, 16, v1
    v_lshlrev_b32 v19, 1, v19
    v_mfma_f32_16x16x32_bf16 v[60:63], a[200:203], a[140:143], v[60:63]
    s_add_u32 s10, s10, 12288
    ds_read_b64_tr_b16 a[192:193], v8 offset:8192
    v_xor_b32 v2, v2, v19
    v_mfma_f32_16x16x32_bf16 v[60:63], a[204:207], a[156:159], v[60:63]
    ds_read_b64_tr_b16 a[194:195], v8 offset:10240
    v_or_b32 v18, v18, v19
    v_mfma_f32_16x16x32_bf16 v[56:59], a[204:207], a[152:155], v[56:59]
    buffer_load_dwordx4 v4, s[12:15], s38 offen lds
    v_mfma_f32_16x16x32_bf16 v[56:59], a[200:203], a[136:139], v[56:59]
    s_lshl1_add_u32 m0, s36, 115712
    v_xor_b32 v19, 32, v18
    v_add_u32 v2, s39, v2
    v_mfma_f32_16x16x32_bf16 v[52:55], a[200:203], a[132:135], v[52:55]
    ds_read_b64_tr_b16 a[196:197], v8 offset:12288
    v_add_u32 v2, s63, v2
    v_mfma_f32_16x16x32_bf16 v[52:55], a[204:207], a[148:151], v[52:55]
    s_waitcnt vmcnt(40)
    s_waitcnt vmcnt(28)
    ds_read_b64_tr_b16 a[198:199], v8 offset:14336
    v_mfma_f32_16x16x32_bf16 v[48:51], a[204:207], a[144:147], v[48:51]
    v_add_u32 v18, 147456, v18
    v_add_u32 v19, 147456, v19
    v_mfma_f32_16x16x32_bf16 v[48:51], a[200:203], a[128:131], v[48:51]
    s_waitcnt lgkmcnt(4)
    buffer_load_dwordx4 v5, s[12:15], s38 offen lds
    v_mfma_f32_16x16x32_bf16 a[224:227], a[208:211], a[160:163], a[224:227]
    s_lshl1_add_u32 m0, s36, 122880
    ds_read_b64_tr_b16 a[200:201], v8 offset:16384
    v_add_f32 v94, -0.5, v94
    v_mfma_f32_16x16x32_bf16 a[224:227], a[212:215], a[176:179], a[224:227]
    s_add_u32 s38, s33, 163968
    ds_read_b64_tr_b16 a[202:203], v8 offset:18432
    v_add_f32 v95, -0.5, v95
    v_mfma_f32_16x16x32_bf16 a[228:231], a[212:215], a[180:183], a[228:231]
    s_add_u32 s57, s34, 163968
    v_add_f32 v124, -0.5, v124
    v_add_f32 v125, -0.5, v125
    v_mfma_f32_16x16x32_bf16 a[228:231], a[208:211], a[164:167], a[228:231]
    s_cmp_lt_u32 s3, 2
    s_cselect_b32 s38, s38, s57
    v_add_f32 v126, -0.5, v126
    v_mfma_f32_16x16x32_bf16 a[232:235], a[208:211], a[168:171], a[232:235]
    ds_read_b64_tr_b16 a[204:205], v8 offset:20480
    v_add_f32 v127, -0.5, v127
    v_mfma_f32_16x16x32_bf16 a[232:235], a[212:215], a[184:187], a[232:235]
    s_waitcnt vmcnt(33)
    s_waitcnt vmcnt(19)
    ds_read_b64_tr_b16 a[206:207], v8 offset:22528
    v_mfma_f32_16x16x32_bf16 a[236:239], a[212:215], a[188:191], a[236:239]
    buffer_load_dwordx4 v4, s[12:15], s38 offen lds
    v_mfma_f32_16x16x32_bf16 a[236:239], a[208:211], a[172:175], a[236:239]
    s_waitcnt lgkmcnt(4)
    v_add_f32 v132, -0.5, v132
    v_add_f32 v133, -0.5, v133
    v_mfma_f32_16x16x32_bf16 a[236:239], a[192:195], a[12:15], a[236:239]
    s_lshl1_add_u32 m0, s36, 123904
    ds_read_b64_tr_b16 a[208:209], v8 offset:24576
    v_add_f32 v134, -0.5, v134
    v_add_u32 v10, v233, v14
    v_add_u32 v11, v233, v15
    v_mfma_f32_16x16x32_bf16 a[236:239], a[196:199], a[28:31], a[236:239]
    s_and_b32 s56, s70, 0x7ff
    ds_read_b64_tr_b16 a[210:211], v8 offset:26624
    v_add_f32 v135, -0.5, v135
    v_mfma_f32_16x16x32_bf16 a[232:235], a[196:199], a[24:27], a[232:235]
    buffer_load_dwordx4 v5, s[12:15], s38 offen lds
    v_mfma_f32_16x16x32_bf16 a[232:235], a[192:195], a[8:11], a[232:235]
    s_lshl1_add_u32 m0, s36, 131072
    v_add_f32 v164, -0.5, v164
    v_add_f32 v165, -0.5, v165
    v_mfma_f32_16x16x32_bf16 a[228:231], a[192:195], a[4:7], a[228:231]
    s_add_u32 s38, s35, 163968
    ds_read_b64_tr_b16 a[212:213], v8 offset:28672
    v_add_f32 v166, -0.5, v166
    v_mfma_f32_16x16x32_bf16 a[228:231], a[196:199], a[20:23], a[228:231]
    s_waitcnt vmcnt(12)
    s_waitcnt vmcnt(16)
    ds_read_b64_tr_b16 a[214:215], v8 offset:30720
    v_mfma_f32_16x16x32_bf16 a[224:227], a[196:199], a[16:19], a[224:227]
    s_add_u32 s57, s33, 204928
    v_add_f32 v167, -0.5, v167
    v_add_f32 v140, -0.5, v140
    v_mfma_f32_16x16x32_bf16 a[224:227], a[192:195], a[0:3], a[224:227]
    s_waitcnt lgkmcnt(4)
    v_add_f32 v141, -0.5, v141
    v_add_f32 v142, -0.5, v142
    v_mfma_f32_16x16x32_bf16 a[224:227], a[200:203], a[32:35], a[224:227]
    s_cmp_lt_u32 s3, 2
    s_cselect_b32 s38, s38, s57
    ds_read_b64_tr_b16 a[192:193], v9 offset:0
    v_mfma_f32_16x16x32_bf16 a[224:227], a[204:207], a[48:51], a[224:227]
    s_sub_u32 s56, 2047, s56
    ds_read_b64_tr_b16 a[194:195], v9 offset:2048
    v_cmp_eq_u32 s[78:79], s56, v20
    v_mfma_f32_16x16x32_bf16 a[228:231], a[204:207], a[52:55], a[228:231]
    buffer_load_dwordx4 v4, s[12:15], s38 offen lds
    v_mfma_f32_16x16x32_bf16 a[228:231], a[200:203], a[36:39], a[228:231]
    s_lshl1_add_u32 m0, s36, 132096
    v_add_f32 v143, -0.5, v143
    v_add_f32 v172, -0.5, v172
    v_mfma_f32_16x16x32_bf16 a[232:235], a[200:203], a[40:43], a[232:235]
    s_and_b32 s56, s71, 0x7ff
    ds_read_b64_tr_b16 a[196:197], v9 offset:4096
    v_add_f32 v173, -0.5, v173
    v_mfma_f32_16x16x32_bf16 a[232:235], a[204:207], a[56:59], a[232:235]
    s_waitcnt vmcnt(9)
    s_waitcnt vmcnt(5)
    ds_read_b64_tr_b16 a[198:199], v9 offset:6144
    v_mfma_f32_16x16x32_bf16 a[236:239], a[204:207], a[60:63], a[236:239]
    buffer_load_dwordx4 v5, s[12:15], s38 offen lds
    v_mfma_f32_16x16x32_bf16 a[236:239], a[200:203], a[44:47], a[236:239]
    s_waitcnt lgkmcnt(4)
    v_add_f32 v174, -0.5, v174
    v_add_f32 v175, -0.5, v175
    v_mfma_f32_16x16x32_bf16 a[236:239], a[208:211], a[76:79], a[236:239]
    s_lshl1_add_u32 m0, s36, 139264
    ds_read_b64_tr_b16 a[200:201], v9 offset:8192
    v_add_f32 v148, -0.5, v148
    v_mfma_f32_16x16x32_bf16 a[236:239], a[212:215], a[92:95], a[236:239]
    s_add_u32 s38, s34, 204928
    ds_read_b64_tr_b16 a[202:203], v9 offset:10240
    v_add_f32 v149, -0.5, v149
    v_mfma_f32_16x16x32_bf16 a[232:235], a[212:215], a[88:91], a[232:235]
    s_add_u32 s57, s35, 204928
    v_add_f32 v150, -0.5, v150
    v_add_f32 v151, -0.5, v151
    v_mfma_f32_16x16x32_bf16 a[232:235], a[208:211], a[72:75], a[232:235]
    s_cmp_lt_u32 s3, 2
    s_cselect_b32 s38, s38, s57
    v_add_f32 v180, -0.5, v180
    v_mfma_f32_16x16x32_bf16 a[228:231], a[208:211], a[68:71], a[228:231]
    s_sub_u32 s56, 2047, s56
    ds_read_b64_tr_b16 a[204:205], v9 offset:12288
    v_cmp_eq_u32 s[80:81], s56, v20
    v_mfma_f32_16x16x32_bf16 a[228:231], a[212:215], a[84:87], a[228:231]
    s_bitcmp0_b32 s53, 0
    s_cselect_b32 s68, 0, 0xff00
    s_lshl_b32 s69, 0x10101, s53
    s_or_b32 s68, s68, s69
    s_sub_u32 s48, s48, s47
    ds_read_b64_tr_b16 a[206:207], v9 offset:14336
    v_mfma_f32_16x16x32_bf16 a[224:227], a[212:215], a[80:83], a[224:227]
    buffer_load_dwordx4 v4, s[12:15], s38 offen lds
    v_mfma_f32_16x16x32_bf16 a[224:227], a[208:211], a[64:67], a[224:227]
    s_waitcnt lgkmcnt(4)
    v_bfe_u32 v12, v1, 3, 2
    v_mul_u32_u24 v23, s48, v12
    v_mfma_f32_16x16x32_bf16 a[240:243], a[192:195], a[160:163], a[240:243]
    s_lshl1_add_u32 m0, s36, 140288
    ds_read_b64_tr_b16 a[208:209], v9 offset:16384
    v_add_u32 v23, s47, v23
    v_mfma_f32_16x16x32_bf16 a[240:243], a[196:199], a[176:179], a[240:243]
    ds_read_b64_tr_b16 a[210:211], v9 offset:18432
    v_and_b32 v12, 7, v1
    v_mfma_f32_16x16x32_bf16 a[244:247], a[196:199], a[180:183], a[244:247]
    buffer_load_dwordx4 v5, s[12:15], s38 offen lds
    v_mfma_f32_16x16x32_bf16 a[244:247], a[192:195], a[164:167], a[244:247]
    v_mul_u32_u24 v13, 8389632, v12
    v_xor_b32 v23, v23, v13
    v_mfma_f32_16x16x32_bf16 a[248:251], a[192:195], a[168:171], a[248:251]
    ds_read_b64_tr_b16 a[212:213], v9 offset:20480
    v_mov_b32 v12, s53
    v_mfma_f32_16x16x32_bf16 a[248:251], a[196:199], a[184:187], a[248:251]
    ds_read_b64_tr_b16 a[214:215], v9 offset:22528
    v_lshrrev_b32 v13, v12, s93
    v_mfma_f32_16x16x32_bf16 a[252:255], a[196:199], a[188:191], a[252:255]
    buffer_load_dwordx4 v[144:147], v22, s[16:19], s41 offen
    v_mfma_f32_16x16x32_bf16 a[252:255], a[192:195], a[172:175], a[252:255]
    s_waitcnt lgkmcnt(4)
    v_and_b32 v13, 0x2000, v13
    v_xor_b32 v23, v23, v13
    v_mfma_f32_16x16x32_bf16 a[252:255], a[200:203], a[12:15], a[252:255]
    s_lshr_b32 s56, s2, 4
    ds_read_b64_tr_b16 a[192:193], v9 offset:24576
    v_accvgpr_read_b32 v64, a224
    v_mfma_f32_16x16x32_bf16 a[252:255], a[204:207], a[28:31], a[252:255]
    s_lshl_b32 s56, s56, 14
    ds_read_b64_tr_b16 a[194:195], v9 offset:26624
    v_accvgpr_read_b32 v65, a225
    v_mfma_f32_16x16x32_bf16 a[248:251], a[204:207], a[24:27], a[248:251]
    buffer_load_dwordx4 v[160:163], v22, s[16:19], s43 offen
    v_mfma_f32_16x16x32_bf16 a[248:251], a[200:203], a[8:11], a[248:251]
    s_and_b32 s46, s2, 8
    v_accvgpr_read_b32 v66, a226
    v_accvgpr_read_b32 v67, a227
    v_mfma_f32_16x16x32_bf16 a[244:247], a[200:203], a[4:7], a[244:247]
    s_lshl_b32 s46, s46, 9
    ds_read_b64_tr_b16 a[196:197], v9 offset:28672
    v_accvgpr_read_b32 v80, a228
    v_mfma_f32_16x16x32_bf16 a[244:247], a[204:207], a[20:23], a[244:247]
    s_add_u32 s56, s56, s46
    ds_read_b64_tr_b16 a[198:199], v9 offset:30720
    v_accvgpr_read_b32 v81, a229
    v_mfma_f32_16x16x32_bf16 a[240:243], a[204:207], a[16:19], a[240:243]
    buffer_load_dwordx4 v[152:155], v22, s[16:19], s66 offen
    v_mfma_f32_16x16x32_bf16 a[240:243], a[200:203], a[0:3], a[240:243]
    s_waitcnt lgkmcnt(4)
    v_accvgpr_read_b32 v82, a230
    v_accvgpr_read_b32 v83, a231
    v_mfma_f32_16x16x32_bf16 a[240:243], a[208:211], a[32:35], a[240:243]
    s_add_u32 s56, s56, 4456448
    ds_read_b64_tr_b16 a[200:201], v10 offset:0
    v_accvgpr_read_b32 v96, a232
    v_mfma_f32_16x16x32_bf16 a[240:243], a[212:215], a[48:51], a[240:243]
    s_lshl_b32 s46, s3, 1
    ds_read_b64_tr_b16 a[202:203], v10 offset:2048
    v_lshrrev_b32 v12, 2, v1
    v_mfma_f32_16x16x32_bf16 a[244:247], a[212:215], a[52:55], a[244:247]
    s_add_u32 m0, s36, 147456
    v_min_u32 v12, 1, v12
    v_lshlrev_b32 v12, 30, v12
    v_mfma_f32_16x16x32_bf16 a[244:247], a[208:211], a[36:39], a[244:247]
    s_add_u32 s38, s34, 123136
    v_lshl_or_b32 v12, v1, 7, v12
    v_accvgpr_read_b32 v97, a233
    v_mfma_f32_16x16x32_bf16 a[248:251], a[208:211], a[40:43], a[248:251]
    s_add_u32 s57, s35, 123136
    ds_read_b64_tr_b16 a[204:205], v10 offset:4096
    v_accvgpr_read_b32 v98, a234
    v_mfma_f32_16x16x32_bf16 a[248:251], a[212:215], a[56:59], a[248:251]
    s_cmp_lt_u32 s3, 2
    s_cselect_b32 s38, s38, s57
    ds_read_b64_tr_b16 a[206:207], v10 offset:6144
    v_mfma_f32_16x16x32_bf16 a[252:255], a[212:215], a[60:63], a[252:255]
    s_lshl_b32 s37, s3, 10
    v_accvgpr_read_b32 v99, a235
    v_accvgpr_read_b32 v112, a236
    v_mfma_f32_16x16x32_bf16 a[252:255], a[208:211], a[44:47], a[252:255]
    s_waitcnt lgkmcnt(4)
    v_accvgpr_read_b32 v113, a237
    v_accvgpr_read_b32 v114, a238
    v_mfma_f32_16x16x32_bf16 a[252:255], a[192:195], a[76:79], a[252:255]
    s_add_u32 s56, s56, s37
    ds_read_b64_tr_b16 a[208:209], v10 offset:8192
    v_accvgpr_read_b32 v115, a239
    v_mfma_f32_16x16x32_bf16 a[252:255], a[196:199], a[92:95], a[252:255]
    s_lshr_b32 s46, s93, s46
    ds_read_b64_tr_b16 a[210:211], v10 offset:10240
    v_add_f32 v181, -0.5, v181
    v_mfma_f32_16x16x32_bf16 a[248:251], a[196:199], a[88:91], a[248:251]
    buffer_load_dwordx4 v2, s[12:15], s38 offen lds
    v_mfma_f32_16x16x32_bf16 a[248:251], a[192:195], a[72:75], a[248:251]
    s_add_u32 m0, s36, 151552
    v_add_f32 v182, -0.5, v182
    v_add_f32 v183, -0.5, v183
    v_mfma_f32_16x16x32_bf16 a[244:247], a[192:195], a[68:71], a[244:247]
    s_add_u32 s38, s33, 164096
    ds_read_b64_tr_b16 a[212:213], v10 offset:12288
    v_add_f32 v156, -0.5, v156
    v_mfma_f32_16x16x32_bf16 a[244:247], a[196:199], a[84:87], a[244:247]
    s_add_u32 s57, s34, 164096
    ds_read_b64_tr_b16 a[214:215], v10 offset:14336
    v_add_f32 v157, -0.5, v157
    v_mfma_f32_16x16x32_bf16 a[240:243], a[196:199], a[80:83], a[240:243]
    s_cmp_lt_u32 s3, 2
    s_cselect_b32 s38, s38, s57
    v_add_f32 v158, -0.5, v158
    v_mfma_f32_16x16x32_bf16 a[240:243], a[192:195], a[64:67], a[240:243]
    s_waitcnt lgkmcnt(4)
    buffer_load_dwordx4 v2, s[12:15], s38 offen lds
    v_mfma_f32_16x16x32_bf16 v[68:71], a[200:203], a[160:163], v[68:71]
    s_add_u32 m0, s36, 155648
    ds_read_b64_tr_b16 a[192:193], v10 offset:16384
    v_and_b32 v14, 15, v1
    v_mfma_f32_16x16x32_bf16 v[68:71], a[204:207], a[176:179], v[68:71]
    s_add_u32 s38, s35, 164096
    ds_read_b64_tr_b16 a[194:195], v10 offset:18432
    v_lshl_add_u32 v14, s3, 4, v14
    v_mfma_f32_16x16x32_bf16 v[76:79], a[204:207], a[180:183], v[76:79]
    s_add_u32 s57, s33, 205056
    v_lshlrev_b32 v14, 6, v14
    v_add_f32 v159, -0.5, v159
    v_mfma_f32_16x16x32_bf16 v[76:79], a[200:203], a[164:167], v[76:79]
    s_cmp_lt_u32 s3, 2
    s_cselect_b32 s38, s38, s57
    v_add_f32 v188, -0.5, v188
    v_mfma_f32_16x16x32_bf16 v[84:87], a[200:203], a[168:171], v[84:87]
    s_and_b32 s37, s46, 0x2000
    ds_read_b64_tr_b16 a[196:197], v10 offset:20480
    v_add_f32 v189, -0.5, v189
    v_mfma_f32_16x16x32_bf16 v[84:87], a[204:207], a[184:187], v[84:87]
    s_add_u32 s37, s37, s56
    ds_read_b64_tr_b16 a[198:199], v10 offset:22528
    v_add_u32 v3, s37, v12
    v_mfma_f32_16x16x32_bf16 v[92:95], a[204:207], a[188:191], v[92:95]
    buffer_load_dwordx4 v2, s[12:15], s38 offen lds
    v_mfma_f32_16x16x32_bf16 v[92:95], a[200:203], a[172:175], v[92:95]
    s_waitcnt lgkmcnt(4)
    v_accvgpr_read_b32 v72, a240
    v_accvgpr_read_b32 v73, a241
    v_mfma_f32_16x16x32_bf16 v[92:95], a[208:211], a[12:15], v[92:95]
    s_add_u32 m0, s36, 159744
    ds_read_b64_tr_b16 a[200:201], v10 offset:24576
    v_accvgpr_read_b32 v74, a242
    v_mfma_f32_16x16x32_bf16 v[92:95], a[212:215], a[28:31], v[92:95]
    s_add_u32 s38, s34, 205056
    ds_read_b64_tr_b16 a[202:203], v10 offset:26624
    v_accvgpr_read_b32 v75, a243
    v_mfma_f32_16x16x32_bf16 v[84:87], a[212:215], a[24:27], v[84:87]
    s_add_u32 s57, s35, 205056
    v_add_f32 v64, -0.5, v64
    v_add_f32 v65, -0.5, v65
    v_mfma_f32_16x16x32_bf16 v[84:87], a[208:211], a[8:11], v[84:87]
    s_cmp_lt_u32 s3, 2
    s_cselect_b32 s38, s38, s57
    v_add_f32 v66, -0.5, v66
    v_mfma_f32_16x16x32_bf16 v[76:79], a[208:211], a[4:7], v[76:79]
    s_lshr_b32 s46, s46, 1
    ds_read_b64_tr_b16 a[204:205], v10 offset:28672
    v_add_f32 v67, -0.5, v67
    v_mfma_f32_16x16x32_bf16 v[76:79], a[212:215], a[20:23], v[76:79]
    s_and_b32 s37, s46, 0x2000
    ds_read_b64_tr_b16 a[206:207], v10 offset:30720
    v_add_f32 v72, -0.5, v72
    v_mfma_f32_16x16x32_bf16 v[68:71], a[212:215], a[16:19], v[68:71]
    buffer_load_dwordx4 v2, s[12:15], s38 offen lds
    v_mfma_f32_16x16x32_bf16 v[68:71], a[208:211], a[0:3], v[68:71]
    s_waitcnt lgkmcnt(4)
    v_add_f32 v73, -0.5, v73
    v_add_f32 v74, -0.5, v74
    v_mfma_f32_16x16x32_bf16 v[68:71], a[192:195], a[32:35], v[68:71]
    s_add_u32 s37, s37, s56
    ds_read_b64_tr_b16 a[208:209], v11 offset:0
    v_add_u32 v131, s37, v12
    v_mfma_f32_16x16x32_bf16 v[68:71], a[196:199], a[48:51], v[68:71]
    s_lshl_b32 s56, 1, s53
    ds_read_b64_tr_b16 a[210:211], v11 offset:2048
    v_mov_b32 v128, s56
    v_mfma_f32_16x16x32_bf16 v[76:79], a[196:199], a[52:55], v[76:79]
    s_waitcnt vmcnt(6)
    v_lshlrev_b32 v129, 8, v128
    v_lshlrev_b32 v130, 16, v128
    v_mfma_f32_16x16x32_bf16 v[76:79], a[192:195], a[36:39], v[76:79]
    s_mov_b32 s67, 0
    v_add_f32 v75, -0.5, v75
    v_cvt_pk_bf16_f32 v64, v64, v65
    v_mfma_f32_16x16x32_bf16 v[84:87], a[192:195], a[40:43], v[84:87]
    s_mul_i32 s37, s3, 24576
    ds_read_b64_tr_b16 a[212:213], v11 offset:4096
    v_cvt_pk_bf16_f32 v65, v66, v67
    v_mfma_f32_16x16x32_bf16 v[84:87], a[196:199], a[56:59], v[84:87]
    s_lshl_b32 s56, s3, 9
    ds_read_b64_tr_b16 a[214:215], v11 offset:6144
    v_cvt_pk_bf16_f32 v66, v72, v73
    v_mfma_f32_16x16x32_bf16 v[92:95], a[196:199], a[60:63], v[92:95]
    s_add_u32 s56, s56, 159744
    v_lshlrev_b32 v138, 3, v1
    v_add_u32 v138, s56, v138
    v_mfma_f32_16x16x32_bf16 v[92:95], a[192:195], a[44:47], v[92:95]
    s_waitcnt lgkmcnt(4)
    v_mov_b32 v139, 256
    v_cndmask_b32 v139, 0, v139, s[80:81]
    v_mfma_f32_16x16x32_bf16 v[92:95], a[200:203], a[76:79], v[92:95]
    ds_read_b64_tr_b16 a[192:193], v11 offset:8192
    v_lshl_add_u32 v139, v21, 4, v139
    v_mfma_f32_16x16x32_bf16 v[92:95], a[204:207], a[92:95], v[92:95]
    ds_read_b64_tr_b16 a[194:195], v11 offset:10240
    v_add_u32 v139, s56, v139
    v_mfma_f32_16x16x32_bf16 v[84:87], a[204:207], a[88:91], v[84:87]
    s_mov_b32 s59, 3670016
    v_cvt_pk_bf16_f32 v67, v74, v75
    v_accvgpr_read_b32 v88, a244
    v_mfma_f32_16x16x32_bf16 v[84:87], a[200:203], a[72:75], v[84:87]
    buffer_store_dwordx4 v[64:67], v7, s[24:27], s55 offen sc1
    v_mfma_f32_16x16x32_bf16 v[76:79], a[200:203], a[68:71], v[76:79]
    s_or_b64 s[88:89], s[78:79], s[80:81]
    s_cselect_b32 s59, s59, 0x70000000
    ds_read_b64_tr_b16 a[196:197], v11 offset:12288
    v_mfma_f32_16x16x32_bf16 v[76:79], a[204:207], a[84:87], v[76:79]
    s_xor_b32 s55, s55, 1024
    ds_read_b64_tr_b16 a[198:199], v11 offset:14336
    v_accvgpr_read_b32 v89, a245
    v_mfma_f32_16x16x32_bf16 v[68:71], a[204:207], a[80:83], v[68:71]
    v_accvgpr_read_b32 v90, a246
    v_accvgpr_read_b32 v91, a247
    v_mfma_f32_16x16x32_bf16 v[68:71], a[200:203], a[64:67], v[68:71]
    s_waitcnt lgkmcnt(4)
    v_add_f32 v80, -0.5, v80
    v_add_f32 v81, -0.5, v81
    v_mfma_f32_16x16x32_bf16 v[100:103], a[208:211], a[160:163], v[100:103]
    ds_read_b64_tr_b16 a[200:201], v11 offset:16384
    v_add_f32 v82, -0.5, v82
    v_mfma_f32_16x16x32_bf16 v[100:103], a[212:215], a[176:179], v[100:103]
    ds_read_b64_tr_b16 a[202:203], v11 offset:18432
    v_add_f32 v83, -0.5, v83
    v_mfma_f32_16x16x32_bf16 v[108:111], a[212:215], a[180:183], v[108:111]
    v_add_f32 v88, -0.5, v88
    v_add_f32 v89, -0.5, v89
    v_mfma_f32_16x16x32_bf16 v[108:111], a[208:211], a[164:167], v[108:111]
    v_add_f32 v90, -0.5, v90
    v_add_f32 v91, -0.5, v91
    v_mfma_f32_16x16x32_bf16 v[116:119], a[208:211], a[168:171], v[116:119]
    ds_read_b64_tr_b16 a[204:205], v11 offset:20480
    v_cvt_pk_bf16_f32 v80, v80, v81
    v_mfma_f32_16x16x32_bf16 v[116:119], a[212:215], a[184:187], v[116:119]
    ds_read_b64_tr_b16 a[206:207], v11 offset:22528
    v_cvt_pk_bf16_f32 v81, v82, v83
    v_mfma_f32_16x16x32_bf16 v[124:127], a[212:215], a[188:191], v[124:127]
    v_cvt_pk_bf16_f32 v82, v88, v89
    v_cvt_pk_bf16_f32 v83, v90, v91
    v_mfma_f32_16x16x32_bf16 v[124:127], a[208:211], a[172:175], v[124:127]
    s_waitcnt lgkmcnt(4)
    buffer_store_dwordx4 v[80:83], v7, s[24:27], s55 offen sc1
    v_mfma_f32_16x16x32_bf16 v[124:127], a[192:195], a[12:15], v[124:127]
    s_xor_b32 s55, s55, 3072
    ds_read_b64_tr_b16 a[208:209], v11 offset:24576
    v_accvgpr_read_b32 v104, a248
    v_mfma_f32_16x16x32_bf16 v[124:127], a[196:199], a[28:31], v[124:127]
    ds_read_b64_tr_b16 a[210:211], v11 offset:26624
    v_accvgpr_read_b32 v105, a249
    v_mfma_f32_16x16x32_bf16 v[116:119], a[196:199], a[24:27], v[116:119]
    v_accvgpr_read_b32 v106, a250
    v_accvgpr_read_b32 v107, a251
    v_mfma_f32_16x16x32_bf16 v[116:119], a[192:195], a[8:11], v[116:119]
pg_12:
    s_cbranch_execz pg_ret2
    v_add_f32 v96, -0.5, v96
    v_add_f32 v97, -0.5, v97
    v_mfma_f32_16x16x32_bf16 v[108:111], a[192:195], a[4:7], v[108:111]
    ds_read_b64_tr_b16 a[212:213], v11 offset:28672
    v_add_f32 v98, -0.5, v98
    v_mfma_f32_16x16x32_bf16 v[108:111], a[196:199], a[20:23], v[108:111]
    s_waitcnt vmcnt(9)
    ds_read_b64_tr_b16 a[214:215], v11 offset:30720
    v_add_f32 v99, -0.5, v99
    v_mfma_f32_16x16x32_bf16 v[100:103], a[196:199], a[16:19], v[100:103]
    s_barrier
    v_mfma_f32_16x16x32_bf16 v[100:103], a[192:195], a[0:3], v[100:103]
    s_waitcnt lgkmcnt(4)
    v_add_f32 v104, -0.5, v104
    v_add_f32 v105, -0.5, v105
    v_mfma_f32_16x16x32_bf16 v[100:103], a[200:203], a[32:35], v[100:103]
    ds_read_b64_tr_b16 a[192:193], v8 offset:32768
    v_add_f32 v106, -0.5, v106
    v_mfma_f32_16x16x32_bf16 v[100:103], a[204:207], a[48:51], v[100:103]
    ds_read_b64_tr_b16 a[194:195], v8 offset:34816
    v_add_f32 v107, -0.5, v107
    v_mfma_f32_16x16x32_bf16 v[108:111], a[204:207], a[52:55], v[108:111]
    v_cvt_pk_bf16_f32 v96, v96, v97
    v_cvt_pk_bf16_f32 v97, v98, v99
    v_mfma_f32_16x16x32_bf16 v[108:111], a[200:203], a[36:39], v[108:111]
    v_cvt_pk_bf16_f32 v98, v104, v105
    v_cvt_pk_bf16_f32 v99, v106, v107
    v_mfma_f32_16x16x32_bf16 v[116:119], a[200:203], a[40:43], v[116:119]
    ds_read_b64_tr_b16 a[196:197], v8 offset:36864
    v_accvgpr_read_b32 v120, a252
    v_mfma_f32_16x16x32_bf16 v[116:119], a[204:207], a[56:59], v[116:119]
    ds_read_b64_tr_b16 a[198:199], v8 offset:38912
    v_accvgpr_read_b32 v121, a253
    v_mfma_f32_16x16x32_bf16 v[124:127], a[204:207], a[60:63], v[124:127]
    buffer_store_dwordx4 v[96:99], v7, s[24:27], s55 offen sc1
    v_mfma_f32_16x16x32_bf16 v[124:127], a[200:203], a[44:47], v[124:127]
    s_waitcnt lgkmcnt(4)
    v_accvgpr_read_b32 v122, a254
    v_accvgpr_read_b32 v123, a255
    v_mfma_f32_16x16x32_bf16 v[124:127], a[208:211], a[76:79], v[124:127]
    s_xor_b32 s55, s55, 1024
    ds_read_b64_tr_b16 a[200:201], v8 offset:40960
    v_add_f32 v112, -0.5, v112
    v_mfma_f32_16x16x32_bf16 v[124:127], a[212:215], a[92:95], v[124:127]
    ds_read_b64_tr_b16 a[202:203], v8 offset:43008
    v_add_f32 v113, -0.5, v113
    v_mfma_f32_16x16x32_bf16 v[116:119], a[212:215], a[88:91], v[116:119]
    v_add_f32 v114, -0.5, v114
    v_add_f32 v115, -0.5, v115
    v_mfma_f32_16x16x32_bf16 v[116:119], a[208:211], a[72:75], v[116:119]
    v_add_f32 v120, -0.5, v120
    v_add_f32 v121, -0.5, v121
    v_mfma_f32_16x16x32_bf16 v[108:111], a[208:211], a[68:71], v[108:111]
    ds_read_b64_tr_b16 a[204:205], v8 offset:45056
    v_add_f32 v122, -0.5, v122
    v_mfma_f32_16x16x32_bf16 v[108:111], a[212:215], a[84:87], v[108:111]
    ds_read_b64_tr_b16 a[206:207], v8 offset:47104
    v_add_f32 v123, -0.5, v123
    v_add_f32 v190, -0.5, v190
    v_add_f32 v191, -0.5, v191
    v_mfma_f32_16x16x32_bf16 v[100:103], a[212:215], a[80:83], v[100:103]
    v_cvt_pk_bf16_f32 v112, v112, v113
    v_cvt_pk_bf16_f32 v113, v114, v115
    v_mfma_f32_16x16x32_bf16 v[100:103], a[208:211], a[64:67], v[100:103]
    s_waitcnt lgkmcnt(4)
    v_cvt_pk_bf16_f32 v114, v120, v121
    v_cvt_pk_bf16_f32 v115, v122, v123
    v_mfma_f32_16x16x32_bf16 v[132:135], a[192:195], a[160:163], v[132:135]
    ds_read_b64_tr_b16 a[208:209], v8 offset:49152
    v_cvt_pk_bf16_f32 v68, v68, v69
    v_mfma_f32_16x16x32_bf16 v[132:135], a[196:199], a[176:179], v[132:135]
    ds_read_b64_tr_b16 a[210:211], v8 offset:51200
    v_cvt_pk_bf16_f32 v69, v70, v71
    v_mfma_f32_16x16x32_bf16 v[140:143], a[196:199], a[180:183], v[140:143]
    buffer_store_dwordx4 v[112:115], v7, s[24:27], s55 offen sc1
    v_mfma_f32_16x16x32_bf16 v[140:143], a[192:195], a[164:167], v[140:143]
    s_xor_b32 s55, s55, 3072
    v_cvt_pk_bf16_f32 v76, v76, v77
    v_cvt_pk_bf16_f32 v77, v78, v79
    v_mfma_f32_16x16x32_bf16 v[148:151], a[192:195], a[168:171], v[148:151]
    s_add_u32 s55, s55, 16384
    ds_read_b64_tr_b16 a[212:213], v8 offset:53248
    v_cvt_pk_bf16_f32 v84, v84, v85
    v_mfma_f32_16x16x32_bf16 v[148:151], a[196:199], a[184:187], v[148:151]
    ds_read_b64_tr_b16 a[214:215], v8 offset:55296
    v_cvt_pk_bf16_f32 v85, v86, v87
    v_mfma_f32_16x16x32_bf16 v[156:159], a[196:199], a[188:191], v[156:159]
    v_cvt_pk_bf16_f32 v70, v100, v101
    v_cvt_pk_bf16_f32 v71, v102, v103
    v_mfma_f32_16x16x32_bf16 v[156:159], a[192:195], a[172:175], v[156:159]
    s_waitcnt lgkmcnt(4)
    v_cvt_pk_bf16_f32 v78, v108, v109
    v_cvt_pk_bf16_f32 v79, v110, v111
    v_mfma_f32_16x16x32_bf16 v[156:159], a[200:203], a[12:15], v[156:159]
    ds_read_b64_tr_b16 a[192:193], v8 offset:57344
    v_cvt_pk_bf16_f32 v86, v116, v117
    v_mfma_f32_16x16x32_bf16 v[156:159], a[204:207], a[28:31], v[156:159]
    ds_read_b64_tr_b16 a[194:195], v8 offset:59392
    v_cvt_pk_bf16_f32 v87, v118, v119
    v_mfma_f32_16x16x32_bf16 v[148:151], a[204:207], a[24:27], v[148:151]
    buffer_store_dwordx4 v[68:71], v6, s[24:27], s55 offen sc1
    v_mfma_f32_16x16x32_bf16 v[148:151], a[200:203], a[8:11], v[148:151]
    s_xor_b32 s55, s55, 1024
    v_cvt_pk_bf16_f32 v92, v92, v93
    v_cvt_pk_bf16_f32 v93, v94, v95
    v_mfma_f32_16x16x32_bf16 v[140:143], a[200:203], a[4:7], v[140:143]
    ds_read_b64_tr_b16 a[196:197], v8 offset:61440
    v_cvt_pk_bf16_f32 v94, v124, v125
    v_mfma_f32_16x16x32_bf16 v[140:143], a[204:207], a[20:23], v[140:143]
    ds_read_b64_tr_b16 a[198:199], v8 offset:63488
    v_cvt_pk_bf16_f32 v95, v126, v127
    v_mfma_f32_16x16x32_bf16 v[132:135], a[204:207], a[16:19], v[132:135]
    v_lshlrev_b32 v26, 16, v144
    v_and_b32 v27, 0xffff0000, v144
    v_mfma_f32_16x16x32_bf16 v[132:135], a[200:203], a[0:3], v[132:135]
    s_waitcnt lgkmcnt(4)
    v_fma_f32 v26, v26, v25, v24
    v_fma_f32 v27, v27, v25, v24
    v_mfma_f32_16x16x32_bf16 v[132:135], a[208:211], a[32:35], v[132:135]
    ds_read_b64_tr_b16 a[200:201], v9 offset:32768
    v_mul_f32 v30, s92, v26
    v_mfma_f32_16x16x32_bf16 v[132:135], a[212:215], a[48:51], v[132:135]
    ds_read_b64_tr_b16 a[202:203], v9 offset:34816
    v_mul_f32 v31, s92, v27
    v_mfma_f32_16x16x32_bf16 v[140:143], a[212:215], a[52:55], v[140:143]
    buffer_store_dwordx4 v[76:79], v6, s[24:27], s55 offen sc1
    v_mfma_f32_16x16x32_bf16 v[140:143], a[208:211], a[36:39], v[140:143]
    s_xor_b32 s55, s55, 3072
    v_exp_f32 v30, v30
    v_mfma_f32_16x16x32_bf16 v[148:151], a[208:211], a[40:43], v[148:151]
    ds_read_b64_tr_b16 a[204:205], v9 offset:36864
    v_add_f32 v196, -0.5, v196
    v_mfma_f32_16x16x32_bf16 v[148:151], a[212:215], a[56:59], v[148:151]
    ds_read_b64_tr_b16 a[206:207], v9 offset:38912
    v_add_f32 v197, -0.5, v197
    v_mfma_f32_16x16x32_bf16 v[156:159], a[212:215], a[60:63], v[156:159]
    v_exp_f32 v31, v31
    v_mfma_f32_16x16x32_bf16 v[156:159], a[208:211], a[44:47], v[156:159]
    s_waitcnt lgkmcnt(4)
    v_add_f32 v30, 1.0, v30
    v_add_f32 v31, 1.0, v31
    v_mfma_f32_16x16x32_bf16 v[156:159], a[192:195], a[76:79], v[156:159]
    ds_read_b64_tr_b16 a[208:209], v9 offset:40960
    v_add_f32 v198, -0.5, v198
    v_mfma_f32_16x16x32_bf16 v[156:159], a[196:199], a[92:95], v[156:159]
    ds_read_b64_tr_b16 a[210:211], v9 offset:43008
    v_add_f32 v199, -0.5, v199
    v_mfma_f32_16x16x32_bf16 v[148:151], a[196:199], a[88:91], v[148:151]
    v_rcp_f32 v30, v30
    v_mfma_f32_16x16x32_bf16 v[148:151], a[192:195], a[72:75], v[148:151]
    v_rcp_f32 v31, v31
    v_mfma_f32_16x16x32_bf16 v[140:143], a[192:195], a[68:71], v[140:143]
    ds_read_b64_tr_b16 a[212:213], v9 offset:45056
    v_mul_f32 v26, v26, v30
    v_mfma_f32_16x16x32_bf16 v[140:143], a[196:199], a[84:87], v[140:143]
    ds_read_b64_tr_b16 a[214:215], v9 offset:47104
    v_mul_f32 v27, v27, v31
    v_mfma_f32_16x16x32_bf16 v[132:135], a[196:199], a[80:83], v[132:135]
    buffer_store_dwordx4 v[84:87], v6, s[24:27], s55 offen sc1
    v_mfma_f32_16x16x32_bf16 v[132:135], a[192:195], a[64:67], v[132:135]
    s_waitcnt lgkmcnt(4)
    v_cvt_pk_bf16_f32 v168, v26, v27
    v_lshlrev_b32 v26, 16, v145
    v_mfma_f32_16x16x32_bf16 v[164:167], a[200:203], a[160:163], v[164:167]
    s_xor_b32 s55, s55, 1024
    ds_read_b64_tr_b16 a[192:193], v9 offset:49152
    v_and_b32 v27, 0xffff0000, v145
    v_mfma_f32_16x16x32_bf16 v[164:167], a[204:207], a[176:179], v[164:167]
    ds_read_b64_tr_b16 a[194:195], v9 offset:51200
    v_fma_f32 v26, v26, v25, v24
    v_mfma_f32_16x16x32_bf16 v[172:175], a[204:207], a[180:183], v[172:175]
    v_fma_f32 v27, v27, v25, v24
    v_mul_f32 v30, s92, v26
    v_mfma_f32_16x16x32_bf16 v[172:175], a[200:203], a[164:167], v[172:175]
    v_mul_f32 v31, s92, v27
    v_add_f32 v228, -0.5, v228
    v_mfma_f32_16x16x32_bf16 v[180:183], a[200:203], a[168:171], v[180:183]
    s_mov_b32 s32, s84
    ds_read_b64_tr_b16 a[196:197], v9 offset:53248
    v_add_f32 v229, -0.5, v229
    v_mfma_f32_16x16x32_bf16 v[180:183], a[204:207], a[184:187], v[180:183]
    s_and_b32 s33, s85, 0xffff
    ds_read_b64_tr_b16 a[198:199], v9 offset:55296
    v_add_f32 v230, -0.5, v230
    v_mfma_f32_16x16x32_bf16 v[188:191], a[204:207], a[188:191], v[188:191]
    s_mov_b32 s34, 2621440
    v_cvt_pk_bf16_f32 v132, v132, v133
    v_cvt_pk_bf16_f32 v133, v134, v135
    v_mfma_f32_16x16x32_bf16 v[188:191], a[200:203], a[172:175], v[188:191]
    s_waitcnt lgkmcnt(4)
    v_cvt_pk_bf16_f32 v140, v140, v141
    v_cvt_pk_bf16_f32 v141, v142, v143
    v_mfma_f32_16x16x32_bf16 v[188:191], a[208:211], a[12:15], v[188:191]
    s_mov_b32 s35, 0x00020000
    ds_read_b64_tr_b16 a[200:201], v9 offset:57344
    v_cvt_pk_bf16_f32 v148, v148, v149
    v_mfma_f32_16x16x32_bf16 v[188:191], a[212:215], a[28:31], v[188:191]
    ds_read_b64_tr_b16 a[202:203], v9 offset:59392
    v_cvt_pk_bf16_f32 v149, v150, v151
    v_mfma_f32_16x16x32_bf16 v[180:183], a[212:215], a[24:27], v[180:183]
    buffer_load_dword v137, v136, s[24:27], s59 offen offset:128 sc1
    v_mfma_f32_16x16x32_bf16 v[180:183], a[208:211], a[8:11], v[180:183]
    buffer_store_dwordx4 v[92:95], v6, s[24:27], s55 offen sc1
    v_mfma_f32_16x16x32_bf16 v[172:175], a[208:211], a[4:7], v[172:175]
    s_xor_b32 s55, s55, 3072
    ds_read_b64_tr_b16 a[204:205], v9 offset:61440
    v_cvt_pk_bf16_f32 v156, v156, v157
    v_mfma_f32_16x16x32_bf16 v[172:175], a[212:215], a[20:23], v[172:175]
    s_add_u32 s55, s55, 16384
    ds_read_b64_tr_b16 a[206:207], v9 offset:63488
    v_cvt_pk_bf16_f32 v157, v158, v159
    v_mfma_f32_16x16x32_bf16 v[164:167], a[212:215], a[16:19], v[164:167]
    v_exp_f32 v30, v30
    v_mfma_f32_16x16x32_bf16 v[164:167], a[208:211], a[0:3], v[164:167]
    s_waitcnt lgkmcnt(4)
    v_exp_f32 v31, v31
    v_mfma_f32_16x16x32_bf16 v[164:167], a[192:195], a[32:35], v[164:167]
    s_waitcnt vmcnt(5)
    ds_read_b64_tr_b16 a[208:209], v10 offset:32768
    v_add_f32 v30, 1.0, v30
    v_mfma_f32_16x16x32_bf16 v[164:167], a[196:199], a[48:51], v[164:167]
    ds_read_b64_tr_b16 a[210:211], v10 offset:34816
    v_add_f32 v31, 1.0, v31
    v_mfma_f32_16x16x32_bf16 v[172:175], a[196:199], a[52:55], v[172:175]
    buffer_atomic_or v128, v131, s[24:27], 0 offen offset:512
    v_mfma_f32_16x16x32_bf16 v[172:175], a[192:195], a[36:39], v[172:175]
    s_load_dword s67, s[86:87], s5 glc
    v_rcp_f32 v30, v30
    v_mfma_f32_16x16x32_bf16 v[180:183], a[192:195], a[40:43], v[180:183]
    ds_read_b64_tr_b16 a[212:213], v10 offset:36864
    v_add_f32 v231, -0.5, v231
    v_mfma_f32_16x16x32_bf16 v[180:183], a[196:199], a[56:59], v[180:183]
    ds_read_b64_tr_b16 a[214:215], v10 offset:38912
    v_add_f32 v204, -0.5, v204
    v_mfma_f32_16x16x32_bf16 v[188:191], a[196:199], a[60:63], v[188:191]
    v_rcp_f32 v31, v31
    v_mfma_f32_16x16x32_bf16 v[188:191], a[192:195], a[44:47], v[188:191]
    s_waitcnt lgkmcnt(4)
    v_mul_f32 v26, v26, v30
    v_mul_f32 v27, v27, v31
    v_mfma_f32_16x16x32_bf16 v[188:191], a[200:203], a[76:79], v[188:191]
    ds_read_b64_tr_b16 a[192:193], v10 offset:40960
    v_cvt_pk_bf16_f32 v169, v26, v27
    v_mfma_f32_16x16x32_bf16 v[188:191], a[204:207], a[92:95], v[188:191]
    ds_read_b64_tr_b16 a[194:195], v10 offset:43008
    v_lshlrev_b32 v26, 16, v146
    v_mfma_f32_16x16x32_bf16 v[180:183], a[204:207], a[88:91], v[180:183]
    v_and_b32 v27, 0xffff0000, v146
    v_fma_f32 v26, v26, v25, v24
    v_mfma_f32_16x16x32_bf16 v[180:183], a[200:203], a[72:75], v[180:183]
    v_fma_f32 v27, v27, v25, v24
    v_mul_f32 v30, s92, v26
    v_mfma_f32_16x16x32_bf16 v[172:175], a[200:203], a[68:71], v[172:175]
    ds_read_b64_tr_b16 a[196:197], v10 offset:45056
    v_mul_f32 v31, s92, v27
    v_mfma_f32_16x16x32_bf16 v[172:175], a[204:207], a[84:87], v[172:175]
    ds_read_b64_tr_b16 a[198:199], v10 offset:47104
    v_add_f32 v205, -0.5, v205
    v_add_f32 v206, -0.5, v206
    v_add_f32 v207, -0.5, v207
    v_add_f32 v236, -0.5, v236
    v_add_f32 v237, -0.5, v237
    v_add_f32 v238, -0.5, v238
    v_add_f32 v239, -0.5, v239
    v_add_f32 v212, -0.5, v212
    v_add_f32 v213, -0.5, v213
    v_add_f32 v214, -0.5, v214
    v_add_f32 v215, -0.5, v215
    v_add_f32 v244, -0.5, v244
    v_add_f32 v245, -0.5, v245
    v_add_f32 v246, -0.5, v246
    v_add_f32 v247, -0.5, v247
    v_add_f32 v220, -0.5, v220
    v_add_f32 v221, -0.5, v221
    v_add_f32 v222, -0.5, v222
    v_add_f32 v223, -0.5, v223
    v_add_f32 v252, -0.5, v252
    v_add_f32 v253, -0.5, v253
    v_add_f32 v254, -0.5, v254
    v_add_f32 v255, -0.5, v255
    v_mfma_f32_16x16x32_bf16 v[164:167], a[204:207], a[80:83], v[164:167]
    v_exp_f32 v30, v30
    v_mfma_f32_16x16x32_bf16 v[164:167], a[200:203], a[64:67], v[164:167]
    s_waitcnt lgkmcnt(4)
    v_exp_f32 v31, v31
    v_mfma_f32_16x16x32_bf16 v[196:199], a[208:211], a[160:163], v[196:199]
    ds_read_b64_tr_b16 a[200:201], v10 offset:49152
    v_add_f32 v30, 1.0, v30
    v_mfma_f32_16x16x32_bf16 v[196:199], a[212:215], a[176:179], v[196:199]
    ds_read_b64_tr_b16 a[202:203], v10 offset:51200
    v_add_f32 v31, 1.0, v31
    v_mfma_f32_16x16x32_bf16 v[204:207], a[212:215], a[180:183], v[204:207]
    v_rcp_f32 v30, v30
    v_mfma_f32_16x16x32_bf16 v[204:207], a[208:211], a[164:167], v[204:207]
    v_rcp_f32 v31, v31
    v_mfma_f32_16x16x32_bf16 v[212:215], a[208:211], a[168:171], v[212:215]
    ds_read_b64_tr_b16 a[204:205], v10 offset:53248
    v_mul_f32 v26, v26, v30
    v_mfma_f32_16x16x32_bf16 v[212:215], a[212:215], a[184:187], v[212:215]
    ds_read_b64_tr_b16 a[206:207], v10 offset:55296
    v_mul_f32 v27, v27, v31
    v_mfma_f32_16x16x32_bf16 v[220:223], a[212:215], a[188:191], v[220:223]
    v_cvt_pk_bf16_f32 v134, v164, v165
    v_cvt_pk_bf16_f32 v135, v166, v167
    v_mfma_f32_16x16x32_bf16 v[220:223], a[208:211], a[172:175], v[220:223]
    s_waitcnt lgkmcnt(4)
    v_cvt_pk_bf16_f32 v142, v172, v173
    v_cvt_pk_bf16_f32 v143, v174, v175
    v_mfma_f32_16x16x32_bf16 v[220:223], a[192:195], a[12:15], v[220:223]
    ds_read_b64_tr_b16 a[208:209], v10 offset:57344
    v_cvt_pk_bf16_f32 v150, v180, v181
    v_mfma_f32_16x16x32_bf16 v[220:223], a[196:199], a[28:31], v[220:223]
    ds_read_b64_tr_b16 a[210:211], v10 offset:59392
    v_cvt_pk_bf16_f32 v151, v182, v183
    v_mfma_f32_16x16x32_bf16 v[212:215], a[196:199], a[24:27], v[212:215]
    buffer_store_dwordx4 v[132:135], v6, s[24:27], s55 offen sc1
    v_mfma_f32_16x16x32_bf16 v[212:215], a[192:195], a[8:11], v[212:215]
    s_xor_b32 s55, s55, 1024
    v_cvt_pk_bf16_f32 v158, v188, v189
    v_cvt_pk_bf16_f32 v159, v190, v191
    v_mfma_f32_16x16x32_bf16 v[204:207], a[192:195], a[4:7], v[204:207]
    ds_read_b64_tr_b16 a[212:213], v10 offset:61440
    v_cvt_pk_bf16_f32 v170, v26, v27
    v_mfma_f32_16x16x32_bf16 v[204:207], a[196:199], a[20:23], v[204:207]
    ds_read_b64_tr_b16 a[214:215], v10 offset:63488
    v_lshlrev_b32 v26, 16, v147
    v_mfma_f32_16x16x32_bf16 v[196:199], a[196:199], a[16:19], v[196:199]
    v_and_b32 v27, 0xffff0000, v147
    v_fma_f32 v26, v26, v25, v24
    v_mfma_f32_16x16x32_bf16 v[196:199], a[192:195], a[0:3], v[196:199]
    s_waitcnt lgkmcnt(4)
    v_fma_f32 v27, v27, v25, v24
    v_mul_f32 v30, s92, v26
    v_mfma_f32_16x16x32_bf16 v[196:199], a[200:203], a[32:35], v[196:199]
    ds_read_b64_tr_b16 a[192:193], v11 offset:32768
    v_mul_f32 v31, s92, v27
    v_mfma_f32_16x16x32_bf16 v[196:199], a[204:207], a[48:51], v[196:199]
    ds_read_b64_tr_b16 a[194:195], v11 offset:34816
    v_add_f32 v32, -0.5, v32
    v_mfma_f32_16x16x32_bf16 v[204:207], a[204:207], a[52:55], v[204:207]
    buffer_store_dwordx4 v[140:143], v6, s[24:27], s55 offen sc1
    v_mfma_f32_16x16x32_bf16 v[204:207], a[200:203], a[36:39], v[204:207]
    s_xor_b32 s55, s55, 3072
    v_exp_f32 v30, v30
    v_mfma_f32_16x16x32_bf16 v[212:215], a[200:203], a[40:43], v[212:215]
    ds_read_b64_tr_b16 a[196:197], v11 offset:36864
    v_add_f32 v33, -0.5, v33
    v_mfma_f32_16x16x32_bf16 v[212:215], a[204:207], a[56:59], v[212:215]
    ds_read_b64_tr_b16 a[198:199], v11 offset:38912
    v_add_f32 v34, -0.5, v34
    v_mfma_f32_16x16x32_bf16 v[220:223], a[204:207], a[60:63], v[220:223]
    s_andn2_b32 s69, s67, s68
    s_and_b32 s69, s69, 255
    s_or_b32 s68, s68, s69
    v_mfma_f32_16x16x32_bf16 v[220:223], a[200:203], a[44:47], v[220:223]
    s_waitcnt lgkmcnt(4)
    v_readlane_b32 s56, v23, 0
    v_add_f32 v35, -0.5, v35
    v_mfma_f32_16x16x32_bf16 v[220:223], a[208:211], a[76:79], v[220:223]
    s_add_u32 m0, s37, 0
    ds_read_b64_tr_b16 a[200:201], v11 offset:40960
    v_add_f32 v48, -0.5, v48
    v_mfma_f32_16x16x32_bf16 v[220:223], a[212:215], a[92:95], v[220:223]
    s_bitcmp1_b32 s69, 0
    s_cselect_b32 s56, s56, 0x70000000
    s_cselect_b32 m0, m0, 0x30000
    ds_read_b64_tr_b16 a[202:203], v11 offset:43008
    v_mfma_f32_16x16x32_bf16 v[212:215], a[212:215], a[88:91], v[212:215]
    buffer_load_dwordx4 v28, s[24:27], s56 offen sc1 lds
    v_mfma_f32_16x16x32_bf16 v[212:215], a[208:211], a[72:75], v[212:215]
    v_readlane_b32 s56, v23, 1
    v_add_f32 v49, -0.5, v49
    v_mfma_f32_16x16x32_bf16 v[204:207], a[208:211], a[68:71], v[204:207]
    s_waitcnt vmcnt(5)
    ds_read_b64_tr_b16 a[204:205], v11 offset:45056
    v_cmp_ne_u32 s[78:79], 24, v137
    v_mfma_f32_16x16x32_bf16 v[204:207], a[212:215], a[84:87], v[204:207]
    s_cmp_eq_u64 s[78:79], 0
    s_cselect_b32 s44, s59, 0x70000000
    ds_read_b64_tr_b16 a[206:207], v11 offset:47104
    v_mfma_f32_16x16x32_bf16 v[196:199], a[212:215], a[80:83], v[196:199]
    buffer_load_dwordx4 v[240:243], v192, s[24:27], s44 offen sc1
    v_mfma_f32_16x16x32_bf16 v[196:199], a[208:211], a[64:67], v[196:199]
    s_waitcnt lgkmcnt(4)
    v_exp_f32 v31, v31
    v_mfma_f32_16x16x32_bf16 v[228:231], a[192:195], a[160:163], v[228:231]
    s_add_u32 m0, s37, 1024
    ds_read_b64_tr_b16 a[208:209], v11 offset:49152
    v_add_f32 v30, 1.0, v30
    v_mfma_f32_16x16x32_bf16 v[228:231], a[196:199], a[176:179], v[228:231]
    s_bitcmp1_b32 s69, 1
    s_cselect_b32 s56, s56, 0x70000000
    s_cselect_b32 m0, m0, 0x30000
    ds_read_b64_tr_b16 a[210:211], v11 offset:51200
    v_mfma_f32_16x16x32_bf16 v[236:239], a[196:199], a[180:183], v[236:239]
    buffer_load_dwordx4 v28, s[24:27], s56 offen sc1 lds
    v_mfma_f32_16x16x32_bf16 v[236:239], a[192:195], a[164:167], v[236:239]
    v_readlane_b32 s56, v23, 2
    v_add_f32 v31, 1.0, v31
    v_mfma_f32_16x16x32_bf16 v[244:247], a[192:195], a[168:171], v[244:247]
    s_add_u32 m0, s37, 2048
    ds_read_b64_tr_b16 a[212:213], v11 offset:53248
    v_add_f32 v50, -0.5, v50
    v_mfma_f32_16x16x32_bf16 v[244:247], a[196:199], a[184:187], v[244:247]
    s_bitcmp1_b32 s69, 2
    s_cselect_b32 s56, s56, 0x70000000
    s_cselect_b32 m0, m0, 0x30000
    ds_read_b64_tr_b16 a[214:215], v11 offset:55296
    v_mfma_f32_16x16x32_bf16 v[252:255], a[196:199], a[188:191], v[252:255]
    buffer_load_dwordx4 v28, s[24:27], s56 offen sc1 lds
    v_mfma_f32_16x16x32_bf16 v[252:255], a[192:195], a[172:175], v[252:255]
    s_waitcnt lgkmcnt(4)
    v_readlane_b32 s56, v23, 3
    v_cvt_pk_bf16_f32 v196, v196, v197
    v_mfma_f32_16x16x32_bf16 v[252:255], a[200:203], a[12:15], v[252:255]
    s_add_u32 m0, s37, 3072
    ds_read_b64_tr_b16 a[192:193], v11 offset:57344
    v_cvt_pk_bf16_f32 v197, v198, v199
    v_mfma_f32_16x16x32_bf16 v[252:255], a[204:207], a[28:31], v[252:255]
    s_bitcmp1_b32 s69, 3
    s_cselect_b32 s56, s56, 0x70000000
    s_cselect_b32 m0, m0, 0x30000
    ds_read_b64_tr_b16 a[194:195], v11 offset:59392
    v_mfma_f32_16x16x32_bf16 v[244:247], a[204:207], a[24:27], v[244:247]
    buffer_store_dwordx4 v[148:151], v6, s[24:27], s55 offen sc1
    v_mfma_f32_16x16x32_bf16 v[244:247], a[200:203], a[8:11], v[244:247]
    s_xor_b32 s55, s55, 1024
    v_cvt_pk_bf16_f32 v204, v204, v205
    v_cvt_pk_bf16_f32 v205, v206, v207
    v_mfma_f32_16x16x32_bf16 v[236:239], a[200:203], a[4:7], v[236:239]
    ds_read_b64_tr_b16 a[196:197], v11 offset:61440
    v_cvt_pk_bf16_f32 v212, v212, v213
    v_mfma_f32_16x16x32_bf16 v[236:239], a[204:207], a[20:23], v[236:239]
    s_waitcnt vmcnt(17)
    ds_read_b64_tr_b16 a[198:199], v11 offset:63488
    v_cvt_pk_bf16_f32 v213, v214, v215
    v_mfma_f32_16x16x32_bf16 v[228:231], a[204:207], a[16:19], v[228:231]
    s_barrier
    v_mfma_f32_16x16x32_bf16 v[228:231], a[200:203], a[0:3], v[228:231]
    s_waitcnt lgkmcnt(4)
    buffer_load_dwordx4 v28, s[24:27], s56 offen sc1 lds
    v_mfma_f32_16x16x32_bf16 v[228:231], a[208:211], a[32:35], v[228:231]
    s_waitcnt vmcnt(9)
    ds_read_b64_tr_b16 a[200:201], v18 offset:0
    v_readlane_b32 s56, v23, 4
    v_mfma_f32_16x16x32_bf16 v[228:231], a[212:215], a[48:51], v[228:231]
    s_add_u32 m0, s37, 4096
    ds_read_b64_tr_b16 a[202:203], v18 offset:1024
    v_cvt_pk_bf16_f32 v220, v220, v221
    v_mfma_f32_16x16x32_bf16 v[236:239], a[212:215], a[52:55], v[236:239]
    buffer_atomic_or v128, v3, s[24:27], 0 offen offset:0
    v_mfma_f32_16x16x32_bf16 v[236:239], a[208:211], a[36:39], v[236:239]
    buffer_store_dwordx4 v[156:159], v6, s[24:27], s55 offen sc1
    v_mfma_f32_16x16x32_bf16 v[244:247], a[208:211], a[40:43], v[244:247]
    s_bitcmp1_b32 s69, 4
    s_cselect_b32 s56, s56, 0x70000000
    s_cselect_b32 m0, m0, 0x30000
    ds_read_b64_tr_b16 a[204:205], v18 offset:2048
    v_mfma_f32_16x16x32_bf16 v[244:247], a[212:215], a[56:59], v[244:247]
    s_xor_b32 s55, s55, 3072
    ds_read_b64_tr_b16 a[206:207], v18 offset:3072
    v_cvt_pk_bf16_f32 v221, v222, v223
    v_mfma_f32_16x16x32_bf16 v[252:255], a[212:215], a[60:63], v[252:255]
    s_add_u32 s55, s55, 16384
    v_rcp_f32 v30, v30
    v_mfma_f32_16x16x32_bf16 v[252:255], a[208:211], a[44:47], v[252:255]
    s_waitcnt lgkmcnt(4)
    buffer_load_dwordx4 v28, s[24:27], s56 offen sc1 lds
    v_mfma_f32_16x16x32_bf16 v[252:255], a[192:195], a[76:79], v[252:255]
    ds_read_b64_tr_b16 a[208:209], v18 offset:4096
    v_readlane_b32 s56, v23, 5
    v_mfma_f32_16x16x32_bf16 v[252:255], a[196:199], a[92:95], v[252:255]
    s_add_u32 m0, s37, 5120
    ds_read_b64_tr_b16 a[210:211], v18 offset:5120
    v_add_f32 v51, -0.5, v51
    v_mfma_f32_16x16x32_bf16 v[244:247], a[196:199], a[88:91], v[244:247]
    s_bitcmp1_b32 s69, 5
    s_cselect_b32 s56, s56, 0x70000000
    s_cselect_b32 m0, m0, 0x30000
    v_mfma_f32_16x16x32_bf16 v[244:247], a[192:195], a[72:75], v[244:247]
    buffer_load_dwordx4 v28, s[24:27], s56 offen sc1 lds
    v_mfma_f32_16x16x32_bf16 v[236:239], a[192:195], a[68:71], v[236:239]
    ds_read_b64_tr_b16 a[212:213], v18 offset:6144
    v_readlane_b32 s56, v23, 6
    v_mfma_f32_16x16x32_bf16 v[236:239], a[196:199], a[84:87], v[236:239]
    s_add_u32 m0, s37, 6144
    ds_read_b64_tr_b16 a[214:215], v18 offset:7168
    v_add_f32 v36, -0.5, v36
    v_add_f32 v37, -0.5, v37
    v_add_f32 v38, -0.5, v38
    v_add_f32 v39, -0.5, v39
    v_add_f32 v52, -0.5, v52
    v_add_f32 v53, -0.5, v53
    v_add_f32 v54, -0.5, v54
    v_add_f32 v55, -0.5, v55
    v_add_f32 v40, -0.5, v40
    v_add_f32 v41, -0.5, v41
    v_add_f32 v42, -0.5, v42
    v_add_f32 v43, -0.5, v43
    v_add_f32 v56, -0.5, v56
    v_add_f32 v57, -0.5, v57
    v_add_f32 v58, -0.5, v58
    v_add_f32 v59, -0.5, v59
    v_add_f32 v44, -0.5, v44
    v_add_f32 v45, -0.5, v45
    v_add_f32 v46, -0.5, v46
    v_add_f32 v47, -0.5, v47
    v_add_f32 v60, -0.5, v60
    v_add_f32 v61, -0.5, v61
    v_add_f32 v62, -0.5, v62
    v_add_f32 v63, -0.5, v63
    v_mfma_f32_16x16x32_bf16 v[228:231], a[196:199], a[80:83], v[228:231]
    s_bitcmp1_b32 s69, 6
    s_cselect_b32 s56, s56, 0x70000000
    s_cselect_b32 m0, m0, 0x30000
    v_mfma_f32_16x16x32_bf16 v[228:231], a[192:195], a[64:67], v[228:231]
    s_waitcnt lgkmcnt(4)
    buffer_load_dwordx4 v28, s[24:27], s56 offen sc1 lds
    v_mfma_f32_16x16x32_bf16 v[32:35], a[200:203], a[160:163], v[32:35]
    ds_read_b64_tr_b16 a[192:193], v18 offset:8192
    v_readlane_b32 s56, v23, 7
    v_mfma_f32_16x16x32_bf16 v[32:35], a[204:207], a[176:179], v[32:35]
    s_add_u32 m0, s37, 7168
    ds_read_b64_tr_b16 a[194:195], v18 offset:9216
    v_and_b32 v4, 0x300, v28
    v_mfma_f32_16x16x32_bf16 v[36:39], a[204:207], a[180:183], v[36:39]
    s_bitcmp1_b32 s69, 7
    s_cselect_b32 s56, s56, 0x70000000
    s_cselect_b32 m0, m0, 0x30000
    v_mfma_f32_16x16x32_bf16 v[36:39], a[200:203], a[164:167], v[36:39]
    buffer_load_dwordx4 v28, s[24:27], s56 offen sc1 lds
    v_mfma_f32_16x16x32_bf16 v[40:43], a[200:203], a[168:171], v[40:43]
    ds_read_b64_tr_b16 a[196:197], v18 offset:10240
    v_add3_u32 v4, v4, v28, s37
    v_mfma_f32_16x16x32_bf16 v[40:43], a[204:207], a[184:187], v[40:43]
    ds_read_b64_tr_b16 a[198:199], v18 offset:11264
    v_mfma_f32_16x16x32_bf16 v[44:47], a[204:207], a[188:191], v[44:47]
    v_cvt_pk_bf16_f32 v198, v228, v229
    v_cvt_pk_bf16_f32 v199, v230, v231
    v_mfma_f32_16x16x32_bf16 v[44:47], a[200:203], a[172:175], v[44:47]
    s_waitcnt lgkmcnt(4)
    v_cvt_pk_bf16_f32 v206, v236, v237
    v_cvt_pk_bf16_f32 v207, v238, v239
    v_mfma_f32_16x16x32_bf16 v[44:47], a[208:211], a[12:15], v[44:47]
    ds_read_b64_tr_b16 a[200:201], v18 offset:12288
    v_cvt_pk_bf16_f32 v214, v244, v245
    v_mfma_f32_16x16x32_bf16 v[44:47], a[212:215], a[28:31], v[44:47]
    ds_read_b64_tr_b16 a[202:203], v18 offset:13312
    v_cvt_pk_bf16_f32 v215, v246, v247
    v_mfma_f32_16x16x32_bf16 v[40:43], a[212:215], a[24:27], v[40:43]
    buffer_store_dwordx4 v[196:199], v6, s[24:27], s55 offen sc1
    v_mfma_f32_16x16x32_bf16 v[40:43], a[208:211], a[8:11], v[40:43]
    s_xor_b32 s55, s55, 1024
    v_cvt_pk_bf16_f32 v222, v252, v253
    v_cvt_pk_bf16_f32 v223, v254, v255
    v_mfma_f32_16x16x32_bf16 v[36:39], a[208:211], a[4:7], v[36:39]
    ds_read_b64_tr_b16 a[204:205], v18 offset:14336
    v_mfma_f32_16x16x32_bf16 v[36:39], a[212:215], a[20:23], v[36:39]
    ds_read_b64_tr_b16 a[206:207], v18 offset:15360
    v_mfma_f32_16x16x32_bf16 v[32:35], a[212:215], a[16:19], v[32:35]
    v_rcp_f32 v31, v31
    v_mfma_f32_16x16x32_bf16 v[32:35], a[208:211], a[0:3], v[32:35]
    s_waitcnt lgkmcnt(4)
    v_mul_f32 v26, v26, v30
    v_mul_f32 v27, v27, v31
    v_mfma_f32_16x16x32_bf16 v[32:35], a[192:195], a[32:35], v[32:35]
    ds_read_b64_tr_b16 a[208:209], v19 offset:0
    v_cvt_pk_bf16_f32 v171, v26, v27
    v_mfma_f32_16x16x32_bf16 v[32:35], a[196:199], a[48:51], v[32:35]
    s_waitcnt vmcnt(30)
    ds_read_b64_tr_b16 a[210:211], v19 offset:1024
    v_lshlrev_b32 v26, 16, v160
    v_mfma_f32_16x16x32_bf16 v[36:39], a[196:199], a[52:55], v[36:39]
    buffer_store_dwordx4 v[204:207], v6, s[24:27], s55 offen sc1
    v_mfma_f32_16x16x32_bf16 v[36:39], a[192:195], a[36:39], v[36:39]
    s_xor_b32 s55, s55, 3072
    v_and_b32 v27, 0xffff0000, v160
    v_fma_f32 v26, v26, v25, v24
    v_mfma_f32_16x16x32_bf16 v[40:43], a[192:195], a[40:43], v[40:43]
    ds_read_b64_tr_b16 a[212:213], v19 offset:2048
    v_fma_f32 v27, v27, v25, v24
    v_mfma_f32_16x16x32_bf16 v[40:43], a[196:199], a[56:59], v[40:43]
    ds_read_b64_tr_b16 a[214:215], v19 offset:3072
    v_mul_f32 v30, s92, v26
    v_mfma_f32_16x16x32_bf16 v[44:47], a[196:199], a[60:63], v[44:47]
    v_mul_f32 v31, s92, v27
    v_mfma_f32_16x16x32_bf16 v[44:47], a[192:195], a[44:47], v[44:47]
    s_waitcnt lgkmcnt(4)
    v_exp_f32 v30, v30
    v_mfma_f32_16x16x32_bf16 v[44:47], a[200:203], a[76:79], v[44:47]
    ds_read_b64_tr_b16 a[192:193], v19 offset:4096
    v_mfma_f32_16x16x32_bf16 v[44:47], a[204:207], a[92:95], v[44:47]
    ds_read_b64_tr_b16 a[194:195], v19 offset:5120
    v_mfma_f32_16x16x32_bf16 v[40:43], a[204:207], a[88:91], v[40:43]
    s_waitcnt vmcnt(6)
    v_exp_f32 v31, v31
    v_mfma_f32_16x16x32_bf16 v[40:43], a[200:203], a[72:75], v[40:43]
pg_13:
    s_cbranch_execz pg_ret2
    buffer_atomic_or v129, v3, s[24:27], 0 offen offset:0
    v_mfma_f32_16x16x32_bf16 v[36:39], a[200:203], a[68:71], v[36:39]
    ds_read_b64_tr_b16 a[196:197], v19 offset:6144
    v_add_f32 v30, 1.0, v30
    v_mfma_f32_16x16x32_bf16 v[36:39], a[204:207], a[84:87], v[36:39]
    ds_read_b64_tr_b16 a[198:199], v19 offset:7168
    v_add_f32 v31, 1.0, v31
    v_mfma_f32_16x16x32_bf16 v[32:35], a[204:207], a[80:83], v[32:35]
    buffer_store_dwordx4 v[212:215], v6, s[24:27], s55 offen sc1
    v_mfma_f32_16x16x32_bf16 v[32:35], a[200:203], a[64:67], v[32:35]
    s_waitcnt lgkmcnt(4)
    v_rcp_f32 v30, v30
    v_mfma_f32_16x16x32_bf16 v[48:51], a[208:211], a[160:163], v[48:51]
    s_xor_b32 s55, s55, 1024
    ds_read_b64_tr_b16 a[200:201], v19 offset:8192
    v_mfma_f32_16x16x32_bf16 v[48:51], a[212:215], a[176:179], v[48:51]
    ds_read_b64_tr_b16 a[202:203], v19 offset:9216
    v_mfma_f32_16x16x32_bf16 v[52:55], a[212:215], a[180:183], v[52:55]
    v_rcp_f32 v31, v31
    v_mfma_f32_16x16x32_bf16 v[52:55], a[208:211], a[164:167], v[52:55]
    v_mul_f32 v26, v26, v30
    v_mul_f32 v27, v27, v31
    v_mfma_f32_16x16x32_bf16 v[56:59], a[208:211], a[168:171], v[56:59]
    ds_read_b64_tr_b16 a[204:205], v19 offset:10240
    v_cvt_pk_bf16_f32 v184, v26, v27
    v_mfma_f32_16x16x32_bf16 v[56:59], a[212:215], a[184:187], v[56:59]
    ds_read_b64_tr_b16 a[206:207], v19 offset:11264
    v_lshlrev_b32 v26, 16, v161
    v_mfma_f32_16x16x32_bf16 v[60:63], a[212:215], a[188:191], v[60:63]
    v_cvt_pk_bf16_f32 v32, v32, v33
    v_cvt_pk_bf16_f32 v33, v34, v35
    v_mfma_f32_16x16x32_bf16 v[60:63], a[208:211], a[172:175], v[60:63]
    s_waitcnt lgkmcnt(4)
    v_cvt_pk_bf16_f32 v36, v36, v37
    v_cvt_pk_bf16_f32 v37, v38, v39
    v_mfma_f32_16x16x32_bf16 v[60:63], a[192:195], a[12:15], v[60:63]
    ds_read_b64_tr_b16 a[208:209], v19 offset:12288
    v_cvt_pk_bf16_f32 v40, v40, v41
    v_mfma_f32_16x16x32_bf16 v[60:63], a[196:199], a[28:31], v[60:63]
    ds_read_b64_tr_b16 a[210:211], v19 offset:13312
    v_cvt_pk_bf16_f32 v41, v42, v43
    v_mfma_f32_16x16x32_bf16 v[56:59], a[196:199], a[24:27], v[56:59]
    buffer_store_dwordx4 v[220:223], v6, s[24:27], s55 offen sc1
    v_mfma_f32_16x16x32_bf16 v[56:59], a[192:195], a[8:11], v[56:59]
    s_xor_b32 s55, s55, 3072
    v_cvt_pk_bf16_f32 v44, v44, v45
    v_cvt_pk_bf16_f32 v45, v46, v47
    v_mfma_f32_16x16x32_bf16 v[52:55], a[192:195], a[4:7], v[52:55]
    s_add_u32 s55, s55, 16384
    ds_read_b64_tr_b16 a[212:213], v19 offset:14336
    v_and_b32 v27, 0xffff0000, v161
    v_mfma_f32_16x16x32_bf16 v[52:55], a[196:199], a[20:23], v[52:55]
    ds_read_b64_tr_b16 a[214:215], v19 offset:15360
    v_fma_f32 v26, v26, v25, v24
    v_mfma_f32_16x16x32_bf16 v[48:51], a[196:199], a[16:19], v[48:51]
    v_fma_f32 v27, v27, v25, v24
    v_mul_f32 v30, s92, v26
    v_mfma_f32_16x16x32_bf16 v[48:51], a[192:195], a[0:3], v[48:51]
    s_waitcnt lgkmcnt(4)
    v_mul_f32 v31, s92, v27
    v_mfma_f32_16x16x32_bf16 v[48:51], a[200:203], a[32:35], v[48:51]
    v_exp_f32 v30, v30
    v_mfma_f32_16x16x32_bf16 v[48:51], a[204:207], a[48:51], v[48:51]
    v_exp_f32 v31, v31
    v_mfma_f32_16x16x32_bf16 v[52:55], a[204:207], a[52:55], v[52:55]
    v_add_f32 v30, 1.0, v30
    v_add_f32 v31, 1.0, v31
    v_mfma_f32_16x16x32_bf16 v[52:55], a[200:203], a[36:39], v[52:55]
    v_rcp_f32 v30, v30
    v_mfma_f32_16x16x32_bf16 v[56:59], a[200:203], a[40:43], v[56:59]
    v_rcp_f32 v31, v31
    v_mfma_f32_16x16x32_bf16 v[56:59], a[204:207], a[56:59], v[56:59]
    v_mul_f32 v26, v26, v30
    v_mul_f32 v27, v27, v31
    v_mfma_f32_16x16x32_bf16 v[60:63], a[204:207], a[60:63], v[60:63]
    v_cvt_pk_bf16_f32 v185, v26, v27
    v_lshlrev_b32 v26, 16, v162
    v_mfma_f32_16x16x32_bf16 v[60:63], a[200:203], a[44:47], v[60:63]
    s_waitcnt lgkmcnt(0)
    v_and_b32 v27, 0xffff0000, v162
    v_fma_f32 v26, v26, v25, v24
    v_mfma_f32_16x16x32_bf16 v[60:63], a[208:211], a[76:79], v[60:63]
    s_load_dword s67, s[86:87], s5 glc
    v_fma_f32 v27, v27, v25, v24
    v_mul_f32 v30, s92, v26
    v_mfma_f32_16x16x32_bf16 v[60:63], a[212:215], a[92:95], v[60:63]
    v_mul_f32 v31, s92, v27
    v_mfma_f32_16x16x32_bf16 v[56:59], a[212:215], a[88:91], v[56:59]
    v_exp_f32 v30, v30
    v_mfma_f32_16x16x32_bf16 v[56:59], a[208:211], a[72:75], v[56:59]
    v_exp_f32 v31, v31
    v_mfma_f32_16x16x32_bf16 v[52:55], a[208:211], a[68:71], v[52:55]
    v_add_f32 v30, 1.0, v30
    v_add_f32 v31, 1.0, v31
    v_mfma_f32_16x16x32_bf16 v[52:55], a[212:215], a[84:87], v[52:55]
    v_rcp_f32 v30, v30
    v_mfma_f32_16x16x32_bf16 v[48:51], a[212:215], a[80:83], v[48:51]
    v_rcp_f32 v31, v31
    v_mfma_f32_16x16x32_bf16 v[48:51], a[208:211], a[64:67], v[48:51]
    v_mul_f32 v26, v26, v30
    v_mul_f32 v27, v27, v31
    s_nop 7
    v_cvt_pk_bf16_f32 v34, v48, v49
    v_cvt_pk_bf16_f32 v35, v50, v51
    buffer_store_dwordx4 v[32:35], v7, s[24:27], s55 offen sc1
    s_xor_b32 s55, s55, 1024
    v_cvt_pk_bf16_f32 v38, v52, v53
    v_cvt_pk_bf16_f32 v39, v54, v55
    buffer_store_dwordx4 v[36:39], v7, s[24:27], s55 offen sc1
    s_xor_b32 s55, s55, 3072
    v_cvt_pk_bf16_f32 v42, v56, v57
    v_cvt_pk_bf16_f32 v43, v58, v59
    buffer_store_dwordx4 v[40:43], v7, s[24:27], s55 offen sc1
    s_xor_b32 s55, s55, 1024
    v_cvt_pk_bf16_f32 v46, v60, v61
    v_cvt_pk_bf16_f32 v47, v62, v63
    buffer_store_dwordx4 v[44:47], v7, s[24:27], s55 offen sc1
    s_xor_b32 s55, s55, 3072
    s_add_u32 s55, s55, 16384
    v_cvt_pk_bf16_f32 v186, v26, v27
    v_lshlrev_b32 v26, 16, v163
    v_and_b32 v27, 0xffff0000, v163
    v_fma_f32 v26, v26, v25, v24
    v_fma_f32 v27, v27, v25, v24
    v_mul_f32 v30, s92, v26
    v_mul_f32 v31, s92, v27
    v_exp_f32 v30, v30
    v_exp_f32 v31, v31
    s_nop 0
    v_add_f32 v30, 1.0, v30
    v_add_f32 v31, 1.0, v31
    v_rcp_f32 v30, v30
    v_rcp_f32 v31, v31
    s_nop 0
    v_mul_f32 v26, v26, v30
    v_mul_f32 v27, v27, v31
    v_cvt_pk_bf16_f32 v187, v26, v27
    s_waitcnt vmcnt(37)
post_code:
    s_mov_b32 s8, 0xff
    s_bitcmp0_b32 s53, 0
    s_cselect_b32 s8, 0xffff, s8
    s_bitcmp0_b32 s53, 0
    s_cselect_b32 s60, 0, 0xff00
    s_mov_b32 s9, 1
    s_mov_b32 s55, s68
    s_waitcnt vmcnt(4)
    buffer_atomic_or v130, v3, s[24:27], 0 offen offset:0
    s_waitcnt lgkmcnt(0)
    s_andn2_b32 s69, s67, s68
    s_load_dword s67, s[86:87], s5 glc
    s_or_b32 s68, s68, s69
    s_and_b32 s8, s69, s8
    s_andn2_b32 s69, s69, s8
    s_cmp_lg_u32 s8, 0
    s_cbranch_scc0 e0_issued
e0_iss:
    s_ff1_i32_b32 s56, s8
    v_readlane_b32 s57, v23, s56
    s_lshl_b32 s39, s56, 10
    s_add_u32 m0, s37, s39
    s_bitset0_b32 s8, s56
    s_add_u32 s9, s9, 1
    s_cmp_lg_u32 s8, 0
    buffer_load_dwordx4 v28, s[24:27], s57 offen sc1 lds
    s_cbranch_scc1 e0_iss
e0_issued:
    s_bitcmp0_b32 s53, 0
    s_cbranch_scc0 gp_skip
    v_lshlrev_b32 v26, 16, v152
    v_and_b32 v27, 0xffff0000, v152
    v_fma_f32 v26, v26, v25, v24
    v_fma_f32 v27, v27, v25, v24
    v_mul_f32 v30, s92, v26
    v_mul_f32 v31, s92, v27
    v_exp_f32 v30, v30
    v_exp_f32 v31, v31
    s_nop 0
    v_add_f32 v30, 1.0, v30
    v_add_f32 v31, 1.0, v31
    v_rcp_f32 v30, v30
    v_rcp_f32 v31, v31
    s_nop 0
    v_mul_f32 v26, v26, v30
    v_mul_f32 v27, v27, v31
    v_cvt_pk_bf16_f32 v176, v26, v27
    v_lshlrev_b32 v26, 16, v153
    v_and_b32 v27, 0xffff0000, v153
    v_fma_f32 v26, v26, v25, v24
    v_fma_f32 v27, v27, v25, v24
    v_mul_f32 v30, s92, v26
    v_mul_f32 v31, s92, v27
    v_exp_f32 v30, v30
    v_exp_f32 v31, v31
    s_nop 0
    v_add_f32 v30, 1.0, v30
    v_add_f32 v31, 1.0, v31
    v_rcp_f32 v30, v30
    v_rcp_f32 v31, v31
    s_nop 0
    v_mul_f32 v26, v26, v30
    v_mul_f32 v27, v27, v31
    v_cvt_pk_bf16_f32 v177, v26, v27
    v_lshlrev_b32 v26, 16, v154
    v_and_b32 v27, 0xffff0000, v154
    v_fma_f32 v26, v26, v25, v24
    v_fma_f32 v27, v27, v25, v24
    v_mul_f32 v30, s92, v26
    v_mul_f32 v31, s92, v27
    v_exp_f32 v30, v30
    v_exp_f32 v31, v31
    s_nop 0
    v_add_f32 v30, 1.0, v30
    v_add_f32 v31, 1.0, v31
    v_rcp_f32 v30, v30
    v_rcp_f32 v31, v31
    s_nop 0
    v_mul_f32 v26, v26, v30
    v_mul_f32 v27, v27, v31
    v_cvt_pk_bf16_f32 v178, v26, v27
    v_lshlrev_b32 v26, 16, v155
    v_and_b32 v27, 0xffff0000, v155
    v_fma_f32 v26, v26, v25, v24
    v_fma_f32 v27, v27, v25, v24
    v_mul_f32 v30, s92, v26
    v_mul_f32 v31, s92, v27
    v_exp_f32 v30, v30
    v_exp_f32 v31, v31
    s_nop 0
    v_add_f32 v30, 1.0, v30
    v_add_f32 v31, 1.0, v31
    v_rcp_f32 v30, v30
    v_rcp_f32 v31, v31
    s_nop 0
    v_mul_f32 v26, v26, v30
    v_mul_f32 v27, v27, v31
    v_cvt_pk_bf16_f32 v179, v26, v27
gp_skip:
w4:
    s_getreg_b32 s56, hwreg(HW_REG_IB_STS)
    s_bfe_u32 s57, s56, 0x20016
    s_and_b32 s56, s56, 15
    s_lshl4_add_u32 s56, s57, s56
    s_cmp_gt_u32 s56, s9
    s_cbranch_scc1 w4
    buffer_atomic_or v130, v131, s[24:27], 0 offen offset:512
    s_mov_b32 s9, 1
    s_lshr_b32 s56, s53, 1
    s_cmp_eq_u32 s56, s3
    s_cbranch_scc0 own_share_ret
    s_lshl_b32 s56, s53, 10
    v_add_u32 v8, s56, v28
    v_add_u32 v11, 73728, v8
    v_add_u32 v10, 49152, v8
    v_add_u32 v9, 24576, v8
    v_add_u32 v8, 0, v8
    s_bitcmp1_b32 s53, 0
    s_cbranch_scc1 own_odd
    ds_write_b128 v8, v[196:199] offset:16384
    ds_write_b128 v9, v[204:207] offset:16384
    ds_write_b128 v10, v[212:215] offset:16384
    ds_write_b128 v11, v[220:223] offset:16384
    ds_write_b128 v8, v[132:135] offset:8192
    ds_write_b128 v9, v[140:143] offset:8192
    ds_write_b128 v10, v[148:151] offset:8192
    ds_write_b128 v11, v[156:159] offset:8192
    ds_write_b128 v8, v[68:71] offset:0
    ds_write_b128 v9, v[76:79] offset:0
    ds_write_b128 v10, v[84:87] offset:0
    ds_write_b128 v11, v[92:95] offset:0
    s_branch own_share_ret
own_odd:
    ds_write_b128 v8, v[32:35] offset:16384
    ds_write_b128 v9, v[36:39] offset:16384
    ds_write_b128 v10, v[40:43] offset:16384
    ds_write_b128 v11, v[44:47] offset:16384
    ds_write_b128 v8, v[64:67] offset:0
    ds_write_b128 v9, v[80:83] offset:0
    ds_write_b128 v10, v[96:99] offset:0
    ds_write_b128 v11, v[112:115] offset:0
own_share_ret:
    s_cmp_lg_u32 s69, 0
    s_cbranch_scc0 e1_issued
e1_iss:
    s_ff1_i32_b32 s56, s69
    v_readlane_b32 s57, v23, s56
    s_lshl_b32 s39, s56, 10
    s_add_u32 m0, s37, s39
    s_bitset0_b32 s69, s56
    s_mov_b32 s9, 0
    s_cmp_lg_u32 s69, 0
    buffer_load_dwordx4 v28, s[24:27], s57 offen sc1 lds
    s_cbranch_scc1 e1_iss
e1_issued:
    s_waitcnt lgkmcnt(0)
    s_barrier
    s_cmp_lg_u64 s[88:89], 0
    s_cbranch_scc1 routed
routed_ret:
ev_loop:
    s_waitcnt lgkmcnt(0)
    s_getreg_b32 s56, hwreg(HW_REG_IB_STS)
    s_bfe_u32 s57, s56, 0x20016
    s_and_b32 s56, s56, 15
    s_lshl4_add_u32 s56, s57, s56
    s_cmp_gt_u32 s56, s9
    s_cselect_b32 s55, s55, s68
    s_andn2_b32 s69, s67, s68
    s_or_b32 s68, s68, s69
    s_cmp_eq_u32 s68, 0xffffff
    s_cbranch_scc1 ev_nopoll
    s_load_dword s67, s[86:87], s5 glc
ev_nopoll:
    s_cmp_lg_u32 s69, 0
    s_cbranch_scc0 ev_issued
ev_iss:
    s_ff1_i32_b32 s56, s69
    v_readlane_b32 s57, v23, s56
    s_lshl_b32 s39, s56, 10
    s_add_u32 m0, s37, s39
    s_bitset0_b32 s69, s56
    s_mov_b32 s9, 0
    s_cmp_lg_u32 s69, 0
    buffer_load_dwordx4 v28, s[24:27], s57 offen sc1 lds
    s_cbranch_scc1 ev_iss
ev_issued:
ev_sel:
    s_andn2_b32 s8, s55, s60
    s_bfe_u32 s56, s8, 524288
    s_cmp_eq_u32 s56, 0xff
    s_cbranch_scc0 ev_r0
    s_or_b32 s60, s60, 255
    s_mov_b32 s38, s41
    ds_read_b128 v[132:135], v4 offset:0
    ds_read_b128 v[140:143], v4 offset:256
    ds_read_b128 v[148:151], v4 offset:2048
    ds_read_b128 v[156:159], v4 offset:2304
    ds_read_b128 v[164:167], v4 offset:4096
    ds_read_b128 v[172:175], v4 offset:4352
    ds_read_b128 v[180:183], v4 offset:6144
    ds_read_b128 v[188:191], v4 offset:6400
    v_lshlrev_b32 v84, 16, v168
    v_and_b32 v85, 0xffff0000, v168
    v_lshlrev_b32 v100, 16, v144
    v_and_b32 v101, 0xffff0000, v144
    v_lshlrev_b32 v86, 16, v169
    v_and_b32 v87, 0xffff0000, v169
    v_lshlrev_b32 v102, 16, v145
    v_and_b32 v103, 0xffff0000, v145
    v_lshlrev_b32 v92, 16, v170
    v_and_b32 v93, 0xffff0000, v170
    v_lshlrev_b32 v108, 16, v146
    v_and_b32 v109, 0xffff0000, v146
    v_lshlrev_b32 v94, 16, v171
    v_and_b32 v95, 0xffff0000, v171
    v_lshlrev_b32 v110, 16, v147
    v_and_b32 v111, 0xffff0000, v147
    s_branch ev_go
ev_r0:
    s_bfe_u32 s56, s8, 524296
    s_cmp_eq_u32 s56, 0xff
    s_cbranch_scc0 ev_r1
    s_or_b32 s60, s60, 65280
    s_mov_b32 s38, s42
    ds_read_b128 v[132:135], v4 offset:8192
    ds_read_b128 v[140:143], v4 offset:8448
    ds_read_b128 v[148:151], v4 offset:10240
    ds_read_b128 v[156:159], v4 offset:10496
    ds_read_b128 v[164:167], v4 offset:12288
    ds_read_b128 v[172:175], v4 offset:12544
    ds_read_b128 v[180:183], v4 offset:14336
    ds_read_b128 v[188:191], v4 offset:14592
    v_lshlrev_b32 v84, 16, v176
    v_and_b32 v85, 0xffff0000, v176
    v_lshlrev_b32 v100, 16, v152
    v_and_b32 v101, 0xffff0000, v152
    v_lshlrev_b32 v86, 16, v177
    v_and_b32 v87, 0xffff0000, v177
    v_lshlrev_b32 v102, 16, v153
    v_and_b32 v103, 0xffff0000, v153
    v_lshlrev_b32 v92, 16, v178
    v_and_b32 v93, 0xffff0000, v178
    v_lshlrev_b32 v108, 16, v154
    v_and_b32 v109, 0xffff0000, v154
    v_lshlrev_b32 v94, 16, v179
    v_and_b32 v95, 0xffff0000, v179
    v_lshlrev_b32 v110, 16, v155
    v_and_b32 v111, 0xffff0000, v155
    s_branch ev_go
ev_r1:
    s_bfe_u32 s56, s8, 524304
    s_cmp_eq_u32 s56, 0xff
    s_cbranch_scc0 ev_r2
    s_or_b32 s60, s60, 16711680
    s_mov_b32 s38, s43
    ds_read_b128 v[132:135], v4 offset:16384
    ds_read_b128 v[140:143], v4 offset:16640
    ds_read_b128 v[148:151], v4 offset:18432
    ds_read_b128 v[156:159], v4 offset:18688
    ds_read_b128 v[164:167], v4 offset:20480
    ds_read_b128 v[172:175], v4 offset:20736
    ds_read_b128 v[180:183], v4 offset:22528
    ds_read_b128 v[188:191], v4 offset:22784
    v_lshlrev_b32 v84, 16, v184
    v_and_b32 v85, 0xffff0000, v184
    v_lshlrev_b32 v100, 16, v160
    v_and_b32 v101, 0xffff0000, v160
    v_lshlrev_b32 v86, 16, v185
    v_and_b32 v87, 0xffff0000, v185
    v_lshlrev_b32 v102, 16, v161
    v_and_b32 v103, 0xffff0000, v161
    v_lshlrev_b32 v92, 16, v186
    v_and_b32 v93, 0xffff0000, v186
    v_lshlrev_b32 v108, 16, v162
    v_and_b32 v109, 0xffff0000, v162
    v_lshlrev_b32 v94, 16, v187
    v_and_b32 v95, 0xffff0000, v187
    v_lshlrev_b32 v110, 16, v163
    v_and_b32 v111, 0xffff0000, v163
    s_branch ev_go
ev_r2:
    s_cmp_eq_u32 s68, 0xffffff
    s_cbranch_scc0 ev_more
w5:
    s_getreg_b32 s56, hwreg(HW_REG_IB_STS)
    s_bfe_u32 s57, s56, 0x20016
    s_and_b32 s56, s56, 15
    s_lshl4_add_u32 s56, s57, s56
    s_cmp_gt_u32 s56, s9
    s_cbranch_scc1 w5
    s_mov_b32 s55, s68
    s_branch ev_sel
ev_more:
    s_add_u32 s101, s101, 1
    s_cmp_gt_u32 s101, 0x2000000
    s_cbranch_scc0 ev_loop
    s_branch ev_done
ev_go:
    s_waitcnt lgkmcnt(7)
    v_mfma_f32_16x16x32_bf16 v[68:71], v[208:211], v[132:135], 0
    s_waitcnt lgkmcnt(6)
    v_mfma_f32_16x16x32_bf16 v[76:79], v[208:211], v[140:143], 0
    s_waitcnt lgkmcnt(5)
    v_mfma_f32_16x16x32_bf16 v[68:71], v[208:211], v[148:151], v[68:71]
    s_waitcnt lgkmcnt(4)
    v_mfma_f32_16x16x32_bf16 v[76:79], v[208:211], v[156:159], v[76:79]
    s_waitcnt lgkmcnt(3)
    v_mfma_f32_16x16x32_bf16 v[68:71], v[208:211], v[164:167], v[68:71]
    s_waitcnt lgkmcnt(2)
    v_mfma_f32_16x16x32_bf16 v[76:79], v[208:211], v[172:175], v[76:79]
    s_waitcnt lgkmcnt(1)
    v_mfma_f32_16x16x32_bf16 v[68:71], v[208:211], v[180:183], v[68:71]
    s_waitcnt lgkmcnt(0)
    v_mfma_f32_16x16x32_bf16 v[76:79], v[208:211], v[188:191], v[76:79]
    s_nop 6
    v_pk_fma_f32 v[68:69], v[68:69], v[84:85], v[100:101]
    v_pk_fma_f32 v[70:71], v[70:71], v[86:87], v[102:103]
    v_pk_fma_f32 v[76:77], v[76:77], v[92:93], v[108:109]
    v_pk_fma_f32 v[78:79], v[78:79], v[94:95], v[110:111]
    v_cvt_pk_bf16_f32 v124, v68, v69
    v_cvt_pk_bf16_f32 v125, v70, v71
    v_cvt_pk_bf16_f32 v126, v76, v77
    v_cvt_pk_bf16_f32 v127, v78, v79
    buffer_store_dwordx4 v[124:127], v22, s[32:35], s38 offen sc1
    s_add_u32 s9, s9, 1
    s_cmp_lg_u32 s60, 0xffffff
    s_cbranch_scc1 ev_sel
ev_done:
    s_or_b32 s56, s2, s3
    s_cbranch_scc1 main_fin
    v_mov_b32 v8, s7
    v_mov_b32 v9, 3203072
    s_mov_b64 exec, 1
    buffer_store_dword v8, v9, s[24:27], 0 offen
main_fin:
main_end:
    s_endpgm
spin_o0:
    s_load_dword s72, s[86:87], s5 offset:4 glc
    s_add_u32 s101, s101, 1
    s_cmp_gt_u32 s101, 0x2000000
    s_waitcnt lgkmcnt(0)
    s_cbranch_scc1 spin_o0_ret
    s_bfe_u32 s88, s72, 262144
    s_cmp_lg_u32 s88, 15
    s_cbranch_scc1 spin_o0
    s_branch spin_o0_ret
spin_o1:
    s_load_dword s72, s[86:87], s5 offset:4 glc
    s_add_u32 s101, s101, 1
    s_cmp_gt_u32 s101, 0x2000000
    s_waitcnt lgkmcnt(0)
    s_cbranch_scc1 spin_o1_ret
    s_bfe_u32 s88, s72, 262148
    s_cmp_lg_u32 s88, 15
    s_cbranch_scc1 spin_o1
    s_branch spin_o1_ret
spin_o2:
    s_load_dword s72, s[86:87], s5 offset:4 glc
    s_add_u32 s101, s101, 1
    s_cmp_gt_u32 s101, 0x2000000
    s_waitcnt lgkmcnt(0)
    s_cbranch_scc1 spin_o2_ret
    s_bfe_u32 s88, s72, 262152
    s_cmp_lg_u32 s88, 15
    s_cbranch_scc1 spin_o2
    s_branch spin_o2_ret
spin_o3:
    s_load_dword s72, s[86:87], s5 offset:4 glc
    s_add_u32 s101, s101, 1
    s_cmp_gt_u32 s101, 0x2000000
    s_waitcnt lgkmcnt(0)
    s_cbranch_scc1 spin_o3_ret
    s_bfe_u32 s88, s72, 262156
    s_cmp_lg_u32 s88, 15
    s_cbranch_scc1 spin_o3
    s_branch spin_o3_ret
spin_o4:
    s_load_dword s72, s[86:87], s5 offset:4 glc
    s_add_u32 s101, s101, 1
    s_cmp_gt_u32 s101, 0x2000000
    s_waitcnt lgkmcnt(0)
    s_cbranch_scc1 spin_o4_ret
    s_bfe_u32 s88, s72, 262160
    s_cmp_lg_u32 s88, 15
    s_cbranch_scc1 spin_o4
    s_branch spin_o4_ret
spin_o5:
    s_load_dword s72, s[86:87], s5 offset:4 glc
    s_add_u32 s101, s101, 1
    s_cmp_gt_u32 s101, 0x2000000
    s_waitcnt lgkmcnt(0)
    s_cbranch_scc1 spin_o5_ret
    s_bfe_u32 s88, s72, 262164
    s_cmp_lg_u32 s88, 15
    s_cbranch_scc1 spin_o5
    s_branch spin_o5_ret
routed:
    s_cmp_eq_u32 s44, s59
    s_cbranch_scc0 spin_y
spin_y_ret:
    v_cvt_pk_bf16_f32 v200, v240, v241
    v_cvt_pk_bf16_f32 v201, v242, v243
    v_lshlrev_b32 v240, 16, v200
    v_and_b32 v241, 0xffff0000, v200
    v_lshlrev_b32 v242, 16, v201
    v_and_b32 v243, 0xffff0000, v201
    v_mul_f32 v240, v240, v195
    v_mul_f32 v241, v241, v195
    v_mul_f32 v242, v242, v195
    v_mul_f32 v243, v243, v195
    v_cvt_pk_bf16_f32 v200, v240, v241
    v_cvt_pk_bf16_f32 v201, v242, v243
    v_lshlrev_b32 v240, 16, v200
    v_and_b32 v241, 0xffff0000, v200
    v_lshlrev_b32 v242, 16, v201
    v_and_b32 v243, 0xffff0000, v201
    v_add_f32 v240, v240, v248
    v_add_f32 v241, v241, v249
    v_add_f32 v242, v242, v250
    v_add_f32 v243, v243, v251
    v_cvt_pk_bf16_f32 v200, v240, v241
    v_cvt_pk_bf16_f32 v201, v242, v243
    v_lshlrev_b32 v240, 16, v200
    v_and_b32 v241, 0xffff0000, v200
    v_lshlrev_b32 v242, 16, v201
    v_and_b32 v243, 0xffff0000, v201
    v_mul_f32 v200, s92, v240
    v_mul_f32 v201, s92, v241
    v_mul_f32 v202, s92, v242
    v_mul_f32 v203, s92, v243
    v_exp_f32 v200, v200
    v_exp_f32 v201, v201
    v_exp_f32 v202, v202
    v_exp_f32 v203, v203
    v_add_f32 v200, 1.0, v200
    v_add_f32 v201, 1.0, v201
    v_add_f32 v202, 1.0, v202
    v_add_f32 v203, 1.0, v203
    v_rcp_f32 v200, v200
    v_rcp_f32 v201, v201
    v_rcp_f32 v202, v202
    v_rcp_f32 v203, v203
    v_mul_f32 v240, v240, v200
    v_mul_f32 v241, v241, v201
    v_mul_f32 v242, v242, v202
    v_mul_f32 v243, v243, v203
    v_cvt_pk_bf16_f32 v240, v240, v241
    v_cvt_pk_bf16_f32 v241, v242, v243
    ds_write_b64 v138, v[240:241]
    s_mov_b64 exec, s[88:89]
    ds_read_b128 v[168:171], v139 offset:0
    ds_read_b128 v[176:179], v139 offset:64
    ds_read_b128 v[184:187], v139 offset:128
    s_waitcnt lgkmcnt(0)
    s_mov_b64 exec, -1
    s_branch routed_ret
spin_y:
    s_add_u32 s101, s101, 1
    s_cmp_gt_u32 s101, 0x2000000
    s_cbranch_scc1 spin_y_x
    buffer_load_dword v137, v136, s[24:27], s59 offen offset:128 sc1
    s_waitcnt vmcnt(0)
    v_cmp_ne_u32 vcc, 24, v137
    s_cbranch_vccnz spin_y
spin_y_x:
    buffer_load_dwordx4 v[240:243], v192, s[24:27], s59 offen sc1
    s_waitcnt vmcnt(0)
    s_branch spin_y_ret
spin_rec:
    s_add_u32 s101, s101, 1
    s_cmp_gt_u32 s101, 0x2000000
    s_cbranch_scc1 spin_rec_x
    buffer_load_dwordx4 v[32:35], v17, s[24:27], s47 offen offset:0 sc1
    buffer_load_dwordx4 v[36:39], v17, s[24:27], s47 offen offset:1024 sc1
    buffer_load_dwordx4 v[40:43], v17, s[24:27], s47 offen offset:2048 sc1
    buffer_load_dwordx4 v[44:47], v17, s[24:27], s47 offen offset:3072 sc1
    s_waitcnt vmcnt(0)
    v_xor_b32 v34, s7, v34
    v_xor_b32 v38, s7, v38
    v_xor_b32 v42, s7, v42
    v_xor_b32 v46, s7, v46
    v_or3_b32 v34, v34, v38, v42
    v_or_b32 v34, v34, v46
    v_cmp_ne_u32 vcc, 0, v34
    s_cbranch_vccnz spin_rec
spin_rec_x:
    s_branch spin_rec_ret
spin_gu:
    s_add_u32 s101, s101, 1
    s_cmp_gt_u32 s101, 0x2000000
    s_cbranch_scc1 spin_gu_x
    buffer_load_dword v61, v60, s[24:27], s37 offen sc1
    s_waitcnt vmcnt(0)
    v_cmp_ne_u32 vcc, s7, v61
    s_cbranch_vccnz spin_gu
spin_gu_x:
    s_branch spin_gu_ret
rare_p:
    s_nop 7
    s_nop 7
    v_max3_f32 v56, v68, v69, v70
    v_max3_f32 v56, v56, v71, v100
    v_max3_f32 v56, v56, v101, v102
    v_max3_f32 v56, v56, v103, v56
    v_mov_b32 v58, v56
    s_nop 1
    v_permlane16_swap_b32 v56, v58
    s_nop 1
    v_max_f32 v56, v56, v58
    v_mov_b32 v58, v56
    s_nop 1
    v_permlane32_swap_b32 v56, v58
    s_nop 1
    v_max_f32 v56, v56, v58
    v_add_f32 v56, 2.0, v56
    v_sub_f32 v32, v32, v56
    v_sub_f32 v33, v33, v56
    v_sub_f32 v34, v34, v56
    v_sub_f32 v35, v35, v56
    v_sub_f32 v68, v68, v56
    v_sub_f32 v69, v69, v56
    v_sub_f32 v70, v70, v56
    v_sub_f32 v71, v71, v56
    v_sub_f32 v100, v100, v56
    v_sub_f32 v101, v101, v56
    v_sub_f32 v102, v102, v56
    v_sub_f32 v103, v103, v56
    v_sub_f32 v132, v132, v56
    v_sub_f32 v133, v133, v56
    v_sub_f32 v134, v134, v56
    v_sub_f32 v135, v135, v56
    v_sub_f32 v164, v164, v56
    v_sub_f32 v165, v165, v56
    v_sub_f32 v166, v166, v56
    v_sub_f32 v167, v167, v56
    v_exp_f32 v48, v68
    v_exp_f32 v49, v69
    v_exp_f32 v50, v70
    v_exp_f32 v51, v71
    v_exp_f32 v52, v100
    v_exp_f32 v53, v101
    v_exp_f32 v54, v102
    v_exp_f32 v55, v103
    s_nop 0
    v_cvt_pk_bf16_f32 v196, v48, v49
    v_cvt_pk_bf16_f32 v197, v50, v51
    v_cvt_pk_bf16_f32 v198, v52, v53
    v_cvt_pk_bf16_f32 v199, v54, v55
    v_add_f32 v24, v48, v49
    v_add_f32 v24, v24, v50
    v_add_f32 v24, v24, v51
    v_add_f32 v24, v24, v52
    v_add_f32 v24, v24, v53
    v_add_f32 v24, v24, v54
    v_add_f32 v24, v24, v55
    v_max3_f32 v56, v76, v77, v78
    v_max3_f32 v56, v56, v79, v108
    v_max3_f32 v56, v56, v109, v110
    v_max3_f32 v56, v56, v111, v56
    v_mov_b32 v58, v56
    s_nop 1
    v_permlane16_swap_b32 v56, v58
    s_nop 1
    v_max_f32 v56, v56, v58
    v_mov_b32 v58, v56
    s_nop 1
    v_permlane32_swap_b32 v56, v58
    s_nop 1
    v_max_f32 v56, v56, v58
    v_add_f32 v56, 2.0, v56
    v_sub_f32 v36, v36, v56
    v_sub_f32 v37, v37, v56
    v_sub_f32 v38, v38, v56
    v_sub_f32 v39, v39, v56
    v_sub_f32 v76, v76, v56
    v_sub_f32 v77, v77, v56
    v_sub_f32 v78, v78, v56
    v_sub_f32 v79, v79, v56
    v_sub_f32 v108, v108, v56
    v_sub_f32 v109, v109, v56
    v_sub_f32 v110, v110, v56
    v_sub_f32 v111, v111, v56
    v_sub_f32 v140, v140, v56
    v_sub_f32 v141, v141, v56
    v_sub_f32 v142, v142, v56
    v_sub_f32 v143, v143, v56
    v_sub_f32 v172, v172, v56
    v_sub_f32 v173, v173, v56
    v_sub_f32 v174, v174, v56
    v_sub_f32 v175, v175, v56
    v_exp_f32 v48, v76
    v_exp_f32 v49, v77
    v_exp_f32 v50, v78
    v_exp_f32 v51, v79
    v_exp_f32 v52, v108
    v_exp_f32 v53, v109
    v_exp_f32 v54, v110
    v_exp_f32 v55, v111
    s_nop 0
    v_cvt_pk_bf16_f32 v204, v48, v49
    v_cvt_pk_bf16_f32 v205, v50, v51
    v_cvt_pk_bf16_f32 v206, v52, v53
    v_cvt_pk_bf16_f32 v207, v54, v55
    v_add_f32 v25, v48, v49
    v_add_f32 v25, v25, v50
    v_add_f32 v25, v25, v51
    v_add_f32 v25, v25, v52
    v_add_f32 v25, v25, v53
    v_add_f32 v25, v25, v54
    v_add_f32 v25, v25, v55
    v_max3_f32 v56, v84, v85, v86
    v_max3_f32 v56, v56, v87, v116
    v_max3_f32 v56, v56, v117, v118
    v_max3_f32 v56, v56, v119, v56
    v_mov_b32 v58, v56
    s_nop 1
    v_permlane16_swap_b32 v56, v58
    s_nop 1
    v_max_f32 v56, v56, v58
    v_mov_b32 v58, v56
    s_nop 1
    v_permlane32_swap_b32 v56, v58
    s_nop 1
    v_max_f32 v56, v56, v58
    v_add_f32 v56, 2.0, v56
    v_sub_f32 v40, v40, v56
    v_sub_f32 v41, v41, v56
    v_sub_f32 v42, v42, v56
    v_sub_f32 v43, v43, v56
    v_sub_f32 v84, v84, v56
    v_sub_f32 v85, v85, v56
    v_sub_f32 v86, v86, v56
    v_sub_f32 v87, v87, v56
    v_sub_f32 v116, v116, v56
    v_sub_f32 v117, v117, v56
    v_sub_f32 v118, v118, v56
    v_sub_f32 v119, v119, v56
    v_sub_f32 v148, v148, v56
    v_sub_f32 v149, v149, v56
    v_sub_f32 v150, v150, v56
    v_sub_f32 v151, v151, v56
    v_sub_f32 v180, v180, v56
    v_sub_f32 v181, v181, v56
    v_sub_f32 v182, v182, v56
    v_sub_f32 v183, v183, v56
    v_exp_f32 v48, v84
    v_exp_f32 v49, v85
    v_exp_f32 v50, v86
    v_exp_f32 v51, v87
    v_exp_f32 v52, v116
    v_exp_f32 v53, v117
    v_exp_f32 v54, v118
    v_exp_f32 v55, v119
    s_nop 0
    v_cvt_pk_bf16_f32 v212, v48, v49
    v_cvt_pk_bf16_f32 v213, v50, v51
    v_cvt_pk_bf16_f32 v214, v52, v53
    v_cvt_pk_bf16_f32 v215, v54, v55
    v_add_f32 v26, v48, v49
    v_add_f32 v26, v26, v50
    v_add_f32 v26, v26, v51
    v_add_f32 v26, v26, v52
    v_add_f32 v26, v26, v53
    v_add_f32 v26, v26, v54
    v_add_f32 v26, v26, v55
    v_max3_f32 v56, v92, v93, v94
    v_max3_f32 v56, v56, v95, v124
    v_max3_f32 v56, v56, v125, v126
    v_max3_f32 v56, v56, v127, v56
    v_mov_b32 v58, v56
    s_nop 1
    v_permlane16_swap_b32 v56, v58
    s_nop 1
    v_max_f32 v56, v56, v58
    v_mov_b32 v58, v56
    s_nop 1
    v_permlane32_swap_b32 v56, v58
    s_nop 1
    v_max_f32 v56, v56, v58
    v_add_f32 v56, 2.0, v56
    v_sub_f32 v44, v44, v56
    v_sub_f32 v45, v45, v56
    v_sub_f32 v46, v46, v56
    v_sub_f32 v47, v47, v56
    v_sub_f32 v92, v92, v56
    v_sub_f32 v93, v93, v56
    v_sub_f32 v94, v94, v56
    v_sub_f32 v95, v95, v56
    v_sub_f32 v124, v124, v56
    v_sub_f32 v125, v125, v56
    v_sub_f32 v126, v126, v56
    v_sub_f32 v127, v127, v56
    v_sub_f32 v156, v156, v56
    v_sub_f32 v157, v157, v56
    v_sub_f32 v158, v158, v56
    v_sub_f32 v159, v159, v56
    v_sub_f32 v188, v188, v56
    v_sub_f32 v189, v189, v56
    v_sub_f32 v190, v190, v56
    v_sub_f32 v191, v191, v56
    v_exp_f32 v48, v92
    v_exp_f32 v49, v93
    v_exp_f32 v50, v94
    v_exp_f32 v51, v95
    v_exp_f32 v52, v124
    v_exp_f32 v53, v125
    v_exp_f32 v54, v126
    v_exp_f32 v55, v127
    s_nop 0
    v_cvt_pk_bf16_f32 v220, v48, v49
    v_cvt_pk_bf16_f32 v221, v50, v51
    v_cvt_pk_bf16_f32 v222, v52, v53
    v_cvt_pk_bf16_f32 v223, v54, v55
    v_add_f32 v27, v48, v49
    v_add_f32 v27, v27, v50
    v_add_f32 v27, v27, v51
    v_add_f32 v27, v27, v52
    v_add_f32 v27, v27, v53
    v_add_f32 v27, v27, v54
    v_add_f32 v27, v27, v55
    s_nop 1
    s_branch rare_p_ret
rare_a:
    s_nop 7
    s_nop 7
    v_max3_f32 v56, v132, v133, v134
    v_max3_f32 v56, v56, v135, v164
    v_max3_f32 v56, v56, v165, v166
    v_max3_f32 v56, v56, v167, 0
    v_mov_b32 v58, v56
    s_nop 1
    v_permlane16_swap_b32 v56, v58
    s_nop 1
    v_max_f32 v56, v56, v58
    v_mov_b32 v58, v56
    s_nop 1
    v_permlane32_swap_b32 v56, v58
    s_nop 1
    v_max_f32 v56, v56, v58
    v_exp_f32 v57, -v56
    v_sub_f32 v32, v32, v56
    v_sub_f32 v33, v33, v56
    v_sub_f32 v34, v34, v56
    v_sub_f32 v35, v35, v56
    v_mul_f32 v20, v20, v57
    v_sub_f32 v58, 1.0, v57
    v_sub_f32 v132, v132, v56
    v_sub_f32 v133, v133, v56
    v_sub_f32 v134, v134, v56
    v_sub_f32 v135, v135, v56
    v_sub_f32 v164, v164, v56
    v_sub_f32 v165, v165, v56
    v_sub_f32 v166, v166, v56
    v_sub_f32 v167, v167, v56
    v_sub_f32 v68, v68, v56
    v_sub_f32 v69, v69, v56
    v_sub_f32 v70, v70, v56
    v_sub_f32 v71, v71, v56
    v_sub_f32 v100, v100, v56
    v_sub_f32 v101, v101, v56
    v_sub_f32 v102, v102, v56
    v_sub_f32 v103, v103, v56
    v_accvgpr_read_b32 v48, a0
    v_accvgpr_read_b32 v49, a1
    v_accvgpr_read_b32 v50, a2
    v_accvgpr_read_b32 v51, a3
    v_fma_f32 v48, v48, v57, v58
    v_fma_f32 v49, v49, v57, v58
    v_fma_f32 v50, v50, v57, v58
    v_fma_f32 v51, v51, v57, v58
    v_accvgpr_write_b32 a0, v48
    v_accvgpr_write_b32 a1, v49
    v_accvgpr_write_b32 a2, v50
    v_accvgpr_write_b32 a3, v51
    v_accvgpr_read_b32 v48, a16
    v_accvgpr_read_b32 v49, a17
    v_accvgpr_read_b32 v50, a18
    v_accvgpr_read_b32 v51, a19
    v_fma_f32 v48, v48, v57, v58
    v_fma_f32 v49, v49, v57, v58
    v_fma_f32 v50, v50, v57, v58
    v_fma_f32 v51, v51, v57, v58
    v_accvgpr_write_b32 a16, v48
    v_accvgpr_write_b32 a17, v49
    v_accvgpr_write_b32 a18, v50
    v_accvgpr_write_b32 a19, v51
    v_accvgpr_read_b32 v48, a32
    v_accvgpr_read_b32 v49, a33
    v_accvgpr_read_b32 v50, a34
    v_accvgpr_read_b32 v51, a35
    v_fma_f32 v48, v48, v57, v58
    v_fma_f32 v49, v49, v57, v58
    v_fma_f32 v50, v50, v57, v58
    v_fma_f32 v51, v51, v57, v58
    v_accvgpr_write_b32 a32, v48
    v_accvgpr_write_b32 a33, v49
    v_accvgpr_write_b32 a34, v50
    v_accvgpr_write_b32 a35, v51
    v_accvgpr_read_b32 v48, a48
    v_accvgpr_read_b32 v49, a49
    v_accvgpr_read_b32 v50, a50
    v_accvgpr_read_b32 v51, a51
    v_fma_f32 v48, v48, v57, v58
    v_fma_f32 v49, v49, v57, v58
    v_fma_f32 v50, v50, v57, v58
    v_fma_f32 v51, v51, v57, v58
    v_accvgpr_write_b32 a48, v48
    v_accvgpr_write_b32 a49, v49
    v_accvgpr_write_b32 a50, v50
    v_accvgpr_write_b32 a51, v51
    v_accvgpr_read_b32 v48, a64
    v_accvgpr_read_b32 v49, a65
    v_accvgpr_read_b32 v50, a66
    v_accvgpr_read_b32 v51, a67
    v_fma_f32 v48, v48, v57, v58
    v_fma_f32 v49, v49, v57, v58
    v_fma_f32 v50, v50, v57, v58
    v_fma_f32 v51, v51, v57, v58
    v_accvgpr_write_b32 a64, v48
    v_accvgpr_write_b32 a65, v49
    v_accvgpr_write_b32 a66, v50
    v_accvgpr_write_b32 a67, v51
    v_accvgpr_read_b32 v48, a80
    v_accvgpr_read_b32 v49, a81
    v_accvgpr_read_b32 v50, a82
    v_accvgpr_read_b32 v51, a83
    v_fma_f32 v48, v48, v57, v58
    v_fma_f32 v49, v49, v57, v58
    v_fma_f32 v50, v50, v57, v58
    v_fma_f32 v51, v51, v57, v58
    v_accvgpr_write_b32 a80, v48
    v_accvgpr_write_b32 a81, v49
    v_accvgpr_write_b32 a82, v50
    v_accvgpr_write_b32 a83, v51
    v_accvgpr_read_b32 v48, a96
    v_accvgpr_read_b32 v49, a97
    v_accvgpr_read_b32 v50, a98
    v_accvgpr_read_b32 v51, a99
    v_fma_f32 v48, v48, v57, v58
    v_fma_f32 v49, v49, v57, v58
    v_fma_f32 v50, v50, v57, v58
    v_fma_f32 v51, v51, v57, v58
    v_accvgpr_write_b32 a96, v48
    v_accvgpr_write_b32 a97, v49
    v_accvgpr_write_b32 a98, v50
    v_accvgpr_write_b32 a99, v51
    v_accvgpr_read_b32 v48, a112
    v_accvgpr_read_b32 v49, a113
    v_accvgpr_read_b32 v50, a114
    v_accvgpr_read_b32 v51, a115
    v_fma_f32 v48, v48, v57, v58
    v_fma_f32 v49, v49, v57, v58
    v_fma_f32 v50, v50, v57, v58
    v_fma_f32 v51, v51, v57, v58
    v_accvgpr_write_b32 a112, v48
    v_accvgpr_write_b32 a113, v49
    v_accvgpr_write_b32 a114, v50
    v_accvgpr_write_b32 a115, v51
    v_accvgpr_read_b32 v48, a128
    v_accvgpr_read_b32 v49, a129
    v_accvgpr_read_b32 v50, a130
    v_accvgpr_read_b32 v51, a131
    v_fma_f32 v48, v48, v57, v58
    v_fma_f32 v49, v49, v57, v58
    v_fma_f32 v50, v50, v57, v58
    v_fma_f32 v51, v51, v57, v58
    v_accvgpr_write_b32 a128, v48
    v_accvgpr_write_b32 a129, v49
    v_accvgpr_write_b32 a130, v50
    v_accvgpr_write_b32 a131, v51
    v_accvgpr_read_b32 v48, a144
    v_accvgpr_read_b32 v49, a145
    v_accvgpr_read_b32 v50, a146
    v_accvgpr_read_b32 v51, a147
    v_fma_f32 v48, v48, v57, v58
    v_fma_f32 v49, v49, v57, v58
    v_fma_f32 v50, v50, v57, v58
    v_fma_f32 v51, v51, v57, v58
    v_accvgpr_write_b32 a144, v48
    v_accvgpr_write_b32 a145, v49
    v_accvgpr_write_b32 a146, v50
    v_accvgpr_write_b32 a147, v51
    v_accvgpr_read_b32 v48, a160
    v_accvgpr_read_b32 v49, a161
    v_accvgpr_read_b32 v50, a162
    v_accvgpr_read_b32 v51, a163
    v_fma_f32 v48, v48, v57, v58
    v_fma_f32 v49, v49, v57, v58
    v_fma_f32 v50, v50, v57, v58
    v_fma_f32 v51, v51, v57, v58
    v_accvgpr_write_b32 a160, v48
    v_accvgpr_write_b32 a161, v49
    v_accvgpr_write_b32 a162, v50
    v_accvgpr_write_b32 a163, v51
    v_accvgpr_read_b32 v48, a176
    v_accvgpr_read_b32 v49, a177
    v_accvgpr_read_b32 v50, a178
    v_accvgpr_read_b32 v51, a179
    v_fma_f32 v48, v48, v57, v58
    v_fma_f32 v49, v49, v57, v58
    v_fma_f32 v50, v50, v57, v58
    v_fma_f32 v51, v51, v57, v58
    v_accvgpr_write_b32 a176, v48
    v_accvgpr_write_b32 a177, v49
    v_accvgpr_write_b32 a178, v50
    v_accvgpr_write_b32 a179, v51
    v_exp_f32 v48, v132
    v_exp_f32 v49, v133
    v_exp_f32 v50, v134
    v_exp_f32 v51, v135
    v_exp_f32 v52, v164
    v_exp_f32 v53, v165
    v_exp_f32 v54, v166
    v_exp_f32 v55, v167
    s_nop 0
    v_cvt_pk_bf16_f32 v228, v48, v49
    v_cvt_pk_bf16_f32 v229, v50, v51
    v_cvt_pk_bf16_f32 v230, v52, v53
    v_cvt_pk_bf16_f32 v231, v54, v55
    v_add_f32 v24, v48, v49
    v_add_f32 v24, v24, v50
    v_add_f32 v24, v24, v51
    v_add_f32 v24, v24, v52
    v_add_f32 v24, v24, v53
    v_add_f32 v24, v24, v54
    v_add_f32 v24, v24, v55
    v_max3_f32 v56, v140, v141, v142
    v_max3_f32 v56, v56, v143, v172
    v_max3_f32 v56, v56, v173, v174
    v_max3_f32 v56, v56, v175, 0
    v_mov_b32 v58, v56
    s_nop 1
    v_permlane16_swap_b32 v56, v58
    s_nop 1
    v_max_f32 v56, v56, v58
    v_mov_b32 v58, v56
    s_nop 1
    v_permlane32_swap_b32 v56, v58
    s_nop 1
    v_max_f32 v56, v56, v58
    v_exp_f32 v57, -v56
    v_sub_f32 v36, v36, v56
    v_sub_f32 v37, v37, v56
    v_sub_f32 v38, v38, v56
    v_sub_f32 v39, v39, v56
    v_mul_f32 v21, v21, v57
    v_sub_f32 v58, 1.0, v57
    v_sub_f32 v140, v140, v56
    v_sub_f32 v141, v141, v56
    v_sub_f32 v142, v142, v56
    v_sub_f32 v143, v143, v56
    v_sub_f32 v172, v172, v56
    v_sub_f32 v173, v173, v56
    v_sub_f32 v174, v174, v56
    v_sub_f32 v175, v175, v56
    v_sub_f32 v76, v76, v56
    v_sub_f32 v77, v77, v56
    v_sub_f32 v78, v78, v56
    v_sub_f32 v79, v79, v56
    v_sub_f32 v108, v108, v56
    v_sub_f32 v109, v109, v56
    v_sub_f32 v110, v110, v56
    v_sub_f32 v111, v111, v56
    v_accvgpr_read_b32 v48, a4
    v_accvgpr_read_b32 v49, a5
    v_accvgpr_read_b32 v50, a6
    v_accvgpr_read_b32 v51, a7
    v_fma_f32 v48, v48, v57, v58
    v_fma_f32 v49, v49, v57, v58
    v_fma_f32 v50, v50, v57, v58
    v_fma_f32 v51, v51, v57, v58
    v_accvgpr_write_b32 a4, v48
    v_accvgpr_write_b32 a5, v49
    v_accvgpr_write_b32 a6, v50
    v_accvgpr_write_b32 a7, v51
    v_accvgpr_read_b32 v48, a20
    v_accvgpr_read_b32 v49, a21
    v_accvgpr_read_b32 v50, a22
    v_accvgpr_read_b32 v51, a23
    v_fma_f32 v48, v48, v57, v58
    v_fma_f32 v49, v49, v57, v58
    v_fma_f32 v50, v50, v57, v58
    v_fma_f32 v51, v51, v57, v58
    v_accvgpr_write_b32 a20, v48
    v_accvgpr_write_b32 a21, v49
    v_accvgpr_write_b32 a22, v50
    v_accvgpr_write_b32 a23, v51
    v_accvgpr_read_b32 v48, a36
    v_accvgpr_read_b32 v49, a37
    v_accvgpr_read_b32 v50, a38
    v_accvgpr_read_b32 v51, a39
    v_fma_f32 v48, v48, v57, v58
    v_fma_f32 v49, v49, v57, v58
    v_fma_f32 v50, v50, v57, v58
    v_fma_f32 v51, v51, v57, v58
    v_accvgpr_write_b32 a36, v48
    v_accvgpr_write_b32 a37, v49
    v_accvgpr_write_b32 a38, v50
    v_accvgpr_write_b32 a39, v51
    v_accvgpr_read_b32 v48, a52
    v_accvgpr_read_b32 v49, a53
    v_accvgpr_read_b32 v50, a54
    v_accvgpr_read_b32 v51, a55
    v_fma_f32 v48, v48, v57, v58
    v_fma_f32 v49, v49, v57, v58
    v_fma_f32 v50, v50, v57, v58
    v_fma_f32 v51, v51, v57, v58
    v_accvgpr_write_b32 a52, v48
    v_accvgpr_write_b32 a53, v49
    v_accvgpr_write_b32 a54, v50
    v_accvgpr_write_b32 a55, v51
    v_accvgpr_read_b32 v48, a68
    v_accvgpr_read_b32 v49, a69
    v_accvgpr_read_b32 v50, a70
    v_accvgpr_read_b32 v51, a71
    v_fma_f32 v48, v48, v57, v58
    v_fma_f32 v49, v49, v57, v58
    v_fma_f32 v50, v50, v57, v58
    v_fma_f32 v51, v51, v57, v58
    v_accvgpr_write_b32 a68, v48
    v_accvgpr_write_b32 a69, v49
    v_accvgpr_write_b32 a70, v50
    v_accvgpr_write_b32 a71, v51
    v_accvgpr_read_b32 v48, a84
    v_accvgpr_read_b32 v49, a85
    v_accvgpr_read_b32 v50, a86
    v_accvgpr_read_b32 v51, a87
    v_fma_f32 v48, v48, v57, v58
    v_fma_f32 v49, v49, v57, v58
    v_fma_f32 v50, v50, v57, v58
    v_fma_f32 v51, v51, v57, v58
    v_accvgpr_write_b32 a84, v48
    v_accvgpr_write_b32 a85, v49
    v_accvgpr_write_b32 a86, v50
    v_accvgpr_write_b32 a87, v51
    v_accvgpr_read_b32 v48, a100
    v_accvgpr_read_b32 v49, a101
    v_accvgpr_read_b32 v50, a102
    v_accvgpr_read_b32 v51, a103
    v_fma_f32 v48, v48, v57, v58
    v_fma_f32 v49, v49, v57, v58
    v_fma_f32 v50, v50, v57, v58
    v_fma_f32 v51, v51, v57, v58
    v_accvgpr_write_b32 a100, v48
    v_accvgpr_write_b32 a101, v49
    v_accvgpr_write_b32 a102, v50
    v_accvgpr_write_b32 a103, v51
    v_accvgpr_read_b32 v48, a116
    v_accvgpr_read_b32 v49, a117
    v_accvgpr_read_b32 v50, a118
    v_accvgpr_read_b32 v51, a119
    v_fma_f32 v48, v48, v57, v58
    v_fma_f32 v49, v49, v57, v58
    v_fma_f32 v50, v50, v57, v58
    v_fma_f32 v51, v51, v57, v58
    v_accvgpr_write_b32 a116, v48
    v_accvgpr_write_b32 a117, v49
    v_accvgpr_write_b32 a118, v50
    v_accvgpr_write_b32 a119, v51
    v_accvgpr_read_b32 v48, a132
    v_accvgpr_read_b32 v49, a133
    v_accvgpr_read_b32 v50, a134
    v_accvgpr_read_b32 v51, a135
    v_fma_f32 v48, v48, v57, v58
    v_fma_f32 v49, v49, v57, v58
    v_fma_f32 v50, v50, v57, v58
    v_fma_f32 v51, v51, v57, v58
    v_accvgpr_write_b32 a132, v48
    v_accvgpr_write_b32 a133, v49
    v_accvgpr_write_b32 a134, v50
    v_accvgpr_write_b32 a135, v51
    v_accvgpr_read_b32 v48, a148
    v_accvgpr_read_b32 v49, a149
    v_accvgpr_read_b32 v50, a150
    v_accvgpr_read_b32 v51, a151
    v_fma_f32 v48, v48, v57, v58
    v_fma_f32 v49, v49, v57, v58
    v_fma_f32 v50, v50, v57, v58
    v_fma_f32 v51, v51, v57, v58
    v_accvgpr_write_b32 a148, v48
    v_accvgpr_write_b32 a149, v49
    v_accvgpr_write_b32 a150, v50
    v_accvgpr_write_b32 a151, v51
    v_accvgpr_read_b32 v48, a164
    v_accvgpr_read_b32 v49, a165
    v_accvgpr_read_b32 v50, a166
    v_accvgpr_read_b32 v51, a167
    v_fma_f32 v48, v48, v57, v58
    v_fma_f32 v49, v49, v57, v58
    v_fma_f32 v50, v50, v57, v58
    v_fma_f32 v51, v51, v57, v58
    v_accvgpr_write_b32 a164, v48
    v_accvgpr_write_b32 a165, v49
    v_accvgpr_write_b32 a166, v50
    v_accvgpr_write_b32 a167, v51
    v_accvgpr_read_b32 v48, a180
    v_accvgpr_read_b32 v49, a181
    v_accvgpr_read_b32 v50, a182
    v_accvgpr_read_b32 v51, a183
    v_fma_f32 v48, v48, v57, v58
    v_fma_f32 v49, v49, v57, v58
    v_fma_f32 v50, v50, v57, v58
    v_fma_f32 v51, v51, v57, v58
    v_accvgpr_write_b32 a180, v48
    v_accvgpr_write_b32 a181, v49
    v_accvgpr_write_b32 a182, v50
    v_accvgpr_write_b32 a183, v51
    v_exp_f32 v48, v140
    v_exp_f32 v49, v141
    v_exp_f32 v50, v142
    v_exp_f32 v51, v143
    v_exp_f32 v52, v172
    v_exp_f32 v53, v173
    v_exp_f32 v54, v174
    v_exp_f32 v55, v175
    s_nop 0
    v_cvt_pk_bf16_f32 v236, v48, v49
    v_cvt_pk_bf16_f32 v237, v50, v51
    v_cvt_pk_bf16_f32 v238, v52, v53
    v_cvt_pk_bf16_f32 v239, v54, v55
    v_add_f32 v25, v48, v49
    v_add_f32 v25, v25, v50
    v_add_f32 v25, v25, v51
    v_add_f32 v25, v25, v52
    v_add_f32 v25, v25, v53
    v_add_f32 v25, v25, v54
    v_add_f32 v25, v25, v55
    v_max3_f32 v56, v148, v149, v150
    v_max3_f32 v56, v56, v151, v180
    v_max3_f32 v56, v56, v181, v182
    v_max3_f32 v56, v56, v183, 0
    v_mov_b32 v58, v56
    s_nop 1
    v_permlane16_swap_b32 v56, v58
    s_nop 1
    v_max_f32 v56, v56, v58
    v_mov_b32 v58, v56
    s_nop 1
    v_permlane32_swap_b32 v56, v58
    s_nop 1
    v_max_f32 v56, v56, v58
    v_exp_f32 v57, -v56
    v_sub_f32 v40, v40, v56
    v_sub_f32 v41, v41, v56
    v_sub_f32 v42, v42, v56
    v_sub_f32 v43, v43, v56
    v_mul_f32 v22, v22, v57
    v_sub_f32 v58, 1.0, v57
    v_sub_f32 v148, v148, v56
    v_sub_f32 v149, v149, v56
    v_sub_f32 v150, v150, v56
    v_sub_f32 v151, v151, v56
    v_sub_f32 v180, v180, v56
    v_sub_f32 v181, v181, v56
    v_sub_f32 v182, v182, v56
    v_sub_f32 v183, v183, v56
    v_sub_f32 v84, v84, v56
    v_sub_f32 v85, v85, v56
    v_sub_f32 v86, v86, v56
    v_sub_f32 v87, v87, v56
    v_sub_f32 v116, v116, v56
    v_sub_f32 v117, v117, v56
    v_sub_f32 v118, v118, v56
    v_sub_f32 v119, v119, v56
    v_accvgpr_read_b32 v48, a8
    v_accvgpr_read_b32 v49, a9
    v_accvgpr_read_b32 v50, a10
    v_accvgpr_read_b32 v51, a11
    v_fma_f32 v48, v48, v57, v58
    v_fma_f32 v49, v49, v57, v58
    v_fma_f32 v50, v50, v57, v58
    v_fma_f32 v51, v51, v57, v58
    v_accvgpr_write_b32 a8, v48
    v_accvgpr_write_b32 a9, v49
    v_accvgpr_write_b32 a10, v50
    v_accvgpr_write_b32 a11, v51
    v_accvgpr_read_b32 v48, a24
    v_accvgpr_read_b32 v49, a25
    v_accvgpr_read_b32 v50, a26
    v_accvgpr_read_b32 v51, a27
    v_fma_f32 v48, v48, v57, v58
    v_fma_f32 v49, v49, v57, v58
    v_fma_f32 v50, v50, v57, v58
    v_fma_f32 v51, v51, v57, v58
    v_accvgpr_write_b32 a24, v48
    v_accvgpr_write_b32 a25, v49
    v_accvgpr_write_b32 a26, v50
    v_accvgpr_write_b32 a27, v51
    v_accvgpr_read_b32 v48, a40
    v_accvgpr_read_b32 v49, a41
    v_accvgpr_read_b32 v50, a42
    v_accvgpr_read_b32 v51, a43
    v_fma_f32 v48, v48, v57, v58
    v_fma_f32 v49, v49, v57, v58
    v_fma_f32 v50, v50, v57, v58
    v_fma_f32 v51, v51, v57, v58
    v_accvgpr_write_b32 a40, v48
    v_accvgpr_write_b32 a41, v49
    v_accvgpr_write_b32 a42, v50
    v_accvgpr_write_b32 a43, v51
    v_accvgpr_read_b32 v48, a56
    v_accvgpr_read_b32 v49, a57
    v_accvgpr_read_b32 v50, a58
    v_accvgpr_read_b32 v51, a59
    v_fma_f32 v48, v48, v57, v58
    v_fma_f32 v49, v49, v57, v58
    v_fma_f32 v50, v50, v57, v58
    v_fma_f32 v51, v51, v57, v58
    v_accvgpr_write_b32 a56, v48
    v_accvgpr_write_b32 a57, v49
    v_accvgpr_write_b32 a58, v50
    v_accvgpr_write_b32 a59, v51
    v_accvgpr_read_b32 v48, a72
    v_accvgpr_read_b32 v49, a73
    v_accvgpr_read_b32 v50, a74
    v_accvgpr_read_b32 v51, a75
    v_fma_f32 v48, v48, v57, v58
    v_fma_f32 v49, v49, v57, v58
    v_fma_f32 v50, v50, v57, v58
    v_fma_f32 v51, v51, v57, v58
    v_accvgpr_write_b32 a72, v48
    v_accvgpr_write_b32 a73, v49
    v_accvgpr_write_b32 a74, v50
    v_accvgpr_write_b32 a75, v51
    v_accvgpr_read_b32 v48, a88
    v_accvgpr_read_b32 v49, a89
    v_accvgpr_read_b32 v50, a90
    v_accvgpr_read_b32 v51, a91
    v_fma_f32 v48, v48, v57, v58
    v_fma_f32 v49, v49, v57, v58
    v_fma_f32 v50, v50, v57, v58
    v_fma_f32 v51, v51, v57, v58
    v_accvgpr_write_b32 a88, v48
    v_accvgpr_write_b32 a89, v49
    v_accvgpr_write_b32 a90, v50
    v_accvgpr_write_b32 a91, v51
    v_accvgpr_read_b32 v48, a104
    v_accvgpr_read_b32 v49, a105
    v_accvgpr_read_b32 v50, a106
    v_accvgpr_read_b32 v51, a107
    v_fma_f32 v48, v48, v57, v58
    v_fma_f32 v49, v49, v57, v58
    v_fma_f32 v50, v50, v57, v58
    v_fma_f32 v51, v51, v57, v58
    v_accvgpr_write_b32 a104, v48
    v_accvgpr_write_b32 a105, v49
    v_accvgpr_write_b32 a106, v50
    v_accvgpr_write_b32 a107, v51
    v_accvgpr_read_b32 v48, a120
    v_accvgpr_read_b32 v49, a121
    v_accvgpr_read_b32 v50, a122
    v_accvgpr_read_b32 v51, a123
    v_fma_f32 v48, v48, v57, v58
    v_fma_f32 v49, v49, v57, v58
    v_fma_f32 v50, v50, v57, v58
    v_fma_f32 v51, v51, v57, v58
    v_accvgpr_write_b32 a120, v48
    v_accvgpr_write_b32 a121, v49
    v_accvgpr_write_b32 a122, v50
    v_accvgpr_write_b32 a123, v51
    v_accvgpr_read_b32 v48, a136
    v_accvgpr_read_b32 v49, a137
    v_accvgpr_read_b32 v50, a138
    v_accvgpr_read_b32 v51, a139
    v_fma_f32 v48, v48, v57, v58
    v_fma_f32 v49, v49, v57, v58
    v_fma_f32 v50, v50, v57, v58
    v_fma_f32 v51, v51, v57, v58
    v_accvgpr_write_b32 a136, v48
    v_accvgpr_write_b32 a137, v49
    v_accvgpr_write_b32 a138, v50
    v_accvgpr_write_b32 a139, v51
    v_accvgpr_read_b32 v48, a152
    v_accvgpr_read_b32 v49, a153
    v_accvgpr_read_b32 v50, a154
    v_accvgpr_read_b32 v51, a155
    v_fma_f32 v48, v48, v57, v58
    v_fma_f32 v49, v49, v57, v58
    v_fma_f32 v50, v50, v57, v58
    v_fma_f32 v51, v51, v57, v58
    v_accvgpr_write_b32 a152, v48
    v_accvgpr_write_b32 a153, v49
    v_accvgpr_write_b32 a154, v50
    v_accvgpr_write_b32 a155, v51
    v_accvgpr_read_b32 v48, a168
    v_accvgpr_read_b32 v49, a169
    v_accvgpr_read_b32 v50, a170
    v_accvgpr_read_b32 v51, a171
    v_fma_f32 v48, v48, v57, v58
    v_fma_f32 v49, v49, v57, v58
    v_fma_f32 v50, v50, v57, v58
    v_fma_f32 v51, v51, v57, v58
    v_accvgpr_write_b32 a168, v48
    v_accvgpr_write_b32 a169, v49
    v_accvgpr_write_b32 a170, v50
    v_accvgpr_write_b32 a171, v51
    v_accvgpr_read_b32 v48, a184
    v_accvgpr_read_b32 v49, a185
    v_accvgpr_read_b32 v50, a186
    v_accvgpr_read_b32 v51, a187
    v_fma_f32 v48, v48, v57, v58
    v_fma_f32 v49, v49, v57, v58
    v_fma_f32 v50, v50, v57, v58
    v_fma_f32 v51, v51, v57, v58
    v_accvgpr_write_b32 a184, v48
    v_accvgpr_write_b32 a185, v49
    v_accvgpr_write_b32 a186, v50
    v_accvgpr_write_b32 a187, v51
    v_exp_f32 v48, v148
    v_exp_f32 v49, v149
    v_exp_f32 v50, v150
    v_exp_f32 v51, v151
    v_exp_f32 v52, v180
    v_exp_f32 v53, v181
    v_exp_f32 v54, v182
    v_exp_f32 v55, v183
    s_nop 0
    v_cvt_pk_bf16_f32 v244, v48, v49
    v_cvt_pk_bf16_f32 v245, v50, v51
    v_cvt_pk_bf16_f32 v246, v52, v53
    v_cvt_pk_bf16_f32 v247, v54, v55
    v_add_f32 v26, v48, v49
    v_add_f32 v26, v26, v50
    v_add_f32 v26, v26, v51
    v_add_f32 v26, v26, v52
    v_add_f32 v26, v26, v53
    v_add_f32 v26, v26, v54
    v_add_f32 v26, v26, v55
    v_max3_f32 v56, v156, v157, v158
    v_max3_f32 v56, v56, v159, v188
    v_max3_f32 v56, v56, v189, v190
    v_max3_f32 v56, v56, v191, 0
    v_mov_b32 v58, v56
    s_nop 1
    v_permlane16_swap_b32 v56, v58
    s_nop 1
    v_max_f32 v56, v56, v58
    v_mov_b32 v58, v56
    s_nop 1
    v_permlane32_swap_b32 v56, v58
    s_nop 1
    v_max_f32 v56, v56, v58
    v_exp_f32 v57, -v56
    v_sub_f32 v44, v44, v56
    v_sub_f32 v45, v45, v56
    v_sub_f32 v46, v46, v56
    v_sub_f32 v47, v47, v56
    v_mul_f32 v23, v23, v57
    v_sub_f32 v58, 1.0, v57
    v_sub_f32 v156, v156, v56
    v_sub_f32 v157, v157, v56
    v_sub_f32 v158, v158, v56
    v_sub_f32 v159, v159, v56
    v_sub_f32 v188, v188, v56
    v_sub_f32 v189, v189, v56
    v_sub_f32 v190, v190, v56
    v_sub_f32 v191, v191, v56
    v_sub_f32 v92, v92, v56
    v_sub_f32 v93, v93, v56
    v_sub_f32 v94, v94, v56
    v_sub_f32 v95, v95, v56
    v_sub_f32 v124, v124, v56
    v_sub_f32 v125, v125, v56
    v_sub_f32 v126, v126, v56
    v_sub_f32 v127, v127, v56
    v_accvgpr_read_b32 v48, a12
    v_accvgpr_read_b32 v49, a13
    v_accvgpr_read_b32 v50, a14
    v_accvgpr_read_b32 v51, a15
    v_fma_f32 v48, v48, v57, v58
    v_fma_f32 v49, v49, v57, v58
    v_fma_f32 v50, v50, v57, v58
    v_fma_f32 v51, v51, v57, v58
    v_accvgpr_write_b32 a12, v48
    v_accvgpr_write_b32 a13, v49
    v_accvgpr_write_b32 a14, v50
    v_accvgpr_write_b32 a15, v51
    v_accvgpr_read_b32 v48, a28
    v_accvgpr_read_b32 v49, a29
    v_accvgpr_read_b32 v50, a30
    v_accvgpr_read_b32 v51, a31
    v_fma_f32 v48, v48, v57, v58
    v_fma_f32 v49, v49, v57, v58
    v_fma_f32 v50, v50, v57, v58
    v_fma_f32 v51, v51, v57, v58
    v_accvgpr_write_b32 a28, v48
    v_accvgpr_write_b32 a29, v49
    v_accvgpr_write_b32 a30, v50
    v_accvgpr_write_b32 a31, v51
    v_accvgpr_read_b32 v48, a44
    v_accvgpr_read_b32 v49, a45
    v_accvgpr_read_b32 v50, a46
    v_accvgpr_read_b32 v51, a47
    v_fma_f32 v48, v48, v57, v58
    v_fma_f32 v49, v49, v57, v58
    v_fma_f32 v50, v50, v57, v58
    v_fma_f32 v51, v51, v57, v58
    v_accvgpr_write_b32 a44, v48
    v_accvgpr_write_b32 a45, v49
    v_accvgpr_write_b32 a46, v50
    v_accvgpr_write_b32 a47, v51
    v_accvgpr_read_b32 v48, a60
    v_accvgpr_read_b32 v49, a61
    v_accvgpr_read_b32 v50, a62
    v_accvgpr_read_b32 v51, a63
    v_fma_f32 v48, v48, v57, v58
    v_fma_f32 v49, v49, v57, v58
    v_fma_f32 v50, v50, v57, v58
    v_fma_f32 v51, v51, v57, v58
    v_accvgpr_write_b32 a60, v48
    v_accvgpr_write_b32 a61, v49
    v_accvgpr_write_b32 a62, v50
    v_accvgpr_write_b32 a63, v51
    v_accvgpr_read_b32 v48, a76
    v_accvgpr_read_b32 v49, a77
    v_accvgpr_read_b32 v50, a78
    v_accvgpr_read_b32 v51, a79
    v_fma_f32 v48, v48, v57, v58
    v_fma_f32 v49, v49, v57, v58
    v_fma_f32 v50, v50, v57, v58
    v_fma_f32 v51, v51, v57, v58
    v_accvgpr_write_b32 a76, v48
    v_accvgpr_write_b32 a77, v49
    v_accvgpr_write_b32 a78, v50
    v_accvgpr_write_b32 a79, v51
    v_accvgpr_read_b32 v48, a92
    v_accvgpr_read_b32 v49, a93
    v_accvgpr_read_b32 v50, a94
    v_accvgpr_read_b32 v51, a95
    v_fma_f32 v48, v48, v57, v58
    v_fma_f32 v49, v49, v57, v58
    v_fma_f32 v50, v50, v57, v58
    v_fma_f32 v51, v51, v57, v58
    v_accvgpr_write_b32 a92, v48
    v_accvgpr_write_b32 a93, v49
    v_accvgpr_write_b32 a94, v50
    v_accvgpr_write_b32 a95, v51
    v_accvgpr_read_b32 v48, a108
    v_accvgpr_read_b32 v49, a109
    v_accvgpr_read_b32 v50, a110
    v_accvgpr_read_b32 v51, a111
    v_fma_f32 v48, v48, v57, v58
    v_fma_f32 v49, v49, v57, v58
    v_fma_f32 v50, v50, v57, v58
    v_fma_f32 v51, v51, v57, v58
    v_accvgpr_write_b32 a108, v48
    v_accvgpr_write_b32 a109, v49
    v_accvgpr_write_b32 a110, v50
    v_accvgpr_write_b32 a111, v51
    v_accvgpr_read_b32 v48, a124
    v_accvgpr_read_b32 v49, a125
    v_accvgpr_read_b32 v50, a126
    v_accvgpr_read_b32 v51, a127
    v_fma_f32 v48, v48, v57, v58
    v_fma_f32 v49, v49, v57, v58
    v_fma_f32 v50, v50, v57, v58
    v_fma_f32 v51, v51, v57, v58
    v_accvgpr_write_b32 a124, v48
    v_accvgpr_write_b32 a125, v49
    v_accvgpr_write_b32 a126, v50
    v_accvgpr_write_b32 a127, v51
    v_accvgpr_read_b32 v48, a140
    v_accvgpr_read_b32 v49, a141
    v_accvgpr_read_b32 v50, a142
    v_accvgpr_read_b32 v51, a143
    v_fma_f32 v48, v48, v57, v58
    v_fma_f32 v49, v49, v57, v58
    v_fma_f32 v50, v50, v57, v58
    v_fma_f32 v51, v51, v57, v58
    v_accvgpr_write_b32 a140, v48
    v_accvgpr_write_b32 a141, v49
    v_accvgpr_write_b32 a142, v50
    v_accvgpr_write_b32 a143, v51
    v_accvgpr_read_b32 v48, a156
    v_accvgpr_read_b32 v49, a157
    v_accvgpr_read_b32 v50, a158
    v_accvgpr_read_b32 v51, a159
    v_fma_f32 v48, v48, v57, v58
    v_fma_f32 v49, v49, v57, v58
    v_fma_f32 v50, v50, v57, v58
    v_fma_f32 v51, v51, v57, v58
    v_accvgpr_write_b32 a156, v48
    v_accvgpr_write_b32 a157, v49
    v_accvgpr_write_b32 a158, v50
    v_accvgpr_write_b32 a159, v51
    v_accvgpr_read_b32 v48, a172
    v_accvgpr_read_b32 v49, a173
    v_accvgpr_read_b32 v50, a174
    v_accvgpr_read_b32 v51, a175
    v_fma_f32 v48, v48, v57, v58
    v_fma_f32 v49, v49, v57, v58
    v_fma_f32 v50, v50, v57, v58
    v_fma_f32 v51, v51, v57, v58
    v_accvgpr_write_b32 a172, v48
    v_accvgpr_write_b32 a173, v49
    v_accvgpr_write_b32 a174, v50
    v_accvgpr_write_b32 a175, v51
    v_accvgpr_read_b32 v48, a188
    v_accvgpr_read_b32 v49, a189
    v_accvgpr_read_b32 v50, a190
    v_accvgpr_read_b32 v51, a191
    v_fma_f32 v48, v48, v57, v58
    v_fma_f32 v49, v49, v57, v58
    v_fma_f32 v50, v50, v57, v58
    v_fma_f32 v51, v51, v57, v58
    v_accvgpr_write_b32 a188, v48
    v_accvgpr_write_b32 a189, v49
    v_accvgpr_write_b32 a190, v50
    v_accvgpr_write_b32 a191, v51
    v_exp_f32 v48, v156
    v_exp_f32 v49, v157
    v_exp_f32 v50, v158
    v_exp_f32 v51, v159
    v_exp_f32 v52, v188
    v_exp_f32 v53, v189
    v_exp_f32 v54, v190
    v_exp_f32 v55, v191
    s_nop 0
    v_cvt_pk_bf16_f32 v252, v48, v49
    v_cvt_pk_bf16_f32 v253, v50, v51
    v_cvt_pk_bf16_f32 v254, v52, v53
    v_cvt_pk_bf16_f32 v255, v54, v55
    v_add_f32 v27, v48, v49
    v_add_f32 v27, v27, v50
    v_add_f32 v27, v27, v51
    v_add_f32 v27, v27, v52
    v_add_f32 v27, v27, v53
    v_add_f32 v27, v27, v54
    v_add_f32 v27, v27, v55
    s_nop 1
    s_branch rare_a_ret
rare_b:
    s_nop 7
    s_nop 7
    v_max3_f32 v56, v68, v69, v70
    v_max3_f32 v56, v56, v71, v100
    v_max3_f32 v56, v56, v101, v102
    v_max3_f32 v56, v56, v103, 0
    v_mov_b32 v58, v56
    s_nop 1
    v_permlane16_swap_b32 v56, v58
    s_nop 1
    v_max_f32 v56, v56, v58
    v_mov_b32 v58, v56
    s_nop 1
    v_permlane32_swap_b32 v56, v58
    s_nop 1
    v_max_f32 v56, v56, v58
    v_exp_f32 v57, -v56
    v_sub_f32 v32, v32, v56
    v_sub_f32 v33, v33, v56
    v_sub_f32 v34, v34, v56
    v_sub_f32 v35, v35, v56
    v_mul_f32 v20, v20, v57
    v_sub_f32 v58, 1.0, v57
    v_sub_f32 v68, v68, v56
    v_sub_f32 v69, v69, v56
    v_sub_f32 v70, v70, v56
    v_sub_f32 v71, v71, v56
    v_sub_f32 v100, v100, v56
    v_sub_f32 v101, v101, v56
    v_sub_f32 v102, v102, v56
    v_sub_f32 v103, v103, v56
    v_sub_f32 v132, v132, v56
    v_sub_f32 v133, v133, v56
    v_sub_f32 v134, v134, v56
    v_sub_f32 v135, v135, v56
    v_sub_f32 v164, v164, v56
    v_sub_f32 v165, v165, v56
    v_sub_f32 v166, v166, v56
    v_sub_f32 v167, v167, v56
    v_accvgpr_read_b32 v48, a0
    v_accvgpr_read_b32 v49, a1
    v_accvgpr_read_b32 v50, a2
    v_accvgpr_read_b32 v51, a3
    v_fma_f32 v48, v48, v57, v58
    v_fma_f32 v49, v49, v57, v58
    v_fma_f32 v50, v50, v57, v58
    v_fma_f32 v51, v51, v57, v58
    v_accvgpr_write_b32 a0, v48
    v_accvgpr_write_b32 a1, v49
    v_accvgpr_write_b32 a2, v50
    v_accvgpr_write_b32 a3, v51
    v_accvgpr_read_b32 v48, a16
    v_accvgpr_read_b32 v49, a17
    v_accvgpr_read_b32 v50, a18
    v_accvgpr_read_b32 v51, a19
    v_fma_f32 v48, v48, v57, v58
    v_fma_f32 v49, v49, v57, v58
    v_fma_f32 v50, v50, v57, v58
    v_fma_f32 v51, v51, v57, v58
    v_accvgpr_write_b32 a16, v48
    v_accvgpr_write_b32 a17, v49
    v_accvgpr_write_b32 a18, v50
    v_accvgpr_write_b32 a19, v51
    v_accvgpr_read_b32 v48, a32
    v_accvgpr_read_b32 v49, a33
    v_accvgpr_read_b32 v50, a34
    v_accvgpr_read_b32 v51, a35
    v_fma_f32 v48, v48, v57, v58
    v_fma_f32 v49, v49, v57, v58
    v_fma_f32 v50, v50, v57, v58
    v_fma_f32 v51, v51, v57, v58
    v_accvgpr_write_b32 a32, v48
    v_accvgpr_write_b32 a33, v49
    v_accvgpr_write_b32 a34, v50
    v_accvgpr_write_b32 a35, v51
    v_accvgpr_read_b32 v48, a48
    v_accvgpr_read_b32 v49, a49
    v_accvgpr_read_b32 v50, a50
    v_accvgpr_read_b32 v51, a51
    v_fma_f32 v48, v48, v57, v58
    v_fma_f32 v49, v49, v57, v58
    v_fma_f32 v50, v50, v57, v58
    v_fma_f32 v51, v51, v57, v58
    v_accvgpr_write_b32 a48, v48
    v_accvgpr_write_b32 a49, v49
    v_accvgpr_write_b32 a50, v50
    v_accvgpr_write_b32 a51, v51
    v_accvgpr_read_b32 v48, a64
    v_accvgpr_read_b32 v49, a65
    v_accvgpr_read_b32 v50, a66
    v_accvgpr_read_b32 v51, a67
    v_fma_f32 v48, v48, v57, v58
    v_fma_f32 v49, v49, v57, v58
    v_fma_f32 v50, v50, v57, v58
    v_fma_f32 v51, v51, v57, v58
    v_accvgpr_write_b32 a64, v48
    v_accvgpr_write_b32 a65, v49
    v_accvgpr_write_b32 a66, v50
    v_accvgpr_write_b32 a67, v51
    v_accvgpr_read_b32 v48, a80
    v_accvgpr_read_b32 v49, a81
    v_accvgpr_read_b32 v50, a82
    v_accvgpr_read_b32 v51, a83
    v_fma_f32 v48, v48, v57, v58
    v_fma_f32 v49, v49, v57, v58
    v_fma_f32 v50, v50, v57, v58
    v_fma_f32 v51, v51, v57, v58
    v_accvgpr_write_b32 a80, v48
    v_accvgpr_write_b32 a81, v49
    v_accvgpr_write_b32 a82, v50
    v_accvgpr_write_b32 a83, v51
    v_accvgpr_read_b32 v48, a96
    v_accvgpr_read_b32 v49, a97
    v_accvgpr_read_b32 v50, a98
    v_accvgpr_read_b32 v51, a99
    v_fma_f32 v48, v48, v57, v58
    v_fma_f32 v49, v49, v57, v58
    v_fma_f32 v50, v50, v57, v58
    v_fma_f32 v51, v51, v57, v58
    v_accvgpr_write_b32 a96, v48
    v_accvgpr_write_b32 a97, v49
    v_accvgpr_write_b32 a98, v50
    v_accvgpr_write_b32 a99, v51
    v_accvgpr_read_b32 v48, a112
    v_accvgpr_read_b32 v49, a113
    v_accvgpr_read_b32 v50, a114
    v_accvgpr_read_b32 v51, a115
    v_fma_f32 v48, v48, v57, v58
    v_fma_f32 v49, v49, v57, v58
    v_fma_f32 v50, v50, v57, v58
    v_fma_f32 v51, v51, v57, v58
    v_accvgpr_write_b32 a112, v48
    v_accvgpr_write_b32 a113, v49
    v_accvgpr_write_b32 a114, v50
    v_accvgpr_write_b32 a115, v51
    v_accvgpr_read_b32 v48, a128
    v_accvgpr_read_b32 v49, a129
    v_accvgpr_read_b32 v50, a130
    v_accvgpr_read_b32 v51, a131
    v_fma_f32 v48, v48, v57, v58
    v_fma_f32 v49, v49, v57, v58
    v_fma_f32 v50, v50, v57, v58
    v_fma_f32 v51, v51, v57, v58
    v_accvgpr_write_b32 a128, v48
    v_accvgpr_write_b32 a129, v49
    v_accvgpr_write_b32 a130, v50
    v_accvgpr_write_b32 a131, v51
    v_accvgpr_read_b32 v48, a144
    v_accvgpr_read_b32 v49, a145
    v_accvgpr_read_b32 v50, a146
    v_accvgpr_read_b32 v51, a147
    v_fma_f32 v48, v48, v57, v58
    v_fma_f32 v49, v49, v57, v58
    v_fma_f32 v50, v50, v57, v58
    v_fma_f32 v51, v51, v57, v58
    v_accvgpr_write_b32 a144, v48
    v_accvgpr_write_b32 a145, v49
    v_accvgpr_write_b32 a146, v50
    v_accvgpr_write_b32 a147, v51
    v_accvgpr_read_b32 v48, a160
    v_accvgpr_read_b32 v49, a161
    v_accvgpr_read_b32 v50, a162
    v_accvgpr_read_b32 v51, a163
    v_fma_f32 v48, v48, v57, v58
    v_fma_f32 v49, v49, v57, v58
    v_fma_f32 v50, v50, v57, v58
    v_fma_f32 v51, v51, v57, v58
    v_accvgpr_write_b32 a160, v48
    v_accvgpr_write_b32 a161, v49
    v_accvgpr_write_b32 a162, v50
    v_accvgpr_write_b32 a163, v51
    v_accvgpr_read_b32 v48, a176
    v_accvgpr_read_b32 v49, a177
    v_accvgpr_read_b32 v50, a178
    v_accvgpr_read_b32 v51, a179
    v_fma_f32 v48, v48, v57, v58
    v_fma_f32 v49, v49, v57, v58
    v_fma_f32 v50, v50, v57, v58
    v_fma_f32 v51, v51, v57, v58
    v_accvgpr_write_b32 a176, v48
    v_accvgpr_write_b32 a177, v49
    v_accvgpr_write_b32 a178, v50
    v_accvgpr_write_b32 a179, v51
    v_exp_f32 v48, v68
    v_exp_f32 v49, v69
    v_exp_f32 v50, v70
    v_exp_f32 v51, v71
    v_exp_f32 v52, v100
    v_exp_f32 v53, v101
    v_exp_f32 v54, v102
    v_exp_f32 v55, v103
    s_nop 0
    v_cvt_pk_bf16_f32 v196, v48, v49
    v_cvt_pk_bf16_f32 v197, v50, v51
    v_cvt_pk_bf16_f32 v198, v52, v53
    v_cvt_pk_bf16_f32 v199, v54, v55
    v_add_f32 v24, v48, v49
    v_add_f32 v24, v24, v50
    v_add_f32 v24, v24, v51
    v_add_f32 v24, v24, v52
    v_add_f32 v24, v24, v53
    v_add_f32 v24, v24, v54
    v_add_f32 v24, v24, v55
    v_max3_f32 v56, v76, v77, v78
    v_max3_f32 v56, v56, v79, v108
    v_max3_f32 v56, v56, v109, v110
    v_max3_f32 v56, v56, v111, 0
    v_mov_b32 v58, v56
    s_nop 1
    v_permlane16_swap_b32 v56, v58
    s_nop 1
    v_max_f32 v56, v56, v58
    v_mov_b32 v58, v56
    s_nop 1
    v_permlane32_swap_b32 v56, v58
    s_nop 1
    v_max_f32 v56, v56, v58
    v_exp_f32 v57, -v56
    v_sub_f32 v36, v36, v56
    v_sub_f32 v37, v37, v56
    v_sub_f32 v38, v38, v56
    v_sub_f32 v39, v39, v56
    v_mul_f32 v21, v21, v57
    v_sub_f32 v58, 1.0, v57
    v_sub_f32 v76, v76, v56
    v_sub_f32 v77, v77, v56
    v_sub_f32 v78, v78, v56
    v_sub_f32 v79, v79, v56
    v_sub_f32 v108, v108, v56
    v_sub_f32 v109, v109, v56
    v_sub_f32 v110, v110, v56
    v_sub_f32 v111, v111, v56
    v_sub_f32 v140, v140, v56
    v_sub_f32 v141, v141, v56
    v_sub_f32 v142, v142, v56
    v_sub_f32 v143, v143, v56
    v_sub_f32 v172, v172, v56
    v_sub_f32 v173, v173, v56
    v_sub_f32 v174, v174, v56
    v_sub_f32 v175, v175, v56
    v_accvgpr_read_b32 v48, a4
    v_accvgpr_read_b32 v49, a5
    v_accvgpr_read_b32 v50, a6
    v_accvgpr_read_b32 v51, a7
    v_fma_f32 v48, v48, v57, v58
    v_fma_f32 v49, v49, v57, v58
    v_fma_f32 v50, v50, v57, v58
    v_fma_f32 v51, v51, v57, v58
    v_accvgpr_write_b32 a4, v48
    v_accvgpr_write_b32 a5, v49
    v_accvgpr_write_b32 a6, v50
    v_accvgpr_write_b32 a7, v51
    v_accvgpr_read_b32 v48, a20
    v_accvgpr_read_b32 v49, a21
    v_accvgpr_read_b32 v50, a22
    v_accvgpr_read_b32 v51, a23
    v_fma_f32 v48, v48, v57, v58
    v_fma_f32 v49, v49, v57, v58
    v_fma_f32 v50, v50, v57, v58
    v_fma_f32 v51, v51, v57, v58
    v_accvgpr_write_b32 a20, v48
    v_accvgpr_write_b32 a21, v49
    v_accvgpr_write_b32 a22, v50
    v_accvgpr_write_b32 a23, v51
    v_accvgpr_read_b32 v48, a36
    v_accvgpr_read_b32 v49, a37
    v_accvgpr_read_b32 v50, a38
    v_accvgpr_read_b32 v51, a39
    v_fma_f32 v48, v48, v57, v58
    v_fma_f32 v49, v49, v57, v58
    v_fma_f32 v50, v50, v57, v58
    v_fma_f32 v51, v51, v57, v58
    v_accvgpr_write_b32 a36, v48
    v_accvgpr_write_b32 a37, v49
    v_accvgpr_write_b32 a38, v50
    v_accvgpr_write_b32 a39, v51
    v_accvgpr_read_b32 v48, a52
    v_accvgpr_read_b32 v49, a53
    v_accvgpr_read_b32 v50, a54
    v_accvgpr_read_b32 v51, a55
    v_fma_f32 v48, v48, v57, v58
    v_fma_f32 v49, v49, v57, v58
    v_fma_f32 v50, v50, v57, v58
    v_fma_f32 v51, v51, v57, v58
    v_accvgpr_write_b32 a52, v48
    v_accvgpr_write_b32 a53, v49
    v_accvgpr_write_b32 a54, v50
    v_accvgpr_write_b32 a55, v51
    v_accvgpr_read_b32 v48, a68
    v_accvgpr_read_b32 v49, a69
    v_accvgpr_read_b32 v50, a70
    v_accvgpr_read_b32 v51, a71
    v_fma_f32 v48, v48, v57, v58
    v_fma_f32 v49, v49, v57, v58
    v_fma_f32 v50, v50, v57, v58
    v_fma_f32 v51, v51, v57, v58
    v_accvgpr_write_b32 a68, v48
    v_accvgpr_write_b32 a69, v49
    v_accvgpr_write_b32 a70, v50
    v_accvgpr_write_b32 a71, v51
    v_accvgpr_read_b32 v48, a84
    v_accvgpr_read_b32 v49, a85
    v_accvgpr_read_b32 v50, a86
    v_accvgpr_read_b32 v51, a87
    v_fma_f32 v48, v48, v57, v58
    v_fma_f32 v49, v49, v57, v58
    v_fma_f32 v50, v50, v57, v58
    v_fma_f32 v51, v51, v57, v58
    v_accvgpr_write_b32 a84, v48
    v_accvgpr_write_b32 a85, v49
    v_accvgpr_write_b32 a86, v50
    v_accvgpr_write_b32 a87, v51
    v_accvgpr_read_b32 v48, a100
    v_accvgpr_read_b32 v49, a101
    v_accvgpr_read_b32 v50, a102
    v_accvgpr_read_b32 v51, a103
    v_fma_f32 v48, v48, v57, v58
    v_fma_f32 v49, v49, v57, v58
    v_fma_f32 v50, v50, v57, v58
    v_fma_f32 v51, v51, v57, v58
    v_accvgpr_write_b32 a100, v48
    v_accvgpr_write_b32 a101, v49
    v_accvgpr_write_b32 a102, v50
    v_accvgpr_write_b32 a103, v51
    v_accvgpr_read_b32 v48, a116
    v_accvgpr_read_b32 v49, a117
    v_accvgpr_read_b32 v50, a118
    v_accvgpr_read_b32 v51, a119
    v_fma_f32 v48, v48, v57, v58
    v_fma_f32 v49, v49, v57, v58
    v_fma_f32 v50, v50, v57, v58
    v_fma_f32 v51, v51, v57, v58
    v_accvgpr_write_b32 a116, v48
    v_accvgpr_write_b32 a117, v49
    v_accvgpr_write_b32 a118, v50
    v_accvgpr_write_b32 a119, v51
    v_accvgpr_read_b32 v48, a132
    v_accvgpr_read_b32 v49, a133
    v_accvgpr_read_b32 v50, a134
    v_accvgpr_read_b32 v51, a135
    v_fma_f32 v48, v48, v57, v58
    v_fma_f32 v49, v49, v57, v58
    v_fma_f32 v50, v50, v57, v58
    v_fma_f32 v51, v51, v57, v58
    v_accvgpr_write_b32 a132, v48
    v_accvgpr_write_b32 a133, v49
    v_accvgpr_write_b32 a134, v50
    v_accvgpr_write_b32 a135, v51
    v_accvgpr_read_b32 v48, a148
    v_accvgpr_read_b32 v49, a149
    v_accvgpr_read_b32 v50, a150
    v_accvgpr_read_b32 v51, a151
    v_fma_f32 v48, v48, v57, v58
    v_fma_f32 v49, v49, v57, v58
    v_fma_f32 v50, v50, v57, v58
    v_fma_f32 v51, v51, v57, v58
    v_accvgpr_write_b32 a148, v48
    v_accvgpr_write_b32 a149, v49
    v_accvgpr_write_b32 a150, v50
    v_accvgpr_write_b32 a151, v51
    v_accvgpr_read_b32 v48, a164
    v_accvgpr_read_b32 v49, a165
    v_accvgpr_read_b32 v50, a166
    v_accvgpr_read_b32 v51, a167
    v_fma_f32 v48, v48, v57, v58
    v_fma_f32 v49, v49, v57, v58
    v_fma_f32 v50, v50, v57, v58
    v_fma_f32 v51, v51, v57, v58
    v_accvgpr_write_b32 a164, v48
    v_accvgpr_write_b32 a165, v49
    v_accvgpr_write_b32 a166, v50
    v_accvgpr_write_b32 a167, v51
    v_accvgpr_read_b32 v48, a180
    v_accvgpr_read_b32 v49, a181
    v_accvgpr_read_b32 v50, a182
    v_accvgpr_read_b32 v51, a183
    v_fma_f32 v48, v48, v57, v58
    v_fma_f32 v49, v49, v57, v58
    v_fma_f32 v50, v50, v57, v58
    v_fma_f32 v51, v51, v57, v58
    v_accvgpr_write_b32 a180, v48
    v_accvgpr_write_b32 a181, v49
    v_accvgpr_write_b32 a182, v50
    v_accvgpr_write_b32 a183, v51
    v_exp_f32 v48, v76
    v_exp_f32 v49, v77
    v_exp_f32 v50, v78
    v_exp_f32 v51, v79
    v_exp_f32 v52, v108
    v_exp_f32 v53, v109
    v_exp_f32 v54, v110
    v_exp_f32 v55, v111
    s_nop 0
    v_cvt_pk_bf16_f32 v204, v48, v49
    v_cvt_pk_bf16_f32 v205, v50, v51
    v_cvt_pk_bf16_f32 v206, v52, v53
    v_cvt_pk_bf16_f32 v207, v54, v55
    v_add_f32 v25, v48, v49
    v_add_f32 v25, v25, v50
    v_add_f32 v25, v25, v51
    v_add_f32 v25, v25, v52
    v_add_f32 v25, v25, v53
    v_add_f32 v25, v25, v54
    v_add_f32 v25, v25, v55
    v_max3_f32 v56, v84, v85, v86
    v_max3_f32 v56, v56, v87, v116
    v_max3_f32 v56, v56, v117, v118
    v_max3_f32 v56, v56, v119, 0
    v_mov_b32 v58, v56
    s_nop 1
    v_permlane16_swap_b32 v56, v58
    s_nop 1
    v_max_f32 v56, v56, v58
    v_mov_b32 v58, v56
    s_nop 1
    v_permlane32_swap_b32 v56, v58
    s_nop 1
    v_max_f32 v56, v56, v58
    v_exp_f32 v57, -v56
    v_sub_f32 v40, v40, v56
    v_sub_f32 v41, v41, v56
    v_sub_f32 v42, v42, v56
    v_sub_f32 v43, v43, v56
    v_mul_f32 v22, v22, v57
    v_sub_f32 v58, 1.0, v57
    v_sub_f32 v84, v84, v56
    v_sub_f32 v85, v85, v56
    v_sub_f32 v86, v86, v56
    v_sub_f32 v87, v87, v56
    v_sub_f32 v116, v116, v56
    v_sub_f32 v117, v117, v56
    v_sub_f32 v118, v118, v56
    v_sub_f32 v119, v119, v56
    v_sub_f32 v148, v148, v56
    v_sub_f32 v149, v149, v56
    v_sub_f32 v150, v150, v56
    v_sub_f32 v151, v151, v56
    v_sub_f32 v180, v180, v56
    v_sub_f32 v181, v181, v56
    v_sub_f32 v182, v182, v56
    v_sub_f32 v183, v183, v56
    v_accvgpr_read_b32 v48, a8
    v_accvgpr_read_b32 v49, a9
    v_accvgpr_read_b32 v50, a10
    v_accvgpr_read_b32 v51, a11
    v_fma_f32 v48, v48, v57, v58
    v_fma_f32 v49, v49, v57, v58
    v_fma_f32 v50, v50, v57, v58
    v_fma_f32 v51, v51, v57, v58
    v_accvgpr_write_b32 a8, v48
    v_accvgpr_write_b32 a9, v49
    v_accvgpr_write_b32 a10, v50
    v_accvgpr_write_b32 a11, v51
    v_accvgpr_read_b32 v48, a24
    v_accvgpr_read_b32 v49, a25
    v_accvgpr_read_b32 v50, a26
    v_accvgpr_read_b32 v51, a27
    v_fma_f32 v48, v48, v57, v58
    v_fma_f32 v49, v49, v57, v58
    v_fma_f32 v50, v50, v57, v58
    v_fma_f32 v51, v51, v57, v58
    v_accvgpr_write_b32 a24, v48
    v_accvgpr_write_b32 a25, v49
    v_accvgpr_write_b32 a26, v50
    v_accvgpr_write_b32 a27, v51
    v_accvgpr_read_b32 v48, a40
    v_accvgpr_read_b32 v49, a41
    v_accvgpr_read_b32 v50, a42
    v_accvgpr_read_b32 v51, a43
    v_fma_f32 v48, v48, v57, v58
    v_fma_f32 v49, v49, v57, v58
    v_fma_f32 v50, v50, v57, v58
    v_fma_f32 v51, v51, v57, v58
    v_accvgpr_write_b32 a40, v48
    v_accvgpr_write_b32 a41, v49
    v_accvgpr_write_b32 a42, v50
    v_accvgpr_write_b32 a43, v51
    v_accvgpr_read_b32 v48, a56
    v_accvgpr_read_b32 v49, a57
    v_accvgpr_read_b32 v50, a58
    v_accvgpr_read_b32 v51, a59
    v_fma_f32 v48, v48, v57, v58
    v_fma_f32 v49, v49, v57, v58
    v_fma_f32 v50, v50, v57, v58
    v_fma_f32 v51, v51, v57, v58
    v_accvgpr_write_b32 a56, v48
    v_accvgpr_write_b32 a57, v49
    v_accvgpr_write_b32 a58, v50
    v_accvgpr_write_b32 a59, v51
    v_accvgpr_read_b32 v48, a72
    v_accvgpr_read_b32 v49, a73
    v_accvgpr_read_b32 v50, a74
    v_accvgpr_read_b32 v51, a75
    v_fma_f32 v48, v48, v57, v58
    v_fma_f32 v49, v49, v57, v58
    v_fma_f32 v50, v50, v57, v58
    v_fma_f32 v51, v51, v57, v58
    v_accvgpr_write_b32 a72, v48
    v_accvgpr_write_b32 a73, v49
    v_accvgpr_write_b32 a74, v50
    v_accvgpr_write_b32 a75, v51
    v_accvgpr_read_b32 v48, a88
    v_accvgpr_read_b32 v49, a89
    v_accvgpr_read_b32 v50, a90
    v_accvgpr_read_b32 v51, a91
    v_fma_f32 v48, v48, v57, v58
    v_fma_f32 v49, v49, v57, v58
    v_fma_f32 v50, v50, v57, v58
    v_fma_f32 v51, v51, v57, v58
    v_accvgpr_write_b32 a88, v48
    v_accvgpr_write_b32 a89, v49
    v_accvgpr_write_b32 a90, v50
    v_accvgpr_write_b32 a91, v51
    v_accvgpr_read_b32 v48, a104
    v_accvgpr_read_b32 v49, a105
    v_accvgpr_read_b32 v50, a106
    v_accvgpr_read_b32 v51, a107
    v_fma_f32 v48, v48, v57, v58
    v_fma_f32 v49, v49, v57, v58
    v_fma_f32 v50, v50, v57, v58
    v_fma_f32 v51, v51, v57, v58
    v_accvgpr_write_b32 a104, v48
    v_accvgpr_write_b32 a105, v49
    v_accvgpr_write_b32 a106, v50
    v_accvgpr_write_b32 a107, v51
    v_accvgpr_read_b32 v48, a120
    v_accvgpr_read_b32 v49, a121
    v_accvgpr_read_b32 v50, a122
    v_accvgpr_read_b32 v51, a123
    v_fma_f32 v48, v48, v57, v58
    v_fma_f32 v49, v49, v57, v58
    v_fma_f32 v50, v50, v57, v58
    v_fma_f32 v51, v51, v57, v58
    v_accvgpr_write_b32 a120, v48
    v_accvgpr_write_b32 a121, v49
    v_accvgpr_write_b32 a122, v50
    v_accvgpr_write_b32 a123, v51
    v_accvgpr_read_b32 v48, a136
    v_accvgpr_read_b32 v49, a137
    v_accvgpr_read_b32 v50, a138
    v_accvgpr_read_b32 v51, a139
    v_fma_f32 v48, v48, v57, v58
    v_fma_f32 v49, v49, v57, v58
    v_fma_f32 v50, v50, v57, v58
    v_fma_f32 v51, v51, v57, v58
    v_accvgpr_write_b32 a136, v48
    v_accvgpr_write_b32 a137, v49
    v_accvgpr_write_b32 a138, v50
    v_accvgpr_write_b32 a139, v51
    v_accvgpr_read_b32 v48, a152
    v_accvgpr_read_b32 v49, a153
    v_accvgpr_read_b32 v50, a154
    v_accvgpr_read_b32 v51, a155
    v_fma_f32 v48, v48, v57, v58
    v_fma_f32 v49, v49, v57, v58
    v_fma_f32 v50, v50, v57, v58
    v_fma_f32 v51, v51, v57, v58
    v_accvgpr_write_b32 a152, v48
    v_accvgpr_write_b32 a153, v49
    v_accvgpr_write_b32 a154, v50
    v_accvgpr_write_b32 a155, v51
    v_accvgpr_read_b32 v48, a168
    v_accvgpr_read_b32 v49, a169
    v_accvgpr_read_b32 v50, a170
    v_accvgpr_read_b32 v51, a171
    v_fma_f32 v48, v48, v57, v58
    v_fma_f32 v49, v49, v57, v58
    v_fma_f32 v50, v50, v57, v58
    v_fma_f32 v51, v51, v57, v58
    v_accvgpr_write_b32 a168, v48
    v_accvgpr_write_b32 a169, v49
    v_accvgpr_write_b32 a170, v50
    v_accvgpr_write_b32 a171, v51
    v_accvgpr_read_b32 v48, a184
    v_accvgpr_read_b32 v49, a185
    v_accvgpr_read_b32 v50, a186
    v_accvgpr_read_b32 v51, a187
    v_fma_f32 v48, v48, v57, v58
    v_fma_f32 v49, v49, v57, v58
    v_fma_f32 v50, v50, v57, v58
    v_fma_f32 v51, v51, v57, v58
    v_accvgpr_write_b32 a184, v48
    v_accvgpr_write_b32 a185, v49
    v_accvgpr_write_b32 a186, v50
    v_accvgpr_write_b32 a187, v51
    v_exp_f32 v48, v84
    v_exp_f32 v49, v85
    v_exp_f32 v50, v86
    v_exp_f32 v51, v87
    v_exp_f32 v52, v116
    v_exp_f32 v53, v117
    v_exp_f32 v54, v118
    v_exp_f32 v55, v119
    s_nop 0
    v_cvt_pk_bf16_f32 v212, v48, v49
    v_cvt_pk_bf16_f32 v213, v50, v51
    v_cvt_pk_bf16_f32 v214, v52, v53
    v_cvt_pk_bf16_f32 v215, v54, v55
    v_add_f32 v26, v48, v49
    v_add_f32 v26, v26, v50
    v_add_f32 v26, v26, v51
    v_add_f32 v26, v26, v52
    v_add_f32 v26, v26, v53
    v_add_f32 v26, v26, v54
    v_add_f32 v26, v26, v55
    v_max3_f32 v56, v92, v93, v94
    v_max3_f32 v56, v56, v95, v124
    v_max3_f32 v56, v56, v125, v126
    v_max3_f32 v56, v56, v127, 0
    v_mov_b32 v58, v56
    s_nop 1
    v_permlane16_swap_b32 v56, v58
    s_nop 1
    v_max_f32 v56, v56, v58
    v_mov_b32 v58, v56
    s_nop 1
    v_permlane32_swap_b32 v56, v58
    s_nop 1
    v_max_f32 v56, v56, v58
    v_exp_f32 v57, -v56
    v_sub_f32 v44, v44, v56
    v_sub_f32 v45, v45, v56
    v_sub_f32 v46, v46, v56
    v_sub_f32 v47, v47, v56
    v_mul_f32 v23, v23, v57
    v_sub_f32 v58, 1.0, v57
    v_sub_f32 v92, v92, v56
    v_sub_f32 v93, v93, v56
    v_sub_f32 v94, v94, v56
    v_sub_f32 v95, v95, v56
    v_sub_f32 v124, v124, v56
    v_sub_f32 v125, v125, v56
    v_sub_f32 v126, v126, v56
    v_sub_f32 v127, v127, v56
    v_sub_f32 v156, v156, v56
    v_sub_f32 v157, v157, v56
    v_sub_f32 v158, v158, v56
    v_sub_f32 v159, v159, v56
    v_sub_f32 v188, v188, v56
    v_sub_f32 v189, v189, v56
    v_sub_f32 v190, v190, v56
    v_sub_f32 v191, v191, v56
    v_accvgpr_read_b32 v48, a12
    v_accvgpr_read_b32 v49, a13
    v_accvgpr_read_b32 v50, a14
    v_accvgpr_read_b32 v51, a15
    v_fma_f32 v48, v48, v57, v58
    v_fma_f32 v49, v49, v57, v58
    v_fma_f32 v50, v50, v57, v58
    v_fma_f32 v51, v51, v57, v58
    v_accvgpr_write_b32 a12, v48
    v_accvgpr_write_b32 a13, v49
    v_accvgpr_write_b32 a14, v50
    v_accvgpr_write_b32 a15, v51
    v_accvgpr_read_b32 v48, a28
    v_accvgpr_read_b32 v49, a29
    v_accvgpr_read_b32 v50, a30
    v_accvgpr_read_b32 v51, a31
    v_fma_f32 v48, v48, v57, v58
    v_fma_f32 v49, v49, v57, v58
    v_fma_f32 v50, v50, v57, v58
    v_fma_f32 v51, v51, v57, v58
    v_accvgpr_write_b32 a28, v48
    v_accvgpr_write_b32 a29, v49
    v_accvgpr_write_b32 a30, v50
    v_accvgpr_write_b32 a31, v51
    v_accvgpr_read_b32 v48, a44
    v_accvgpr_read_b32 v49, a45
    v_accvgpr_read_b32 v50, a46
    v_accvgpr_read_b32 v51, a47
    v_fma_f32 v48, v48, v57, v58
    v_fma_f32 v49, v49, v57, v58
    v_fma_f32 v50, v50, v57, v58
    v_fma_f32 v51, v51, v57, v58
    v_accvgpr_write_b32 a44, v48
    v_accvgpr_write_b32 a45, v49
    v_accvgpr_write_b32 a46, v50
    v_accvgpr_write_b32 a47, v51
    v_accvgpr_read_b32 v48, a60
    v_accvgpr_read_b32 v49, a61
    v_accvgpr_read_b32 v50, a62
    v_accvgpr_read_b32 v51, a63
    v_fma_f32 v48, v48, v57, v58
    v_fma_f32 v49, v49, v57, v58
    v_fma_f32 v50, v50, v57, v58
    v_fma_f32 v51, v51, v57, v58
    v_accvgpr_write_b32 a60, v48
    v_accvgpr_write_b32 a61, v49
    v_accvgpr_write_b32 a62, v50
    v_accvgpr_write_b32 a63, v51
    v_accvgpr_read_b32 v48, a76
    v_accvgpr_read_b32 v49, a77
    v_accvgpr_read_b32 v50, a78
    v_accvgpr_read_b32 v51, a79
    v_fma_f32 v48, v48, v57, v58
    v_fma_f32 v49, v49, v57, v58
    v_fma_f32 v50, v50, v57, v58
    v_fma_f32 v51, v51, v57, v58
    v_accvgpr_write_b32 a76, v48
    v_accvgpr_write_b32 a77, v49
    v_accvgpr_write_b32 a78, v50
    v_accvgpr_write_b32 a79, v51
    v_accvgpr_read_b32 v48, a92
    v_accvgpr_read_b32 v49, a93
    v_accvgpr_read_b32 v50, a94
    v_accvgpr_read_b32 v51, a95
    v_fma_f32 v48, v48, v57, v58
    v_fma_f32 v49, v49, v57, v58
    v_fma_f32 v50, v50, v57, v58
    v_fma_f32 v51, v51, v57, v58
    v_accvgpr_write_b32 a92, v48
    v_accvgpr_write_b32 a93, v49
    v_accvgpr_write_b32 a94, v50
    v_accvgpr_write_b32 a95, v51
    v_accvgpr_read_b32 v48, a108
    v_accvgpr_read_b32 v49, a109
    v_accvgpr_read_b32 v50, a110
    v_accvgpr_read_b32 v51, a111
    v_fma_f32 v48, v48, v57, v58
    v_fma_f32 v49, v49, v57, v58
    v_fma_f32 v50, v50, v57, v58
    v_fma_f32 v51, v51, v57, v58
    v_accvgpr_write_b32 a108, v48
    v_accvgpr_write_b32 a109, v49
    v_accvgpr_write_b32 a110, v50
    v_accvgpr_write_b32 a111, v51
    v_accvgpr_read_b32 v48, a124
    v_accvgpr_read_b32 v49, a125
    v_accvgpr_read_b32 v50, a126
    v_accvgpr_read_b32 v51, a127
    v_fma_f32 v48, v48, v57, v58
    v_fma_f32 v49, v49, v57, v58
    v_fma_f32 v50, v50, v57, v58
    v_fma_f32 v51, v51, v57, v58
    v_accvgpr_write_b32 a124, v48
    v_accvgpr_write_b32 a125, v49
    v_accvgpr_write_b32 a126, v50
    v_accvgpr_write_b32 a127, v51
    v_accvgpr_read_b32 v48, a140
    v_accvgpr_read_b32 v49, a141
    v_accvgpr_read_b32 v50, a142
    v_accvgpr_read_b32 v51, a143
    v_fma_f32 v48, v48, v57, v58
    v_fma_f32 v49, v49, v57, v58
    v_fma_f32 v50, v50, v57, v58
    v_fma_f32 v51, v51, v57, v58
    v_accvgpr_write_b32 a140, v48
    v_accvgpr_write_b32 a141, v49
    v_accvgpr_write_b32 a142, v50
    v_accvgpr_write_b32 a143, v51
    v_accvgpr_read_b32 v48, a156
    v_accvgpr_read_b32 v49, a157
    v_accvgpr_read_b32 v50, a158
    v_accvgpr_read_b32 v51, a159
    v_fma_f32 v48, v48, v57, v58
    v_fma_f32 v49, v49, v57, v58
    v_fma_f32 v50, v50, v57, v58
    v_fma_f32 v51, v51, v57, v58
    v_accvgpr_write_b32 a156, v48
    v_accvgpr_write_b32 a157, v49
    v_accvgpr_write_b32 a158, v50
    v_accvgpr_write_b32 a159, v51
    v_accvgpr_read_b32 v48, a172
    v_accvgpr_read_b32 v49, a173
    v_accvgpr_read_b32 v50, a174
    v_accvgpr_read_b32 v51, a175
    v_fma_f32 v48, v48, v57, v58
    v_fma_f32 v49, v49, v57, v58
    v_fma_f32 v50, v50, v57, v58
    v_fma_f32 v51, v51, v57, v58
    v_accvgpr_write_b32 a172, v48
    v_accvgpr_write_b32 a173, v49
    v_accvgpr_write_b32 a174, v50
    v_accvgpr_write_b32 a175, v51
    v_accvgpr_read_b32 v48, a188
    v_accvgpr_read_b32 v49, a189
    v_accvgpr_read_b32 v50, a190
    v_accvgpr_read_b32 v51, a191
    v_fma_f32 v48, v48, v57, v58
    v_fma_f32 v49, v49, v57, v58
    v_fma_f32 v50, v50, v57, v58
    v_fma_f32 v51, v51, v57, v58
    v_accvgpr_write_b32 a188, v48
    v_accvgpr_write_b32 a189, v49
    v_accvgpr_write_b32 a190, v50
    v_accvgpr_write_b32 a191, v51
    v_exp_f32 v48, v92
    v_exp_f32 v49, v93
    v_exp_f32 v50, v94
    v_exp_f32 v51, v95
    v_exp_f32 v52, v124
    v_exp_f32 v53, v125
    v_exp_f32 v54, v126
    v_exp_f32 v55, v127
    s_nop 0
    v_cvt_pk_bf16_f32 v220, v48, v49
    v_cvt_pk_bf16_f32 v221, v50, v51
    v_cvt_pk_bf16_f32 v222, v52, v53
    v_cvt_pk_bf16_f32 v223, v54, v55
    v_add_f32 v27, v48, v49
    v_add_f32 v27, v27, v50
    v_add_f32 v27, v27, v51
    v_add_f32 v27, v27, v52
    v_add_f32 v27, v27, v53
    v_add_f32 v27, v27, v54
    v_add_f32 v27, v27, v55
    s_nop 1
    s_branch rare_b_ret
rare_e:
    s_nop 7
    s_nop 7
    v_max3_f32 v56, v132, v133, v134
    v_max3_f32 v56, v56, v135, v164
    v_max3_f32 v56, v56, v165, v166
    v_max3_f32 v56, v56, v167, 0
    v_mov_b32 v58, v56
    s_nop 1
    v_permlane16_swap_b32 v56, v58
    s_nop 1
    v_max_f32 v56, v56, v58
    v_mov_b32 v58, v56
    s_nop 1
    v_permlane32_swap_b32 v56, v58
    s_nop 1
    v_max_f32 v56, v56, v58
    v_exp_f32 v57, -v56
    v_sub_f32 v32, v32, v56
    v_sub_f32 v33, v33, v56
    v_sub_f32 v34, v34, v56
    v_sub_f32 v35, v35, v56
    v_mul_f32 v20, v20, v57
    v_sub_f32 v58, 1.0, v57
    v_sub_f32 v132, v132, v56
    v_sub_f32 v133, v133, v56
    v_sub_f32 v134, v134, v56
    v_sub_f32 v135, v135, v56
    v_sub_f32 v164, v164, v56
    v_sub_f32 v165, v165, v56
    v_sub_f32 v166, v166, v56
    v_sub_f32 v167, v167, v56
    v_accvgpr_read_b32 v48, a0
    v_accvgpr_read_b32 v49, a1
    v_accvgpr_read_b32 v50, a2
    v_accvgpr_read_b32 v51, a3
    v_fma_f32 v48, v48, v57, v58
    v_fma_f32 v49, v49, v57, v58
    v_fma_f32 v50, v50, v57, v58
    v_fma_f32 v51, v51, v57, v58
    v_accvgpr_write_b32 a0, v48
    v_accvgpr_write_b32 a1, v49
    v_accvgpr_write_b32 a2, v50
    v_accvgpr_write_b32 a3, v51
    v_accvgpr_read_b32 v48, a16
    v_accvgpr_read_b32 v49, a17
    v_accvgpr_read_b32 v50, a18
    v_accvgpr_read_b32 v51, a19
    v_fma_f32 v48, v48, v57, v58
    v_fma_f32 v49, v49, v57, v58
    v_fma_f32 v50, v50, v57, v58
    v_fma_f32 v51, v51, v57, v58
    v_accvgpr_write_b32 a16, v48
    v_accvgpr_write_b32 a17, v49
    v_accvgpr_write_b32 a18, v50
    v_accvgpr_write_b32 a19, v51
    v_accvgpr_read_b32 v48, a32
    v_accvgpr_read_b32 v49, a33
    v_accvgpr_read_b32 v50, a34
    v_accvgpr_read_b32 v51, a35
    v_fma_f32 v48, v48, v57, v58
    v_fma_f32 v49, v49, v57, v58
    v_fma_f32 v50, v50, v57, v58
    v_fma_f32 v51, v51, v57, v58
    v_accvgpr_write_b32 a32, v48
    v_accvgpr_write_b32 a33, v49
    v_accvgpr_write_b32 a34, v50
    v_accvgpr_write_b32 a35, v51
    v_accvgpr_read_b32 v48, a48
    v_accvgpr_read_b32 v49, a49
    v_accvgpr_read_b32 v50, a50
    v_accvgpr_read_b32 v51, a51
    v_fma_f32 v48, v48, v57, v58
    v_fma_f32 v49, v49, v57, v58
    v_fma_f32 v50, v50, v57, v58
    v_fma_f32 v51, v51, v57, v58
    v_accvgpr_write_b32 a48, v48
    v_accvgpr_write_b32 a49, v49
    v_accvgpr_write_b32 a50, v50
    v_accvgpr_write_b32 a51, v51
    v_accvgpr_read_b32 v48, a64
    v_accvgpr_read_b32 v49, a65
    v_accvgpr_read_b32 v50, a66
    v_accvgpr_read_b32 v51, a67
    v_fma_f32 v48, v48, v57, v58
    v_fma_f32 v49, v49, v57, v58
    v_fma_f32 v50, v50, v57, v58
    v_fma_f32 v51, v51, v57, v58
    v_accvgpr_write_b32 a64, v48
    v_accvgpr_write_b32 a65, v49
    v_accvgpr_write_b32 a66, v50
    v_accvgpr_write_b32 a67, v51
    v_accvgpr_read_b32 v48, a80
    v_accvgpr_read_b32 v49, a81
    v_accvgpr_read_b32 v50, a82
    v_accvgpr_read_b32 v51, a83
    v_fma_f32 v48, v48, v57, v58
    v_fma_f32 v49, v49, v57, v58
    v_fma_f32 v50, v50, v57, v58
    v_fma_f32 v51, v51, v57, v58
    v_accvgpr_write_b32 a80, v48
    v_accvgpr_write_b32 a81, v49
    v_accvgpr_write_b32 a82, v50
    v_accvgpr_write_b32 a83, v51
    v_accvgpr_read_b32 v48, a96
    v_accvgpr_read_b32 v49, a97
    v_accvgpr_read_b32 v50, a98
    v_accvgpr_read_b32 v51, a99
    v_fma_f32 v48, v48, v57, v58
    v_fma_f32 v49, v49, v57, v58
    v_fma_f32 v50, v50, v57, v58
    v_fma_f32 v51, v51, v57, v58
    v_accvgpr_write_b32 a96, v48
    v_accvgpr_write_b32 a97, v49
    v_accvgpr_write_b32 a98, v50
    v_accvgpr_write_b32 a99, v51
    v_accvgpr_read_b32 v48, a112
    v_accvgpr_read_b32 v49, a113
    v_accvgpr_read_b32 v50, a114
    v_accvgpr_read_b32 v51, a115
    v_fma_f32 v48, v48, v57, v58
    v_fma_f32 v49, v49, v57, v58
    v_fma_f32 v50, v50, v57, v58
    v_fma_f32 v51, v51, v57, v58
    v_accvgpr_write_b32 a112, v48
    v_accvgpr_write_b32 a113, v49
    v_accvgpr_write_b32 a114, v50
    v_accvgpr_write_b32 a115, v51
    v_accvgpr_read_b32 v48, a128
    v_accvgpr_read_b32 v49, a129
    v_accvgpr_read_b32 v50, a130
    v_accvgpr_read_b32 v51, a131
    v_fma_f32 v48, v48, v57, v58
    v_fma_f32 v49, v49, v57, v58
    v_fma_f32 v50, v50, v57, v58
    v_fma_f32 v51, v51, v57, v58
    v_accvgpr_write_b32 a128, v48
    v_accvgpr_write_b32 a129, v49
    v_accvgpr_write_b32 a130, v50
    v_accvgpr_write_b32 a131, v51
    v_accvgpr_read_b32 v48, a144
    v_accvgpr_read_b32 v49, a145
    v_accvgpr_read_b32 v50, a146
    v_accvgpr_read_b32 v51, a147
    v_fma_f32 v48, v48, v57, v58
    v_fma_f32 v49, v49, v57, v58
    v_fma_f32 v50, v50, v57, v58
    v_fma_f32 v51, v51, v57, v58
    v_accvgpr_write_b32 a144, v48
    v_accvgpr_write_b32 a145, v49
    v_accvgpr_write_b32 a146, v50
    v_accvgpr_write_b32 a147, v51
    v_accvgpr_read_b32 v48, a160
    v_accvgpr_read_b32 v49, a161
    v_accvgpr_read_b32 v50, a162
    v_accvgpr_read_b32 v51, a163
    v_fma_f32 v48, v48, v57, v58
    v_fma_f32 v49, v49, v57, v58
    v_fma_f32 v50, v50, v57, v58
    v_fma_f32 v51, v51, v57, v58
    v_accvgpr_write_b32 a160, v48
    v_accvgpr_write_b32 a161, v49
    v_accvgpr_write_b32 a162, v50
    v_accvgpr_write_b32 a163, v51
    v_accvgpr_read_b32 v48, a176
    v_accvgpr_read_b32 v49, a177
    v_accvgpr_read_b32 v50, a178
    v_accvgpr_read_b32 v51, a179
    v_fma_f32 v48, v48, v57, v58
    v_fma_f32 v49, v49, v57, v58
    v_fma_f32 v50, v50, v57, v58
    v_fma_f32 v51, v51, v57, v58
    v_accvgpr_write_b32 a176, v48
    v_accvgpr_write_b32 a177, v49
    v_accvgpr_write_b32 a178, v50
    v_accvgpr_write_b32 a179, v51
    v_exp_f32 v48, v132
    v_exp_f32 v49, v133
    v_exp_f32 v50, v134
    v_exp_f32 v51, v135
    v_exp_f32 v52, v164
    v_exp_f32 v53, v165
    v_exp_f32 v54, v166
    v_exp_f32 v55, v167
    s_nop 0
    v_cvt_pk_bf16_f32 v228, v48, v49
    v_cvt_pk_bf16_f32 v229, v50, v51
    v_cvt_pk_bf16_f32 v230, v52, v53
    v_cvt_pk_bf16_f32 v231, v54, v55
    v_add_f32 v24, v48, v49
    v_add_f32 v24, v24, v50
    v_add_f32 v24, v24, v51
    v_add_f32 v24, v24, v52
    v_add_f32 v24, v24, v53
    v_add_f32 v24, v24, v54
    v_add_f32 v24, v24, v55
    v_max3_f32 v56, v140, v141, v142
    v_max3_f32 v56, v56, v143, v172
    v_max3_f32 v56, v56, v173, v174
    v_max3_f32 v56, v56, v175, 0
    v_mov_b32 v58, v56
    s_nop 1
    v_permlane16_swap_b32 v56, v58
    s_nop 1
    v_max_f32 v56, v56, v58
    v_mov_b32 v58, v56
    s_nop 1
    v_permlane32_swap_b32 v56, v58
    s_nop 1
    v_max_f32 v56, v56, v58
    v_exp_f32 v57, -v56
    v_sub_f32 v36, v36, v56
    v_sub_f32 v37, v37, v56
    v_sub_f32 v38, v38, v56
    v_sub_f32 v39, v39, v56
    v_mul_f32 v21, v21, v57
    v_sub_f32 v58, 1.0, v57
    v_sub_f32 v140, v140, v56
    v_sub_f32 v141, v141, v56
    v_sub_f32 v142, v142, v56
    v_sub_f32 v143, v143, v56
    v_sub_f32 v172, v172, v56
    v_sub_f32 v173, v173, v56
    v_sub_f32 v174, v174, v56
    v_sub_f32 v175, v175, v56
    v_accvgpr_read_b32 v48, a4
    v_accvgpr_read_b32 v49, a5
    v_accvgpr_read_b32 v50, a6
    v_accvgpr_read_b32 v51, a7
    v_fma_f32 v48, v48, v57, v58
    v_fma_f32 v49, v49, v57, v58
    v_fma_f32 v50, v50, v57, v58
    v_fma_f32 v51, v51, v57, v58
    v_accvgpr_write_b32 a4, v48
    v_accvgpr_write_b32 a5, v49
    v_accvgpr_write_b32 a6, v50
    v_accvgpr_write_b32 a7, v51
    v_accvgpr_read_b32 v48, a20
    v_accvgpr_read_b32 v49, a21
    v_accvgpr_read_b32 v50, a22
    v_accvgpr_read_b32 v51, a23
    v_fma_f32 v48, v48, v57, v58
    v_fma_f32 v49, v49, v57, v58
    v_fma_f32 v50, v50, v57, v58
    v_fma_f32 v51, v51, v57, v58
    v_accvgpr_write_b32 a20, v48
    v_accvgpr_write_b32 a21, v49
    v_accvgpr_write_b32 a22, v50
    v_accvgpr_write_b32 a23, v51
    v_accvgpr_read_b32 v48, a36
    v_accvgpr_read_b32 v49, a37
    v_accvgpr_read_b32 v50, a38
    v_accvgpr_read_b32 v51, a39
    v_fma_f32 v48, v48, v57, v58
    v_fma_f32 v49, v49, v57, v58
    v_fma_f32 v50, v50, v57, v58
    v_fma_f32 v51, v51, v57, v58
    v_accvgpr_write_b32 a36, v48
    v_accvgpr_write_b32 a37, v49
    v_accvgpr_write_b32 a38, v50
    v_accvgpr_write_b32 a39, v51
    v_accvgpr_read_b32 v48, a52
    v_accvgpr_read_b32 v49, a53
    v_accvgpr_read_b32 v50, a54
    v_accvgpr_read_b32 v51, a55
    v_fma_f32 v48, v48, v57, v58
    v_fma_f32 v49, v49, v57, v58
    v_fma_f32 v50, v50, v57, v58
    v_fma_f32 v51, v51, v57, v58
    v_accvgpr_write_b32 a52, v48
    v_accvgpr_write_b32 a53, v49
    v_accvgpr_write_b32 a54, v50
    v_accvgpr_write_b32 a55, v51
    v_accvgpr_read_b32 v48, a68
    v_accvgpr_read_b32 v49, a69
    v_accvgpr_read_b32 v50, a70
    v_accvgpr_read_b32 v51, a71
    v_fma_f32 v48, v48, v57, v58
    v_fma_f32 v49, v49, v57, v58
    v_fma_f32 v50, v50, v57, v58
    v_fma_f32 v51, v51, v57, v58
    v_accvgpr_write_b32 a68, v48
    v_accvgpr_write_b32 a69, v49
    v_accvgpr_write_b32 a70, v50
    v_accvgpr_write_b32 a71, v51
    v_accvgpr_read_b32 v48, a84
    v_accvgpr_read_b32 v49, a85
    v_accvgpr_read_b32 v50, a86
    v_accvgpr_read_b32 v51, a87
    v_fma_f32 v48, v48, v57, v58
    v_fma_f32 v49, v49, v57, v58
    v_fma_f32 v50, v50, v57, v58
    v_fma_f32 v51, v51, v57, v58
    v_accvgpr_write_b32 a84, v48
    v_accvgpr_write_b32 a85, v49
    v_accvgpr_write_b32 a86, v50
    v_accvgpr_write_b32 a87, v51
    v_accvgpr_read_b32 v48, a100
    v_accvgpr_read_b32 v49, a101
    v_accvgpr_read_b32 v50, a102
    v_accvgpr_read_b32 v51, a103
    v_fma_f32 v48, v48, v57, v58
    v_fma_f32 v49, v49, v57, v58
    v_fma_f32 v50, v50, v57, v58
    v_fma_f32 v51, v51, v57, v58
    v_accvgpr_write_b32 a100, v48
    v_accvgpr_write_b32 a101, v49
    v_accvgpr_write_b32 a102, v50
    v_accvgpr_write_b32 a103, v51
    v_accvgpr_read_b32 v48, a116
    v_accvgpr_read_b32 v49, a117
    v_accvgpr_read_b32 v50, a118
    v_accvgpr_read_b32 v51, a119
    v_fma_f32 v48, v48, v57, v58
    v_fma_f32 v49, v49, v57, v58
    v_fma_f32 v50, v50, v57, v58
    v_fma_f32 v51, v51, v57, v58
    v_accvgpr_write_b32 a116, v48
    v_accvgpr_write_b32 a117, v49
    v_accvgpr_write_b32 a118, v50
    v_accvgpr_write_b32 a119, v51
    v_accvgpr_read_b32 v48, a132
    v_accvgpr_read_b32 v49, a133
    v_accvgpr_read_b32 v50, a134
    v_accvgpr_read_b32 v51, a135
    v_fma_f32 v48, v48, v57, v58
    v_fma_f32 v49, v49, v57, v58
    v_fma_f32 v50, v50, v57, v58
    v_fma_f32 v51, v51, v57, v58
    v_accvgpr_write_b32 a132, v48
    v_accvgpr_write_b32 a133, v49
    v_accvgpr_write_b32 a134, v50
    v_accvgpr_write_b32 a135, v51
    v_accvgpr_read_b32 v48, a148
    v_accvgpr_read_b32 v49, a149
    v_accvgpr_read_b32 v50, a150
    v_accvgpr_read_b32 v51, a151
    v_fma_f32 v48, v48, v57, v58
    v_fma_f32 v49, v49, v57, v58
    v_fma_f32 v50, v50, v57, v58
    v_fma_f32 v51, v51, v57, v58
    v_accvgpr_write_b32 a148, v48
    v_accvgpr_write_b32 a149, v49
    v_accvgpr_write_b32 a150, v50
    v_accvgpr_write_b32 a151, v51
    v_accvgpr_read_b32 v48, a164
    v_accvgpr_read_b32 v49, a165
    v_accvgpr_read_b32 v50, a166
    v_accvgpr_read_b32 v51, a167
    v_fma_f32 v48, v48, v57, v58
    v_fma_f32 v49, v49, v57, v58
    v_fma_f32 v50, v50, v57, v58
    v_fma_f32 v51, v51, v57, v58
    v_accvgpr_write_b32 a164, v48
    v_accvgpr_write_b32 a165, v49
    v_accvgpr_write_b32 a166, v50
    v_accvgpr_write_b32 a167, v51
    v_accvgpr_read_b32 v48, a180
    v_accvgpr_read_b32 v49, a181
    v_accvgpr_read_b32 v50, a182
    v_accvgpr_read_b32 v51, a183
    v_fma_f32 v48, v48, v57, v58
    v_fma_f32 v49, v49, v57, v58
    v_fma_f32 v50, v50, v57, v58
    v_fma_f32 v51, v51, v57, v58
    v_accvgpr_write_b32 a180, v48
    v_accvgpr_write_b32 a181, v49
    v_accvgpr_write_b32 a182, v50
    v_accvgpr_write_b32 a183, v51
    v_exp_f32 v48, v140
    v_exp_f32 v49, v141
    v_exp_f32 v50, v142
    v_exp_f32 v51, v143
    v_exp_f32 v52, v172
    v_exp_f32 v53, v173
    v_exp_f32 v54, v174
    v_exp_f32 v55, v175
    s_nop 0
    v_cvt_pk_bf16_f32 v236, v48, v49
    v_cvt_pk_bf16_f32 v237, v50, v51
    v_cvt_pk_bf16_f32 v238, v52, v53
    v_cvt_pk_bf16_f32 v239, v54, v55
    v_add_f32 v25, v48, v49
    v_add_f32 v25, v25, v50
    v_add_f32 v25, v25, v51
    v_add_f32 v25, v25, v52
    v_add_f32 v25, v25, v53
    v_add_f32 v25, v25, v54
    v_add_f32 v25, v25, v55
    v_max3_f32 v56, v148, v149, v150
    v_max3_f32 v56, v56, v151, v180
    v_max3_f32 v56, v56, v181, v182
    v_max3_f32 v56, v56, v183, 0
    v_mov_b32 v58, v56
    s_nop 1
    v_permlane16_swap_b32 v56, v58
    s_nop 1
    v_max_f32 v56, v56, v58
    v_mov_b32 v58, v56
    s_nop 1
    v_permlane32_swap_b32 v56, v58
    s_nop 1
    v_max_f32 v56, v56, v58
    v_exp_f32 v57, -v56
    v_sub_f32 v40, v40, v56
    v_sub_f32 v41, v41, v56
    v_sub_f32 v42, v42, v56
    v_sub_f32 v43, v43, v56
    v_mul_f32 v22, v22, v57
    v_sub_f32 v58, 1.0, v57
    v_sub_f32 v148, v148, v56
    v_sub_f32 v149, v149, v56
    v_sub_f32 v150, v150, v56
    v_sub_f32 v151, v151, v56
    v_sub_f32 v180, v180, v56
    v_sub_f32 v181, v181, v56
    v_sub_f32 v182, v182, v56
    v_sub_f32 v183, v183, v56
    v_accvgpr_read_b32 v48, a8
    v_accvgpr_read_b32 v49, a9
    v_accvgpr_read_b32 v50, a10
    v_accvgpr_read_b32 v51, a11
    v_fma_f32 v48, v48, v57, v58
    v_fma_f32 v49, v49, v57, v58
    v_fma_f32 v50, v50, v57, v58
    v_fma_f32 v51, v51, v57, v58
    v_accvgpr_write_b32 a8, v48
    v_accvgpr_write_b32 a9, v49
    v_accvgpr_write_b32 a10, v50
    v_accvgpr_write_b32 a11, v51
    v_accvgpr_read_b32 v48, a24
    v_accvgpr_read_b32 v49, a25
    v_accvgpr_read_b32 v50, a26
    v_accvgpr_read_b32 v51, a27
    v_fma_f32 v48, v48, v57, v58
    v_fma_f32 v49, v49, v57, v58
    v_fma_f32 v50, v50, v57, v58
    v_fma_f32 v51, v51, v57, v58
    v_accvgpr_write_b32 a24, v48
    v_accvgpr_write_b32 a25, v49
    v_accvgpr_write_b32 a26, v50
    v_accvgpr_write_b32 a27, v51
    v_accvgpr_read_b32 v48, a40
    v_accvgpr_read_b32 v49, a41
    v_accvgpr_read_b32 v50, a42
    v_accvgpr_read_b32 v51, a43
    v_fma_f32 v48, v48, v57, v58
    v_fma_f32 v49, v49, v57, v58
    v_fma_f32 v50, v50, v57, v58
    v_fma_f32 v51, v51, v57, v58
    v_accvgpr_write_b32 a40, v48
    v_accvgpr_write_b32 a41, v49
    v_accvgpr_write_b32 a42, v50
    v_accvgpr_write_b32 a43, v51
    v_accvgpr_read_b32 v48, a56
    v_accvgpr_read_b32 v49, a57
    v_accvgpr_read_b32 v50, a58
    v_accvgpr_read_b32 v51, a59
    v_fma_f32 v48, v48, v57, v58
    v_fma_f32 v49, v49, v57, v58
    v_fma_f32 v50, v50, v57, v58
    v_fma_f32 v51, v51, v57, v58
    v_accvgpr_write_b32 a56, v48
    v_accvgpr_write_b32 a57, v49
    v_accvgpr_write_b32 a58, v50
    v_accvgpr_write_b32 a59, v51
    v_accvgpr_read_b32 v48, a72
    v_accvgpr_read_b32 v49, a73
    v_accvgpr_read_b32 v50, a74
    v_accvgpr_read_b32 v51, a75
    v_fma_f32 v48, v48, v57, v58
    v_fma_f32 v49, v49, v57, v58
    v_fma_f32 v50, v50, v57, v58
    v_fma_f32 v51, v51, v57, v58
    v_accvgpr_write_b32 a72, v48
    v_accvgpr_write_b32 a73, v49
    v_accvgpr_write_b32 a74, v50
    v_accvgpr_write_b32 a75, v51
    v_accvgpr_read_b32 v48, a88
    v_accvgpr_read_b32 v49, a89
    v_accvgpr_read_b32 v50, a90
    v_accvgpr_read_b32 v51, a91
    v_fma_f32 v48, v48, v57, v58
    v_fma_f32 v49, v49, v57, v58
    v_fma_f32 v50, v50, v57, v58
    v_fma_f32 v51, v51, v57, v58
    v_accvgpr_write_b32 a88, v48
    v_accvgpr_write_b32 a89, v49
    v_accvgpr_write_b32 a90, v50
    v_accvgpr_write_b32 a91, v51
    v_accvgpr_read_b32 v48, a104
    v_accvgpr_read_b32 v49, a105
    v_accvgpr_read_b32 v50, a106
    v_accvgpr_read_b32 v51, a107
    v_fma_f32 v48, v48, v57, v58
    v_fma_f32 v49, v49, v57, v58
    v_fma_f32 v50, v50, v57, v58
    v_fma_f32 v51, v51, v57, v58
    v_accvgpr_write_b32 a104, v48
    v_accvgpr_write_b32 a105, v49
    v_accvgpr_write_b32 a106, v50
    v_accvgpr_write_b32 a107, v51
    v_accvgpr_read_b32 v48, a120
    v_accvgpr_read_b32 v49, a121
    v_accvgpr_read_b32 v50, a122
    v_accvgpr_read_b32 v51, a123
    v_fma_f32 v48, v48, v57, v58
    v_fma_f32 v49, v49, v57, v58
    v_fma_f32 v50, v50, v57, v58
    v_fma_f32 v51, v51, v57, v58
    v_accvgpr_write_b32 a120, v48
    v_accvgpr_write_b32 a121, v49
    v_accvgpr_write_b32 a122, v50
    v_accvgpr_write_b32 a123, v51
    v_accvgpr_read_b32 v48, a136
    v_accvgpr_read_b32 v49, a137
    v_accvgpr_read_b32 v50, a138
    v_accvgpr_read_b32 v51, a139
    v_fma_f32 v48, v48, v57, v58
    v_fma_f32 v49, v49, v57, v58
    v_fma_f32 v50, v50, v57, v58
    v_fma_f32 v51, v51, v57, v58
    v_accvgpr_write_b32 a136, v48
    v_accvgpr_write_b32 a137, v49
    v_accvgpr_write_b32 a138, v50
    v_accvgpr_write_b32 a139, v51
    v_accvgpr_read_b32 v48, a152
    v_accvgpr_read_b32 v49, a153
    v_accvgpr_read_b32 v50, a154
    v_accvgpr_read_b32 v51, a155
    v_fma_f32 v48, v48, v57, v58
    v_fma_f32 v49, v49, v57, v58
    v_fma_f32 v50, v50, v57, v58
    v_fma_f32 v51, v51, v57, v58
    v_accvgpr_write_b32 a152, v48
    v_accvgpr_write_b32 a153, v49
    v_accvgpr_write_b32 a154, v50
    v_accvgpr_write_b32 a155, v51
    v_accvgpr_read_b32 v48, a168
    v_accvgpr_read_b32 v49, a169
    v_accvgpr_read_b32 v50, a170
    v_accvgpr_read_b32 v51, a171
    v_fma_f32 v48, v48, v57, v58
    v_fma_f32 v49, v49, v57, v58
    v_fma_f32 v50, v50, v57, v58
    v_fma_f32 v51, v51, v57, v58
    v_accvgpr_write_b32 a168, v48
    v_accvgpr_write_b32 a169, v49
    v_accvgpr_write_b32 a170, v50
    v_accvgpr_write_b32 a171, v51
    v_accvgpr_read_b32 v48, a184
    v_accvgpr_read_b32 v49, a185
    v_accvgpr_read_b32 v50, a186
    v_accvgpr_read_b32 v51, a187
    v_fma_f32 v48, v48, v57, v58
    v_fma_f32 v49, v49, v57, v58
    v_fma_f32 v50, v50, v57, v58
    v_fma_f32 v51, v51, v57, v58
    v_accvgpr_write_b32 a184, v48
    v_accvgpr_write_b32 a185, v49
    v_accvgpr_write_b32 a186, v50
    v_accvgpr_write_b32 a187, v51
    v_exp_f32 v48, v148
    v_exp_f32 v49, v149
    v_exp_f32 v50, v150
    v_exp_f32 v51, v151
    v_exp_f32 v52, v180
    v_exp_f32 v53, v181
    v_exp_f32 v54, v182
    v_exp_f32 v55, v183
    s_nop 0
    v_cvt_pk_bf16_f32 v244, v48, v49
    v_cvt_pk_bf16_f32 v245, v50, v51
    v_cvt_pk_bf16_f32 v246, v52, v53
    v_cvt_pk_bf16_f32 v247, v54, v55
    v_add_f32 v26, v48, v49
    v_add_f32 v26, v26, v50
    v_add_f32 v26, v26, v51
    v_add_f32 v26, v26, v52
    v_add_f32 v26, v26, v53
    v_add_f32 v26, v26, v54
    v_add_f32 v26, v26, v55
    v_max3_f32 v56, v156, v157, v158
    v_max3_f32 v56, v56, v159, v188
    v_max3_f32 v56, v56, v189, v190
    v_max3_f32 v56, v56, v191, 0
    v_mov_b32 v58, v56
    s_nop 1
    v_permlane16_swap_b32 v56, v58
    s_nop 1
    v_max_f32 v56, v56, v58
    v_mov_b32 v58, v56
    s_nop 1
    v_permlane32_swap_b32 v56, v58
    s_nop 1
    v_max_f32 v56, v56, v58
    v_exp_f32 v57, -v56
    v_sub_f32 v44, v44, v56
    v_sub_f32 v45, v45, v56
    v_sub_f32 v46, v46, v56
    v_sub_f32 v47, v47, v56
    v_mul_f32 v23, v23, v57
    v_sub_f32 v58, 1.0, v57
    v_sub_f32 v156, v156, v56
    v_sub_f32 v157, v157, v56
    v_sub_f32 v158, v158, v56
    v_sub_f32 v159, v159, v56
    v_sub_f32 v188, v188, v56
    v_sub_f32 v189, v189, v56
    v_sub_f32 v190, v190, v56
    v_sub_f32 v191, v191, v56
    v_accvgpr_read_b32 v48, a12
    v_accvgpr_read_b32 v49, a13
    v_accvgpr_read_b32 v50, a14
    v_accvgpr_read_b32 v51, a15
    v_fma_f32 v48, v48, v57, v58
    v_fma_f32 v49, v49, v57, v58
    v_fma_f32 v50, v50, v57, v58
    v_fma_f32 v51, v51, v57, v58
    v_accvgpr_write_b32 a12, v48
    v_accvgpr_write_b32 a13, v49
    v_accvgpr_write_b32 a14, v50
    v_accvgpr_write_b32 a15, v51
    v_accvgpr_read_b32 v48, a28
    v_accvgpr_read_b32 v49, a29
    v_accvgpr_read_b32 v50, a30
    v_accvgpr_read_b32 v51, a31
    v_fma_f32 v48, v48, v57, v58
    v_fma_f32 v49, v49, v57, v58
    v_fma_f32 v50, v50, v57, v58
    v_fma_f32 v51, v51, v57, v58
    v_accvgpr_write_b32 a28, v48
    v_accvgpr_write_b32 a29, v49
    v_accvgpr_write_b32 a30, v50
    v_accvgpr_write_b32 a31, v51
    v_accvgpr_read_b32 v48, a44
    v_accvgpr_read_b32 v49, a45
    v_accvgpr_read_b32 v50, a46
    v_accvgpr_read_b32 v51, a47
    v_fma_f32 v48, v48, v57, v58
    v_fma_f32 v49, v49, v57, v58
    v_fma_f32 v50, v50, v57, v58
    v_fma_f32 v51, v51, v57, v58
    v_accvgpr_write_b32 a44, v48
    v_accvgpr_write_b32 a45, v49
    v_accvgpr_write_b32 a46, v50
    v_accvgpr_write_b32 a47, v51
    v_accvgpr_read_b32 v48, a60
    v_accvgpr_read_b32 v49, a61
    v_accvgpr_read_b32 v50, a62
    v_accvgpr_read_b32 v51, a63
    v_fma_f32 v48, v48, v57, v58
    v_fma_f32 v49, v49, v57, v58
    v_fma_f32 v50, v50, v57, v58
    v_fma_f32 v51, v51, v57, v58
    v_accvgpr_write_b32 a60, v48
    v_accvgpr_write_b32 a61, v49
    v_accvgpr_write_b32 a62, v50
    v_accvgpr_write_b32 a63, v51
    v_accvgpr_read_b32 v48, a76
    v_accvgpr_read_b32 v49, a77
    v_accvgpr_read_b32 v50, a78
    v_accvgpr_read_b32 v51, a79
    v_fma_f32 v48, v48, v57, v58
    v_fma_f32 v49, v49, v57, v58
    v_fma_f32 v50, v50, v57, v58
    v_fma_f32 v51, v51, v57, v58
    v_accvgpr_write_b32 a76, v48
    v_accvgpr_write_b32 a77, v49
    v_accvgpr_write_b32 a78, v50
    v_accvgpr_write_b32 a79, v51
    v_accvgpr_read_b32 v48, a92
    v_accvgpr_read_b32 v49, a93
    v_accvgpr_read_b32 v50, a94
    v_accvgpr_read_b32 v51, a95
    v_fma_f32 v48, v48, v57, v58
    v_fma_f32 v49, v49, v57, v58
    v_fma_f32 v50, v50, v57, v58
    v_fma_f32 v51, v51, v57, v58
    v_accvgpr_write_b32 a92, v48
    v_accvgpr_write_b32 a93, v49
    v_accvgpr_write_b32 a94, v50
    v_accvgpr_write_b32 a95, v51
    v_accvgpr_read_b32 v48, a108
    v_accvgpr_read_b32 v49, a109
    v_accvgpr_read_b32 v50, a110
    v_accvgpr_read_b32 v51, a111
    v_fma_f32 v48, v48, v57, v58
    v_fma_f32 v49, v49, v57, v58
    v_fma_f32 v50, v50, v57, v58
    v_fma_f32 v51, v51, v57, v58
    v_accvgpr_write_b32 a108, v48
    v_accvgpr_write_b32 a109, v49
    v_accvgpr_write_b32 a110, v50
    v_accvgpr_write_b32 a111, v51
    v_accvgpr_read_b32 v48, a124
    v_accvgpr_read_b32 v49, a125
    v_accvgpr_read_b32 v50, a126
    v_accvgpr_read_b32 v51, a127
    v_fma_f32 v48, v48, v57, v58
    v_fma_f32 v49, v49, v57, v58
    v_fma_f32 v50, v50, v57, v58
    v_fma_f32 v51, v51, v57, v58
    v_accvgpr_write_b32 a124, v48
    v_accvgpr_write_b32 a125, v49
    v_accvgpr_write_b32 a126, v50
    v_accvgpr_write_b32 a127, v51
    v_accvgpr_read_b32 v48, a140
    v_accvgpr_read_b32 v49, a141
    v_accvgpr_read_b32 v50, a142
    v_accvgpr_read_b32 v51, a143
    v_fma_f32 v48, v48, v57, v58
    v_fma_f32 v49, v49, v57, v58
    v_fma_f32 v50, v50, v57, v58
    v_fma_f32 v51, v51, v57, v58
    v_accvgpr_write_b32 a140, v48
    v_accvgpr_write_b32 a141, v49
    v_accvgpr_write_b32 a142, v50
    v_accvgpr_write_b32 a143, v51
    v_accvgpr_read_b32 v48, a156
    v_accvgpr_read_b32 v49, a157
    v_accvgpr_read_b32 v50, a158
    v_accvgpr_read_b32 v51, a159
    v_fma_f32 v48, v48, v57, v58
    v_fma_f32 v49, v49, v57, v58
    v_fma_f32 v50, v50, v57, v58
    v_fma_f32 v51, v51, v57, v58
    v_accvgpr_write_b32 a156, v48
    v_accvgpr_write_b32 a157, v49
    v_accvgpr_write_b32 a158, v50
    v_accvgpr_write_b32 a159, v51
    v_accvgpr_read_b32 v48, a172
    v_accvgpr_read_b32 v49, a173
    v_accvgpr_read_b32 v50, a174
    v_accvgpr_read_b32 v51, a175
    v_fma_f32 v48, v48, v57, v58
    v_fma_f32 v49, v49, v57, v58
    v_fma_f32 v50, v50, v57, v58
    v_fma_f32 v51, v51, v57, v58
    v_accvgpr_write_b32 a172, v48
    v_accvgpr_write_b32 a173, v49
    v_accvgpr_write_b32 a174, v50
    v_accvgpr_write_b32 a175, v51
    v_accvgpr_read_b32 v48, a188
    v_accvgpr_read_b32 v49, a189
    v_accvgpr_read_b32 v50, a190
    v_accvgpr_read_b32 v51, a191
    v_fma_f32 v48, v48, v57, v58
    v_fma_f32 v49, v49, v57, v58
    v_fma_f32 v50, v50, v57, v58
    v_fma_f32 v51, v51, v57, v58
    v_accvgpr_write_b32 a188, v48
    v_accvgpr_write_b32 a189, v49
    v_accvgpr_write_b32 a190, v50
    v_accvgpr_write_b32 a191, v51
    v_exp_f32 v48, v156
    v_exp_f32 v49, v157
    v_exp_f32 v50, v158
    v_exp_f32 v51, v159
    v_exp_f32 v52, v188
    v_exp_f32 v53, v189
    v_exp_f32 v54, v190
    v_exp_f32 v55, v191
    s_nop 0
    v_cvt_pk_bf16_f32 v252, v48, v49
    v_cvt_pk_bf16_f32 v253, v50, v51
    v_cvt_pk_bf16_f32 v254, v52, v53
    v_cvt_pk_bf16_f32 v255, v54, v55
    v_add_f32 v27, v48, v49
    v_add_f32 v27, v27, v50
    v_add_f32 v27, v27, v51
    v_add_f32 v27, v27, v52
    v_add_f32 v27, v27, v53
    v_add_f32 v27, v27, v54
    v_add_f32 v27, v27, v55
    s_nop 1
    s_branch rare_e_ret
.section .rodata,"a"
.p2align 6
.amdhsa_kernel recurrent_scan__sliding_block_cached__moe_arch_mod__prompt_kernel
  .amdhsa_next_free_vgpr 512
  .amdhsa_next_free_sgpr 102
  .amdhsa_accum_offset 256
  .amdhsa_group_segment_fixed_size 0
  .amdhsa_kernarg_size 104
  .amdhsa_user_sgpr_count 2
  .amdhsa_user_sgpr_kernarg_segment_ptr 1
  .amdhsa_system_sgpr_workgroup_id_x 1
  .amdhsa_float_denorm_mode_32 3
.end_amdhsa_kernel
```
